```python
import torch

def _softmax(x, axis=-1):
    return torch.softmax(x, dim=axis)
def _gelu(x):
    return torch.nn.functional.gelu(x, approximate="tanh")
def _silu(x):
    return torch.nn.functional.silu(x)
def _sigmoid(x):
    return torch.sigmoid(x)
def _layernorm(x, axis=-1, eps=1e-5):
    m = x.mean(dim=axis, keepdim=True)
    v = x.var(dim=axis, keepdim=True, unbiased=False)
    return (x - m) / torch.sqrt(v + eps)
def _scatter_add(tgt, idx, src, axis=0):
    return tgt.clone().index_add_(axis, idx, src)
def _segment_sum(src, seg, n):
    out = torch.zeros((n,) + src.shape[1:], dtype=src.dtype)
    return out.index_add_(0, seg, src)
def _pad(x, pw):
    flat = tuple(v for pair in reversed(pw) for v in pair)
    return torch.nn.functional.pad(x, flat)

kernel_name = 'concat_heads__mha_block_cached__gqa_block_cached__near_ridge'

def setup_inputs():

    _w = (lambda a: (lambda t: t.to(torch.bfloat16) if t.is_floating_point() else t)(torch.as_tensor(a)))
    def _A_setup():
        B, Sq, D = 16, 96, 640
        H, Sk, Dh = 32, 512, 192
        return {
            "x": _w((lambda *s: torch.randn(*s, dtype=torch.bfloat16) * 0.8)(B, Sq, D)),
            "k_cache": _w((lambda *s: torch.randn(*s, dtype=torch.bfloat16) * 0.8)(B, H, Sk, Dh)),
            "v_cache": _w((lambda *s: torch.randn(*s, dtype=torch.bfloat16) * 0.05)(B, H, Sk, Dh)),
            "wq": _w((lambda *s: torch.randn(*s, dtype=torch.bfloat16) * 0.8)(D, H * Dh) * (D ** -0.5)),
            "wo": _w((lambda *s: torch.randn(*s, dtype=torch.bfloat16) * 0.05)(H * Dh, D) * ((H * Dh) ** -0.5)),
        }
    _A_in = _A_setup()

    def _B_setup():
        B, Sq, D = 16, 96, 640
        Hq, Hkv, Sk, Dh = 32, 32, 512, 192
        assert Hq % Hkv == 0, (Hq, Hkv)
        return {
            "x": _w((lambda *s: torch.randn(*s, dtype=torch.bfloat16) * 0.8)(B, Sq, D)),
            "k_cache": _w((lambda *s: torch.randn(*s, dtype=torch.bfloat16) * 0.8)(B, Hkv, Sk, Dh)),
            "v_cache": _w((lambda *s: torch.randn(*s, dtype=torch.bfloat16) * 0.05)(B, Hkv, Sk, Dh)),
            "wq": _w((lambda *s: torch.randn(*s, dtype=torch.bfloat16) * 0.8)(D, Hq * Dh) * (D ** -0.5)),
            "wo": _w((lambda *s: torch.randn(*s, dtype=torch.bfloat16) * 0.05)(Hq * Dh, D) * ((Hq * Dh) ** -0.5)),
        }
    _B_in = _B_setup()

    return {
        "A_x": _A_in["x"],
        "A_k_cache": _A_in["k_cache"],
        "A_v_cache": _A_in["v_cache"],
        "A_wq": _A_in["wq"],
        "A_wo": _A_in["wo"],
        "B_x": _B_in["x"],
        "B_k_cache": _B_in["k_cache"],
        "B_v_cache": _B_in["v_cache"],
        "B_wq": _B_in["wq"],
        "B_wo": _B_in["wo"],
    }

def reference(A_x, A_k_cache, A_v_cache, A_wq, A_wo, B_x, B_k_cache, B_v_cache, B_wq, B_wo):
    def _A_ref(x, k_cache, v_cache, wq, wo):
        B, Sq, D = x.shape
        H, Dh = 32, 192
        q = (lambda x, *d: x.permute(*d))((x @ wq).reshape(B, Sq, H, Dh), 0, 2, 1, 3)
        scores = torch.einsum("bhqd,bhkd->bhqk", q, k_cache) * (Dh ** -0.5)
        p = _softmax(scores, axis=-1)
        o = torch.einsum("bhqk,bhkd->bhqd", p, v_cache)
        return (lambda x, *d: x.permute(*d))(o, 0, 2, 1, 3).reshape(B, Sq, H * Dh) @ wo

    def _B_ref(x, k_cache, v_cache, wq, wo):
        B, Sq, D = x.shape
        Hq, Dh = 32, 192
        Hkv = k_cache.shape[1]
        rep = Hq // Hkv
        q = (lambda x, *d: x.permute(*d))((x @ wq).reshape(B, Sq, Hq, Dh), 0, 2, 1, 3)
        k = (lambda x, n, axis: torch.repeat_interleave(x, n, dim=axis))(k_cache, rep, axis=1)
        v = (lambda x, n, axis: torch.repeat_interleave(x, n, dim=axis))(v_cache, rep, axis=1)
        scores = torch.einsum("bhqd,bhkd->bhqk", q, k) * (Dh ** -0.5)
        p = _softmax(scores, axis=-1)
        o = torch.einsum("bhqk,bhkd->bhqd", p, v)
        return (lambda x, *d: x.permute(*d))(o, 0, 2, 1, 3).reshape(B, Sq, Hq * Dh) @ wo

    a = _A_ref(A_x, A_k_cache, A_v_cache, A_wq, A_wo)
    b = _B_ref(B_x, B_k_cache, B_v_cache, B_wq, B_wo)
    return torch.concatenate([a, b], axis=-1)
```

```asm
; @launch grid=(256,1,1) block=(512,1,1) lds=163840
.amdgcn_target "amdgcn-amd-amdhsa--gfx950"
.text
.globl concat_heads__mha_block_cached__gqa_block_cached__near_ridge_kernel
.p2align 8
.type concat_heads__mha_block_cached__gqa_block_cached__near_ridge_kernel,@function
concat_heads__mha_block_cached__gqa_block_cached__near_ridge_kernel:
s_cmp_ge_u32 s2, 256
s_cbranch_scc1 L_exit_concat_heads__mha_block_cached__gqa_block_cached__near_ridge_kernel
s_load_dwordx16 s[4:19], s[0:1], 0
s_load_dwordx8 s[20:27], s[0:1], 64
s_load_dwordx2 s[28:29], s[0:1], 96
v_lshrrev_b32 v1, 6, v0
v_and_b32 v0, 63, v0
s_and_b32 s3, s2, 7
s_lshr_b32 s64, s3, 2
s_and_b32 s3, s3, 3
s_lshl_b32 s3, s3, 1
v_readfirstlane_b32 s67, v1
s_lshr_b32 s30, s2, 3
s_and_b32 s65, s30, 15
s_lshr_b32 s30, s30, 4
s_add_u32 s66, s3, s30
s_and_b32 s3, s67, 3
s_cmp_eq_u32 s3, 3
s_cselect_b32 s3, 4, 0
s_xor_b32 s67, s67, s3
s_mov_b32 s46, 1966080
s_mov_b32 s47, 0x20000
s_mov_b32 s42, 7864320
s_mov_b32 s43, 0x20000
s_mov_b32 s34, 100663296
s_mov_b32 s35, 0x20000
s_mov_b32 s38, 100663296
s_mov_b32 s39, 0x20000
s_mov_b32 s58, 7864320
s_mov_b32 s59, 0x20000
s_mov_b32 s62, 3932160
s_mov_b32 s63, 0x20000
s_mov_b32 s54, 256
s_mov_b32 s55, 0x20000
s_mov_b32 s50, 438042624
s_mov_b32 s51, 0x20000
s_cmp_lg_u32 s67, 3
s_cbranch_scc1 L_srd
s_setprio 3
s_mov_b32 s84, 0
v_mul_u32_u24 v2, 171, v0
v_lshrrev_b32 v2, 9, v2
v_mul_u32_u24 v3, 3, v2
v_sub_u32 v3, v0, v3
v_lshlrev_b32 v3, 7, v3
v_mul_u32_u24 v2, 12288, v2
v_add_u32 v2, v2, v3
v_mov_b32 v3, 0x7f000000
v_cmp_gt_u32 vcc, 30, v0
s_nop 1
v_cndmask_b32 v24, v3, v2, vcc
s_mul_i32 s81, s66, 384
s_mul_i32 s83, s65, 491520
s_add_u32 s83, s83, s81
v_lshrrev_b32 v2, 3, v0
v_add_u32 v2, 0, v2
v_and_b32 v3, 7, v0
v_bfe_u32 v4, v2, 1, 3
v_xor_b32 v3, v3, v4
v_lshlrev_b32 v3, 4, v3
v_mul_u32_u24 v2, 1280, v2
v_add_u32 v2, v2, v3
v_subrev_u32 v20, 0, v2
v_lshrrev_b32 v2, 3, v0
v_add_u32 v2, 8, v2
v_and_b32 v3, 7, v0
v_bfe_u32 v4, v2, 1, 3
v_xor_b32 v3, v3, v4
v_lshlrev_b32 v3, 4, v3
v_mul_u32_u24 v2, 1280, v2
v_add_u32 v2, v2, v3
v_subrev_u32 v21, 1024, v2
v_lshrrev_b32 v2, 3, v0
v_add_u32 v2, 16, v2
v_and_b32 v3, 7, v0
v_bfe_u32 v4, v2, 1, 3
v_xor_b32 v3, v3, v4
v_lshlrev_b32 v3, 4, v3
v_mul_u32_u24 v2, 1280, v2
v_add_u32 v2, v2, v3
v_subrev_u32 v22, 2048, v2
v_lshrrev_b32 v2, 3, v0
v_add_u32 v2, 24, v2
v_and_b32 v3, 7, v0
v_bfe_u32 v4, v2, 1, 3
v_xor_b32 v3, v3, v4
v_lshlrev_b32 v3, 4, v3
v_mul_u32_u24 v2, 1280, v2
v_add_u32 v2, v2, v3
v_subrev_u32 v23, 3072, v2
s_mul_i32 s82, s65, 122880
s_and_b32 s68, s66, 1
s_mul_i32 s69, s68, 640
s_mul_i32 s68, s68, 3932160
s_add_u32 s88, s82, s69
s_sub_u32 s89, s82, s69
s_add_u32 s93, s81, s68
s_sub_u32 s100, s81, s68
v_add_u32 v2, 0, v0
v_mul_u32_u24 v3, 2731, v2
v_lshrrev_b32 v3, 16, v3
v_mul_u32_u24 v4, 24, v3
v_sub_u32 v2, v2, v4
v_bfe_u32 v4, v3, 1, 1
v_lshlrev_b32 v4, 2, v4
v_xor_b32 v2, v2, v4
v_lshlrev_b32 v2, 4, v2
v_mul_u32_u24 v3, 12288, v3
v_add_u32 v2, v2, v3
v_subrev_u32 v17, 0, v2
v_add_u32 v2, 64, v0
v_mul_u32_u24 v3, 2731, v2
v_lshrrev_b32 v3, 16, v3
v_mul_u32_u24 v4, 24, v3
v_sub_u32 v2, v2, v4
v_bfe_u32 v4, v3, 1, 1
v_lshlrev_b32 v4, 2, v4
v_xor_b32 v2, v2, v4
v_lshlrev_b32 v2, 4, v2
v_mul_u32_u24 v3, 12288, v3
v_add_u32 v2, v2, v3
v_subrev_u32 v18, 1024, v2
v_add_u32 v2, 128, v0
v_mul_u32_u24 v3, 2731, v2
v_lshrrev_b32 v3, 16, v3
v_mul_u32_u24 v4, 24, v3
v_sub_u32 v2, v2, v4
v_bfe_u32 v4, v3, 1, 1
v_lshlrev_b32 v4, 2, v4
v_xor_b32 v2, v2, v4
v_lshlrev_b32 v2, 4, v2
v_mul_u32_u24 v3, 12288, v3
v_add_u32 v2, v2, v3
v_subrev_u32 v19, 2048, v2
v_add_u32 v2, 0, v0
v_mul_u32_u24 v3, 2731, v2
v_lshrrev_b32 v3, 16, v3
v_mul_u32_u24 v4, 24, v3
v_sub_u32 v2, v2, v4
v_bfe_u32 v4, v3, 1, 1
v_lshlrev_b32 v4, 2, v4
v_xor_b32 v4, 2, v4
v_xor_b32 v2, v2, v4
v_lshlrev_b32 v2, 4, v2
v_mul_u32_u24 v3, 12288, v3
v_add_u32 v2, v2, v3
v_subrev_u32 v32, 0, v2
v_add_u32 v2, 64, v0
v_mul_u32_u24 v3, 2731, v2
v_lshrrev_b32 v3, 16, v3
v_mul_u32_u24 v4, 24, v3
v_sub_u32 v2, v2, v4
v_bfe_u32 v4, v3, 1, 1
v_lshlrev_b32 v4, 2, v4
v_xor_b32 v4, 2, v4
v_xor_b32 v2, v2, v4
v_lshlrev_b32 v2, 4, v2
v_mul_u32_u24 v3, 12288, v3
v_add_u32 v2, v2, v3
v_subrev_u32 v33, 1024, v2
v_add_u32 v2, 128, v0
v_mul_u32_u24 v3, 2731, v2
v_lshrrev_b32 v3, 16, v3
v_mul_u32_u24 v4, 24, v3
v_sub_u32 v2, v2, v4
v_bfe_u32 v4, v3, 1, 1
v_lshlrev_b32 v4, 2, v4
v_xor_b32 v4, 2, v4
v_xor_b32 v2, v2, v4
v_lshlrev_b32 v2, 4, v2
v_mul_u32_u24 v3, 12288, v3
v_add_u32 v2, v2, v3
v_subrev_u32 v34, 2048, v2
s_waitcnt lgkmcnt(0)
s_cmp_eq_u32 s64, 1
s_cselect_b32 s44, s14, s4
s_cselect_b32 s45, s15, s5
s_cselect_b32 s40, s20, s10
s_cselect_b32 s41, s21, s11
s_branch L_loader
L_srd:
s_waitcnt lgkmcnt(0)
s_cmp_eq_u32 s64, 1
s_cselect_b32 s44, s14, s4
s_cselect_b32 s45, s15, s5
s_cselect_b32 s40, s20, s10
s_cselect_b32 s41, s21, s11
s_cselect_b32 s32, s16, s6
s_cselect_b32 s33, s17, s7
s_cselect_b32 s36, s18, s8
s_cselect_b32 s37, s19, s9
s_cselect_b32 s56, s22, s12
s_cselect_b32 s57, s23, s13
s_mov_b32 s60, s24
s_mov_b32 s61, s25
s_mov_b32 s52, s26
s_mov_b32 s53, s27
s_mov_b32 s48, s28
s_mov_b32 s49, s29
s_cmp_eq_u32 s67, 7
s_cbranch_scc1 L_w7
s_branch L_xy
L_exit_concat_heads__mha_block_cached__gqa_block_cached__near_ridge_kernel:
s_endpgm
L_loader:
s_mov_b32 m0, 163584
s_add_u32 s85, s83, 0
buffer_load_dword v24, s[40:43], s85 offen lds
s_mov_b32 m0, 163584
s_add_u32 s85, s83, 122880
buffer_load_dword v24, s[40:43], s85 offen lds
s_mov_b32 m0, 163584
s_add_u32 s85, s83, 245760
buffer_load_dword v24, s[40:43], s85 offen lds
s_mov_b32 m0, 163584
s_add_u32 s85, s83, 368640
buffer_load_dword v24, s[40:43], s85 offen lds
s_add_u32 s83, s83, 3072
s_add_u32 m0, s84, 0
s_add_u32 s85, s88, 0
buffer_load_dwordx4 v20, s[44:47], s85 offen offset:0 lds
buffer_load_dwordx4 v21, s[44:47], s85 offen offset:1024 lds
buffer_load_dwordx4 v22, s[44:47], s85 offen offset:2048 lds
buffer_load_dwordx4 v23, s[44:47], s85 offen offset:3072 lds
s_add_u32 m0, s84, 4096
s_add_u32 s85, s88, 40960
buffer_load_dwordx4 v20, s[44:47], s85 offen offset:0 lds
buffer_load_dwordx4 v21, s[44:47], s85 offen offset:1024 lds
buffer_load_dwordx4 v22, s[44:47], s85 offen offset:2048 lds
buffer_load_dwordx4 v23, s[44:47], s85 offen offset:3072 lds
s_add_u32 m0, s84, 8192
s_add_u32 s85, s88, 81920
buffer_load_dwordx4 v20, s[44:47], s85 offen offset:0 lds
buffer_load_dwordx4 v21, s[44:47], s85 offen offset:1024 lds
buffer_load_dwordx4 v22, s[44:47], s85 offen offset:2048 lds
buffer_load_dwordx4 v23, s[44:47], s85 offen offset:3072 lds
s_waitcnt vmcnt(44)
s_lshl_b32 s80, s65, 5
s_add_u32 s80, s80, s66
s_mul_i32 s80, s80, 196608
s_mul_i32 s77, s65, 5
s_mul_i32 s68, s66, 3
s_add_u32 s77, s77, s68
s_mul_i32 s68, s64, 7
s_add_u32 s77, s77, s68
s_and_b32 s77, s77, 15
s_mul_i32 s77, s77, 12288
s_add_u32 m0, s84, 73728
s_add_u32 s85, s93, 0
buffer_load_dwordx4 v17, s[40:43], s85 offen offset:0 lds
buffer_load_dwordx4 v18, s[40:43], s85 offen offset:1024 lds
buffer_load_dwordx4 v19, s[40:43], s85 offen offset:2048 lds
s_add_u32 m0, s84, 76800
s_add_u32 s85, s93, 98304
buffer_load_dwordx4 v32, s[40:43], s85 offen offset:0 lds
buffer_load_dwordx4 v33, s[40:43], s85 offen offset:1024 lds
buffer_load_dwordx4 v34, s[40:43], s85 offen offset:2048 lds
s_add_u32 m0, s84, 79872
s_add_u32 s85, s93, 196608
buffer_load_dwordx4 v17, s[40:43], s85 offen offset:0 lds
buffer_load_dwordx4 v18, s[40:43], s85 offen offset:1024 lds
buffer_load_dwordx4 v19, s[40:43], s85 offen offset:2048 lds
s_add_u32 m0, s84, 82944
s_add_u32 s85, s93, 294912
buffer_load_dwordx4 v32, s[40:43], s85 offen offset:0 lds
buffer_load_dwordx4 v33, s[40:43], s85 offen offset:1024 lds
buffer_load_dwordx4 v34, s[40:43], s85 offen offset:2048 lds
s_add_u32 m0, s84, 86016
s_add_u32 s85, s93, 393216
buffer_load_dwordx4 v17, s[40:43], s85 offen offset:0 lds
buffer_load_dwordx4 v18, s[40:43], s85 offen offset:1024 lds
buffer_load_dwordx4 v19, s[40:43], s85 offen offset:2048 lds
s_add_u32 m0, s84, 89088
s_add_u32 s85, s93, 491520
buffer_load_dwordx4 v32, s[40:43], s85 offen offset:0 lds
s_waitcnt vmcnt(44)
buffer_load_dwordx4 v33, s[40:43], s85 offen offset:1024 lds
buffer_load_dwordx4 v34, s[40:43], s85 offen offset:2048 lds
s_add_u32 m0, s84, 92160
s_add_u32 s85, s93, 589824
buffer_load_dwordx4 v17, s[40:43], s85 offen offset:0 lds
buffer_load_dwordx4 v18, s[40:43], s85 offen offset:1024 lds
buffer_load_dwordx4 v19, s[40:43], s85 offen offset:2048 lds
s_add_u32 m0, s84, 95232
s_add_u32 s85, s93, 688128
buffer_load_dwordx4 v32, s[40:43], s85 offen offset:0 lds
buffer_load_dwordx4 v33, s[40:43], s85 offen offset:1024 lds
buffer_load_dwordx4 v34, s[40:43], s85 offen offset:2048 lds
s_add_u32 m0, s84, 12288
s_add_u32 s85, s88, 128
buffer_load_dwordx4 v20, s[44:47], s85 offen offset:0 lds
buffer_load_dwordx4 v21, s[44:47], s85 offen offset:1024 lds
buffer_load_dwordx4 v22, s[44:47], s85 offen offset:2048 lds
buffer_load_dwordx4 v23, s[44:47], s85 offen offset:3072 lds
s_add_u32 m0, s84, 16384
s_add_u32 s85, s88, 41088
buffer_load_dwordx4 v20, s[44:47], s85 offen offset:0 lds
buffer_load_dwordx4 v21, s[44:47], s85 offen offset:1024 lds
buffer_load_dwordx4 v22, s[44:47], s85 offen offset:2048 lds
buffer_load_dwordx4 v23, s[44:47], s85 offen offset:3072 lds
s_waitcnt vmcnt(44)
s_add_u32 m0, s84, 20480
s_add_u32 s85, s88, 82048
buffer_load_dwordx4 v20, s[44:47], s85 offen offset:0 lds
buffer_load_dwordx4 v21, s[44:47], s85 offen offset:1024 lds
buffer_load_dwordx4 v22, s[44:47], s85 offen offset:2048 lds
buffer_load_dwordx4 v23, s[44:47], s85 offen offset:3072 lds
s_cmp_eq_u32 s64, 1
s_cselect_b32 s32, s16, s6
s_cselect_b32 s33, s17, s7
s_cselect_b32 s36, s18, s8
s_cselect_b32 s37, s19, s9
s_cselect_b32 s56, s22, s12
s_cselect_b32 s57, s23, s13
s_mov_b32 s60, s24
s_mov_b32 s61, s25
s_mov_b32 s52, s26
s_mov_b32 s53, s27
s_mov_b32 s48, s28
s_mov_b32 s49, s29
v_add_u32 v2, 0, v0
v_mul_u32_u24 v3, 2731, v2
v_lshrrev_b32 v3, 16, v3
v_mul_u32_u24 v4, 24, v3
v_sub_u32 v2, v2, v4
v_bfe_u32 v4, v3, 1, 3
v_xor_b32 v2, v2, v4
v_lshlrev_b32 v2, 4, v2
v_mul_u32_u24 v3, 384, v3
v_add_u32 v2, v2, v3
v_subrev_u32 v8, 0, v2
v_add_u32 v2, 64, v0
v_mul_u32_u24 v3, 2731, v2
v_lshrrev_b32 v3, 16, v3
v_mul_u32_u24 v4, 24, v3
v_sub_u32 v2, v2, v4
v_bfe_u32 v4, v3, 1, 3
v_xor_b32 v2, v2, v4
v_lshlrev_b32 v2, 4, v2
v_mul_u32_u24 v3, 384, v3
v_add_u32 v2, v2, v3
v_subrev_u32 v9, 1024, v2
v_add_u32 v2, 128, v0
v_mul_u32_u24 v3, 2731, v2
v_lshrrev_b32 v3, 16, v3
v_mul_u32_u24 v4, 24, v3
v_sub_u32 v2, v2, v4
v_bfe_u32 v4, v3, 1, 3
v_xor_b32 v2, v2, v4
v_lshlrev_b32 v2, 4, v2
v_mul_u32_u24 v3, 384, v3
v_add_u32 v2, v2, v3
v_subrev_u32 v10, 2048, v2
v_add_u32 v2, 192, v0
v_mul_u32_u24 v3, 2731, v2
v_lshrrev_b32 v3, 16, v3
v_mul_u32_u24 v4, 24, v3
v_sub_u32 v2, v2, v4
v_bfe_u32 v4, v3, 1, 3
v_xor_b32 v2, v2, v4
v_lshlrev_b32 v2, 4, v2
v_mul_u32_u24 v3, 384, v3
v_add_u32 v2, v2, v3
v_subrev_u32 v11, 3072, v2
v_add_u32 v2, 256, v0
v_mul_u32_u24 v3, 2731, v2
v_lshrrev_b32 v3, 16, v3
v_mul_u32_u24 v4, 24, v3
v_sub_u32 v2, v2, v4
v_bfe_u32 v4, v3, 1, 3
v_xor_b32 v2, v2, v4
v_lshlrev_b32 v2, 4, v2
v_mul_u32_u24 v3, 384, v3
v_add_u32 v2, v2, v3
v_subrev_u32 v12, 4096, v2
v_add_u32 v2, 320, v0
v_mul_u32_u24 v3, 2731, v2
v_lshrrev_b32 v3, 16, v3
v_mul_u32_u24 v4, 24, v3
v_sub_u32 v2, v2, v4
v_bfe_u32 v4, v3, 1, 3
v_xor_b32 v2, v2, v4
v_lshlrev_b32 v2, 4, v2
v_mul_u32_u24 v3, 384, v3
v_add_u32 v2, v2, v3
v_subrev_u32 v13, 5120, v2
v_add_u32 v2, 0, v0
v_mul_u32_u24 v3, 2731, v2
v_lshrrev_b32 v3, 16, v3
v_mul_u32_u24 v4, 24, v3
v_sub_u32 v2, v2, v4
v_bfe_u32 v4, v3, 1, 1
v_lshlrev_b32 v4, 2, v4
v_bfe_u32 v5, v3, 2, 1
v_lshl_add_u32 v4, v5, 1, v4
v_xor_b32 v2, v2, v4
v_lshlrev_b32 v2, 4, v2
v_mul_u32_u24 v3, 384, v3
v_add_u32 v2, v2, v3
v_subrev_u32 v14, 0, v2
v_add_u32 v2, 64, v0
v_mul_u32_u24 v3, 2731, v2
v_lshrrev_b32 v3, 16, v3
v_mul_u32_u24 v4, 24, v3
v_sub_u32 v2, v2, v4
v_bfe_u32 v4, v3, 1, 1
v_lshlrev_b32 v4, 2, v4
v_bfe_u32 v5, v3, 2, 1
v_lshl_add_u32 v4, v5, 1, v4
v_xor_b32 v2, v2, v4
v_lshlrev_b32 v2, 4, v2
v_mul_u32_u24 v3, 384, v3
v_add_u32 v2, v2, v3
v_subrev_u32 v15, 1024, v2
v_add_u32 v2, 128, v0
v_mul_u32_u24 v3, 2731, v2
v_lshrrev_b32 v3, 16, v3
v_mul_u32_u24 v4, 24, v3
v_sub_u32 v2, v2, v4
v_bfe_u32 v4, v3, 1, 1
v_lshlrev_b32 v4, 2, v4
v_bfe_u32 v5, v3, 2, 1
v_lshl_add_u32 v4, v5, 1, v4
v_xor_b32 v2, v2, v4
v_lshlrev_b32 v2, 4, v2
v_mul_u32_u24 v3, 384, v3
v_add_u32 v2, v2, v3
v_subrev_u32 v16, 2048, v2
s_waitcnt vmcnt(24)
s_barrier
s_add_u32 m0, s84, 24576
s_add_u32 s85, s88, 256
buffer_load_dwordx4 v20, s[44:47], s85 offen offset:0 lds
buffer_load_dwordx4 v21, s[44:47], s85 offen offset:1024 lds
buffer_load_dwordx4 v22, s[44:47], s85 offen offset:2048 lds
buffer_load_dwordx4 v23, s[44:47], s85 offen offset:3072 lds
s_add_u32 m0, s84, 28672
s_add_u32 s85, s88, 41216
buffer_load_dwordx4 v20, s[44:47], s85 offen offset:0 lds
buffer_load_dwordx4 v21, s[44:47], s85 offen offset:1024 lds
buffer_load_dwordx4 v22, s[44:47], s85 offen offset:2048 lds
buffer_load_dwordx4 v23, s[44:47], s85 offen offset:3072 lds
s_add_u32 m0, s84, 32768
s_add_u32 s85, s88, 82176
buffer_load_dwordx4 v20, s[44:47], s85 offen offset:0 lds
buffer_load_dwordx4 v21, s[44:47], s85 offen offset:1024 lds
buffer_load_dwordx4 v22, s[44:47], s85 offen offset:2048 lds
buffer_load_dwordx4 v23, s[44:47], s85 offen offset:3072 lds
s_waitcnt vmcnt(44)
s_mov_b32 m0, 163584
s_add_u32 s85, s83, 0
buffer_load_dword v24, s[40:43], s85 offen lds
s_waitcnt vmcnt(25)
s_barrier
s_add_u32 m0, s84, 98304
s_add_u32 s85, s93, 786432
buffer_load_dwordx4 v17, s[40:43], s85 offen offset:0 lds
buffer_load_dwordx4 v18, s[40:43], s85 offen offset:1024 lds
buffer_load_dwordx4 v19, s[40:43], s85 offen offset:2048 lds
s_add_u32 m0, s84, 101376
s_add_u32 s85, s93, 884736
buffer_load_dwordx4 v32, s[40:43], s85 offen offset:0 lds
buffer_load_dwordx4 v33, s[40:43], s85 offen offset:1024 lds
buffer_load_dwordx4 v34, s[40:43], s85 offen offset:2048 lds
s_add_u32 m0, s84, 104448
s_add_u32 s85, s93, 983040
buffer_load_dwordx4 v17, s[40:43], s85 offen offset:0 lds
buffer_load_dwordx4 v18, s[40:43], s85 offen offset:1024 lds
buffer_load_dwordx4 v19, s[40:43], s85 offen offset:2048 lds
s_add_u32 m0, s84, 107520
s_add_u32 s85, s93, 1081344
buffer_load_dwordx4 v32, s[40:43], s85 offen offset:0 lds
buffer_load_dwordx4 v33, s[40:43], s85 offen offset:1024 lds
buffer_load_dwordx4 v34, s[40:43], s85 offen offset:2048 lds
s_add_u32 m0, s84, 110592
s_add_u32 s85, s93, 1179648
buffer_load_dwordx4 v17, s[40:43], s85 offen offset:0 lds
buffer_load_dwordx4 v18, s[40:43], s85 offen offset:1024 lds
buffer_load_dwordx4 v19, s[40:43], s85 offen offset:2048 lds
s_waitcnt vmcnt(44)
s_add_u32 m0, s84, 113664
s_add_u32 s85, s93, 1277952
buffer_load_dwordx4 v32, s[40:43], s85 offen offset:0 lds
buffer_load_dwordx4 v33, s[40:43], s85 offen offset:1024 lds
buffer_load_dwordx4 v34, s[40:43], s85 offen offset:2048 lds
s_add_u32 m0, s84, 116736
s_add_u32 s85, s93, 1376256
buffer_load_dwordx4 v17, s[40:43], s85 offen offset:0 lds
buffer_load_dwordx4 v18, s[40:43], s85 offen offset:1024 lds
buffer_load_dwordx4 v19, s[40:43], s85 offen offset:2048 lds
s_add_u32 m0, s84, 119808
s_add_u32 s85, s93, 1474560
buffer_load_dwordx4 v32, s[40:43], s85 offen offset:0 lds
buffer_load_dwordx4 v33, s[40:43], s85 offen offset:1024 lds
buffer_load_dwordx4 v34, s[40:43], s85 offen offset:2048 lds
s_add_u32 m0, s84, 122880
s_add_u32 s85, s93, 1572864
buffer_load_dwordx4 v17, s[40:43], s85 offen offset:0 lds
buffer_load_dwordx4 v18, s[40:43], s85 offen offset:1024 lds
buffer_load_dwordx4 v19, s[40:43], s85 offen offset:2048 lds
s_add_u32 m0, s84, 125952
s_add_u32 s85, s93, 1671168
buffer_load_dwordx4 v32, s[40:43], s85 offen offset:0 lds
buffer_load_dwordx4 v33, s[40:43], s85 offen offset:1024 lds
buffer_load_dwordx4 v34, s[40:43], s85 offen offset:2048 lds
s_add_u32 m0, s84, 129024
s_add_u32 s85, s93, 1769472
buffer_load_dwordx4 v17, s[40:43], s85 offen offset:0 lds
s_waitcnt vmcnt(44)
buffer_load_dwordx4 v18, s[40:43], s85 offen offset:1024 lds
buffer_load_dwordx4 v19, s[40:43], s85 offen offset:2048 lds
s_add_u32 m0, s84, 132096
s_add_u32 s85, s93, 1867776
buffer_load_dwordx4 v32, s[40:43], s85 offen offset:0 lds
buffer_load_dwordx4 v33, s[40:43], s85 offen offset:1024 lds
buffer_load_dwordx4 v34, s[40:43], s85 offen offset:2048 lds
s_waitcnt vmcnt(24)
s_barrier
s_add_u32 m0, s84, 73728
s_add_u32 s85, s93, 1966080
buffer_load_dwordx4 v17, s[40:43], s85 offen offset:0 lds
buffer_load_dwordx4 v18, s[40:43], s85 offen offset:1024 lds
buffer_load_dwordx4 v19, s[40:43], s85 offen offset:2048 lds
s_add_u32 m0, s84, 76800
s_add_u32 s85, s93, 2064384
buffer_load_dwordx4 v32, s[40:43], s85 offen offset:0 lds
buffer_load_dwordx4 v33, s[40:43], s85 offen offset:1024 lds
buffer_load_dwordx4 v34, s[40:43], s85 offen offset:2048 lds
s_add_u32 m0, s84, 79872
s_add_u32 s85, s93, 2162688
buffer_load_dwordx4 v17, s[40:43], s85 offen offset:0 lds
buffer_load_dwordx4 v18, s[40:43], s85 offen offset:1024 lds
buffer_load_dwordx4 v19, s[40:43], s85 offen offset:2048 lds
s_add_u32 m0, s84, 82944
s_add_u32 s85, s93, 2260992
buffer_load_dwordx4 v32, s[40:43], s85 offen offset:0 lds
buffer_load_dwordx4 v33, s[40:43], s85 offen offset:1024 lds
s_waitcnt vmcnt(44)
buffer_load_dwordx4 v34, s[40:43], s85 offen offset:2048 lds
v_mul_u32_u24 v2, 1, v0
v_lshrrev_b32 v2, 1, v2
v_mul_u32_u24 v3, 2, v2
v_sub_u32 v3, v0, v3
v_lshlrev_b32 v3, 7, v3
v_mul_u32_u24 v2, 1280, v2
v_add_u32 v2, v2, v3
v_mov_b32 v3, 0x7f000000
v_cmp_gt_u32 vcc, 24, v0
s_nop 1
v_cndmask_b32 v25, v3, v2, vcc
v_mul_u32_u24 v2, 171, v0
v_lshrrev_b32 v2, 9, v2
v_mul_u32_u24 v3, 3, v2
v_sub_u32 v3, v0, v3
v_lshlrev_b32 v3, 7, v3
v_mul_u32_u24 v2, 12288, v2
v_add_u32 v2, v2, v3
v_mov_b32 v3, 0x7f000000
v_cmp_gt_u32 vcc, 30, v0
s_nop 1
v_cndmask_b32 v31, v3, v2, vcc
v_lshrrev_b32 v2, 4, v0
v_and_b32 v3, 15, v0
v_lshlrev_b32 v3, 4, v3
v_lshlrev_b32 v2, 3, v2
v_add_u32 v2, 0, v2
v_mul_u32_u24 v2, 1280, v2
v_add_u32 v2, v2, v3
v_subrev_u32 v26, 0, v2
v_lshrrev_b32 v2, 4, v0
v_and_b32 v3, 15, v0
v_lshlrev_b32 v3, 4, v3
v_lshlrev_b32 v2, 3, v2
v_add_u32 v2, 1, v2
v_mul_u32_u24 v2, 1280, v2
v_add_u32 v2, v2, v3
v_subrev_u32 v27, 1088, v2
v_lshrrev_b32 v2, 4, v0
v_and_b32 v3, 15, v0
v_lshlrev_b32 v3, 4, v3
v_lshlrev_b32 v2, 3, v2
v_add_u32 v2, 2, v2
v_mul_u32_u24 v2, 1280, v2
v_add_u32 v2, v2, v3
v_subrev_u32 v28, 2176, v2
v_lshrrev_b32 v2, 4, v0
v_and_b32 v3, 15, v0
v_lshlrev_b32 v3, 4, v3
v_lshlrev_b32 v2, 3, v2
v_add_u32 v2, 3, v2
v_mul_u32_u24 v2, 1280, v2
v_add_u32 v2, v2, v3
v_subrev_u32 v29, 3264, v2
v_lshrrev_b32 v2, 3, v0
v_and_b32 v3, 7, v0
v_bfe_u32 v4, v2, 1, 2
v_lshlrev_b32 v4, 1, v4
v_xor_b32 v3, v3, v4
v_lshlrev_b32 v3, 4, v3
v_add_u32 v2, 0, v2
v_mul_u32_u24 v2, 1280, v2
v_add_u32 v2, v2, v3
v_subrev_u32 v36, 0, v2
v_lshrrev_b32 v2, 3, v0
v_and_b32 v3, 7, v0
v_bfe_u32 v4, v2, 1, 2
v_lshlrev_b32 v4, 1, v4
v_xor_b32 v3, v3, v4
v_lshlrev_b32 v3, 4, v3
v_add_u32 v2, 8, v2
v_mul_u32_u24 v2, 1280, v2
v_add_u32 v2, v2, v3
v_subrev_u32 v37, 1024, v2
v_lshrrev_b32 v2, 3, v0
v_and_b32 v3, 7, v0
v_bfe_u32 v4, v2, 1, 2
v_lshlrev_b32 v4, 1, v4
v_xor_b32 v3, v3, v4
v_lshlrev_b32 v3, 4, v3
v_add_u32 v2, 16, v2
v_mul_u32_u24 v2, 1280, v2
v_add_u32 v2, v2, v3
v_subrev_u32 v38, 2048, v2
v_lshrrev_b32 v2, 3, v0
v_and_b32 v3, 7, v0
v_bfe_u32 v4, v2, 1, 2
v_lshlrev_b32 v4, 1, v4
v_xor_b32 v3, v3, v4
v_lshlrev_b32 v3, 4, v3
v_add_u32 v2, 24, v2
v_mul_u32_u24 v2, 1280, v2
v_add_u32 v2, v2, v3
v_subrev_u32 v39, 3072, v2
s_waitcnt vmcnt(24)
s_barrier
s_add_u32 m0, s84, 36864
s_add_u32 s85, s88, 384
buffer_load_dwordx4 v20, s[44:47], s85 offen offset:0 lds
buffer_load_dwordx4 v21, s[44:47], s85 offen offset:1024 lds
buffer_load_dwordx4 v22, s[44:47], s85 offen offset:2048 lds
buffer_load_dwordx4 v23, s[44:47], s85 offen offset:3072 lds
s_add_u32 m0, s84, 40960
s_add_u32 s85, s88, 41344
buffer_load_dwordx4 v20, s[44:47], s85 offen offset:0 lds
buffer_load_dwordx4 v21, s[44:47], s85 offen offset:1024 lds
buffer_load_dwordx4 v22, s[44:47], s85 offen offset:2048 lds
buffer_load_dwordx4 v23, s[44:47], s85 offen offset:3072 lds
s_add_u32 m0, s84, 45056
s_add_u32 s85, s88, 82304
buffer_load_dwordx4 v20, s[44:47], s85 offen offset:0 lds
buffer_load_dwordx4 v21, s[44:47], s85 offen offset:1024 lds
buffer_load_dwordx4 v22, s[44:47], s85 offen offset:2048 lds
buffer_load_dwordx4 v23, s[44:47], s85 offen offset:3072 lds
s_waitcnt vmcnt(24)
s_barrier
s_add_u32 m0, s84, 49152
s_add_u32 s85, s88, 512
buffer_load_dwordx4 v20, s[44:47], s85 offen offset:0 lds
buffer_load_dwordx4 v21, s[44:47], s85 offen offset:1024 lds
buffer_load_dwordx4 v22, s[44:47], s85 offen offset:2048 lds
s_waitcnt vmcnt(44)
buffer_load_dwordx4 v23, s[44:47], s85 offen offset:3072 lds
s_add_u32 m0, s84, 53248
s_add_u32 s85, s88, 41472
buffer_load_dwordx4 v20, s[44:47], s85 offen offset:0 lds
buffer_load_dwordx4 v21, s[44:47], s85 offen offset:1024 lds
buffer_load_dwordx4 v22, s[44:47], s85 offen offset:2048 lds
buffer_load_dwordx4 v23, s[44:47], s85 offen offset:3072 lds
s_add_u32 m0, s84, 57344
s_add_u32 s85, s88, 82432
buffer_load_dwordx4 v20, s[44:47], s85 offen offset:0 lds
buffer_load_dwordx4 v21, s[44:47], s85 offen offset:1024 lds
buffer_load_dwordx4 v22, s[44:47], s85 offen offset:2048 lds
buffer_load_dwordx4 v23, s[44:47], s85 offen offset:3072 lds
s_mov_b32 m0, 163584
s_add_u32 s85, s83, 122880
buffer_load_dword v24, s[40:43], s85 offen lds
s_waitcnt vmcnt(25)
s_barrier
s_add_u32 m0, s84, 86016
s_add_u32 s85, s93, 2359296
buffer_load_dwordx4 v17, s[40:43], s85 offen offset:0 lds
buffer_load_dwordx4 v18, s[40:43], s85 offen offset:1024 lds
buffer_load_dwordx4 v19, s[40:43], s85 offen offset:2048 lds
s_add_u32 m0, s84, 89088
s_add_u32 s85, s93, 2457600
buffer_load_dwordx4 v32, s[40:43], s85 offen offset:0 lds
buffer_load_dwordx4 v33, s[40:43], s85 offen offset:1024 lds
buffer_load_dwordx4 v34, s[40:43], s85 offen offset:2048 lds
s_waitcnt vmcnt(44)
s_add_u32 m0, s84, 92160
s_add_u32 s85, s93, 2555904
buffer_load_dwordx4 v17, s[40:43], s85 offen offset:0 lds
buffer_load_dwordx4 v18, s[40:43], s85 offen offset:1024 lds
buffer_load_dwordx4 v19, s[40:43], s85 offen offset:2048 lds
s_add_u32 m0, s84, 95232
s_add_u32 s85, s93, 2654208
buffer_load_dwordx4 v32, s[40:43], s85 offen offset:0 lds
buffer_load_dwordx4 v33, s[40:43], s85 offen offset:1024 lds
buffer_load_dwordx4 v34, s[40:43], s85 offen offset:2048 lds
s_add_u32 m0, s84, 98304
s_add_u32 s85, s93, 2752512
buffer_load_dwordx4 v17, s[40:43], s85 offen offset:0 lds
buffer_load_dwordx4 v18, s[40:43], s85 offen offset:1024 lds
buffer_load_dwordx4 v19, s[40:43], s85 offen offset:2048 lds
s_add_u32 m0, s84, 101376
s_add_u32 s85, s93, 2850816
buffer_load_dwordx4 v32, s[40:43], s85 offen offset:0 lds
buffer_load_dwordx4 v33, s[40:43], s85 offen offset:1024 lds
buffer_load_dwordx4 v34, s[40:43], s85 offen offset:2048 lds
s_add_u32 m0, s84, 104448
s_add_u32 s85, s93, 2949120
buffer_load_dwordx4 v17, s[40:43], s85 offen offset:0 lds
buffer_load_dwordx4 v18, s[40:43], s85 offen offset:1024 lds
buffer_load_dwordx4 v19, s[40:43], s85 offen offset:2048 lds
s_add_u32 m0, s84, 107520
s_add_u32 s85, s93, 3047424
buffer_load_dwordx4 v32, s[40:43], s85 offen offset:0 lds
s_waitcnt vmcnt(44)
buffer_load_dwordx4 v33, s[40:43], s85 offen offset:1024 lds
buffer_load_dwordx4 v34, s[40:43], s85 offen offset:2048 lds
s_add_u32 m0, s84, 110592
s_add_u32 s85, s93, 3145728
buffer_load_dwordx4 v17, s[40:43], s85 offen offset:0 lds
buffer_load_dwordx4 v18, s[40:43], s85 offen offset:1024 lds
buffer_load_dwordx4 v19, s[40:43], s85 offen offset:2048 lds
s_add_u32 m0, s84, 113664
s_add_u32 s85, s93, 3244032
buffer_load_dwordx4 v32, s[40:43], s85 offen offset:0 lds
buffer_load_dwordx4 v33, s[40:43], s85 offen offset:1024 lds
buffer_load_dwordx4 v34, s[40:43], s85 offen offset:2048 lds
s_add_u32 m0, s84, 116736
s_add_u32 s85, s93, 3342336
buffer_load_dwordx4 v17, s[40:43], s85 offen offset:0 lds
buffer_load_dwordx4 v18, s[40:43], s85 offen offset:1024 lds
buffer_load_dwordx4 v19, s[40:43], s85 offen offset:2048 lds
s_add_u32 m0, s84, 119808
s_add_u32 s85, s93, 3440640
buffer_load_dwordx4 v32, s[40:43], s85 offen offset:0 lds
buffer_load_dwordx4 v33, s[40:43], s85 offen offset:1024 lds
buffer_load_dwordx4 v34, s[40:43], s85 offen offset:2048 lds
s_waitcnt vmcnt(24)
s_barrier
s_add_u32 m0, s84, 122880
s_add_u32 s85, s93, 3538944
buffer_load_dwordx4 v17, s[40:43], s85 offen offset:0 lds
buffer_load_dwordx4 v18, s[40:43], s85 offen offset:1024 lds
s_waitcnt vmcnt(44)
buffer_load_dwordx4 v19, s[40:43], s85 offen offset:2048 lds
s_add_u32 m0, s84, 125952
s_add_u32 s85, s93, 3637248
buffer_load_dwordx4 v32, s[40:43], s85 offen offset:0 lds
buffer_load_dwordx4 v33, s[40:43], s85 offen offset:1024 lds
buffer_load_dwordx4 v34, s[40:43], s85 offen offset:2048 lds
s_add_u32 m0, s84, 129024
s_add_u32 s85, s93, 3735552
buffer_load_dwordx4 v17, s[40:43], s85 offen offset:0 lds
buffer_load_dwordx4 v18, s[40:43], s85 offen offset:1024 lds
buffer_load_dwordx4 v19, s[40:43], s85 offen offset:2048 lds
s_add_u32 m0, s84, 132096
s_add_u32 s85, s93, 3833856
buffer_load_dwordx4 v32, s[40:43], s85 offen offset:0 lds
buffer_load_dwordx4 v33, s[40:43], s85 offen offset:1024 lds
buffer_load_dwordx4 v34, s[40:43], s85 offen offset:2048 lds
s_waitcnt vmcnt(24)
s_barrier
s_add_u32 m0, s84, 61440
s_add_u32 s85, s89, 640
buffer_load_dwordx4 v20, s[44:47], s85 offen offset:0 lds
buffer_load_dwordx4 v21, s[44:47], s85 offen offset:1024 lds
buffer_load_dwordx4 v22, s[44:47], s85 offen offset:2048 lds
buffer_load_dwordx4 v23, s[44:47], s85 offen offset:3072 lds
s_add_u32 m0, s84, 65536
s_add_u32 s85, s89, 41600
buffer_load_dwordx4 v20, s[44:47], s85 offen offset:0 lds
buffer_load_dwordx4 v21, s[44:47], s85 offen offset:1024 lds
s_waitcnt vmcnt(44)
buffer_load_dwordx4 v22, s[44:47], s85 offen offset:2048 lds
buffer_load_dwordx4 v23, s[44:47], s85 offen offset:3072 lds
s_add_u32 m0, s84, 69632
s_add_u32 s85, s89, 82560
buffer_load_dwordx4 v20, s[44:47], s85 offen offset:0 lds
buffer_load_dwordx4 v21, s[44:47], s85 offen offset:1024 lds
buffer_load_dwordx4 v22, s[44:47], s85 offen offset:2048 lds
buffer_load_dwordx4 v23, s[44:47], s85 offen offset:3072 lds
s_waitcnt vmcnt(24)
s_barrier
s_add_u32 m0, s84, 73728
s_add_u32 s85, s100, 3932160
buffer_load_dwordx4 v17, s[40:43], s85 offen offset:0 lds
buffer_load_dwordx4 v18, s[40:43], s85 offen offset:1024 lds
buffer_load_dwordx4 v19, s[40:43], s85 offen offset:2048 lds
s_add_u32 m0, s84, 76800
s_add_u32 s85, s100, 4030464
buffer_load_dwordx4 v32, s[40:43], s85 offen offset:0 lds
buffer_load_dwordx4 v33, s[40:43], s85 offen offset:1024 lds
buffer_load_dwordx4 v34, s[40:43], s85 offen offset:2048 lds
s_add_u32 m0, s84, 79872
s_add_u32 s85, s100, 4128768
buffer_load_dwordx4 v17, s[40:43], s85 offen offset:0 lds
buffer_load_dwordx4 v18, s[40:43], s85 offen offset:1024 lds
buffer_load_dwordx4 v19, s[40:43], s85 offen offset:2048 lds
s_add_u32 m0, s84, 82944
s_add_u32 s85, s100, 4227072
buffer_load_dwordx4 v32, s[40:43], s85 offen offset:0 lds
s_waitcnt vmcnt(44)
buffer_load_dwordx4 v33, s[40:43], s85 offen offset:1024 lds
buffer_load_dwordx4 v34, s[40:43], s85 offen offset:2048 lds
s_waitcnt vmcnt(24)
s_barrier
s_add_u32 m0, s84, 86016
s_add_u32 s85, s100, 4325376
buffer_load_dwordx4 v17, s[40:43], s85 offen offset:0 lds
buffer_load_dwordx4 v18, s[40:43], s85 offen offset:1024 lds
buffer_load_dwordx4 v19, s[40:43], s85 offen offset:2048 lds
s_add_u32 m0, s84, 89088
s_add_u32 s85, s100, 4423680
buffer_load_dwordx4 v32, s[40:43], s85 offen offset:0 lds
buffer_load_dwordx4 v33, s[40:43], s85 offen offset:1024 lds
buffer_load_dwordx4 v34, s[40:43], s85 offen offset:2048 lds
s_add_u32 m0, s84, 92160
s_add_u32 s85, s100, 4521984
buffer_load_dwordx4 v17, s[40:43], s85 offen offset:0 lds
buffer_load_dwordx4 v18, s[40:43], s85 offen offset:1024 lds
buffer_load_dwordx4 v19, s[40:43], s85 offen offset:2048 lds
s_add_u32 m0, s84, 95232
s_add_u32 s85, s100, 4620288
buffer_load_dwordx4 v32, s[40:43], s85 offen offset:0 lds
buffer_load_dwordx4 v33, s[40:43], s85 offen offset:1024 lds
buffer_load_dwordx4 v34, s[40:43], s85 offen offset:2048 lds
s_add_u32 m0, s84, 0
s_add_u32 s85, s89, 768
buffer_load_dwordx4 v20, s[44:47], s85 offen offset:0 lds
buffer_load_dwordx4 v21, s[44:47], s85 offen offset:1024 lds
s_waitcnt vmcnt(44)
buffer_load_dwordx4 v22, s[44:47], s85 offen offset:2048 lds
buffer_load_dwordx4 v23, s[44:47], s85 offen offset:3072 lds
s_add_u32 m0, s84, 4096
s_add_u32 s85, s89, 41728
buffer_load_dwordx4 v20, s[44:47], s85 offen offset:0 lds
buffer_load_dwordx4 v21, s[44:47], s85 offen offset:1024 lds
buffer_load_dwordx4 v22, s[44:47], s85 offen offset:2048 lds
buffer_load_dwordx4 v23, s[44:47], s85 offen offset:3072 lds
s_add_u32 m0, s84, 8192
s_add_u32 s85, s89, 82688
buffer_load_dwordx4 v20, s[44:47], s85 offen offset:0 lds
buffer_load_dwordx4 v21, s[44:47], s85 offen offset:1024 lds
buffer_load_dwordx4 v22, s[44:47], s85 offen offset:2048 lds
buffer_load_dwordx4 v23, s[44:47], s85 offen offset:3072 lds
s_waitcnt vmcnt(24)
s_barrier
s_add_u32 m0, s84, 98304
s_add_u32 s85, s100, 4718592
buffer_load_dwordx4 v17, s[40:43], s85 offen offset:0 lds
buffer_load_dwordx4 v18, s[40:43], s85 offen offset:1024 lds
buffer_load_dwordx4 v19, s[40:43], s85 offen offset:2048 lds
s_add_u32 m0, s84, 101376
s_add_u32 s85, s100, 4816896
buffer_load_dwordx4 v32, s[40:43], s85 offen offset:0 lds
buffer_load_dwordx4 v33, s[40:43], s85 offen offset:1024 lds
buffer_load_dwordx4 v34, s[40:43], s85 offen offset:2048 lds
s_waitcnt vmcnt(44)
s_add_u32 m0, s84, 104448
s_add_u32 s85, s100, 4915200
buffer_load_dwordx4 v17, s[40:43], s85 offen offset:0 lds
buffer_load_dwordx4 v18, s[40:43], s85 offen offset:1024 lds
buffer_load_dwordx4 v19, s[40:43], s85 offen offset:2048 lds
s_add_u32 m0, s84, 107520
s_add_u32 s85, s100, 5013504
buffer_load_dwordx4 v32, s[40:43], s85 offen offset:0 lds
buffer_load_dwordx4 v33, s[40:43], s85 offen offset:1024 lds
buffer_load_dwordx4 v34, s[40:43], s85 offen offset:2048 lds
s_waitcnt vmcnt(24)
s_barrier
s_add_u32 m0, s84, 110592
s_add_u32 s85, s100, 5111808
buffer_load_dwordx4 v17, s[40:43], s85 offen offset:0 lds
buffer_load_dwordx4 v18, s[40:43], s85 offen offset:1024 lds
buffer_load_dwordx4 v19, s[40:43], s85 offen offset:2048 lds
s_add_u32 m0, s84, 113664
s_add_u32 s85, s100, 5210112
buffer_load_dwordx4 v32, s[40:43], s85 offen offset:0 lds
buffer_load_dwordx4 v33, s[40:43], s85 offen offset:1024 lds
buffer_load_dwordx4 v34, s[40:43], s85 offen offset:2048 lds
s_add_u32 m0, s84, 116736
s_add_u32 s85, s100, 5308416
buffer_load_dwordx4 v17, s[40:43], s85 offen offset:0 lds
buffer_load_dwordx4 v18, s[40:43], s85 offen offset:1024 lds
buffer_load_dwordx4 v19, s[40:43], s85 offen offset:2048 lds
s_add_u32 m0, s84, 119808
s_add_u32 s85, s100, 5406720
buffer_load_dwordx4 v32, s[40:43], s85 offen offset:0 lds
s_waitcnt vmcnt(44)
buffer_load_dwordx4 v33, s[40:43], s85 offen offset:1024 lds
buffer_load_dwordx4 v34, s[40:43], s85 offen offset:2048 lds
s_add_u32 m0, s84, 12288
s_add_u32 s85, s89, 896
buffer_load_dwordx4 v20, s[44:47], s85 offen offset:0 lds
buffer_load_dwordx4 v21, s[44:47], s85 offen offset:1024 lds
buffer_load_dwordx4 v22, s[44:47], s85 offen offset:2048 lds
buffer_load_dwordx4 v23, s[44:47], s85 offen offset:3072 lds
s_add_u32 m0, s84, 16384
s_add_u32 s85, s89, 41856
buffer_load_dwordx4 v20, s[44:47], s85 offen offset:0 lds
buffer_load_dwordx4 v21, s[44:47], s85 offen offset:1024 lds
buffer_load_dwordx4 v22, s[44:47], s85 offen offset:2048 lds
buffer_load_dwordx4 v23, s[44:47], s85 offen offset:3072 lds
s_add_u32 m0, s84, 20480
s_add_u32 s85, s89, 82816
buffer_load_dwordx4 v20, s[44:47], s85 offen offset:0 lds
buffer_load_dwordx4 v21, s[44:47], s85 offen offset:1024 lds
buffer_load_dwordx4 v22, s[44:47], s85 offen offset:2048 lds
buffer_load_dwordx4 v23, s[44:47], s85 offen offset:3072 lds
s_waitcnt vmcnt(24)
s_barrier
s_add_u32 m0, s84, 122880
s_add_u32 s85, s100, 5505024
buffer_load_dwordx4 v17, s[40:43], s85 offen offset:0 lds
buffer_load_dwordx4 v18, s[40:43], s85 offen offset:1024 lds
s_waitcnt vmcnt(44)
buffer_load_dwordx4 v19, s[40:43], s85 offen offset:2048 lds
s_add_u32 m0, s84, 125952
s_add_u32 s85, s100, 5603328
buffer_load_dwordx4 v32, s[40:43], s85 offen offset:0 lds
buffer_load_dwordx4 v33, s[40:43], s85 offen offset:1024 lds
buffer_load_dwordx4 v34, s[40:43], s85 offen offset:2048 lds
s_add_u32 m0, s84, 129024
s_add_u32 s85, s100, 5701632
buffer_load_dwordx4 v17, s[40:43], s85 offen offset:0 lds
buffer_load_dwordx4 v18, s[40:43], s85 offen offset:1024 lds
buffer_load_dwordx4 v19, s[40:43], s85 offen offset:2048 lds
s_add_u32 m0, s84, 132096
s_add_u32 s85, s100, 5799936
buffer_load_dwordx4 v32, s[40:43], s85 offen offset:0 lds
buffer_load_dwordx4 v33, s[40:43], s85 offen offset:1024 lds
buffer_load_dwordx4 v34, s[40:43], s85 offen offset:2048 lds
s_waitcnt vmcnt(24)
s_barrier
s_add_u32 m0, s84, 73728
s_add_u32 s85, s100, 5898240
buffer_load_dwordx4 v17, s[40:43], s85 offen offset:0 lds
buffer_load_dwordx4 v18, s[40:43], s85 offen offset:1024 lds
buffer_load_dwordx4 v19, s[40:43], s85 offen offset:2048 lds
s_add_u32 m0, s84, 76800
s_add_u32 s85, s100, 5996544
buffer_load_dwordx4 v32, s[40:43], s85 offen offset:0 lds
buffer_load_dwordx4 v33, s[40:43], s85 offen offset:1024 lds
buffer_load_dwordx4 v34, s[40:43], s85 offen offset:2048 lds
s_waitcnt vmcnt(44)
s_add_u32 m0, s84, 79872
s_add_u32 s85, s100, 6094848
buffer_load_dwordx4 v17, s[40:43], s85 offen offset:0 lds
buffer_load_dwordx4 v18, s[40:43], s85 offen offset:1024 lds
buffer_load_dwordx4 v19, s[40:43], s85 offen offset:2048 lds
s_add_u32 m0, s84, 82944
s_add_u32 s85, s100, 6193152
buffer_load_dwordx4 v32, s[40:43], s85 offen offset:0 lds
buffer_load_dwordx4 v33, s[40:43], s85 offen offset:1024 lds
buffer_load_dwordx4 v34, s[40:43], s85 offen offset:2048 lds
s_add_u32 m0, s84, 24576
s_add_u32 s85, s89, 1024
buffer_load_dwordx4 v20, s[44:47], s85 offen offset:0 lds
buffer_load_dwordx4 v21, s[44:47], s85 offen offset:1024 lds
buffer_load_dwordx4 v22, s[44:47], s85 offen offset:2048 lds
buffer_load_dwordx4 v23, s[44:47], s85 offen offset:3072 lds
s_add_u32 m0, s84, 28672
s_add_u32 s85, s89, 41984
buffer_load_dwordx4 v20, s[44:47], s85 offen offset:0 lds
buffer_load_dwordx4 v21, s[44:47], s85 offen offset:1024 lds
buffer_load_dwordx4 v22, s[44:47], s85 offen offset:2048 lds
buffer_load_dwordx4 v23, s[44:47], s85 offen offset:3072 lds
s_add_u32 m0, s84, 32768
s_add_u32 s85, s89, 82944
buffer_load_dwordx4 v20, s[44:47], s85 offen offset:0 lds
buffer_load_dwordx4 v21, s[44:47], s85 offen offset:1024 lds
s_waitcnt vmcnt(44)
buffer_load_dwordx4 v22, s[44:47], s85 offen offset:2048 lds
buffer_load_dwordx4 v23, s[44:47], s85 offen offset:3072 lds
s_waitcnt vmcnt(24)
s_barrier
s_add_u32 m0, s84, 86016
s_add_u32 s85, s100, 6291456
buffer_load_dwordx4 v17, s[40:43], s85 offen offset:0 lds
buffer_load_dwordx4 v18, s[40:43], s85 offen offset:1024 lds
buffer_load_dwordx4 v19, s[40:43], s85 offen offset:2048 lds
s_add_u32 m0, s84, 89088
s_add_u32 s85, s100, 6389760
buffer_load_dwordx4 v32, s[40:43], s85 offen offset:0 lds
buffer_load_dwordx4 v33, s[40:43], s85 offen offset:1024 lds
buffer_load_dwordx4 v34, s[40:43], s85 offen offset:2048 lds
s_add_u32 m0, s84, 92160
s_add_u32 s85, s100, 6488064
buffer_load_dwordx4 v17, s[40:43], s85 offen offset:0 lds
buffer_load_dwordx4 v18, s[40:43], s85 offen offset:1024 lds
buffer_load_dwordx4 v19, s[40:43], s85 offen offset:2048 lds
s_add_u32 m0, s84, 95232
s_add_u32 s85, s100, 6586368
buffer_load_dwordx4 v32, s[40:43], s85 offen offset:0 lds
buffer_load_dwordx4 v33, s[40:43], s85 offen offset:1024 lds
buffer_load_dwordx4 v34, s[40:43], s85 offen offset:2048 lds
s_waitcnt vmcnt(24)
s_barrier
s_add_u32 m0, s84, 98304
s_add_u32 s85, s100, 6684672
buffer_load_dwordx4 v17, s[40:43], s85 offen offset:0 lds
buffer_load_dwordx4 v18, s[40:43], s85 offen offset:1024 lds
s_waitcnt vmcnt(44)
buffer_load_dwordx4 v19, s[40:43], s85 offen offset:2048 lds
s_add_u32 m0, s84, 101376
s_add_u32 s85, s100, 6782976
buffer_load_dwordx4 v32, s[40:43], s85 offen offset:0 lds
buffer_load_dwordx4 v33, s[40:43], s85 offen offset:1024 lds
buffer_load_dwordx4 v34, s[40:43], s85 offen offset:2048 lds
s_add_u32 m0, s84, 104448
s_add_u32 s85, s100, 6881280
buffer_load_dwordx4 v17, s[40:43], s85 offen offset:0 lds
buffer_load_dwordx4 v18, s[40:43], s85 offen offset:1024 lds
buffer_load_dwordx4 v19, s[40:43], s85 offen offset:2048 lds
s_add_u32 m0, s84, 107520
s_add_u32 s85, s100, 6979584
buffer_load_dwordx4 v32, s[40:43], s85 offen offset:0 lds
buffer_load_dwordx4 v33, s[40:43], s85 offen offset:1024 lds
buffer_load_dwordx4 v34, s[40:43], s85 offen offset:2048 lds
s_add_u32 m0, s84, 147456
s_add_u32 s85, s89, 1152
buffer_load_dwordx4 v20, s[44:47], s85 offen offset:0 lds
buffer_load_dwordx4 v21, s[44:47], s85 offen offset:1024 lds
buffer_load_dwordx4 v22, s[44:47], s85 offen offset:2048 lds
buffer_load_dwordx4 v23, s[44:47], s85 offen offset:3072 lds
s_add_u32 m0, s84, 151552
s_add_u32 s85, s89, 42112
buffer_load_dwordx4 v20, s[44:47], s85 offen offset:0 lds
buffer_load_dwordx4 v21, s[44:47], s85 offen offset:1024 lds
s_waitcnt vmcnt(44)
buffer_load_dwordx4 v22, s[44:47], s85 offen offset:2048 lds
buffer_load_dwordx4 v23, s[44:47], s85 offen offset:3072 lds
s_add_u32 m0, s84, 155648
s_add_u32 s85, s89, 83072
buffer_load_dwordx4 v20, s[44:47], s85 offen offset:0 lds
buffer_load_dwordx4 v21, s[44:47], s85 offen offset:1024 lds
buffer_load_dwordx4 v22, s[44:47], s85 offen offset:2048 lds
buffer_load_dwordx4 v23, s[44:47], s85 offen offset:3072 lds
s_waitcnt vmcnt(24)
s_barrier
s_add_u32 m0, s84, 110592
s_add_u32 s85, s100, 7077888
buffer_load_dwordx4 v17, s[40:43], s85 offen offset:0 lds
buffer_load_dwordx4 v18, s[40:43], s85 offen offset:1024 lds
buffer_load_dwordx4 v19, s[40:43], s85 offen offset:2048 lds
s_add_u32 m0, s84, 113664
s_add_u32 s85, s100, 7176192
buffer_load_dwordx4 v32, s[40:43], s85 offen offset:0 lds
buffer_load_dwordx4 v33, s[40:43], s85 offen offset:1024 lds
buffer_load_dwordx4 v34, s[40:43], s85 offen offset:2048 lds
s_add_u32 m0, s84, 116736
s_add_u32 s85, s100, 7274496
buffer_load_dwordx4 v17, s[40:43], s85 offen offset:0 lds
buffer_load_dwordx4 v18, s[40:43], s85 offen offset:1024 lds
buffer_load_dwordx4 v19, s[40:43], s85 offen offset:2048 lds
s_add_u32 m0, s84, 119808
s_add_u32 s85, s100, 7372800
buffer_load_dwordx4 v32, s[40:43], s85 offen offset:0 lds
s_waitcnt vmcnt(44)
buffer_load_dwordx4 v33, s[40:43], s85 offen offset:1024 lds
buffer_load_dwordx4 v34, s[40:43], s85 offen offset:2048 lds
s_waitcnt vmcnt(24)
s_barrier
s_add_u32 m0, s84, 122880
s_add_u32 s85, s100, 7471104
buffer_load_dwordx4 v17, s[40:43], s85 offen offset:0 lds
buffer_load_dwordx4 v18, s[40:43], s85 offen offset:1024 lds
buffer_load_dwordx4 v19, s[40:43], s85 offen offset:2048 lds
s_add_u32 m0, s84, 125952
s_add_u32 s85, s100, 7569408
buffer_load_dwordx4 v32, s[40:43], s85 offen offset:0 lds
buffer_load_dwordx4 v33, s[40:43], s85 offen offset:1024 lds
buffer_load_dwordx4 v34, s[40:43], s85 offen offset:2048 lds
s_add_u32 m0, s84, 129024
s_add_u32 s85, s100, 7667712
buffer_load_dwordx4 v17, s[40:43], s85 offen offset:0 lds
buffer_load_dwordx4 v18, s[40:43], s85 offen offset:1024 lds
buffer_load_dwordx4 v19, s[40:43], s85 offen offset:2048 lds
s_add_u32 m0, s84, 132096
s_add_u32 s85, s100, 7766016
buffer_load_dwordx4 v32, s[40:43], s85 offen offset:0 lds
buffer_load_dwordx4 v33, s[40:43], s85 offen offset:1024 lds
buffer_load_dwordx4 v34, s[40:43], s85 offen offset:2048 lds
s_add_u32 s101, s80, s77
s_add_u32 m0, s84, 49152
s_add_u32 s85, s101, 0
buffer_load_dwordx4 v8, s[32:35], s85 offen offset:0 nt lds
buffer_load_dwordx4 v9, s[32:35], s85 offen offset:1024 nt lds
s_waitcnt vmcnt(44)
buffer_load_dwordx4 v10, s[32:35], s85 offen offset:2048 nt lds
s_add_u32 m0, s84, 52224
s_add_u32 s85, s101, 3072
buffer_load_dwordx4 v11, s[32:35], s85 offen offset:0 nt lds
buffer_load_dwordx4 v12, s[32:35], s85 offen offset:1024 nt lds
buffer_load_dwordx4 v13, s[32:35], s85 offen offset:2048 nt lds
s_add_u32 m0, s84, 55296
s_add_u32 s85, s101, 6144
buffer_load_dwordx4 v8, s[32:35], s85 offen offset:0 nt lds
buffer_load_dwordx4 v9, s[32:35], s85 offen offset:1024 nt lds
buffer_load_dwordx4 v10, s[32:35], s85 offen offset:2048 nt lds
s_add_u32 m0, s84, 58368
s_add_u32 s85, s101, 9216
buffer_load_dwordx4 v11, s[32:35], s85 offen offset:0 nt lds
buffer_load_dwordx4 v12, s[32:35], s85 offen offset:1024 nt lds
buffer_load_dwordx4 v13, s[32:35], s85 offen offset:2048 nt lds
s_waitcnt vmcnt(24)
s_barrier
s_add_u32 m0, s84, 61440
s_add_u32 s85, s101, 0
buffer_load_dwordx4 v14, s[36:39], s85 offen offset:0 nt lds
buffer_load_dwordx4 v15, s[36:39], s85 offen offset:1024 nt lds
buffer_load_dwordx4 v16, s[36:39], s85 offen offset:2048 nt lds
s_add_u32 m0, s84, 64512
s_add_u32 s85, s101, 3072
buffer_load_dwordx4 v14, s[36:39], s85 offen offset:0 nt lds
buffer_load_dwordx4 v15, s[36:39], s85 offen offset:1024 nt lds
buffer_load_dwordx4 v16, s[36:39], s85 offen offset:2048 nt lds
s_waitcnt vmcnt(44)
s_add_u32 m0, s84, 67584
s_add_u32 s85, s101, 6144
buffer_load_dwordx4 v14, s[36:39], s85 offen offset:0 nt lds
buffer_load_dwordx4 v15, s[36:39], s85 offen offset:1024 nt lds
buffer_load_dwordx4 v16, s[36:39], s85 offen offset:2048 nt lds
s_add_u32 m0, s84, 70656
s_add_u32 s85, s101, 9216
buffer_load_dwordx4 v14, s[36:39], s85 offen offset:0 nt lds
buffer_load_dwordx4 v15, s[36:39], s85 offen offset:1024 nt lds
buffer_load_dwordx4 v16, s[36:39], s85 offen offset:2048 nt lds
s_add_u32 s77, s77, 12288
s_cmp_eq_u32 s77, 196608
s_cselect_b32 s77, 0, s77
s_mov_b32 m0, 163584
s_add_u32 s85, s83, 245760
buffer_load_dword v24, s[40:43], s85 offen lds
s_waitcnt vmcnt(25)
s_barrier
s_add_u32 s101, s80, s77
s_add_u32 m0, s84, 0
s_add_u32 s85, s101, 0
buffer_load_dwordx4 v8, s[32:35], s85 offen offset:0 nt lds
buffer_load_dwordx4 v9, s[32:35], s85 offen offset:1024 nt lds
buffer_load_dwordx4 v10, s[32:35], s85 offen offset:2048 nt lds
s_add_u32 m0, s84, 3072
s_add_u32 s85, s101, 3072
buffer_load_dwordx4 v11, s[32:35], s85 offen offset:0 nt lds
buffer_load_dwordx4 v12, s[32:35], s85 offen offset:1024 nt lds
buffer_load_dwordx4 v13, s[32:35], s85 offen offset:2048 nt lds
s_add_u32 m0, s84, 6144
s_add_u32 s85, s101, 6144
buffer_load_dwordx4 v8, s[32:35], s85 offen offset:0 nt lds
buffer_load_dwordx4 v9, s[32:35], s85 offen offset:1024 nt lds
buffer_load_dwordx4 v10, s[32:35], s85 offen offset:2048 nt lds
s_waitcnt vmcnt(44)
s_add_u32 m0, s84, 9216
s_add_u32 s85, s101, 9216
buffer_load_dwordx4 v11, s[32:35], s85 offen offset:0 nt lds
buffer_load_dwordx4 v12, s[32:35], s85 offen offset:1024 nt lds
buffer_load_dwordx4 v13, s[32:35], s85 offen offset:2048 nt lds
s_add_u32 m0, s84, 12288
s_add_u32 s85, s101, 0
buffer_load_dwordx4 v14, s[36:39], s85 offen offset:0 nt lds
buffer_load_dwordx4 v15, s[36:39], s85 offen offset:1024 nt lds
buffer_load_dwordx4 v16, s[36:39], s85 offen offset:2048 nt lds
s_add_u32 m0, s84, 15360
s_add_u32 s85, s101, 3072
buffer_load_dwordx4 v14, s[36:39], s85 offen offset:0 nt lds
buffer_load_dwordx4 v15, s[36:39], s85 offen offset:1024 nt lds
buffer_load_dwordx4 v16, s[36:39], s85 offen offset:2048 nt lds
s_add_u32 m0, s84, 18432
s_add_u32 s85, s101, 6144
buffer_load_dwordx4 v14, s[36:39], s85 offen offset:0 nt lds
buffer_load_dwordx4 v15, s[36:39], s85 offen offset:1024 nt lds
buffer_load_dwordx4 v16, s[36:39], s85 offen offset:2048 nt lds
s_add_u32 m0, s84, 21504
s_add_u32 s85, s101, 9216
buffer_load_dwordx4 v14, s[36:39], s85 offen offset:0 nt lds
buffer_load_dwordx4 v15, s[36:39], s85 offen offset:1024 nt lds
buffer_load_dwordx4 v16, s[36:39], s85 offen offset:2048 nt lds
s_add_u32 s77, s77, 12288
s_cmp_eq_u32 s77, 196608
s_cselect_b32 s77, 0, s77
s_mov_b32 m0, 163584
s_add_u32 s85, s83, 368640
buffer_load_dword v24, s[40:43], s85 offen lds
s_waitcnt vmcnt(26)
s_barrier
s_mov_b32 s75, 24576
s_add_u32 s93, s93, 3072
s_add_u32 s100, s100, 3072
s_add_u32 s83, s83, 3072
s_mov_b32 s74, 0
s_mul_i32 s86, s66, 245760
s_mul_i32 s87, s65, 15360
s_add_u32 s87, s87, s86
L_ld_round:
s_add_u32 m0, s84, 73728
s_add_u32 s85, s93, 0
buffer_load_dwordx4 v17, s[40:43], s85 offen offset:0 lds
buffer_load_dwordx4 v18, s[40:43], s85 offen offset:1024 lds
buffer_load_dwordx4 v19, s[40:43], s85 offen offset:2048 lds
s_add_u32 m0, s84, 76800
s_add_u32 s85, s93, 98304
buffer_load_dwordx4 v32, s[40:43], s85 offen offset:0 lds
buffer_load_dwordx4 v33, s[40:43], s85 offen offset:1024 lds
buffer_load_dwordx4 v34, s[40:43], s85 offen offset:2048 lds
s_add_u32 m0, s84, 79872
s_add_u32 s85, s93, 196608
buffer_load_dwordx4 v17, s[40:43], s85 offen offset:0 lds
buffer_load_dwordx4 v18, s[40:43], s85 offen offset:1024 lds
buffer_load_dwordx4 v19, s[40:43], s85 offen offset:2048 lds
s_add_u32 m0, s84, 82944
s_add_u32 s85, s93, 294912
buffer_load_dwordx4 v32, s[40:43], s85 offen offset:0 lds
buffer_load_dwordx4 v33, s[40:43], s85 offen offset:1024 lds
buffer_load_dwordx4 v34, s[40:43], s85 offen offset:2048 lds
s_add_u32 m0, s84, 86016
s_add_u32 s85, s93, 393216
buffer_load_dwordx4 v17, s[40:43], s85 offen offset:0 lds
buffer_load_dwordx4 v18, s[40:43], s85 offen offset:1024 lds
buffer_load_dwordx4 v19, s[40:43], s85 offen offset:2048 lds
s_add_u32 m0, s84, 89088
s_add_u32 s85, s93, 491520
buffer_load_dwordx4 v32, s[40:43], s85 offen offset:0 lds
s_waitcnt vmcnt(44)
buffer_load_dwordx4 v33, s[40:43], s85 offen offset:1024 lds
buffer_load_dwordx4 v34, s[40:43], s85 offen offset:2048 lds
s_add_u32 m0, s84, 92160
s_add_u32 s85, s93, 589824
buffer_load_dwordx4 v17, s[40:43], s85 offen offset:0 lds
buffer_load_dwordx4 v18, s[40:43], s85 offen offset:1024 lds
buffer_load_dwordx4 v19, s[40:43], s85 offen offset:2048 lds
s_add_u32 m0, s84, 95232
s_add_u32 s85, s93, 688128
buffer_load_dwordx4 v32, s[40:43], s85 offen offset:0 lds
buffer_load_dwordx4 v33, s[40:43], s85 offen offset:1024 lds
buffer_load_dwordx4 v34, s[40:43], s85 offen offset:2048 lds
s_add_u32 s101, s80, s77
s_add_u32 m0, s75, 0
s_add_u32 s85, s101, 0
buffer_load_dwordx4 v8, s[32:35], s85 offen offset:0 nt lds
buffer_load_dwordx4 v9, s[32:35], s85 offen offset:1024 nt lds
buffer_load_dwordx4 v10, s[32:35], s85 offen offset:2048 nt lds
s_add_u32 m0, s75, 3072
s_add_u32 s85, s101, 3072
buffer_load_dwordx4 v11, s[32:35], s85 offen offset:0 nt lds
buffer_load_dwordx4 v12, s[32:35], s85 offen offset:1024 nt lds
buffer_load_dwordx4 v13, s[32:35], s85 offen offset:2048 nt lds
s_add_u32 m0, s75, 6144
s_add_u32 s85, s101, 6144
buffer_load_dwordx4 v8, s[32:35], s85 offen offset:0 nt lds
buffer_load_dwordx4 v9, s[32:35], s85 offen offset:1024 nt lds
s_waitcnt vmcnt(44)
buffer_load_dwordx4 v10, s[32:35], s85 offen offset:2048 nt lds
s_add_u32 m0, s75, 9216
s_add_u32 s85, s101, 9216
buffer_load_dwordx4 v11, s[32:35], s85 offen offset:0 nt lds
buffer_load_dwordx4 v12, s[32:35], s85 offen offset:1024 nt lds
buffer_load_dwordx4 v13, s[32:35], s85 offen offset:2048 nt lds
s_add_u32 m0, s75, 12288
s_add_u32 s85, s101, 0
buffer_load_dwordx4 v14, s[36:39], s85 offen offset:0 nt lds
buffer_load_dwordx4 v15, s[36:39], s85 offen offset:1024 nt lds
buffer_load_dwordx4 v16, s[36:39], s85 offen offset:2048 nt lds
s_add_u32 m0, s75, 15360
s_add_u32 s85, s101, 3072
buffer_load_dwordx4 v14, s[36:39], s85 offen offset:0 nt lds
buffer_load_dwordx4 v15, s[36:39], s85 offen offset:1024 nt lds
buffer_load_dwordx4 v16, s[36:39], s85 offen offset:2048 nt lds
s_add_u32 m0, s75, 18432
s_add_u32 s85, s101, 6144
buffer_load_dwordx4 v14, s[36:39], s85 offen offset:0 nt lds
buffer_load_dwordx4 v15, s[36:39], s85 offen offset:1024 nt lds
buffer_load_dwordx4 v16, s[36:39], s85 offen offset:2048 nt lds
s_add_u32 m0, s75, 21504
s_add_u32 s85, s101, 9216
buffer_load_dwordx4 v14, s[36:39], s85 offen offset:0 nt lds
buffer_load_dwordx4 v15, s[36:39], s85 offen offset:1024 nt lds
buffer_load_dwordx4 v16, s[36:39], s85 offen offset:2048 nt lds
s_waitcnt vmcnt(44)
s_add_u32 s77, s77, 12288
s_cmp_eq_u32 s77, 196608
s_cselect_b32 s77, 0, s77
s_add_u32 s75, s75, 24576
s_cmp_eq_u32 s75, 73728
s_cselect_b32 s75, 0, s75
s_cmp_ge_u32 s74, 2
s_cbranch_scc1 L_ld_nopf0
s_waitcnt vmcnt(24)
s_barrier
s_branch L_ld_b0
L_ld_nopf0:
s_mov_b32 m0, 163584
s_add_u32 s85, s87, 0
buffer_load_dword v25, s[56:59], s85 offen lds
s_waitcnt vmcnt(25)
s_barrier
L_ld_b0:
s_add_u32 m0, s84, 135168
s_add_u32 s85, s88, 128
buffer_load_dwordx4 v20, s[44:47], s85 offen offset:0 lds
buffer_load_dwordx4 v21, s[44:47], s85 offen offset:1024 lds
buffer_load_dwordx4 v22, s[44:47], s85 offen offset:2048 lds
buffer_load_dwordx4 v23, s[44:47], s85 offen offset:3072 lds
s_add_u32 m0, s84, 139264
s_add_u32 s85, s88, 41088
buffer_load_dwordx4 v20, s[44:47], s85 offen offset:0 lds
buffer_load_dwordx4 v21, s[44:47], s85 offen offset:1024 lds
buffer_load_dwordx4 v22, s[44:47], s85 offen offset:2048 lds
buffer_load_dwordx4 v23, s[44:47], s85 offen offset:3072 lds
s_add_u32 m0, s84, 143360
s_add_u32 s85, s88, 82048
buffer_load_dwordx4 v20, s[44:47], s85 offen offset:0 lds
buffer_load_dwordx4 v21, s[44:47], s85 offen offset:1024 lds
buffer_load_dwordx4 v22, s[44:47], s85 offen offset:2048 lds
buffer_load_dwordx4 v23, s[44:47], s85 offen offset:3072 lds
s_add_u32 m0, s84, 98304
s_add_u32 s85, s93, 786432
buffer_load_dwordx4 v17, s[40:43], s85 offen offset:0 lds
buffer_load_dwordx4 v18, s[40:43], s85 offen offset:1024 lds
buffer_load_dwordx4 v19, s[40:43], s85 offen offset:2048 lds
s_waitcnt vmcnt(44)
s_add_u32 m0, s84, 101376
s_add_u32 s85, s93, 884736
buffer_load_dwordx4 v32, s[40:43], s85 offen offset:0 lds
buffer_load_dwordx4 v33, s[40:43], s85 offen offset:1024 lds
buffer_load_dwordx4 v34, s[40:43], s85 offen offset:2048 lds
s_add_u32 m0, s84, 104448
s_add_u32 s85, s93, 983040
buffer_load_dwordx4 v17, s[40:43], s85 offen offset:0 lds
buffer_load_dwordx4 v18, s[40:43], s85 offen offset:1024 lds
buffer_load_dwordx4 v19, s[40:43], s85 offen offset:2048 lds
s_add_u32 m0, s84, 107520
s_add_u32 s85, s93, 1081344
buffer_load_dwordx4 v32, s[40:43], s85 offen offset:0 lds
buffer_load_dwordx4 v33, s[40:43], s85 offen offset:1024 lds
buffer_load_dwordx4 v34, s[40:43], s85 offen offset:2048 lds
s_add_u32 s101, s80, s77
s_add_u32 m0, s75, 0
s_add_u32 s85, s101, 0
buffer_load_dwordx4 v8, s[32:35], s85 offen offset:0 nt lds
buffer_load_dwordx4 v9, s[32:35], s85 offen offset:1024 nt lds
buffer_load_dwordx4 v10, s[32:35], s85 offen offset:2048 nt lds
s_add_u32 m0, s75, 3072
s_add_u32 s85, s101, 3072
buffer_load_dwordx4 v11, s[32:35], s85 offen offset:0 nt lds
buffer_load_dwordx4 v12, s[32:35], s85 offen offset:1024 nt lds
buffer_load_dwordx4 v13, s[32:35], s85 offen offset:2048 nt lds
s_add_u32 m0, s75, 6144
s_add_u32 s85, s101, 6144
buffer_load_dwordx4 v8, s[32:35], s85 offen offset:0 nt lds
s_waitcnt vmcnt(44)
buffer_load_dwordx4 v9, s[32:35], s85 offen offset:1024 nt lds
buffer_load_dwordx4 v10, s[32:35], s85 offen offset:2048 nt lds
s_add_u32 m0, s75, 9216
s_add_u32 s85, s101, 9216
buffer_load_dwordx4 v11, s[32:35], s85 offen offset:0 nt lds
buffer_load_dwordx4 v12, s[32:35], s85 offen offset:1024 nt lds
buffer_load_dwordx4 v13, s[32:35], s85 offen offset:2048 nt lds
s_add_u32 m0, s75, 12288
s_add_u32 s85, s101, 0
buffer_load_dwordx4 v14, s[36:39], s85 offen offset:0 nt lds
buffer_load_dwordx4 v15, s[36:39], s85 offen offset:1024 nt lds
buffer_load_dwordx4 v16, s[36:39], s85 offen offset:2048 nt lds
s_add_u32 m0, s75, 15360
s_add_u32 s85, s101, 3072
buffer_load_dwordx4 v14, s[36:39], s85 offen offset:0 nt lds
buffer_load_dwordx4 v15, s[36:39], s85 offen offset:1024 nt lds
buffer_load_dwordx4 v16, s[36:39], s85 offen offset:2048 nt lds
s_add_u32 m0, s75, 18432
s_add_u32 s85, s101, 6144
buffer_load_dwordx4 v14, s[36:39], s85 offen offset:0 nt lds
buffer_load_dwordx4 v15, s[36:39], s85 offen offset:1024 nt lds
buffer_load_dwordx4 v16, s[36:39], s85 offen offset:2048 nt lds
s_add_u32 m0, s75, 21504
s_add_u32 s85, s101, 9216
buffer_load_dwordx4 v14, s[36:39], s85 offen offset:0 nt lds
buffer_load_dwordx4 v15, s[36:39], s85 offen offset:1024 nt lds
s_waitcnt vmcnt(44)
buffer_load_dwordx4 v16, s[36:39], s85 offen offset:2048 nt lds
s_add_u32 s77, s77, 12288
s_cmp_eq_u32 s77, 196608
s_cselect_b32 s77, 0, s77
s_add_u32 s75, s75, 24576
s_cmp_eq_u32 s75, 73728
s_cselect_b32 s75, 0, s75
s_cmp_ge_u32 s74, 2
s_cbranch_scc1 L_ld_nopf1
s_waitcnt vmcnt(24)
s_barrier
s_branch L_ld_b1
L_ld_nopf1:
s_mov_b32 m0, 163584
s_add_u32 s85, s87, 1966080
buffer_load_dword v25, s[56:59], s85 offen lds
s_waitcnt vmcnt(25)
s_barrier
L_ld_b1:
s_add_u32 m0, s84, 110592
s_add_u32 s85, s93, 1179648
buffer_load_dwordx4 v17, s[40:43], s85 offen offset:0 lds
buffer_load_dwordx4 v18, s[40:43], s85 offen offset:1024 lds
buffer_load_dwordx4 v19, s[40:43], s85 offen offset:2048 lds
s_add_u32 m0, s84, 113664
s_add_u32 s85, s93, 1277952
buffer_load_dwordx4 v32, s[40:43], s85 offen offset:0 lds
buffer_load_dwordx4 v33, s[40:43], s85 offen offset:1024 lds
buffer_load_dwordx4 v34, s[40:43], s85 offen offset:2048 lds
s_add_u32 m0, s84, 116736
s_add_u32 s85, s93, 1376256
buffer_load_dwordx4 v17, s[40:43], s85 offen offset:0 lds
buffer_load_dwordx4 v18, s[40:43], s85 offen offset:1024 lds
buffer_load_dwordx4 v19, s[40:43], s85 offen offset:2048 lds
s_add_u32 m0, s84, 119808
s_add_u32 s85, s93, 1474560
buffer_load_dwordx4 v32, s[40:43], s85 offen offset:0 lds
buffer_load_dwordx4 v33, s[40:43], s85 offen offset:1024 lds
buffer_load_dwordx4 v34, s[40:43], s85 offen offset:2048 lds
s_add_u32 s101, s80, s77
s_add_u32 m0, s75, 0
s_add_u32 s85, s101, 0
buffer_load_dwordx4 v8, s[32:35], s85 offen offset:0 nt lds
buffer_load_dwordx4 v9, s[32:35], s85 offen offset:1024 nt lds
s_waitcnt vmcnt(44)
buffer_load_dwordx4 v10, s[32:35], s85 offen offset:2048 nt lds
s_add_u32 m0, s75, 3072
s_add_u32 s85, s101, 3072
buffer_load_dwordx4 v11, s[32:35], s85 offen offset:0 nt lds
buffer_load_dwordx4 v12, s[32:35], s85 offen offset:1024 nt lds
buffer_load_dwordx4 v13, s[32:35], s85 offen offset:2048 nt lds
s_add_u32 m0, s75, 6144
s_add_u32 s85, s101, 6144
buffer_load_dwordx4 v8, s[32:35], s85 offen offset:0 nt lds
buffer_load_dwordx4 v9, s[32:35], s85 offen offset:1024 nt lds
buffer_load_dwordx4 v10, s[32:35], s85 offen offset:2048 nt lds
s_add_u32 m0, s75, 9216
s_add_u32 s85, s101, 9216
buffer_load_dwordx4 v11, s[32:35], s85 offen offset:0 nt lds
buffer_load_dwordx4 v12, s[32:35], s85 offen offset:1024 nt lds
buffer_load_dwordx4 v13, s[32:35], s85 offen offset:2048 nt lds
s_add_u32 m0, s75, 12288
s_add_u32 s85, s101, 0
buffer_load_dwordx4 v14, s[36:39], s85 offen offset:0 nt lds
buffer_load_dwordx4 v15, s[36:39], s85 offen offset:1024 nt lds
buffer_load_dwordx4 v16, s[36:39], s85 offen offset:2048 nt lds
s_add_u32 m0, s75, 15360
s_add_u32 s85, s101, 3072
buffer_load_dwordx4 v14, s[36:39], s85 offen offset:0 nt lds
buffer_load_dwordx4 v15, s[36:39], s85 offen offset:1024 nt lds
buffer_load_dwordx4 v16, s[36:39], s85 offen offset:2048 nt lds
s_waitcnt vmcnt(44)
s_add_u32 m0, s75, 18432
s_add_u32 s85, s101, 6144
buffer_load_dwordx4 v14, s[36:39], s85 offen offset:0 nt lds
buffer_load_dwordx4 v15, s[36:39], s85 offen offset:1024 nt lds
buffer_load_dwordx4 v16, s[36:39], s85 offen offset:2048 nt lds
s_add_u32 m0, s75, 21504
s_add_u32 s85, s101, 9216
buffer_load_dwordx4 v14, s[36:39], s85 offen offset:0 nt lds
buffer_load_dwordx4 v15, s[36:39], s85 offen offset:1024 nt lds
buffer_load_dwordx4 v16, s[36:39], s85 offen offset:2048 nt lds
s_add_u32 s77, s77, 12288
s_cmp_eq_u32 s77, 196608
s_cselect_b32 s77, 0, s77
s_add_u32 s75, s75, 24576
s_cmp_eq_u32 s75, 73728
s_cselect_b32 s75, 0, s75
s_cmp_ge_u32 s74, 2
s_cbranch_scc1 L_ld_nopf2
s_mov_b32 m0, 163584
s_add_u32 s85, s83, 0
buffer_load_dword v31, s[40:43], s85 offen lds
s_waitcnt vmcnt(25)
s_barrier
s_branch L_ld_b2
L_ld_nopf2:
s_mov_b32 m0, 163584
s_add_u32 s85, s87, 3932160
buffer_load_dword v25, s[56:59], s85 offen lds
s_waitcnt vmcnt(25)
s_barrier
L_ld_b2:
s_add_u32 m0, s84, 73728
s_add_u32 s85, s93, 1572864
buffer_load_dwordx4 v17, s[40:43], s85 offen offset:0 lds
buffer_load_dwordx4 v18, s[40:43], s85 offen offset:1024 lds
buffer_load_dwordx4 v19, s[40:43], s85 offen offset:2048 lds
s_add_u32 m0, s84, 76800
s_add_u32 s85, s93, 1671168
buffer_load_dwordx4 v32, s[40:43], s85 offen offset:0 lds
buffer_load_dwordx4 v33, s[40:43], s85 offen offset:1024 lds
buffer_load_dwordx4 v34, s[40:43], s85 offen offset:2048 lds
s_add_u32 m0, s84, 79872
s_add_u32 s85, s93, 1769472
buffer_load_dwordx4 v17, s[40:43], s85 offen offset:0 lds
buffer_load_dwordx4 v18, s[40:43], s85 offen offset:1024 lds
s_waitcnt vmcnt(44)
buffer_load_dwordx4 v19, s[40:43], s85 offen offset:2048 lds
s_add_u32 m0, s84, 82944
s_add_u32 s85, s93, 1867776
buffer_load_dwordx4 v32, s[40:43], s85 offen offset:0 lds
buffer_load_dwordx4 v33, s[40:43], s85 offen offset:1024 lds
buffer_load_dwordx4 v34, s[40:43], s85 offen offset:2048 lds
s_add_u32 m0, s84, 86016
s_add_u32 s85, s93, 1966080
buffer_load_dwordx4 v17, s[40:43], s85 offen offset:0 lds
buffer_load_dwordx4 v18, s[40:43], s85 offen offset:1024 lds
buffer_load_dwordx4 v19, s[40:43], s85 offen offset:2048 lds
s_add_u32 m0, s84, 89088
s_add_u32 s85, s93, 2064384
buffer_load_dwordx4 v32, s[40:43], s85 offen offset:0 lds
buffer_load_dwordx4 v33, s[40:43], s85 offen offset:1024 lds
buffer_load_dwordx4 v34, s[40:43], s85 offen offset:2048 lds
s_add_u32 m0, s84, 92160
s_add_u32 s85, s93, 2162688
buffer_load_dwordx4 v17, s[40:43], s85 offen offset:0 lds
buffer_load_dwordx4 v18, s[40:43], s85 offen offset:1024 lds
buffer_load_dwordx4 v19, s[40:43], s85 offen offset:2048 lds
s_add_u32 m0, s84, 95232
s_add_u32 s85, s93, 2260992
buffer_load_dwordx4 v32, s[40:43], s85 offen offset:0 lds
buffer_load_dwordx4 v33, s[40:43], s85 offen offset:1024 lds
buffer_load_dwordx4 v34, s[40:43], s85 offen offset:2048 lds
s_waitcnt vmcnt(44)
s_add_u32 s101, s80, s77
s_add_u32 m0, s75, 0
s_add_u32 s85, s101, 0
buffer_load_dwordx4 v8, s[32:35], s85 offen offset:0 nt lds
buffer_load_dwordx4 v9, s[32:35], s85 offen offset:1024 nt lds
buffer_load_dwordx4 v10, s[32:35], s85 offen offset:2048 nt lds
s_add_u32 m0, s75, 3072
s_add_u32 s85, s101, 3072
buffer_load_dwordx4 v11, s[32:35], s85 offen offset:0 nt lds
buffer_load_dwordx4 v12, s[32:35], s85 offen offset:1024 nt lds
buffer_load_dwordx4 v13, s[32:35], s85 offen offset:2048 nt lds
s_add_u32 m0, s75, 6144
s_add_u32 s85, s101, 6144
buffer_load_dwordx4 v8, s[32:35], s85 offen offset:0 nt lds
buffer_load_dwordx4 v9, s[32:35], s85 offen offset:1024 nt lds
buffer_load_dwordx4 v10, s[32:35], s85 offen offset:2048 nt lds
s_add_u32 m0, s75, 9216
s_add_u32 s85, s101, 9216
buffer_load_dwordx4 v11, s[32:35], s85 offen offset:0 nt lds
buffer_load_dwordx4 v12, s[32:35], s85 offen offset:1024 nt lds
buffer_load_dwordx4 v13, s[32:35], s85 offen offset:2048 nt lds
s_add_u32 m0, s75, 12288
s_add_u32 s85, s101, 0
buffer_load_dwordx4 v14, s[36:39], s85 offen offset:0 nt lds
buffer_load_dwordx4 v15, s[36:39], s85 offen offset:1024 nt lds
buffer_load_dwordx4 v16, s[36:39], s85 offen offset:2048 nt lds
s_add_u32 m0, s75, 15360
s_add_u32 s85, s101, 3072
buffer_load_dwordx4 v14, s[36:39], s85 offen offset:0 nt lds
s_waitcnt vmcnt(44)
buffer_load_dwordx4 v15, s[36:39], s85 offen offset:1024 nt lds
buffer_load_dwordx4 v16, s[36:39], s85 offen offset:2048 nt lds
s_add_u32 m0, s75, 18432
s_add_u32 s85, s101, 6144
buffer_load_dwordx4 v14, s[36:39], s85 offen offset:0 nt lds
buffer_load_dwordx4 v15, s[36:39], s85 offen offset:1024 nt lds
buffer_load_dwordx4 v16, s[36:39], s85 offen offset:2048 nt lds
s_add_u32 m0, s75, 21504
s_add_u32 s85, s101, 9216
buffer_load_dwordx4 v14, s[36:39], s85 offen offset:0 nt lds
buffer_load_dwordx4 v15, s[36:39], s85 offen offset:1024 nt lds
buffer_load_dwordx4 v16, s[36:39], s85 offen offset:2048 nt lds
s_add_u32 s77, s77, 12288
s_cmp_eq_u32 s77, 196608
s_cselect_b32 s77, 0, s77
s_add_u32 s75, s75, 24576
s_cmp_eq_u32 s75, 73728
s_cselect_b32 s75, 0, s75
s_cmp_ge_u32 s74, 2
s_cbranch_scc1 L_ld_nopf3
s_waitcnt vmcnt(24)
s_barrier
s_branch L_ld_b3
L_ld_nopf3:
s_mov_b32 m0, 163584
s_add_u32 s85, s87, 256
buffer_load_dword v25, s[56:59], s85 offen lds
s_waitcnt vmcnt(25)
s_barrier
L_ld_b3:
s_add_u32 m0, s84, 135168
s_add_u32 s85, s88, 384
buffer_load_dwordx4 v20, s[44:47], s85 offen offset:0 lds
buffer_load_dwordx4 v21, s[44:47], s85 offen offset:1024 lds
buffer_load_dwordx4 v22, s[44:47], s85 offen offset:2048 lds
buffer_load_dwordx4 v23, s[44:47], s85 offen offset:3072 lds
s_add_u32 m0, s84, 139264
s_add_u32 s85, s88, 41344
buffer_load_dwordx4 v20, s[44:47], s85 offen offset:0 lds
buffer_load_dwordx4 v21, s[44:47], s85 offen offset:1024 lds
buffer_load_dwordx4 v22, s[44:47], s85 offen offset:2048 lds
s_waitcnt vmcnt(44)
buffer_load_dwordx4 v23, s[44:47], s85 offen offset:3072 lds
s_add_u32 m0, s84, 143360
s_add_u32 s85, s88, 82304
buffer_load_dwordx4 v20, s[44:47], s85 offen offset:0 lds
buffer_load_dwordx4 v21, s[44:47], s85 offen offset:1024 lds
buffer_load_dwordx4 v22, s[44:47], s85 offen offset:2048 lds
buffer_load_dwordx4 v23, s[44:47], s85 offen offset:3072 lds
s_add_u32 m0, s84, 98304
s_add_u32 s85, s93, 2359296
buffer_load_dwordx4 v17, s[40:43], s85 offen offset:0 lds
buffer_load_dwordx4 v18, s[40:43], s85 offen offset:1024 lds
buffer_load_dwordx4 v19, s[40:43], s85 offen offset:2048 lds
s_add_u32 m0, s84, 101376
s_add_u32 s85, s93, 2457600
buffer_load_dwordx4 v32, s[40:43], s85 offen offset:0 lds
buffer_load_dwordx4 v33, s[40:43], s85 offen offset:1024 lds
buffer_load_dwordx4 v34, s[40:43], s85 offen offset:2048 lds
s_add_u32 m0, s84, 104448
s_add_u32 s85, s93, 2555904
buffer_load_dwordx4 v17, s[40:43], s85 offen offset:0 lds
buffer_load_dwordx4 v18, s[40:43], s85 offen offset:1024 lds
buffer_load_dwordx4 v19, s[40:43], s85 offen offset:2048 lds
s_add_u32 m0, s84, 107520
s_add_u32 s85, s93, 2654208
buffer_load_dwordx4 v32, s[40:43], s85 offen offset:0 lds
buffer_load_dwordx4 v33, s[40:43], s85 offen offset:1024 lds
s_waitcnt vmcnt(44)
buffer_load_dwordx4 v34, s[40:43], s85 offen offset:2048 lds
s_add_u32 s101, s80, s77
s_add_u32 m0, s75, 0
s_add_u32 s85, s101, 0
buffer_load_dwordx4 v8, s[32:35], s85 offen offset:0 nt lds
buffer_load_dwordx4 v9, s[32:35], s85 offen offset:1024 nt lds
buffer_load_dwordx4 v10, s[32:35], s85 offen offset:2048 nt lds
s_add_u32 m0, s75, 3072
s_add_u32 s85, s101, 3072
buffer_load_dwordx4 v11, s[32:35], s85 offen offset:0 nt lds
buffer_load_dwordx4 v12, s[32:35], s85 offen offset:1024 nt lds
buffer_load_dwordx4 v13, s[32:35], s85 offen offset:2048 nt lds
s_add_u32 m0, s75, 6144
s_add_u32 s85, s101, 6144
buffer_load_dwordx4 v8, s[32:35], s85 offen offset:0 nt lds
buffer_load_dwordx4 v9, s[32:35], s85 offen offset:1024 nt lds
buffer_load_dwordx4 v10, s[32:35], s85 offen offset:2048 nt lds
s_add_u32 m0, s75, 9216
s_add_u32 s85, s101, 9216
buffer_load_dwordx4 v11, s[32:35], s85 offen offset:0 nt lds
buffer_load_dwordx4 v12, s[32:35], s85 offen offset:1024 nt lds
buffer_load_dwordx4 v13, s[32:35], s85 offen offset:2048 nt lds
s_add_u32 m0, s75, 12288
s_add_u32 s85, s101, 0
buffer_load_dwordx4 v14, s[36:39], s85 offen offset:0 nt lds
buffer_load_dwordx4 v15, s[36:39], s85 offen offset:1024 nt lds
buffer_load_dwordx4 v16, s[36:39], s85 offen offset:2048 nt lds
s_waitcnt vmcnt(44)
s_add_u32 m0, s75, 15360
s_add_u32 s85, s101, 3072
buffer_load_dwordx4 v14, s[36:39], s85 offen offset:0 nt lds
buffer_load_dwordx4 v15, s[36:39], s85 offen offset:1024 nt lds
buffer_load_dwordx4 v16, s[36:39], s85 offen offset:2048 nt lds
s_add_u32 m0, s75, 18432
s_add_u32 s85, s101, 6144
buffer_load_dwordx4 v14, s[36:39], s85 offen offset:0 nt lds
buffer_load_dwordx4 v15, s[36:39], s85 offen offset:1024 nt lds
buffer_load_dwordx4 v16, s[36:39], s85 offen offset:2048 nt lds
s_add_u32 m0, s75, 21504
s_add_u32 s85, s101, 9216
buffer_load_dwordx4 v14, s[36:39], s85 offen offset:0 nt lds
buffer_load_dwordx4 v15, s[36:39], s85 offen offset:1024 nt lds
buffer_load_dwordx4 v16, s[36:39], s85 offen offset:2048 nt lds
s_add_u32 s77, s77, 12288
s_cmp_eq_u32 s77, 196608
s_cselect_b32 s77, 0, s77
s_add_u32 s75, s75, 24576
s_cmp_eq_u32 s75, 73728
s_cselect_b32 s75, 0, s75
s_cmp_ge_u32 s74, 2
s_cbranch_scc1 L_ld_nopf4
s_waitcnt vmcnt(24)
s_barrier
s_branch L_ld_b4
L_ld_nopf4:
s_mov_b32 m0, 163584
s_add_u32 s85, s87, 1966336
buffer_load_dword v25, s[56:59], s85 offen lds
s_waitcnt vmcnt(25)
s_barrier
L_ld_b4:
s_add_u32 m0, s84, 110592
s_add_u32 s85, s93, 2752512
buffer_load_dwordx4 v17, s[40:43], s85 offen offset:0 lds
buffer_load_dwordx4 v18, s[40:43], s85 offen offset:1024 lds
buffer_load_dwordx4 v19, s[40:43], s85 offen offset:2048 lds
s_add_u32 m0, s84, 113664
s_add_u32 s85, s93, 2850816
buffer_load_dwordx4 v32, s[40:43], s85 offen offset:0 lds
buffer_load_dwordx4 v33, s[40:43], s85 offen offset:1024 lds
buffer_load_dwordx4 v34, s[40:43], s85 offen offset:2048 lds
s_waitcnt vmcnt(44)
s_add_u32 m0, s84, 116736
s_add_u32 s85, s93, 2949120
buffer_load_dwordx4 v17, s[40:43], s85 offen offset:0 lds
buffer_load_dwordx4 v18, s[40:43], s85 offen offset:1024 lds
buffer_load_dwordx4 v19, s[40:43], s85 offen offset:2048 lds
s_add_u32 m0, s84, 119808
s_add_u32 s85, s93, 3047424
buffer_load_dwordx4 v32, s[40:43], s85 offen offset:0 lds
buffer_load_dwordx4 v33, s[40:43], s85 offen offset:1024 lds
buffer_load_dwordx4 v34, s[40:43], s85 offen offset:2048 lds
s_add_u32 s101, s80, s77
s_add_u32 m0, s75, 0
s_add_u32 s85, s101, 0
buffer_load_dwordx4 v8, s[32:35], s85 offen offset:0 nt lds
buffer_load_dwordx4 v9, s[32:35], s85 offen offset:1024 nt lds
buffer_load_dwordx4 v10, s[32:35], s85 offen offset:2048 nt lds
s_add_u32 m0, s75, 3072
s_add_u32 s85, s101, 3072
buffer_load_dwordx4 v11, s[32:35], s85 offen offset:0 nt lds
buffer_load_dwordx4 v12, s[32:35], s85 offen offset:1024 nt lds
buffer_load_dwordx4 v13, s[32:35], s85 offen offset:2048 nt lds
s_add_u32 m0, s75, 6144
s_add_u32 s85, s101, 6144
buffer_load_dwordx4 v8, s[32:35], s85 offen offset:0 nt lds
buffer_load_dwordx4 v9, s[32:35], s85 offen offset:1024 nt lds
buffer_load_dwordx4 v10, s[32:35], s85 offen offset:2048 nt lds
s_add_u32 m0, s75, 9216
s_add_u32 s85, s101, 9216
buffer_load_dwordx4 v11, s[32:35], s85 offen offset:0 nt lds
s_waitcnt vmcnt(44)
buffer_load_dwordx4 v12, s[32:35], s85 offen offset:1024 nt lds
buffer_load_dwordx4 v13, s[32:35], s85 offen offset:2048 nt lds
s_add_u32 m0, s75, 12288
s_add_u32 s85, s101, 0
buffer_load_dwordx4 v14, s[36:39], s85 offen offset:0 nt lds
buffer_load_dwordx4 v15, s[36:39], s85 offen offset:1024 nt lds
buffer_load_dwordx4 v16, s[36:39], s85 offen offset:2048 nt lds
s_add_u32 m0, s75, 15360
s_add_u32 s85, s101, 3072
buffer_load_dwordx4 v14, s[36:39], s85 offen offset:0 nt lds
buffer_load_dwordx4 v15, s[36:39], s85 offen offset:1024 nt lds
buffer_load_dwordx4 v16, s[36:39], s85 offen offset:2048 nt lds
s_add_u32 m0, s75, 18432
s_add_u32 s85, s101, 6144
buffer_load_dwordx4 v14, s[36:39], s85 offen offset:0 nt lds
buffer_load_dwordx4 v15, s[36:39], s85 offen offset:1024 nt lds
buffer_load_dwordx4 v16, s[36:39], s85 offen offset:2048 nt lds
s_add_u32 m0, s75, 21504
s_add_u32 s85, s101, 9216
buffer_load_dwordx4 v14, s[36:39], s85 offen offset:0 nt lds
buffer_load_dwordx4 v15, s[36:39], s85 offen offset:1024 nt lds
buffer_load_dwordx4 v16, s[36:39], s85 offen offset:2048 nt lds
s_add_u32 s77, s77, 12288
s_cmp_eq_u32 s77, 196608
s_cselect_b32 s77, 0, s77
s_add_u32 s75, s75, 24576
s_cmp_eq_u32 s75, 73728
s_cselect_b32 s75, 0, s75
s_cmp_ge_u32 s74, 2
s_cbranch_scc1 L_ld_nopf5
s_mov_b32 m0, 163584
s_add_u32 s85, s83, 122880
buffer_load_dword v31, s[40:43], s85 offen lds
s_waitcnt vmcnt(25)
s_barrier
s_branch L_ld_b5
L_ld_nopf5:
s_mov_b32 m0, 163584
s_add_u32 s85, s87, 3932416
buffer_load_dword v25, s[56:59], s85 offen lds
s_waitcnt vmcnt(25)
s_barrier
L_ld_b5:
s_add_u32 m0, s84, 73728
s_add_u32 s85, s93, 3145728
buffer_load_dwordx4 v17, s[40:43], s85 offen offset:0 lds
buffer_load_dwordx4 v18, s[40:43], s85 offen offset:1024 lds
buffer_load_dwordx4 v19, s[40:43], s85 offen offset:2048 lds
s_add_u32 m0, s84, 76800
s_add_u32 s85, s93, 3244032
buffer_load_dwordx4 v32, s[40:43], s85 offen offset:0 lds
buffer_load_dwordx4 v33, s[40:43], s85 offen offset:1024 lds
buffer_load_dwordx4 v34, s[40:43], s85 offen offset:2048 lds
s_add_u32 m0, s84, 79872
s_add_u32 s85, s93, 3342336
buffer_load_dwordx4 v17, s[40:43], s85 offen offset:0 lds
buffer_load_dwordx4 v18, s[40:43], s85 offen offset:1024 lds
buffer_load_dwordx4 v19, s[40:43], s85 offen offset:2048 lds
s_add_u32 m0, s84, 82944
s_add_u32 s85, s93, 3440640
buffer_load_dwordx4 v32, s[40:43], s85 offen offset:0 lds
buffer_load_dwordx4 v33, s[40:43], s85 offen offset:1024 lds
buffer_load_dwordx4 v34, s[40:43], s85 offen offset:2048 lds
s_add_u32 m0, s84, 86016
s_add_u32 s85, s93, 3538944
buffer_load_dwordx4 v17, s[40:43], s85 offen offset:0 lds
buffer_load_dwordx4 v18, s[40:43], s85 offen offset:1024 lds
buffer_load_dwordx4 v19, s[40:43], s85 offen offset:2048 lds
s_add_u32 m0, s84, 89088
s_add_u32 s85, s93, 3637248
buffer_load_dwordx4 v32, s[40:43], s85 offen offset:0 lds
s_waitcnt vmcnt(44)
buffer_load_dwordx4 v33, s[40:43], s85 offen offset:1024 lds
buffer_load_dwordx4 v34, s[40:43], s85 offen offset:2048 lds
s_add_u32 m0, s84, 92160
s_add_u32 s85, s93, 3735552
buffer_load_dwordx4 v17, s[40:43], s85 offen offset:0 lds
buffer_load_dwordx4 v18, s[40:43], s85 offen offset:1024 lds
buffer_load_dwordx4 v19, s[40:43], s85 offen offset:2048 lds
s_add_u32 m0, s84, 95232
s_add_u32 s85, s93, 3833856
buffer_load_dwordx4 v32, s[40:43], s85 offen offset:0 lds
buffer_load_dwordx4 v33, s[40:43], s85 offen offset:1024 lds
buffer_load_dwordx4 v34, s[40:43], s85 offen offset:2048 lds
s_add_u32 s101, s80, s77
s_add_u32 m0, s75, 0
s_add_u32 s85, s101, 0
buffer_load_dwordx4 v8, s[32:35], s85 offen offset:0 nt lds
buffer_load_dwordx4 v9, s[32:35], s85 offen offset:1024 nt lds
buffer_load_dwordx4 v10, s[32:35], s85 offen offset:2048 nt lds
s_add_u32 m0, s75, 3072
s_add_u32 s85, s101, 3072
buffer_load_dwordx4 v11, s[32:35], s85 offen offset:0 nt lds
buffer_load_dwordx4 v12, s[32:35], s85 offen offset:1024 nt lds
buffer_load_dwordx4 v13, s[32:35], s85 offen offset:2048 nt lds
s_add_u32 m0, s75, 6144
s_add_u32 s85, s101, 6144
buffer_load_dwordx4 v8, s[32:35], s85 offen offset:0 nt lds
buffer_load_dwordx4 v9, s[32:35], s85 offen offset:1024 nt lds
s_waitcnt vmcnt(44)
buffer_load_dwordx4 v10, s[32:35], s85 offen offset:2048 nt lds
s_add_u32 m0, s75, 9216
s_add_u32 s85, s101, 9216
buffer_load_dwordx4 v11, s[32:35], s85 offen offset:0 nt lds
buffer_load_dwordx4 v12, s[32:35], s85 offen offset:1024 nt lds
buffer_load_dwordx4 v13, s[32:35], s85 offen offset:2048 nt lds
s_add_u32 m0, s75, 12288
s_add_u32 s85, s101, 0
buffer_load_dwordx4 v14, s[36:39], s85 offen offset:0 nt lds
buffer_load_dwordx4 v15, s[36:39], s85 offen offset:1024 nt lds
buffer_load_dwordx4 v16, s[36:39], s85 offen offset:2048 nt lds
s_add_u32 m0, s75, 15360
s_add_u32 s85, s101, 3072
buffer_load_dwordx4 v14, s[36:39], s85 offen offset:0 nt lds
buffer_load_dwordx4 v15, s[36:39], s85 offen offset:1024 nt lds
buffer_load_dwordx4 v16, s[36:39], s85 offen offset:2048 nt lds
s_add_u32 m0, s75, 18432
s_add_u32 s85, s101, 6144
buffer_load_dwordx4 v14, s[36:39], s85 offen offset:0 nt lds
buffer_load_dwordx4 v15, s[36:39], s85 offen offset:1024 nt lds
buffer_load_dwordx4 v16, s[36:39], s85 offen offset:2048 nt lds
s_add_u32 m0, s75, 21504
s_add_u32 s85, s101, 9216
buffer_load_dwordx4 v14, s[36:39], s85 offen offset:0 nt lds
buffer_load_dwordx4 v15, s[36:39], s85 offen offset:1024 nt lds
buffer_load_dwordx4 v16, s[36:39], s85 offen offset:2048 nt lds
s_waitcnt vmcnt(44)
s_add_u32 s77, s77, 12288
s_cmp_eq_u32 s77, 196608
s_cselect_b32 s77, 0, s77
s_add_u32 s75, s75, 24576
s_cmp_eq_u32 s75, 73728
s_cselect_b32 s75, 0, s75
s_waitcnt vmcnt(24)
s_barrier
s_add_u32 m0, s84, 135168
s_add_u32 s85, s89, 640
buffer_load_dwordx4 v20, s[44:47], s85 offen offset:0 lds
buffer_load_dwordx4 v21, s[44:47], s85 offen offset:1024 lds
buffer_load_dwordx4 v22, s[44:47], s85 offen offset:2048 lds
buffer_load_dwordx4 v23, s[44:47], s85 offen offset:3072 lds
s_add_u32 m0, s84, 139264
s_add_u32 s85, s89, 41600
buffer_load_dwordx4 v20, s[44:47], s85 offen offset:0 lds
buffer_load_dwordx4 v21, s[44:47], s85 offen offset:1024 lds
buffer_load_dwordx4 v22, s[44:47], s85 offen offset:2048 lds
buffer_load_dwordx4 v23, s[44:47], s85 offen offset:3072 lds
s_add_u32 m0, s84, 143360
s_add_u32 s85, s89, 82560
buffer_load_dwordx4 v20, s[44:47], s85 offen offset:0 lds
buffer_load_dwordx4 v21, s[44:47], s85 offen offset:1024 lds
buffer_load_dwordx4 v22, s[44:47], s85 offen offset:2048 lds
buffer_load_dwordx4 v23, s[44:47], s85 offen offset:3072 lds
s_add_u32 m0, s84, 98304
s_add_u32 s85, s100, 3932160
buffer_load_dwordx4 v17, s[40:43], s85 offen offset:0 lds
buffer_load_dwordx4 v18, s[40:43], s85 offen offset:1024 lds
buffer_load_dwordx4 v19, s[40:43], s85 offen offset:2048 lds
s_add_u32 m0, s84, 101376
s_add_u32 s85, s100, 4030464
buffer_load_dwordx4 v32, s[40:43], s85 offen offset:0 lds
s_waitcnt vmcnt(44)
buffer_load_dwordx4 v33, s[40:43], s85 offen offset:1024 lds
buffer_load_dwordx4 v34, s[40:43], s85 offen offset:2048 lds
s_add_u32 m0, s84, 104448
s_add_u32 s85, s100, 4128768
buffer_load_dwordx4 v17, s[40:43], s85 offen offset:0 lds
buffer_load_dwordx4 v18, s[40:43], s85 offen offset:1024 lds
buffer_load_dwordx4 v19, s[40:43], s85 offen offset:2048 lds
s_add_u32 m0, s84, 107520
s_add_u32 s85, s100, 4227072
buffer_load_dwordx4 v32, s[40:43], s85 offen offset:0 lds
buffer_load_dwordx4 v33, s[40:43], s85 offen offset:1024 lds
buffer_load_dwordx4 v34, s[40:43], s85 offen offset:2048 lds
s_add_u32 s101, s80, s77
s_add_u32 m0, s75, 0
s_add_u32 s85, s101, 0
buffer_load_dwordx4 v8, s[32:35], s85 offen offset:0 nt lds
buffer_load_dwordx4 v9, s[32:35], s85 offen offset:1024 nt lds
buffer_load_dwordx4 v10, s[32:35], s85 offen offset:2048 nt lds
s_add_u32 m0, s75, 3072
s_add_u32 s85, s101, 3072
buffer_load_dwordx4 v11, s[32:35], s85 offen offset:0 nt lds
buffer_load_dwordx4 v12, s[32:35], s85 offen offset:1024 nt lds
buffer_load_dwordx4 v13, s[32:35], s85 offen offset:2048 nt lds
s_add_u32 m0, s75, 6144
s_add_u32 s85, s101, 6144
buffer_load_dwordx4 v8, s[32:35], s85 offen offset:0 nt lds
buffer_load_dwordx4 v9, s[32:35], s85 offen offset:1024 nt lds
s_waitcnt vmcnt(44)
buffer_load_dwordx4 v10, s[32:35], s85 offen offset:2048 nt lds
s_add_u32 m0, s75, 9216
s_add_u32 s85, s101, 9216
buffer_load_dwordx4 v11, s[32:35], s85 offen offset:0 nt lds
buffer_load_dwordx4 v12, s[32:35], s85 offen offset:1024 nt lds
buffer_load_dwordx4 v13, s[32:35], s85 offen offset:2048 nt lds
s_add_u32 m0, s75, 12288
s_add_u32 s85, s101, 0
buffer_load_dwordx4 v14, s[36:39], s85 offen offset:0 nt lds
buffer_load_dwordx4 v15, s[36:39], s85 offen offset:1024 nt lds
buffer_load_dwordx4 v16, s[36:39], s85 offen offset:2048 nt lds
s_add_u32 m0, s75, 15360
s_add_u32 s85, s101, 3072
buffer_load_dwordx4 v14, s[36:39], s85 offen offset:0 nt lds
buffer_load_dwordx4 v15, s[36:39], s85 offen offset:1024 nt lds
buffer_load_dwordx4 v16, s[36:39], s85 offen offset:2048 nt lds
s_add_u32 m0, s75, 18432
s_add_u32 s85, s101, 6144
buffer_load_dwordx4 v14, s[36:39], s85 offen offset:0 nt lds
buffer_load_dwordx4 v15, s[36:39], s85 offen offset:1024 nt lds
buffer_load_dwordx4 v16, s[36:39], s85 offen offset:2048 nt lds
s_add_u32 m0, s75, 21504
s_add_u32 s85, s101, 9216
buffer_load_dwordx4 v14, s[36:39], s85 offen offset:0 nt lds
buffer_load_dwordx4 v15, s[36:39], s85 offen offset:1024 nt lds
buffer_load_dwordx4 v16, s[36:39], s85 offen offset:2048 nt lds
s_waitcnt vmcnt(44)
s_add_u32 s77, s77, 12288
s_cmp_eq_u32 s77, 196608
s_cselect_b32 s77, 0, s77
s_add_u32 s75, s75, 24576
s_cmp_eq_u32 s75, 73728
s_cselect_b32 s75, 0, s75
s_waitcnt vmcnt(24)
s_barrier
s_add_u32 m0, s84, 110592
s_add_u32 s85, s100, 4325376
buffer_load_dwordx4 v17, s[40:43], s85 offen offset:0 lds
buffer_load_dwordx4 v18, s[40:43], s85 offen offset:1024 lds
buffer_load_dwordx4 v19, s[40:43], s85 offen offset:2048 lds
s_add_u32 m0, s84, 113664
s_add_u32 s85, s100, 4423680
buffer_load_dwordx4 v32, s[40:43], s85 offen offset:0 lds
buffer_load_dwordx4 v33, s[40:43], s85 offen offset:1024 lds
buffer_load_dwordx4 v34, s[40:43], s85 offen offset:2048 lds
s_add_u32 m0, s84, 116736
s_add_u32 s85, s100, 4521984
buffer_load_dwordx4 v17, s[40:43], s85 offen offset:0 lds
buffer_load_dwordx4 v18, s[40:43], s85 offen offset:1024 lds
buffer_load_dwordx4 v19, s[40:43], s85 offen offset:2048 lds
s_add_u32 m0, s84, 119808
s_add_u32 s85, s100, 4620288
buffer_load_dwordx4 v32, s[40:43], s85 offen offset:0 lds
buffer_load_dwordx4 v33, s[40:43], s85 offen offset:1024 lds
buffer_load_dwordx4 v34, s[40:43], s85 offen offset:2048 lds
s_add_u32 s101, s80, s77
s_add_u32 m0, s75, 0
s_add_u32 s85, s101, 0
buffer_load_dwordx4 v8, s[32:35], s85 offen offset:0 nt lds
buffer_load_dwordx4 v9, s[32:35], s85 offen offset:1024 nt lds
buffer_load_dwordx4 v10, s[32:35], s85 offen offset:2048 nt lds
s_add_u32 m0, s75, 3072
s_add_u32 s85, s101, 3072
buffer_load_dwordx4 v11, s[32:35], s85 offen offset:0 nt lds
s_waitcnt vmcnt(44)
buffer_load_dwordx4 v12, s[32:35], s85 offen offset:1024 nt lds
buffer_load_dwordx4 v13, s[32:35], s85 offen offset:2048 nt lds
s_add_u32 m0, s75, 6144
s_add_u32 s85, s101, 6144
buffer_load_dwordx4 v8, s[32:35], s85 offen offset:0 nt lds
buffer_load_dwordx4 v9, s[32:35], s85 offen offset:1024 nt lds
buffer_load_dwordx4 v10, s[32:35], s85 offen offset:2048 nt lds
s_add_u32 m0, s75, 9216
s_add_u32 s85, s101, 9216
buffer_load_dwordx4 v11, s[32:35], s85 offen offset:0 nt lds
buffer_load_dwordx4 v12, s[32:35], s85 offen offset:1024 nt lds
buffer_load_dwordx4 v13, s[32:35], s85 offen offset:2048 nt lds
s_add_u32 m0, s75, 12288
s_add_u32 s85, s101, 0
buffer_load_dwordx4 v14, s[36:39], s85 offen offset:0 nt lds
buffer_load_dwordx4 v15, s[36:39], s85 offen offset:1024 nt lds
buffer_load_dwordx4 v16, s[36:39], s85 offen offset:2048 nt lds
s_add_u32 m0, s75, 15360
s_add_u32 s85, s101, 3072
buffer_load_dwordx4 v14, s[36:39], s85 offen offset:0 nt lds
buffer_load_dwordx4 v15, s[36:39], s85 offen offset:1024 nt lds
buffer_load_dwordx4 v16, s[36:39], s85 offen offset:2048 nt lds
s_add_u32 m0, s75, 18432
s_add_u32 s85, s101, 6144
buffer_load_dwordx4 v14, s[36:39], s85 offen offset:0 nt lds
buffer_load_dwordx4 v15, s[36:39], s85 offen offset:1024 nt lds
s_waitcnt vmcnt(44)
buffer_load_dwordx4 v16, s[36:39], s85 offen offset:2048 nt lds
s_add_u32 m0, s75, 21504
s_add_u32 s85, s101, 9216
buffer_load_dwordx4 v14, s[36:39], s85 offen offset:0 nt lds
buffer_load_dwordx4 v15, s[36:39], s85 offen offset:1024 nt lds
buffer_load_dwordx4 v16, s[36:39], s85 offen offset:2048 nt lds
s_add_u32 s77, s77, 12288
s_cmp_eq_u32 s77, 196608
s_cselect_b32 s77, 0, s77
s_add_u32 s75, s75, 24576
s_cmp_eq_u32 s75, 73728
s_cselect_b32 s75, 0, s75
s_cmp_ge_u32 s74, 2
s_cbranch_scc1 L_ld_nopf8
s_mov_b32 m0, 163584
s_add_u32 s85, s83, 245760
buffer_load_dword v31, s[40:43], s85 offen lds
s_waitcnt vmcnt(25)
s_barrier
s_branch L_ld_b8
L_ld_nopf8:
s_waitcnt vmcnt(24)
s_barrier
L_ld_b8:
s_add_u32 m0, s84, 73728
s_add_u32 s85, s100, 4718592
buffer_load_dwordx4 v17, s[40:43], s85 offen offset:0 lds
buffer_load_dwordx4 v18, s[40:43], s85 offen offset:1024 lds
buffer_load_dwordx4 v19, s[40:43], s85 offen offset:2048 lds
s_add_u32 m0, s84, 76800
s_add_u32 s85, s100, 4816896
buffer_load_dwordx4 v32, s[40:43], s85 offen offset:0 lds
buffer_load_dwordx4 v33, s[40:43], s85 offen offset:1024 lds
buffer_load_dwordx4 v34, s[40:43], s85 offen offset:2048 lds
s_add_u32 m0, s84, 79872
s_add_u32 s85, s100, 4915200
buffer_load_dwordx4 v17, s[40:43], s85 offen offset:0 lds
buffer_load_dwordx4 v18, s[40:43], s85 offen offset:1024 lds
buffer_load_dwordx4 v19, s[40:43], s85 offen offset:2048 lds
s_add_u32 m0, s84, 82944
s_add_u32 s85, s100, 5013504
buffer_load_dwordx4 v32, s[40:43], s85 offen offset:0 lds
buffer_load_dwordx4 v33, s[40:43], s85 offen offset:1024 lds
s_waitcnt vmcnt(44)
buffer_load_dwordx4 v34, s[40:43], s85 offen offset:2048 lds
s_add_u32 m0, s84, 86016
s_add_u32 s85, s100, 5111808
buffer_load_dwordx4 v17, s[40:43], s85 offen offset:0 lds
buffer_load_dwordx4 v18, s[40:43], s85 offen offset:1024 lds
buffer_load_dwordx4 v19, s[40:43], s85 offen offset:2048 lds
s_add_u32 m0, s84, 89088
s_add_u32 s85, s100, 5210112
buffer_load_dwordx4 v32, s[40:43], s85 offen offset:0 lds
buffer_load_dwordx4 v33, s[40:43], s85 offen offset:1024 lds
buffer_load_dwordx4 v34, s[40:43], s85 offen offset:2048 lds
s_add_u32 m0, s84, 92160
s_add_u32 s85, s100, 5308416
buffer_load_dwordx4 v17, s[40:43], s85 offen offset:0 lds
buffer_load_dwordx4 v18, s[40:43], s85 offen offset:1024 lds
buffer_load_dwordx4 v19, s[40:43], s85 offen offset:2048 lds
s_add_u32 m0, s84, 95232
s_add_u32 s85, s100, 5406720
buffer_load_dwordx4 v32, s[40:43], s85 offen offset:0 lds
buffer_load_dwordx4 v33, s[40:43], s85 offen offset:1024 lds
buffer_load_dwordx4 v34, s[40:43], s85 offen offset:2048 lds
s_add_u32 s101, s80, s77
s_add_u32 m0, s75, 0
s_add_u32 s85, s101, 0
buffer_load_dwordx4 v8, s[32:35], s85 offen offset:0 nt lds
buffer_load_dwordx4 v9, s[32:35], s85 offen offset:1024 nt lds
buffer_load_dwordx4 v10, s[32:35], s85 offen offset:2048 nt lds
s_waitcnt vmcnt(44)
s_add_u32 m0, s75, 3072
s_add_u32 s85, s101, 3072
buffer_load_dwordx4 v11, s[32:35], s85 offen offset:0 nt lds
buffer_load_dwordx4 v12, s[32:35], s85 offen offset:1024 nt lds
buffer_load_dwordx4 v13, s[32:35], s85 offen offset:2048 nt lds
s_add_u32 m0, s75, 6144
s_add_u32 s85, s101, 6144
buffer_load_dwordx4 v8, s[32:35], s85 offen offset:0 nt lds
buffer_load_dwordx4 v9, s[32:35], s85 offen offset:1024 nt lds
buffer_load_dwordx4 v10, s[32:35], s85 offen offset:2048 nt lds
s_add_u32 m0, s75, 9216
s_add_u32 s85, s101, 9216
buffer_load_dwordx4 v11, s[32:35], s85 offen offset:0 nt lds
buffer_load_dwordx4 v12, s[32:35], s85 offen offset:1024 nt lds
buffer_load_dwordx4 v13, s[32:35], s85 offen offset:2048 nt lds
s_add_u32 m0, s75, 12288
s_add_u32 s85, s101, 0
buffer_load_dwordx4 v14, s[36:39], s85 offen offset:0 nt lds
buffer_load_dwordx4 v15, s[36:39], s85 offen offset:1024 nt lds
buffer_load_dwordx4 v16, s[36:39], s85 offen offset:2048 nt lds
s_add_u32 m0, s75, 15360
s_add_u32 s85, s101, 3072
buffer_load_dwordx4 v14, s[36:39], s85 offen offset:0 nt lds
buffer_load_dwordx4 v15, s[36:39], s85 offen offset:1024 nt lds
buffer_load_dwordx4 v16, s[36:39], s85 offen offset:2048 nt lds
s_add_u32 m0, s75, 18432
s_add_u32 s85, s101, 6144
buffer_load_dwordx4 v14, s[36:39], s85 offen offset:0 nt lds
s_waitcnt vmcnt(44)
buffer_load_dwordx4 v15, s[36:39], s85 offen offset:1024 nt lds
buffer_load_dwordx4 v16, s[36:39], s85 offen offset:2048 nt lds
s_add_u32 m0, s75, 21504
s_add_u32 s85, s101, 9216
buffer_load_dwordx4 v14, s[36:39], s85 offen offset:0 nt lds
buffer_load_dwordx4 v15, s[36:39], s85 offen offset:1024 nt lds
buffer_load_dwordx4 v16, s[36:39], s85 offen offset:2048 nt lds
s_add_u32 s77, s77, 12288
s_cmp_eq_u32 s77, 196608
s_cselect_b32 s77, 0, s77
s_add_u32 s75, s75, 24576
s_cmp_eq_u32 s75, 73728
s_cselect_b32 s75, 0, s75
s_waitcnt vmcnt(24)
s_barrier
s_add_u32 m0, s84, 135168
s_add_u32 s85, s89, 896
buffer_load_dwordx4 v20, s[44:47], s85 offen offset:0 lds
buffer_load_dwordx4 v21, s[44:47], s85 offen offset:1024 lds
buffer_load_dwordx4 v22, s[44:47], s85 offen offset:2048 lds
buffer_load_dwordx4 v23, s[44:47], s85 offen offset:3072 lds
s_add_u32 m0, s84, 139264
s_add_u32 s85, s89, 41856
buffer_load_dwordx4 v20, s[44:47], s85 offen offset:0 lds
buffer_load_dwordx4 v21, s[44:47], s85 offen offset:1024 lds
buffer_load_dwordx4 v22, s[44:47], s85 offen offset:2048 lds
buffer_load_dwordx4 v23, s[44:47], s85 offen offset:3072 lds
s_add_u32 m0, s84, 143360
s_add_u32 s85, s89, 82816
buffer_load_dwordx4 v20, s[44:47], s85 offen offset:0 lds
buffer_load_dwordx4 v21, s[44:47], s85 offen offset:1024 lds
buffer_load_dwordx4 v22, s[44:47], s85 offen offset:2048 lds
s_waitcnt vmcnt(44)
buffer_load_dwordx4 v23, s[44:47], s85 offen offset:3072 lds
s_add_u32 m0, s84, 98304
s_add_u32 s85, s100, 5505024
buffer_load_dwordx4 v17, s[40:43], s85 offen offset:0 lds
buffer_load_dwordx4 v18, s[40:43], s85 offen offset:1024 lds
buffer_load_dwordx4 v19, s[40:43], s85 offen offset:2048 lds
s_add_u32 m0, s84, 101376
s_add_u32 s85, s100, 5603328
buffer_load_dwordx4 v32, s[40:43], s85 offen offset:0 lds
buffer_load_dwordx4 v33, s[40:43], s85 offen offset:1024 lds
buffer_load_dwordx4 v34, s[40:43], s85 offen offset:2048 lds
s_add_u32 m0, s84, 104448
s_add_u32 s85, s100, 5701632
buffer_load_dwordx4 v17, s[40:43], s85 offen offset:0 lds
buffer_load_dwordx4 v18, s[40:43], s85 offen offset:1024 lds
buffer_load_dwordx4 v19, s[40:43], s85 offen offset:2048 lds
s_add_u32 m0, s84, 107520
s_add_u32 s85, s100, 5799936
buffer_load_dwordx4 v32, s[40:43], s85 offen offset:0 lds
buffer_load_dwordx4 v33, s[40:43], s85 offen offset:1024 lds
buffer_load_dwordx4 v34, s[40:43], s85 offen offset:2048 lds
s_add_u32 s101, s80, s77
s_add_u32 m0, s75, 0
s_add_u32 s85, s101, 0
buffer_load_dwordx4 v8, s[32:35], s85 offen offset:0 nt lds
buffer_load_dwordx4 v9, s[32:35], s85 offen offset:1024 nt lds
buffer_load_dwordx4 v10, s[32:35], s85 offen offset:2048 nt lds
s_waitcnt vmcnt(44)
s_add_u32 m0, s75, 3072
s_add_u32 s85, s101, 3072
buffer_load_dwordx4 v11, s[32:35], s85 offen offset:0 nt lds
buffer_load_dwordx4 v12, s[32:35], s85 offen offset:1024 nt lds
buffer_load_dwordx4 v13, s[32:35], s85 offen offset:2048 nt lds
s_add_u32 m0, s75, 6144
s_add_u32 s85, s101, 6144
buffer_load_dwordx4 v8, s[32:35], s85 offen offset:0 nt lds
buffer_load_dwordx4 v9, s[32:35], s85 offen offset:1024 nt lds
buffer_load_dwordx4 v10, s[32:35], s85 offen offset:2048 nt lds
s_add_u32 m0, s75, 9216
s_add_u32 s85, s101, 9216
buffer_load_dwordx4 v11, s[32:35], s85 offen offset:0 nt lds
buffer_load_dwordx4 v12, s[32:35], s85 offen offset:1024 nt lds
buffer_load_dwordx4 v13, s[32:35], s85 offen offset:2048 nt lds
s_add_u32 m0, s75, 12288
s_add_u32 s85, s101, 0
buffer_load_dwordx4 v14, s[36:39], s85 offen offset:0 nt lds
buffer_load_dwordx4 v15, s[36:39], s85 offen offset:1024 nt lds
buffer_load_dwordx4 v16, s[36:39], s85 offen offset:2048 nt lds
s_add_u32 m0, s75, 15360
s_add_u32 s85, s101, 3072
buffer_load_dwordx4 v14, s[36:39], s85 offen offset:0 nt lds
buffer_load_dwordx4 v15, s[36:39], s85 offen offset:1024 nt lds
buffer_load_dwordx4 v16, s[36:39], s85 offen offset:2048 nt lds
s_add_u32 m0, s75, 18432
s_add_u32 s85, s101, 6144
buffer_load_dwordx4 v14, s[36:39], s85 offen offset:0 nt lds
s_waitcnt vmcnt(44)
buffer_load_dwordx4 v15, s[36:39], s85 offen offset:1024 nt lds
buffer_load_dwordx4 v16, s[36:39], s85 offen offset:2048 nt lds
s_add_u32 m0, s75, 21504
s_add_u32 s85, s101, 9216
buffer_load_dwordx4 v14, s[36:39], s85 offen offset:0 nt lds
buffer_load_dwordx4 v15, s[36:39], s85 offen offset:1024 nt lds
buffer_load_dwordx4 v16, s[36:39], s85 offen offset:2048 nt lds
s_add_u32 s77, s77, 12288
s_cmp_eq_u32 s77, 196608
s_cselect_b32 s77, 0, s77
s_add_u32 s75, s75, 24576
s_cmp_eq_u32 s75, 73728
s_cselect_b32 s75, 0, s75
s_waitcnt vmcnt(24)
s_barrier
s_add_u32 m0, s84, 110592
s_add_u32 s85, s100, 5898240
buffer_load_dwordx4 v17, s[40:43], s85 offen offset:0 lds
buffer_load_dwordx4 v18, s[40:43], s85 offen offset:1024 lds
buffer_load_dwordx4 v19, s[40:43], s85 offen offset:2048 lds
s_add_u32 m0, s84, 113664
s_add_u32 s85, s100, 5996544
buffer_load_dwordx4 v32, s[40:43], s85 offen offset:0 lds
buffer_load_dwordx4 v33, s[40:43], s85 offen offset:1024 lds
buffer_load_dwordx4 v34, s[40:43], s85 offen offset:2048 lds
s_add_u32 m0, s84, 116736
s_add_u32 s85, s100, 6094848
buffer_load_dwordx4 v17, s[40:43], s85 offen offset:0 lds
buffer_load_dwordx4 v18, s[40:43], s85 offen offset:1024 lds
buffer_load_dwordx4 v19, s[40:43], s85 offen offset:2048 lds
s_add_u32 m0, s84, 119808
s_add_u32 s85, s100, 6193152
buffer_load_dwordx4 v32, s[40:43], s85 offen offset:0 lds
buffer_load_dwordx4 v33, s[40:43], s85 offen offset:1024 lds
s_waitcnt vmcnt(44)
buffer_load_dwordx4 v34, s[40:43], s85 offen offset:2048 lds
s_add_u32 s101, s80, s77
s_add_u32 m0, s75, 0
s_add_u32 s85, s101, 0
buffer_load_dwordx4 v8, s[32:35], s85 offen offset:0 nt lds
buffer_load_dwordx4 v9, s[32:35], s85 offen offset:1024 nt lds
buffer_load_dwordx4 v10, s[32:35], s85 offen offset:2048 nt lds
s_add_u32 m0, s75, 3072
s_add_u32 s85, s101, 3072
buffer_load_dwordx4 v11, s[32:35], s85 offen offset:0 nt lds
buffer_load_dwordx4 v12, s[32:35], s85 offen offset:1024 nt lds
buffer_load_dwordx4 v13, s[32:35], s85 offen offset:2048 nt lds
s_add_u32 m0, s75, 6144
s_add_u32 s85, s101, 6144
buffer_load_dwordx4 v8, s[32:35], s85 offen offset:0 nt lds
buffer_load_dwordx4 v9, s[32:35], s85 offen offset:1024 nt lds
buffer_load_dwordx4 v10, s[32:35], s85 offen offset:2048 nt lds
s_add_u32 m0, s75, 9216
s_add_u32 s85, s101, 9216
buffer_load_dwordx4 v11, s[32:35], s85 offen offset:0 nt lds
buffer_load_dwordx4 v12, s[32:35], s85 offen offset:1024 nt lds
buffer_load_dwordx4 v13, s[32:35], s85 offen offset:2048 nt lds
s_add_u32 m0, s75, 12288
s_add_u32 s85, s101, 0
buffer_load_dwordx4 v14, s[36:39], s85 offen offset:0 nt lds
buffer_load_dwordx4 v15, s[36:39], s85 offen offset:1024 nt lds
buffer_load_dwordx4 v16, s[36:39], s85 offen offset:2048 nt lds
s_waitcnt vmcnt(44)
s_add_u32 m0, s75, 15360
s_add_u32 s85, s101, 3072
buffer_load_dwordx4 v14, s[36:39], s85 offen offset:0 nt lds
buffer_load_dwordx4 v15, s[36:39], s85 offen offset:1024 nt lds
buffer_load_dwordx4 v16, s[36:39], s85 offen offset:2048 nt lds
s_add_u32 m0, s75, 18432
s_add_u32 s85, s101, 6144
buffer_load_dwordx4 v14, s[36:39], s85 offen offset:0 nt lds
buffer_load_dwordx4 v15, s[36:39], s85 offen offset:1024 nt lds
buffer_load_dwordx4 v16, s[36:39], s85 offen offset:2048 nt lds
s_add_u32 m0, s75, 21504
s_add_u32 s85, s101, 9216
buffer_load_dwordx4 v14, s[36:39], s85 offen offset:0 nt lds
buffer_load_dwordx4 v15, s[36:39], s85 offen offset:1024 nt lds
buffer_load_dwordx4 v16, s[36:39], s85 offen offset:2048 nt lds
s_add_u32 s77, s77, 12288
s_cmp_eq_u32 s77, 196608
s_cselect_b32 s77, 0, s77
s_add_u32 s75, s75, 24576
s_cmp_eq_u32 s75, 73728
s_cselect_b32 s75, 0, s75
s_cmp_ge_u32 s74, 2
s_cbranch_scc1 L_ld_nopf11
s_mov_b32 m0, 163584
s_add_u32 s85, s83, 368640
buffer_load_dword v31, s[40:43], s85 offen lds
s_waitcnt vmcnt(25)
s_barrier
s_branch L_ld_b11
L_ld_nopf11:
s_waitcnt vmcnt(24)
s_barrier
L_ld_b11:
s_add_u32 m0, s84, 73728
s_add_u32 s85, s100, 6291456
buffer_load_dwordx4 v17, s[40:43], s85 offen offset:0 lds
buffer_load_dwordx4 v18, s[40:43], s85 offen offset:1024 lds
buffer_load_dwordx4 v19, s[40:43], s85 offen offset:2048 lds
s_add_u32 m0, s84, 76800
s_add_u32 s85, s100, 6389760
buffer_load_dwordx4 v32, s[40:43], s85 offen offset:0 lds
buffer_load_dwordx4 v33, s[40:43], s85 offen offset:1024 lds
buffer_load_dwordx4 v34, s[40:43], s85 offen offset:2048 lds
s_waitcnt vmcnt(44)
s_add_u32 m0, s84, 79872
s_add_u32 s85, s100, 6488064
buffer_load_dwordx4 v17, s[40:43], s85 offen offset:0 lds
buffer_load_dwordx4 v18, s[40:43], s85 offen offset:1024 lds
buffer_load_dwordx4 v19, s[40:43], s85 offen offset:2048 lds
s_add_u32 m0, s84, 82944
s_add_u32 s85, s100, 6586368
buffer_load_dwordx4 v32, s[40:43], s85 offen offset:0 lds
buffer_load_dwordx4 v33, s[40:43], s85 offen offset:1024 lds
buffer_load_dwordx4 v34, s[40:43], s85 offen offset:2048 lds
s_add_u32 m0, s84, 86016
s_add_u32 s85, s100, 6684672
buffer_load_dwordx4 v17, s[40:43], s85 offen offset:0 lds
buffer_load_dwordx4 v18, s[40:43], s85 offen offset:1024 lds
buffer_load_dwordx4 v19, s[40:43], s85 offen offset:2048 lds
s_add_u32 m0, s84, 89088
s_add_u32 s85, s100, 6782976
buffer_load_dwordx4 v32, s[40:43], s85 offen offset:0 lds
buffer_load_dwordx4 v33, s[40:43], s85 offen offset:1024 lds
buffer_load_dwordx4 v34, s[40:43], s85 offen offset:2048 lds
s_add_u32 m0, s84, 92160
s_add_u32 s85, s100, 6881280
buffer_load_dwordx4 v17, s[40:43], s85 offen offset:0 lds
buffer_load_dwordx4 v18, s[40:43], s85 offen offset:1024 lds
buffer_load_dwordx4 v19, s[40:43], s85 offen offset:2048 lds
s_add_u32 m0, s84, 95232
s_add_u32 s85, s100, 6979584
buffer_load_dwordx4 v32, s[40:43], s85 offen offset:0 lds
s_waitcnt vmcnt(44)
buffer_load_dwordx4 v33, s[40:43], s85 offen offset:1024 lds
buffer_load_dwordx4 v34, s[40:43], s85 offen offset:2048 lds
s_add_u32 s101, s80, s77
s_add_u32 m0, s75, 0
s_add_u32 s85, s101, 0
buffer_load_dwordx4 v8, s[32:35], s85 offen offset:0 nt lds
buffer_load_dwordx4 v9, s[32:35], s85 offen offset:1024 nt lds
buffer_load_dwordx4 v10, s[32:35], s85 offen offset:2048 nt lds
s_add_u32 m0, s75, 3072
s_add_u32 s85, s101, 3072
buffer_load_dwordx4 v11, s[32:35], s85 offen offset:0 nt lds
buffer_load_dwordx4 v12, s[32:35], s85 offen offset:1024 nt lds
buffer_load_dwordx4 v13, s[32:35], s85 offen offset:2048 nt lds
s_add_u32 m0, s75, 6144
s_add_u32 s85, s101, 6144
buffer_load_dwordx4 v8, s[32:35], s85 offen offset:0 nt lds
buffer_load_dwordx4 v9, s[32:35], s85 offen offset:1024 nt lds
buffer_load_dwordx4 v10, s[32:35], s85 offen offset:2048 nt lds
s_add_u32 m0, s75, 9216
s_add_u32 s85, s101, 9216
buffer_load_dwordx4 v11, s[32:35], s85 offen offset:0 nt lds
buffer_load_dwordx4 v12, s[32:35], s85 offen offset:1024 nt lds
buffer_load_dwordx4 v13, s[32:35], s85 offen offset:2048 nt lds
s_add_u32 m0, s75, 12288
s_add_u32 s85, s101, 0
buffer_load_dwordx4 v14, s[36:39], s85 offen offset:0 nt lds
buffer_load_dwordx4 v15, s[36:39], s85 offen offset:1024 nt lds
s_waitcnt vmcnt(44)
buffer_load_dwordx4 v16, s[36:39], s85 offen offset:2048 nt lds
s_add_u32 m0, s75, 15360
s_add_u32 s85, s101, 3072
buffer_load_dwordx4 v14, s[36:39], s85 offen offset:0 nt lds
buffer_load_dwordx4 v15, s[36:39], s85 offen offset:1024 nt lds
buffer_load_dwordx4 v16, s[36:39], s85 offen offset:2048 nt lds
s_add_u32 m0, s75, 18432
s_add_u32 s85, s101, 6144
buffer_load_dwordx4 v14, s[36:39], s85 offen offset:0 nt lds
buffer_load_dwordx4 v15, s[36:39], s85 offen offset:1024 nt lds
buffer_load_dwordx4 v16, s[36:39], s85 offen offset:2048 nt lds
s_add_u32 m0, s75, 21504
s_add_u32 s85, s101, 9216
buffer_load_dwordx4 v14, s[36:39], s85 offen offset:0 nt lds
buffer_load_dwordx4 v15, s[36:39], s85 offen offset:1024 nt lds
buffer_load_dwordx4 v16, s[36:39], s85 offen offset:2048 nt lds
s_add_u32 s77, s77, 12288
s_cmp_eq_u32 s77, 196608
s_cselect_b32 s77, 0, s77
s_add_u32 s75, s75, 24576
s_cmp_eq_u32 s75, 73728
s_cselect_b32 s75, 0, s75
s_waitcnt vmcnt(24)
s_barrier
s_add_u32 m0, s84, 98304
s_add_u32 s85, s100, 7077888
buffer_load_dwordx4 v17, s[40:43], s85 offen offset:0 lds
buffer_load_dwordx4 v18, s[40:43], s85 offen offset:1024 lds
buffer_load_dwordx4 v19, s[40:43], s85 offen offset:2048 lds
s_add_u32 m0, s84, 101376
s_add_u32 s85, s100, 7176192
buffer_load_dwordx4 v32, s[40:43], s85 offen offset:0 lds
buffer_load_dwordx4 v33, s[40:43], s85 offen offset:1024 lds
buffer_load_dwordx4 v34, s[40:43], s85 offen offset:2048 lds
s_waitcnt vmcnt(44)
s_add_u32 m0, s84, 104448
s_add_u32 s85, s100, 7274496
buffer_load_dwordx4 v17, s[40:43], s85 offen offset:0 lds
buffer_load_dwordx4 v18, s[40:43], s85 offen offset:1024 lds
buffer_load_dwordx4 v19, s[40:43], s85 offen offset:2048 lds
s_add_u32 m0, s84, 107520
s_add_u32 s85, s100, 7372800
buffer_load_dwordx4 v32, s[40:43], s85 offen offset:0 lds
buffer_load_dwordx4 v33, s[40:43], s85 offen offset:1024 lds
buffer_load_dwordx4 v34, s[40:43], s85 offen offset:2048 lds
s_add_u32 s101, s80, s77
s_add_u32 m0, s75, 0
s_add_u32 s85, s101, 0
buffer_load_dwordx4 v8, s[32:35], s85 offen offset:0 nt lds
buffer_load_dwordx4 v9, s[32:35], s85 offen offset:1024 nt lds
buffer_load_dwordx4 v10, s[32:35], s85 offen offset:2048 nt lds
s_add_u32 m0, s75, 3072
s_add_u32 s85, s101, 3072
buffer_load_dwordx4 v11, s[32:35], s85 offen offset:0 nt lds
buffer_load_dwordx4 v12, s[32:35], s85 offen offset:1024 nt lds
buffer_load_dwordx4 v13, s[32:35], s85 offen offset:2048 nt lds
s_add_u32 m0, s75, 6144
s_add_u32 s85, s101, 6144
buffer_load_dwordx4 v8, s[32:35], s85 offen offset:0 nt lds
buffer_load_dwordx4 v9, s[32:35], s85 offen offset:1024 nt lds
buffer_load_dwordx4 v10, s[32:35], s85 offen offset:2048 nt lds
s_add_u32 m0, s75, 9216
s_add_u32 s85, s101, 9216
buffer_load_dwordx4 v11, s[32:35], s85 offen offset:0 nt lds
s_waitcnt vmcnt(44)
buffer_load_dwordx4 v12, s[32:35], s85 offen offset:1024 nt lds
buffer_load_dwordx4 v13, s[32:35], s85 offen offset:2048 nt lds
s_add_u32 m0, s75, 12288
s_add_u32 s85, s101, 0
buffer_load_dwordx4 v14, s[36:39], s85 offen offset:0 nt lds
buffer_load_dwordx4 v15, s[36:39], s85 offen offset:1024 nt lds
buffer_load_dwordx4 v16, s[36:39], s85 offen offset:2048 nt lds
s_add_u32 m0, s75, 15360
s_add_u32 s85, s101, 3072
buffer_load_dwordx4 v14, s[36:39], s85 offen offset:0 nt lds
buffer_load_dwordx4 v15, s[36:39], s85 offen offset:1024 nt lds
buffer_load_dwordx4 v16, s[36:39], s85 offen offset:2048 nt lds
s_add_u32 m0, s75, 18432
s_add_u32 s85, s101, 6144
buffer_load_dwordx4 v14, s[36:39], s85 offen offset:0 nt lds
buffer_load_dwordx4 v15, s[36:39], s85 offen offset:1024 nt lds
buffer_load_dwordx4 v16, s[36:39], s85 offen offset:2048 nt lds
s_add_u32 m0, s75, 21504
s_add_u32 s85, s101, 9216
buffer_load_dwordx4 v14, s[36:39], s85 offen offset:0 nt lds
buffer_load_dwordx4 v15, s[36:39], s85 offen offset:1024 nt lds
buffer_load_dwordx4 v16, s[36:39], s85 offen offset:2048 nt lds
s_add_u32 s77, s77, 12288
s_cmp_eq_u32 s77, 196608
s_cselect_b32 s77, 0, s77
s_add_u32 s75, s75, 24576
s_cmp_eq_u32 s75, 73728
s_cselect_b32 s75, 0, s75
s_waitcnt vmcnt(24)
s_barrier
s_add_u32 m0, s84, 110592
s_add_u32 s85, s100, 7471104
buffer_load_dwordx4 v17, s[40:43], s85 offen offset:0 lds
buffer_load_dwordx4 v18, s[40:43], s85 offen offset:1024 lds
s_waitcnt vmcnt(44)
buffer_load_dwordx4 v19, s[40:43], s85 offen offset:2048 lds
s_add_u32 m0, s84, 113664
s_add_u32 s85, s100, 7569408
buffer_load_dwordx4 v32, s[40:43], s85 offen offset:0 lds
buffer_load_dwordx4 v33, s[40:43], s85 offen offset:1024 lds
buffer_load_dwordx4 v34, s[40:43], s85 offen offset:2048 lds
s_add_u32 m0, s84, 116736
s_add_u32 s85, s100, 7667712
buffer_load_dwordx4 v17, s[40:43], s85 offen offset:0 lds
buffer_load_dwordx4 v18, s[40:43], s85 offen offset:1024 lds
buffer_load_dwordx4 v19, s[40:43], s85 offen offset:2048 lds
s_add_u32 m0, s84, 119808
s_add_u32 s85, s100, 7766016
buffer_load_dwordx4 v32, s[40:43], s85 offen offset:0 lds
buffer_load_dwordx4 v33, s[40:43], s85 offen offset:1024 lds
buffer_load_dwordx4 v34, s[40:43], s85 offen offset:2048 lds
s_add_u32 s80, s80, 1572864
s_add_u32 s101, s80, s77
s_add_u32 m0, s75, 0
s_add_u32 s85, s101, 0
buffer_load_dwordx4 v8, s[32:35], s85 offen offset:0 nt lds
buffer_load_dwordx4 v9, s[32:35], s85 offen offset:1024 nt lds
buffer_load_dwordx4 v10, s[32:35], s85 offen offset:2048 nt lds
s_add_u32 m0, s75, 3072
s_add_u32 s85, s101, 3072
buffer_load_dwordx4 v11, s[32:35], s85 offen offset:0 nt lds
buffer_load_dwordx4 v12, s[32:35], s85 offen offset:1024 nt lds
buffer_load_dwordx4 v13, s[32:35], s85 offen offset:2048 nt lds
s_waitcnt vmcnt(44)
s_add_u32 m0, s75, 6144
s_add_u32 s85, s101, 6144
buffer_load_dwordx4 v8, s[32:35], s85 offen offset:0 nt lds
buffer_load_dwordx4 v9, s[32:35], s85 offen offset:1024 nt lds
buffer_load_dwordx4 v10, s[32:35], s85 offen offset:2048 nt lds
s_add_u32 m0, s75, 9216
s_add_u32 s85, s101, 9216
buffer_load_dwordx4 v11, s[32:35], s85 offen offset:0 nt lds
buffer_load_dwordx4 v12, s[32:35], s85 offen offset:1024 nt lds
buffer_load_dwordx4 v13, s[32:35], s85 offen offset:2048 nt lds
s_add_u32 m0, s75, 12288
s_add_u32 s85, s101, 0
buffer_load_dwordx4 v14, s[36:39], s85 offen offset:0 nt lds
buffer_load_dwordx4 v15, s[36:39], s85 offen offset:1024 nt lds
buffer_load_dwordx4 v16, s[36:39], s85 offen offset:2048 nt lds
s_add_u32 m0, s75, 15360
s_add_u32 s85, s101, 3072
buffer_load_dwordx4 v14, s[36:39], s85 offen offset:0 nt lds
buffer_load_dwordx4 v15, s[36:39], s85 offen offset:1024 nt lds
buffer_load_dwordx4 v16, s[36:39], s85 offen offset:2048 nt lds
s_add_u32 m0, s75, 18432
s_add_u32 s85, s101, 6144
buffer_load_dwordx4 v14, s[36:39], s85 offen offset:0 nt lds
buffer_load_dwordx4 v15, s[36:39], s85 offen offset:1024 nt lds
buffer_load_dwordx4 v16, s[36:39], s85 offen offset:2048 nt lds
s_add_u32 m0, s75, 21504
s_add_u32 s85, s101, 9216
buffer_load_dwordx4 v14, s[36:39], s85 offen offset:0 nt lds
s_waitcnt vmcnt(44)
buffer_load_dwordx4 v15, s[36:39], s85 offen offset:1024 nt lds
buffer_load_dwordx4 v16, s[36:39], s85 offen offset:2048 nt lds
s_add_u32 s77, s77, 12288
s_cmp_eq_u32 s77, 196608
s_cselect_b32 s77, 0, s77
s_add_u32 s75, s75, 24576
s_cmp_eq_u32 s75, 73728
s_cselect_b32 s75, 0, s75
s_waitcnt vmcnt(24)
s_barrier
s_add_u32 s101, s80, s77
s_add_u32 m0, s75, 0
s_add_u32 s85, s101, 0
buffer_load_dwordx4 v8, s[32:35], s85 offen offset:0 nt lds
buffer_load_dwordx4 v9, s[32:35], s85 offen offset:1024 nt lds
buffer_load_dwordx4 v10, s[32:35], s85 offen offset:2048 nt lds
s_add_u32 m0, s75, 3072
s_add_u32 s85, s101, 3072
buffer_load_dwordx4 v11, s[32:35], s85 offen offset:0 nt lds
buffer_load_dwordx4 v12, s[32:35], s85 offen offset:1024 nt lds
buffer_load_dwordx4 v13, s[32:35], s85 offen offset:2048 nt lds
s_add_u32 m0, s75, 6144
s_add_u32 s85, s101, 6144
buffer_load_dwordx4 v8, s[32:35], s85 offen offset:0 nt lds
buffer_load_dwordx4 v9, s[32:35], s85 offen offset:1024 nt lds
buffer_load_dwordx4 v10, s[32:35], s85 offen offset:2048 nt lds
s_add_u32 m0, s75, 9216
s_add_u32 s85, s101, 9216
buffer_load_dwordx4 v11, s[32:35], s85 offen offset:0 nt lds
buffer_load_dwordx4 v12, s[32:35], s85 offen offset:1024 nt lds
buffer_load_dwordx4 v13, s[32:35], s85 offen offset:2048 nt lds
s_add_u32 m0, s75, 12288
s_add_u32 s85, s101, 0
buffer_load_dwordx4 v14, s[36:39], s85 offen offset:0 nt lds
buffer_load_dwordx4 v15, s[36:39], s85 offen offset:1024 nt lds
s_waitcnt vmcnt(44)
buffer_load_dwordx4 v16, s[36:39], s85 offen offset:2048 nt lds
s_add_u32 m0, s75, 15360
s_add_u32 s85, s101, 3072
buffer_load_dwordx4 v14, s[36:39], s85 offen offset:0 nt lds
buffer_load_dwordx4 v15, s[36:39], s85 offen offset:1024 nt lds
buffer_load_dwordx4 v16, s[36:39], s85 offen offset:2048 nt lds
s_add_u32 m0, s75, 18432
s_add_u32 s85, s101, 6144
buffer_load_dwordx4 v14, s[36:39], s85 offen offset:0 nt lds
buffer_load_dwordx4 v15, s[36:39], s85 offen offset:1024 nt lds
buffer_load_dwordx4 v16, s[36:39], s85 offen offset:2048 nt lds
s_add_u32 m0, s75, 21504
s_add_u32 s85, s101, 9216
buffer_load_dwordx4 v14, s[36:39], s85 offen offset:0 nt lds
buffer_load_dwordx4 v15, s[36:39], s85 offen offset:1024 nt lds
buffer_load_dwordx4 v16, s[36:39], s85 offen offset:2048 nt lds
s_add_u32 s77, s77, 12288
s_cmp_eq_u32 s77, 196608
s_cselect_b32 s77, 0, s77
s_add_u32 s75, s75, 24576
s_cmp_eq_u32 s75, 73728
s_cselect_b32 s75, 0, s75
s_waitcnt vmcnt(24)
s_barrier
s_add_u32 s93, s93, 3072
s_add_u32 s100, s100, 3072
s_add_u32 s83, s83, 3072
s_add_u32 s74, s74, 1
s_cmp_lt_u32 s74, 3
s_cbranch_scc1 L_ld_round
s_lshl_b32 s79, s64, 4
s_add_u32 s79, s79, s65
s_lshl_b32 s99, s79, 7
s_add_u32 s99, s99, 131072
s_lshl_b32 s79, s79, 2
s_add_u32 s79, s79, 128
v_mov_b32 v2, s66
v_lshlrev_b32 v2, 2, v2
v_lshlrev_b32 v6, 2, v0
s_add_u32 m0, s84, 137344
s_add_u32 s85, s86, 0
buffer_load_dwordx4 v26, s[56:59], s85 offen offset:0 lds
buffer_load_dwordx4 v27, s[56:59], s85 offen offset:1088 lds
buffer_load_dwordx4 v28, s[56:59], s85 offen offset:2176 lds
buffer_load_dwordx4 v29, s[56:59], s85 offen offset:3264 lds
s_add_u32 m0, s84, 141728
s_add_u32 s85, s86, 5120
buffer_load_dwordx4 v26, s[56:59], s85 offen offset:0 lds
buffer_load_dwordx4 v27, s[56:59], s85 offen offset:1088 lds
s_waitcnt vmcnt(44)
buffer_load_dwordx4 v28, s[56:59], s85 offen offset:2176 lds
buffer_load_dwordx4 v29, s[56:59], s85 offen offset:3264 lds
s_add_u32 m0, s84, 146080
s_add_u32 s85, s86, 40960
buffer_load_dwordx4 v26, s[56:59], s85 offen offset:0 lds
buffer_load_dwordx4 v27, s[56:59], s85 offen offset:1088 lds
buffer_load_dwordx4 v28, s[56:59], s85 offen offset:2176 lds
buffer_load_dwordx4 v29, s[56:59], s85 offen offset:3264 lds
s_add_u32 m0, s84, 150464
s_add_u32 s85, s86, 46080
buffer_load_dwordx4 v26, s[56:59], s85 offen offset:0 lds
buffer_load_dwordx4 v27, s[56:59], s85 offen offset:1088 lds
buffer_load_dwordx4 v28, s[56:59], s85 offen offset:2176 lds
buffer_load_dwordx4 v29, s[56:59], s85 offen offset:3264 lds
s_add_u32 m0, s84, 154816
s_add_u32 s85, s86, 81920
buffer_load_dwordx4 v26, s[56:59], s85 offen offset:0 lds
buffer_load_dwordx4 v27, s[56:59], s85 offen offset:1088 lds
buffer_load_dwordx4 v28, s[56:59], s85 offen offset:2176 lds
buffer_load_dwordx4 v29, s[56:59], s85 offen offset:3264 lds
s_add_u32 m0, s84, 159200
s_add_u32 s85, s86, 87040
buffer_load_dwordx4 v26, s[56:59], s85 offen offset:0 lds
buffer_load_dwordx4 v27, s[56:59], s85 offen offset:1088 lds
s_waitcnt vmcnt(44)
buffer_load_dwordx4 v28, s[56:59], s85 offen offset:2176 lds
buffer_load_dwordx4 v29, s[56:59], s85 offen offset:3264 lds
s_add_u32 s101, s80, s77
s_add_u32 m0, s75, 0
s_add_u32 s85, s101, 0
buffer_load_dwordx4 v8, s[32:35], s85 offen offset:0 nt lds
buffer_load_dwordx4 v9, s[32:35], s85 offen offset:1024 nt lds
buffer_load_dwordx4 v10, s[32:35], s85 offen offset:2048 nt lds
s_add_u32 m0, s75, 3072
s_add_u32 s85, s101, 3072
buffer_load_dwordx4 v11, s[32:35], s85 offen offset:0 nt lds
buffer_load_dwordx4 v12, s[32:35], s85 offen offset:1024 nt lds
buffer_load_dwordx4 v13, s[32:35], s85 offen offset:2048 nt lds
s_add_u32 m0, s75, 6144
s_add_u32 s85, s101, 6144
buffer_load_dwordx4 v8, s[32:35], s85 offen offset:0 nt lds
buffer_load_dwordx4 v9, s[32:35], s85 offen offset:1024 nt lds
buffer_load_dwordx4 v10, s[32:35], s85 offen offset:2048 nt lds
s_add_u32 m0, s75, 9216
s_add_u32 s85, s101, 9216
buffer_load_dwordx4 v11, s[32:35], s85 offen offset:0 nt lds
buffer_load_dwordx4 v12, s[32:35], s85 offen offset:1024 nt lds
buffer_load_dwordx4 v13, s[32:35], s85 offen offset:2048 nt lds
s_add_u32 m0, s75, 12288
s_add_u32 s85, s101, 0
buffer_load_dwordx4 v14, s[36:39], s85 offen offset:0 nt lds
buffer_load_dwordx4 v15, s[36:39], s85 offen offset:1024 nt lds
s_waitcnt vmcnt(44)
buffer_load_dwordx4 v16, s[36:39], s85 offen offset:2048 nt lds
s_add_u32 m0, s75, 15360
s_add_u32 s85, s101, 3072
buffer_load_dwordx4 v14, s[36:39], s85 offen offset:0 nt lds
buffer_load_dwordx4 v15, s[36:39], s85 offen offset:1024 nt lds
buffer_load_dwordx4 v16, s[36:39], s85 offen offset:2048 nt lds
s_add_u32 m0, s75, 18432
s_add_u32 s85, s101, 6144
buffer_load_dwordx4 v14, s[36:39], s85 offen offset:0 nt lds
buffer_load_dwordx4 v15, s[36:39], s85 offen offset:1024 nt lds
buffer_load_dwordx4 v16, s[36:39], s85 offen offset:2048 nt lds
s_add_u32 m0, s75, 21504
s_add_u32 s85, s101, 9216
buffer_load_dwordx4 v14, s[36:39], s85 offen offset:0 nt lds
buffer_load_dwordx4 v15, s[36:39], s85 offen offset:1024 nt lds
buffer_load_dwordx4 v16, s[36:39], s85 offen offset:2048 nt lds
s_add_u32 s77, s77, 12288
s_cmp_eq_u32 s77, 196608
s_cselect_b32 s77, 0, s77
s_add_u32 s75, s75, 24576
s_cmp_eq_u32 s75, 73728
s_cselect_b32 s75, 0, s75
s_waitcnt vmcnt(32)
s_barrier
s_add_u32 s101, s80, s77
s_add_u32 m0, s75, 0
s_add_u32 s85, s101, 0
buffer_load_dwordx4 v8, s[32:35], s85 offen offset:0 nt lds
buffer_load_dwordx4 v9, s[32:35], s85 offen offset:1024 nt lds
buffer_load_dwordx4 v10, s[32:35], s85 offen offset:2048 nt lds
s_add_u32 m0, s75, 3072
s_add_u32 s85, s101, 3072
buffer_load_dwordx4 v11, s[32:35], s85 offen offset:0 nt lds
buffer_load_dwordx4 v12, s[32:35], s85 offen offset:1024 nt lds
buffer_load_dwordx4 v13, s[32:35], s85 offen offset:2048 nt lds
s_waitcnt vmcnt(44)
s_add_u32 m0, s75, 6144
s_add_u32 s85, s101, 6144
buffer_load_dwordx4 v8, s[32:35], s85 offen offset:0 nt lds
buffer_load_dwordx4 v9, s[32:35], s85 offen offset:1024 nt lds
buffer_load_dwordx4 v10, s[32:35], s85 offen offset:2048 nt lds
s_add_u32 m0, s75, 9216
s_add_u32 s85, s101, 9216
buffer_load_dwordx4 v11, s[32:35], s85 offen offset:0 nt lds
buffer_load_dwordx4 v12, s[32:35], s85 offen offset:1024 nt lds
buffer_load_dwordx4 v13, s[32:35], s85 offen offset:2048 nt lds
s_add_u32 m0, s75, 12288
s_add_u32 s85, s101, 0
buffer_load_dwordx4 v14, s[36:39], s85 offen offset:0 nt lds
buffer_load_dwordx4 v15, s[36:39], s85 offen offset:1024 nt lds
buffer_load_dwordx4 v16, s[36:39], s85 offen offset:2048 nt lds
s_add_u32 m0, s75, 15360
s_add_u32 s85, s101, 3072
buffer_load_dwordx4 v14, s[36:39], s85 offen offset:0 nt lds
buffer_load_dwordx4 v15, s[36:39], s85 offen offset:1024 nt lds
buffer_load_dwordx4 v16, s[36:39], s85 offen offset:2048 nt lds
s_add_u32 m0, s75, 18432
s_add_u32 s85, s101, 6144
buffer_load_dwordx4 v14, s[36:39], s85 offen offset:0 nt lds
buffer_load_dwordx4 v15, s[36:39], s85 offen offset:1024 nt lds
buffer_load_dwordx4 v16, s[36:39], s85 offen offset:2048 nt lds
s_add_u32 m0, s75, 21504
s_add_u32 s85, s101, 9216
buffer_load_dwordx4 v14, s[36:39], s85 offen offset:0 nt lds
s_waitcnt vmcnt(44)
buffer_load_dwordx4 v15, s[36:39], s85 offen offset:1024 nt lds
buffer_load_dwordx4 v16, s[36:39], s85 offen offset:2048 nt lds
s_add_u32 s77, s77, 12288
s_cmp_eq_u32 s77, 196608
s_cselect_b32 s77, 0, s77
s_add_u32 s75, s75, 24576
s_cmp_eq_u32 s75, 73728
s_cselect_b32 s75, 0, s75
s_waitcnt vmcnt(24)
s_barrier
s_add_u32 m0, s84, 137344
s_add_u32 s85, s86, 122880
buffer_load_dwordx4 v26, s[56:59], s85 offen offset:0 lds
buffer_load_dwordx4 v27, s[56:59], s85 offen offset:1088 lds
buffer_load_dwordx4 v28, s[56:59], s85 offen offset:2176 lds
buffer_load_dwordx4 v29, s[56:59], s85 offen offset:3264 lds
s_add_u32 m0, s84, 141728
s_add_u32 s85, s86, 128000
buffer_load_dwordx4 v26, s[56:59], s85 offen offset:0 lds
buffer_load_dwordx4 v27, s[56:59], s85 offen offset:1088 lds
buffer_load_dwordx4 v28, s[56:59], s85 offen offset:2176 lds
buffer_load_dwordx4 v29, s[56:59], s85 offen offset:3264 lds
s_add_u32 m0, s84, 102400
s_add_u32 s85, s86, 163840
buffer_load_dwordx4 v26, s[56:59], s85 offen offset:0 lds
buffer_load_dwordx4 v27, s[56:59], s85 offen offset:1088 lds
buffer_load_dwordx4 v28, s[56:59], s85 offen offset:2176 lds
buffer_load_dwordx4 v29, s[56:59], s85 offen offset:3264 lds
s_add_u32 m0, s84, 106784
s_add_u32 s85, s86, 168960
buffer_load_dwordx4 v26, s[56:59], s85 offen offset:0 lds
buffer_load_dwordx4 v27, s[56:59], s85 offen offset:1088 lds
s_waitcnt vmcnt(44)
buffer_load_dwordx4 v28, s[56:59], s85 offen offset:2176 lds
buffer_load_dwordx4 v29, s[56:59], s85 offen offset:3264 lds
s_add_u32 m0, s84, 111136
s_add_u32 s85, s86, 204800
buffer_load_dwordx4 v26, s[56:59], s85 offen offset:0 lds
buffer_load_dwordx4 v27, s[56:59], s85 offen offset:1088 lds
buffer_load_dwordx4 v28, s[56:59], s85 offen offset:2176 lds
buffer_load_dwordx4 v29, s[56:59], s85 offen offset:3264 lds
s_add_u32 m0, s84, 115520
s_add_u32 s85, s86, 209920
buffer_load_dwordx4 v26, s[56:59], s85 offen offset:0 lds
buffer_load_dwordx4 v27, s[56:59], s85 offen offset:1088 lds
buffer_load_dwordx4 v28, s[56:59], s85 offen offset:2176 lds
buffer_load_dwordx4 v29, s[56:59], s85 offen offset:3264 lds
s_add_u32 s101, s80, s77
s_add_u32 m0, s75, 0
s_add_u32 s85, s101, 0
buffer_load_dwordx4 v8, s[32:35], s85 offen offset:0 nt lds
buffer_load_dwordx4 v9, s[32:35], s85 offen offset:1024 nt lds
buffer_load_dwordx4 v10, s[32:35], s85 offen offset:2048 nt lds
s_add_u32 m0, s75, 3072
s_add_u32 s85, s101, 3072
buffer_load_dwordx4 v11, s[32:35], s85 offen offset:0 nt lds
buffer_load_dwordx4 v12, s[32:35], s85 offen offset:1024 nt lds
buffer_load_dwordx4 v13, s[32:35], s85 offen offset:2048 nt lds
s_waitcnt vmcnt(44)
s_add_u32 m0, s75, 6144
s_add_u32 s85, s101, 6144
buffer_load_dwordx4 v8, s[32:35], s85 offen offset:0 nt lds
buffer_load_dwordx4 v9, s[32:35], s85 offen offset:1024 nt lds
buffer_load_dwordx4 v10, s[32:35], s85 offen offset:2048 nt lds
s_add_u32 m0, s75, 9216
s_add_u32 s85, s101, 9216
buffer_load_dwordx4 v11, s[32:35], s85 offen offset:0 nt lds
buffer_load_dwordx4 v12, s[32:35], s85 offen offset:1024 nt lds
buffer_load_dwordx4 v13, s[32:35], s85 offen offset:2048 nt lds
s_add_u32 m0, s75, 12288
s_add_u32 s85, s101, 0
buffer_load_dwordx4 v14, s[36:39], s85 offen offset:0 nt lds
buffer_load_dwordx4 v15, s[36:39], s85 offen offset:1024 nt lds
buffer_load_dwordx4 v16, s[36:39], s85 offen offset:2048 nt lds
s_add_u32 m0, s75, 15360
s_add_u32 s85, s101, 3072
buffer_load_dwordx4 v14, s[36:39], s85 offen offset:0 nt lds
buffer_load_dwordx4 v15, s[36:39], s85 offen offset:1024 nt lds
buffer_load_dwordx4 v16, s[36:39], s85 offen offset:2048 nt lds
s_add_u32 m0, s75, 18432
s_add_u32 s85, s101, 6144
buffer_load_dwordx4 v14, s[36:39], s85 offen offset:0 nt lds
buffer_load_dwordx4 v15, s[36:39], s85 offen offset:1024 nt lds
buffer_load_dwordx4 v16, s[36:39], s85 offen offset:2048 nt lds
s_add_u32 m0, s75, 21504
s_add_u32 s85, s101, 9216
buffer_load_dwordx4 v14, s[36:39], s85 offen offset:0 nt lds
s_waitcnt vmcnt(44)
buffer_load_dwordx4 v15, s[36:39], s85 offen offset:1024 nt lds
buffer_load_dwordx4 v16, s[36:39], s85 offen offset:2048 nt lds
s_add_u32 s77, s77, 12288
s_cmp_eq_u32 s77, 196608
s_cselect_b32 s77, 0, s77
s_add_u32 s75, s75, 24576
s_cmp_eq_u32 s75, 73728
s_cselect_b32 s75, 0, s75
s_waitcnt vmcnt(40)
s_barrier
s_add_u32 m0, s84, 146080
s_add_u32 s85, s86, 3932160
buffer_load_dwordx4 v26, s[56:59], s85 offen offset:0 lds
buffer_load_dwordx4 v27, s[56:59], s85 offen offset:1088 lds
buffer_load_dwordx4 v28, s[56:59], s85 offen offset:2176 lds
buffer_load_dwordx4 v29, s[56:59], s85 offen offset:3264 lds
s_add_u32 m0, s84, 150464
s_add_u32 s85, s86, 3937280
buffer_load_dwordx4 v26, s[56:59], s85 offen offset:0 lds
buffer_load_dwordx4 v27, s[56:59], s85 offen offset:1088 lds
buffer_load_dwordx4 v28, s[56:59], s85 offen offset:2176 lds
buffer_load_dwordx4 v29, s[56:59], s85 offen offset:3264 lds
s_add_u32 m0, s84, 119872
s_add_u32 s85, s86, 3973120
buffer_load_dwordx4 v26, s[56:59], s85 offen offset:0 lds
buffer_load_dwordx4 v27, s[56:59], s85 offen offset:1088 lds
buffer_load_dwordx4 v28, s[56:59], s85 offen offset:2176 lds
buffer_load_dwordx4 v29, s[56:59], s85 offen offset:3264 lds
s_add_u32 m0, s84, 124256
s_add_u32 s85, s86, 3978240
buffer_load_dwordx4 v26, s[56:59], s85 offen offset:0 lds
buffer_load_dwordx4 v27, s[56:59], s85 offen offset:1088 lds
s_waitcnt vmcnt(44)
buffer_load_dwordx4 v28, s[56:59], s85 offen offset:2176 lds
buffer_load_dwordx4 v29, s[56:59], s85 offen offset:3264 lds
s_add_u32 m0, s84, 128608
s_add_u32 s85, s86, 4014080
buffer_load_dwordx4 v26, s[56:59], s85 offen offset:0 lds
buffer_load_dwordx4 v27, s[56:59], s85 offen offset:1088 lds
buffer_load_dwordx4 v28, s[56:59], s85 offen offset:2176 lds
buffer_load_dwordx4 v29, s[56:59], s85 offen offset:3264 lds
s_add_u32 m0, s84, 132992
s_add_u32 s85, s86, 4019200
buffer_load_dwordx4 v26, s[56:59], s85 offen offset:0 lds
buffer_load_dwordx4 v27, s[56:59], s85 offen offset:1088 lds
buffer_load_dwordx4 v28, s[56:59], s85 offen offset:2176 lds
buffer_load_dwordx4 v29, s[56:59], s85 offen offset:3264 lds
s_add_u32 s101, s80, s77
s_add_u32 m0, s75, 0
s_add_u32 s85, s101, 0
buffer_load_dwordx4 v8, s[32:35], s85 offen offset:0 nt lds
buffer_load_dwordx4 v9, s[32:35], s85 offen offset:1024 nt lds
buffer_load_dwordx4 v10, s[32:35], s85 offen offset:2048 nt lds
s_add_u32 m0, s75, 3072
s_add_u32 s85, s101, 3072
buffer_load_dwordx4 v11, s[32:35], s85 offen offset:0 nt lds
buffer_load_dwordx4 v12, s[32:35], s85 offen offset:1024 nt lds
buffer_load_dwordx4 v13, s[32:35], s85 offen offset:2048 nt lds
s_waitcnt vmcnt(44)
s_add_u32 m0, s75, 6144
s_add_u32 s85, s101, 6144
buffer_load_dwordx4 v8, s[32:35], s85 offen offset:0 nt lds
buffer_load_dwordx4 v9, s[32:35], s85 offen offset:1024 nt lds
buffer_load_dwordx4 v10, s[32:35], s85 offen offset:2048 nt lds
s_add_u32 m0, s75, 9216
s_add_u32 s85, s101, 9216
buffer_load_dwordx4 v11, s[32:35], s85 offen offset:0 nt lds
buffer_load_dwordx4 v12, s[32:35], s85 offen offset:1024 nt lds
buffer_load_dwordx4 v13, s[32:35], s85 offen offset:2048 nt lds
s_add_u32 m0, s75, 12288
s_add_u32 s85, s101, 0
buffer_load_dwordx4 v14, s[36:39], s85 offen offset:0 nt lds
buffer_load_dwordx4 v15, s[36:39], s85 offen offset:1024 nt lds
buffer_load_dwordx4 v16, s[36:39], s85 offen offset:2048 nt lds
s_add_u32 m0, s75, 15360
s_add_u32 s85, s101, 3072
buffer_load_dwordx4 v14, s[36:39], s85 offen offset:0 nt lds
buffer_load_dwordx4 v15, s[36:39], s85 offen offset:1024 nt lds
buffer_load_dwordx4 v16, s[36:39], s85 offen offset:2048 nt lds
s_add_u32 m0, s75, 18432
s_add_u32 s85, s101, 6144
buffer_load_dwordx4 v14, s[36:39], s85 offen offset:0 nt lds
buffer_load_dwordx4 v15, s[36:39], s85 offen offset:1024 nt lds
buffer_load_dwordx4 v16, s[36:39], s85 offen offset:2048 nt lds
s_add_u32 m0, s75, 21504
s_add_u32 s85, s101, 9216
buffer_load_dwordx4 v14, s[36:39], s85 offen offset:0 nt lds
s_waitcnt vmcnt(44)
buffer_load_dwordx4 v15, s[36:39], s85 offen offset:1024 nt lds
buffer_load_dwordx4 v16, s[36:39], s85 offen offset:2048 nt lds
s_add_u32 s77, s77, 12288
s_cmp_eq_u32 s77, 196608
s_cselect_b32 s77, 0, s77
s_add_u32 s75, s75, 24576
s_cmp_eq_u32 s75, 73728
s_cselect_b32 s75, 0, s75
s_waitcnt vmcnt(48)
s_barrier
s_add_u32 m0, s84, 154816
s_add_u32 s85, s86, 4055040
buffer_load_dwordx4 v26, s[56:59], s85 offen offset:0 lds
buffer_load_dwordx4 v27, s[56:59], s85 offen offset:1088 lds
buffer_load_dwordx4 v28, s[56:59], s85 offen offset:2176 lds
buffer_load_dwordx4 v29, s[56:59], s85 offen offset:3264 lds
s_add_u32 m0, s84, 159200
s_add_u32 s85, s86, 4060160
buffer_load_dwordx4 v26, s[56:59], s85 offen offset:0 lds
buffer_load_dwordx4 v27, s[56:59], s85 offen offset:1088 lds
buffer_load_dwordx4 v28, s[56:59], s85 offen offset:2176 lds
buffer_load_dwordx4 v29, s[56:59], s85 offen offset:3264 lds
s_add_u32 s101, s80, s77
s_add_u32 m0, s75, 0
s_add_u32 s85, s101, 0
buffer_load_dwordx4 v8, s[32:35], s85 offen offset:0 nt lds
buffer_load_dwordx4 v9, s[32:35], s85 offen offset:1024 nt lds
buffer_load_dwordx4 v10, s[32:35], s85 offen offset:2048 nt lds
s_add_u32 m0, s75, 3072
s_add_u32 s85, s101, 3072
buffer_load_dwordx4 v11, s[32:35], s85 offen offset:0 nt lds
buffer_load_dwordx4 v12, s[32:35], s85 offen offset:1024 nt lds
buffer_load_dwordx4 v13, s[32:35], s85 offen offset:2048 nt lds
s_waitcnt vmcnt(44)
s_add_u32 m0, s75, 6144
s_add_u32 s85, s101, 6144
buffer_load_dwordx4 v8, s[32:35], s85 offen offset:0 nt lds
buffer_load_dwordx4 v9, s[32:35], s85 offen offset:1024 nt lds
buffer_load_dwordx4 v10, s[32:35], s85 offen offset:2048 nt lds
s_add_u32 m0, s75, 9216
s_add_u32 s85, s101, 9216
buffer_load_dwordx4 v11, s[32:35], s85 offen offset:0 nt lds
buffer_load_dwordx4 v12, s[32:35], s85 offen offset:1024 nt lds
buffer_load_dwordx4 v13, s[32:35], s85 offen offset:2048 nt lds
s_add_u32 m0, s75, 12288
s_add_u32 s85, s101, 0
buffer_load_dwordx4 v14, s[36:39], s85 offen offset:0 nt lds
buffer_load_dwordx4 v15, s[36:39], s85 offen offset:1024 nt lds
buffer_load_dwordx4 v16, s[36:39], s85 offen offset:2048 nt lds
s_add_u32 m0, s75, 15360
s_add_u32 s85, s101, 3072
buffer_load_dwordx4 v14, s[36:39], s85 offen offset:0 nt lds
buffer_load_dwordx4 v15, s[36:39], s85 offen offset:1024 nt lds
buffer_load_dwordx4 v16, s[36:39], s85 offen offset:2048 nt lds
s_add_u32 m0, s75, 18432
s_add_u32 s85, s101, 6144
buffer_load_dwordx4 v14, s[36:39], s85 offen offset:0 nt lds
buffer_load_dwordx4 v15, s[36:39], s85 offen offset:1024 nt lds
buffer_load_dwordx4 v16, s[36:39], s85 offen offset:2048 nt lds
s_add_u32 m0, s75, 21504
s_add_u32 s85, s101, 9216
buffer_load_dwordx4 v14, s[36:39], s85 offen offset:0 nt lds
s_waitcnt vmcnt(44)
buffer_load_dwordx4 v15, s[36:39], s85 offen offset:1024 nt lds
buffer_load_dwordx4 v16, s[36:39], s85 offen offset:2048 nt lds
s_add_u32 s77, s77, 12288
s_cmp_eq_u32 s77, 196608
s_cselect_b32 s77, 0, s77
s_add_u32 s75, s75, 24576
s_cmp_eq_u32 s75, 73728
s_cselect_b32 s75, 0, s75
s_waitcnt vmcnt(32)
s_barrier
s_add_u32 m0, s84, 137344
s_add_u32 s85, s86, 4096000
buffer_load_dwordx4 v26, s[56:59], s85 offen offset:0 lds
buffer_load_dwordx4 v27, s[56:59], s85 offen offset:1088 lds
buffer_load_dwordx4 v28, s[56:59], s85 offen offset:2176 lds
buffer_load_dwordx4 v29, s[56:59], s85 offen offset:3264 lds
s_add_u32 m0, s84, 141728
s_add_u32 s85, s86, 4101120
buffer_load_dwordx4 v26, s[56:59], s85 offen offset:0 lds
buffer_load_dwordx4 v27, s[56:59], s85 offen offset:1088 lds
buffer_load_dwordx4 v28, s[56:59], s85 offen offset:2176 lds
buffer_load_dwordx4 v29, s[56:59], s85 offen offset:3264 lds
s_add_u32 m0, s84, 102400
s_add_u32 s85, s86, 4136960
buffer_load_dwordx4 v26, s[56:59], s85 offen offset:0 lds
buffer_load_dwordx4 v27, s[56:59], s85 offen offset:1088 lds
buffer_load_dwordx4 v28, s[56:59], s85 offen offset:2176 lds
buffer_load_dwordx4 v29, s[56:59], s85 offen offset:3264 lds
s_add_u32 m0, s84, 106784
s_add_u32 s85, s86, 4142080
buffer_load_dwordx4 v26, s[56:59], s85 offen offset:0 lds
buffer_load_dwordx4 v27, s[56:59], s85 offen offset:1088 lds
s_waitcnt vmcnt(44)
buffer_load_dwordx4 v28, s[56:59], s85 offen offset:2176 lds
buffer_load_dwordx4 v29, s[56:59], s85 offen offset:3264 lds
s_add_u32 s101, s80, s77
s_add_u32 m0, s75, 0
s_add_u32 s85, s101, 0
buffer_load_dwordx4 v8, s[32:35], s85 offen offset:0 nt lds
buffer_load_dwordx4 v9, s[32:35], s85 offen offset:1024 nt lds
buffer_load_dwordx4 v10, s[32:35], s85 offen offset:2048 nt lds
s_add_u32 m0, s75, 3072
s_add_u32 s85, s101, 3072
buffer_load_dwordx4 v11, s[32:35], s85 offen offset:0 nt lds
buffer_load_dwordx4 v12, s[32:35], s85 offen offset:1024 nt lds
buffer_load_dwordx4 v13, s[32:35], s85 offen offset:2048 nt lds
s_add_u32 m0, s75, 6144
s_add_u32 s85, s101, 6144
buffer_load_dwordx4 v8, s[32:35], s85 offen offset:0 nt lds
buffer_load_dwordx4 v9, s[32:35], s85 offen offset:1024 nt lds
buffer_load_dwordx4 v10, s[32:35], s85 offen offset:2048 nt lds
s_add_u32 m0, s75, 9216
s_add_u32 s85, s101, 9216
buffer_load_dwordx4 v11, s[32:35], s85 offen offset:0 nt lds
buffer_load_dwordx4 v12, s[32:35], s85 offen offset:1024 nt lds
buffer_load_dwordx4 v13, s[32:35], s85 offen offset:2048 nt lds
s_add_u32 m0, s75, 12288
s_add_u32 s85, s101, 0
buffer_load_dwordx4 v14, s[36:39], s85 offen offset:0 nt lds
buffer_load_dwordx4 v15, s[36:39], s85 offen offset:1024 nt lds
s_waitcnt vmcnt(44)
buffer_load_dwordx4 v16, s[36:39], s85 offen offset:2048 nt lds
s_add_u32 m0, s75, 15360
s_add_u32 s85, s101, 3072
buffer_load_dwordx4 v14, s[36:39], s85 offen offset:0 nt lds
buffer_load_dwordx4 v15, s[36:39], s85 offen offset:1024 nt lds
buffer_load_dwordx4 v16, s[36:39], s85 offen offset:2048 nt lds
s_add_u32 m0, s75, 18432
s_add_u32 s85, s101, 6144
buffer_load_dwordx4 v14, s[36:39], s85 offen offset:0 nt lds
buffer_load_dwordx4 v15, s[36:39], s85 offen offset:1024 nt lds
buffer_load_dwordx4 v16, s[36:39], s85 offen offset:2048 nt lds
s_add_u32 m0, s75, 21504
s_add_u32 s85, s101, 9216
buffer_load_dwordx4 v14, s[36:39], s85 offen offset:0 nt lds
buffer_load_dwordx4 v15, s[36:39], s85 offen offset:1024 nt lds
buffer_load_dwordx4 v16, s[36:39], s85 offen offset:2048 nt lds
s_add_u32 s77, s77, 12288
s_cmp_eq_u32 s77, 196608
s_cselect_b32 s77, 0, s77
s_add_u32 s75, s75, 24576
s_cmp_eq_u32 s75, 73728
s_cselect_b32 s75, 0, s75
s_waitcnt vmcnt(40)
s_barrier
s_add_u32 m0, s84, 146080
s_add_u32 s85, s86, 1966080
buffer_load_dwordx4 v26, s[56:59], s85 offen offset:0 lds
buffer_load_dwordx4 v27, s[56:59], s85 offen offset:1088 lds
buffer_load_dwordx4 v28, s[56:59], s85 offen offset:2176 lds
buffer_load_dwordx4 v29, s[56:59], s85 offen offset:3264 lds
s_add_u32 m0, s84, 150464
s_add_u32 s85, s86, 1971200
buffer_load_dwordx4 v26, s[56:59], s85 offen offset:0 lds
buffer_load_dwordx4 v27, s[56:59], s85 offen offset:1088 lds
s_waitcnt vmcnt(44)
buffer_load_dwordx4 v28, s[56:59], s85 offen offset:2176 lds
buffer_load_dwordx4 v29, s[56:59], s85 offen offset:3264 lds
s_add_u32 m0, s84, 111136
s_add_u32 s85, s86, 2007040
buffer_load_dwordx4 v26, s[56:59], s85 offen offset:0 lds
buffer_load_dwordx4 v27, s[56:59], s85 offen offset:1088 lds
buffer_load_dwordx4 v28, s[56:59], s85 offen offset:2176 lds
buffer_load_dwordx4 v29, s[56:59], s85 offen offset:3264 lds
s_add_u32 m0, s84, 115520
s_add_u32 s85, s86, 2012160
buffer_load_dwordx4 v26, s[56:59], s85 offen offset:0 lds
buffer_load_dwordx4 v27, s[56:59], s85 offen offset:1088 lds
buffer_load_dwordx4 v28, s[56:59], s85 offen offset:2176 lds
buffer_load_dwordx4 v29, s[56:59], s85 offen offset:3264 lds
s_add_u32 s101, s80, s77
s_add_u32 m0, s75, 0
s_add_u32 s85, s101, 0
buffer_load_dwordx4 v8, s[32:35], s85 offen offset:0 nt lds
buffer_load_dwordx4 v9, s[32:35], s85 offen offset:1024 nt lds
buffer_load_dwordx4 v10, s[32:35], s85 offen offset:2048 nt lds
s_add_u32 m0, s75, 3072
s_add_u32 s85, s101, 3072
buffer_load_dwordx4 v11, s[32:35], s85 offen offset:0 nt lds
buffer_load_dwordx4 v12, s[32:35], s85 offen offset:1024 nt lds
buffer_load_dwordx4 v13, s[32:35], s85 offen offset:2048 nt lds
s_waitcnt vmcnt(44)
s_add_u32 m0, s75, 6144
s_add_u32 s85, s101, 6144
buffer_load_dwordx4 v8, s[32:35], s85 offen offset:0 nt lds
buffer_load_dwordx4 v9, s[32:35], s85 offen offset:1024 nt lds
buffer_load_dwordx4 v10, s[32:35], s85 offen offset:2048 nt lds
s_add_u32 m0, s75, 9216
s_add_u32 s85, s101, 9216
buffer_load_dwordx4 v11, s[32:35], s85 offen offset:0 nt lds
buffer_load_dwordx4 v12, s[32:35], s85 offen offset:1024 nt lds
buffer_load_dwordx4 v13, s[32:35], s85 offen offset:2048 nt lds
s_add_u32 m0, s75, 12288
s_add_u32 s85, s101, 0
buffer_load_dwordx4 v14, s[36:39], s85 offen offset:0 nt lds
buffer_load_dwordx4 v15, s[36:39], s85 offen offset:1024 nt lds
buffer_load_dwordx4 v16, s[36:39], s85 offen offset:2048 nt lds
s_add_u32 m0, s75, 15360
s_add_u32 s85, s101, 3072
buffer_load_dwordx4 v14, s[36:39], s85 offen offset:0 nt lds
buffer_load_dwordx4 v15, s[36:39], s85 offen offset:1024 nt lds
buffer_load_dwordx4 v16, s[36:39], s85 offen offset:2048 nt lds
s_add_u32 m0, s75, 18432
s_add_u32 s85, s101, 6144
buffer_load_dwordx4 v14, s[36:39], s85 offen offset:0 nt lds
buffer_load_dwordx4 v15, s[36:39], s85 offen offset:1024 nt lds
buffer_load_dwordx4 v16, s[36:39], s85 offen offset:2048 nt lds
s_add_u32 m0, s75, 21504
s_add_u32 s85, s101, 9216
buffer_load_dwordx4 v14, s[36:39], s85 offen offset:0 nt lds
s_waitcnt vmcnt(44)
buffer_load_dwordx4 v15, s[36:39], s85 offen offset:1024 nt lds
buffer_load_dwordx4 v16, s[36:39], s85 offen offset:2048 nt lds
s_add_u32 s77, s77, 12288
s_cmp_eq_u32 s77, 196608
s_cselect_b32 s77, 0, s77
s_add_u32 s75, s75, 24576
s_cmp_eq_u32 s75, 73728
s_cselect_b32 s75, 0, s75
s_waitcnt vmcnt(32)
s_barrier
s_add_u32 m0, s84, 119872
s_add_u32 s85, s86, 2048000
buffer_load_dwordx4 v26, s[56:59], s85 offen offset:0 lds
buffer_load_dwordx4 v27, s[56:59], s85 offen offset:1088 lds
buffer_load_dwordx4 v28, s[56:59], s85 offen offset:2176 lds
buffer_load_dwordx4 v29, s[56:59], s85 offen offset:3264 lds
s_add_u32 m0, s84, 124256
s_add_u32 s85, s86, 2053120
buffer_load_dwordx4 v26, s[56:59], s85 offen offset:0 lds
buffer_load_dwordx4 v27, s[56:59], s85 offen offset:1088 lds
buffer_load_dwordx4 v28, s[56:59], s85 offen offset:2176 lds
buffer_load_dwordx4 v29, s[56:59], s85 offen offset:3264 lds
s_add_u32 m0, s84, 128608
s_add_u32 s85, s86, 2088960
buffer_load_dwordx4 v26, s[56:59], s85 offen offset:0 lds
buffer_load_dwordx4 v27, s[56:59], s85 offen offset:1088 lds
buffer_load_dwordx4 v28, s[56:59], s85 offen offset:2176 lds
buffer_load_dwordx4 v29, s[56:59], s85 offen offset:3264 lds
s_add_u32 m0, s84, 132992
s_add_u32 s85, s86, 2094080
buffer_load_dwordx4 v26, s[56:59], s85 offen offset:0 lds
buffer_load_dwordx4 v27, s[56:59], s85 offen offset:1088 lds
s_waitcnt vmcnt(44)
buffer_load_dwordx4 v28, s[56:59], s85 offen offset:2176 lds
buffer_load_dwordx4 v29, s[56:59], s85 offen offset:3264 lds
s_add_u32 s101, s80, s77
s_add_u32 m0, s75, 0
s_add_u32 s85, s101, 0
buffer_load_dwordx4 v8, s[32:35], s85 offen offset:0 nt lds
buffer_load_dwordx4 v9, s[32:35], s85 offen offset:1024 nt lds
buffer_load_dwordx4 v10, s[32:35], s85 offen offset:2048 nt lds
s_add_u32 m0, s75, 3072
s_add_u32 s85, s101, 3072
buffer_load_dwordx4 v11, s[32:35], s85 offen offset:0 nt lds
buffer_load_dwordx4 v12, s[32:35], s85 offen offset:1024 nt lds
buffer_load_dwordx4 v13, s[32:35], s85 offen offset:2048 nt lds
s_add_u32 m0, s75, 6144
s_add_u32 s85, s101, 6144
buffer_load_dwordx4 v8, s[32:35], s85 offen offset:0 nt lds
buffer_load_dwordx4 v9, s[32:35], s85 offen offset:1024 nt lds
buffer_load_dwordx4 v10, s[32:35], s85 offen offset:2048 nt lds
s_add_u32 m0, s75, 9216
s_add_u32 s85, s101, 9216
buffer_load_dwordx4 v11, s[32:35], s85 offen offset:0 nt lds
buffer_load_dwordx4 v12, s[32:35], s85 offen offset:1024 nt lds
buffer_load_dwordx4 v13, s[32:35], s85 offen offset:2048 nt lds
s_add_u32 m0, s75, 12288
s_add_u32 s85, s101, 0
buffer_load_dwordx4 v14, s[36:39], s85 offen offset:0 nt lds
buffer_load_dwordx4 v15, s[36:39], s85 offen offset:1024 nt lds
s_waitcnt vmcnt(44)
buffer_load_dwordx4 v16, s[36:39], s85 offen offset:2048 nt lds
s_add_u32 m0, s75, 15360
s_add_u32 s85, s101, 3072
buffer_load_dwordx4 v14, s[36:39], s85 offen offset:0 nt lds
buffer_load_dwordx4 v15, s[36:39], s85 offen offset:1024 nt lds
buffer_load_dwordx4 v16, s[36:39], s85 offen offset:2048 nt lds
s_add_u32 m0, s75, 18432
s_add_u32 s85, s101, 6144
buffer_load_dwordx4 v14, s[36:39], s85 offen offset:0 nt lds
buffer_load_dwordx4 v15, s[36:39], s85 offen offset:1024 nt lds
buffer_load_dwordx4 v16, s[36:39], s85 offen offset:2048 nt lds
s_add_u32 m0, s75, 21504
s_add_u32 s85, s101, 9216
buffer_load_dwordx4 v14, s[36:39], s85 offen offset:0 nt lds
buffer_load_dwordx4 v15, s[36:39], s85 offen offset:1024 nt lds
buffer_load_dwordx4 v16, s[36:39], s85 offen offset:2048 nt lds
s_add_u32 s77, s77, 12288
s_cmp_eq_u32 s77, 196608
s_cselect_b32 s77, 0, s77
s_add_u32 s75, s75, 24576
s_cmp_eq_u32 s75, 73728
s_cselect_b32 s75, 0, s75
s_waitcnt vmcnt(24)
s_barrier
s_add_u32 m0, s84, 137344
s_add_u32 s85, s86, 2129920
buffer_load_dwordx4 v26, s[56:59], s85 offen offset:0 lds
buffer_load_dwordx4 v27, s[56:59], s85 offen offset:1088 lds
buffer_load_dwordx4 v28, s[56:59], s85 offen offset:2176 lds
buffer_load_dwordx4 v29, s[56:59], s85 offen offset:3264 lds
s_add_u32 m0, s84, 141728
s_add_u32 s85, s86, 2135040
buffer_load_dwordx4 v26, s[56:59], s85 offen offset:0 lds
buffer_load_dwordx4 v27, s[56:59], s85 offen offset:1088 lds
s_waitcnt vmcnt(44)
buffer_load_dwordx4 v28, s[56:59], s85 offen offset:2176 lds
buffer_load_dwordx4 v29, s[56:59], s85 offen offset:3264 lds
s_add_u32 m0, s84, 154816
s_add_u32 s85, s86, 2170880
buffer_load_dwordx4 v26, s[56:59], s85 offen offset:0 lds
buffer_load_dwordx4 v27, s[56:59], s85 offen offset:1088 lds
buffer_load_dwordx4 v28, s[56:59], s85 offen offset:2176 lds
buffer_load_dwordx4 v29, s[56:59], s85 offen offset:3264 lds
s_add_u32 m0, s84, 159200
s_add_u32 s85, s86, 2176000
buffer_load_dwordx4 v26, s[56:59], s85 offen offset:0 lds
buffer_load_dwordx4 v27, s[56:59], s85 offen offset:1088 lds
buffer_load_dwordx4 v28, s[56:59], s85 offen offset:2176 lds
buffer_load_dwordx4 v29, s[56:59], s85 offen offset:3264 lds
s_add_u32 m0, s84, 102400
s_add_u32 s85, s86, 256
buffer_load_dwordx4 v26, s[56:59], s85 offen offset:0 lds
buffer_load_dwordx4 v27, s[56:59], s85 offen offset:1088 lds
buffer_load_dwordx4 v28, s[56:59], s85 offen offset:2176 lds
buffer_load_dwordx4 v29, s[56:59], s85 offen offset:3264 lds
s_add_u32 m0, s84, 106784
s_add_u32 s85, s86, 5376
buffer_load_dwordx4 v26, s[56:59], s85 offen offset:0 lds
buffer_load_dwordx4 v27, s[56:59], s85 offen offset:1088 lds
s_waitcnt vmcnt(44)
buffer_load_dwordx4 v28, s[56:59], s85 offen offset:2176 lds
buffer_load_dwordx4 v29, s[56:59], s85 offen offset:3264 lds
s_add_u32 s101, s80, s77
s_add_u32 m0, s75, 0
s_add_u32 s85, s101, 0
buffer_load_dwordx4 v8, s[32:35], s85 offen offset:0 nt lds
buffer_load_dwordx4 v9, s[32:35], s85 offen offset:1024 nt lds
buffer_load_dwordx4 v10, s[32:35], s85 offen offset:2048 nt lds
s_add_u32 m0, s75, 3072
s_add_u32 s85, s101, 3072
buffer_load_dwordx4 v11, s[32:35], s85 offen offset:0 nt lds
buffer_load_dwordx4 v12, s[32:35], s85 offen offset:1024 nt lds
buffer_load_dwordx4 v13, s[32:35], s85 offen offset:2048 nt lds
s_add_u32 m0, s75, 6144
s_add_u32 s85, s101, 6144
buffer_load_dwordx4 v8, s[32:35], s85 offen offset:0 nt lds
buffer_load_dwordx4 v9, s[32:35], s85 offen offset:1024 nt lds
buffer_load_dwordx4 v10, s[32:35], s85 offen offset:2048 nt lds
s_add_u32 m0, s75, 9216
s_add_u32 s85, s101, 9216
buffer_load_dwordx4 v11, s[32:35], s85 offen offset:0 nt lds
buffer_load_dwordx4 v12, s[32:35], s85 offen offset:1024 nt lds
buffer_load_dwordx4 v13, s[32:35], s85 offen offset:2048 nt lds
s_add_u32 m0, s75, 12288
s_add_u32 s85, s101, 0
buffer_load_dwordx4 v14, s[36:39], s85 offen offset:0 nt lds
buffer_load_dwordx4 v15, s[36:39], s85 offen offset:1024 nt lds
s_waitcnt vmcnt(44)
buffer_load_dwordx4 v16, s[36:39], s85 offen offset:2048 nt lds
s_add_u32 m0, s75, 15360
s_add_u32 s85, s101, 3072
buffer_load_dwordx4 v14, s[36:39], s85 offen offset:0 nt lds
buffer_load_dwordx4 v15, s[36:39], s85 offen offset:1024 nt lds
buffer_load_dwordx4 v16, s[36:39], s85 offen offset:2048 nt lds
s_add_u32 m0, s75, 18432
s_add_u32 s85, s101, 6144
buffer_load_dwordx4 v14, s[36:39], s85 offen offset:0 nt lds
buffer_load_dwordx4 v15, s[36:39], s85 offen offset:1024 nt lds
buffer_load_dwordx4 v16, s[36:39], s85 offen offset:2048 nt lds
s_add_u32 m0, s75, 21504
s_add_u32 s85, s101, 9216
buffer_load_dwordx4 v14, s[36:39], s85 offen offset:0 nt lds
buffer_load_dwordx4 v15, s[36:39], s85 offen offset:1024 nt lds
buffer_load_dwordx4 v16, s[36:39], s85 offen offset:2048 nt lds
s_add_u32 s77, s77, 12288
s_cmp_eq_u32 s77, 196608
s_cselect_b32 s77, 0, s77
s_add_u32 s75, s75, 24576
s_cmp_eq_u32 s75, 73728
s_cselect_b32 s75, 0, s75
s_waitcnt vmcnt(24)
s_barrier
s_add_u32 m0, s84, 146080
s_add_u32 s85, s86, 41216
buffer_load_dwordx4 v26, s[56:59], s85 offen offset:0 lds
buffer_load_dwordx4 v27, s[56:59], s85 offen offset:1088 lds
buffer_load_dwordx4 v28, s[56:59], s85 offen offset:2176 lds
buffer_load_dwordx4 v29, s[56:59], s85 offen offset:3264 lds
s_add_u32 m0, s84, 150464
s_add_u32 s85, s86, 46336
buffer_load_dwordx4 v26, s[56:59], s85 offen offset:0 lds
buffer_load_dwordx4 v27, s[56:59], s85 offen offset:1088 lds
s_waitcnt vmcnt(44)
buffer_load_dwordx4 v28, s[56:59], s85 offen offset:2176 lds
buffer_load_dwordx4 v29, s[56:59], s85 offen offset:3264 lds
s_add_u32 m0, s84, 111136
s_add_u32 s85, s86, 82176
buffer_load_dwordx4 v26, s[56:59], s85 offen offset:0 lds
buffer_load_dwordx4 v27, s[56:59], s85 offen offset:1088 lds
buffer_load_dwordx4 v28, s[56:59], s85 offen offset:2176 lds
buffer_load_dwordx4 v29, s[56:59], s85 offen offset:3264 lds
s_add_u32 m0, s84, 115520
s_add_u32 s85, s86, 87296
buffer_load_dwordx4 v26, s[56:59], s85 offen offset:0 lds
buffer_load_dwordx4 v27, s[56:59], s85 offen offset:1088 lds
buffer_load_dwordx4 v28, s[56:59], s85 offen offset:2176 lds
buffer_load_dwordx4 v29, s[56:59], s85 offen offset:3264 lds
s_add_u32 m0, s84, 119872
s_add_u32 s85, s86, 123136
buffer_load_dwordx4 v26, s[56:59], s85 offen offset:0 lds
buffer_load_dwordx4 v27, s[56:59], s85 offen offset:1088 lds
buffer_load_dwordx4 v28, s[56:59], s85 offen offset:2176 lds
buffer_load_dwordx4 v29, s[56:59], s85 offen offset:3264 lds
s_add_u32 m0, s84, 124256
s_add_u32 s85, s86, 128256
buffer_load_dwordx4 v26, s[56:59], s85 offen offset:0 lds
buffer_load_dwordx4 v27, s[56:59], s85 offen offset:1088 lds
s_waitcnt vmcnt(44)
buffer_load_dwordx4 v28, s[56:59], s85 offen offset:2176 lds
buffer_load_dwordx4 v29, s[56:59], s85 offen offset:3264 lds
s_add_u32 s101, s80, s77
s_add_u32 m0, s75, 0
s_add_u32 s85, s101, 0
buffer_load_dwordx4 v8, s[32:35], s85 offen offset:0 nt lds
buffer_load_dwordx4 v9, s[32:35], s85 offen offset:1024 nt lds
buffer_load_dwordx4 v10, s[32:35], s85 offen offset:2048 nt lds
s_add_u32 m0, s75, 3072
s_add_u32 s85, s101, 3072
buffer_load_dwordx4 v11, s[32:35], s85 offen offset:0 nt lds
buffer_load_dwordx4 v12, s[32:35], s85 offen offset:1024 nt lds
buffer_load_dwordx4 v13, s[32:35], s85 offen offset:2048 nt lds
s_add_u32 m0, s75, 6144
s_add_u32 s85, s101, 6144
buffer_load_dwordx4 v8, s[32:35], s85 offen offset:0 nt lds
buffer_load_dwordx4 v9, s[32:35], s85 offen offset:1024 nt lds
buffer_load_dwordx4 v10, s[32:35], s85 offen offset:2048 nt lds
s_add_u32 m0, s75, 9216
s_add_u32 s85, s101, 9216
buffer_load_dwordx4 v11, s[32:35], s85 offen offset:0 nt lds
buffer_load_dwordx4 v12, s[32:35], s85 offen offset:1024 nt lds
buffer_load_dwordx4 v13, s[32:35], s85 offen offset:2048 nt lds
s_add_u32 m0, s75, 12288
s_add_u32 s85, s101, 0
buffer_load_dwordx4 v14, s[36:39], s85 offen offset:0 nt lds
buffer_load_dwordx4 v15, s[36:39], s85 offen offset:1024 nt lds
s_waitcnt vmcnt(44)
buffer_load_dwordx4 v16, s[36:39], s85 offen offset:2048 nt lds
s_add_u32 m0, s75, 15360
s_add_u32 s85, s101, 3072
buffer_load_dwordx4 v14, s[36:39], s85 offen offset:0 nt lds
buffer_load_dwordx4 v15, s[36:39], s85 offen offset:1024 nt lds
buffer_load_dwordx4 v16, s[36:39], s85 offen offset:2048 nt lds
s_add_u32 m0, s75, 18432
s_add_u32 s85, s101, 6144
buffer_load_dwordx4 v14, s[36:39], s85 offen offset:0 nt lds
buffer_load_dwordx4 v15, s[36:39], s85 offen offset:1024 nt lds
buffer_load_dwordx4 v16, s[36:39], s85 offen offset:2048 nt lds
s_add_u32 m0, s75, 21504
s_add_u32 s85, s101, 9216
buffer_load_dwordx4 v14, s[36:39], s85 offen offset:0 nt lds
buffer_load_dwordx4 v15, s[36:39], s85 offen offset:1024 nt lds
buffer_load_dwordx4 v16, s[36:39], s85 offen offset:2048 nt lds
s_add_u32 s77, s77, 12288
s_cmp_eq_u32 s77, 196608
s_cselect_b32 s77, 0, s77
s_add_u32 s75, s75, 24576
s_cmp_eq_u32 s75, 73728
s_cselect_b32 s75, 0, s75
s_waitcnt vmcnt(24)
s_barrier
s_add_u32 m0, s84, 137344
s_add_u32 s85, s86, 164096
buffer_load_dwordx4 v26, s[56:59], s85 offen offset:0 lds
buffer_load_dwordx4 v27, s[56:59], s85 offen offset:1088 lds
buffer_load_dwordx4 v28, s[56:59], s85 offen offset:2176 lds
buffer_load_dwordx4 v29, s[56:59], s85 offen offset:3264 lds
s_add_u32 m0, s84, 141728
s_add_u32 s85, s86, 169216
buffer_load_dwordx4 v26, s[56:59], s85 offen offset:0 lds
buffer_load_dwordx4 v27, s[56:59], s85 offen offset:1088 lds
s_waitcnt vmcnt(44)
buffer_load_dwordx4 v28, s[56:59], s85 offen offset:2176 lds
buffer_load_dwordx4 v29, s[56:59], s85 offen offset:3264 lds
s_add_u32 m0, s84, 154816
s_add_u32 s85, s86, 205056
buffer_load_dwordx4 v26, s[56:59], s85 offen offset:0 lds
buffer_load_dwordx4 v27, s[56:59], s85 offen offset:1088 lds
buffer_load_dwordx4 v28, s[56:59], s85 offen offset:2176 lds
buffer_load_dwordx4 v29, s[56:59], s85 offen offset:3264 lds
s_add_u32 m0, s84, 159200
s_add_u32 s85, s86, 210176
buffer_load_dwordx4 v26, s[56:59], s85 offen offset:0 lds
buffer_load_dwordx4 v27, s[56:59], s85 offen offset:1088 lds
buffer_load_dwordx4 v28, s[56:59], s85 offen offset:2176 lds
buffer_load_dwordx4 v29, s[56:59], s85 offen offset:3264 lds
s_add_u32 m0, s84, 128608
s_add_u32 s85, s86, 3932416
buffer_load_dwordx4 v26, s[56:59], s85 offen offset:0 lds
buffer_load_dwordx4 v27, s[56:59], s85 offen offset:1088 lds
buffer_load_dwordx4 v28, s[56:59], s85 offen offset:2176 lds
buffer_load_dwordx4 v29, s[56:59], s85 offen offset:3264 lds
s_add_u32 m0, s84, 132992
s_add_u32 s85, s86, 3937536
buffer_load_dwordx4 v26, s[56:59], s85 offen offset:0 lds
buffer_load_dwordx4 v27, s[56:59], s85 offen offset:1088 lds
s_waitcnt vmcnt(44)
buffer_load_dwordx4 v28, s[56:59], s85 offen offset:2176 lds
buffer_load_dwordx4 v29, s[56:59], s85 offen offset:3264 lds
s_add_u32 s101, s80, s77
s_add_u32 m0, s75, 0
s_add_u32 s85, s101, 0
buffer_load_dwordx4 v8, s[32:35], s85 offen offset:0 nt lds
buffer_load_dwordx4 v9, s[32:35], s85 offen offset:1024 nt lds
buffer_load_dwordx4 v10, s[32:35], s85 offen offset:2048 nt lds
s_add_u32 m0, s75, 3072
s_add_u32 s85, s101, 3072
buffer_load_dwordx4 v11, s[32:35], s85 offen offset:0 nt lds
buffer_load_dwordx4 v12, s[32:35], s85 offen offset:1024 nt lds
buffer_load_dwordx4 v13, s[32:35], s85 offen offset:2048 nt lds
s_add_u32 m0, s75, 6144
s_add_u32 s85, s101, 6144
buffer_load_dwordx4 v8, s[32:35], s85 offen offset:0 nt lds
buffer_load_dwordx4 v9, s[32:35], s85 offen offset:1024 nt lds
buffer_load_dwordx4 v10, s[32:35], s85 offen offset:2048 nt lds
s_add_u32 m0, s75, 9216
s_add_u32 s85, s101, 9216
buffer_load_dwordx4 v11, s[32:35], s85 offen offset:0 nt lds
buffer_load_dwordx4 v12, s[32:35], s85 offen offset:1024 nt lds
buffer_load_dwordx4 v13, s[32:35], s85 offen offset:2048 nt lds
s_add_u32 m0, s75, 12288
s_add_u32 s85, s101, 0
buffer_load_dwordx4 v14, s[36:39], s85 offen offset:0 nt lds
buffer_load_dwordx4 v15, s[36:39], s85 offen offset:1024 nt lds
s_waitcnt vmcnt(44)
buffer_load_dwordx4 v16, s[36:39], s85 offen offset:2048 nt lds
s_add_u32 m0, s75, 15360
s_add_u32 s85, s101, 3072
buffer_load_dwordx4 v14, s[36:39], s85 offen offset:0 nt lds
buffer_load_dwordx4 v15, s[36:39], s85 offen offset:1024 nt lds
buffer_load_dwordx4 v16, s[36:39], s85 offen offset:2048 nt lds
s_add_u32 m0, s75, 18432
s_add_u32 s85, s101, 6144
buffer_load_dwordx4 v14, s[36:39], s85 offen offset:0 nt lds
buffer_load_dwordx4 v15, s[36:39], s85 offen offset:1024 nt lds
buffer_load_dwordx4 v16, s[36:39], s85 offen offset:2048 nt lds
s_add_u32 m0, s75, 21504
s_add_u32 s85, s101, 9216
buffer_load_dwordx4 v14, s[36:39], s85 offen offset:0 nt lds
buffer_load_dwordx4 v15, s[36:39], s85 offen offset:1024 nt lds
buffer_load_dwordx4 v16, s[36:39], s85 offen offset:2048 nt lds
s_add_u32 s77, s77, 12288
s_cmp_eq_u32 s77, 196608
s_cselect_b32 s77, 0, s77
s_add_u32 s75, s75, 24576
s_cmp_eq_u32 s75, 73728
s_cselect_b32 s75, 0, s75
s_waitcnt vmcnt(24)
s_barrier
s_add_u32 m0, s84, 146080
s_add_u32 s85, s86, 3973376
buffer_load_dwordx4 v26, s[56:59], s85 offen offset:0 lds
buffer_load_dwordx4 v27, s[56:59], s85 offen offset:1088 lds
buffer_load_dwordx4 v28, s[56:59], s85 offen offset:2176 lds
buffer_load_dwordx4 v29, s[56:59], s85 offen offset:3264 lds
s_add_u32 m0, s84, 150464
s_add_u32 s85, s86, 3978496
buffer_load_dwordx4 v26, s[56:59], s85 offen offset:0 lds
buffer_load_dwordx4 v27, s[56:59], s85 offen offset:1088 lds
s_waitcnt vmcnt(44)
buffer_load_dwordx4 v28, s[56:59], s85 offen offset:2176 lds
buffer_load_dwordx4 v29, s[56:59], s85 offen offset:3264 lds
s_add_u32 m0, s84, 102400
s_add_u32 s85, s86, 4014336
buffer_load_dwordx4 v26, s[56:59], s85 offen offset:0 lds
buffer_load_dwordx4 v27, s[56:59], s85 offen offset:1088 lds
buffer_load_dwordx4 v28, s[56:59], s85 offen offset:2176 lds
buffer_load_dwordx4 v29, s[56:59], s85 offen offset:3264 lds
s_add_u32 m0, s84, 106784
s_add_u32 s85, s86, 4019456
buffer_load_dwordx4 v26, s[56:59], s85 offen offset:0 lds
buffer_load_dwordx4 v27, s[56:59], s85 offen offset:1088 lds
buffer_load_dwordx4 v28, s[56:59], s85 offen offset:2176 lds
buffer_load_dwordx4 v29, s[56:59], s85 offen offset:3264 lds
s_add_u32 m0, s84, 111136
s_add_u32 s85, s86, 4055296
buffer_load_dwordx4 v26, s[56:59], s85 offen offset:0 lds
buffer_load_dwordx4 v27, s[56:59], s85 offen offset:1088 lds
buffer_load_dwordx4 v28, s[56:59], s85 offen offset:2176 lds
buffer_load_dwordx4 v29, s[56:59], s85 offen offset:3264 lds
s_add_u32 m0, s84, 115520
s_add_u32 s85, s86, 4060416
buffer_load_dwordx4 v26, s[56:59], s85 offen offset:0 lds
buffer_load_dwordx4 v27, s[56:59], s85 offen offset:1088 lds
s_waitcnt vmcnt(44)
buffer_load_dwordx4 v28, s[56:59], s85 offen offset:2176 lds
buffer_load_dwordx4 v29, s[56:59], s85 offen offset:3264 lds
s_add_u32 s101, s80, s77
s_add_u32 m0, s75, 0
s_add_u32 s85, s101, 0
buffer_load_dwordx4 v8, s[32:35], s85 offen offset:0 nt lds
buffer_load_dwordx4 v9, s[32:35], s85 offen offset:1024 nt lds
buffer_load_dwordx4 v10, s[32:35], s85 offen offset:2048 nt lds
s_add_u32 m0, s75, 3072
s_add_u32 s85, s101, 3072
buffer_load_dwordx4 v11, s[32:35], s85 offen offset:0 nt lds
buffer_load_dwordx4 v12, s[32:35], s85 offen offset:1024 nt lds
buffer_load_dwordx4 v13, s[32:35], s85 offen offset:2048 nt lds
s_add_u32 m0, s75, 6144
s_add_u32 s85, s101, 6144
buffer_load_dwordx4 v8, s[32:35], s85 offen offset:0 nt lds
buffer_load_dwordx4 v9, s[32:35], s85 offen offset:1024 nt lds
buffer_load_dwordx4 v10, s[32:35], s85 offen offset:2048 nt lds
s_add_u32 m0, s75, 9216
s_add_u32 s85, s101, 9216
buffer_load_dwordx4 v11, s[32:35], s85 offen offset:0 nt lds
buffer_load_dwordx4 v12, s[32:35], s85 offen offset:1024 nt lds
buffer_load_dwordx4 v13, s[32:35], s85 offen offset:2048 nt lds
s_add_u32 m0, s75, 12288
s_add_u32 s85, s101, 0
buffer_load_dwordx4 v14, s[36:39], s85 offen offset:0 nt lds
buffer_load_dwordx4 v15, s[36:39], s85 offen offset:1024 nt lds
s_waitcnt vmcnt(44)
buffer_load_dwordx4 v16, s[36:39], s85 offen offset:2048 nt lds
s_add_u32 m0, s75, 15360
s_add_u32 s85, s101, 3072
buffer_load_dwordx4 v14, s[36:39], s85 offen offset:0 nt lds
buffer_load_dwordx4 v15, s[36:39], s85 offen offset:1024 nt lds
buffer_load_dwordx4 v16, s[36:39], s85 offen offset:2048 nt lds
s_add_u32 m0, s75, 18432
s_add_u32 s85, s101, 6144
buffer_load_dwordx4 v14, s[36:39], s85 offen offset:0 nt lds
buffer_load_dwordx4 v15, s[36:39], s85 offen offset:1024 nt lds
buffer_load_dwordx4 v16, s[36:39], s85 offen offset:2048 nt lds
s_add_u32 m0, s75, 21504
s_add_u32 s85, s101, 9216
buffer_load_dwordx4 v14, s[36:39], s85 offen offset:0 nt lds
buffer_load_dwordx4 v15, s[36:39], s85 offen offset:1024 nt lds
buffer_load_dwordx4 v16, s[36:39], s85 offen offset:2048 nt lds
s_add_u32 s77, s77, 12288
s_cmp_eq_u32 s77, 196608
s_cselect_b32 s77, 0, s77
s_add_u32 s75, s75, 24576
s_cmp_eq_u32 s75, 73728
s_cselect_b32 s75, 0, s75
s_waitcnt vmcnt(24)
s_barrier
s_add_u32 m0, s84, 137344
s_add_u32 s85, s86, 4096256
buffer_load_dwordx4 v26, s[56:59], s85 offen offset:0 lds
buffer_load_dwordx4 v27, s[56:59], s85 offen offset:1088 lds
buffer_load_dwordx4 v28, s[56:59], s85 offen offset:2176 lds
buffer_load_dwordx4 v29, s[56:59], s85 offen offset:3264 lds
s_add_u32 m0, s84, 141728
s_add_u32 s85, s86, 4101376
buffer_load_dwordx4 v26, s[56:59], s85 offen offset:0 lds
buffer_load_dwordx4 v27, s[56:59], s85 offen offset:1088 lds
s_waitcnt vmcnt(44)
buffer_load_dwordx4 v28, s[56:59], s85 offen offset:2176 lds
buffer_load_dwordx4 v29, s[56:59], s85 offen offset:3264 lds
s_add_u32 m0, s84, 154816
s_add_u32 s85, s86, 4137216
buffer_load_dwordx4 v26, s[56:59], s85 offen offset:0 lds
buffer_load_dwordx4 v27, s[56:59], s85 offen offset:1088 lds
buffer_load_dwordx4 v28, s[56:59], s85 offen offset:2176 lds
buffer_load_dwordx4 v29, s[56:59], s85 offen offset:3264 lds
s_add_u32 m0, s84, 159200
s_add_u32 s85, s86, 4142336
buffer_load_dwordx4 v26, s[56:59], s85 offen offset:0 lds
buffer_load_dwordx4 v27, s[56:59], s85 offen offset:1088 lds
buffer_load_dwordx4 v28, s[56:59], s85 offen offset:2176 lds
buffer_load_dwordx4 v29, s[56:59], s85 offen offset:3264 lds
s_add_u32 m0, s84, 119872
s_add_u32 s85, s86, 1966336
buffer_load_dwordx4 v26, s[56:59], s85 offen offset:0 lds
buffer_load_dwordx4 v27, s[56:59], s85 offen offset:1088 lds
buffer_load_dwordx4 v28, s[56:59], s85 offen offset:2176 lds
buffer_load_dwordx4 v29, s[56:59], s85 offen offset:3264 lds
s_add_u32 m0, s84, 124256
s_add_u32 s85, s86, 1971456
buffer_load_dwordx4 v26, s[56:59], s85 offen offset:0 lds
buffer_load_dwordx4 v27, s[56:59], s85 offen offset:1088 lds
s_waitcnt vmcnt(44)
buffer_load_dwordx4 v28, s[56:59], s85 offen offset:2176 lds
buffer_load_dwordx4 v29, s[56:59], s85 offen offset:3264 lds
s_add_u32 s101, s80, s77
s_add_u32 m0, s75, 0
s_add_u32 s85, s101, 0
buffer_load_dwordx4 v8, s[32:35], s85 offen offset:0 nt lds
buffer_load_dwordx4 v9, s[32:35], s85 offen offset:1024 nt lds
buffer_load_dwordx4 v10, s[32:35], s85 offen offset:2048 nt lds
s_add_u32 m0, s75, 3072
s_add_u32 s85, s101, 3072
buffer_load_dwordx4 v11, s[32:35], s85 offen offset:0 nt lds
buffer_load_dwordx4 v12, s[32:35], s85 offen offset:1024 nt lds
buffer_load_dwordx4 v13, s[32:35], s85 offen offset:2048 nt lds
s_add_u32 m0, s75, 6144
s_add_u32 s85, s101, 6144
buffer_load_dwordx4 v8, s[32:35], s85 offen offset:0 nt lds
buffer_load_dwordx4 v9, s[32:35], s85 offen offset:1024 nt lds
buffer_load_dwordx4 v10, s[32:35], s85 offen offset:2048 nt lds
s_add_u32 m0, s75, 9216
s_add_u32 s85, s101, 9216
buffer_load_dwordx4 v11, s[32:35], s85 offen offset:0 nt lds
buffer_load_dwordx4 v12, s[32:35], s85 offen offset:1024 nt lds
buffer_load_dwordx4 v13, s[32:35], s85 offen offset:2048 nt lds
s_add_u32 m0, s75, 12288
s_add_u32 s85, s101, 0
buffer_load_dwordx4 v14, s[36:39], s85 offen offset:0 nt lds
buffer_load_dwordx4 v15, s[36:39], s85 offen offset:1024 nt lds
s_waitcnt vmcnt(44)
buffer_load_dwordx4 v16, s[36:39], s85 offen offset:2048 nt lds
s_add_u32 m0, s75, 15360
s_add_u32 s85, s101, 3072
buffer_load_dwordx4 v14, s[36:39], s85 offen offset:0 nt lds
buffer_load_dwordx4 v15, s[36:39], s85 offen offset:1024 nt lds
buffer_load_dwordx4 v16, s[36:39], s85 offen offset:2048 nt lds
s_add_u32 m0, s75, 18432
s_add_u32 s85, s101, 6144
buffer_load_dwordx4 v14, s[36:39], s85 offen offset:0 nt lds
buffer_load_dwordx4 v15, s[36:39], s85 offen offset:1024 nt lds
buffer_load_dwordx4 v16, s[36:39], s85 offen offset:2048 nt lds
s_add_u32 m0, s75, 21504
s_add_u32 s85, s101, 9216
buffer_load_dwordx4 v14, s[36:39], s85 offen offset:0 nt lds
buffer_load_dwordx4 v15, s[36:39], s85 offen offset:1024 nt lds
buffer_load_dwordx4 v16, s[36:39], s85 offen offset:2048 nt lds
s_add_u32 s77, s77, 12288
s_cmp_eq_u32 s77, 196608
s_cselect_b32 s77, 0, s77
s_add_u32 s75, s75, 24576
s_cmp_eq_u32 s75, 73728
s_cselect_b32 s75, 0, s75
s_waitcnt vmcnt(24)
s_barrier
s_add_u32 m0, s84, 146080
s_add_u32 s85, s86, 2007296
buffer_load_dwordx4 v26, s[56:59], s85 offen offset:0 lds
buffer_load_dwordx4 v27, s[56:59], s85 offen offset:1088 lds
buffer_load_dwordx4 v28, s[56:59], s85 offen offset:2176 lds
buffer_load_dwordx4 v29, s[56:59], s85 offen offset:3264 lds
s_add_u32 m0, s84, 150464
s_add_u32 s85, s86, 2012416
buffer_load_dwordx4 v26, s[56:59], s85 offen offset:0 lds
buffer_load_dwordx4 v27, s[56:59], s85 offen offset:1088 lds
s_waitcnt vmcnt(44)
buffer_load_dwordx4 v28, s[56:59], s85 offen offset:2176 lds
buffer_load_dwordx4 v29, s[56:59], s85 offen offset:3264 lds
s_add_u32 m0, s84, 102400
s_add_u32 s85, s86, 2048256
buffer_load_dwordx4 v26, s[56:59], s85 offen offset:0 lds
buffer_load_dwordx4 v27, s[56:59], s85 offen offset:1088 lds
buffer_load_dwordx4 v28, s[56:59], s85 offen offset:2176 lds
buffer_load_dwordx4 v29, s[56:59], s85 offen offset:3264 lds
s_add_u32 m0, s84, 106784
s_add_u32 s85, s86, 2053376
buffer_load_dwordx4 v26, s[56:59], s85 offen offset:0 lds
buffer_load_dwordx4 v27, s[56:59], s85 offen offset:1088 lds
buffer_load_dwordx4 v28, s[56:59], s85 offen offset:2176 lds
buffer_load_dwordx4 v29, s[56:59], s85 offen offset:3264 lds
s_add_u32 m0, s84, 128608
s_add_u32 s85, s86, 2089216
buffer_load_dwordx4 v26, s[56:59], s85 offen offset:0 lds
buffer_load_dwordx4 v27, s[56:59], s85 offen offset:1088 lds
buffer_load_dwordx4 v28, s[56:59], s85 offen offset:2176 lds
buffer_load_dwordx4 v29, s[56:59], s85 offen offset:3264 lds
s_add_u32 m0, s84, 132992
s_add_u32 s85, s86, 2094336
buffer_load_dwordx4 v26, s[56:59], s85 offen offset:0 lds
buffer_load_dwordx4 v27, s[56:59], s85 offen offset:1088 lds
s_waitcnt vmcnt(44)
buffer_load_dwordx4 v28, s[56:59], s85 offen offset:2176 lds
buffer_load_dwordx4 v29, s[56:59], s85 offen offset:3264 lds
s_add_u32 s101, s80, s77
s_add_u32 m0, s75, 0
s_add_u32 s85, s101, 0
buffer_load_dwordx4 v8, s[32:35], s85 offen offset:0 nt lds
buffer_load_dwordx4 v9, s[32:35], s85 offen offset:1024 nt lds
buffer_load_dwordx4 v10, s[32:35], s85 offen offset:2048 nt lds
s_add_u32 m0, s75, 3072
s_add_u32 s85, s101, 3072
buffer_load_dwordx4 v11, s[32:35], s85 offen offset:0 nt lds
buffer_load_dwordx4 v12, s[32:35], s85 offen offset:1024 nt lds
buffer_load_dwordx4 v13, s[32:35], s85 offen offset:2048 nt lds
s_add_u32 m0, s75, 6144
s_add_u32 s85, s101, 6144
buffer_load_dwordx4 v8, s[32:35], s85 offen offset:0 nt lds
buffer_load_dwordx4 v9, s[32:35], s85 offen offset:1024 nt lds
buffer_load_dwordx4 v10, s[32:35], s85 offen offset:2048 nt lds
s_add_u32 m0, s75, 9216
s_add_u32 s85, s101, 9216
buffer_load_dwordx4 v11, s[32:35], s85 offen offset:0 nt lds
buffer_load_dwordx4 v12, s[32:35], s85 offen offset:1024 nt lds
buffer_load_dwordx4 v13, s[32:35], s85 offen offset:2048 nt lds
s_add_u32 m0, s75, 12288
s_add_u32 s85, s101, 0
buffer_load_dwordx4 v14, s[36:39], s85 offen offset:0 nt lds
buffer_load_dwordx4 v15, s[36:39], s85 offen offset:1024 nt lds
s_waitcnt vmcnt(44)
buffer_load_dwordx4 v16, s[36:39], s85 offen offset:2048 nt lds
s_add_u32 m0, s75, 15360
s_add_u32 s85, s101, 3072
buffer_load_dwordx4 v14, s[36:39], s85 offen offset:0 nt lds
buffer_load_dwordx4 v15, s[36:39], s85 offen offset:1024 nt lds
buffer_load_dwordx4 v16, s[36:39], s85 offen offset:2048 nt lds
s_add_u32 m0, s75, 18432
s_add_u32 s85, s101, 6144
buffer_load_dwordx4 v14, s[36:39], s85 offen offset:0 nt lds
buffer_load_dwordx4 v15, s[36:39], s85 offen offset:1024 nt lds
buffer_load_dwordx4 v16, s[36:39], s85 offen offset:2048 nt lds
s_add_u32 m0, s75, 21504
s_add_u32 s85, s101, 9216
buffer_load_dwordx4 v14, s[36:39], s85 offen offset:0 nt lds
buffer_load_dwordx4 v15, s[36:39], s85 offen offset:1024 nt lds
buffer_load_dwordx4 v16, s[36:39], s85 offen offset:2048 nt lds
s_add_u32 s77, s77, 12288
s_cmp_eq_u32 s77, 196608
s_cselect_b32 s77, 0, s77
s_add_u32 s75, s75, 24576
s_cmp_eq_u32 s75, 73728
s_cselect_b32 s75, 0, s75
s_waitcnt vmcnt(24)
s_barrier
s_add_u32 m0, s84, 137344
s_add_u32 s85, s86, 2130176
buffer_load_dwordx4 v26, s[56:59], s85 offen offset:0 lds
buffer_load_dwordx4 v27, s[56:59], s85 offen offset:1088 lds
buffer_load_dwordx4 v28, s[56:59], s85 offen offset:2176 lds
buffer_load_dwordx4 v29, s[56:59], s85 offen offset:3264 lds
s_add_u32 m0, s84, 141728
s_add_u32 s85, s86, 2135296
buffer_load_dwordx4 v26, s[56:59], s85 offen offset:0 lds
buffer_load_dwordx4 v27, s[56:59], s85 offen offset:1088 lds
s_waitcnt vmcnt(44)
buffer_load_dwordx4 v28, s[56:59], s85 offen offset:2176 lds
buffer_load_dwordx4 v29, s[56:59], s85 offen offset:3264 lds
s_add_u32 m0, s84, 154816
s_add_u32 s85, s86, 2171136
buffer_load_dwordx4 v26, s[56:59], s85 offen offset:0 lds
buffer_load_dwordx4 v27, s[56:59], s85 offen offset:1088 lds
buffer_load_dwordx4 v28, s[56:59], s85 offen offset:2176 lds
buffer_load_dwordx4 v29, s[56:59], s85 offen offset:3264 lds
s_add_u32 m0, s84, 159200
s_add_u32 s85, s86, 2176256
buffer_load_dwordx4 v26, s[56:59], s85 offen offset:0 lds
buffer_load_dwordx4 v27, s[56:59], s85 offen offset:1088 lds
buffer_load_dwordx4 v28, s[56:59], s85 offen offset:2176 lds
buffer_load_dwordx4 v29, s[56:59], s85 offen offset:3264 lds
s_add_u32 m0, s84, 111136
s_add_u32 s85, s86, 512
buffer_load_dwordx4 v26, s[56:59], s85 offen offset:0 lds
buffer_load_dwordx4 v27, s[56:59], s85 offen offset:1088 lds
buffer_load_dwordx4 v28, s[56:59], s85 offen offset:2176 lds
buffer_load_dwordx4 v29, s[56:59], s85 offen offset:3264 lds
s_add_u32 m0, s84, 115520
s_add_u32 s85, s86, 5632
buffer_load_dwordx4 v26, s[56:59], s85 offen offset:0 lds
buffer_load_dwordx4 v27, s[56:59], s85 offen offset:1088 lds
s_waitcnt vmcnt(44)
buffer_load_dwordx4 v28, s[56:59], s85 offen offset:2176 lds
buffer_load_dwordx4 v29, s[56:59], s85 offen offset:3264 lds
s_mov_b32 m0, 163584
s_add_u32 s85, s87, 5898240
buffer_load_dword v25, s[56:59], s85 offen lds
s_mov_b32 m0, 163584
s_add_u32 s85, s87, 512
buffer_load_dword v25, s[56:59], s85 offen lds
s_mov_b32 m0, 163584
s_add_u32 s85, s87, 3932672
buffer_load_dword v25, s[56:59], s85 offen lds
s_mov_b32 m0, 163584
s_add_u32 s85, s87, 1966592
buffer_load_dword v25, s[56:59], s85 offen lds
s_mov_b32 m0, 163584
s_add_u32 s85, s87, 5898496
buffer_load_dword v25, s[56:59], s85 offen lds
s_mov_b32 m0, 163584
s_add_u32 s85, s87, 768
buffer_load_dword v25, s[56:59], s85 offen lds
s_mov_b32 m0, 163584
s_add_u32 s85, s87, 3932928
buffer_load_dword v25, s[56:59], s85 offen lds
v_mov_b32 v7, 0
s_mov_b32 m0, 163584
s_nop 0
buffer_load_dword v7, s[52:55], s79 offen  lds
s_waitcnt vmcnt(8)
s_barrier
s_add_u32 m0, s84, 146080
s_add_u32 s85, s86, 41472
buffer_load_dwordx4 v26, s[56:59], s85 offen offset:0 lds
buffer_load_dwordx4 v27, s[56:59], s85 offen offset:1088 lds
buffer_load_dwordx4 v28, s[56:59], s85 offen offset:2176 lds
buffer_load_dwordx4 v29, s[56:59], s85 offen offset:3264 lds
s_add_u32 m0, s84, 150464
s_add_u32 s85, s86, 46592
buffer_load_dwordx4 v26, s[56:59], s85 offen offset:0 lds
buffer_load_dwordx4 v27, s[56:59], s85 offen offset:1088 lds
s_waitcnt vmcnt(44)
buffer_load_dwordx4 v28, s[56:59], s85 offen offset:2176 lds
buffer_load_dwordx4 v29, s[56:59], s85 offen offset:3264 lds
s_add_u32 m0, s84, 102400
s_add_u32 s85, s86, 82432
buffer_load_dwordx4 v26, s[56:59], s85 offen offset:0 lds
buffer_load_dwordx4 v27, s[56:59], s85 offen offset:1088 lds
buffer_load_dwordx4 v28, s[56:59], s85 offen offset:2176 lds
buffer_load_dwordx4 v29, s[56:59], s85 offen offset:3264 lds
s_add_u32 m0, s84, 106784
s_add_u32 s85, s86, 87552
buffer_load_dwordx4 v26, s[56:59], s85 offen offset:0 lds
buffer_load_dwordx4 v27, s[56:59], s85 offen offset:1088 lds
buffer_load_dwordx4 v28, s[56:59], s85 offen offset:2176 lds
buffer_load_dwordx4 v29, s[56:59], s85 offen offset:3264 lds
s_add_u32 m0, s84, 119872
s_add_u32 s85, s86, 123392
buffer_load_dwordx4 v26, s[56:59], s85 offen offset:0 lds
buffer_load_dwordx4 v27, s[56:59], s85 offen offset:1088 lds
buffer_load_dwordx4 v28, s[56:59], s85 offen offset:2176 lds
buffer_load_dwordx4 v29, s[56:59], s85 offen offset:3264 lds
s_add_u32 m0, s84, 124256
s_add_u32 s85, s86, 128512
buffer_load_dwordx4 v26, s[56:59], s85 offen offset:0 lds
buffer_load_dwordx4 v27, s[56:59], s85 offen offset:1088 lds
s_waitcnt vmcnt(44)
buffer_load_dwordx4 v28, s[56:59], s85 offen offset:2176 lds
buffer_load_dwordx4 v29, s[56:59], s85 offen offset:3264 lds
s_mov_b32 m0, 163584
s_add_u32 s85, s87, 5898752
buffer_load_dword v25, s[56:59], s85 offen lds
s_mov_b32 m0, 163584
s_add_u32 s85, s87, 1966848
buffer_load_dword v25, s[56:59], s85 offen lds
s_mov_b32 m0, 163584
s_add_u32 s85, s87, 1024
buffer_load_dword v25, s[56:59], s85 offen lds
s_mov_b32 m0, 163584
s_add_u32 s85, s87, 3933184
buffer_load_dword v25, s[56:59], s85 offen lds
s_mov_b32 m0, 163584
s_add_u32 s85, s87, 5899008
buffer_load_dword v25, s[56:59], s85 offen lds
s_mov_b32 m0, 163584
s_add_u32 s85, s87, 1967104
buffer_load_dword v25, s[56:59], s85 offen lds
s_mov_b32 m0, 163584
s_add_u32 s85, s87, 5899264
buffer_load_dword v25, s[56:59], s85 offen lds
s_waitcnt vmcnt(23)
s_barrier
s_add_u32 m0, s84, 137344
s_add_u32 s85, s86, 164352
buffer_load_dwordx4 v26, s[56:59], s85 offen offset:0 lds
buffer_load_dwordx4 v27, s[56:59], s85 offen offset:1088 lds
buffer_load_dwordx4 v28, s[56:59], s85 offen offset:2176 lds
buffer_load_dwordx4 v29, s[56:59], s85 offen offset:3264 lds
s_add_u32 m0, s84, 141728
s_add_u32 s85, s86, 169472
buffer_load_dwordx4 v26, s[56:59], s85 offen offset:0 lds
buffer_load_dwordx4 v27, s[56:59], s85 offen offset:1088 lds
buffer_load_dwordx4 v28, s[56:59], s85 offen offset:2176 lds
s_waitcnt vmcnt(44)
buffer_load_dwordx4 v29, s[56:59], s85 offen offset:3264 lds
s_add_u32 m0, s84, 154816
s_add_u32 s85, s86, 205312
buffer_load_dwordx4 v26, s[56:59], s85 offen offset:0 lds
buffer_load_dwordx4 v27, s[56:59], s85 offen offset:1088 lds
buffer_load_dwordx4 v28, s[56:59], s85 offen offset:2176 lds
buffer_load_dwordx4 v29, s[56:59], s85 offen offset:3264 lds
s_add_u32 m0, s84, 159200
s_add_u32 s85, s86, 210432
buffer_load_dwordx4 v26, s[56:59], s85 offen offset:0 lds
buffer_load_dwordx4 v27, s[56:59], s85 offen offset:1088 lds
buffer_load_dwordx4 v28, s[56:59], s85 offen offset:2176 lds
buffer_load_dwordx4 v29, s[56:59], s85 offen offset:3264 lds
s_add_u32 m0, s84, 128608
s_add_u32 s85, s86, 3932672
buffer_load_dwordx4 v26, s[56:59], s85 offen offset:0 lds
buffer_load_dwordx4 v27, s[56:59], s85 offen offset:1088 lds
buffer_load_dwordx4 v28, s[56:59], s85 offen offset:2176 lds
buffer_load_dwordx4 v29, s[56:59], s85 offen offset:3264 lds
s_add_u32 m0, s84, 132992
s_add_u32 s85, s86, 3937792
buffer_load_dwordx4 v26, s[56:59], s85 offen offset:0 lds
buffer_load_dwordx4 v27, s[56:59], s85 offen offset:1088 lds
buffer_load_dwordx4 v28, s[56:59], s85 offen offset:2176 lds
s_waitcnt vmcnt(44)
buffer_load_dwordx4 v29, s[56:59], s85 offen offset:3264 lds
s_add_u32 m0, s84, 77824
s_add_u32 s85, s86, 5898240
buffer_load_dwordx4 v36, s[56:59], s85 offen offset:0 lds
buffer_load_dwordx4 v37, s[56:59], s85 offen offset:1024 lds
buffer_load_dwordx4 v38, s[56:59], s85 offen offset:2048 lds
buffer_load_dwordx4 v39, s[56:59], s85 offen offset:3072 lds
s_add_u32 m0, s84, 81920
s_add_u32 s85, s86, 5939200
buffer_load_dwordx4 v36, s[56:59], s85 offen offset:0 lds
buffer_load_dwordx4 v37, s[56:59], s85 offen offset:1024 lds
buffer_load_dwordx4 v38, s[56:59], s85 offen offset:2048 lds
buffer_load_dwordx4 v39, s[56:59], s85 offen offset:3072 lds
s_add_u32 m0, s84, 86016
s_add_u32 s85, s86, 5980160
buffer_load_dwordx4 v36, s[56:59], s85 offen offset:0 lds
buffer_load_dwordx4 v37, s[56:59], s85 offen offset:1024 lds
buffer_load_dwordx4 v38, s[56:59], s85 offen offset:2048 lds
buffer_load_dwordx4 v39, s[56:59], s85 offen offset:3072 lds
s_add_u32 m0, s84, 90112
s_add_u32 s85, s86, 6021120
buffer_load_dwordx4 v36, s[56:59], s85 offen offset:0 lds
buffer_load_dwordx4 v37, s[56:59], s85 offen offset:1024 lds
buffer_load_dwordx4 v38, s[56:59], s85 offen offset:2048 lds
s_waitcnt vmcnt(44)
buffer_load_dwordx4 v39, s[56:59], s85 offen offset:3072 lds
s_add_u32 m0, s84, 94208
s_add_u32 s85, s86, 6062080
buffer_load_dwordx4 v36, s[56:59], s85 offen offset:0 lds
buffer_load_dwordx4 v37, s[56:59], s85 offen offset:1024 lds
buffer_load_dwordx4 v38, s[56:59], s85 offen offset:2048 lds
buffer_load_dwordx4 v39, s[56:59], s85 offen offset:3072 lds
s_add_u32 m0, s84, 98304
s_add_u32 s85, s86, 6103040
buffer_load_dwordx4 v36, s[56:59], s85 offen offset:0 lds
buffer_load_dwordx4 v37, s[56:59], s85 offen offset:1024 lds
buffer_load_dwordx4 v38, s[56:59], s85 offen offset:2048 lds
buffer_load_dwordx4 v39, s[56:59], s85 offen offset:3072 lds
v_mov_b32 v4, 163584
ds_read_b32 v4, v4
s_waitcnt lgkmcnt(0)
v_readfirstlane_b32 s69, v4
s_mov_b32 s73, 0
L_ichk:
s_cmp_ge_u32 s69, 8
s_cbranch_scc1 L_ichk_done
s_add_u32 s73, s73, 1
s_cmp_ge_u32 s73, 200000
s_cbranch_scc1 L_ichk_done
v_mov_b32 v7, 0
v_mov_b32 v4, 0
s_mov_b64 exec, 1
buffer_atomic_add v4, v7, s[52:55], s79 offen sc0 sc1
s_mov_b64 exec, -1
s_waitcnt vmcnt(0)
v_readfirstlane_b32 s69, v4
s_branch L_ichk
L_ichk_done:
s_waitcnt vmcnt(55)
s_barrier
s_add_u32 m0, s84, 111136
s_add_u32 s85, s86, 3973632
buffer_load_dwordx4 v26, s[56:59], s85 offen offset:0 lds
buffer_load_dwordx4 v27, s[56:59], s85 offen offset:1088 lds
buffer_load_dwordx4 v28, s[56:59], s85 offen offset:2176 lds
buffer_load_dwordx4 v29, s[56:59], s85 offen offset:3264 lds
s_add_u32 m0, s84, 115520
s_add_u32 s85, s86, 3978752
buffer_load_dwordx4 v26, s[56:59], s85 offen offset:0 lds
buffer_load_dwordx4 v27, s[56:59], s85 offen offset:1088 lds
buffer_load_dwordx4 v28, s[56:59], s85 offen offset:2176 lds
s_waitcnt vmcnt(44)
buffer_load_dwordx4 v29, s[56:59], s85 offen offset:3264 lds
s_add_u32 m0, s84, 61440
s_add_u32 s85, s86, 5898368
buffer_load_dwordx4 v36, s[56:59], s85 offen offset:0 lds
buffer_load_dwordx4 v37, s[56:59], s85 offen offset:1024 lds
buffer_load_dwordx4 v38, s[56:59], s85 offen offset:2048 lds
buffer_load_dwordx4 v39, s[56:59], s85 offen offset:3072 lds
s_add_u32 m0, s84, 65536
s_add_u32 s85, s86, 5939328
buffer_load_dwordx4 v36, s[56:59], s85 offen offset:0 lds
buffer_load_dwordx4 v37, s[56:59], s85 offen offset:1024 lds
buffer_load_dwordx4 v38, s[56:59], s85 offen offset:2048 lds
buffer_load_dwordx4 v39, s[56:59], s85 offen offset:3072 lds
s_add_u32 m0, s84, 69632
s_add_u32 s85, s86, 5980288
buffer_load_dwordx4 v36, s[56:59], s85 offen offset:0 lds
buffer_load_dwordx4 v37, s[56:59], s85 offen offset:1024 lds
buffer_load_dwordx4 v38, s[56:59], s85 offen offset:2048 lds
buffer_load_dwordx4 v39, s[56:59], s85 offen offset:3072 lds
s_add_u32 m0, s84, 73728
s_add_u32 s85, s86, 6021248
buffer_load_dwordx4 v36, s[56:59], s85 offen offset:0 lds
buffer_load_dwordx4 v37, s[56:59], s85 offen offset:1024 lds
buffer_load_dwordx4 v38, s[56:59], s85 offen offset:2048 lds
s_waitcnt vmcnt(44)
buffer_load_dwordx4 v39, s[56:59], s85 offen offset:3072 lds
s_waitcnt vmcnt(24)
s_barrier
s_add_u32 m0, s84, 146080
s_add_u32 s85, s86, 4014592
buffer_load_dwordx4 v26, s[56:59], s85 offen offset:0 lds
buffer_load_dwordx4 v27, s[56:59], s85 offen offset:1088 lds
buffer_load_dwordx4 v28, s[56:59], s85 offen offset:2176 lds
buffer_load_dwordx4 v29, s[56:59], s85 offen offset:3264 lds
s_add_u32 m0, s84, 150464
s_add_u32 s85, s86, 4019712
buffer_load_dwordx4 v26, s[56:59], s85 offen offset:0 lds
buffer_load_dwordx4 v27, s[56:59], s85 offen offset:1088 lds
buffer_load_dwordx4 v28, s[56:59], s85 offen offset:2176 lds
buffer_load_dwordx4 v29, s[56:59], s85 offen offset:3264 lds
s_add_u32 m0, s84, 102400
s_add_u32 s85, s86, 4055552
buffer_load_dwordx4 v26, s[56:59], s85 offen offset:0 lds
buffer_load_dwordx4 v27, s[56:59], s85 offen offset:1088 lds
buffer_load_dwordx4 v28, s[56:59], s85 offen offset:2176 lds
buffer_load_dwordx4 v29, s[56:59], s85 offen offset:3264 lds
s_add_u32 m0, s84, 106784
s_add_u32 s85, s86, 4060672
buffer_load_dwordx4 v26, s[56:59], s85 offen offset:0 lds
buffer_load_dwordx4 v27, s[56:59], s85 offen offset:1088 lds
buffer_load_dwordx4 v28, s[56:59], s85 offen offset:2176 lds
s_waitcnt vmcnt(44)
buffer_load_dwordx4 v29, s[56:59], s85 offen offset:3264 lds
s_add_u32 m0, s84, 24576
s_add_u32 s85, s86, 4096512
buffer_load_dwordx4 v26, s[56:59], s85 offen offset:0 lds
buffer_load_dwordx4 v27, s[56:59], s85 offen offset:1088 lds
buffer_load_dwordx4 v28, s[56:59], s85 offen offset:2176 lds
buffer_load_dwordx4 v29, s[56:59], s85 offen offset:3264 lds
s_add_u32 m0, s84, 28960
s_add_u32 s85, s86, 4101632
buffer_load_dwordx4 v26, s[56:59], s85 offen offset:0 lds
buffer_load_dwordx4 v27, s[56:59], s85 offen offset:1088 lds
buffer_load_dwordx4 v28, s[56:59], s85 offen offset:2176 lds
buffer_load_dwordx4 v29, s[56:59], s85 offen offset:3264 lds
s_add_u32 m0, s84, 33312
s_add_u32 s85, s86, 4137472
buffer_load_dwordx4 v26, s[56:59], s85 offen offset:0 lds
buffer_load_dwordx4 v27, s[56:59], s85 offen offset:1088 lds
buffer_load_dwordx4 v28, s[56:59], s85 offen offset:2176 lds
buffer_load_dwordx4 v29, s[56:59], s85 offen offset:3264 lds
s_add_u32 m0, s84, 37696
s_add_u32 s85, s86, 4142592
buffer_load_dwordx4 v26, s[56:59], s85 offen offset:0 lds
buffer_load_dwordx4 v27, s[56:59], s85 offen offset:1088 lds
buffer_load_dwordx4 v28, s[56:59], s85 offen offset:2176 lds
s_waitcnt vmcnt(44)
buffer_load_dwordx4 v29, s[56:59], s85 offen offset:3264 lds
s_add_u32 m0, s84, 42048
s_add_u32 s85, s86, 1966592
buffer_load_dwordx4 v26, s[56:59], s85 offen offset:0 lds
buffer_load_dwordx4 v27, s[56:59], s85 offen offset:1088 lds
buffer_load_dwordx4 v28, s[56:59], s85 offen offset:2176 lds
buffer_load_dwordx4 v29, s[56:59], s85 offen offset:3264 lds
s_add_u32 m0, s84, 46432
s_add_u32 s85, s86, 1971712
buffer_load_dwordx4 v26, s[56:59], s85 offen offset:0 lds
buffer_load_dwordx4 v27, s[56:59], s85 offen offset:1088 lds
buffer_load_dwordx4 v28, s[56:59], s85 offen offset:2176 lds
buffer_load_dwordx4 v29, s[56:59], s85 offen offset:3264 lds
s_add_u32 m0, s84, 53248
s_add_u32 s85, s86, 6062208
buffer_load_dwordx4 v36, s[56:59], s85 offen offset:0 lds
buffer_load_dwordx4 v37, s[56:59], s85 offen offset:1024 lds
buffer_load_dwordx4 v38, s[56:59], s85 offen offset:2048 lds
buffer_load_dwordx4 v39, s[56:59], s85 offen offset:3072 lds
s_add_u32 m0, s84, 57344
s_add_u32 s85, s86, 6103168
buffer_load_dwordx4 v36, s[56:59], s85 offen offset:0 lds
buffer_load_dwordx4 v37, s[56:59], s85 offen offset:1024 lds
buffer_load_dwordx4 v38, s[56:59], s85 offen offset:2048 lds
s_waitcnt vmcnt(44)
buffer_load_dwordx4 v39, s[56:59], s85 offen offset:3072 lds
s_waitcnt vmcnt(40)
s_barrier
s_add_u32 m0, s84, 137344
s_add_u32 s85, s86, 2007552
buffer_load_dwordx4 v26, s[56:59], s85 offen offset:0 lds
buffer_load_dwordx4 v27, s[56:59], s85 offen offset:1088 lds
buffer_load_dwordx4 v28, s[56:59], s85 offen offset:2176 lds
buffer_load_dwordx4 v29, s[56:59], s85 offen offset:3264 lds
s_add_u32 m0, s84, 141728
s_add_u32 s85, s86, 2012672
buffer_load_dwordx4 v26, s[56:59], s85 offen offset:0 lds
buffer_load_dwordx4 v27, s[56:59], s85 offen offset:1088 lds
buffer_load_dwordx4 v28, s[56:59], s85 offen offset:2176 lds
buffer_load_dwordx4 v29, s[56:59], s85 offen offset:3264 lds
s_add_u32 m0, s84, 154816
s_add_u32 s85, s86, 2048512
buffer_load_dwordx4 v26, s[56:59], s85 offen offset:0 lds
buffer_load_dwordx4 v27, s[56:59], s85 offen offset:1088 lds
buffer_load_dwordx4 v28, s[56:59], s85 offen offset:2176 lds
buffer_load_dwordx4 v29, s[56:59], s85 offen offset:3264 lds
s_add_u32 m0, s84, 159200
s_add_u32 s85, s86, 2053632
buffer_load_dwordx4 v26, s[56:59], s85 offen offset:0 lds
buffer_load_dwordx4 v27, s[56:59], s85 offen offset:1088 lds
buffer_load_dwordx4 v28, s[56:59], s85 offen offset:2176 lds
s_waitcnt vmcnt(44)
buffer_load_dwordx4 v29, s[56:59], s85 offen offset:3264 lds
s_add_u32 m0, s84, 119872
s_add_u32 s85, s86, 2089472
buffer_load_dwordx4 v26, s[56:59], s85 offen offset:0 lds
buffer_load_dwordx4 v27, s[56:59], s85 offen offset:1088 lds
buffer_load_dwordx4 v28, s[56:59], s85 offen offset:2176 lds
buffer_load_dwordx4 v29, s[56:59], s85 offen offset:3264 lds
s_add_u32 m0, s84, 124256
s_add_u32 s85, s86, 2094592
buffer_load_dwordx4 v26, s[56:59], s85 offen offset:0 lds
buffer_load_dwordx4 v27, s[56:59], s85 offen offset:1088 lds
buffer_load_dwordx4 v28, s[56:59], s85 offen offset:2176 lds
buffer_load_dwordx4 v29, s[56:59], s85 offen offset:3264 lds
s_waitcnt vmcnt(40)
s_barrier
s_add_u32 m0, s84, 111136
s_add_u32 s85, s86, 2130432
buffer_load_dwordx4 v26, s[56:59], s85 offen offset:0 lds
buffer_load_dwordx4 v27, s[56:59], s85 offen offset:1088 lds
buffer_load_dwordx4 v28, s[56:59], s85 offen offset:2176 lds
buffer_load_dwordx4 v29, s[56:59], s85 offen offset:3264 lds
s_add_u32 m0, s84, 115520
s_add_u32 s85, s86, 2135552
buffer_load_dwordx4 v26, s[56:59], s85 offen offset:0 lds
buffer_load_dwordx4 v27, s[56:59], s85 offen offset:1088 lds
buffer_load_dwordx4 v28, s[56:59], s85 offen offset:2176 lds
s_waitcnt vmcnt(44)
buffer_load_dwordx4 v29, s[56:59], s85 offen offset:3264 lds
s_add_u32 m0, s84, 77824
s_add_u32 s85, s86, 5898496
buffer_load_dwordx4 v36, s[56:59], s85 offen offset:0 lds
buffer_load_dwordx4 v37, s[56:59], s85 offen offset:1024 lds
buffer_load_dwordx4 v38, s[56:59], s85 offen offset:2048 lds
buffer_load_dwordx4 v39, s[56:59], s85 offen offset:3072 lds
s_add_u32 m0, s84, 81920
s_add_u32 s85, s86, 5939456
buffer_load_dwordx4 v36, s[56:59], s85 offen offset:0 lds
buffer_load_dwordx4 v37, s[56:59], s85 offen offset:1024 lds
buffer_load_dwordx4 v38, s[56:59], s85 offen offset:2048 lds
buffer_load_dwordx4 v39, s[56:59], s85 offen offset:3072 lds
s_add_u32 m0, s84, 128608
s_add_u32 s85, s86, 2171392
buffer_load_dwordx4 v26, s[56:59], s85 offen offset:0 lds
buffer_load_dwordx4 v27, s[56:59], s85 offen offset:1088 lds
buffer_load_dwordx4 v28, s[56:59], s85 offen offset:2176 lds
buffer_load_dwordx4 v29, s[56:59], s85 offen offset:3264 lds
s_add_u32 m0, s84, 132992
s_add_u32 s85, s86, 2176512
buffer_load_dwordx4 v26, s[56:59], s85 offen offset:0 lds
buffer_load_dwordx4 v27, s[56:59], s85 offen offset:1088 lds
buffer_load_dwordx4 v28, s[56:59], s85 offen offset:2176 lds
s_waitcnt vmcnt(44)
buffer_load_dwordx4 v29, s[56:59], s85 offen offset:3264 lds
s_waitcnt vmcnt(40)
s_barrier
s_add_u32 m0, s84, 146080
s_add_u32 s85, s86, 768
buffer_load_dwordx4 v26, s[56:59], s85 offen offset:0 lds
buffer_load_dwordx4 v27, s[56:59], s85 offen offset:1088 lds
buffer_load_dwordx4 v28, s[56:59], s85 offen offset:2176 lds
buffer_load_dwordx4 v29, s[56:59], s85 offen offset:3264 lds
s_add_u32 m0, s84, 150464
s_add_u32 s85, s86, 5888
buffer_load_dwordx4 v26, s[56:59], s85 offen offset:0 lds
buffer_load_dwordx4 v27, s[56:59], s85 offen offset:1088 lds
buffer_load_dwordx4 v28, s[56:59], s85 offen offset:2176 lds
buffer_load_dwordx4 v29, s[56:59], s85 offen offset:3264 lds
s_add_u32 m0, s84, 86016
s_add_u32 s85, s86, 5980416
buffer_load_dwordx4 v36, s[56:59], s85 offen offset:0 lds
buffer_load_dwordx4 v37, s[56:59], s85 offen offset:1024 lds
buffer_load_dwordx4 v38, s[56:59], s85 offen offset:2048 lds
buffer_load_dwordx4 v39, s[56:59], s85 offen offset:3072 lds
s_add_u32 m0, s84, 90112
s_add_u32 s85, s86, 6021376
buffer_load_dwordx4 v36, s[56:59], s85 offen offset:0 lds
buffer_load_dwordx4 v37, s[56:59], s85 offen offset:1024 lds
buffer_load_dwordx4 v38, s[56:59], s85 offen offset:2048 lds
s_waitcnt vmcnt(44)
buffer_load_dwordx4 v39, s[56:59], s85 offen offset:3072 lds
s_add_u32 m0, s84, 102400
s_add_u32 s85, s86, 41728
buffer_load_dwordx4 v26, s[56:59], s85 offen offset:0 lds
buffer_load_dwordx4 v27, s[56:59], s85 offen offset:1088 lds
buffer_load_dwordx4 v28, s[56:59], s85 offen offset:2176 lds
buffer_load_dwordx4 v29, s[56:59], s85 offen offset:3264 lds
s_add_u32 m0, s84, 106784
s_add_u32 s85, s86, 46848
buffer_load_dwordx4 v26, s[56:59], s85 offen offset:0 lds
buffer_load_dwordx4 v27, s[56:59], s85 offen offset:1088 lds
buffer_load_dwordx4 v28, s[56:59], s85 offen offset:2176 lds
buffer_load_dwordx4 v29, s[56:59], s85 offen offset:3264 lds
s_add_u32 m0, s84, 94208
s_add_u32 s85, s86, 6062336
buffer_load_dwordx4 v36, s[56:59], s85 offen offset:0 lds
buffer_load_dwordx4 v37, s[56:59], s85 offen offset:1024 lds
buffer_load_dwordx4 v38, s[56:59], s85 offen offset:2048 lds
buffer_load_dwordx4 v39, s[56:59], s85 offen offset:3072 lds
s_add_u32 m0, s84, 98304
s_add_u32 s85, s86, 6103296
buffer_load_dwordx4 v36, s[56:59], s85 offen offset:0 lds
buffer_load_dwordx4 v37, s[56:59], s85 offen offset:1024 lds
buffer_load_dwordx4 v38, s[56:59], s85 offen offset:2048 lds
s_waitcnt vmcnt(44)
buffer_load_dwordx4 v39, s[56:59], s85 offen offset:3072 lds
s_waitcnt vmcnt(40)
s_barrier
s_add_u32 m0, s84, 24576
s_add_u32 s85, s86, 82688
buffer_load_dwordx4 v26, s[56:59], s85 offen offset:0 lds
buffer_load_dwordx4 v27, s[56:59], s85 offen offset:1088 lds
buffer_load_dwordx4 v28, s[56:59], s85 offen offset:2176 lds
buffer_load_dwordx4 v29, s[56:59], s85 offen offset:3264 lds
s_add_u32 m0, s84, 28960
s_add_u32 s85, s86, 87808
buffer_load_dwordx4 v26, s[56:59], s85 offen offset:0 lds
buffer_load_dwordx4 v27, s[56:59], s85 offen offset:1088 lds
buffer_load_dwordx4 v28, s[56:59], s85 offen offset:2176 lds
buffer_load_dwordx4 v29, s[56:59], s85 offen offset:3264 lds
s_add_u32 m0, s84, 33312
s_add_u32 s85, s86, 123648
buffer_load_dwordx4 v26, s[56:59], s85 offen offset:0 lds
buffer_load_dwordx4 v27, s[56:59], s85 offen offset:1088 lds
buffer_load_dwordx4 v28, s[56:59], s85 offen offset:2176 lds
buffer_load_dwordx4 v29, s[56:59], s85 offen offset:3264 lds
s_add_u32 m0, s84, 37696
s_add_u32 s85, s86, 128768
buffer_load_dwordx4 v26, s[56:59], s85 offen offset:0 lds
buffer_load_dwordx4 v27, s[56:59], s85 offen offset:1088 lds
buffer_load_dwordx4 v28, s[56:59], s85 offen offset:2176 lds
s_waitcnt vmcnt(44)
buffer_load_dwordx4 v29, s[56:59], s85 offen offset:3264 lds
s_add_u32 m0, s84, 42048
s_add_u32 s85, s86, 164608
buffer_load_dwordx4 v26, s[56:59], s85 offen offset:0 lds
buffer_load_dwordx4 v27, s[56:59], s85 offen offset:1088 lds
buffer_load_dwordx4 v28, s[56:59], s85 offen offset:2176 lds
buffer_load_dwordx4 v29, s[56:59], s85 offen offset:3264 lds
s_add_u32 m0, s84, 46432
s_add_u32 s85, s86, 169728
buffer_load_dwordx4 v26, s[56:59], s85 offen offset:0 lds
buffer_load_dwordx4 v27, s[56:59], s85 offen offset:1088 lds
buffer_load_dwordx4 v28, s[56:59], s85 offen offset:2176 lds
buffer_load_dwordx4 v29, s[56:59], s85 offen offset:3264 lds
s_waitcnt vmcnt(40)
s_barrier
s_add_u32 m0, s84, 137344
s_add_u32 s85, s86, 205568
buffer_load_dwordx4 v26, s[56:59], s85 offen offset:0 lds
buffer_load_dwordx4 v27, s[56:59], s85 offen offset:1088 lds
buffer_load_dwordx4 v28, s[56:59], s85 offen offset:2176 lds
buffer_load_dwordx4 v29, s[56:59], s85 offen offset:3264 lds
s_add_u32 m0, s84, 141728
s_add_u32 s85, s86, 210688
buffer_load_dwordx4 v26, s[56:59], s85 offen offset:0 lds
buffer_load_dwordx4 v27, s[56:59], s85 offen offset:1088 lds
buffer_load_dwordx4 v28, s[56:59], s85 offen offset:2176 lds
s_waitcnt vmcnt(44)
buffer_load_dwordx4 v29, s[56:59], s85 offen offset:3264 lds
s_add_u32 m0, s84, 61440
s_add_u32 s85, s86, 5898624
buffer_load_dwordx4 v36, s[56:59], s85 offen offset:0 lds
buffer_load_dwordx4 v37, s[56:59], s85 offen offset:1024 lds
buffer_load_dwordx4 v38, s[56:59], s85 offen offset:2048 lds
buffer_load_dwordx4 v39, s[56:59], s85 offen offset:3072 lds
s_add_u32 m0, s84, 65536
s_add_u32 s85, s86, 5939584
buffer_load_dwordx4 v36, s[56:59], s85 offen offset:0 lds
buffer_load_dwordx4 v37, s[56:59], s85 offen offset:1024 lds
buffer_load_dwordx4 v38, s[56:59], s85 offen offset:2048 lds
buffer_load_dwordx4 v39, s[56:59], s85 offen offset:3072 lds
s_add_u32 m0, s84, 154816
s_add_u32 s85, s86, 3932928
buffer_load_dwordx4 v26, s[56:59], s85 offen offset:0 lds
buffer_load_dwordx4 v27, s[56:59], s85 offen offset:1088 lds
buffer_load_dwordx4 v28, s[56:59], s85 offen offset:2176 lds
buffer_load_dwordx4 v29, s[56:59], s85 offen offset:3264 lds
s_add_u32 m0, s84, 159200
s_add_u32 s85, s86, 3938048
buffer_load_dwordx4 v26, s[56:59], s85 offen offset:0 lds
buffer_load_dwordx4 v27, s[56:59], s85 offen offset:1088 lds
buffer_load_dwordx4 v28, s[56:59], s85 offen offset:2176 lds
s_waitcnt vmcnt(44)
buffer_load_dwordx4 v29, s[56:59], s85 offen offset:3264 lds
s_waitcnt vmcnt(32)
s_barrier
s_add_u32 m0, s84, 111136
s_add_u32 s85, s86, 3973888
buffer_load_dwordx4 v26, s[56:59], s85 offen offset:0 lds
buffer_load_dwordx4 v27, s[56:59], s85 offen offset:1088 lds
buffer_load_dwordx4 v28, s[56:59], s85 offen offset:2176 lds
buffer_load_dwordx4 v29, s[56:59], s85 offen offset:3264 lds
s_add_u32 m0, s84, 115520
s_add_u32 s85, s86, 3979008
buffer_load_dwordx4 v26, s[56:59], s85 offen offset:0 lds
buffer_load_dwordx4 v27, s[56:59], s85 offen offset:1088 lds
buffer_load_dwordx4 v28, s[56:59], s85 offen offset:2176 lds
buffer_load_dwordx4 v29, s[56:59], s85 offen offset:3264 lds
s_add_u32 m0, s84, 119872
s_add_u32 s85, s86, 4014848
buffer_load_dwordx4 v26, s[56:59], s85 offen offset:0 lds
buffer_load_dwordx4 v27, s[56:59], s85 offen offset:1088 lds
buffer_load_dwordx4 v28, s[56:59], s85 offen offset:2176 lds
buffer_load_dwordx4 v29, s[56:59], s85 offen offset:3264 lds
s_add_u32 m0, s84, 124256
s_add_u32 s85, s86, 4019968
buffer_load_dwordx4 v26, s[56:59], s85 offen offset:0 lds
buffer_load_dwordx4 v27, s[56:59], s85 offen offset:1088 lds
buffer_load_dwordx4 v28, s[56:59], s85 offen offset:2176 lds
s_waitcnt vmcnt(44)
buffer_load_dwordx4 v29, s[56:59], s85 offen offset:3264 lds
s_add_u32 m0, s84, 69632
s_add_u32 s85, s86, 5980544
buffer_load_dwordx4 v36, s[56:59], s85 offen offset:0 lds
buffer_load_dwordx4 v37, s[56:59], s85 offen offset:1024 lds
buffer_load_dwordx4 v38, s[56:59], s85 offen offset:2048 lds
buffer_load_dwordx4 v39, s[56:59], s85 offen offset:3072 lds
s_add_u32 m0, s84, 73728
s_add_u32 s85, s86, 6021504
buffer_load_dwordx4 v36, s[56:59], s85 offen offset:0 lds
buffer_load_dwordx4 v37, s[56:59], s85 offen offset:1024 lds
buffer_load_dwordx4 v38, s[56:59], s85 offen offset:2048 lds
buffer_load_dwordx4 v39, s[56:59], s85 offen offset:3072 lds
s_add_u32 m0, s84, 53248
s_add_u32 s85, s86, 6062464
buffer_load_dwordx4 v36, s[56:59], s85 offen offset:0 lds
buffer_load_dwordx4 v37, s[56:59], s85 offen offset:1024 lds
buffer_load_dwordx4 v38, s[56:59], s85 offen offset:2048 lds
buffer_load_dwordx4 v39, s[56:59], s85 offen offset:3072 lds
s_add_u32 m0, s84, 57344
s_add_u32 s85, s86, 6103424
buffer_load_dwordx4 v36, s[56:59], s85 offen offset:0 lds
buffer_load_dwordx4 v37, s[56:59], s85 offen offset:1024 lds
buffer_load_dwordx4 v38, s[56:59], s85 offen offset:2048 lds
s_waitcnt vmcnt(44)
buffer_load_dwordx4 v39, s[56:59], s85 offen offset:3072 lds
s_add_u32 m0, s84, 128608
s_add_u32 s85, s86, 4055808
buffer_load_dwordx4 v26, s[56:59], s85 offen offset:0 lds
buffer_load_dwordx4 v27, s[56:59], s85 offen offset:1088 lds
buffer_load_dwordx4 v28, s[56:59], s85 offen offset:2176 lds
buffer_load_dwordx4 v29, s[56:59], s85 offen offset:3264 lds
s_add_u32 m0, s84, 132992
s_add_u32 s85, s86, 4060928
buffer_load_dwordx4 v26, s[56:59], s85 offen offset:0 lds
buffer_load_dwordx4 v27, s[56:59], s85 offen offset:1088 lds
buffer_load_dwordx4 v28, s[56:59], s85 offen offset:2176 lds
buffer_load_dwordx4 v29, s[56:59], s85 offen offset:3264 lds
s_waitcnt vmcnt(48)
s_barrier
s_add_u32 m0, s84, 146080
s_add_u32 s85, s86, 4096768
buffer_load_dwordx4 v26, s[56:59], s85 offen offset:0 lds
buffer_load_dwordx4 v27, s[56:59], s85 offen offset:1088 lds
buffer_load_dwordx4 v28, s[56:59], s85 offen offset:2176 lds
buffer_load_dwordx4 v29, s[56:59], s85 offen offset:3264 lds
s_add_u32 m0, s84, 150464
s_add_u32 s85, s86, 4101888
buffer_load_dwordx4 v26, s[56:59], s85 offen offset:0 lds
buffer_load_dwordx4 v27, s[56:59], s85 offen offset:1088 lds
buffer_load_dwordx4 v28, s[56:59], s85 offen offset:2176 lds
s_waitcnt vmcnt(44)
buffer_load_dwordx4 v29, s[56:59], s85 offen offset:3264 lds
s_add_u32 m0, s84, 102400
s_add_u32 s85, s86, 4137728
buffer_load_dwordx4 v26, s[56:59], s85 offen offset:0 lds
buffer_load_dwordx4 v27, s[56:59], s85 offen offset:1088 lds
buffer_load_dwordx4 v28, s[56:59], s85 offen offset:2176 lds
buffer_load_dwordx4 v29, s[56:59], s85 offen offset:3264 lds
s_add_u32 m0, s84, 106784
s_add_u32 s85, s86, 4142848
buffer_load_dwordx4 v26, s[56:59], s85 offen offset:0 lds
buffer_load_dwordx4 v27, s[56:59], s85 offen offset:1088 lds
buffer_load_dwordx4 v28, s[56:59], s85 offen offset:2176 lds
buffer_load_dwordx4 v29, s[56:59], s85 offen offset:3264 lds
s_add_u32 m0, s84, 24576
s_add_u32 s85, s86, 1966848
buffer_load_dwordx4 v26, s[56:59], s85 offen offset:0 lds
buffer_load_dwordx4 v27, s[56:59], s85 offen offset:1088 lds
buffer_load_dwordx4 v28, s[56:59], s85 offen offset:2176 lds
buffer_load_dwordx4 v29, s[56:59], s85 offen offset:3264 lds
s_add_u32 m0, s84, 28960
s_add_u32 s85, s86, 1971968
buffer_load_dwordx4 v26, s[56:59], s85 offen offset:0 lds
buffer_load_dwordx4 v27, s[56:59], s85 offen offset:1088 lds
buffer_load_dwordx4 v28, s[56:59], s85 offen offset:2176 lds
s_waitcnt vmcnt(44)
buffer_load_dwordx4 v29, s[56:59], s85 offen offset:3264 lds
s_waitcnt vmcnt(32)
s_barrier
s_add_u32 m0, s84, 77824
s_add_u32 s85, s86, 5898752
buffer_load_dwordx4 v36, s[56:59], s85 offen offset:0 lds
buffer_load_dwordx4 v37, s[56:59], s85 offen offset:1024 lds
buffer_load_dwordx4 v38, s[56:59], s85 offen offset:2048 lds
buffer_load_dwordx4 v39, s[56:59], s85 offen offset:3072 lds
s_add_u32 m0, s84, 81920
s_add_u32 s85, s86, 5939712
buffer_load_dwordx4 v36, s[56:59], s85 offen offset:0 lds
buffer_load_dwordx4 v37, s[56:59], s85 offen offset:1024 lds
buffer_load_dwordx4 v38, s[56:59], s85 offen offset:2048 lds
buffer_load_dwordx4 v39, s[56:59], s85 offen offset:3072 lds
s_add_u32 m0, s84, 33312
s_add_u32 s85, s86, 2007808
buffer_load_dwordx4 v26, s[56:59], s85 offen offset:0 lds
buffer_load_dwordx4 v27, s[56:59], s85 offen offset:1088 lds
buffer_load_dwordx4 v28, s[56:59], s85 offen offset:2176 lds
buffer_load_dwordx4 v29, s[56:59], s85 offen offset:3264 lds
s_add_u32 m0, s84, 37696
s_add_u32 s85, s86, 2012928
buffer_load_dwordx4 v26, s[56:59], s85 offen offset:0 lds
buffer_load_dwordx4 v27, s[56:59], s85 offen offset:1088 lds
buffer_load_dwordx4 v28, s[56:59], s85 offen offset:2176 lds
s_waitcnt vmcnt(44)
buffer_load_dwordx4 v29, s[56:59], s85 offen offset:3264 lds
s_add_u32 m0, s84, 42048
s_add_u32 s85, s86, 2048768
buffer_load_dwordx4 v26, s[56:59], s85 offen offset:0 lds
buffer_load_dwordx4 v27, s[56:59], s85 offen offset:1088 lds
buffer_load_dwordx4 v28, s[56:59], s85 offen offset:2176 lds
buffer_load_dwordx4 v29, s[56:59], s85 offen offset:3264 lds
s_add_u32 m0, s84, 46432
s_add_u32 s85, s86, 2053888
buffer_load_dwordx4 v26, s[56:59], s85 offen offset:0 lds
buffer_load_dwordx4 v27, s[56:59], s85 offen offset:1088 lds
buffer_load_dwordx4 v28, s[56:59], s85 offen offset:2176 lds
buffer_load_dwordx4 v29, s[56:59], s85 offen offset:3264 lds
s_add_u32 m0, s84, 86016
s_add_u32 s85, s86, 5980672
buffer_load_dwordx4 v36, s[56:59], s85 offen offset:0 lds
buffer_load_dwordx4 v37, s[56:59], s85 offen offset:1024 lds
buffer_load_dwordx4 v38, s[56:59], s85 offen offset:2048 lds
buffer_load_dwordx4 v39, s[56:59], s85 offen offset:3072 lds
s_add_u32 m0, s84, 90112
s_add_u32 s85, s86, 6021632
buffer_load_dwordx4 v36, s[56:59], s85 offen offset:0 lds
buffer_load_dwordx4 v37, s[56:59], s85 offen offset:1024 lds
buffer_load_dwordx4 v38, s[56:59], s85 offen offset:2048 lds
s_waitcnt vmcnt(44)
buffer_load_dwordx4 v39, s[56:59], s85 offen offset:3072 lds
s_waitcnt vmcnt(24)
s_barrier
s_add_u32 m0, s84, 137344
s_add_u32 s85, s86, 2089728
buffer_load_dwordx4 v26, s[56:59], s85 offen offset:0 lds
buffer_load_dwordx4 v27, s[56:59], s85 offen offset:1088 lds
buffer_load_dwordx4 v28, s[56:59], s85 offen offset:2176 lds
buffer_load_dwordx4 v29, s[56:59], s85 offen offset:3264 lds
s_add_u32 m0, s84, 141728
s_add_u32 s85, s86, 2094848
buffer_load_dwordx4 v26, s[56:59], s85 offen offset:0 lds
buffer_load_dwordx4 v27, s[56:59], s85 offen offset:1088 lds
buffer_load_dwordx4 v28, s[56:59], s85 offen offset:2176 lds
buffer_load_dwordx4 v29, s[56:59], s85 offen offset:3264 lds
s_add_u32 m0, s84, 154816
s_add_u32 s85, s86, 2130688
buffer_load_dwordx4 v26, s[56:59], s85 offen offset:0 lds
buffer_load_dwordx4 v27, s[56:59], s85 offen offset:1088 lds
buffer_load_dwordx4 v28, s[56:59], s85 offen offset:2176 lds
buffer_load_dwordx4 v29, s[56:59], s85 offen offset:3264 lds
s_add_u32 m0, s84, 159200
s_add_u32 s85, s86, 2135808
buffer_load_dwordx4 v26, s[56:59], s85 offen offset:0 lds
buffer_load_dwordx4 v27, s[56:59], s85 offen offset:1088 lds
buffer_load_dwordx4 v28, s[56:59], s85 offen offset:2176 lds
s_waitcnt vmcnt(44)
buffer_load_dwordx4 v29, s[56:59], s85 offen offset:3264 lds
s_add_u32 m0, s84, 94208
s_add_u32 s85, s86, 6062592
buffer_load_dwordx4 v36, s[56:59], s85 offen offset:0 lds
buffer_load_dwordx4 v37, s[56:59], s85 offen offset:1024 lds
buffer_load_dwordx4 v38, s[56:59], s85 offen offset:2048 lds
buffer_load_dwordx4 v39, s[56:59], s85 offen offset:3072 lds
s_add_u32 m0, s84, 98304
s_add_u32 s85, s86, 6103552
buffer_load_dwordx4 v36, s[56:59], s85 offen offset:0 lds
buffer_load_dwordx4 v37, s[56:59], s85 offen offset:1024 lds
buffer_load_dwordx4 v38, s[56:59], s85 offen offset:2048 lds
buffer_load_dwordx4 v39, s[56:59], s85 offen offset:3072 lds
s_add_u32 m0, s84, 111136
s_add_u32 s85, s86, 2171648
buffer_load_dwordx4 v26, s[56:59], s85 offen offset:0 lds
buffer_load_dwordx4 v27, s[56:59], s85 offen offset:1088 lds
buffer_load_dwordx4 v28, s[56:59], s85 offen offset:2176 lds
buffer_load_dwordx4 v29, s[56:59], s85 offen offset:3264 lds
s_add_u32 m0, s84, 115520
s_add_u32 s85, s86, 2176768
buffer_load_dwordx4 v26, s[56:59], s85 offen offset:0 lds
buffer_load_dwordx4 v27, s[56:59], s85 offen offset:1088 lds
buffer_load_dwordx4 v28, s[56:59], s85 offen offset:2176 lds
s_waitcnt vmcnt(44)
buffer_load_dwordx4 v29, s[56:59], s85 offen offset:3264 lds
s_waitcnt vmcnt(48)
s_barrier
s_add_u32 m0, s84, 119872
s_add_u32 s85, s86, 1024
buffer_load_dwordx4 v26, s[56:59], s85 offen offset:0 lds
buffer_load_dwordx4 v27, s[56:59], s85 offen offset:1088 lds
buffer_load_dwordx4 v28, s[56:59], s85 offen offset:2176 lds
buffer_load_dwordx4 v29, s[56:59], s85 offen offset:3264 lds
s_add_u32 m0, s84, 124256
s_add_u32 s85, s86, 6144
buffer_load_dwordx4 v26, s[56:59], s85 offen offset:0 lds
buffer_load_dwordx4 v27, s[56:59], s85 offen offset:1088 lds
buffer_load_dwordx4 v28, s[56:59], s85 offen offset:2176 lds
buffer_load_dwordx4 v29, s[56:59], s85 offen offset:3264 lds
s_add_u32 m0, s84, 61440
s_add_u32 s85, s86, 5898880
buffer_load_dwordx4 v36, s[56:59], s85 offen offset:0 lds
buffer_load_dwordx4 v37, s[56:59], s85 offen offset:1024 lds
buffer_load_dwordx4 v38, s[56:59], s85 offen offset:2048 lds
buffer_load_dwordx4 v39, s[56:59], s85 offen offset:3072 lds
s_add_u32 m0, s84, 65536
s_add_u32 s85, s86, 5939840
buffer_load_dwordx4 v36, s[56:59], s85 offen offset:0 lds
buffer_load_dwordx4 v37, s[56:59], s85 offen offset:1024 lds
buffer_load_dwordx4 v38, s[56:59], s85 offen offset:2048 lds
s_waitcnt vmcnt(44)
buffer_load_dwordx4 v39, s[56:59], s85 offen offset:3072 lds
s_add_u32 m0, s84, 128608
s_add_u32 s85, s86, 41984
buffer_load_dwordx4 v26, s[56:59], s85 offen offset:0 lds
buffer_load_dwordx4 v27, s[56:59], s85 offen offset:1088 lds
buffer_load_dwordx4 v28, s[56:59], s85 offen offset:2176 lds
buffer_load_dwordx4 v29, s[56:59], s85 offen offset:3264 lds
s_add_u32 m0, s84, 132992
s_add_u32 s85, s86, 47104
buffer_load_dwordx4 v26, s[56:59], s85 offen offset:0 lds
buffer_load_dwordx4 v27, s[56:59], s85 offen offset:1088 lds
buffer_load_dwordx4 v28, s[56:59], s85 offen offset:2176 lds
buffer_load_dwordx4 v29, s[56:59], s85 offen offset:3264 lds
s_waitcnt vmcnt(32)
s_barrier
s_add_u32 m0, s84, 146080
s_add_u32 s85, s86, 82944
buffer_load_dwordx4 v26, s[56:59], s85 offen offset:0 lds
buffer_load_dwordx4 v27, s[56:59], s85 offen offset:1088 lds
buffer_load_dwordx4 v28, s[56:59], s85 offen offset:2176 lds
buffer_load_dwordx4 v29, s[56:59], s85 offen offset:3264 lds
s_add_u32 m0, s84, 150464
s_add_u32 s85, s86, 88064
buffer_load_dwordx4 v26, s[56:59], s85 offen offset:0 lds
buffer_load_dwordx4 v27, s[56:59], s85 offen offset:1088 lds
buffer_load_dwordx4 v28, s[56:59], s85 offen offset:2176 lds
s_waitcnt vmcnt(44)
buffer_load_dwordx4 v29, s[56:59], s85 offen offset:3264 lds
s_add_u32 m0, s84, 69632
s_add_u32 s85, s86, 5980800
buffer_load_dwordx4 v36, s[56:59], s85 offen offset:0 lds
buffer_load_dwordx4 v37, s[56:59], s85 offen offset:1024 lds
buffer_load_dwordx4 v38, s[56:59], s85 offen offset:2048 lds
buffer_load_dwordx4 v39, s[56:59], s85 offen offset:3072 lds
s_add_u32 m0, s84, 73728
s_add_u32 s85, s86, 6021760
buffer_load_dwordx4 v36, s[56:59], s85 offen offset:0 lds
buffer_load_dwordx4 v37, s[56:59], s85 offen offset:1024 lds
buffer_load_dwordx4 v38, s[56:59], s85 offen offset:2048 lds
buffer_load_dwordx4 v39, s[56:59], s85 offen offset:3072 lds
s_add_u32 m0, s84, 102400
s_add_u32 s85, s86, 123904
buffer_load_dwordx4 v26, s[56:59], s85 offen offset:0 lds
buffer_load_dwordx4 v27, s[56:59], s85 offen offset:1088 lds
buffer_load_dwordx4 v28, s[56:59], s85 offen offset:2176 lds
buffer_load_dwordx4 v29, s[56:59], s85 offen offset:3264 lds
s_add_u32 m0, s84, 106784
s_add_u32 s85, s86, 129024
buffer_load_dwordx4 v26, s[56:59], s85 offen offset:0 lds
buffer_load_dwordx4 v27, s[56:59], s85 offen offset:1088 lds
buffer_load_dwordx4 v28, s[56:59], s85 offen offset:2176 lds
s_waitcnt vmcnt(44)
buffer_load_dwordx4 v29, s[56:59], s85 offen offset:3264 lds
s_add_u32 m0, s84, 24576
s_add_u32 s85, s86, 164864
buffer_load_dwordx4 v26, s[56:59], s85 offen offset:0 lds
buffer_load_dwordx4 v27, s[56:59], s85 offen offset:1088 lds
buffer_load_dwordx4 v28, s[56:59], s85 offen offset:2176 lds
buffer_load_dwordx4 v29, s[56:59], s85 offen offset:3264 lds
s_add_u32 m0, s84, 28960
s_add_u32 s85, s86, 169984
buffer_load_dwordx4 v26, s[56:59], s85 offen offset:0 lds
buffer_load_dwordx4 v27, s[56:59], s85 offen offset:1088 lds
buffer_load_dwordx4 v28, s[56:59], s85 offen offset:2176 lds
buffer_load_dwordx4 v29, s[56:59], s85 offen offset:3264 lds
s_waitcnt vmcnt(40)
s_barrier
s_add_u32 m0, s84, 53248
s_add_u32 s85, s86, 6062720
buffer_load_dwordx4 v36, s[56:59], s85 offen offset:0 lds
buffer_load_dwordx4 v37, s[56:59], s85 offen offset:1024 lds
buffer_load_dwordx4 v38, s[56:59], s85 offen offset:2048 lds
buffer_load_dwordx4 v39, s[56:59], s85 offen offset:3072 lds
s_add_u32 m0, s84, 57344
s_add_u32 s85, s86, 6103680
buffer_load_dwordx4 v36, s[56:59], s85 offen offset:0 lds
buffer_load_dwordx4 v37, s[56:59], s85 offen offset:1024 lds
buffer_load_dwordx4 v38, s[56:59], s85 offen offset:2048 lds
s_waitcnt vmcnt(44)
buffer_load_dwordx4 v39, s[56:59], s85 offen offset:3072 lds
s_add_u32 m0, s84, 33312
s_add_u32 s85, s86, 205824
buffer_load_dwordx4 v26, s[56:59], s85 offen offset:0 lds
buffer_load_dwordx4 v27, s[56:59], s85 offen offset:1088 lds
buffer_load_dwordx4 v28, s[56:59], s85 offen offset:2176 lds
buffer_load_dwordx4 v29, s[56:59], s85 offen offset:3264 lds
s_add_u32 m0, s84, 37696
s_add_u32 s85, s86, 210944
buffer_load_dwordx4 v26, s[56:59], s85 offen offset:0 lds
buffer_load_dwordx4 v27, s[56:59], s85 offen offset:1088 lds
buffer_load_dwordx4 v28, s[56:59], s85 offen offset:2176 lds
buffer_load_dwordx4 v29, s[56:59], s85 offen offset:3264 lds
s_add_u32 m0, s84, 42048
s_add_u32 s85, s86, 3933184
buffer_load_dwordx4 v26, s[56:59], s85 offen offset:0 lds
buffer_load_dwordx4 v27, s[56:59], s85 offen offset:1088 lds
buffer_load_dwordx4 v28, s[56:59], s85 offen offset:2176 lds
buffer_load_dwordx4 v29, s[56:59], s85 offen offset:3264 lds
s_add_u32 m0, s84, 46432
s_add_u32 s85, s86, 3938304
buffer_load_dwordx4 v26, s[56:59], s85 offen offset:0 lds
buffer_load_dwordx4 v27, s[56:59], s85 offen offset:1088 lds
buffer_load_dwordx4 v28, s[56:59], s85 offen offset:2176 lds
s_waitcnt vmcnt(44)
buffer_load_dwordx4 v29, s[56:59], s85 offen offset:3264 lds
s_waitcnt vmcnt(40)
s_barrier
s_add_u32 m0, s84, 137344
s_add_u32 s85, s86, 3974144
buffer_load_dwordx4 v26, s[56:59], s85 offen offset:0 lds
buffer_load_dwordx4 v27, s[56:59], s85 offen offset:1088 lds
buffer_load_dwordx4 v28, s[56:59], s85 offen offset:2176 lds
buffer_load_dwordx4 v29, s[56:59], s85 offen offset:3264 lds
s_add_u32 m0, s84, 141728
s_add_u32 s85, s86, 3979264
buffer_load_dwordx4 v26, s[56:59], s85 offen offset:0 lds
buffer_load_dwordx4 v27, s[56:59], s85 offen offset:1088 lds
buffer_load_dwordx4 v28, s[56:59], s85 offen offset:2176 lds
buffer_load_dwordx4 v29, s[56:59], s85 offen offset:3264 lds
s_add_u32 m0, s84, 77824
s_add_u32 s85, s86, 5899008
buffer_load_dwordx4 v36, s[56:59], s85 offen offset:0 lds
buffer_load_dwordx4 v37, s[56:59], s85 offen offset:1024 lds
buffer_load_dwordx4 v38, s[56:59], s85 offen offset:2048 lds
buffer_load_dwordx4 v39, s[56:59], s85 offen offset:3072 lds
s_add_u32 m0, s84, 81920
s_add_u32 s85, s86, 5939968
buffer_load_dwordx4 v36, s[56:59], s85 offen offset:0 lds
buffer_load_dwordx4 v37, s[56:59], s85 offen offset:1024 lds
buffer_load_dwordx4 v38, s[56:59], s85 offen offset:2048 lds
s_waitcnt vmcnt(44)
buffer_load_dwordx4 v39, s[56:59], s85 offen offset:3072 lds
s_add_u32 m0, s84, 154816
s_add_u32 s85, s86, 4015104
buffer_load_dwordx4 v26, s[56:59], s85 offen offset:0 lds
buffer_load_dwordx4 v27, s[56:59], s85 offen offset:1088 lds
buffer_load_dwordx4 v28, s[56:59], s85 offen offset:2176 lds
buffer_load_dwordx4 v29, s[56:59], s85 offen offset:3264 lds
s_add_u32 m0, s84, 159200
s_add_u32 s85, s86, 4020224
buffer_load_dwordx4 v26, s[56:59], s85 offen offset:0 lds
buffer_load_dwordx4 v27, s[56:59], s85 offen offset:1088 lds
buffer_load_dwordx4 v28, s[56:59], s85 offen offset:2176 lds
buffer_load_dwordx4 v29, s[56:59], s85 offen offset:3264 lds
s_add_u32 m0, s84, 111136
s_add_u32 s85, s86, 4056064
buffer_load_dwordx4 v26, s[56:59], s85 offen offset:0 lds
buffer_load_dwordx4 v27, s[56:59], s85 offen offset:1088 lds
buffer_load_dwordx4 v28, s[56:59], s85 offen offset:2176 lds
buffer_load_dwordx4 v29, s[56:59], s85 offen offset:3264 lds
s_add_u32 m0, s84, 115520
s_add_u32 s85, s86, 4061184
buffer_load_dwordx4 v26, s[56:59], s85 offen offset:0 lds
buffer_load_dwordx4 v27, s[56:59], s85 offen offset:1088 lds
buffer_load_dwordx4 v28, s[56:59], s85 offen offset:2176 lds
s_waitcnt vmcnt(44)
buffer_load_dwordx4 v29, s[56:59], s85 offen offset:3264 lds
s_waitcnt vmcnt(48)
s_barrier
s_add_u32 m0, s84, 119872
s_add_u32 s85, s86, 4097024
buffer_load_dwordx4 v26, s[56:59], s85 offen offset:0 lds
buffer_load_dwordx4 v27, s[56:59], s85 offen offset:1088 lds
buffer_load_dwordx4 v28, s[56:59], s85 offen offset:2176 lds
buffer_load_dwordx4 v29, s[56:59], s85 offen offset:3264 lds
s_add_u32 m0, s84, 124256
s_add_u32 s85, s86, 4102144
buffer_load_dwordx4 v26, s[56:59], s85 offen offset:0 lds
buffer_load_dwordx4 v27, s[56:59], s85 offen offset:1088 lds
buffer_load_dwordx4 v28, s[56:59], s85 offen offset:2176 lds
buffer_load_dwordx4 v29, s[56:59], s85 offen offset:3264 lds
s_add_u32 m0, s84, 86016
s_add_u32 s85, s86, 5980928
buffer_load_dwordx4 v36, s[56:59], s85 offen offset:0 lds
buffer_load_dwordx4 v37, s[56:59], s85 offen offset:1024 lds
buffer_load_dwordx4 v38, s[56:59], s85 offen offset:2048 lds
buffer_load_dwordx4 v39, s[56:59], s85 offen offset:3072 lds
s_add_u32 m0, s84, 90112
s_add_u32 s85, s86, 6021888
buffer_load_dwordx4 v36, s[56:59], s85 offen offset:0 lds
buffer_load_dwordx4 v37, s[56:59], s85 offen offset:1024 lds
buffer_load_dwordx4 v38, s[56:59], s85 offen offset:2048 lds
s_waitcnt vmcnt(44)
buffer_load_dwordx4 v39, s[56:59], s85 offen offset:3072 lds
s_add_u32 m0, s84, 94208
s_add_u32 s85, s86, 6062848
buffer_load_dwordx4 v36, s[56:59], s85 offen offset:0 lds
buffer_load_dwordx4 v37, s[56:59], s85 offen offset:1024 lds
buffer_load_dwordx4 v38, s[56:59], s85 offen offset:2048 lds
buffer_load_dwordx4 v39, s[56:59], s85 offen offset:3072 lds
s_add_u32 m0, s84, 98304
s_add_u32 s85, s86, 6103808
buffer_load_dwordx4 v36, s[56:59], s85 offen offset:0 lds
buffer_load_dwordx4 v37, s[56:59], s85 offen offset:1024 lds
buffer_load_dwordx4 v38, s[56:59], s85 offen offset:2048 lds
buffer_load_dwordx4 v39, s[56:59], s85 offen offset:3072 lds
s_add_u32 m0, s84, 128608
s_add_u32 s85, s86, 4137984
buffer_load_dwordx4 v26, s[56:59], s85 offen offset:0 lds
buffer_load_dwordx4 v27, s[56:59], s85 offen offset:1088 lds
buffer_load_dwordx4 v28, s[56:59], s85 offen offset:2176 lds
buffer_load_dwordx4 v29, s[56:59], s85 offen offset:3264 lds
s_add_u32 m0, s84, 132992
s_add_u32 s85, s86, 4143104
buffer_load_dwordx4 v26, s[56:59], s85 offen offset:0 lds
buffer_load_dwordx4 v27, s[56:59], s85 offen offset:1088 lds
buffer_load_dwordx4 v28, s[56:59], s85 offen offset:2176 lds
s_waitcnt vmcnt(44)
buffer_load_dwordx4 v29, s[56:59], s85 offen offset:3264 lds
s_waitcnt vmcnt(48)
s_barrier
s_add_u32 m0, s84, 146080
s_add_u32 s85, s86, 1967104
buffer_load_dwordx4 v26, s[56:59], s85 offen offset:0 lds
buffer_load_dwordx4 v27, s[56:59], s85 offen offset:1088 lds
buffer_load_dwordx4 v28, s[56:59], s85 offen offset:2176 lds
buffer_load_dwordx4 v29, s[56:59], s85 offen offset:3264 lds
s_add_u32 m0, s84, 150464
s_add_u32 s85, s86, 1972224
buffer_load_dwordx4 v26, s[56:59], s85 offen offset:0 lds
buffer_load_dwordx4 v27, s[56:59], s85 offen offset:1088 lds
buffer_load_dwordx4 v28, s[56:59], s85 offen offset:2176 lds
buffer_load_dwordx4 v29, s[56:59], s85 offen offset:3264 lds
s_add_u32 m0, s84, 102400
s_add_u32 s85, s86, 2008064
buffer_load_dwordx4 v26, s[56:59], s85 offen offset:0 lds
buffer_load_dwordx4 v27, s[56:59], s85 offen offset:1088 lds
buffer_load_dwordx4 v28, s[56:59], s85 offen offset:2176 lds
buffer_load_dwordx4 v29, s[56:59], s85 offen offset:3264 lds
s_add_u32 m0, s84, 106784
s_add_u32 s85, s86, 2013184
buffer_load_dwordx4 v26, s[56:59], s85 offen offset:0 lds
buffer_load_dwordx4 v27, s[56:59], s85 offen offset:1088 lds
buffer_load_dwordx4 v28, s[56:59], s85 offen offset:2176 lds
s_waitcnt vmcnt(44)
buffer_load_dwordx4 v29, s[56:59], s85 offen offset:3264 lds
s_waitcnt vmcnt(24)
s_barrier
s_add_u32 m0, s84, 61440
s_add_u32 s85, s86, 5899136
buffer_load_dwordx4 v36, s[56:59], s85 offen offset:0 lds
buffer_load_dwordx4 v37, s[56:59], s85 offen offset:1024 lds
buffer_load_dwordx4 v38, s[56:59], s85 offen offset:2048 lds
buffer_load_dwordx4 v39, s[56:59], s85 offen offset:3072 lds
s_add_u32 m0, s84, 65536
s_add_u32 s85, s86, 5940096
buffer_load_dwordx4 v36, s[56:59], s85 offen offset:0 lds
buffer_load_dwordx4 v37, s[56:59], s85 offen offset:1024 lds
buffer_load_dwordx4 v38, s[56:59], s85 offen offset:2048 lds
buffer_load_dwordx4 v39, s[56:59], s85 offen offset:3072 lds
s_add_u32 m0, s84, 69632
s_add_u32 s85, s86, 5981056
buffer_load_dwordx4 v36, s[56:59], s85 offen offset:0 lds
buffer_load_dwordx4 v37, s[56:59], s85 offen offset:1024 lds
buffer_load_dwordx4 v38, s[56:59], s85 offen offset:2048 lds
buffer_load_dwordx4 v39, s[56:59], s85 offen offset:3072 lds
s_add_u32 m0, s84, 73728
s_add_u32 s85, s86, 6022016
buffer_load_dwordx4 v36, s[56:59], s85 offen offset:0 lds
buffer_load_dwordx4 v37, s[56:59], s85 offen offset:1024 lds
buffer_load_dwordx4 v38, s[56:59], s85 offen offset:2048 lds
s_waitcnt vmcnt(44)
buffer_load_dwordx4 v39, s[56:59], s85 offen offset:3072 lds
s_waitcnt vmcnt(8)
s_barrier
s_add_u32 m0, s84, 137344
s_add_u32 s85, s86, 2049024
buffer_load_dwordx4 v26, s[56:59], s85 offen offset:0 lds
buffer_load_dwordx4 v27, s[56:59], s85 offen offset:1088 lds
buffer_load_dwordx4 v28, s[56:59], s85 offen offset:2176 lds
buffer_load_dwordx4 v29, s[56:59], s85 offen offset:3264 lds
s_add_u32 m0, s84, 141728
s_add_u32 s85, s86, 2054144
buffer_load_dwordx4 v26, s[56:59], s85 offen offset:0 lds
buffer_load_dwordx4 v27, s[56:59], s85 offen offset:1088 lds
buffer_load_dwordx4 v28, s[56:59], s85 offen offset:2176 lds
buffer_load_dwordx4 v29, s[56:59], s85 offen offset:3264 lds
s_add_u32 m0, s84, 154816
s_add_u32 s85, s86, 2089984
buffer_load_dwordx4 v26, s[56:59], s85 offen offset:0 lds
buffer_load_dwordx4 v27, s[56:59], s85 offen offset:1088 lds
buffer_load_dwordx4 v28, s[56:59], s85 offen offset:2176 lds
buffer_load_dwordx4 v29, s[56:59], s85 offen offset:3264 lds
s_add_u32 m0, s84, 159200
s_add_u32 s85, s86, 2095104
buffer_load_dwordx4 v26, s[56:59], s85 offen offset:0 lds
buffer_load_dwordx4 v27, s[56:59], s85 offen offset:1088 lds
buffer_load_dwordx4 v28, s[56:59], s85 offen offset:2176 lds
s_waitcnt vmcnt(44)
buffer_load_dwordx4 v29, s[56:59], s85 offen offset:3264 lds
s_add_u32 m0, s84, 111136
s_add_u32 s85, s86, 2130944
buffer_load_dwordx4 v26, s[56:59], s85 offen offset:0 lds
buffer_load_dwordx4 v27, s[56:59], s85 offen offset:1088 lds
buffer_load_dwordx4 v28, s[56:59], s85 offen offset:2176 lds
buffer_load_dwordx4 v29, s[56:59], s85 offen offset:3264 lds
s_add_u32 m0, s84, 115520
s_add_u32 s85, s86, 2136064
buffer_load_dwordx4 v26, s[56:59], s85 offen offset:0 lds
buffer_load_dwordx4 v27, s[56:59], s85 offen offset:1088 lds
buffer_load_dwordx4 v28, s[56:59], s85 offen offset:2176 lds
buffer_load_dwordx4 v29, s[56:59], s85 offen offset:3264 lds
s_waitcnt vmcnt(0)
s_barrier
s_add_u32 m0, s84, 146080
s_add_u32 s85, s86, 2171904
buffer_load_dwordx4 v26, s[56:59], s85 offen offset:0 lds
buffer_load_dwordx4 v27, s[56:59], s85 offen offset:1088 lds
buffer_load_dwordx4 v28, s[56:59], s85 offen offset:2176 lds
buffer_load_dwordx4 v29, s[56:59], s85 offen offset:3264 lds
s_add_u32 m0, s84, 150464
s_add_u32 s85, s86, 2177024
buffer_load_dwordx4 v26, s[56:59], s85 offen offset:0 lds
buffer_load_dwordx4 v27, s[56:59], s85 offen offset:1088 lds
buffer_load_dwordx4 v28, s[56:59], s85 offen offset:2176 lds
s_waitcnt vmcnt(44)
buffer_load_dwordx4 v29, s[56:59], s85 offen offset:3264 lds
s_add_u32 m0, s84, 119872
s_add_u32 s85, s86, 5899264
buffer_load_dwordx4 v26, s[56:59], s85 offen offset:0 lds
buffer_load_dwordx4 v27, s[56:59], s85 offen offset:1088 lds
buffer_load_dwordx4 v28, s[56:59], s85 offen offset:2176 lds
buffer_load_dwordx4 v29, s[56:59], s85 offen offset:3264 lds
s_add_u32 m0, s84, 124256
s_add_u32 s85, s86, 5904384
buffer_load_dwordx4 v26, s[56:59], s85 offen offset:0 lds
buffer_load_dwordx4 v27, s[56:59], s85 offen offset:1088 lds
buffer_load_dwordx4 v28, s[56:59], s85 offen offset:2176 lds
buffer_load_dwordx4 v29, s[56:59], s85 offen offset:3264 lds
s_add_u32 m0, s84, 77824
s_add_u32 s85, s86, 6062976
buffer_load_dwordx4 v36, s[56:59], s85 offen offset:0 lds
buffer_load_dwordx4 v37, s[56:59], s85 offen offset:1024 lds
buffer_load_dwordx4 v38, s[56:59], s85 offen offset:2048 lds
buffer_load_dwordx4 v39, s[56:59], s85 offen offset:3072 lds
s_add_u32 m0, s84, 81920
s_add_u32 s85, s86, 6103936
buffer_load_dwordx4 v36, s[56:59], s85 offen offset:0 lds
buffer_load_dwordx4 v37, s[56:59], s85 offen offset:1024 lds
buffer_load_dwordx4 v38, s[56:59], s85 offen offset:2048 lds
s_waitcnt vmcnt(44)
buffer_load_dwordx4 v39, s[56:59], s85 offen offset:3072 lds
s_add_u32 m0, s84, 128608
s_add_u32 s85, s86, 5940224
buffer_load_dwordx4 v26, s[56:59], s85 offen offset:0 lds
buffer_load_dwordx4 v27, s[56:59], s85 offen offset:1088 lds
buffer_load_dwordx4 v28, s[56:59], s85 offen offset:2176 lds
buffer_load_dwordx4 v29, s[56:59], s85 offen offset:3264 lds
s_add_u32 m0, s84, 132992
s_add_u32 s85, s86, 5945344
buffer_load_dwordx4 v26, s[56:59], s85 offen offset:0 lds
buffer_load_dwordx4 v27, s[56:59], s85 offen offset:1088 lds
buffer_load_dwordx4 v28, s[56:59], s85 offen offset:2176 lds
buffer_load_dwordx4 v29, s[56:59], s85 offen offset:3264 lds
s_waitcnt vmcnt(8)
s_barrier
s_add_u32 m0, s84, 137344
s_add_u32 s85, s86, 5981184
buffer_load_dwordx4 v26, s[56:59], s85 offen offset:0 lds
buffer_load_dwordx4 v27, s[56:59], s85 offen offset:1088 lds
buffer_load_dwordx4 v28, s[56:59], s85 offen offset:2176 lds
buffer_load_dwordx4 v29, s[56:59], s85 offen offset:3264 lds
s_add_u32 m0, s84, 141728
s_add_u32 s85, s86, 5986304
buffer_load_dwordx4 v26, s[56:59], s85 offen offset:0 lds
buffer_load_dwordx4 v27, s[56:59], s85 offen offset:1088 lds
buffer_load_dwordx4 v28, s[56:59], s85 offen offset:2176 lds
s_waitcnt vmcnt(44)
buffer_load_dwordx4 v29, s[56:59], s85 offen offset:3264 lds
s_add_u32 m0, s84, 154816
s_add_u32 s85, s86, 6022144
buffer_load_dwordx4 v26, s[56:59], s85 offen offset:0 lds
buffer_load_dwordx4 v27, s[56:59], s85 offen offset:1088 lds
buffer_load_dwordx4 v28, s[56:59], s85 offen offset:2176 lds
buffer_load_dwordx4 v29, s[56:59], s85 offen offset:3264 lds
s_add_u32 m0, s84, 159200
s_add_u32 s85, s86, 6027264
buffer_load_dwordx4 v26, s[56:59], s85 offen offset:0 lds
buffer_load_dwordx4 v27, s[56:59], s85 offen offset:1088 lds
buffer_load_dwordx4 v28, s[56:59], s85 offen offset:2176 lds
buffer_load_dwordx4 v29, s[56:59], s85 offen offset:3264 lds
s_add_u32 m0, s84, 102400
s_add_u32 s85, s86, 6063104
buffer_load_dwordx4 v26, s[56:59], s85 offen offset:0 lds
buffer_load_dwordx4 v27, s[56:59], s85 offen offset:1088 lds
buffer_load_dwordx4 v28, s[56:59], s85 offen offset:2176 lds
buffer_load_dwordx4 v29, s[56:59], s85 offen offset:3264 lds
s_add_u32 m0, s84, 106784
s_add_u32 s85, s86, 6068224
buffer_load_dwordx4 v26, s[56:59], s85 offen offset:0 lds
buffer_load_dwordx4 v27, s[56:59], s85 offen offset:1088 lds
buffer_load_dwordx4 v28, s[56:59], s85 offen offset:2176 lds
s_waitcnt vmcnt(44)
buffer_load_dwordx4 v29, s[56:59], s85 offen offset:3264 lds
s_waitcnt vmcnt(8)
s_barrier
s_add_u32 m0, s84, 146080
s_add_u32 s85, s86, 6104064
buffer_load_dwordx4 v26, s[56:59], s85 offen offset:0 lds
buffer_load_dwordx4 v27, s[56:59], s85 offen offset:1088 lds
buffer_load_dwordx4 v28, s[56:59], s85 offen offset:2176 lds
buffer_load_dwordx4 v29, s[56:59], s85 offen offset:3264 lds
s_add_u32 m0, s84, 150464
s_add_u32 s85, s86, 6109184
buffer_load_dwordx4 v26, s[56:59], s85 offen offset:0 lds
buffer_load_dwordx4 v27, s[56:59], s85 offen offset:1088 lds
buffer_load_dwordx4 v28, s[56:59], s85 offen offset:2176 lds
buffer_load_dwordx4 v29, s[56:59], s85 offen offset:3264 lds
s_waitcnt vmcnt(0)
s_barrier
s_waitcnt vmcnt(0)
s_barrier
v_mov_b32 v7, 3
s_mov_b64 exec, 1
buffer_store_dword v7, v2, s[48:51], s99 offen sc1
s_mov_b64 exec, -1
v_mbcnt_lo_u32_b32 v4, -1, 0
v_mbcnt_hi_u32_b32 v4, -1, v4
s_lshl_b32 s88, s64, 4
s_add_u32 s88, s88, s65
s_mul_i32 s88, s88, 983040
s_mul_i32 s73, s66, 3072
s_add_u32 s88, s88, s73
v_lshlrev_b32 v2, 4, v4
v_and_b32 v3, 15, v4
v_mul_u32_u24 v3, 2560, v3
v_lshrrev_b32 v4, 4, v4
v_lshl_add_u32 v3, v4, 3, v3
s_mul_i32 s80, s65, 245760
s_mul_i32 s69, s64, 1280
s_add_u32 s80, s80, s69
s_mov_b32 s73, 0
s_mov_b64 exec, 0xff
L_pollb:
buffer_load_dword v4, v6, s[48:51], s99 offen sc1
s_waitcnt vmcnt(0)
v_cmp_ne_u32 vcc, 3, v4
s_add_u32 s73, s73, 1
s_cbranch_vccz L_poll_doneb
s_cmp_lt_u32 s73, 200000
s_cbranch_scc1 L_pollb
L_poll_doneb:
s_mov_b64 exec, -1
s_branch L_red3
L_xy:
s_mov_b32 s72, 0x3dd53b95
s_mov_b32 s77, 0x43800000
s_cmp_ge_u32 s67, 4
s_cbranch_scc1 L_y_start
s_mov_b32 s74, 0
s_mov_b32 s75, 49152
s_and_b32 s68, s67, 3
s_lshl_b32 s68, s68, 12
s_add_u32 s68, s68, 0
s_mov_b32 s69, 73728
v_and_b32 v14, 31, v0
v_bfe_u32 v15, v0, 1, 3
v_mul_u32_u24 v14, 128, v14
v_add_u32 v14, s68, v14
v_lshrrev_b32 v1, 5, v0
v_add_u32 v1, 0, v1
v_xor_b32 v1, v1, v15
v_lshl_add_u32 v2, v1, 4, v14
v_lshrrev_b32 v1, 5, v0
v_add_u32 v1, 2, v1
v_xor_b32 v1, v1, v15
v_lshl_add_u32 v3, v1, 4, v14
v_lshrrev_b32 v1, 5, v0
v_add_u32 v1, 4, v1
v_xor_b32 v1, v1, v15
v_lshl_add_u32 v4, v1, 4, v14
v_lshrrev_b32 v1, 5, v0
v_add_u32 v1, 6, v1
v_xor_b32 v1, v1, v15
v_lshl_add_u32 v5, v1, 4, v14
v_lshrrev_b32 v14, 5, v0
v_bfe_u32 v15, v0, 2, 2
v_lshl_add_u32 v14, v14, 3, v15
v_mul_u32_u24 v14, 384, v14
v_bfe_u32 v15, v0, 4, 1
v_lshrrev_b32 v1, 5, v0
v_xor_b32 v15, v15, v1
v_lshl_add_u32 v14, v15, 5, v14
v_and_b32 v15, 1, v0
v_lshl_add_u32 v14, v15, 4, v14
v_bfe_u32 v15, v0, 1, 1
v_lshl_add_u32 v14, v15, 3, v14
v_add_u32 v14, s69, v14
v_bfe_u32 v15, v0, 3, 1
v_lshlrev_b32 v15, 6, v15
v_add_u32 v6, v14, v15
v_sub_u32 v7, v14, v15
s_barrier
ds_read_b128 v[24:27], v2 offset:0
ds_read_b64_tr_b16 v[112:113], v6 offset:0
ds_read_b64_tr_b16 v[114:115], v6 offset:1536
ds_read_b64_tr_b16 v[116:117], v7 offset:64
ds_read_b64_tr_b16 v[118:119], v7 offset:1600
ds_read_b64_tr_b16 v[120:121], v6 offset:128
ds_read_b64_tr_b16 v[122:123], v6 offset:1664
ds_read_b64_tr_b16 v[124:125], v7 offset:192
ds_read_b64_tr_b16 v[126:127], v7 offset:1728
ds_read_b64_tr_b16 v[128:129], v6 offset:256
ds_read_b64_tr_b16 v[130:131], v6 offset:1792
ds_read_b64_tr_b16 v[132:133], v7 offset:320
ds_read_b64_tr_b16 v[134:135], v7 offset:1856
s_waitcnt lgkmcnt(10)
v_mfma_f32_32x32x16_bf16 v[160:175], v[112:115], v[24:27], 0
ds_read_b128 v[28:31], v3 offset:0
ds_read_b64_tr_b16 v[136:137], v6 offset:6144
ds_read_b64_tr_b16 v[138:139], v6 offset:7680
s_waitcnt lgkmcnt(11)
v_mfma_f32_32x32x16_bf16 v[176:191], v[116:119], v[24:27], 0
ds_read_b64_tr_b16 v[140:141], v7 offset:6208
ds_read_b64_tr_b16 v[142:143], v7 offset:7744
s_waitcnt lgkmcnt(11)
v_mfma_f32_32x32x16_bf16 v[192:207], v[120:123], v[24:27], 0
ds_read_b64_tr_b16 v[144:145], v6 offset:6272
ds_read_b64_tr_b16 v[146:147], v6 offset:7808
s_waitcnt lgkmcnt(11)
v_mfma_f32_32x32x16_bf16 v[208:223], v[124:127], v[24:27], 0
ds_read_b64_tr_b16 v[148:149], v7 offset:6336
ds_read_b64_tr_b16 v[150:151], v7 offset:7872
s_waitcnt lgkmcnt(11)
v_mfma_f32_32x32x16_bf16 v[224:239], v[128:131], v[24:27], 0
ds_read_b64_tr_b16 v[152:153], v6 offset:6400
ds_read_b64_tr_b16 v[154:155], v6 offset:7936
s_waitcnt lgkmcnt(11)
v_mfma_f32_32x32x16_bf16 v[240:255], v[132:135], v[24:27], 0
ds_read_b64_tr_b16 v[156:157], v7 offset:6464
ds_read_b64_tr_b16 v[158:159], v7 offset:8000
s_waitcnt lgkmcnt(10)
v_mfma_f32_32x32x16_bf16 v[160:175], v[136:139], v[28:31], v[160:175]
s_barrier
ds_read_b128 v[32:35], v4 offset:0
ds_read_b64_tr_b16 v[112:113], v6 offset:12288
ds_read_b64_tr_b16 v[114:115], v6 offset:13824
s_waitcnt lgkmcnt(11)
v_mfma_f32_32x32x16_bf16 v[176:191], v[140:143], v[28:31], v[176:191]
ds_read_b64_tr_b16 v[116:117], v7 offset:12352
ds_read_b64_tr_b16 v[118:119], v7 offset:13888
s_waitcnt lgkmcnt(11)
v_mfma_f32_32x32x16_bf16 v[192:207], v[144:147], v[28:31], v[192:207]
ds_read_b64_tr_b16 v[120:121], v6 offset:12416
ds_read_b64_tr_b16 v[122:123], v6 offset:13952
s_waitcnt lgkmcnt(11)
v_mfma_f32_32x32x16_bf16 v[208:223], v[148:151], v[28:31], v[208:223]
ds_read_b64_tr_b16 v[124:125], v7 offset:12480
ds_read_b64_tr_b16 v[126:127], v7 offset:14016
s_waitcnt lgkmcnt(11)
v_mfma_f32_32x32x16_bf16 v[224:239], v[152:155], v[28:31], v[224:239]
ds_read_b64_tr_b16 v[128:129], v6 offset:12544
ds_read_b64_tr_b16 v[130:131], v6 offset:14080
s_waitcnt lgkmcnt(11)
v_mfma_f32_32x32x16_bf16 v[240:255], v[156:159], v[28:31], v[240:255]
ds_read_b64_tr_b16 v[132:133], v7 offset:12608
ds_read_b64_tr_b16 v[134:135], v7 offset:14144
s_waitcnt lgkmcnt(10)
v_mfma_f32_32x32x16_bf16 v[160:175], v[112:115], v[32:35], v[160:175]
ds_read_b128 v[36:39], v5 offset:0
ds_read_b64_tr_b16 v[136:137], v6 offset:18432
ds_read_b64_tr_b16 v[138:139], v6 offset:19968
s_waitcnt lgkmcnt(11)
v_mfma_f32_32x32x16_bf16 v[176:191], v[116:119], v[32:35], v[176:191]
ds_read_b64_tr_b16 v[140:141], v7 offset:18496
ds_read_b64_tr_b16 v[142:143], v7 offset:20032
s_waitcnt lgkmcnt(11)
v_mfma_f32_32x32x16_bf16 v[192:207], v[120:123], v[32:35], v[192:207]
ds_read_b64_tr_b16 v[144:145], v6 offset:18560
ds_read_b64_tr_b16 v[146:147], v6 offset:20096
s_waitcnt lgkmcnt(11)
v_mfma_f32_32x32x16_bf16 v[208:223], v[124:127], v[32:35], v[208:223]
ds_read_b64_tr_b16 v[148:149], v7 offset:18624
ds_read_b64_tr_b16 v[150:151], v7 offset:20160
s_waitcnt lgkmcnt(11)
v_mfma_f32_32x32x16_bf16 v[224:239], v[128:131], v[32:35], v[224:239]
ds_read_b64_tr_b16 v[152:153], v6 offset:18688
ds_read_b64_tr_b16 v[154:155], v6 offset:20224
s_waitcnt lgkmcnt(11)
v_mfma_f32_32x32x16_bf16 v[240:255], v[132:135], v[32:35], v[240:255]
ds_read_b64_tr_b16 v[156:157], v7 offset:18752
ds_read_b64_tr_b16 v[158:159], v7 offset:20288
s_waitcnt lgkmcnt(10)
v_mfma_f32_32x32x16_bf16 v[160:175], v[136:139], v[36:39], v[160:175]
s_barrier
ds_read_b128 v[24:27], v2 offset:12288
ds_read_b64_tr_b16 v[112:113], v6 offset:24576
ds_read_b64_tr_b16 v[114:115], v6 offset:26112
s_waitcnt lgkmcnt(11)
v_mfma_f32_32x32x16_bf16 v[176:191], v[140:143], v[36:39], v[176:191]
ds_read_b64_tr_b16 v[116:117], v7 offset:24640
ds_read_b64_tr_b16 v[118:119], v7 offset:26176
s_waitcnt lgkmcnt(11)
v_mfma_f32_32x32x16_bf16 v[192:207], v[144:147], v[36:39], v[192:207]
ds_read_b64_tr_b16 v[120:121], v6 offset:24704
ds_read_b64_tr_b16 v[122:123], v6 offset:26240
s_waitcnt lgkmcnt(11)
v_mfma_f32_32x32x16_bf16 v[208:223], v[148:151], v[36:39], v[208:223]
ds_read_b64_tr_b16 v[124:125], v7 offset:24768
ds_read_b64_tr_b16 v[126:127], v7 offset:26304
s_waitcnt lgkmcnt(11)
v_mfma_f32_32x32x16_bf16 v[224:239], v[152:155], v[36:39], v[224:239]
ds_read_b64_tr_b16 v[128:129], v6 offset:24832
ds_read_b64_tr_b16 v[130:131], v6 offset:26368
s_waitcnt lgkmcnt(11)
v_mfma_f32_32x32x16_bf16 v[240:255], v[156:159], v[36:39], v[240:255]
ds_read_b64_tr_b16 v[132:133], v7 offset:24896
ds_read_b64_tr_b16 v[134:135], v7 offset:26432
s_waitcnt lgkmcnt(10)
v_mfma_f32_32x32x16_bf16 v[160:175], v[112:115], v[24:27], v[160:175]
ds_read_b128 v[28:31], v3 offset:12288
ds_read_b64_tr_b16 v[136:137], v6 offset:30720
ds_read_b64_tr_b16 v[138:139], v6 offset:32256
s_waitcnt lgkmcnt(11)
v_mfma_f32_32x32x16_bf16 v[176:191], v[116:119], v[24:27], v[176:191]
ds_read_b64_tr_b16 v[140:141], v7 offset:30784
ds_read_b64_tr_b16 v[142:143], v7 offset:32320
s_waitcnt lgkmcnt(11)
v_mfma_f32_32x32x16_bf16 v[192:207], v[120:123], v[24:27], v[192:207]
ds_read_b64_tr_b16 v[144:145], v6 offset:30848
ds_read_b64_tr_b16 v[146:147], v6 offset:32384
s_waitcnt lgkmcnt(11)
v_mfma_f32_32x32x16_bf16 v[208:223], v[124:127], v[24:27], v[208:223]
ds_read_b64_tr_b16 v[148:149], v7 offset:30912
ds_read_b64_tr_b16 v[150:151], v7 offset:32448
s_waitcnt lgkmcnt(11)
v_mfma_f32_32x32x16_bf16 v[224:239], v[128:131], v[24:27], v[224:239]
ds_read_b64_tr_b16 v[152:153], v6 offset:30976
ds_read_b64_tr_b16 v[154:155], v6 offset:32512
s_waitcnt lgkmcnt(11)
v_mfma_f32_32x32x16_bf16 v[240:255], v[132:135], v[24:27], v[240:255]
ds_read_b64_tr_b16 v[156:157], v7 offset:31040
ds_read_b64_tr_b16 v[158:159], v7 offset:32576
s_waitcnt lgkmcnt(10)
v_mfma_f32_32x32x16_bf16 v[160:175], v[136:139], v[28:31], v[160:175]
s_barrier
ds_read_b128 v[32:35], v4 offset:12288
ds_read_b64_tr_b16 v[112:113], v6 offset:36864
ds_read_b64_tr_b16 v[114:115], v6 offset:38400
s_waitcnt lgkmcnt(11)
v_mfma_f32_32x32x16_bf16 v[176:191], v[140:143], v[28:31], v[176:191]
ds_read_b64_tr_b16 v[116:117], v7 offset:36928
ds_read_b64_tr_b16 v[118:119], v7 offset:38464
s_waitcnt lgkmcnt(11)
v_mfma_f32_32x32x16_bf16 v[192:207], v[144:147], v[28:31], v[192:207]
ds_read_b64_tr_b16 v[120:121], v6 offset:36992
ds_read_b64_tr_b16 v[122:123], v6 offset:38528
s_waitcnt lgkmcnt(11)
v_mfma_f32_32x32x16_bf16 v[208:223], v[148:151], v[28:31], v[208:223]
ds_read_b64_tr_b16 v[124:125], v7 offset:37056
ds_read_b64_tr_b16 v[126:127], v7 offset:38592
s_waitcnt lgkmcnt(11)
v_mfma_f32_32x32x16_bf16 v[224:239], v[152:155], v[28:31], v[224:239]
ds_read_b64_tr_b16 v[128:129], v6 offset:37120
ds_read_b64_tr_b16 v[130:131], v6 offset:38656
s_waitcnt lgkmcnt(11)
v_mfma_f32_32x32x16_bf16 v[240:255], v[156:159], v[28:31], v[240:255]
ds_read_b64_tr_b16 v[132:133], v7 offset:37184
ds_read_b64_tr_b16 v[134:135], v7 offset:38720
s_waitcnt lgkmcnt(10)
v_mfma_f32_32x32x16_bf16 v[160:175], v[112:115], v[32:35], v[160:175]
ds_read_b128 v[36:39], v5 offset:12288
ds_read_b64_tr_b16 v[136:137], v6 offset:43008
ds_read_b64_tr_b16 v[138:139], v6 offset:44544
s_waitcnt lgkmcnt(11)
v_mfma_f32_32x32x16_bf16 v[176:191], v[116:119], v[32:35], v[176:191]
ds_read_b64_tr_b16 v[140:141], v7 offset:43072
ds_read_b64_tr_b16 v[142:143], v7 offset:44608
s_waitcnt lgkmcnt(11)
v_mfma_f32_32x32x16_bf16 v[192:207], v[120:123], v[32:35], v[192:207]
ds_read_b64_tr_b16 v[144:145], v6 offset:43136
ds_read_b64_tr_b16 v[146:147], v6 offset:44672
s_waitcnt lgkmcnt(11)
v_mfma_f32_32x32x16_bf16 v[208:223], v[124:127], v[32:35], v[208:223]
ds_read_b64_tr_b16 v[148:149], v7 offset:43200
ds_read_b64_tr_b16 v[150:151], v7 offset:44736
s_waitcnt lgkmcnt(11)
v_mfma_f32_32x32x16_bf16 v[224:239], v[128:131], v[32:35], v[224:239]
ds_read_b64_tr_b16 v[152:153], v6 offset:43264
ds_read_b64_tr_b16 v[154:155], v6 offset:44800
s_waitcnt lgkmcnt(11)
v_mfma_f32_32x32x16_bf16 v[240:255], v[132:135], v[32:35], v[240:255]
ds_read_b64_tr_b16 v[156:157], v7 offset:43328
ds_read_b64_tr_b16 v[158:159], v7 offset:44864
s_waitcnt lgkmcnt(10)
v_mfma_f32_32x32x16_bf16 v[160:175], v[136:139], v[36:39], v[160:175]
s_barrier
ds_read_b128 v[24:27], v2 offset:24576
ds_read_b64_tr_b16 v[112:113], v6 offset:49152
ds_read_b64_tr_b16 v[114:115], v6 offset:50688
s_waitcnt lgkmcnt(11)
v_mfma_f32_32x32x16_bf16 v[176:191], v[140:143], v[36:39], v[176:191]
ds_read_b64_tr_b16 v[116:117], v7 offset:49216
ds_read_b64_tr_b16 v[118:119], v7 offset:50752
s_waitcnt lgkmcnt(11)
v_mfma_f32_32x32x16_bf16 v[192:207], v[144:147], v[36:39], v[192:207]
ds_read_b64_tr_b16 v[120:121], v6 offset:49280
ds_read_b64_tr_b16 v[122:123], v6 offset:50816
s_waitcnt lgkmcnt(11)
v_mfma_f32_32x32x16_bf16 v[208:223], v[148:151], v[36:39], v[208:223]
ds_read_b64_tr_b16 v[124:125], v7 offset:49344
ds_read_b64_tr_b16 v[126:127], v7 offset:50880
s_waitcnt lgkmcnt(11)
v_mfma_f32_32x32x16_bf16 v[224:239], v[152:155], v[36:39], v[224:239]
ds_read_b64_tr_b16 v[128:129], v6 offset:49408
ds_read_b64_tr_b16 v[130:131], v6 offset:50944
s_waitcnt lgkmcnt(11)
v_mfma_f32_32x32x16_bf16 v[240:255], v[156:159], v[36:39], v[240:255]
ds_read_b64_tr_b16 v[132:133], v7 offset:49472
ds_read_b64_tr_b16 v[134:135], v7 offset:51008
s_waitcnt lgkmcnt(10)
v_mfma_f32_32x32x16_bf16 v[160:175], v[112:115], v[24:27], v[160:175]
ds_read_b128 v[28:31], v3 offset:24576
ds_read_b64_tr_b16 v[136:137], v6 offset:55296
ds_read_b64_tr_b16 v[138:139], v6 offset:56832
s_waitcnt lgkmcnt(11)
v_mfma_f32_32x32x16_bf16 v[176:191], v[116:119], v[24:27], v[176:191]
ds_read_b64_tr_b16 v[140:141], v7 offset:55360
ds_read_b64_tr_b16 v[142:143], v7 offset:56896
s_waitcnt lgkmcnt(11)
v_mfma_f32_32x32x16_bf16 v[192:207], v[120:123], v[24:27], v[192:207]
ds_read_b64_tr_b16 v[144:145], v6 offset:55424
ds_read_b64_tr_b16 v[146:147], v6 offset:56960
s_waitcnt lgkmcnt(11)
v_mfma_f32_32x32x16_bf16 v[208:223], v[124:127], v[24:27], v[208:223]
ds_read_b64_tr_b16 v[148:149], v7 offset:55488
ds_read_b64_tr_b16 v[150:151], v7 offset:57024
s_waitcnt lgkmcnt(11)
v_mfma_f32_32x32x16_bf16 v[224:239], v[128:131], v[24:27], v[224:239]
ds_read_b64_tr_b16 v[152:153], v6 offset:55552
ds_read_b64_tr_b16 v[154:155], v6 offset:57088
s_waitcnt lgkmcnt(11)
v_mfma_f32_32x32x16_bf16 v[240:255], v[132:135], v[24:27], v[240:255]
ds_read_b64_tr_b16 v[156:157], v7 offset:55616
ds_read_b64_tr_b16 v[158:159], v7 offset:57152
s_waitcnt lgkmcnt(10)
v_mfma_f32_32x32x16_bf16 v[160:175], v[136:139], v[28:31], v[160:175]
s_barrier
ds_read_b128 v[32:35], v4 offset:24576
ds_read_b64_tr_b16 v[112:113], v6 offset:0
ds_read_b64_tr_b16 v[114:115], v6 offset:1536
s_waitcnt lgkmcnt(11)
v_mfma_f32_32x32x16_bf16 v[176:191], v[140:143], v[28:31], v[176:191]
ds_read_b64_tr_b16 v[116:117], v7 offset:64
ds_read_b64_tr_b16 v[118:119], v7 offset:1600
s_waitcnt lgkmcnt(11)
v_mfma_f32_32x32x16_bf16 v[192:207], v[144:147], v[28:31], v[192:207]
ds_read_b64_tr_b16 v[120:121], v6 offset:128
ds_read_b64_tr_b16 v[122:123], v6 offset:1664
s_waitcnt lgkmcnt(11)
v_mfma_f32_32x32x16_bf16 v[208:223], v[148:151], v[28:31], v[208:223]
ds_read_b64_tr_b16 v[124:125], v7 offset:192
ds_read_b64_tr_b16 v[126:127], v7 offset:1728
s_waitcnt lgkmcnt(11)
v_mfma_f32_32x32x16_bf16 v[224:239], v[152:155], v[28:31], v[224:239]
ds_read_b64_tr_b16 v[128:129], v6 offset:256
ds_read_b64_tr_b16 v[130:131], v6 offset:1792
s_waitcnt lgkmcnt(11)
v_mfma_f32_32x32x16_bf16 v[240:255], v[156:159], v[28:31], v[240:255]
ds_read_b64_tr_b16 v[132:133], v7 offset:320
ds_read_b64_tr_b16 v[134:135], v7 offset:1856
s_waitcnt lgkmcnt(10)
v_mfma_f32_32x32x16_bf16 v[160:175], v[112:115], v[32:35], v[160:175]
ds_read_b128 v[36:39], v5 offset:24576
ds_read_b64_tr_b16 v[136:137], v6 offset:6144
ds_read_b64_tr_b16 v[138:139], v6 offset:7680
s_waitcnt lgkmcnt(11)
v_mfma_f32_32x32x16_bf16 v[176:191], v[116:119], v[32:35], v[176:191]
ds_read_b64_tr_b16 v[140:141], v7 offset:6208
ds_read_b64_tr_b16 v[142:143], v7 offset:7744
s_waitcnt lgkmcnt(11)
v_mfma_f32_32x32x16_bf16 v[192:207], v[120:123], v[32:35], v[192:207]
ds_read_b64_tr_b16 v[144:145], v6 offset:6272
ds_read_b64_tr_b16 v[146:147], v6 offset:7808
s_waitcnt lgkmcnt(11)
v_mfma_f32_32x32x16_bf16 v[208:223], v[124:127], v[32:35], v[208:223]
ds_read_b64_tr_b16 v[148:149], v7 offset:6336
ds_read_b64_tr_b16 v[150:151], v7 offset:7872
s_waitcnt lgkmcnt(11)
v_mfma_f32_32x32x16_bf16 v[224:239], v[128:131], v[32:35], v[224:239]
ds_read_b64_tr_b16 v[152:153], v6 offset:6400
ds_read_b64_tr_b16 v[154:155], v6 offset:7936
s_waitcnt lgkmcnt(11)
v_mfma_f32_32x32x16_bf16 v[240:255], v[132:135], v[32:35], v[240:255]
ds_read_b64_tr_b16 v[156:157], v7 offset:6464
ds_read_b64_tr_b16 v[158:159], v7 offset:8000
s_waitcnt lgkmcnt(10)
v_mfma_f32_32x32x16_bf16 v[160:175], v[136:139], v[36:39], v[160:175]
s_barrier
ds_read_b128 v[24:27], v2 offset:36864
ds_read_b64_tr_b16 v[112:113], v6 offset:12288
ds_read_b64_tr_b16 v[114:115], v6 offset:13824
s_waitcnt lgkmcnt(11)
v_mfma_f32_32x32x16_bf16 v[176:191], v[140:143], v[36:39], v[176:191]
ds_read_b64_tr_b16 v[116:117], v7 offset:12352
ds_read_b64_tr_b16 v[118:119], v7 offset:13888
s_waitcnt lgkmcnt(11)
v_mfma_f32_32x32x16_bf16 v[192:207], v[144:147], v[36:39], v[192:207]
ds_read_b64_tr_b16 v[120:121], v6 offset:12416
ds_read_b64_tr_b16 v[122:123], v6 offset:13952
s_waitcnt lgkmcnt(11)
v_mfma_f32_32x32x16_bf16 v[208:223], v[148:151], v[36:39], v[208:223]
ds_read_b64_tr_b16 v[124:125], v7 offset:12480
ds_read_b64_tr_b16 v[126:127], v7 offset:14016
s_waitcnt lgkmcnt(11)
v_mfma_f32_32x32x16_bf16 v[224:239], v[152:155], v[36:39], v[224:239]
ds_read_b64_tr_b16 v[128:129], v6 offset:12544
ds_read_b64_tr_b16 v[130:131], v6 offset:14080
s_waitcnt lgkmcnt(11)
v_mfma_f32_32x32x16_bf16 v[240:255], v[156:159], v[36:39], v[240:255]
ds_read_b64_tr_b16 v[132:133], v7 offset:12608
ds_read_b64_tr_b16 v[134:135], v7 offset:14144
s_waitcnt lgkmcnt(10)
v_mfma_f32_32x32x16_bf16 v[160:175], v[112:115], v[24:27], v[160:175]
ds_read_b128 v[28:31], v3 offset:36864
ds_read_b64_tr_b16 v[136:137], v6 offset:18432
ds_read_b64_tr_b16 v[138:139], v6 offset:19968
s_waitcnt lgkmcnt(11)
v_mfma_f32_32x32x16_bf16 v[176:191], v[116:119], v[24:27], v[176:191]
ds_read_b64_tr_b16 v[140:141], v7 offset:18496
ds_read_b64_tr_b16 v[142:143], v7 offset:20032
s_waitcnt lgkmcnt(11)
v_mfma_f32_32x32x16_bf16 v[192:207], v[120:123], v[24:27], v[192:207]
ds_read_b64_tr_b16 v[144:145], v6 offset:18560
ds_read_b64_tr_b16 v[146:147], v6 offset:20096
s_waitcnt lgkmcnt(11)
v_mfma_f32_32x32x16_bf16 v[208:223], v[124:127], v[24:27], v[208:223]
ds_read_b64_tr_b16 v[148:149], v7 offset:18624
ds_read_b64_tr_b16 v[150:151], v7 offset:20160
s_waitcnt lgkmcnt(11)
v_mfma_f32_32x32x16_bf16 v[224:239], v[128:131], v[24:27], v[224:239]
ds_read_b64_tr_b16 v[152:153], v6 offset:18688
ds_read_b64_tr_b16 v[154:155], v6 offset:20224
s_waitcnt lgkmcnt(11)
v_mfma_f32_32x32x16_bf16 v[240:255], v[132:135], v[24:27], v[240:255]
ds_read_b64_tr_b16 v[156:157], v7 offset:18752
ds_read_b64_tr_b16 v[158:159], v7 offset:20288
s_waitcnt lgkmcnt(10)
v_mfma_f32_32x32x16_bf16 v[160:175], v[136:139], v[28:31], v[160:175]
s_barrier
ds_read_b128 v[32:35], v4 offset:36864
ds_read_b64_tr_b16 v[112:113], v6 offset:24576
ds_read_b64_tr_b16 v[114:115], v6 offset:26112
s_waitcnt lgkmcnt(11)
v_mfma_f32_32x32x16_bf16 v[176:191], v[140:143], v[28:31], v[176:191]
ds_read_b64_tr_b16 v[116:117], v7 offset:24640
ds_read_b64_tr_b16 v[118:119], v7 offset:26176
s_waitcnt lgkmcnt(11)
v_mfma_f32_32x32x16_bf16 v[192:207], v[144:147], v[28:31], v[192:207]
ds_read_b64_tr_b16 v[120:121], v6 offset:24704
ds_read_b64_tr_b16 v[122:123], v6 offset:26240
s_waitcnt lgkmcnt(11)
v_mfma_f32_32x32x16_bf16 v[208:223], v[148:151], v[28:31], v[208:223]
ds_read_b64_tr_b16 v[124:125], v7 offset:24768
ds_read_b64_tr_b16 v[126:127], v7 offset:26304
s_waitcnt lgkmcnt(11)
v_mfma_f32_32x32x16_bf16 v[224:239], v[152:155], v[28:31], v[224:239]
ds_read_b64_tr_b16 v[128:129], v6 offset:24832
ds_read_b64_tr_b16 v[130:131], v6 offset:26368
s_waitcnt lgkmcnt(11)
v_mfma_f32_32x32x16_bf16 v[240:255], v[156:159], v[28:31], v[240:255]
ds_read_b64_tr_b16 v[132:133], v7 offset:24896
ds_read_b64_tr_b16 v[134:135], v7 offset:26432
s_waitcnt lgkmcnt(10)
v_mfma_f32_32x32x16_bf16 v[160:175], v[112:115], v[32:35], v[160:175]
ds_read_b128 v[36:39], v5 offset:36864
ds_read_b64_tr_b16 v[136:137], v6 offset:30720
ds_read_b64_tr_b16 v[138:139], v6 offset:32256
s_waitcnt lgkmcnt(11)
v_mfma_f32_32x32x16_bf16 v[176:191], v[116:119], v[32:35], v[176:191]
ds_read_b64_tr_b16 v[140:141], v7 offset:30784
ds_read_b64_tr_b16 v[142:143], v7 offset:32320
s_waitcnt lgkmcnt(11)
v_mfma_f32_32x32x16_bf16 v[192:207], v[120:123], v[32:35], v[192:207]
ds_read_b64_tr_b16 v[144:145], v6 offset:30848
ds_read_b64_tr_b16 v[146:147], v6 offset:32384
s_waitcnt lgkmcnt(11)
v_mfma_f32_32x32x16_bf16 v[208:223], v[124:127], v[32:35], v[208:223]
ds_read_b64_tr_b16 v[148:149], v7 offset:30912
ds_read_b64_tr_b16 v[150:151], v7 offset:32448
s_waitcnt lgkmcnt(11)
v_mfma_f32_32x32x16_bf16 v[224:239], v[128:131], v[32:35], v[224:239]
ds_read_b64_tr_b16 v[152:153], v6 offset:30976
ds_read_b64_tr_b16 v[154:155], v6 offset:32512
s_waitcnt lgkmcnt(11)
v_mfma_f32_32x32x16_bf16 v[240:255], v[132:135], v[32:35], v[240:255]
ds_read_b64_tr_b16 v[156:157], v7 offset:31040
ds_read_b64_tr_b16 v[158:159], v7 offset:32576
s_waitcnt lgkmcnt(10)
v_mfma_f32_32x32x16_bf16 v[160:175], v[136:139], v[36:39], v[160:175]
s_barrier
ds_read_b128 v[24:27], v2 offset:49152
ds_read_b64_tr_b16 v[112:113], v6 offset:36864
ds_read_b64_tr_b16 v[114:115], v6 offset:38400
s_waitcnt lgkmcnt(11)
v_mfma_f32_32x32x16_bf16 v[176:191], v[140:143], v[36:39], v[176:191]
ds_read_b64_tr_b16 v[116:117], v7 offset:36928
ds_read_b64_tr_b16 v[118:119], v7 offset:38464
s_waitcnt lgkmcnt(11)
v_mfma_f32_32x32x16_bf16 v[192:207], v[144:147], v[36:39], v[192:207]
ds_read_b64_tr_b16 v[120:121], v6 offset:36992
ds_read_b64_tr_b16 v[122:123], v6 offset:38528
s_waitcnt lgkmcnt(11)
v_mfma_f32_32x32x16_bf16 v[208:223], v[148:151], v[36:39], v[208:223]
ds_read_b64_tr_b16 v[124:125], v7 offset:37056
ds_read_b64_tr_b16 v[126:127], v7 offset:38592
s_waitcnt lgkmcnt(11)
v_mfma_f32_32x32x16_bf16 v[224:239], v[152:155], v[36:39], v[224:239]
ds_read_b64_tr_b16 v[128:129], v6 offset:37120
ds_read_b64_tr_b16 v[130:131], v6 offset:38656
s_waitcnt lgkmcnt(11)
v_mfma_f32_32x32x16_bf16 v[240:255], v[156:159], v[36:39], v[240:255]
ds_read_b64_tr_b16 v[132:133], v7 offset:37184
ds_read_b64_tr_b16 v[134:135], v7 offset:38720
s_waitcnt lgkmcnt(10)
v_mfma_f32_32x32x16_bf16 v[160:175], v[112:115], v[24:27], v[160:175]
ds_read_b128 v[28:31], v3 offset:49152
ds_read_b64_tr_b16 v[136:137], v6 offset:43008
ds_read_b64_tr_b16 v[138:139], v6 offset:44544
s_waitcnt lgkmcnt(11)
v_mfma_f32_32x32x16_bf16 v[176:191], v[116:119], v[24:27], v[176:191]
ds_read_b64_tr_b16 v[140:141], v7 offset:43072
ds_read_b64_tr_b16 v[142:143], v7 offset:44608
s_waitcnt lgkmcnt(11)
v_mfma_f32_32x32x16_bf16 v[192:207], v[120:123], v[24:27], v[192:207]
ds_read_b64_tr_b16 v[144:145], v6 offset:43136
ds_read_b64_tr_b16 v[146:147], v6 offset:44672
s_waitcnt lgkmcnt(11)
v_mfma_f32_32x32x16_bf16 v[208:223], v[124:127], v[24:27], v[208:223]
ds_read_b64_tr_b16 v[148:149], v7 offset:43200
ds_read_b64_tr_b16 v[150:151], v7 offset:44736
s_waitcnt lgkmcnt(11)
v_mfma_f32_32x32x16_bf16 v[224:239], v[128:131], v[24:27], v[224:239]
ds_read_b64_tr_b16 v[152:153], v6 offset:43264
ds_read_b64_tr_b16 v[154:155], v6 offset:44800
s_waitcnt lgkmcnt(11)
v_mfma_f32_32x32x16_bf16 v[240:255], v[132:135], v[24:27], v[240:255]
ds_read_b64_tr_b16 v[156:157], v7 offset:43328
ds_read_b64_tr_b16 v[158:159], v7 offset:44864
s_waitcnt lgkmcnt(10)
v_mfma_f32_32x32x16_bf16 v[160:175], v[136:139], v[28:31], v[160:175]
s_barrier
ds_read_b128 v[32:35], v4 offset:49152
ds_read_b64_tr_b16 v[112:113], v6 offset:49152
ds_read_b64_tr_b16 v[114:115], v6 offset:50688
s_waitcnt lgkmcnt(11)
v_mfma_f32_32x32x16_bf16 v[176:191], v[140:143], v[28:31], v[176:191]
ds_read_b64_tr_b16 v[116:117], v7 offset:49216
ds_read_b64_tr_b16 v[118:119], v7 offset:50752
s_waitcnt lgkmcnt(11)
v_mfma_f32_32x32x16_bf16 v[192:207], v[144:147], v[28:31], v[192:207]
ds_read_b64_tr_b16 v[120:121], v6 offset:49280
ds_read_b64_tr_b16 v[122:123], v6 offset:50816
s_waitcnt lgkmcnt(11)
v_mfma_f32_32x32x16_bf16 v[208:223], v[148:151], v[28:31], v[208:223]
ds_read_b64_tr_b16 v[124:125], v7 offset:49344
ds_read_b64_tr_b16 v[126:127], v7 offset:50880
s_waitcnt lgkmcnt(11)
v_mfma_f32_32x32x16_bf16 v[224:239], v[152:155], v[28:31], v[224:239]
ds_read_b64_tr_b16 v[128:129], v6 offset:49408
ds_read_b64_tr_b16 v[130:131], v6 offset:50944
s_waitcnt lgkmcnt(11)
v_mfma_f32_32x32x16_bf16 v[240:255], v[156:159], v[28:31], v[240:255]
ds_read_b64_tr_b16 v[132:133], v7 offset:49472
ds_read_b64_tr_b16 v[134:135], v7 offset:51008
s_waitcnt lgkmcnt(10)
v_mfma_f32_32x32x16_bf16 v[160:175], v[112:115], v[32:35], v[160:175]
ds_read_b128 v[36:39], v5 offset:49152
ds_read_b64_tr_b16 v[136:137], v6 offset:55296
ds_read_b64_tr_b16 v[138:139], v6 offset:56832
s_waitcnt lgkmcnt(11)
v_mfma_f32_32x32x16_bf16 v[176:191], v[116:119], v[32:35], v[176:191]
ds_read_b64_tr_b16 v[140:141], v7 offset:55360
ds_read_b64_tr_b16 v[142:143], v7 offset:56896
s_waitcnt lgkmcnt(11)
v_mfma_f32_32x32x16_bf16 v[192:207], v[120:123], v[32:35], v[192:207]
ds_read_b64_tr_b16 v[144:145], v6 offset:55424
ds_read_b64_tr_b16 v[146:147], v6 offset:56960
s_waitcnt lgkmcnt(11)
v_mfma_f32_32x32x16_bf16 v[208:223], v[124:127], v[32:35], v[208:223]
ds_read_b64_tr_b16 v[148:149], v7 offset:55488
ds_read_b64_tr_b16 v[150:151], v7 offset:57024
s_waitcnt lgkmcnt(11)
v_mfma_f32_32x32x16_bf16 v[224:239], v[128:131], v[32:35], v[224:239]
ds_read_b64_tr_b16 v[152:153], v6 offset:55552
ds_read_b64_tr_b16 v[154:155], v6 offset:57088
s_waitcnt lgkmcnt(11)
v_mfma_f32_32x32x16_bf16 v[240:255], v[132:135], v[32:35], v[240:255]
ds_read_b64_tr_b16 v[156:157], v7 offset:55616
ds_read_b64_tr_b16 v[158:159], v7 offset:57152
s_waitcnt lgkmcnt(10)
v_mfma_f32_32x32x16_bf16 v[160:175], v[136:139], v[36:39], v[160:175]
s_barrier
ds_read_b128 v[24:27], v2 offset:61440
ds_read_b64_tr_b16 v[112:113], v6 offset:0
ds_read_b64_tr_b16 v[114:115], v6 offset:1536
s_waitcnt lgkmcnt(11)
v_mfma_f32_32x32x16_bf16 v[176:191], v[140:143], v[36:39], v[176:191]
ds_read_b64_tr_b16 v[116:117], v7 offset:64
ds_read_b64_tr_b16 v[118:119], v7 offset:1600
s_waitcnt lgkmcnt(11)
v_mfma_f32_32x32x16_bf16 v[192:207], v[144:147], v[36:39], v[192:207]
ds_read_b64_tr_b16 v[120:121], v6 offset:128
ds_read_b64_tr_b16 v[122:123], v6 offset:1664
s_waitcnt lgkmcnt(11)
v_mfma_f32_32x32x16_bf16 v[208:223], v[148:151], v[36:39], v[208:223]
ds_read_b64_tr_b16 v[124:125], v7 offset:192
ds_read_b64_tr_b16 v[126:127], v7 offset:1728
s_waitcnt lgkmcnt(11)
v_mfma_f32_32x32x16_bf16 v[224:239], v[152:155], v[36:39], v[224:239]
ds_read_b64_tr_b16 v[128:129], v6 offset:256
ds_read_b64_tr_b16 v[130:131], v6 offset:1792
s_waitcnt lgkmcnt(11)
v_mfma_f32_32x32x16_bf16 v[240:255], v[156:159], v[36:39], v[240:255]
ds_read_b64_tr_b16 v[132:133], v7 offset:320
ds_read_b64_tr_b16 v[134:135], v7 offset:1856
s_waitcnt lgkmcnt(10)
v_mfma_f32_32x32x16_bf16 v[160:175], v[112:115], v[24:27], v[160:175]
ds_read_b128 v[28:31], v3 offset:61440
ds_read_b64_tr_b16 v[136:137], v6 offset:6144
ds_read_b64_tr_b16 v[138:139], v6 offset:7680
s_waitcnt lgkmcnt(11)
v_mfma_f32_32x32x16_bf16 v[176:191], v[116:119], v[24:27], v[176:191]
ds_read_b64_tr_b16 v[140:141], v7 offset:6208
ds_read_b64_tr_b16 v[142:143], v7 offset:7744
s_waitcnt lgkmcnt(11)
v_mfma_f32_32x32x16_bf16 v[192:207], v[120:123], v[24:27], v[192:207]
ds_read_b64_tr_b16 v[144:145], v6 offset:6272
ds_read_b64_tr_b16 v[146:147], v6 offset:7808
s_waitcnt lgkmcnt(11)
v_mfma_f32_32x32x16_bf16 v[208:223], v[124:127], v[24:27], v[208:223]
ds_read_b64_tr_b16 v[148:149], v7 offset:6336
ds_read_b64_tr_b16 v[150:151], v7 offset:7872
s_waitcnt lgkmcnt(11)
v_mfma_f32_32x32x16_bf16 v[224:239], v[128:131], v[24:27], v[224:239]
ds_read_b64_tr_b16 v[152:153], v6 offset:6400
ds_read_b64_tr_b16 v[154:155], v6 offset:7936
s_waitcnt lgkmcnt(11)
v_mfma_f32_32x32x16_bf16 v[240:255], v[132:135], v[24:27], v[240:255]
ds_read_b64_tr_b16 v[156:157], v7 offset:6464
ds_read_b64_tr_b16 v[158:159], v7 offset:8000
s_waitcnt lgkmcnt(10)
v_mfma_f32_32x32x16_bf16 v[160:175], v[136:139], v[28:31], v[160:175]
s_barrier
ds_read_b128 v[32:35], v4 offset:61440
ds_read_b64_tr_b16 v[112:113], v6 offset:12288
ds_read_b64_tr_b16 v[114:115], v6 offset:13824
s_waitcnt lgkmcnt(11)
v_mfma_f32_32x32x16_bf16 v[176:191], v[140:143], v[28:31], v[176:191]
ds_read_b64_tr_b16 v[116:117], v7 offset:12352
ds_read_b64_tr_b16 v[118:119], v7 offset:13888
s_waitcnt lgkmcnt(11)
v_mfma_f32_32x32x16_bf16 v[192:207], v[144:147], v[28:31], v[192:207]
ds_read_b64_tr_b16 v[120:121], v6 offset:12416
ds_read_b64_tr_b16 v[122:123], v6 offset:13952
s_waitcnt lgkmcnt(11)
v_mfma_f32_32x32x16_bf16 v[208:223], v[148:151], v[28:31], v[208:223]
ds_read_b64_tr_b16 v[124:125], v7 offset:12480
ds_read_b64_tr_b16 v[126:127], v7 offset:14016
s_waitcnt lgkmcnt(11)
v_mfma_f32_32x32x16_bf16 v[224:239], v[152:155], v[28:31], v[224:239]
ds_read_b64_tr_b16 v[128:129], v6 offset:12544
ds_read_b64_tr_b16 v[130:131], v6 offset:14080
s_waitcnt lgkmcnt(11)
v_mfma_f32_32x32x16_bf16 v[240:255], v[156:159], v[28:31], v[240:255]
ds_read_b64_tr_b16 v[132:133], v7 offset:12608
ds_read_b64_tr_b16 v[134:135], v7 offset:14144
s_waitcnt lgkmcnt(10)
v_mfma_f32_32x32x16_bf16 v[160:175], v[112:115], v[32:35], v[160:175]
ds_read_b128 v[36:39], v5 offset:61440
ds_read_b64_tr_b16 v[136:137], v6 offset:18432
ds_read_b64_tr_b16 v[138:139], v6 offset:19968
s_waitcnt lgkmcnt(11)
v_mfma_f32_32x32x16_bf16 v[176:191], v[116:119], v[32:35], v[176:191]
ds_read_b64_tr_b16 v[140:141], v7 offset:18496
ds_read_b64_tr_b16 v[142:143], v7 offset:20032
s_waitcnt lgkmcnt(11)
v_mfma_f32_32x32x16_bf16 v[192:207], v[120:123], v[32:35], v[192:207]
ds_read_b64_tr_b16 v[144:145], v6 offset:18560
ds_read_b64_tr_b16 v[146:147], v6 offset:20096
s_waitcnt lgkmcnt(11)
v_mfma_f32_32x32x16_bf16 v[208:223], v[124:127], v[32:35], v[208:223]
ds_read_b64_tr_b16 v[148:149], v7 offset:18624
ds_read_b64_tr_b16 v[150:151], v7 offset:20160
s_waitcnt lgkmcnt(11)
v_mfma_f32_32x32x16_bf16 v[224:239], v[128:131], v[32:35], v[224:239]
ds_read_b64_tr_b16 v[152:153], v6 offset:18688
ds_read_b64_tr_b16 v[154:155], v6 offset:20224
s_waitcnt lgkmcnt(11)
v_mfma_f32_32x32x16_bf16 v[240:255], v[132:135], v[32:35], v[240:255]
ds_read_b64_tr_b16 v[156:157], v7 offset:18752
ds_read_b64_tr_b16 v[158:159], v7 offset:20288
s_waitcnt lgkmcnt(10)
v_mfma_f32_32x32x16_bf16 v[160:175], v[136:139], v[36:39], v[160:175]
s_barrier
ds_read_b128 v[24:27], v2 offset:0
ds_read_b64_tr_b16 v[112:113], v6 offset:24576
ds_read_b64_tr_b16 v[114:115], v6 offset:26112
s_waitcnt lgkmcnt(11)
v_mfma_f32_32x32x16_bf16 v[176:191], v[140:143], v[36:39], v[176:191]
ds_read_b64_tr_b16 v[116:117], v7 offset:24640
ds_read_b64_tr_b16 v[118:119], v7 offset:26176
s_waitcnt lgkmcnt(11)
v_mfma_f32_32x32x16_bf16 v[192:207], v[144:147], v[36:39], v[192:207]
ds_read_b64_tr_b16 v[120:121], v6 offset:24704
ds_read_b64_tr_b16 v[122:123], v6 offset:26240
s_waitcnt lgkmcnt(11)
v_mfma_f32_32x32x16_bf16 v[208:223], v[148:151], v[36:39], v[208:223]
ds_read_b64_tr_b16 v[124:125], v7 offset:24768
ds_read_b64_tr_b16 v[126:127], v7 offset:26304
s_waitcnt lgkmcnt(11)
v_mfma_f32_32x32x16_bf16 v[224:239], v[152:155], v[36:39], v[224:239]
ds_read_b64_tr_b16 v[128:129], v6 offset:24832
ds_read_b64_tr_b16 v[130:131], v6 offset:26368
s_waitcnt lgkmcnt(11)
v_mfma_f32_32x32x16_bf16 v[240:255], v[156:159], v[36:39], v[240:255]
ds_read_b64_tr_b16 v[132:133], v7 offset:24896
ds_read_b64_tr_b16 v[134:135], v7 offset:26432
s_waitcnt lgkmcnt(10)
v_mfma_f32_32x32x16_bf16 v[160:175], v[112:115], v[24:27], v[160:175]
ds_read_b128 v[28:31], v3 offset:0
ds_read_b64_tr_b16 v[136:137], v6 offset:30720
ds_read_b64_tr_b16 v[138:139], v6 offset:32256
s_waitcnt lgkmcnt(11)
v_mfma_f32_32x32x16_bf16 v[176:191], v[116:119], v[24:27], v[176:191]
ds_read_b64_tr_b16 v[140:141], v7 offset:30784
ds_read_b64_tr_b16 v[142:143], v7 offset:32320
s_waitcnt lgkmcnt(11)
v_mfma_f32_32x32x16_bf16 v[192:207], v[120:123], v[24:27], v[192:207]
ds_read_b64_tr_b16 v[144:145], v6 offset:30848
ds_read_b64_tr_b16 v[146:147], v6 offset:32384
s_waitcnt lgkmcnt(11)
v_mfma_f32_32x32x16_bf16 v[208:223], v[124:127], v[24:27], v[208:223]
ds_read_b64_tr_b16 v[148:149], v7 offset:30912
ds_read_b64_tr_b16 v[150:151], v7 offset:32448
s_waitcnt lgkmcnt(11)
v_mfma_f32_32x32x16_bf16 v[224:239], v[128:131], v[24:27], v[224:239]
ds_read_b64_tr_b16 v[152:153], v6 offset:30976
ds_read_b64_tr_b16 v[154:155], v6 offset:32512
s_waitcnt lgkmcnt(11)
v_mfma_f32_32x32x16_bf16 v[240:255], v[132:135], v[24:27], v[240:255]
ds_read_b64_tr_b16 v[156:157], v7 offset:31040
ds_read_b64_tr_b16 v[158:159], v7 offset:32576
s_waitcnt lgkmcnt(10)
v_mfma_f32_32x32x16_bf16 v[160:175], v[136:139], v[28:31], v[160:175]
s_barrier
ds_read_b128 v[32:35], v4 offset:0
ds_read_b64_tr_b16 v[112:113], v6 offset:36864
ds_read_b64_tr_b16 v[114:115], v6 offset:38400
s_waitcnt lgkmcnt(11)
v_mfma_f32_32x32x16_bf16 v[176:191], v[140:143], v[28:31], v[176:191]
ds_read_b64_tr_b16 v[116:117], v7 offset:36928
ds_read_b64_tr_b16 v[118:119], v7 offset:38464
s_waitcnt lgkmcnt(11)
v_mfma_f32_32x32x16_bf16 v[192:207], v[144:147], v[28:31], v[192:207]
ds_read_b64_tr_b16 v[120:121], v6 offset:36992
ds_read_b64_tr_b16 v[122:123], v6 offset:38528
s_waitcnt lgkmcnt(11)
v_mfma_f32_32x32x16_bf16 v[208:223], v[148:151], v[28:31], v[208:223]
ds_read_b64_tr_b16 v[124:125], v7 offset:37056
ds_read_b64_tr_b16 v[126:127], v7 offset:38592
s_waitcnt lgkmcnt(11)
v_mfma_f32_32x32x16_bf16 v[224:239], v[152:155], v[28:31], v[224:239]
ds_read_b64_tr_b16 v[128:129], v6 offset:37120
ds_read_b64_tr_b16 v[130:131], v6 offset:38656
s_waitcnt lgkmcnt(11)
v_mfma_f32_32x32x16_bf16 v[240:255], v[156:159], v[28:31], v[240:255]
ds_read_b64_tr_b16 v[132:133], v7 offset:37184
ds_read_b64_tr_b16 v[134:135], v7 offset:38720
s_waitcnt lgkmcnt(10)
v_mfma_f32_32x32x16_bf16 v[160:175], v[112:115], v[32:35], v[160:175]
ds_read_b128 v[36:39], v5 offset:0
ds_read_b64_tr_b16 v[136:137], v6 offset:43008
ds_read_b64_tr_b16 v[138:139], v6 offset:44544
s_waitcnt lgkmcnt(11)
v_mfma_f32_32x32x16_bf16 v[176:191], v[116:119], v[32:35], v[176:191]
ds_read_b64_tr_b16 v[140:141], v7 offset:43072
ds_read_b64_tr_b16 v[142:143], v7 offset:44608
s_waitcnt lgkmcnt(11)
v_mfma_f32_32x32x16_bf16 v[192:207], v[120:123], v[32:35], v[192:207]
ds_read_b64_tr_b16 v[144:145], v6 offset:43136
ds_read_b64_tr_b16 v[146:147], v6 offset:44672
s_waitcnt lgkmcnt(11)
v_mfma_f32_32x32x16_bf16 v[208:223], v[124:127], v[32:35], v[208:223]
ds_read_b64_tr_b16 v[148:149], v7 offset:43200
ds_read_b64_tr_b16 v[150:151], v7 offset:44736
s_waitcnt lgkmcnt(11)
v_mfma_f32_32x32x16_bf16 v[224:239], v[128:131], v[32:35], v[224:239]
ds_read_b64_tr_b16 v[152:153], v6 offset:43264
ds_read_b64_tr_b16 v[154:155], v6 offset:44800
s_waitcnt lgkmcnt(11)
v_mfma_f32_32x32x16_bf16 v[240:255], v[132:135], v[32:35], v[240:255]
ds_read_b64_tr_b16 v[156:157], v7 offset:43328
ds_read_b64_tr_b16 v[158:159], v7 offset:44864
s_waitcnt lgkmcnt(10)
v_mfma_f32_32x32x16_bf16 v[160:175], v[136:139], v[36:39], v[160:175]
s_barrier
ds_read_b128 v[24:27], v2 offset:12288
ds_read_b64_tr_b16 v[112:113], v6 offset:49152
ds_read_b64_tr_b16 v[114:115], v6 offset:50688
s_waitcnt lgkmcnt(11)
v_mfma_f32_32x32x16_bf16 v[176:191], v[140:143], v[36:39], v[176:191]
ds_read_b64_tr_b16 v[116:117], v7 offset:49216
ds_read_b64_tr_b16 v[118:119], v7 offset:50752
s_waitcnt lgkmcnt(11)
v_mfma_f32_32x32x16_bf16 v[192:207], v[144:147], v[36:39], v[192:207]
ds_read_b64_tr_b16 v[120:121], v6 offset:49280
ds_read_b64_tr_b16 v[122:123], v6 offset:50816
s_waitcnt lgkmcnt(11)
v_mfma_f32_32x32x16_bf16 v[208:223], v[148:151], v[36:39], v[208:223]
ds_read_b64_tr_b16 v[124:125], v7 offset:49344
ds_read_b64_tr_b16 v[126:127], v7 offset:50880
s_waitcnt lgkmcnt(11)
v_mfma_f32_32x32x16_bf16 v[224:239], v[152:155], v[36:39], v[224:239]
ds_read_b64_tr_b16 v[128:129], v6 offset:49408
ds_read_b64_tr_b16 v[130:131], v6 offset:50944
s_waitcnt lgkmcnt(11)
v_mfma_f32_32x32x16_bf16 v[240:255], v[156:159], v[36:39], v[240:255]
ds_read_b64_tr_b16 v[132:133], v7 offset:49472
ds_read_b64_tr_b16 v[134:135], v7 offset:51008
s_waitcnt lgkmcnt(10)
v_mfma_f32_32x32x16_bf16 v[160:175], v[112:115], v[24:27], v[160:175]
ds_read_b128 v[28:31], v3 offset:12288
ds_read_b64_tr_b16 v[136:137], v6 offset:55296
ds_read_b64_tr_b16 v[138:139], v6 offset:56832
s_waitcnt lgkmcnt(11)
v_mfma_f32_32x32x16_bf16 v[176:191], v[116:119], v[24:27], v[176:191]
ds_read_b64_tr_b16 v[140:141], v7 offset:55360
ds_read_b64_tr_b16 v[142:143], v7 offset:56896
s_waitcnt lgkmcnt(11)
v_mfma_f32_32x32x16_bf16 v[192:207], v[120:123], v[24:27], v[192:207]
ds_read_b64_tr_b16 v[144:145], v6 offset:55424
ds_read_b64_tr_b16 v[146:147], v6 offset:56960
s_waitcnt lgkmcnt(11)
v_mfma_f32_32x32x16_bf16 v[208:223], v[124:127], v[24:27], v[208:223]
ds_read_b64_tr_b16 v[148:149], v7 offset:55488
ds_read_b64_tr_b16 v[150:151], v7 offset:57024
s_waitcnt lgkmcnt(11)
v_mfma_f32_32x32x16_bf16 v[224:239], v[128:131], v[24:27], v[224:239]
ds_read_b64_tr_b16 v[152:153], v6 offset:55552
ds_read_b64_tr_b16 v[154:155], v6 offset:57088
s_waitcnt lgkmcnt(11)
v_mfma_f32_32x32x16_bf16 v[240:255], v[132:135], v[24:27], v[240:255]
ds_read_b64_tr_b16 v[156:157], v7 offset:55616
ds_read_b64_tr_b16 v[158:159], v7 offset:57152
s_waitcnt lgkmcnt(10)
v_mfma_f32_32x32x16_bf16 v[160:175], v[136:139], v[28:31], v[160:175]
s_barrier
ds_read_b128 v[32:35], v4 offset:12288
ds_read_b64_tr_b16 v[112:113], v6 offset:0
ds_read_b64_tr_b16 v[114:115], v6 offset:1536
s_waitcnt lgkmcnt(11)
v_mfma_f32_32x32x16_bf16 v[176:191], v[140:143], v[28:31], v[176:191]
ds_read_b64_tr_b16 v[116:117], v7 offset:64
ds_read_b64_tr_b16 v[118:119], v7 offset:1600
s_waitcnt lgkmcnt(11)
v_mfma_f32_32x32x16_bf16 v[192:207], v[144:147], v[28:31], v[192:207]
ds_read_b64_tr_b16 v[120:121], v6 offset:128
ds_read_b64_tr_b16 v[122:123], v6 offset:1664
s_waitcnt lgkmcnt(11)
v_mfma_f32_32x32x16_bf16 v[208:223], v[148:151], v[28:31], v[208:223]
ds_read_b64_tr_b16 v[124:125], v7 offset:192
ds_read_b64_tr_b16 v[126:127], v7 offset:1728
s_waitcnt lgkmcnt(11)
v_mfma_f32_32x32x16_bf16 v[224:239], v[152:155], v[28:31], v[224:239]
ds_read_b64_tr_b16 v[128:129], v6 offset:256
ds_read_b64_tr_b16 v[130:131], v6 offset:1792
s_waitcnt lgkmcnt(11)
v_mfma_f32_32x32x16_bf16 v[240:255], v[156:159], v[28:31], v[240:255]
ds_read_b64_tr_b16 v[132:133], v7 offset:320
ds_read_b64_tr_b16 v[134:135], v7 offset:1856
s_waitcnt lgkmcnt(10)
v_mfma_f32_32x32x16_bf16 v[160:175], v[112:115], v[32:35], v[160:175]
ds_read_b128 v[36:39], v5 offset:12288
ds_read_b64_tr_b16 v[136:137], v6 offset:6144
ds_read_b64_tr_b16 v[138:139], v6 offset:7680
s_waitcnt lgkmcnt(11)
v_mfma_f32_32x32x16_bf16 v[176:191], v[116:119], v[32:35], v[176:191]
ds_read_b64_tr_b16 v[140:141], v7 offset:6208
ds_read_b64_tr_b16 v[142:143], v7 offset:7744
s_waitcnt lgkmcnt(11)
v_mfma_f32_32x32x16_bf16 v[192:207], v[120:123], v[32:35], v[192:207]
ds_read_b64_tr_b16 v[144:145], v6 offset:6272
ds_read_b64_tr_b16 v[146:147], v6 offset:7808
s_waitcnt lgkmcnt(11)
v_mfma_f32_32x32x16_bf16 v[208:223], v[124:127], v[32:35], v[208:223]
ds_read_b64_tr_b16 v[148:149], v7 offset:6336
ds_read_b64_tr_b16 v[150:151], v7 offset:7872
s_waitcnt lgkmcnt(11)
v_mfma_f32_32x32x16_bf16 v[224:239], v[128:131], v[32:35], v[224:239]
ds_read_b64_tr_b16 v[152:153], v6 offset:6400
ds_read_b64_tr_b16 v[154:155], v6 offset:7936
s_waitcnt lgkmcnt(11)
v_mfma_f32_32x32x16_bf16 v[240:255], v[132:135], v[32:35], v[240:255]
ds_read_b64_tr_b16 v[156:157], v7 offset:6464
ds_read_b64_tr_b16 v[158:159], v7 offset:8000
s_waitcnt lgkmcnt(10)
v_mfma_f32_32x32x16_bf16 v[160:175], v[136:139], v[36:39], v[160:175]
s_barrier
ds_read_b128 v[24:27], v2 offset:24576
ds_read_b64_tr_b16 v[112:113], v6 offset:12288
ds_read_b64_tr_b16 v[114:115], v6 offset:13824
s_waitcnt lgkmcnt(11)
v_mfma_f32_32x32x16_bf16 v[176:191], v[140:143], v[36:39], v[176:191]
ds_read_b64_tr_b16 v[116:117], v7 offset:12352
ds_read_b64_tr_b16 v[118:119], v7 offset:13888
s_waitcnt lgkmcnt(11)
v_mfma_f32_32x32x16_bf16 v[192:207], v[144:147], v[36:39], v[192:207]
ds_read_b64_tr_b16 v[120:121], v6 offset:12416
ds_read_b64_tr_b16 v[122:123], v6 offset:13952
s_waitcnt lgkmcnt(11)
v_mfma_f32_32x32x16_bf16 v[208:223], v[148:151], v[36:39], v[208:223]
ds_read_b64_tr_b16 v[124:125], v7 offset:12480
ds_read_b64_tr_b16 v[126:127], v7 offset:14016
s_waitcnt lgkmcnt(11)
v_mfma_f32_32x32x16_bf16 v[224:239], v[152:155], v[36:39], v[224:239]
ds_read_b64_tr_b16 v[128:129], v6 offset:12544
ds_read_b64_tr_b16 v[130:131], v6 offset:14080
s_waitcnt lgkmcnt(11)
v_mfma_f32_32x32x16_bf16 v[240:255], v[156:159], v[36:39], v[240:255]
ds_read_b64_tr_b16 v[132:133], v7 offset:12608
ds_read_b64_tr_b16 v[134:135], v7 offset:14144
s_waitcnt lgkmcnt(10)
v_mfma_f32_32x32x16_bf16 v[160:175], v[112:115], v[24:27], v[160:175]
ds_read_b128 v[28:31], v3 offset:24576
ds_read_b64_tr_b16 v[136:137], v6 offset:18432
ds_read_b64_tr_b16 v[138:139], v6 offset:19968
s_waitcnt lgkmcnt(11)
v_mfma_f32_32x32x16_bf16 v[176:191], v[116:119], v[24:27], v[176:191]
ds_read_b64_tr_b16 v[140:141], v7 offset:18496
ds_read_b64_tr_b16 v[142:143], v7 offset:20032
s_waitcnt lgkmcnt(11)
v_mfma_f32_32x32x16_bf16 v[192:207], v[120:123], v[24:27], v[192:207]
ds_read_b64_tr_b16 v[144:145], v6 offset:18560
ds_read_b64_tr_b16 v[146:147], v6 offset:20096
s_waitcnt lgkmcnt(11)
v_mfma_f32_32x32x16_bf16 v[208:223], v[124:127], v[24:27], v[208:223]
ds_read_b64_tr_b16 v[148:149], v7 offset:18624
ds_read_b64_tr_b16 v[150:151], v7 offset:20160
s_waitcnt lgkmcnt(11)
v_mfma_f32_32x32x16_bf16 v[224:239], v[128:131], v[24:27], v[224:239]
ds_read_b64_tr_b16 v[152:153], v6 offset:18688
ds_read_b64_tr_b16 v[154:155], v6 offset:20224
s_waitcnt lgkmcnt(11)
v_mfma_f32_32x32x16_bf16 v[240:255], v[132:135], v[24:27], v[240:255]
ds_read_b64_tr_b16 v[156:157], v7 offset:18752
ds_read_b64_tr_b16 v[158:159], v7 offset:20288
s_waitcnt lgkmcnt(10)
v_mfma_f32_32x32x16_bf16 v[160:175], v[136:139], v[28:31], v[160:175]
s_barrier
ds_read_b128 v[32:35], v4 offset:24576
ds_read_b64_tr_b16 v[112:113], v6 offset:24576
ds_read_b64_tr_b16 v[114:115], v6 offset:26112
s_waitcnt lgkmcnt(11)
v_mfma_f32_32x32x16_bf16 v[176:191], v[140:143], v[28:31], v[176:191]
ds_read_b64_tr_b16 v[116:117], v7 offset:24640
ds_read_b64_tr_b16 v[118:119], v7 offset:26176
s_waitcnt lgkmcnt(11)
v_mfma_f32_32x32x16_bf16 v[192:207], v[144:147], v[28:31], v[192:207]
ds_read_b64_tr_b16 v[120:121], v6 offset:24704
ds_read_b64_tr_b16 v[122:123], v6 offset:26240
s_waitcnt lgkmcnt(11)
v_mfma_f32_32x32x16_bf16 v[208:223], v[148:151], v[28:31], v[208:223]
ds_read_b64_tr_b16 v[124:125], v7 offset:24768
ds_read_b64_tr_b16 v[126:127], v7 offset:26304
s_waitcnt lgkmcnt(11)
v_mfma_f32_32x32x16_bf16 v[224:239], v[152:155], v[28:31], v[224:239]
ds_read_b64_tr_b16 v[128:129], v6 offset:24832
ds_read_b64_tr_b16 v[130:131], v6 offset:26368
s_waitcnt lgkmcnt(11)
v_mfma_f32_32x32x16_bf16 v[240:255], v[156:159], v[28:31], v[240:255]
ds_read_b64_tr_b16 v[132:133], v7 offset:24896
ds_read_b64_tr_b16 v[134:135], v7 offset:26432
s_waitcnt lgkmcnt(10)
v_mfma_f32_32x32x16_bf16 v[160:175], v[112:115], v[32:35], v[160:175]
ds_read_b128 v[36:39], v5 offset:24576
ds_read_b64_tr_b16 v[136:137], v6 offset:30720
ds_read_b64_tr_b16 v[138:139], v6 offset:32256
s_waitcnt lgkmcnt(11)
v_mfma_f32_32x32x16_bf16 v[176:191], v[116:119], v[32:35], v[176:191]
ds_read_b64_tr_b16 v[140:141], v7 offset:30784
ds_read_b64_tr_b16 v[142:143], v7 offset:32320
s_waitcnt lgkmcnt(11)
v_mfma_f32_32x32x16_bf16 v[192:207], v[120:123], v[32:35], v[192:207]
ds_read_b64_tr_b16 v[144:145], v6 offset:30848
ds_read_b64_tr_b16 v[146:147], v6 offset:32384
s_waitcnt lgkmcnt(11)
v_mfma_f32_32x32x16_bf16 v[208:223], v[124:127], v[32:35], v[208:223]
ds_read_b64_tr_b16 v[148:149], v7 offset:30912
ds_read_b64_tr_b16 v[150:151], v7 offset:32448
s_waitcnt lgkmcnt(11)
v_mfma_f32_32x32x16_bf16 v[224:239], v[128:131], v[32:35], v[224:239]
ds_read_b64_tr_b16 v[152:153], v6 offset:30976
ds_read_b64_tr_b16 v[154:155], v6 offset:32512
s_waitcnt lgkmcnt(11)
v_mfma_f32_32x32x16_bf16 v[240:255], v[132:135], v[32:35], v[240:255]
ds_read_b64_tr_b16 v[156:157], v7 offset:31040
ds_read_b64_tr_b16 v[158:159], v7 offset:32576
s_waitcnt lgkmcnt(10)
v_mfma_f32_32x32x16_bf16 v[160:175], v[136:139], v[36:39], v[160:175]
s_barrier
v_add_u32 v2, 147456, v2
ds_read_b128 v[24:27], v2 offset:0
ds_read_b64_tr_b16 v[112:113], v6 offset:36864
ds_read_b64_tr_b16 v[114:115], v6 offset:38400
s_waitcnt lgkmcnt(11)
v_mfma_f32_32x32x16_bf16 v[176:191], v[140:143], v[36:39], v[176:191]
ds_read_b64_tr_b16 v[116:117], v7 offset:36928
ds_read_b64_tr_b16 v[118:119], v7 offset:38464
s_waitcnt lgkmcnt(11)
v_mfma_f32_32x32x16_bf16 v[192:207], v[144:147], v[36:39], v[192:207]
ds_read_b64_tr_b16 v[120:121], v6 offset:36992
ds_read_b64_tr_b16 v[122:123], v6 offset:38528
s_waitcnt lgkmcnt(11)
v_mfma_f32_32x32x16_bf16 v[208:223], v[148:151], v[36:39], v[208:223]
ds_read_b64_tr_b16 v[124:125], v7 offset:37056
ds_read_b64_tr_b16 v[126:127], v7 offset:38592
s_waitcnt lgkmcnt(11)
v_mfma_f32_32x32x16_bf16 v[224:239], v[152:155], v[36:39], v[224:239]
ds_read_b64_tr_b16 v[128:129], v6 offset:37120
ds_read_b64_tr_b16 v[130:131], v6 offset:38656
s_waitcnt lgkmcnt(11)
v_mfma_f32_32x32x16_bf16 v[240:255], v[156:159], v[36:39], v[240:255]
ds_read_b64_tr_b16 v[132:133], v7 offset:37184
ds_read_b64_tr_b16 v[134:135], v7 offset:38720
s_waitcnt lgkmcnt(10)
v_mfma_f32_32x32x16_bf16 v[160:175], v[112:115], v[24:27], v[160:175]
v_add_u32 v3, 147456, v3
ds_read_b128 v[28:31], v3 offset:0
ds_read_b64_tr_b16 v[136:137], v6 offset:43008
ds_read_b64_tr_b16 v[138:139], v6 offset:44544
s_waitcnt lgkmcnt(11)
v_mfma_f32_32x32x16_bf16 v[176:191], v[116:119], v[24:27], v[176:191]
ds_read_b64_tr_b16 v[140:141], v7 offset:43072
ds_read_b64_tr_b16 v[142:143], v7 offset:44608
s_waitcnt lgkmcnt(11)
v_mfma_f32_32x32x16_bf16 v[192:207], v[120:123], v[24:27], v[192:207]
ds_read_b64_tr_b16 v[144:145], v6 offset:43136
ds_read_b64_tr_b16 v[146:147], v6 offset:44672
s_waitcnt lgkmcnt(11)
v_mfma_f32_32x32x16_bf16 v[208:223], v[124:127], v[24:27], v[208:223]
ds_read_b64_tr_b16 v[148:149], v7 offset:43200
ds_read_b64_tr_b16 v[150:151], v7 offset:44736
s_waitcnt lgkmcnt(11)
v_mfma_f32_32x32x16_bf16 v[224:239], v[128:131], v[24:27], v[224:239]
ds_read_b64_tr_b16 v[152:153], v6 offset:43264
ds_read_b64_tr_b16 v[154:155], v6 offset:44800
s_waitcnt lgkmcnt(11)
v_mfma_f32_32x32x16_bf16 v[240:255], v[132:135], v[24:27], v[240:255]
ds_read_b64_tr_b16 v[156:157], v7 offset:43328
ds_read_b64_tr_b16 v[158:159], v7 offset:44864
s_waitcnt lgkmcnt(10)
v_mfma_f32_32x32x16_bf16 v[160:175], v[136:139], v[28:31], v[160:175]
s_barrier
v_add_u32 v4, 147456, v4
ds_read_b128 v[32:35], v4 offset:0
ds_read_b64_tr_b16 v[112:113], v6 offset:49152
ds_read_b64_tr_b16 v[114:115], v6 offset:50688
s_waitcnt lgkmcnt(11)
v_mfma_f32_32x32x16_bf16 v[176:191], v[140:143], v[28:31], v[176:191]
ds_read_b64_tr_b16 v[116:117], v7 offset:49216
ds_read_b64_tr_b16 v[118:119], v7 offset:50752
s_waitcnt lgkmcnt(11)
v_mfma_f32_32x32x16_bf16 v[192:207], v[144:147], v[28:31], v[192:207]
ds_read_b64_tr_b16 v[120:121], v6 offset:49280
ds_read_b64_tr_b16 v[122:123], v6 offset:50816
s_waitcnt lgkmcnt(11)
v_mfma_f32_32x32x16_bf16 v[208:223], v[148:151], v[28:31], v[208:223]
ds_read_b64_tr_b16 v[124:125], v7 offset:49344
ds_read_b64_tr_b16 v[126:127], v7 offset:50880
s_waitcnt lgkmcnt(11)
v_mfma_f32_32x32x16_bf16 v[224:239], v[152:155], v[28:31], v[224:239]
ds_read_b64_tr_b16 v[128:129], v6 offset:49408
ds_read_b64_tr_b16 v[130:131], v6 offset:50944
s_waitcnt lgkmcnt(11)
v_mfma_f32_32x32x16_bf16 v[240:255], v[156:159], v[28:31], v[240:255]
ds_read_b64_tr_b16 v[132:133], v7 offset:49472
ds_read_b64_tr_b16 v[134:135], v7 offset:51008
s_waitcnt lgkmcnt(10)
v_mfma_f32_32x32x16_bf16 v[160:175], v[112:115], v[32:35], v[160:175]
v_add_u32 v5, 147456, v5
ds_read_b128 v[36:39], v5 offset:0
ds_read_b64_tr_b16 v[136:137], v6 offset:55296
ds_read_b64_tr_b16 v[138:139], v6 offset:56832
s_waitcnt lgkmcnt(11)
v_mfma_f32_32x32x16_bf16 v[176:191], v[116:119], v[32:35], v[176:191]
ds_read_b64_tr_b16 v[140:141], v7 offset:55360
ds_read_b64_tr_b16 v[142:143], v7 offset:56896
s_waitcnt lgkmcnt(11)
v_mfma_f32_32x32x16_bf16 v[192:207], v[120:123], v[32:35], v[192:207]
ds_read_b64_tr_b16 v[144:145], v6 offset:55424
ds_read_b64_tr_b16 v[146:147], v6 offset:56960
s_waitcnt lgkmcnt(11)
v_mfma_f32_32x32x16_bf16 v[208:223], v[124:127], v[32:35], v[208:223]
ds_read_b64_tr_b16 v[148:149], v7 offset:55488
ds_read_b64_tr_b16 v[150:151], v7 offset:57024
s_waitcnt lgkmcnt(11)
v_mfma_f32_32x32x16_bf16 v[224:239], v[128:131], v[32:35], v[224:239]
ds_read_b64_tr_b16 v[152:153], v6 offset:55552
ds_read_b64_tr_b16 v[154:155], v6 offset:57088
s_waitcnt lgkmcnt(11)
v_mfma_f32_32x32x16_bf16 v[240:255], v[132:135], v[32:35], v[240:255]
ds_read_b64_tr_b16 v[156:157], v7 offset:55616
ds_read_b64_tr_b16 v[158:159], v7 offset:57152
s_waitcnt lgkmcnt(10)
v_mfma_f32_32x32x16_bf16 v[160:175], v[136:139], v[36:39], v[160:175]
s_waitcnt lgkmcnt(8)
v_mfma_f32_32x32x16_bf16 v[176:191], v[140:143], v[36:39], v[176:191]
s_waitcnt lgkmcnt(6)
v_mfma_f32_32x32x16_bf16 v[192:207], v[144:147], v[36:39], v[192:207]
s_waitcnt lgkmcnt(4)
v_mfma_f32_32x32x16_bf16 v[208:223], v[148:151], v[36:39], v[208:223]
s_waitcnt lgkmcnt(2)
v_mfma_f32_32x32x16_bf16 v[224:239], v[152:155], v[36:39], v[224:239]
s_waitcnt lgkmcnt(0)
v_mfma_f32_32x32x16_bf16 v[240:255], v[156:159], v[36:39], v[240:255]
s_nop 11
v_mov_b32 v12, s72
v_mov_b32 v13, s72
v_pk_mul_f32 v[160:161], v[160:161], v[12:13]
v_pk_mul_f32 v[162:163], v[162:163], v[12:13]
v_pk_mul_f32 v[164:165], v[164:165], v[12:13]
v_pk_mul_f32 v[166:167], v[166:167], v[12:13]
v_pk_mul_f32 v[168:169], v[168:169], v[12:13]
v_pk_mul_f32 v[170:171], v[170:171], v[12:13]
v_pk_mul_f32 v[172:173], v[172:173], v[12:13]
v_pk_mul_f32 v[174:175], v[174:175], v[12:13]
v_pk_mul_f32 v[176:177], v[176:177], v[12:13]
v_pk_mul_f32 v[178:179], v[178:179], v[12:13]
v_pk_mul_f32 v[180:181], v[180:181], v[12:13]
v_pk_mul_f32 v[182:183], v[182:183], v[12:13]
v_pk_mul_f32 v[184:185], v[184:185], v[12:13]
v_pk_mul_f32 v[186:187], v[186:187], v[12:13]
v_pk_mul_f32 v[188:189], v[188:189], v[12:13]
v_pk_mul_f32 v[190:191], v[190:191], v[12:13]
v_pk_mul_f32 v[192:193], v[192:193], v[12:13]
v_pk_mul_f32 v[194:195], v[194:195], v[12:13]
v_pk_mul_f32 v[196:197], v[196:197], v[12:13]
v_pk_mul_f32 v[198:199], v[198:199], v[12:13]
v_pk_mul_f32 v[200:201], v[200:201], v[12:13]
v_pk_mul_f32 v[202:203], v[202:203], v[12:13]
v_pk_mul_f32 v[204:205], v[204:205], v[12:13]
v_pk_mul_f32 v[206:207], v[206:207], v[12:13]
v_pk_mul_f32 v[208:209], v[208:209], v[12:13]
v_pk_mul_f32 v[210:211], v[210:211], v[12:13]
v_pk_mul_f32 v[212:213], v[212:213], v[12:13]
v_pk_mul_f32 v[214:215], v[214:215], v[12:13]
v_pk_mul_f32 v[216:217], v[216:217], v[12:13]
v_pk_mul_f32 v[218:219], v[218:219], v[12:13]
v_pk_mul_f32 v[220:221], v[220:221], v[12:13]
v_pk_mul_f32 v[222:223], v[222:223], v[12:13]
v_pk_mul_f32 v[224:225], v[224:225], v[12:13]
v_pk_mul_f32 v[226:227], v[226:227], v[12:13]
v_pk_mul_f32 v[228:229], v[228:229], v[12:13]
v_pk_mul_f32 v[230:231], v[230:231], v[12:13]
v_pk_mul_f32 v[232:233], v[232:233], v[12:13]
v_pk_mul_f32 v[234:235], v[234:235], v[12:13]
v_pk_mul_f32 v[236:237], v[236:237], v[12:13]
v_pk_mul_f32 v[238:239], v[238:239], v[12:13]
v_pk_mul_f32 v[240:241], v[240:241], v[12:13]
v_pk_mul_f32 v[242:243], v[242:243], v[12:13]
v_pk_mul_f32 v[244:245], v[244:245], v[12:13]
v_pk_mul_f32 v[246:247], v[246:247], v[12:13]
v_pk_mul_f32 v[248:249], v[248:249], v[12:13]
v_pk_mul_f32 v[250:251], v[250:251], v[12:13]
v_pk_mul_f32 v[252:253], v[252:253], v[12:13]
v_pk_mul_f32 v[254:255], v[254:255], v[12:13]
v_cvt_pk_bf16_f32 v112, v160, v161
v_cvt_pk_bf16_f32 v113, v162, v163
v_cvt_pk_bf16_f32 v114, v164, v165
v_cvt_pk_bf16_f32 v115, v166, v167
v_cvt_pk_bf16_f32 v116, v168, v169
v_cvt_pk_bf16_f32 v117, v170, v171
v_cvt_pk_bf16_f32 v118, v172, v173
v_cvt_pk_bf16_f32 v119, v174, v175
v_cvt_pk_bf16_f32 v120, v176, v177
v_cvt_pk_bf16_f32 v121, v178, v179
v_cvt_pk_bf16_f32 v122, v180, v181
v_cvt_pk_bf16_f32 v123, v182, v183
v_cvt_pk_bf16_f32 v124, v184, v185
v_cvt_pk_bf16_f32 v125, v186, v187
v_cvt_pk_bf16_f32 v126, v188, v189
v_cvt_pk_bf16_f32 v127, v190, v191
v_cvt_pk_bf16_f32 v128, v192, v193
v_cvt_pk_bf16_f32 v129, v194, v195
v_cvt_pk_bf16_f32 v130, v196, v197
v_cvt_pk_bf16_f32 v131, v198, v199
v_cvt_pk_bf16_f32 v132, v200, v201
v_cvt_pk_bf16_f32 v133, v202, v203
v_cvt_pk_bf16_f32 v134, v204, v205
v_cvt_pk_bf16_f32 v135, v206, v207
v_cvt_pk_bf16_f32 v136, v208, v209
v_cvt_pk_bf16_f32 v137, v210, v211
v_cvt_pk_bf16_f32 v138, v212, v213
v_cvt_pk_bf16_f32 v139, v214, v215
v_cvt_pk_bf16_f32 v140, v216, v217
v_cvt_pk_bf16_f32 v141, v218, v219
v_cvt_pk_bf16_f32 v142, v220, v221
v_cvt_pk_bf16_f32 v143, v222, v223
v_cvt_pk_bf16_f32 v144, v224, v225
v_cvt_pk_bf16_f32 v145, v226, v227
v_cvt_pk_bf16_f32 v146, v228, v229
v_cvt_pk_bf16_f32 v147, v230, v231
v_cvt_pk_bf16_f32 v148, v232, v233
v_cvt_pk_bf16_f32 v149, v234, v235
v_cvt_pk_bf16_f32 v150, v236, v237
v_cvt_pk_bf16_f32 v151, v238, v239
v_cvt_pk_bf16_f32 v152, v240, v241
v_cvt_pk_bf16_f32 v153, v242, v243
v_cvt_pk_bf16_f32 v154, v244, v245
v_cvt_pk_bf16_f32 v155, v246, v247
v_cvt_pk_bf16_f32 v156, v248, v249
v_cvt_pk_bf16_f32 v157, v250, v251
v_cvt_pk_bf16_f32 v158, v252, v253
v_cvt_pk_bf16_f32 v159, v254, v255
s_nop 1
v_permlane32_swap_b32 v112, v116
v_permlane32_swap_b32 v113, v117
v_permlane32_swap_b32 v114, v118
v_permlane32_swap_b32 v115, v119
v_permlane32_swap_b32 v120, v124
v_permlane32_swap_b32 v121, v125
v_permlane32_swap_b32 v122, v126
v_permlane32_swap_b32 v123, v127
v_permlane32_swap_b32 v128, v132
v_permlane32_swap_b32 v129, v133
v_permlane32_swap_b32 v130, v134
v_permlane32_swap_b32 v131, v135
v_permlane32_swap_b32 v136, v140
v_permlane32_swap_b32 v137, v141
v_permlane32_swap_b32 v138, v142
v_permlane32_swap_b32 v139, v143
v_permlane32_swap_b32 v144, v148
v_permlane32_swap_b32 v145, v149
v_permlane32_swap_b32 v146, v150
v_permlane32_swap_b32 v147, v151
v_permlane32_swap_b32 v152, v156
v_permlane32_swap_b32 v153, v157
v_permlane32_swap_b32 v154, v158
v_permlane32_swap_b32 v155, v159
s_nop 1
v_permlane16_swap_b32 v112, v116
v_permlane16_swap_b32 v113, v117
v_permlane16_swap_b32 v114, v118
v_permlane16_swap_b32 v115, v119
v_permlane16_swap_b32 v120, v124
v_permlane16_swap_b32 v121, v125
v_permlane16_swap_b32 v122, v126
v_permlane16_swap_b32 v123, v127
v_permlane16_swap_b32 v128, v132
v_permlane16_swap_b32 v129, v133
v_permlane16_swap_b32 v130, v134
v_permlane16_swap_b32 v131, v135
v_permlane16_swap_b32 v136, v140
v_permlane16_swap_b32 v137, v141
v_permlane16_swap_b32 v138, v142
v_permlane16_swap_b32 v139, v143
v_permlane16_swap_b32 v144, v148
v_permlane16_swap_b32 v145, v149
v_permlane16_swap_b32 v146, v150
v_permlane16_swap_b32 v147, v151
v_permlane16_swap_b32 v152, v156
v_permlane16_swap_b32 v153, v157
v_permlane16_swap_b32 v154, v158
v_permlane16_swap_b32 v155, v159
s_branch L_q_done
L_y_start:
s_lshl_b32 s79, s64, 4
s_add_u32 s79, s79, s65
s_lshl_b32 s99, s79, 7
s_add_u32 s99, s99, 131072
s_lshl_b32 s79, s79, 2
s_add_u32 s79, s79, 128
v_mov_b32 v2, s66
v_lshlrev_b32 v2, 2, v2
v_mov_b32 v3, 0
v_mov_b32 v4, 1
s_and_b32 s68, s65, 0
s_add_u32 s68, s68, 1
s_mov_b32 s73, 0
L_y_idle:
s_cmp_lg_u32 s67, 6
s_cbranch_scc1 L_y_nf
s_mov_b64 exec, 1
s_cmp_lg_u32 s73, 0
s_cbranch_scc1 L_y_n1
buffer_store_dword v3, v2, s[48:51], s99 offen sc1
L_y_n1:
s_cmp_lg_u32 s73, s68
s_cbranch_scc1 L_y_n2
s_waitcnt vmcnt(0)
buffer_atomic_add v4, v3, s[52:55], s79 offen sc1
L_y_n2:
s_mov_b64 exec, -1
L_y_nf:
s_barrier
s_add_u32 s73, s73, 1
s_cmp_lt_u32 s73, 21
s_cbranch_scc1 L_y_idle
s_mov_b32 s74, 1
s_mov_b32 s75, 0
L_qround:
s_setprio 0
s_and_b32 s68, s67, 3
s_lshl_b32 s68, s68, 12
s_add_u32 s68, s68, 122880
v_and_b32 v14, 15, v0
v_lshlrev_b32 v14, 7, v14
v_add_u32 v14, s68, v14
v_bfe_u32 v15, v0, 1, 3
v_lshrrev_b32 v1, 4, v0
v_add_u32 v1, 0, v1
v_xor_b32 v1, v1, v15
v_lshl_add_u32 v2, v1, 4, v14
v_lshrrev_b32 v1, 4, v0
v_add_u32 v1, 4, v1
v_xor_b32 v1, v1, v15
v_lshl_add_u32 v3, v1, 4, v14
v_lshrrev_b32 v14, 4, v0
v_bfe_u32 v15, v0, 2, 2
v_lshl_add_u32 v14, v14, 3, v15
v_mul_u32_u24 v14, 384, v14
v_and_b32 v15, 3, v0
v_lshl_add_u32 v14, v15, 3, v14
v_add_u32 v14, 73728, v14
v_bfe_u32 v15, v0, 3, 1
v_lshlrev_b32 v15, 1, v15
v_bfe_u32 v1, v0, 4, 1
v_or_b32 v15, v15, v1
v_xor_b32 v1, 0, v15
v_lshl_add_u32 v4, v1, 5, v14
v_xor_b32 v1, 1, v15
v_lshl_add_u32 v5, v1, 5, v14
v_xor_b32 v1, 2, v15
v_lshl_add_u32 v6, v1, 5, v14
v_xor_b32 v1, 3, v15
v_lshl_add_u32 v7, v1, 5, v14
s_barrier
ds_read_b128 v[24:27], v2 offset:0
ds_read_b128 v[28:31], v2 offset:2048
ds_read_b64_tr_b16 v[112:113], v4 offset:0
ds_read_b64_tr_b16 v[114:115], v4 offset:1536
ds_read_b64_tr_b16 v[116:117], v5 offset:0
ds_read_b64_tr_b16 v[118:119], v5 offset:1536
ds_read_b64_tr_b16 v[120:121], v6 offset:0
ds_read_b64_tr_b16 v[122:123], v6 offset:1536
ds_read_b64_tr_b16 v[124:125], v7 offset:0
ds_read_b64_tr_b16 v[126:127], v7 offset:1536
ds_read_b64_tr_b16 v[128:129], v4 offset:128
ds_read_b64_tr_b16 v[130:131], v4 offset:1664
s_waitcnt lgkmcnt(8)
v_mfma_f32_16x16x32_bf16 v[160:163], v[112:115], v[24:27], 0
v_mfma_f32_16x16x32_bf16 v[164:167], v[112:115], v[28:31], 0
ds_read_b64_tr_b16 v[132:133], v5 offset:128
ds_read_b64_tr_b16 v[134:135], v5 offset:1664
s_waitcnt lgkmcnt(8)
v_mfma_f32_16x16x32_bf16 v[168:171], v[116:119], v[24:27], 0
v_mfma_f32_16x16x32_bf16 v[172:175], v[116:119], v[28:31], 0
ds_read_b64_tr_b16 v[136:137], v6 offset:128
ds_read_b64_tr_b16 v[138:139], v6 offset:1664
s_waitcnt lgkmcnt(8)
v_mfma_f32_16x16x32_bf16 v[176:179], v[120:123], v[24:27], 0
v_mfma_f32_16x16x32_bf16 v[180:183], v[120:123], v[28:31], 0
ds_read_b64_tr_b16 v[140:141], v7 offset:128
ds_read_b64_tr_b16 v[142:143], v7 offset:1664
s_waitcnt lgkmcnt(8)
v_mfma_f32_16x16x32_bf16 v[184:187], v[124:127], v[24:27], 0
v_mfma_f32_16x16x32_bf16 v[188:191], v[124:127], v[28:31], 0
ds_read_b64_tr_b16 v[144:145], v4 offset:256
ds_read_b64_tr_b16 v[146:147], v4 offset:1792
s_waitcnt lgkmcnt(8)
v_mfma_f32_16x16x32_bf16 v[192:195], v[128:131], v[24:27], 0
v_mfma_f32_16x16x32_bf16 v[196:199], v[128:131], v[28:31], 0
ds_read_b64_tr_b16 v[148:149], v5 offset:256
ds_read_b64_tr_b16 v[150:151], v5 offset:1792
s_waitcnt lgkmcnt(8)
v_mfma_f32_16x16x32_bf16 v[200:203], v[132:135], v[24:27], 0
v_mfma_f32_16x16x32_bf16 v[204:207], v[132:135], v[28:31], 0
ds_read_b64_tr_b16 v[152:153], v6 offset:256
ds_read_b64_tr_b16 v[154:155], v6 offset:1792
s_waitcnt lgkmcnt(8)
v_mfma_f32_16x16x32_bf16 v[208:211], v[136:139], v[24:27], 0
v_mfma_f32_16x16x32_bf16 v[212:215], v[136:139], v[28:31], 0
ds_read_b64_tr_b16 v[156:157], v7 offset:256
ds_read_b64_tr_b16 v[158:159], v7 offset:1792
s_waitcnt lgkmcnt(8)
v_mfma_f32_16x16x32_bf16 v[216:219], v[140:143], v[24:27], 0
v_mfma_f32_16x16x32_bf16 v[220:223], v[140:143], v[28:31], 0
ds_read_b128 v[32:35], v3 offset:0
ds_read_b128 v[36:39], v3 offset:2048
ds_read_b64_tr_b16 v[112:113], v4 offset:12288
ds_read_b64_tr_b16 v[114:115], v4 offset:13824
s_waitcnt lgkmcnt(10)
v_mfma_f32_16x16x32_bf16 v[224:227], v[144:147], v[24:27], 0
v_mfma_f32_16x16x32_bf16 v[228:231], v[144:147], v[28:31], 0
ds_read_b64_tr_b16 v[116:117], v5 offset:12288
ds_read_b64_tr_b16 v[118:119], v5 offset:13824
s_waitcnt lgkmcnt(10)
v_mfma_f32_16x16x32_bf16 v[232:235], v[148:151], v[24:27], 0
v_mfma_f32_16x16x32_bf16 v[236:239], v[148:151], v[28:31], 0
ds_read_b64_tr_b16 v[120:121], v6 offset:12288
ds_read_b64_tr_b16 v[122:123], v6 offset:13824
s_waitcnt lgkmcnt(10)
v_mfma_f32_16x16x32_bf16 v[240:243], v[152:155], v[24:27], 0
v_mfma_f32_16x16x32_bf16 v[244:247], v[152:155], v[28:31], 0
ds_read_b64_tr_b16 v[124:125], v7 offset:12288
ds_read_b64_tr_b16 v[126:127], v7 offset:13824
s_waitcnt lgkmcnt(10)
v_mfma_f32_16x16x32_bf16 v[248:251], v[156:159], v[24:27], 0
v_mfma_f32_16x16x32_bf16 v[252:255], v[156:159], v[28:31], 0
ds_read_b64_tr_b16 v[128:129], v4 offset:12416
ds_read_b64_tr_b16 v[130:131], v4 offset:13952
s_waitcnt lgkmcnt(8)
v_mfma_f32_16x16x32_bf16 v[160:163], v[112:115], v[32:35], v[160:163]
v_mfma_f32_16x16x32_bf16 v[164:167], v[112:115], v[36:39], v[164:167]
ds_read_b64_tr_b16 v[132:133], v5 offset:12416
ds_read_b64_tr_b16 v[134:135], v5 offset:13952
s_waitcnt lgkmcnt(8)
v_mfma_f32_16x16x32_bf16 v[168:171], v[116:119], v[32:35], v[168:171]
v_mfma_f32_16x16x32_bf16 v[172:175], v[116:119], v[36:39], v[172:175]
s_waitcnt lgkmcnt(6)
v_mfma_f32_16x16x32_bf16 v[176:179], v[120:123], v[32:35], v[176:179]
v_mfma_f32_16x16x32_bf16 v[180:183], v[120:123], v[36:39], v[180:183]
s_waitcnt lgkmcnt(4)
v_mfma_f32_16x16x32_bf16 v[184:187], v[124:127], v[32:35], v[184:187]
v_mfma_f32_16x16x32_bf16 v[188:191], v[124:127], v[36:39], v[188:191]
s_waitcnt lgkmcnt(2)
v_mfma_f32_16x16x32_bf16 v[192:195], v[128:131], v[32:35], v[192:195]
v_mfma_f32_16x16x32_bf16 v[196:199], v[128:131], v[36:39], v[196:199]
s_waitcnt lgkmcnt(0)
v_mfma_f32_16x16x32_bf16 v[200:203], v[132:135], v[32:35], v[200:203]
v_mfma_f32_16x16x32_bf16 v[204:207], v[132:135], v[36:39], v[204:207]
L_qs1:
s_barrier
ds_read_b64_tr_b16 v[112:113], v6 offset:12416
ds_read_b64_tr_b16 v[114:115], v6 offset:13952
ds_read_b64_tr_b16 v[116:117], v7 offset:12416
ds_read_b64_tr_b16 v[118:119], v7 offset:13952
ds_read_b64_tr_b16 v[120:121], v4 offset:12544
ds_read_b64_tr_b16 v[122:123], v4 offset:14080
ds_read_b64_tr_b16 v[124:125], v5 offset:12544
ds_read_b64_tr_b16 v[126:127], v5 offset:14080
ds_read_b64_tr_b16 v[128:129], v6 offset:12544
ds_read_b64_tr_b16 v[130:131], v6 offset:14080
s_waitcnt lgkmcnt(8)
v_mfma_f32_16x16x32_bf16 v[208:211], v[112:115], v[32:35], v[208:211]
v_mfma_f32_16x16x32_bf16 v[212:215], v[112:115], v[36:39], v[212:215]
ds_read_b64_tr_b16 v[132:133], v7 offset:12544
ds_read_b64_tr_b16 v[134:135], v7 offset:14080
s_waitcnt lgkmcnt(8)
v_mfma_f32_16x16x32_bf16 v[216:219], v[116:119], v[32:35], v[216:219]
v_mfma_f32_16x16x32_bf16 v[220:223], v[116:119], v[36:39], v[220:223]
ds_read_b128 v[24:27], v2 offset:12288
ds_read_b128 v[28:31], v2 offset:14336
ds_read_b64_tr_b16 v[136:137], v4 offset:24576
ds_read_b64_tr_b16 v[138:139], v4 offset:26112
s_waitcnt lgkmcnt(10)
v_mfma_f32_16x16x32_bf16 v[224:227], v[120:123], v[32:35], v[224:227]
v_mfma_f32_16x16x32_bf16 v[228:231], v[120:123], v[36:39], v[228:231]
ds_read_b64_tr_b16 v[140:141], v5 offset:24576
ds_read_b64_tr_b16 v[142:143], v5 offset:26112
s_waitcnt lgkmcnt(10)
v_mfma_f32_16x16x32_bf16 v[232:235], v[124:127], v[32:35], v[232:235]
v_mfma_f32_16x16x32_bf16 v[236:239], v[124:127], v[36:39], v[236:239]
ds_read_b64_tr_b16 v[144:145], v6 offset:24576
ds_read_b64_tr_b16 v[146:147], v6 offset:26112
s_waitcnt lgkmcnt(10)
v_mfma_f32_16x16x32_bf16 v[240:243], v[128:131], v[32:35], v[240:243]
v_mfma_f32_16x16x32_bf16 v[244:247], v[128:131], v[36:39], v[244:247]
ds_read_b64_tr_b16 v[148:149], v7 offset:24576
ds_read_b64_tr_b16 v[150:151], v7 offset:26112
s_waitcnt lgkmcnt(10)
v_mfma_f32_16x16x32_bf16 v[248:251], v[132:135], v[32:35], v[248:251]
v_mfma_f32_16x16x32_bf16 v[252:255], v[132:135], v[36:39], v[252:255]
ds_read_b64_tr_b16 v[152:153], v4 offset:24704
ds_read_b64_tr_b16 v[154:155], v4 offset:26240
s_waitcnt lgkmcnt(8)
v_mfma_f32_16x16x32_bf16 v[160:163], v[136:139], v[24:27], v[160:163]
v_mfma_f32_16x16x32_bf16 v[164:167], v[136:139], v[28:31], v[164:167]
ds_read_b64_tr_b16 v[156:157], v5 offset:24704
ds_read_b64_tr_b16 v[158:159], v5 offset:26240
s_waitcnt lgkmcnt(8)
v_mfma_f32_16x16x32_bf16 v[168:171], v[140:143], v[24:27], v[168:171]
v_mfma_f32_16x16x32_bf16 v[172:175], v[140:143], v[28:31], v[172:175]
ds_read_b64_tr_b16 v[112:113], v6 offset:24704
ds_read_b64_tr_b16 v[114:115], v6 offset:26240
s_waitcnt lgkmcnt(8)
v_mfma_f32_16x16x32_bf16 v[176:179], v[144:147], v[24:27], v[176:179]
v_mfma_f32_16x16x32_bf16 v[180:183], v[144:147], v[28:31], v[180:183]
ds_read_b64_tr_b16 v[116:117], v7 offset:24704
ds_read_b64_tr_b16 v[118:119], v7 offset:26240
s_waitcnt lgkmcnt(8)
v_mfma_f32_16x16x32_bf16 v[184:187], v[148:151], v[24:27], v[184:187]
v_mfma_f32_16x16x32_bf16 v[188:191], v[148:151], v[28:31], v[188:191]
ds_read_b64_tr_b16 v[120:121], v4 offset:24832
ds_read_b64_tr_b16 v[122:123], v4 offset:26368
s_waitcnt lgkmcnt(8)
v_mfma_f32_16x16x32_bf16 v[192:195], v[152:155], v[24:27], v[192:195]
v_mfma_f32_16x16x32_bf16 v[196:199], v[152:155], v[28:31], v[196:199]
ds_read_b64_tr_b16 v[124:125], v5 offset:24832
ds_read_b64_tr_b16 v[126:127], v5 offset:26368
s_waitcnt lgkmcnt(8)
v_mfma_f32_16x16x32_bf16 v[200:203], v[156:159], v[24:27], v[200:203]
v_mfma_f32_16x16x32_bf16 v[204:207], v[156:159], v[28:31], v[204:207]
ds_read_b64_tr_b16 v[128:129], v6 offset:24832
ds_read_b64_tr_b16 v[130:131], v6 offset:26368
s_waitcnt lgkmcnt(8)
v_mfma_f32_16x16x32_bf16 v[208:211], v[112:115], v[24:27], v[208:211]
v_mfma_f32_16x16x32_bf16 v[212:215], v[112:115], v[28:31], v[212:215]
ds_read_b64_tr_b16 v[132:133], v7 offset:24832
ds_read_b64_tr_b16 v[134:135], v7 offset:26368
s_waitcnt lgkmcnt(8)
v_mfma_f32_16x16x32_bf16 v[216:219], v[116:119], v[24:27], v[216:219]
v_mfma_f32_16x16x32_bf16 v[220:223], v[116:119], v[28:31], v[220:223]
s_waitcnt lgkmcnt(6)
v_mfma_f32_16x16x32_bf16 v[224:227], v[120:123], v[24:27], v[224:227]
v_mfma_f32_16x16x32_bf16 v[228:231], v[120:123], v[28:31], v[228:231]
s_waitcnt lgkmcnt(4)
v_mfma_f32_16x16x32_bf16 v[232:235], v[124:127], v[24:27], v[232:235]
v_mfma_f32_16x16x32_bf16 v[236:239], v[124:127], v[28:31], v[236:239]
s_waitcnt lgkmcnt(2)
v_mfma_f32_16x16x32_bf16 v[240:243], v[128:131], v[24:27], v[240:243]
v_mfma_f32_16x16x32_bf16 v[244:247], v[128:131], v[28:31], v[244:247]
s_waitcnt lgkmcnt(0)
v_mfma_f32_16x16x32_bf16 v[248:251], v[132:135], v[24:27], v[248:251]
v_mfma_f32_16x16x32_bf16 v[252:255], v[132:135], v[28:31], v[252:255]
L_qs2:
s_barrier
ds_read_b128 v[32:35], v3 offset:12288
ds_read_b128 v[36:39], v3 offset:14336
ds_read_b64_tr_b16 v[112:113], v4 offset:36864
ds_read_b64_tr_b16 v[114:115], v4 offset:38400
ds_read_b64_tr_b16 v[116:117], v5 offset:36864
ds_read_b64_tr_b16 v[118:119], v5 offset:38400
ds_read_b64_tr_b16 v[120:121], v6 offset:36864
ds_read_b64_tr_b16 v[122:123], v6 offset:38400
ds_read_b64_tr_b16 v[124:125], v7 offset:36864
ds_read_b64_tr_b16 v[126:127], v7 offset:38400
ds_read_b64_tr_b16 v[128:129], v4 offset:36992
ds_read_b64_tr_b16 v[130:131], v4 offset:38528
s_waitcnt lgkmcnt(8)
v_mfma_f32_16x16x32_bf16 v[160:163], v[112:115], v[32:35], v[160:163]
v_mfma_f32_16x16x32_bf16 v[164:167], v[112:115], v[36:39], v[164:167]
ds_read_b64_tr_b16 v[132:133], v5 offset:36992
ds_read_b64_tr_b16 v[134:135], v5 offset:38528
s_waitcnt lgkmcnt(8)
v_mfma_f32_16x16x32_bf16 v[168:171], v[116:119], v[32:35], v[168:171]
v_mfma_f32_16x16x32_bf16 v[172:175], v[116:119], v[36:39], v[172:175]
ds_read_b64_tr_b16 v[136:137], v6 offset:36992
ds_read_b64_tr_b16 v[138:139], v6 offset:38528
s_waitcnt lgkmcnt(8)
v_mfma_f32_16x16x32_bf16 v[176:179], v[120:123], v[32:35], v[176:179]
v_mfma_f32_16x16x32_bf16 v[180:183], v[120:123], v[36:39], v[180:183]
ds_read_b64_tr_b16 v[140:141], v7 offset:36992
ds_read_b64_tr_b16 v[142:143], v7 offset:38528
s_waitcnt lgkmcnt(8)
v_mfma_f32_16x16x32_bf16 v[184:187], v[124:127], v[32:35], v[184:187]
v_mfma_f32_16x16x32_bf16 v[188:191], v[124:127], v[36:39], v[188:191]
ds_read_b64_tr_b16 v[144:145], v4 offset:37120
ds_read_b64_tr_b16 v[146:147], v4 offset:38656
s_waitcnt lgkmcnt(8)
v_mfma_f32_16x16x32_bf16 v[192:195], v[128:131], v[32:35], v[192:195]
v_mfma_f32_16x16x32_bf16 v[196:199], v[128:131], v[36:39], v[196:199]
ds_read_b64_tr_b16 v[148:149], v5 offset:37120
ds_read_b64_tr_b16 v[150:151], v5 offset:38656
s_waitcnt lgkmcnt(8)
v_mfma_f32_16x16x32_bf16 v[200:203], v[132:135], v[32:35], v[200:203]
v_mfma_f32_16x16x32_bf16 v[204:207], v[132:135], v[36:39], v[204:207]
ds_read_b64_tr_b16 v[152:153], v6 offset:37120
ds_read_b64_tr_b16 v[154:155], v6 offset:38656
s_waitcnt lgkmcnt(8)
v_mfma_f32_16x16x32_bf16 v[208:211], v[136:139], v[32:35], v[208:211]
v_mfma_f32_16x16x32_bf16 v[212:215], v[136:139], v[36:39], v[212:215]
ds_read_b64_tr_b16 v[156:157], v7 offset:37120
ds_read_b64_tr_b16 v[158:159], v7 offset:38656
s_waitcnt lgkmcnt(8)
v_mfma_f32_16x16x32_bf16 v[216:219], v[140:143], v[32:35], v[216:219]
v_mfma_f32_16x16x32_bf16 v[220:223], v[140:143], v[36:39], v[220:223]
s_waitcnt lgkmcnt(6)
v_mfma_f32_16x16x32_bf16 v[224:227], v[144:147], v[32:35], v[224:227]
v_mfma_f32_16x16x32_bf16 v[228:231], v[144:147], v[36:39], v[228:231]
s_waitcnt lgkmcnt(4)
v_mfma_f32_16x16x32_bf16 v[232:235], v[148:151], v[32:35], v[232:235]
v_mfma_f32_16x16x32_bf16 v[236:239], v[148:151], v[36:39], v[236:239]
s_waitcnt lgkmcnt(2)
v_mfma_f32_16x16x32_bf16 v[240:243], v[152:155], v[32:35], v[240:243]
v_mfma_f32_16x16x32_bf16 v[244:247], v[152:155], v[36:39], v[244:247]
s_waitcnt lgkmcnt(0)
v_mfma_f32_16x16x32_bf16 v[248:251], v[156:159], v[32:35], v[248:251]
v_mfma_f32_16x16x32_bf16 v[252:255], v[156:159], v[36:39], v[252:255]
L_qs3:
s_barrier
ds_read_b128 v[24:27], v2 offset:0
ds_read_b128 v[28:31], v2 offset:2048
ds_read_b64_tr_b16 v[112:113], v4 offset:0
ds_read_b64_tr_b16 v[114:115], v4 offset:1536
ds_read_b64_tr_b16 v[116:117], v5 offset:0
ds_read_b64_tr_b16 v[118:119], v5 offset:1536
ds_read_b64_tr_b16 v[120:121], v6 offset:0
ds_read_b64_tr_b16 v[122:123], v6 offset:1536
ds_read_b64_tr_b16 v[124:125], v7 offset:0
ds_read_b64_tr_b16 v[126:127], v7 offset:1536
ds_read_b64_tr_b16 v[128:129], v4 offset:128
ds_read_b64_tr_b16 v[130:131], v4 offset:1664
s_waitcnt lgkmcnt(8)
v_mfma_f32_16x16x32_bf16 v[160:163], v[112:115], v[24:27], v[160:163]
v_mfma_f32_16x16x32_bf16 v[164:167], v[112:115], v[28:31], v[164:167]
ds_read_b64_tr_b16 v[132:133], v5 offset:128
ds_read_b64_tr_b16 v[134:135], v5 offset:1664
s_waitcnt lgkmcnt(8)
v_mfma_f32_16x16x32_bf16 v[168:171], v[116:119], v[24:27], v[168:171]
v_mfma_f32_16x16x32_bf16 v[172:175], v[116:119], v[28:31], v[172:175]
ds_read_b64_tr_b16 v[136:137], v6 offset:128
ds_read_b64_tr_b16 v[138:139], v6 offset:1664
s_waitcnt lgkmcnt(8)
v_mfma_f32_16x16x32_bf16 v[176:179], v[120:123], v[24:27], v[176:179]
v_mfma_f32_16x16x32_bf16 v[180:183], v[120:123], v[28:31], v[180:183]
ds_read_b64_tr_b16 v[140:141], v7 offset:128
ds_read_b64_tr_b16 v[142:143], v7 offset:1664
s_waitcnt lgkmcnt(8)
v_mfma_f32_16x16x32_bf16 v[184:187], v[124:127], v[24:27], v[184:187]
v_mfma_f32_16x16x32_bf16 v[188:191], v[124:127], v[28:31], v[188:191]
ds_read_b64_tr_b16 v[144:145], v4 offset:256
ds_read_b64_tr_b16 v[146:147], v4 offset:1792
s_waitcnt lgkmcnt(8)
v_mfma_f32_16x16x32_bf16 v[192:195], v[128:131], v[24:27], v[192:195]
v_mfma_f32_16x16x32_bf16 v[196:199], v[128:131], v[28:31], v[196:199]
ds_read_b64_tr_b16 v[148:149], v5 offset:256
ds_read_b64_tr_b16 v[150:151], v5 offset:1792
s_waitcnt lgkmcnt(8)
v_mfma_f32_16x16x32_bf16 v[200:203], v[132:135], v[24:27], v[200:203]
v_mfma_f32_16x16x32_bf16 v[204:207], v[132:135], v[28:31], v[204:207]
ds_read_b64_tr_b16 v[152:153], v6 offset:256
ds_read_b64_tr_b16 v[154:155], v6 offset:1792
s_waitcnt lgkmcnt(8)
v_mfma_f32_16x16x32_bf16 v[208:211], v[136:139], v[24:27], v[208:211]
v_mfma_f32_16x16x32_bf16 v[212:215], v[136:139], v[28:31], v[212:215]
ds_read_b64_tr_b16 v[156:157], v7 offset:256
ds_read_b64_tr_b16 v[158:159], v7 offset:1792
s_waitcnt lgkmcnt(8)
v_mfma_f32_16x16x32_bf16 v[216:219], v[140:143], v[24:27], v[216:219]
v_mfma_f32_16x16x32_bf16 v[220:223], v[140:143], v[28:31], v[220:223]
ds_read_b128 v[32:35], v3 offset:0
ds_read_b128 v[36:39], v3 offset:2048
ds_read_b64_tr_b16 v[112:113], v4 offset:12288
ds_read_b64_tr_b16 v[114:115], v4 offset:13824
s_waitcnt lgkmcnt(10)
v_mfma_f32_16x16x32_bf16 v[224:227], v[144:147], v[24:27], v[224:227]
v_mfma_f32_16x16x32_bf16 v[228:231], v[144:147], v[28:31], v[228:231]
ds_read_b64_tr_b16 v[116:117], v5 offset:12288
ds_read_b64_tr_b16 v[118:119], v5 offset:13824
s_waitcnt lgkmcnt(10)
v_mfma_f32_16x16x32_bf16 v[232:235], v[148:151], v[24:27], v[232:235]
v_mfma_f32_16x16x32_bf16 v[236:239], v[148:151], v[28:31], v[236:239]
ds_read_b64_tr_b16 v[120:121], v6 offset:12288
ds_read_b64_tr_b16 v[122:123], v6 offset:13824
s_waitcnt lgkmcnt(10)
v_mfma_f32_16x16x32_bf16 v[240:243], v[152:155], v[24:27], v[240:243]
v_mfma_f32_16x16x32_bf16 v[244:247], v[152:155], v[28:31], v[244:247]
ds_read_b64_tr_b16 v[124:125], v7 offset:12288
ds_read_b64_tr_b16 v[126:127], v7 offset:13824
s_waitcnt lgkmcnt(10)
v_mfma_f32_16x16x32_bf16 v[248:251], v[156:159], v[24:27], v[248:251]
v_mfma_f32_16x16x32_bf16 v[252:255], v[156:159], v[28:31], v[252:255]
ds_read_b64_tr_b16 v[128:129], v4 offset:12416
ds_read_b64_tr_b16 v[130:131], v4 offset:13952
s_waitcnt lgkmcnt(8)
v_mfma_f32_16x16x32_bf16 v[160:163], v[112:115], v[32:35], v[160:163]
v_mfma_f32_16x16x32_bf16 v[164:167], v[112:115], v[36:39], v[164:167]
ds_read_b64_tr_b16 v[132:133], v5 offset:12416
ds_read_b64_tr_b16 v[134:135], v5 offset:13952
s_waitcnt lgkmcnt(8)
v_mfma_f32_16x16x32_bf16 v[168:171], v[116:119], v[32:35], v[168:171]
v_mfma_f32_16x16x32_bf16 v[172:175], v[116:119], v[36:39], v[172:175]
s_waitcnt lgkmcnt(6)
v_mfma_f32_16x16x32_bf16 v[176:179], v[120:123], v[32:35], v[176:179]
v_mfma_f32_16x16x32_bf16 v[180:183], v[120:123], v[36:39], v[180:183]
s_waitcnt lgkmcnt(4)
v_mfma_f32_16x16x32_bf16 v[184:187], v[124:127], v[32:35], v[184:187]
v_mfma_f32_16x16x32_bf16 v[188:191], v[124:127], v[36:39], v[188:191]
s_waitcnt lgkmcnt(2)
v_mfma_f32_16x16x32_bf16 v[192:195], v[128:131], v[32:35], v[192:195]
v_mfma_f32_16x16x32_bf16 v[196:199], v[128:131], v[36:39], v[196:199]
s_waitcnt lgkmcnt(0)
v_mfma_f32_16x16x32_bf16 v[200:203], v[132:135], v[32:35], v[200:203]
v_mfma_f32_16x16x32_bf16 v[204:207], v[132:135], v[36:39], v[204:207]
L_qs4:
s_barrier
ds_read_b64_tr_b16 v[112:113], v6 offset:12416
ds_read_b64_tr_b16 v[114:115], v6 offset:13952
ds_read_b64_tr_b16 v[116:117], v7 offset:12416
ds_read_b64_tr_b16 v[118:119], v7 offset:13952
ds_read_b64_tr_b16 v[120:121], v4 offset:12544
ds_read_b64_tr_b16 v[122:123], v4 offset:14080
ds_read_b64_tr_b16 v[124:125], v5 offset:12544
ds_read_b64_tr_b16 v[126:127], v5 offset:14080
ds_read_b64_tr_b16 v[128:129], v6 offset:12544
ds_read_b64_tr_b16 v[130:131], v6 offset:14080
s_waitcnt lgkmcnt(8)
v_mfma_f32_16x16x32_bf16 v[208:211], v[112:115], v[32:35], v[208:211]
v_mfma_f32_16x16x32_bf16 v[212:215], v[112:115], v[36:39], v[212:215]
ds_read_b64_tr_b16 v[132:133], v7 offset:12544
ds_read_b64_tr_b16 v[134:135], v7 offset:14080
s_waitcnt lgkmcnt(8)
v_mfma_f32_16x16x32_bf16 v[216:219], v[116:119], v[32:35], v[216:219]
v_mfma_f32_16x16x32_bf16 v[220:223], v[116:119], v[36:39], v[220:223]
ds_read_b128 v[24:27], v2 offset:12288
ds_read_b128 v[28:31], v2 offset:14336
ds_read_b64_tr_b16 v[136:137], v4 offset:24576
ds_read_b64_tr_b16 v[138:139], v4 offset:26112
s_waitcnt lgkmcnt(10)
v_mfma_f32_16x16x32_bf16 v[224:227], v[120:123], v[32:35], v[224:227]
v_mfma_f32_16x16x32_bf16 v[228:231], v[120:123], v[36:39], v[228:231]
ds_read_b64_tr_b16 v[140:141], v5 offset:24576
ds_read_b64_tr_b16 v[142:143], v5 offset:26112
s_waitcnt lgkmcnt(10)
v_mfma_f32_16x16x32_bf16 v[232:235], v[124:127], v[32:35], v[232:235]
v_mfma_f32_16x16x32_bf16 v[236:239], v[124:127], v[36:39], v[236:239]
ds_read_b64_tr_b16 v[144:145], v6 offset:24576
ds_read_b64_tr_b16 v[146:147], v6 offset:26112
s_waitcnt lgkmcnt(10)
v_mfma_f32_16x16x32_bf16 v[240:243], v[128:131], v[32:35], v[240:243]
v_mfma_f32_16x16x32_bf16 v[244:247], v[128:131], v[36:39], v[244:247]
ds_read_b64_tr_b16 v[148:149], v7 offset:24576
ds_read_b64_tr_b16 v[150:151], v7 offset:26112
s_waitcnt lgkmcnt(10)
v_mfma_f32_16x16x32_bf16 v[248:251], v[132:135], v[32:35], v[248:251]
v_mfma_f32_16x16x32_bf16 v[252:255], v[132:135], v[36:39], v[252:255]
ds_read_b64_tr_b16 v[152:153], v4 offset:24704
ds_read_b64_tr_b16 v[154:155], v4 offset:26240
s_waitcnt lgkmcnt(8)
v_mfma_f32_16x16x32_bf16 v[160:163], v[136:139], v[24:27], v[160:163]
v_mfma_f32_16x16x32_bf16 v[164:167], v[136:139], v[28:31], v[164:167]
ds_read_b64_tr_b16 v[156:157], v5 offset:24704
ds_read_b64_tr_b16 v[158:159], v5 offset:26240
s_waitcnt lgkmcnt(8)
v_mfma_f32_16x16x32_bf16 v[168:171], v[140:143], v[24:27], v[168:171]
v_mfma_f32_16x16x32_bf16 v[172:175], v[140:143], v[28:31], v[172:175]
ds_read_b64_tr_b16 v[112:113], v6 offset:24704
ds_read_b64_tr_b16 v[114:115], v6 offset:26240
s_waitcnt lgkmcnt(8)
v_mfma_f32_16x16x32_bf16 v[176:179], v[144:147], v[24:27], v[176:179]
v_mfma_f32_16x16x32_bf16 v[180:183], v[144:147], v[28:31], v[180:183]
ds_read_b64_tr_b16 v[116:117], v7 offset:24704
ds_read_b64_tr_b16 v[118:119], v7 offset:26240
s_waitcnt lgkmcnt(8)
v_mfma_f32_16x16x32_bf16 v[184:187], v[148:151], v[24:27], v[184:187]
v_mfma_f32_16x16x32_bf16 v[188:191], v[148:151], v[28:31], v[188:191]
ds_read_b64_tr_b16 v[120:121], v4 offset:24832
ds_read_b64_tr_b16 v[122:123], v4 offset:26368
s_waitcnt lgkmcnt(8)
v_mfma_f32_16x16x32_bf16 v[192:195], v[152:155], v[24:27], v[192:195]
v_mfma_f32_16x16x32_bf16 v[196:199], v[152:155], v[28:31], v[196:199]
ds_read_b64_tr_b16 v[124:125], v5 offset:24832
ds_read_b64_tr_b16 v[126:127], v5 offset:26368
s_waitcnt lgkmcnt(8)
v_mfma_f32_16x16x32_bf16 v[200:203], v[156:159], v[24:27], v[200:203]
v_mfma_f32_16x16x32_bf16 v[204:207], v[156:159], v[28:31], v[204:207]
ds_read_b64_tr_b16 v[128:129], v6 offset:24832
ds_read_b64_tr_b16 v[130:131], v6 offset:26368
s_waitcnt lgkmcnt(8)
v_mfma_f32_16x16x32_bf16 v[208:211], v[112:115], v[24:27], v[208:211]
v_mfma_f32_16x16x32_bf16 v[212:215], v[112:115], v[28:31], v[212:215]
ds_read_b64_tr_b16 v[132:133], v7 offset:24832
ds_read_b64_tr_b16 v[134:135], v7 offset:26368
s_waitcnt lgkmcnt(8)
v_mfma_f32_16x16x32_bf16 v[216:219], v[116:119], v[24:27], v[216:219]
v_mfma_f32_16x16x32_bf16 v[220:223], v[116:119], v[28:31], v[220:223]
s_waitcnt lgkmcnt(6)
v_mfma_f32_16x16x32_bf16 v[224:227], v[120:123], v[24:27], v[224:227]
v_mfma_f32_16x16x32_bf16 v[228:231], v[120:123], v[28:31], v[228:231]
s_waitcnt lgkmcnt(4)
v_mfma_f32_16x16x32_bf16 v[232:235], v[124:127], v[24:27], v[232:235]
v_mfma_f32_16x16x32_bf16 v[236:239], v[124:127], v[28:31], v[236:239]
s_waitcnt lgkmcnt(2)
v_mfma_f32_16x16x32_bf16 v[240:243], v[128:131], v[24:27], v[240:243]
v_mfma_f32_16x16x32_bf16 v[244:247], v[128:131], v[28:31], v[244:247]
s_waitcnt lgkmcnt(0)
v_mfma_f32_16x16x32_bf16 v[248:251], v[132:135], v[24:27], v[248:251]
v_mfma_f32_16x16x32_bf16 v[252:255], v[132:135], v[28:31], v[252:255]
L_qs5:
s_barrier
ds_read_b128 v[32:35], v3 offset:12288
ds_read_b128 v[36:39], v3 offset:14336
ds_read_b64_tr_b16 v[112:113], v4 offset:36864
ds_read_b64_tr_b16 v[114:115], v4 offset:38400
ds_read_b64_tr_b16 v[116:117], v5 offset:36864
ds_read_b64_tr_b16 v[118:119], v5 offset:38400
ds_read_b64_tr_b16 v[120:121], v6 offset:36864
ds_read_b64_tr_b16 v[122:123], v6 offset:38400
ds_read_b64_tr_b16 v[124:125], v7 offset:36864
ds_read_b64_tr_b16 v[126:127], v7 offset:38400
ds_read_b64_tr_b16 v[128:129], v4 offset:36992
ds_read_b64_tr_b16 v[130:131], v4 offset:38528
s_waitcnt lgkmcnt(8)
v_mfma_f32_16x16x32_bf16 v[160:163], v[112:115], v[32:35], v[160:163]
v_mfma_f32_16x16x32_bf16 v[164:167], v[112:115], v[36:39], v[164:167]
ds_read_b64_tr_b16 v[132:133], v5 offset:36992
ds_read_b64_tr_b16 v[134:135], v5 offset:38528
s_waitcnt lgkmcnt(8)
v_mfma_f32_16x16x32_bf16 v[168:171], v[116:119], v[32:35], v[168:171]
v_mfma_f32_16x16x32_bf16 v[172:175], v[116:119], v[36:39], v[172:175]
ds_read_b64_tr_b16 v[136:137], v6 offset:36992
ds_read_b64_tr_b16 v[138:139], v6 offset:38528
s_waitcnt lgkmcnt(8)
v_mfma_f32_16x16x32_bf16 v[176:179], v[120:123], v[32:35], v[176:179]
v_mfma_f32_16x16x32_bf16 v[180:183], v[120:123], v[36:39], v[180:183]
ds_read_b64_tr_b16 v[140:141], v7 offset:36992
ds_read_b64_tr_b16 v[142:143], v7 offset:38528
s_waitcnt lgkmcnt(8)
v_mfma_f32_16x16x32_bf16 v[184:187], v[124:127], v[32:35], v[184:187]
v_mfma_f32_16x16x32_bf16 v[188:191], v[124:127], v[36:39], v[188:191]
ds_read_b64_tr_b16 v[144:145], v4 offset:37120
ds_read_b64_tr_b16 v[146:147], v4 offset:38656
s_waitcnt lgkmcnt(8)
v_mfma_f32_16x16x32_bf16 v[192:195], v[128:131], v[32:35], v[192:195]
v_mfma_f32_16x16x32_bf16 v[196:199], v[128:131], v[36:39], v[196:199]
ds_read_b64_tr_b16 v[148:149], v5 offset:37120
ds_read_b64_tr_b16 v[150:151], v5 offset:38656
s_waitcnt lgkmcnt(8)
v_mfma_f32_16x16x32_bf16 v[200:203], v[132:135], v[32:35], v[200:203]
v_mfma_f32_16x16x32_bf16 v[204:207], v[132:135], v[36:39], v[204:207]
ds_read_b64_tr_b16 v[152:153], v6 offset:37120
ds_read_b64_tr_b16 v[154:155], v6 offset:38656
s_waitcnt lgkmcnt(8)
v_mfma_f32_16x16x32_bf16 v[208:211], v[136:139], v[32:35], v[208:211]
v_mfma_f32_16x16x32_bf16 v[212:215], v[136:139], v[36:39], v[212:215]
ds_read_b64_tr_b16 v[156:157], v7 offset:37120
ds_read_b64_tr_b16 v[158:159], v7 offset:38656
s_waitcnt lgkmcnt(8)
v_mfma_f32_16x16x32_bf16 v[216:219], v[140:143], v[32:35], v[216:219]
v_mfma_f32_16x16x32_bf16 v[220:223], v[140:143], v[36:39], v[220:223]
s_waitcnt lgkmcnt(6)
v_mfma_f32_16x16x32_bf16 v[224:227], v[144:147], v[32:35], v[224:227]
v_mfma_f32_16x16x32_bf16 v[228:231], v[144:147], v[36:39], v[228:231]
s_waitcnt lgkmcnt(4)
v_mfma_f32_16x16x32_bf16 v[232:235], v[148:151], v[32:35], v[232:235]
v_mfma_f32_16x16x32_bf16 v[236:239], v[148:151], v[36:39], v[236:239]
s_waitcnt lgkmcnt(2)
v_mfma_f32_16x16x32_bf16 v[240:243], v[152:155], v[32:35], v[240:243]
v_mfma_f32_16x16x32_bf16 v[244:247], v[152:155], v[36:39], v[244:247]
s_waitcnt lgkmcnt(0)
v_mfma_f32_16x16x32_bf16 v[248:251], v[156:159], v[32:35], v[248:251]
v_mfma_f32_16x16x32_bf16 v[252:255], v[156:159], v[36:39], v[252:255]
L_qs6:
s_barrier
ds_read_b128 v[24:27], v2 offset:0
ds_read_b128 v[28:31], v2 offset:2048
ds_read_b64_tr_b16 v[112:113], v4 offset:0
ds_read_b64_tr_b16 v[114:115], v4 offset:1536
ds_read_b64_tr_b16 v[116:117], v5 offset:0
ds_read_b64_tr_b16 v[118:119], v5 offset:1536
ds_read_b64_tr_b16 v[120:121], v6 offset:0
ds_read_b64_tr_b16 v[122:123], v6 offset:1536
ds_read_b64_tr_b16 v[124:125], v7 offset:0
ds_read_b64_tr_b16 v[126:127], v7 offset:1536
ds_read_b64_tr_b16 v[128:129], v4 offset:128
ds_read_b64_tr_b16 v[130:131], v4 offset:1664
s_waitcnt lgkmcnt(8)
v_mfma_f32_16x16x32_bf16 v[160:163], v[112:115], v[24:27], v[160:163]
v_mfma_f32_16x16x32_bf16 v[164:167], v[112:115], v[28:31], v[164:167]
ds_read_b64_tr_b16 v[132:133], v5 offset:128
ds_read_b64_tr_b16 v[134:135], v5 offset:1664
s_waitcnt lgkmcnt(8)
v_mfma_f32_16x16x32_bf16 v[168:171], v[116:119], v[24:27], v[168:171]
v_mfma_f32_16x16x32_bf16 v[172:175], v[116:119], v[28:31], v[172:175]
ds_read_b64_tr_b16 v[136:137], v6 offset:128
ds_read_b64_tr_b16 v[138:139], v6 offset:1664
s_waitcnt lgkmcnt(8)
v_mfma_f32_16x16x32_bf16 v[176:179], v[120:123], v[24:27], v[176:179]
v_mfma_f32_16x16x32_bf16 v[180:183], v[120:123], v[28:31], v[180:183]
ds_read_b64_tr_b16 v[140:141], v7 offset:128
ds_read_b64_tr_b16 v[142:143], v7 offset:1664
s_waitcnt lgkmcnt(8)
v_mfma_f32_16x16x32_bf16 v[184:187], v[124:127], v[24:27], v[184:187]
v_mfma_f32_16x16x32_bf16 v[188:191], v[124:127], v[28:31], v[188:191]
ds_read_b64_tr_b16 v[144:145], v4 offset:256
ds_read_b64_tr_b16 v[146:147], v4 offset:1792
s_waitcnt lgkmcnt(8)
v_mfma_f32_16x16x32_bf16 v[192:195], v[128:131], v[24:27], v[192:195]
v_mfma_f32_16x16x32_bf16 v[196:199], v[128:131], v[28:31], v[196:199]
ds_read_b64_tr_b16 v[148:149], v5 offset:256
ds_read_b64_tr_b16 v[150:151], v5 offset:1792
s_waitcnt lgkmcnt(8)
v_mfma_f32_16x16x32_bf16 v[200:203], v[132:135], v[24:27], v[200:203]
v_mfma_f32_16x16x32_bf16 v[204:207], v[132:135], v[28:31], v[204:207]
ds_read_b64_tr_b16 v[152:153], v6 offset:256
ds_read_b64_tr_b16 v[154:155], v6 offset:1792
s_waitcnt lgkmcnt(8)
v_mfma_f32_16x16x32_bf16 v[208:211], v[136:139], v[24:27], v[208:211]
v_mfma_f32_16x16x32_bf16 v[212:215], v[136:139], v[28:31], v[212:215]
ds_read_b64_tr_b16 v[156:157], v7 offset:256
ds_read_b64_tr_b16 v[158:159], v7 offset:1792
s_waitcnt lgkmcnt(8)
v_mfma_f32_16x16x32_bf16 v[216:219], v[140:143], v[24:27], v[216:219]
v_mfma_f32_16x16x32_bf16 v[220:223], v[140:143], v[28:31], v[220:223]
ds_read_b128 v[32:35], v3 offset:0
ds_read_b128 v[36:39], v3 offset:2048
ds_read_b64_tr_b16 v[112:113], v4 offset:12288
ds_read_b64_tr_b16 v[114:115], v4 offset:13824
s_waitcnt lgkmcnt(10)
v_mfma_f32_16x16x32_bf16 v[224:227], v[144:147], v[24:27], v[224:227]
v_mfma_f32_16x16x32_bf16 v[228:231], v[144:147], v[28:31], v[228:231]
ds_read_b64_tr_b16 v[116:117], v5 offset:12288
ds_read_b64_tr_b16 v[118:119], v5 offset:13824
s_waitcnt lgkmcnt(10)
v_mfma_f32_16x16x32_bf16 v[232:235], v[148:151], v[24:27], v[232:235]
v_mfma_f32_16x16x32_bf16 v[236:239], v[148:151], v[28:31], v[236:239]
ds_read_b64_tr_b16 v[120:121], v6 offset:12288
ds_read_b64_tr_b16 v[122:123], v6 offset:13824
s_waitcnt lgkmcnt(10)
v_mfma_f32_16x16x32_bf16 v[240:243], v[152:155], v[24:27], v[240:243]
v_mfma_f32_16x16x32_bf16 v[244:247], v[152:155], v[28:31], v[244:247]
ds_read_b64_tr_b16 v[124:125], v7 offset:12288
ds_read_b64_tr_b16 v[126:127], v7 offset:13824
s_waitcnt lgkmcnt(10)
v_mfma_f32_16x16x32_bf16 v[248:251], v[156:159], v[24:27], v[248:251]
v_mfma_f32_16x16x32_bf16 v[252:255], v[156:159], v[28:31], v[252:255]
ds_read_b64_tr_b16 v[128:129], v4 offset:12416
ds_read_b64_tr_b16 v[130:131], v4 offset:13952
s_waitcnt lgkmcnt(8)
v_mfma_f32_16x16x32_bf16 v[160:163], v[112:115], v[32:35], v[160:163]
v_mfma_f32_16x16x32_bf16 v[164:167], v[112:115], v[36:39], v[164:167]
ds_read_b64_tr_b16 v[132:133], v5 offset:12416
ds_read_b64_tr_b16 v[134:135], v5 offset:13952
s_waitcnt lgkmcnt(8)
v_mfma_f32_16x16x32_bf16 v[168:171], v[116:119], v[32:35], v[168:171]
v_mfma_f32_16x16x32_bf16 v[172:175], v[116:119], v[36:39], v[172:175]
s_waitcnt lgkmcnt(6)
v_mfma_f32_16x16x32_bf16 v[176:179], v[120:123], v[32:35], v[176:179]
v_mfma_f32_16x16x32_bf16 v[180:183], v[120:123], v[36:39], v[180:183]
s_waitcnt lgkmcnt(4)
v_mfma_f32_16x16x32_bf16 v[184:187], v[124:127], v[32:35], v[184:187]
v_mfma_f32_16x16x32_bf16 v[188:191], v[124:127], v[36:39], v[188:191]
s_waitcnt lgkmcnt(2)
v_mfma_f32_16x16x32_bf16 v[192:195], v[128:131], v[32:35], v[192:195]
v_mfma_f32_16x16x32_bf16 v[196:199], v[128:131], v[36:39], v[196:199]
s_waitcnt lgkmcnt(0)
v_mfma_f32_16x16x32_bf16 v[200:203], v[132:135], v[32:35], v[200:203]
v_mfma_f32_16x16x32_bf16 v[204:207], v[132:135], v[36:39], v[204:207]
L_qs7:
s_barrier
ds_read_b64_tr_b16 v[112:113], v6 offset:12416
ds_read_b64_tr_b16 v[114:115], v6 offset:13952
ds_read_b64_tr_b16 v[116:117], v7 offset:12416
ds_read_b64_tr_b16 v[118:119], v7 offset:13952
ds_read_b64_tr_b16 v[120:121], v4 offset:12544
ds_read_b64_tr_b16 v[122:123], v4 offset:14080
ds_read_b64_tr_b16 v[124:125], v5 offset:12544
ds_read_b64_tr_b16 v[126:127], v5 offset:14080
ds_read_b64_tr_b16 v[128:129], v6 offset:12544
ds_read_b64_tr_b16 v[130:131], v6 offset:14080
s_waitcnt lgkmcnt(8)
v_mfma_f32_16x16x32_bf16 v[208:211], v[112:115], v[32:35], v[208:211]
v_mfma_f32_16x16x32_bf16 v[212:215], v[112:115], v[36:39], v[212:215]
ds_read_b64_tr_b16 v[132:133], v7 offset:12544
ds_read_b64_tr_b16 v[134:135], v7 offset:14080
s_waitcnt lgkmcnt(8)
v_mfma_f32_16x16x32_bf16 v[216:219], v[116:119], v[32:35], v[216:219]
v_mfma_f32_16x16x32_bf16 v[220:223], v[116:119], v[36:39], v[220:223]
ds_read_b128 v[24:27], v2 offset:12288
ds_read_b128 v[28:31], v2 offset:14336
ds_read_b64_tr_b16 v[136:137], v4 offset:24576
ds_read_b64_tr_b16 v[138:139], v4 offset:26112
s_waitcnt lgkmcnt(10)
v_mfma_f32_16x16x32_bf16 v[224:227], v[120:123], v[32:35], v[224:227]
v_mfma_f32_16x16x32_bf16 v[228:231], v[120:123], v[36:39], v[228:231]
ds_read_b64_tr_b16 v[140:141], v5 offset:24576
ds_read_b64_tr_b16 v[142:143], v5 offset:26112
s_waitcnt lgkmcnt(10)
v_mfma_f32_16x16x32_bf16 v[232:235], v[124:127], v[32:35], v[232:235]
v_mfma_f32_16x16x32_bf16 v[236:239], v[124:127], v[36:39], v[236:239]
ds_read_b64_tr_b16 v[144:145], v6 offset:24576
ds_read_b64_tr_b16 v[146:147], v6 offset:26112
s_waitcnt lgkmcnt(10)
v_mfma_f32_16x16x32_bf16 v[240:243], v[128:131], v[32:35], v[240:243]
v_mfma_f32_16x16x32_bf16 v[244:247], v[128:131], v[36:39], v[244:247]
ds_read_b64_tr_b16 v[148:149], v7 offset:24576
ds_read_b64_tr_b16 v[150:151], v7 offset:26112
s_waitcnt lgkmcnt(10)
v_mfma_f32_16x16x32_bf16 v[248:251], v[132:135], v[32:35], v[248:251]
v_mfma_f32_16x16x32_bf16 v[252:255], v[132:135], v[36:39], v[252:255]
ds_read_b64_tr_b16 v[152:153], v4 offset:24704
ds_read_b64_tr_b16 v[154:155], v4 offset:26240
s_waitcnt lgkmcnt(8)
v_mfma_f32_16x16x32_bf16 v[160:163], v[136:139], v[24:27], v[160:163]
v_mfma_f32_16x16x32_bf16 v[164:167], v[136:139], v[28:31], v[164:167]
ds_read_b64_tr_b16 v[156:157], v5 offset:24704
ds_read_b64_tr_b16 v[158:159], v5 offset:26240
s_waitcnt lgkmcnt(8)
v_mfma_f32_16x16x32_bf16 v[168:171], v[140:143], v[24:27], v[168:171]
v_mfma_f32_16x16x32_bf16 v[172:175], v[140:143], v[28:31], v[172:175]
ds_read_b64_tr_b16 v[112:113], v6 offset:24704
ds_read_b64_tr_b16 v[114:115], v6 offset:26240
s_waitcnt lgkmcnt(8)
v_mfma_f32_16x16x32_bf16 v[176:179], v[144:147], v[24:27], v[176:179]
v_mfma_f32_16x16x32_bf16 v[180:183], v[144:147], v[28:31], v[180:183]
ds_read_b64_tr_b16 v[116:117], v7 offset:24704
ds_read_b64_tr_b16 v[118:119], v7 offset:26240
s_waitcnt lgkmcnt(8)
v_mfma_f32_16x16x32_bf16 v[184:187], v[148:151], v[24:27], v[184:187]
v_mfma_f32_16x16x32_bf16 v[188:191], v[148:151], v[28:31], v[188:191]
ds_read_b64_tr_b16 v[120:121], v4 offset:24832
ds_read_b64_tr_b16 v[122:123], v4 offset:26368
s_waitcnt lgkmcnt(8)
v_mfma_f32_16x16x32_bf16 v[192:195], v[152:155], v[24:27], v[192:195]
v_mfma_f32_16x16x32_bf16 v[196:199], v[152:155], v[28:31], v[196:199]
ds_read_b64_tr_b16 v[124:125], v5 offset:24832
ds_read_b64_tr_b16 v[126:127], v5 offset:26368
s_waitcnt lgkmcnt(8)
v_mfma_f32_16x16x32_bf16 v[200:203], v[156:159], v[24:27], v[200:203]
v_mfma_f32_16x16x32_bf16 v[204:207], v[156:159], v[28:31], v[204:207]
ds_read_b64_tr_b16 v[128:129], v6 offset:24832
ds_read_b64_tr_b16 v[130:131], v6 offset:26368
s_waitcnt lgkmcnt(8)
v_mfma_f32_16x16x32_bf16 v[208:211], v[112:115], v[24:27], v[208:211]
v_mfma_f32_16x16x32_bf16 v[212:215], v[112:115], v[28:31], v[212:215]
ds_read_b64_tr_b16 v[132:133], v7 offset:24832
ds_read_b64_tr_b16 v[134:135], v7 offset:26368
s_waitcnt lgkmcnt(8)
v_mfma_f32_16x16x32_bf16 v[216:219], v[116:119], v[24:27], v[216:219]
v_mfma_f32_16x16x32_bf16 v[220:223], v[116:119], v[28:31], v[220:223]
s_waitcnt lgkmcnt(6)
v_mfma_f32_16x16x32_bf16 v[224:227], v[120:123], v[24:27], v[224:227]
v_mfma_f32_16x16x32_bf16 v[228:231], v[120:123], v[28:31], v[228:231]
s_waitcnt lgkmcnt(4)
v_mfma_f32_16x16x32_bf16 v[232:235], v[124:127], v[24:27], v[232:235]
v_mfma_f32_16x16x32_bf16 v[236:239], v[124:127], v[28:31], v[236:239]
s_waitcnt lgkmcnt(2)
v_mfma_f32_16x16x32_bf16 v[240:243], v[128:131], v[24:27], v[240:243]
v_mfma_f32_16x16x32_bf16 v[244:247], v[128:131], v[28:31], v[244:247]
s_waitcnt lgkmcnt(0)
v_mfma_f32_16x16x32_bf16 v[248:251], v[132:135], v[24:27], v[248:251]
v_mfma_f32_16x16x32_bf16 v[252:255], v[132:135], v[28:31], v[252:255]
L_qs8:
s_barrier
ds_read_b128 v[32:35], v3 offset:12288
ds_read_b128 v[36:39], v3 offset:14336
ds_read_b64_tr_b16 v[112:113], v4 offset:36864
ds_read_b64_tr_b16 v[114:115], v4 offset:38400
ds_read_b64_tr_b16 v[116:117], v5 offset:36864
ds_read_b64_tr_b16 v[118:119], v5 offset:38400
ds_read_b64_tr_b16 v[120:121], v6 offset:36864
ds_read_b64_tr_b16 v[122:123], v6 offset:38400
ds_read_b64_tr_b16 v[124:125], v7 offset:36864
ds_read_b64_tr_b16 v[126:127], v7 offset:38400
ds_read_b64_tr_b16 v[128:129], v4 offset:36992
ds_read_b64_tr_b16 v[130:131], v4 offset:38528
s_waitcnt lgkmcnt(8)
v_mfma_f32_16x16x32_bf16 v[160:163], v[112:115], v[32:35], v[160:163]
v_mfma_f32_16x16x32_bf16 v[164:167], v[112:115], v[36:39], v[164:167]
ds_read_b64_tr_b16 v[132:133], v5 offset:36992
ds_read_b64_tr_b16 v[134:135], v5 offset:38528
s_waitcnt lgkmcnt(8)
v_mfma_f32_16x16x32_bf16 v[168:171], v[116:119], v[32:35], v[168:171]
v_mfma_f32_16x16x32_bf16 v[172:175], v[116:119], v[36:39], v[172:175]
ds_read_b64_tr_b16 v[136:137], v6 offset:36992
ds_read_b64_tr_b16 v[138:139], v6 offset:38528
s_waitcnt lgkmcnt(8)
v_mfma_f32_16x16x32_bf16 v[176:179], v[120:123], v[32:35], v[176:179]
v_mfma_f32_16x16x32_bf16 v[180:183], v[120:123], v[36:39], v[180:183]
ds_read_b64_tr_b16 v[140:141], v7 offset:36992
ds_read_b64_tr_b16 v[142:143], v7 offset:38528
s_waitcnt lgkmcnt(8)
v_mfma_f32_16x16x32_bf16 v[184:187], v[124:127], v[32:35], v[184:187]
v_mfma_f32_16x16x32_bf16 v[188:191], v[124:127], v[36:39], v[188:191]
ds_read_b64_tr_b16 v[144:145], v4 offset:37120
ds_read_b64_tr_b16 v[146:147], v4 offset:38656
s_waitcnt lgkmcnt(8)
v_mfma_f32_16x16x32_bf16 v[192:195], v[128:131], v[32:35], v[192:195]
v_mfma_f32_16x16x32_bf16 v[196:199], v[128:131], v[36:39], v[196:199]
ds_read_b64_tr_b16 v[148:149], v5 offset:37120
ds_read_b64_tr_b16 v[150:151], v5 offset:38656
s_waitcnt lgkmcnt(8)
v_mfma_f32_16x16x32_bf16 v[200:203], v[132:135], v[32:35], v[200:203]
v_mfma_f32_16x16x32_bf16 v[204:207], v[132:135], v[36:39], v[204:207]
ds_read_b64_tr_b16 v[152:153], v6 offset:37120
ds_read_b64_tr_b16 v[154:155], v6 offset:38656
s_waitcnt lgkmcnt(8)
v_mfma_f32_16x16x32_bf16 v[208:211], v[136:139], v[32:35], v[208:211]
v_mfma_f32_16x16x32_bf16 v[212:215], v[136:139], v[36:39], v[212:215]
ds_read_b64_tr_b16 v[156:157], v7 offset:37120
ds_read_b64_tr_b16 v[158:159], v7 offset:38656
s_waitcnt lgkmcnt(8)
v_mfma_f32_16x16x32_bf16 v[216:219], v[140:143], v[32:35], v[216:219]
v_mfma_f32_16x16x32_bf16 v[220:223], v[140:143], v[36:39], v[220:223]
s_waitcnt lgkmcnt(6)
v_mfma_f32_16x16x32_bf16 v[224:227], v[144:147], v[32:35], v[224:227]
v_mfma_f32_16x16x32_bf16 v[228:231], v[144:147], v[36:39], v[228:231]
s_waitcnt lgkmcnt(4)
v_mfma_f32_16x16x32_bf16 v[232:235], v[148:151], v[32:35], v[232:235]
v_mfma_f32_16x16x32_bf16 v[236:239], v[148:151], v[36:39], v[236:239]
s_waitcnt lgkmcnt(2)
v_mfma_f32_16x16x32_bf16 v[240:243], v[152:155], v[32:35], v[240:243]
v_mfma_f32_16x16x32_bf16 v[244:247], v[152:155], v[36:39], v[244:247]
s_waitcnt lgkmcnt(0)
v_mfma_f32_16x16x32_bf16 v[248:251], v[156:159], v[32:35], v[248:251]
v_mfma_f32_16x16x32_bf16 v[252:255], v[156:159], v[36:39], v[252:255]
L_qs9:
s_barrier
ds_read_b128 v[24:27], v2 offset:0
ds_read_b128 v[28:31], v2 offset:2048
ds_read_b64_tr_b16 v[112:113], v4 offset:0
ds_read_b64_tr_b16 v[114:115], v4 offset:1536
ds_read_b64_tr_b16 v[116:117], v5 offset:0
ds_read_b64_tr_b16 v[118:119], v5 offset:1536
ds_read_b64_tr_b16 v[120:121], v6 offset:0
ds_read_b64_tr_b16 v[122:123], v6 offset:1536
ds_read_b64_tr_b16 v[124:125], v7 offset:0
ds_read_b64_tr_b16 v[126:127], v7 offset:1536
ds_read_b64_tr_b16 v[128:129], v4 offset:128
ds_read_b64_tr_b16 v[130:131], v4 offset:1664
s_waitcnt lgkmcnt(8)
v_mfma_f32_16x16x32_bf16 v[160:163], v[112:115], v[24:27], v[160:163]
v_mfma_f32_16x16x32_bf16 v[164:167], v[112:115], v[28:31], v[164:167]
ds_read_b64_tr_b16 v[132:133], v5 offset:128
ds_read_b64_tr_b16 v[134:135], v5 offset:1664
s_waitcnt lgkmcnt(8)
v_mfma_f32_16x16x32_bf16 v[168:171], v[116:119], v[24:27], v[168:171]
v_mfma_f32_16x16x32_bf16 v[172:175], v[116:119], v[28:31], v[172:175]
ds_read_b64_tr_b16 v[136:137], v6 offset:128
ds_read_b64_tr_b16 v[138:139], v6 offset:1664
s_waitcnt lgkmcnt(8)
v_mfma_f32_16x16x32_bf16 v[176:179], v[120:123], v[24:27], v[176:179]
v_mfma_f32_16x16x32_bf16 v[180:183], v[120:123], v[28:31], v[180:183]
ds_read_b64_tr_b16 v[140:141], v7 offset:128
ds_read_b64_tr_b16 v[142:143], v7 offset:1664
s_waitcnt lgkmcnt(8)
v_mfma_f32_16x16x32_bf16 v[184:187], v[124:127], v[24:27], v[184:187]
v_mfma_f32_16x16x32_bf16 v[188:191], v[124:127], v[28:31], v[188:191]
ds_read_b64_tr_b16 v[144:145], v4 offset:256
ds_read_b64_tr_b16 v[146:147], v4 offset:1792
s_waitcnt lgkmcnt(8)
v_mfma_f32_16x16x32_bf16 v[192:195], v[128:131], v[24:27], v[192:195]
v_mfma_f32_16x16x32_bf16 v[196:199], v[128:131], v[28:31], v[196:199]
ds_read_b64_tr_b16 v[148:149], v5 offset:256
ds_read_b64_tr_b16 v[150:151], v5 offset:1792
s_waitcnt lgkmcnt(8)
v_mfma_f32_16x16x32_bf16 v[200:203], v[132:135], v[24:27], v[200:203]
v_mfma_f32_16x16x32_bf16 v[204:207], v[132:135], v[28:31], v[204:207]
ds_read_b64_tr_b16 v[152:153], v6 offset:256
ds_read_b64_tr_b16 v[154:155], v6 offset:1792
s_waitcnt lgkmcnt(8)
v_mfma_f32_16x16x32_bf16 v[208:211], v[136:139], v[24:27], v[208:211]
v_mfma_f32_16x16x32_bf16 v[212:215], v[136:139], v[28:31], v[212:215]
ds_read_b64_tr_b16 v[156:157], v7 offset:256
ds_read_b64_tr_b16 v[158:159], v7 offset:1792
s_waitcnt lgkmcnt(8)
v_mfma_f32_16x16x32_bf16 v[216:219], v[140:143], v[24:27], v[216:219]
v_mfma_f32_16x16x32_bf16 v[220:223], v[140:143], v[28:31], v[220:223]
ds_read_b128 v[32:35], v3 offset:0
ds_read_b128 v[36:39], v3 offset:2048
ds_read_b64_tr_b16 v[112:113], v4 offset:12288
ds_read_b64_tr_b16 v[114:115], v4 offset:13824
s_waitcnt lgkmcnt(10)
v_mfma_f32_16x16x32_bf16 v[224:227], v[144:147], v[24:27], v[224:227]
v_mfma_f32_16x16x32_bf16 v[228:231], v[144:147], v[28:31], v[228:231]
ds_read_b64_tr_b16 v[116:117], v5 offset:12288
ds_read_b64_tr_b16 v[118:119], v5 offset:13824
s_waitcnt lgkmcnt(10)
v_mfma_f32_16x16x32_bf16 v[232:235], v[148:151], v[24:27], v[232:235]
v_mfma_f32_16x16x32_bf16 v[236:239], v[148:151], v[28:31], v[236:239]
ds_read_b64_tr_b16 v[120:121], v6 offset:12288
ds_read_b64_tr_b16 v[122:123], v6 offset:13824
s_waitcnt lgkmcnt(10)
v_mfma_f32_16x16x32_bf16 v[240:243], v[152:155], v[24:27], v[240:243]
v_mfma_f32_16x16x32_bf16 v[244:247], v[152:155], v[28:31], v[244:247]
ds_read_b64_tr_b16 v[124:125], v7 offset:12288
ds_read_b64_tr_b16 v[126:127], v7 offset:13824
s_waitcnt lgkmcnt(10)
v_mfma_f32_16x16x32_bf16 v[248:251], v[156:159], v[24:27], v[248:251]
v_mfma_f32_16x16x32_bf16 v[252:255], v[156:159], v[28:31], v[252:255]
ds_read_b64_tr_b16 v[128:129], v4 offset:12416
ds_read_b64_tr_b16 v[130:131], v4 offset:13952
s_waitcnt lgkmcnt(8)
v_mfma_f32_16x16x32_bf16 v[160:163], v[112:115], v[32:35], v[160:163]
v_mfma_f32_16x16x32_bf16 v[164:167], v[112:115], v[36:39], v[164:167]
ds_read_b64_tr_b16 v[132:133], v5 offset:12416
ds_read_b64_tr_b16 v[134:135], v5 offset:13952
s_waitcnt lgkmcnt(8)
v_mfma_f32_16x16x32_bf16 v[168:171], v[116:119], v[32:35], v[168:171]
v_mfma_f32_16x16x32_bf16 v[172:175], v[116:119], v[36:39], v[172:175]
s_waitcnt lgkmcnt(6)
v_mfma_f32_16x16x32_bf16 v[176:179], v[120:123], v[32:35], v[176:179]
v_mfma_f32_16x16x32_bf16 v[180:183], v[120:123], v[36:39], v[180:183]
s_waitcnt lgkmcnt(4)
v_mfma_f32_16x16x32_bf16 v[184:187], v[124:127], v[32:35], v[184:187]
v_mfma_f32_16x16x32_bf16 v[188:191], v[124:127], v[36:39], v[188:191]
s_waitcnt lgkmcnt(2)
v_mfma_f32_16x16x32_bf16 v[192:195], v[128:131], v[32:35], v[192:195]
v_mfma_f32_16x16x32_bf16 v[196:199], v[128:131], v[36:39], v[196:199]
s_waitcnt lgkmcnt(0)
v_mfma_f32_16x16x32_bf16 v[200:203], v[132:135], v[32:35], v[200:203]
v_mfma_f32_16x16x32_bf16 v[204:207], v[132:135], v[36:39], v[204:207]
L_qs10:
s_barrier
ds_read_b64_tr_b16 v[112:113], v6 offset:12416
ds_read_b64_tr_b16 v[114:115], v6 offset:13952
ds_read_b64_tr_b16 v[116:117], v7 offset:12416
ds_read_b64_tr_b16 v[118:119], v7 offset:13952
ds_read_b64_tr_b16 v[120:121], v4 offset:12544
ds_read_b64_tr_b16 v[122:123], v4 offset:14080
ds_read_b64_tr_b16 v[124:125], v5 offset:12544
ds_read_b64_tr_b16 v[126:127], v5 offset:14080
ds_read_b64_tr_b16 v[128:129], v6 offset:12544
ds_read_b64_tr_b16 v[130:131], v6 offset:14080
s_waitcnt lgkmcnt(8)
v_mfma_f32_16x16x32_bf16 v[208:211], v[112:115], v[32:35], v[208:211]
v_mfma_f32_16x16x32_bf16 v[212:215], v[112:115], v[36:39], v[212:215]
ds_read_b64_tr_b16 v[132:133], v7 offset:12544
ds_read_b64_tr_b16 v[134:135], v7 offset:14080
s_waitcnt lgkmcnt(8)
v_mfma_f32_16x16x32_bf16 v[216:219], v[116:119], v[32:35], v[216:219]
v_mfma_f32_16x16x32_bf16 v[220:223], v[116:119], v[36:39], v[220:223]
ds_read_b128 v[24:27], v2 offset:12288
ds_read_b128 v[28:31], v2 offset:14336
ds_read_b64_tr_b16 v[136:137], v4 offset:24576
ds_read_b64_tr_b16 v[138:139], v4 offset:26112
s_waitcnt lgkmcnt(10)
v_mfma_f32_16x16x32_bf16 v[224:227], v[120:123], v[32:35], v[224:227]
v_mfma_f32_16x16x32_bf16 v[228:231], v[120:123], v[36:39], v[228:231]
ds_read_b64_tr_b16 v[140:141], v5 offset:24576
ds_read_b64_tr_b16 v[142:143], v5 offset:26112
s_waitcnt lgkmcnt(10)
v_mfma_f32_16x16x32_bf16 v[232:235], v[124:127], v[32:35], v[232:235]
v_mfma_f32_16x16x32_bf16 v[236:239], v[124:127], v[36:39], v[236:239]
ds_read_b64_tr_b16 v[144:145], v6 offset:24576
ds_read_b64_tr_b16 v[146:147], v6 offset:26112
s_waitcnt lgkmcnt(10)
v_mfma_f32_16x16x32_bf16 v[240:243], v[128:131], v[32:35], v[240:243]
v_mfma_f32_16x16x32_bf16 v[244:247], v[128:131], v[36:39], v[244:247]
ds_read_b64_tr_b16 v[148:149], v7 offset:24576
ds_read_b64_tr_b16 v[150:151], v7 offset:26112
s_waitcnt lgkmcnt(10)
v_mfma_f32_16x16x32_bf16 v[248:251], v[132:135], v[32:35], v[248:251]
v_mfma_f32_16x16x32_bf16 v[252:255], v[132:135], v[36:39], v[252:255]
ds_read_b64_tr_b16 v[152:153], v4 offset:24704
ds_read_b64_tr_b16 v[154:155], v4 offset:26240
s_waitcnt lgkmcnt(8)
v_mfma_f32_16x16x32_bf16 v[160:163], v[136:139], v[24:27], v[160:163]
v_mfma_f32_16x16x32_bf16 v[164:167], v[136:139], v[28:31], v[164:167]
ds_read_b64_tr_b16 v[156:157], v5 offset:24704
ds_read_b64_tr_b16 v[158:159], v5 offset:26240
s_waitcnt lgkmcnt(8)
v_mfma_f32_16x16x32_bf16 v[168:171], v[140:143], v[24:27], v[168:171]
v_mfma_f32_16x16x32_bf16 v[172:175], v[140:143], v[28:31], v[172:175]
ds_read_b64_tr_b16 v[112:113], v6 offset:24704
ds_read_b64_tr_b16 v[114:115], v6 offset:26240
s_waitcnt lgkmcnt(8)
v_mfma_f32_16x16x32_bf16 v[176:179], v[144:147], v[24:27], v[176:179]
v_mfma_f32_16x16x32_bf16 v[180:183], v[144:147], v[28:31], v[180:183]
ds_read_b64_tr_b16 v[116:117], v7 offset:24704
ds_read_b64_tr_b16 v[118:119], v7 offset:26240
s_waitcnt lgkmcnt(8)
v_mfma_f32_16x16x32_bf16 v[184:187], v[148:151], v[24:27], v[184:187]
v_mfma_f32_16x16x32_bf16 v[188:191], v[148:151], v[28:31], v[188:191]
ds_read_b64_tr_b16 v[120:121], v4 offset:24832
ds_read_b64_tr_b16 v[122:123], v4 offset:26368
s_waitcnt lgkmcnt(8)
v_mfma_f32_16x16x32_bf16 v[192:195], v[152:155], v[24:27], v[192:195]
v_mfma_f32_16x16x32_bf16 v[196:199], v[152:155], v[28:31], v[196:199]
ds_read_b64_tr_b16 v[124:125], v5 offset:24832
ds_read_b64_tr_b16 v[126:127], v5 offset:26368
s_waitcnt lgkmcnt(8)
v_mfma_f32_16x16x32_bf16 v[200:203], v[156:159], v[24:27], v[200:203]
v_mfma_f32_16x16x32_bf16 v[204:207], v[156:159], v[28:31], v[204:207]
ds_read_b64_tr_b16 v[128:129], v6 offset:24832
ds_read_b64_tr_b16 v[130:131], v6 offset:26368
s_waitcnt lgkmcnt(8)
v_mfma_f32_16x16x32_bf16 v[208:211], v[112:115], v[24:27], v[208:211]
v_mfma_f32_16x16x32_bf16 v[212:215], v[112:115], v[28:31], v[212:215]
ds_read_b64_tr_b16 v[132:133], v7 offset:24832
ds_read_b64_tr_b16 v[134:135], v7 offset:26368
s_waitcnt lgkmcnt(8)
v_mfma_f32_16x16x32_bf16 v[216:219], v[116:119], v[24:27], v[216:219]
v_mfma_f32_16x16x32_bf16 v[220:223], v[116:119], v[28:31], v[220:223]
s_waitcnt lgkmcnt(6)
v_mfma_f32_16x16x32_bf16 v[224:227], v[120:123], v[24:27], v[224:227]
v_mfma_f32_16x16x32_bf16 v[228:231], v[120:123], v[28:31], v[228:231]
s_waitcnt lgkmcnt(4)
v_mfma_f32_16x16x32_bf16 v[232:235], v[124:127], v[24:27], v[232:235]
v_mfma_f32_16x16x32_bf16 v[236:239], v[124:127], v[28:31], v[236:239]
s_waitcnt lgkmcnt(2)
v_mfma_f32_16x16x32_bf16 v[240:243], v[128:131], v[24:27], v[240:243]
v_mfma_f32_16x16x32_bf16 v[244:247], v[128:131], v[28:31], v[244:247]
s_waitcnt lgkmcnt(0)
v_mfma_f32_16x16x32_bf16 v[248:251], v[132:135], v[24:27], v[248:251]
v_mfma_f32_16x16x32_bf16 v[252:255], v[132:135], v[28:31], v[252:255]
L_qs11:
s_barrier
ds_read_b128 v[32:35], v3 offset:12288
ds_read_b128 v[36:39], v3 offset:14336
ds_read_b64_tr_b16 v[112:113], v4 offset:36864
ds_read_b64_tr_b16 v[114:115], v4 offset:38400
ds_read_b64_tr_b16 v[116:117], v5 offset:36864
ds_read_b64_tr_b16 v[118:119], v5 offset:38400
ds_read_b64_tr_b16 v[120:121], v6 offset:36864
ds_read_b64_tr_b16 v[122:123], v6 offset:38400
ds_read_b64_tr_b16 v[124:125], v7 offset:36864
ds_read_b64_tr_b16 v[126:127], v7 offset:38400
ds_read_b64_tr_b16 v[128:129], v4 offset:36992
ds_read_b64_tr_b16 v[130:131], v4 offset:38528
s_waitcnt lgkmcnt(8)
v_mfma_f32_16x16x32_bf16 v[160:163], v[112:115], v[32:35], v[160:163]
v_mfma_f32_16x16x32_bf16 v[164:167], v[112:115], v[36:39], v[164:167]
ds_read_b64_tr_b16 v[132:133], v5 offset:36992
ds_read_b64_tr_b16 v[134:135], v5 offset:38528
s_waitcnt lgkmcnt(8)
v_mfma_f32_16x16x32_bf16 v[168:171], v[116:119], v[32:35], v[168:171]
v_mfma_f32_16x16x32_bf16 v[172:175], v[116:119], v[36:39], v[172:175]
ds_read_b64_tr_b16 v[136:137], v6 offset:36992
ds_read_b64_tr_b16 v[138:139], v6 offset:38528
s_waitcnt lgkmcnt(8)
v_mfma_f32_16x16x32_bf16 v[176:179], v[120:123], v[32:35], v[176:179]
v_mfma_f32_16x16x32_bf16 v[180:183], v[120:123], v[36:39], v[180:183]
ds_read_b64_tr_b16 v[140:141], v7 offset:36992
ds_read_b64_tr_b16 v[142:143], v7 offset:38528
s_waitcnt lgkmcnt(8)
v_mfma_f32_16x16x32_bf16 v[184:187], v[124:127], v[32:35], v[184:187]
v_mfma_f32_16x16x32_bf16 v[188:191], v[124:127], v[36:39], v[188:191]
ds_read_b64_tr_b16 v[144:145], v4 offset:37120
ds_read_b64_tr_b16 v[146:147], v4 offset:38656
s_waitcnt lgkmcnt(8)
v_mfma_f32_16x16x32_bf16 v[192:195], v[128:131], v[32:35], v[192:195]
v_mfma_f32_16x16x32_bf16 v[196:199], v[128:131], v[36:39], v[196:199]
ds_read_b64_tr_b16 v[148:149], v5 offset:37120
ds_read_b64_tr_b16 v[150:151], v5 offset:38656
s_waitcnt lgkmcnt(8)
v_mfma_f32_16x16x32_bf16 v[200:203], v[132:135], v[32:35], v[200:203]
v_mfma_f32_16x16x32_bf16 v[204:207], v[132:135], v[36:39], v[204:207]
ds_read_b64_tr_b16 v[152:153], v6 offset:37120
ds_read_b64_tr_b16 v[154:155], v6 offset:38656
s_waitcnt lgkmcnt(8)
v_mfma_f32_16x16x32_bf16 v[208:211], v[136:139], v[32:35], v[208:211]
v_mfma_f32_16x16x32_bf16 v[212:215], v[136:139], v[36:39], v[212:215]
ds_read_b64_tr_b16 v[156:157], v7 offset:37120
ds_read_b64_tr_b16 v[158:159], v7 offset:38656
s_waitcnt lgkmcnt(8)
v_mfma_f32_16x16x32_bf16 v[216:219], v[140:143], v[32:35], v[216:219]
v_mfma_f32_16x16x32_bf16 v[220:223], v[140:143], v[36:39], v[220:223]
s_waitcnt lgkmcnt(6)
v_mfma_f32_16x16x32_bf16 v[224:227], v[144:147], v[32:35], v[224:227]
v_mfma_f32_16x16x32_bf16 v[228:231], v[144:147], v[36:39], v[228:231]
s_waitcnt lgkmcnt(4)
v_mfma_f32_16x16x32_bf16 v[232:235], v[148:151], v[32:35], v[232:235]
v_mfma_f32_16x16x32_bf16 v[236:239], v[148:151], v[36:39], v[236:239]
s_waitcnt lgkmcnt(2)
v_mfma_f32_16x16x32_bf16 v[240:243], v[152:155], v[32:35], v[240:243]
v_mfma_f32_16x16x32_bf16 v[244:247], v[152:155], v[36:39], v[244:247]
s_waitcnt lgkmcnt(0)
v_mfma_f32_16x16x32_bf16 v[248:251], v[156:159], v[32:35], v[248:251]
v_mfma_f32_16x16x32_bf16 v[252:255], v[156:159], v[36:39], v[252:255]
L_qs12:
s_barrier
ds_read_b128 v[24:27], v2 offset:0
ds_read_b128 v[28:31], v2 offset:2048
ds_read_b64_tr_b16 v[112:113], v4 offset:0
ds_read_b64_tr_b16 v[114:115], v4 offset:1536
ds_read_b64_tr_b16 v[116:117], v5 offset:0
ds_read_b64_tr_b16 v[118:119], v5 offset:1536
ds_read_b64_tr_b16 v[120:121], v6 offset:0
ds_read_b64_tr_b16 v[122:123], v6 offset:1536
ds_read_b64_tr_b16 v[124:125], v7 offset:0
ds_read_b64_tr_b16 v[126:127], v7 offset:1536
ds_read_b64_tr_b16 v[128:129], v4 offset:128
ds_read_b64_tr_b16 v[130:131], v4 offset:1664
s_waitcnt lgkmcnt(8)
v_mfma_f32_16x16x32_bf16 v[160:163], v[112:115], v[24:27], v[160:163]
v_mfma_f32_16x16x32_bf16 v[164:167], v[112:115], v[28:31], v[164:167]
ds_read_b64_tr_b16 v[132:133], v5 offset:128
ds_read_b64_tr_b16 v[134:135], v5 offset:1664
s_waitcnt lgkmcnt(8)
v_mfma_f32_16x16x32_bf16 v[168:171], v[116:119], v[24:27], v[168:171]
v_mfma_f32_16x16x32_bf16 v[172:175], v[116:119], v[28:31], v[172:175]
ds_read_b64_tr_b16 v[136:137], v6 offset:128
ds_read_b64_tr_b16 v[138:139], v6 offset:1664
s_waitcnt lgkmcnt(8)
v_mfma_f32_16x16x32_bf16 v[176:179], v[120:123], v[24:27], v[176:179]
v_mfma_f32_16x16x32_bf16 v[180:183], v[120:123], v[28:31], v[180:183]
ds_read_b64_tr_b16 v[140:141], v7 offset:128
ds_read_b64_tr_b16 v[142:143], v7 offset:1664
s_waitcnt lgkmcnt(8)
v_mfma_f32_16x16x32_bf16 v[184:187], v[124:127], v[24:27], v[184:187]
v_mfma_f32_16x16x32_bf16 v[188:191], v[124:127], v[28:31], v[188:191]
ds_read_b64_tr_b16 v[144:145], v4 offset:256
ds_read_b64_tr_b16 v[146:147], v4 offset:1792
s_waitcnt lgkmcnt(8)
v_mfma_f32_16x16x32_bf16 v[192:195], v[128:131], v[24:27], v[192:195]
v_mfma_f32_16x16x32_bf16 v[196:199], v[128:131], v[28:31], v[196:199]
ds_read_b64_tr_b16 v[148:149], v5 offset:256
ds_read_b64_tr_b16 v[150:151], v5 offset:1792
s_waitcnt lgkmcnt(8)
v_mfma_f32_16x16x32_bf16 v[200:203], v[132:135], v[24:27], v[200:203]
v_mfma_f32_16x16x32_bf16 v[204:207], v[132:135], v[28:31], v[204:207]
ds_read_b64_tr_b16 v[152:153], v6 offset:256
ds_read_b64_tr_b16 v[154:155], v6 offset:1792
s_waitcnt lgkmcnt(8)
v_mfma_f32_16x16x32_bf16 v[208:211], v[136:139], v[24:27], v[208:211]
v_mfma_f32_16x16x32_bf16 v[212:215], v[136:139], v[28:31], v[212:215]
ds_read_b64_tr_b16 v[156:157], v7 offset:256
ds_read_b64_tr_b16 v[158:159], v7 offset:1792
s_waitcnt lgkmcnt(8)
v_mfma_f32_16x16x32_bf16 v[216:219], v[140:143], v[24:27], v[216:219]
v_mfma_f32_16x16x32_bf16 v[220:223], v[140:143], v[28:31], v[220:223]
ds_read_b128 v[32:35], v3 offset:0
ds_read_b128 v[36:39], v3 offset:2048
ds_read_b64_tr_b16 v[112:113], v4 offset:12288
ds_read_b64_tr_b16 v[114:115], v4 offset:13824
s_waitcnt lgkmcnt(10)
v_mfma_f32_16x16x32_bf16 v[224:227], v[144:147], v[24:27], v[224:227]
v_mfma_f32_16x16x32_bf16 v[228:231], v[144:147], v[28:31], v[228:231]
ds_read_b64_tr_b16 v[116:117], v5 offset:12288
ds_read_b64_tr_b16 v[118:119], v5 offset:13824
s_waitcnt lgkmcnt(10)
v_mfma_f32_16x16x32_bf16 v[232:235], v[148:151], v[24:27], v[232:235]
v_mfma_f32_16x16x32_bf16 v[236:239], v[148:151], v[28:31], v[236:239]
ds_read_b64_tr_b16 v[120:121], v6 offset:12288
ds_read_b64_tr_b16 v[122:123], v6 offset:13824
s_waitcnt lgkmcnt(10)
v_mfma_f32_16x16x32_bf16 v[240:243], v[152:155], v[24:27], v[240:243]
v_mfma_f32_16x16x32_bf16 v[244:247], v[152:155], v[28:31], v[244:247]
ds_read_b64_tr_b16 v[124:125], v7 offset:12288
ds_read_b64_tr_b16 v[126:127], v7 offset:13824
s_waitcnt lgkmcnt(10)
v_mfma_f32_16x16x32_bf16 v[248:251], v[156:159], v[24:27], v[248:251]
v_mfma_f32_16x16x32_bf16 v[252:255], v[156:159], v[28:31], v[252:255]
ds_read_b64_tr_b16 v[128:129], v4 offset:12416
ds_read_b64_tr_b16 v[130:131], v4 offset:13952
s_waitcnt lgkmcnt(8)
v_mfma_f32_16x16x32_bf16 v[160:163], v[112:115], v[32:35], v[160:163]
v_mfma_f32_16x16x32_bf16 v[164:167], v[112:115], v[36:39], v[164:167]
ds_read_b64_tr_b16 v[132:133], v5 offset:12416
ds_read_b64_tr_b16 v[134:135], v5 offset:13952
s_waitcnt lgkmcnt(8)
v_mfma_f32_16x16x32_bf16 v[168:171], v[116:119], v[32:35], v[168:171]
v_mfma_f32_16x16x32_bf16 v[172:175], v[116:119], v[36:39], v[172:175]
s_waitcnt lgkmcnt(6)
v_mfma_f32_16x16x32_bf16 v[176:179], v[120:123], v[32:35], v[176:179]
v_mfma_f32_16x16x32_bf16 v[180:183], v[120:123], v[36:39], v[180:183]
s_waitcnt lgkmcnt(4)
v_mfma_f32_16x16x32_bf16 v[184:187], v[124:127], v[32:35], v[184:187]
v_mfma_f32_16x16x32_bf16 v[188:191], v[124:127], v[36:39], v[188:191]
s_waitcnt lgkmcnt(2)
v_mfma_f32_16x16x32_bf16 v[192:195], v[128:131], v[32:35], v[192:195]
v_mfma_f32_16x16x32_bf16 v[196:199], v[128:131], v[36:39], v[196:199]
s_waitcnt lgkmcnt(0)
v_mfma_f32_16x16x32_bf16 v[200:203], v[132:135], v[32:35], v[200:203]
v_mfma_f32_16x16x32_bf16 v[204:207], v[132:135], v[36:39], v[204:207]
L_qs13:
s_barrier
ds_read_b64_tr_b16 v[112:113], v6 offset:12416
ds_read_b64_tr_b16 v[114:115], v6 offset:13952
ds_read_b64_tr_b16 v[116:117], v7 offset:12416
ds_read_b64_tr_b16 v[118:119], v7 offset:13952
ds_read_b64_tr_b16 v[120:121], v4 offset:12544
ds_read_b64_tr_b16 v[122:123], v4 offset:14080
ds_read_b64_tr_b16 v[124:125], v5 offset:12544
ds_read_b64_tr_b16 v[126:127], v5 offset:14080
ds_read_b64_tr_b16 v[128:129], v6 offset:12544
ds_read_b64_tr_b16 v[130:131], v6 offset:14080
s_waitcnt lgkmcnt(8)
v_mfma_f32_16x16x32_bf16 v[208:211], v[112:115], v[32:35], v[208:211]
v_mfma_f32_16x16x32_bf16 v[212:215], v[112:115], v[36:39], v[212:215]
ds_read_b64_tr_b16 v[132:133], v7 offset:12544
ds_read_b64_tr_b16 v[134:135], v7 offset:14080
s_waitcnt lgkmcnt(8)
v_mfma_f32_16x16x32_bf16 v[216:219], v[116:119], v[32:35], v[216:219]
v_mfma_f32_16x16x32_bf16 v[220:223], v[116:119], v[36:39], v[220:223]
ds_read_b128 v[24:27], v2 offset:24576
ds_read_b128 v[28:31], v2 offset:26624
ds_read_b64_tr_b16 v[136:137], v4 offset:24576
ds_read_b64_tr_b16 v[138:139], v4 offset:26112
s_waitcnt lgkmcnt(10)
v_mfma_f32_16x16x32_bf16 v[224:227], v[120:123], v[32:35], v[224:227]
v_mfma_f32_16x16x32_bf16 v[228:231], v[120:123], v[36:39], v[228:231]
ds_read_b64_tr_b16 v[140:141], v5 offset:24576
ds_read_b64_tr_b16 v[142:143], v5 offset:26112
s_waitcnt lgkmcnt(10)
v_mfma_f32_16x16x32_bf16 v[232:235], v[124:127], v[32:35], v[232:235]
v_mfma_f32_16x16x32_bf16 v[236:239], v[124:127], v[36:39], v[236:239]
ds_read_b64_tr_b16 v[144:145], v6 offset:24576
ds_read_b64_tr_b16 v[146:147], v6 offset:26112
s_waitcnt lgkmcnt(10)
v_mfma_f32_16x16x32_bf16 v[240:243], v[128:131], v[32:35], v[240:243]
v_mfma_f32_16x16x32_bf16 v[244:247], v[128:131], v[36:39], v[244:247]
ds_read_b64_tr_b16 v[148:149], v7 offset:24576
ds_read_b64_tr_b16 v[150:151], v7 offset:26112
s_waitcnt lgkmcnt(10)
v_mfma_f32_16x16x32_bf16 v[248:251], v[132:135], v[32:35], v[248:251]
v_mfma_f32_16x16x32_bf16 v[252:255], v[132:135], v[36:39], v[252:255]
ds_read_b64_tr_b16 v[152:153], v4 offset:24704
ds_read_b64_tr_b16 v[154:155], v4 offset:26240
s_waitcnt lgkmcnt(8)
v_mfma_f32_16x16x32_bf16 v[160:163], v[136:139], v[24:27], v[160:163]
v_mfma_f32_16x16x32_bf16 v[164:167], v[136:139], v[28:31], v[164:167]
ds_read_b64_tr_b16 v[156:157], v5 offset:24704
ds_read_b64_tr_b16 v[158:159], v5 offset:26240
s_waitcnt lgkmcnt(8)
v_mfma_f32_16x16x32_bf16 v[168:171], v[140:143], v[24:27], v[168:171]
v_mfma_f32_16x16x32_bf16 v[172:175], v[140:143], v[28:31], v[172:175]
ds_read_b64_tr_b16 v[112:113], v6 offset:24704
ds_read_b64_tr_b16 v[114:115], v6 offset:26240
s_waitcnt lgkmcnt(8)
v_mfma_f32_16x16x32_bf16 v[176:179], v[144:147], v[24:27], v[176:179]
v_mfma_f32_16x16x32_bf16 v[180:183], v[144:147], v[28:31], v[180:183]
ds_read_b64_tr_b16 v[116:117], v7 offset:24704
ds_read_b64_tr_b16 v[118:119], v7 offset:26240
s_waitcnt lgkmcnt(8)
v_mfma_f32_16x16x32_bf16 v[184:187], v[148:151], v[24:27], v[184:187]
v_mfma_f32_16x16x32_bf16 v[188:191], v[148:151], v[28:31], v[188:191]
ds_read_b64_tr_b16 v[120:121], v4 offset:24832
ds_read_b64_tr_b16 v[122:123], v4 offset:26368
s_waitcnt lgkmcnt(8)
v_mfma_f32_16x16x32_bf16 v[192:195], v[152:155], v[24:27], v[192:195]
v_mfma_f32_16x16x32_bf16 v[196:199], v[152:155], v[28:31], v[196:199]
ds_read_b64_tr_b16 v[124:125], v5 offset:24832
ds_read_b64_tr_b16 v[126:127], v5 offset:26368
s_waitcnt lgkmcnt(8)
v_mfma_f32_16x16x32_bf16 v[200:203], v[156:159], v[24:27], v[200:203]
v_mfma_f32_16x16x32_bf16 v[204:207], v[156:159], v[28:31], v[204:207]
ds_read_b64_tr_b16 v[128:129], v6 offset:24832
ds_read_b64_tr_b16 v[130:131], v6 offset:26368
s_waitcnt lgkmcnt(8)
v_mfma_f32_16x16x32_bf16 v[208:211], v[112:115], v[24:27], v[208:211]
v_mfma_f32_16x16x32_bf16 v[212:215], v[112:115], v[28:31], v[212:215]
ds_read_b64_tr_b16 v[132:133], v7 offset:24832
ds_read_b64_tr_b16 v[134:135], v7 offset:26368
s_waitcnt lgkmcnt(8)
v_mfma_f32_16x16x32_bf16 v[216:219], v[116:119], v[24:27], v[216:219]
v_mfma_f32_16x16x32_bf16 v[220:223], v[116:119], v[28:31], v[220:223]
s_waitcnt lgkmcnt(6)
v_mfma_f32_16x16x32_bf16 v[224:227], v[120:123], v[24:27], v[224:227]
v_mfma_f32_16x16x32_bf16 v[228:231], v[120:123], v[28:31], v[228:231]
s_waitcnt lgkmcnt(4)
v_mfma_f32_16x16x32_bf16 v[232:235], v[124:127], v[24:27], v[232:235]
v_mfma_f32_16x16x32_bf16 v[236:239], v[124:127], v[28:31], v[236:239]
s_waitcnt lgkmcnt(2)
v_mfma_f32_16x16x32_bf16 v[240:243], v[128:131], v[24:27], v[240:243]
v_mfma_f32_16x16x32_bf16 v[244:247], v[128:131], v[28:31], v[244:247]
s_waitcnt lgkmcnt(0)
v_mfma_f32_16x16x32_bf16 v[248:251], v[132:135], v[24:27], v[248:251]
v_mfma_f32_16x16x32_bf16 v[252:255], v[132:135], v[28:31], v[252:255]
L_qs14:
s_barrier
ds_read_b128 v[32:35], v3 offset:24576
ds_read_b128 v[36:39], v3 offset:26624
ds_read_b64_tr_b16 v[112:113], v4 offset:36864
ds_read_b64_tr_b16 v[114:115], v4 offset:38400
ds_read_b64_tr_b16 v[116:117], v5 offset:36864
ds_read_b64_tr_b16 v[118:119], v5 offset:38400
ds_read_b64_tr_b16 v[120:121], v6 offset:36864
ds_read_b64_tr_b16 v[122:123], v6 offset:38400
ds_read_b64_tr_b16 v[124:125], v7 offset:36864
ds_read_b64_tr_b16 v[126:127], v7 offset:38400
ds_read_b64_tr_b16 v[128:129], v4 offset:36992
ds_read_b64_tr_b16 v[130:131], v4 offset:38528
s_waitcnt lgkmcnt(8)
v_mfma_f32_16x16x32_bf16 v[160:163], v[112:115], v[32:35], v[160:163]
v_mfma_f32_16x16x32_bf16 v[164:167], v[112:115], v[36:39], v[164:167]
ds_read_b64_tr_b16 v[132:133], v5 offset:36992
ds_read_b64_tr_b16 v[134:135], v5 offset:38528
s_waitcnt lgkmcnt(8)
v_mfma_f32_16x16x32_bf16 v[168:171], v[116:119], v[32:35], v[168:171]
v_mfma_f32_16x16x32_bf16 v[172:175], v[116:119], v[36:39], v[172:175]
ds_read_b64_tr_b16 v[136:137], v6 offset:36992
ds_read_b64_tr_b16 v[138:139], v6 offset:38528
s_waitcnt lgkmcnt(8)
v_mfma_f32_16x16x32_bf16 v[176:179], v[120:123], v[32:35], v[176:179]
v_mfma_f32_16x16x32_bf16 v[180:183], v[120:123], v[36:39], v[180:183]
ds_read_b64_tr_b16 v[140:141], v7 offset:36992
ds_read_b64_tr_b16 v[142:143], v7 offset:38528
s_waitcnt lgkmcnt(8)
v_mfma_f32_16x16x32_bf16 v[184:187], v[124:127], v[32:35], v[184:187]
v_mfma_f32_16x16x32_bf16 v[188:191], v[124:127], v[36:39], v[188:191]
ds_read_b64_tr_b16 v[144:145], v4 offset:37120
ds_read_b64_tr_b16 v[146:147], v4 offset:38656
s_waitcnt lgkmcnt(8)
v_mfma_f32_16x16x32_bf16 v[192:195], v[128:131], v[32:35], v[192:195]
v_mfma_f32_16x16x32_bf16 v[196:199], v[128:131], v[36:39], v[196:199]
ds_read_b64_tr_b16 v[148:149], v5 offset:37120
ds_read_b64_tr_b16 v[150:151], v5 offset:38656
s_waitcnt lgkmcnt(8)
v_mfma_f32_16x16x32_bf16 v[200:203], v[132:135], v[32:35], v[200:203]
v_mfma_f32_16x16x32_bf16 v[204:207], v[132:135], v[36:39], v[204:207]
ds_read_b64_tr_b16 v[152:153], v6 offset:37120
ds_read_b64_tr_b16 v[154:155], v6 offset:38656
s_waitcnt lgkmcnt(8)
v_mfma_f32_16x16x32_bf16 v[208:211], v[136:139], v[32:35], v[208:211]
v_mfma_f32_16x16x32_bf16 v[212:215], v[136:139], v[36:39], v[212:215]
ds_read_b64_tr_b16 v[156:157], v7 offset:37120
ds_read_b64_tr_b16 v[158:159], v7 offset:38656
s_waitcnt lgkmcnt(8)
v_mfma_f32_16x16x32_bf16 v[216:219], v[140:143], v[32:35], v[216:219]
v_mfma_f32_16x16x32_bf16 v[220:223], v[140:143], v[36:39], v[220:223]
s_waitcnt lgkmcnt(6)
v_mfma_f32_16x16x32_bf16 v[224:227], v[144:147], v[32:35], v[224:227]
v_mfma_f32_16x16x32_bf16 v[228:231], v[144:147], v[36:39], v[228:231]
s_waitcnt lgkmcnt(4)
v_mfma_f32_16x16x32_bf16 v[232:235], v[148:151], v[32:35], v[232:235]
v_mfma_f32_16x16x32_bf16 v[236:239], v[148:151], v[36:39], v[236:239]
s_waitcnt lgkmcnt(2)
v_mfma_f32_16x16x32_bf16 v[240:243], v[152:155], v[32:35], v[240:243]
v_mfma_f32_16x16x32_bf16 v[244:247], v[152:155], v[36:39], v[244:247]
s_waitcnt lgkmcnt(0)
v_mfma_f32_16x16x32_bf16 v[248:251], v[156:159], v[32:35], v[248:251]
v_mfma_f32_16x16x32_bf16 v[252:255], v[156:159], v[36:39], v[252:255]
L_qs15:
s_nop 7
v_mov_b32 v12, s72
v_mov_b32 v13, s72
v_pk_mul_f32 v[160:161], v[160:161], v[12:13]
v_pk_mul_f32 v[162:163], v[162:163], v[12:13]
v_pk_mul_f32 v[164:165], v[164:165], v[12:13]
v_pk_mul_f32 v[166:167], v[166:167], v[12:13]
v_pk_mul_f32 v[168:169], v[168:169], v[12:13]
v_pk_mul_f32 v[170:171], v[170:171], v[12:13]
v_pk_mul_f32 v[172:173], v[172:173], v[12:13]
v_pk_mul_f32 v[174:175], v[174:175], v[12:13]
v_pk_mul_f32 v[176:177], v[176:177], v[12:13]
v_pk_mul_f32 v[178:179], v[178:179], v[12:13]
v_pk_mul_f32 v[180:181], v[180:181], v[12:13]
v_pk_mul_f32 v[182:183], v[182:183], v[12:13]
v_pk_mul_f32 v[184:185], v[184:185], v[12:13]
v_pk_mul_f32 v[186:187], v[186:187], v[12:13]
v_pk_mul_f32 v[188:189], v[188:189], v[12:13]
v_pk_mul_f32 v[190:191], v[190:191], v[12:13]
v_pk_mul_f32 v[192:193], v[192:193], v[12:13]
v_pk_mul_f32 v[194:195], v[194:195], v[12:13]
v_pk_mul_f32 v[196:197], v[196:197], v[12:13]
v_pk_mul_f32 v[198:199], v[198:199], v[12:13]
v_pk_mul_f32 v[200:201], v[200:201], v[12:13]
v_pk_mul_f32 v[202:203], v[202:203], v[12:13]
v_pk_mul_f32 v[204:205], v[204:205], v[12:13]
v_pk_mul_f32 v[206:207], v[206:207], v[12:13]
v_pk_mul_f32 v[208:209], v[208:209], v[12:13]
v_pk_mul_f32 v[210:211], v[210:211], v[12:13]
v_pk_mul_f32 v[212:213], v[212:213], v[12:13]
v_pk_mul_f32 v[214:215], v[214:215], v[12:13]
v_pk_mul_f32 v[216:217], v[216:217], v[12:13]
v_pk_mul_f32 v[218:219], v[218:219], v[12:13]
v_pk_mul_f32 v[220:221], v[220:221], v[12:13]
v_pk_mul_f32 v[222:223], v[222:223], v[12:13]
v_pk_mul_f32 v[224:225], v[224:225], v[12:13]
v_pk_mul_f32 v[226:227], v[226:227], v[12:13]
v_pk_mul_f32 v[228:229], v[228:229], v[12:13]
v_pk_mul_f32 v[230:231], v[230:231], v[12:13]
v_pk_mul_f32 v[232:233], v[232:233], v[12:13]
v_pk_mul_f32 v[234:235], v[234:235], v[12:13]
v_pk_mul_f32 v[236:237], v[236:237], v[12:13]
v_pk_mul_f32 v[238:239], v[238:239], v[12:13]
v_pk_mul_f32 v[240:241], v[240:241], v[12:13]
v_pk_mul_f32 v[242:243], v[242:243], v[12:13]
v_pk_mul_f32 v[244:245], v[244:245], v[12:13]
v_pk_mul_f32 v[246:247], v[246:247], v[12:13]
v_pk_mul_f32 v[248:249], v[248:249], v[12:13]
v_pk_mul_f32 v[250:251], v[250:251], v[12:13]
v_pk_mul_f32 v[252:253], v[252:253], v[12:13]
v_pk_mul_f32 v[254:255], v[254:255], v[12:13]
v_cvt_pk_bf16_f32 v112, v160, v161
v_cvt_pk_bf16_f32 v113, v162, v163
v_cvt_pk_bf16_f32 v114, v168, v169
v_cvt_pk_bf16_f32 v115, v170, v171
v_cvt_pk_bf16_f32 v116, v164, v165
v_cvt_pk_bf16_f32 v117, v166, v167
v_cvt_pk_bf16_f32 v118, v172, v173
v_cvt_pk_bf16_f32 v119, v174, v175
v_cvt_pk_bf16_f32 v120, v176, v177
v_cvt_pk_bf16_f32 v121, v178, v179
v_cvt_pk_bf16_f32 v122, v184, v185
v_cvt_pk_bf16_f32 v123, v186, v187
v_cvt_pk_bf16_f32 v124, v180, v181
v_cvt_pk_bf16_f32 v125, v182, v183
v_cvt_pk_bf16_f32 v126, v188, v189
v_cvt_pk_bf16_f32 v127, v190, v191
v_cvt_pk_bf16_f32 v128, v192, v193
v_cvt_pk_bf16_f32 v129, v194, v195
v_cvt_pk_bf16_f32 v130, v200, v201
v_cvt_pk_bf16_f32 v131, v202, v203
v_cvt_pk_bf16_f32 v132, v196, v197
v_cvt_pk_bf16_f32 v133, v198, v199
v_cvt_pk_bf16_f32 v134, v204, v205
v_cvt_pk_bf16_f32 v135, v206, v207
v_cvt_pk_bf16_f32 v136, v208, v209
v_cvt_pk_bf16_f32 v137, v210, v211
v_cvt_pk_bf16_f32 v138, v216, v217
v_cvt_pk_bf16_f32 v139, v218, v219
v_cvt_pk_bf16_f32 v140, v212, v213
v_cvt_pk_bf16_f32 v141, v214, v215
v_cvt_pk_bf16_f32 v142, v220, v221
v_cvt_pk_bf16_f32 v143, v222, v223
v_cvt_pk_bf16_f32 v144, v224, v225
v_cvt_pk_bf16_f32 v145, v226, v227
v_cvt_pk_bf16_f32 v146, v232, v233
v_cvt_pk_bf16_f32 v147, v234, v235
v_cvt_pk_bf16_f32 v148, v228, v229
v_cvt_pk_bf16_f32 v149, v230, v231
v_cvt_pk_bf16_f32 v150, v236, v237
v_cvt_pk_bf16_f32 v151, v238, v239
v_cvt_pk_bf16_f32 v152, v240, v241
v_cvt_pk_bf16_f32 v153, v242, v243
v_cvt_pk_bf16_f32 v154, v248, v249
v_cvt_pk_bf16_f32 v155, v250, v251
v_cvt_pk_bf16_f32 v156, v244, v245
v_cvt_pk_bf16_f32 v157, v246, v247
v_cvt_pk_bf16_f32 v158, v252, v253
v_cvt_pk_bf16_f32 v159, v254, v255
s_nop 1
v_permlane32_swap_b32 v112, v114
v_permlane32_swap_b32 v113, v115
v_permlane32_swap_b32 v116, v118
v_permlane32_swap_b32 v117, v119
v_permlane32_swap_b32 v120, v122
v_permlane32_swap_b32 v121, v123
v_permlane32_swap_b32 v124, v126
v_permlane32_swap_b32 v125, v127
v_permlane32_swap_b32 v128, v130
v_permlane32_swap_b32 v129, v131
v_permlane32_swap_b32 v132, v134
v_permlane32_swap_b32 v133, v135
v_permlane32_swap_b32 v136, v138
v_permlane32_swap_b32 v137, v139
v_permlane32_swap_b32 v140, v142
v_permlane32_swap_b32 v141, v143
v_permlane32_swap_b32 v144, v146
v_permlane32_swap_b32 v145, v147
v_permlane32_swap_b32 v148, v150
v_permlane32_swap_b32 v149, v151
v_permlane32_swap_b32 v152, v154
v_permlane32_swap_b32 v153, v155
v_permlane32_swap_b32 v156, v158
v_permlane32_swap_b32 v157, v159
s_nop 1
v_permlane16_swap_b32 v112, v114
v_permlane16_swap_b32 v113, v115
v_permlane16_swap_b32 v116, v118
v_permlane16_swap_b32 v117, v119
v_permlane16_swap_b32 v120, v122
v_permlane16_swap_b32 v121, v123
v_permlane16_swap_b32 v124, v126
v_permlane16_swap_b32 v125, v127
v_permlane16_swap_b32 v128, v130
v_permlane16_swap_b32 v129, v131
v_permlane16_swap_b32 v132, v134
v_permlane16_swap_b32 v133, v135
v_permlane16_swap_b32 v136, v138
v_permlane16_swap_b32 v137, v139
v_permlane16_swap_b32 v140, v142
v_permlane16_swap_b32 v141, v143
v_permlane16_swap_b32 v144, v146
v_permlane16_swap_b32 v145, v147
v_permlane16_swap_b32 v148, v150
v_permlane16_swap_b32 v149, v151
v_permlane16_swap_b32 v152, v154
v_permlane16_swap_b32 v153, v155
v_permlane16_swap_b32 v156, v158
v_permlane16_swap_b32 v157, v159
L_q_done:
v_and_b32 v14, 15, v0
v_mul_u32_u24 v14, 384, v14
v_add_u32 v14, s75, v14
v_bfe_u32 v15, v0, 1, 3
v_lshrrev_b32 v1, 4, v0
v_add_u32 v1, 0, v1
v_xor_b32 v1, v1, v15
v_lshl_add_u32 v2, v1, 4, v14
v_lshrrev_b32 v1, 4, v0
v_add_u32 v1, 4, v1
v_xor_b32 v1, v1, v15
v_lshl_add_u32 v3, v1, 4, v14
v_lshrrev_b32 v14, 2, v0
v_mul_u32_u24 v14, 384, v14
v_and_b32 v15, 3, v0
v_lshl_add_u32 v14, v15, 3, v14
v_add_u32 v14, s75, v14
v_bfe_u32 v15, v0, 3, 1
v_lshlrev_b32 v15, 1, v15
v_bfe_u32 v1, v0, 4, 1
v_or_b32 v15, v15, v1
v_xor_b32 v1, 0, v15
v_lshl_add_u32 v4, v1, 5, v14
v_xor_b32 v1, 1, v15
v_lshl_add_u32 v5, v1, 5, v14
v_xor_b32 v1, 2, v15
v_lshl_add_u32 v6, v1, 5, v14
v_xor_b32 v1, 3, v15
v_lshl_add_u32 v7, v1, 5, v14
s_mov_b32 s70, 4294918144
s_mov_b32 s71, 24576
s_setprio 1
s_barrier
s_cmp_lg_u32 s74, 3
s_cbranch_scc1 L_nodump1
s_and_b32 s68, s67, 3
s_mul_i32 s68, s68, 12288
s_add_u32 s68, s68, 73728
v_lshlrev_b32 v1, 4, v0
v_add_u32 v1, s68, v1
ds_write_b128 v1, v[64:67] offset:0
ds_write_b128 v1, v[68:71] offset:1024
ds_write_b128 v1, v[72:75] offset:2048
ds_write_b128 v1, v[76:79] offset:3072
ds_write_b128 v1, v[80:83] offset:4096
ds_write_b128 v1, v[84:87] offset:5120
ds_write_b128 v1, v[88:91] offset:6144
ds_write_b128 v1, v[92:95] offset:7168
ds_write_b128 v1, v[96:99] offset:8192
ds_write_b128 v1, v[100:103] offset:9216
ds_write_b128 v1, v[104:107] offset:10240
ds_write_b128 v1, v[108:111] offset:11264
s_waitcnt lgkmcnt(0)
L_nodump1:
ds_read_b128 v[48:51], v2 offset:0
ds_read_b128 v[52:55], v2 offset:6144
ds_read_b128 v[56:59], v3 offset:0
ds_read_b128 v[60:63], v3 offset:6144
s_add_u32 s75, s75, 24576
s_cmp_eq_u32 s75, 73728
s_cselect_b32 s75, 0, s75
s_cselect_b32 s76, s70, s71
s_waitcnt lgkmcnt(3)
v_mfma_f32_16x16x32_bf16 v[24:27], v[48:51], v[112:115], 0
v_mfma_f32_16x16x32_bf16 v[32:35], v[48:51], v[116:119], 0
ds_read_b128 v[48:51], v2 offset:128
s_waitcnt lgkmcnt(3)
v_mfma_f32_16x16x32_bf16 v[28:31], v[52:55], v[112:115], 0
v_mfma_f32_16x16x32_bf16 v[36:39], v[52:55], v[116:119], 0
ds_read_b128 v[52:55], v2 offset:6272
s_waitcnt lgkmcnt(3)
v_mfma_f32_16x16x32_bf16 v[24:27], v[56:59], v[120:123], v[24:27]
v_mfma_f32_16x16x32_bf16 v[32:35], v[56:59], v[124:127], v[32:35]
ds_read_b128 v[56:59], v3 offset:128
s_waitcnt lgkmcnt(3)
v_mfma_f32_16x16x32_bf16 v[28:31], v[60:63], v[120:123], v[28:31]
v_mfma_f32_16x16x32_bf16 v[36:39], v[60:63], v[124:127], v[36:39]
ds_read_b128 v[60:63], v3 offset:6272
s_waitcnt lgkmcnt(3)
v_mfma_f32_16x16x32_bf16 v[24:27], v[48:51], v[128:131], v[24:27]
v_mfma_f32_16x16x32_bf16 v[32:35], v[48:51], v[132:135], v[32:35]
ds_read_b128 v[48:51], v2 offset:256
s_waitcnt lgkmcnt(3)
v_mfma_f32_16x16x32_bf16 v[28:31], v[52:55], v[128:131], v[28:31]
v_mfma_f32_16x16x32_bf16 v[36:39], v[52:55], v[132:135], v[36:39]
ds_read_b128 v[52:55], v2 offset:6400
s_waitcnt lgkmcnt(3)
v_mfma_f32_16x16x32_bf16 v[24:27], v[56:59], v[136:139], v[24:27]
v_mfma_f32_16x16x32_bf16 v[32:35], v[56:59], v[140:143], v[32:35]
ds_read_b128 v[56:59], v3 offset:256
s_waitcnt lgkmcnt(3)
v_mfma_f32_16x16x32_bf16 v[28:31], v[60:63], v[136:139], v[28:31]
v_mfma_f32_16x16x32_bf16 v[36:39], v[60:63], v[140:143], v[36:39]
ds_read_b128 v[60:63], v3 offset:6400
s_waitcnt lgkmcnt(3)
v_mfma_f32_16x16x32_bf16 v[24:27], v[48:51], v[144:147], v[24:27]
v_mfma_f32_16x16x32_bf16 v[32:35], v[48:51], v[148:151], v[32:35]
ds_read_b64_tr_b16 v[48:49], v4 offset:12288
ds_read_b64_tr_b16 v[50:51], v4 offset:18432
s_waitcnt lgkmcnt(4)
v_mfma_f32_16x16x32_bf16 v[28:31], v[52:55], v[144:147], v[28:31]
v_mfma_f32_16x16x32_bf16 v[36:39], v[52:55], v[148:151], v[36:39]
ds_read_b64_tr_b16 v[52:53], v5 offset:12288
ds_read_b64_tr_b16 v[54:55], v5 offset:18432
s_waitcnt lgkmcnt(5)
v_mfma_f32_16x16x32_bf16 v[24:27], v[56:59], v[152:155], v[24:27]
v_mfma_f32_16x16x32_bf16 v[32:35], v[56:59], v[156:159], v[32:35]
ds_read_b64_tr_b16 v[56:57], v6 offset:12288
ds_read_b64_tr_b16 v[58:59], v6 offset:18432
s_waitcnt lgkmcnt(6)
v_mfma_f32_16x16x32_bf16 v[28:31], v[60:63], v[152:155], v[28:31]
v_mfma_f32_16x16x32_bf16 v[36:39], v[60:63], v[156:159], v[36:39]
ds_read_b64_tr_b16 v[60:61], v7 offset:12288
ds_read_b64_tr_b16 v[62:63], v7 offset:18432
v_add_u32 v2, s76, v2
v_add_u32 v3, s76, v3
v_max3_f32 v12, v24, v25, v26
v_max3_f32 v13, v32, v33, v34
s_nop 0
v_max3_f32 v12, v12, v27, v28
v_max3_f32 v13, v13, v35, v36
v_max3_f32 v12, v12, v29, v30
v_max3_f32 v13, v13, v37, v38
v_max_f32 v12, v12, v31
v_max_f32 v13, v13, v39
s_nop 1
v_permlane32_swap_b32 v12, v13
v_max_f32 v12, v12, v13
v_mov_b32 v13, v12
s_nop 1
v_permlane16_swap_b32 v12, v13
v_max_f32 v12, v12, v13
v_mov_b32 v13, v12
s_nop 1
v_permlane32_swap_b32 v12, v13
v_sub_f32 v24, v24, v12
v_sub_f32 v25, v25, v12
v_sub_f32 v26, v26, v12
v_sub_f32 v27, v27, v12
v_sub_f32 v28, v28, v12
v_sub_f32 v29, v29, v12
v_sub_f32 v30, v30, v12
v_sub_f32 v31, v31, v12
v_sub_f32 v32, v32, v13
v_sub_f32 v33, v33, v13
v_sub_f32 v34, v34, v13
v_sub_f32 v35, v35, v13
v_sub_f32 v36, v36, v13
v_sub_f32 v37, v37, v13
v_sub_f32 v38, v38, v13
v_sub_f32 v39, v39, v13
v_sub_f32 v40, 0, v12
v_sub_f32 v41, 0, v12
v_sub_f32 v42, 0, v12
v_sub_f32 v43, 0, v12
v_sub_f32 v44, 0, v13
v_sub_f32 v45, 0, v13
v_sub_f32 v46, 0, v13
v_sub_f32 v47, 0, v13
v_exp_f32 v12, v24
v_exp_f32 v13, v25
v_exp_f32 v14, v26
v_exp_f32 v15, v27
v_cvt_pk_bf16_f32 v16, v12, v13
v_add_f32 v10, v12, v13
v_exp_f32 v12, v28
v_exp_f32 v13, v29
v_cvt_pk_bf16_f32 v17, v14, v15
v_add_f32 v10, v10, v14
v_add_f32 v10, v10, v15
v_exp_f32 v14, v30
v_exp_f32 v15, v31
v_cvt_pk_bf16_f32 v18, v12, v13
v_add_f32 v10, v10, v12
v_add_f32 v10, v10, v13
v_exp_f32 v12, v32
v_exp_f32 v13, v33
v_cvt_pk_bf16_f32 v19, v14, v15
v_add_f32 v10, v10, v14
v_add_f32 v10, v10, v15
v_exp_f32 v14, v34
v_exp_f32 v15, v35
v_cvt_pk_bf16_f32 v20, v12, v13
v_add_f32 v11, v12, v13
v_exp_f32 v12, v36
v_exp_f32 v13, v37
v_cvt_pk_bf16_f32 v21, v14, v15
v_add_f32 v11, v11, v14
v_add_f32 v11, v11, v15
v_exp_f32 v14, v38
v_exp_f32 v15, v39
v_cvt_pk_bf16_f32 v22, v12, v13
v_add_f32 v11, v11, v12
v_add_f32 v11, v11, v13
v_cvt_pk_bf16_f32 v23, v14, v15
v_add_f32 v11, v11, v14
v_add_f32 v11, v11, v15
s_waitcnt lgkmcnt(6)
v_mfma_f32_16x16x32_bf16 v[160:163], v[48:51], v[16:19], 0
v_mov_b32 v8, v10
v_mfma_f32_16x16x32_bf16 v[164:167], v[48:51], v[20:23], 0
ds_read_b64_tr_b16 v[48:49], v4 offset:12416
ds_read_b64_tr_b16 v[50:51], v4 offset:18560
v_mov_b32 v9, v11
s_waitcnt lgkmcnt(6)
v_mfma_f32_16x16x32_bf16 v[168:171], v[52:55], v[16:19], 0
v_mfma_f32_16x16x32_bf16 v[172:175], v[52:55], v[20:23], 0
ds_read_b64_tr_b16 v[52:53], v5 offset:12416
ds_read_b64_tr_b16 v[54:55], v5 offset:18560
s_waitcnt lgkmcnt(6)
v_mfma_f32_16x16x32_bf16 v[176:179], v[56:59], v[16:19], 0
v_mfma_f32_16x16x32_bf16 v[180:183], v[56:59], v[20:23], 0
ds_read_b64_tr_b16 v[56:57], v6 offset:12416
ds_read_b64_tr_b16 v[58:59], v6 offset:18560
s_waitcnt lgkmcnt(6)
v_mfma_f32_16x16x32_bf16 v[184:187], v[60:63], v[16:19], 0
v_mfma_f32_16x16x32_bf16 v[188:191], v[60:63], v[20:23], 0
ds_read_b64_tr_b16 v[60:61], v7 offset:12416
ds_read_b64_tr_b16 v[62:63], v7 offset:18560
s_waitcnt lgkmcnt(6)
v_mfma_f32_16x16x32_bf16 v[192:195], v[48:51], v[16:19], 0
v_mfma_f32_16x16x32_bf16 v[196:199], v[48:51], v[20:23], 0
ds_read_b64_tr_b16 v[48:49], v4 offset:12544
ds_read_b64_tr_b16 v[50:51], v4 offset:18688
s_waitcnt lgkmcnt(6)
v_mfma_f32_16x16x32_bf16 v[200:203], v[52:55], v[16:19], 0
v_mfma_f32_16x16x32_bf16 v[204:207], v[52:55], v[20:23], 0
ds_read_b64_tr_b16 v[52:53], v5 offset:12544
ds_read_b64_tr_b16 v[54:55], v5 offset:18688
s_waitcnt lgkmcnt(6)
v_mfma_f32_16x16x32_bf16 v[208:211], v[56:59], v[16:19], 0
v_mfma_f32_16x16x32_bf16 v[212:215], v[56:59], v[20:23], 0
ds_read_b64_tr_b16 v[56:57], v6 offset:12544
ds_read_b64_tr_b16 v[58:59], v6 offset:18688
s_waitcnt lgkmcnt(6)
v_mfma_f32_16x16x32_bf16 v[216:219], v[60:63], v[16:19], 0
v_mfma_f32_16x16x32_bf16 v[220:223], v[60:63], v[20:23], 0
ds_read_b64_tr_b16 v[60:61], v7 offset:12544
ds_read_b64_tr_b16 v[62:63], v7 offset:18688
v_add_u32 v4, s76, v4
v_add_u32 v5, s76, v5
v_add_u32 v6, s76, v6
v_add_u32 v7, s76, v7
s_waitcnt lgkmcnt(6)
v_mfma_f32_16x16x32_bf16 v[224:227], v[48:51], v[16:19], 0
v_mfma_f32_16x16x32_bf16 v[228:231], v[48:51], v[20:23], 0
s_waitcnt lgkmcnt(4)
v_mfma_f32_16x16x32_bf16 v[232:235], v[52:55], v[16:19], 0
v_mfma_f32_16x16x32_bf16 v[236:239], v[52:55], v[20:23], 0
s_waitcnt lgkmcnt(2)
v_mfma_f32_16x16x32_bf16 v[240:243], v[56:59], v[16:19], 0
v_mfma_f32_16x16x32_bf16 v[244:247], v[56:59], v[20:23], 0
s_waitcnt lgkmcnt(0)
v_mfma_f32_16x16x32_bf16 v[248:251], v[60:63], v[16:19], 0
v_mfma_f32_16x16x32_bf16 v[252:255], v[60:63], v[20:23], 0
s_mov_b32 s73, 1
s_barrier
L_attn_loop:
ds_read_b128 v[48:51], v2 offset:0
ds_read_b128 v[52:55], v2 offset:6144
ds_read_b128 v[56:59], v3 offset:0
ds_read_b128 v[60:63], v3 offset:6144
s_add_u32 s75, s75, 24576
s_cmp_eq_u32 s75, 73728
s_cselect_b32 s75, 0, s75
s_cselect_b32 s76, s70, s71
s_waitcnt lgkmcnt(3)
v_mfma_f32_16x16x32_bf16 v[24:27], v[48:51], v[112:115], v[40:43]
v_mfma_f32_16x16x32_bf16 v[32:35], v[48:51], v[116:119], v[44:47]
ds_read_b128 v[48:51], v2 offset:128
s_waitcnt lgkmcnt(3)
v_mfma_f32_16x16x32_bf16 v[28:31], v[52:55], v[112:115], v[40:43]
v_mfma_f32_16x16x32_bf16 v[36:39], v[52:55], v[116:119], v[44:47]
ds_read_b128 v[52:55], v2 offset:6272
s_waitcnt lgkmcnt(3)
v_mfma_f32_16x16x32_bf16 v[24:27], v[56:59], v[120:123], v[24:27]
v_mfma_f32_16x16x32_bf16 v[32:35], v[56:59], v[124:127], v[32:35]
ds_read_b128 v[56:59], v3 offset:128
s_waitcnt lgkmcnt(3)
v_mfma_f32_16x16x32_bf16 v[28:31], v[60:63], v[120:123], v[28:31]
v_mfma_f32_16x16x32_bf16 v[36:39], v[60:63], v[124:127], v[36:39]
ds_read_b128 v[60:63], v3 offset:6272
s_waitcnt lgkmcnt(3)
v_mfma_f32_16x16x32_bf16 v[24:27], v[48:51], v[128:131], v[24:27]
v_mfma_f32_16x16x32_bf16 v[32:35], v[48:51], v[132:135], v[32:35]
ds_read_b128 v[48:51], v2 offset:256
s_waitcnt lgkmcnt(3)
v_mfma_f32_16x16x32_bf16 v[28:31], v[52:55], v[128:131], v[28:31]
v_mfma_f32_16x16x32_bf16 v[36:39], v[52:55], v[132:135], v[36:39]
ds_read_b128 v[52:55], v2 offset:6400
s_waitcnt lgkmcnt(3)
v_mfma_f32_16x16x32_bf16 v[24:27], v[56:59], v[136:139], v[24:27]
v_mfma_f32_16x16x32_bf16 v[32:35], v[56:59], v[140:143], v[32:35]
ds_read_b128 v[56:59], v3 offset:256
s_waitcnt lgkmcnt(3)
v_mfma_f32_16x16x32_bf16 v[28:31], v[60:63], v[136:139], v[28:31]
v_mfma_f32_16x16x32_bf16 v[36:39], v[60:63], v[140:143], v[36:39]
ds_read_b128 v[60:63], v3 offset:6400
s_waitcnt lgkmcnt(3)
v_mfma_f32_16x16x32_bf16 v[24:27], v[48:51], v[144:147], v[24:27]
v_mfma_f32_16x16x32_bf16 v[32:35], v[48:51], v[148:151], v[32:35]
ds_read_b64_tr_b16 v[48:49], v4 offset:12288
ds_read_b64_tr_b16 v[50:51], v4 offset:18432
s_waitcnt lgkmcnt(4)
v_mfma_f32_16x16x32_bf16 v[28:31], v[52:55], v[144:147], v[28:31]
v_mfma_f32_16x16x32_bf16 v[36:39], v[52:55], v[148:151], v[36:39]
ds_read_b64_tr_b16 v[52:53], v5 offset:12288
ds_read_b64_tr_b16 v[54:55], v5 offset:18432
s_waitcnt lgkmcnt(5)
v_mfma_f32_16x16x32_bf16 v[24:27], v[56:59], v[152:155], v[24:27]
v_mfma_f32_16x16x32_bf16 v[32:35], v[56:59], v[156:159], v[32:35]
ds_read_b64_tr_b16 v[56:57], v6 offset:12288
ds_read_b64_tr_b16 v[58:59], v6 offset:18432
s_waitcnt lgkmcnt(6)
v_mfma_f32_16x16x32_bf16 v[28:31], v[60:63], v[152:155], v[28:31]
v_mfma_f32_16x16x32_bf16 v[36:39], v[60:63], v[156:159], v[36:39]
ds_read_b64_tr_b16 v[60:61], v7 offset:12288
ds_read_b64_tr_b16 v[62:63], v7 offset:18432
v_add_u32 v2, s76, v2
v_add_u32 v3, s76, v3
L_back_b:
v_exp_f32 v12, v24
v_exp_f32 v13, v25
v_exp_f32 v14, v26
v_exp_f32 v15, v27
v_cvt_pk_bf16_f32 v16, v12, v13
v_add_f32 v10, v12, v13
v_exp_f32 v12, v28
v_exp_f32 v13, v29
v_cvt_pk_bf16_f32 v17, v14, v15
v_add_f32 v10, v10, v14
v_add_f32 v10, v10, v15
v_exp_f32 v14, v30
v_exp_f32 v15, v31
v_cvt_pk_bf16_f32 v18, v12, v13
v_add_f32 v10, v10, v12
v_add_f32 v10, v10, v13
v_exp_f32 v12, v32
v_exp_f32 v13, v33
v_cvt_pk_bf16_f32 v19, v14, v15
v_add_f32 v10, v10, v14
v_add_f32 v10, v10, v15
v_exp_f32 v14, v34
v_exp_f32 v15, v35
v_cvt_pk_bf16_f32 v20, v12, v13
v_add_f32 v11, v12, v13
v_exp_f32 v12, v36
v_exp_f32 v13, v37
v_cvt_pk_bf16_f32 v21, v14, v15
v_add_f32 v11, v11, v14
v_add_f32 v11, v11, v15
v_exp_f32 v14, v38
v_exp_f32 v15, v39
v_cvt_pk_bf16_f32 v22, v12, v13
v_add_f32 v11, v11, v12
v_add_f32 v11, v11, v13
v_cvt_pk_bf16_f32 v23, v14, v15
v_add_f32 v11, v11, v14
v_add_f32 v11, v11, v15
v_max_f32 v1, v10, v11
v_cmp_lt_f32 vcc, s77, v1
s_cbranch_vccnz L_rare_b
s_waitcnt lgkmcnt(6)
v_mfma_f32_16x16x32_bf16 v[160:163], v[48:51], v[16:19], v[160:163]
v_add_f32 v8, v8, v10
v_mfma_f32_16x16x32_bf16 v[164:167], v[48:51], v[20:23], v[164:167]
ds_read_b64_tr_b16 v[48:49], v4 offset:12416
ds_read_b64_tr_b16 v[50:51], v4 offset:18560
v_add_f32 v9, v9, v11
s_waitcnt lgkmcnt(6)
v_mfma_f32_16x16x32_bf16 v[168:171], v[52:55], v[16:19], v[168:171]
v_mfma_f32_16x16x32_bf16 v[172:175], v[52:55], v[20:23], v[172:175]
ds_read_b64_tr_b16 v[52:53], v5 offset:12416
ds_read_b64_tr_b16 v[54:55], v5 offset:18560
s_waitcnt lgkmcnt(6)
v_mfma_f32_16x16x32_bf16 v[176:179], v[56:59], v[16:19], v[176:179]
v_mfma_f32_16x16x32_bf16 v[180:183], v[56:59], v[20:23], v[180:183]
ds_read_b64_tr_b16 v[56:57], v6 offset:12416
ds_read_b64_tr_b16 v[58:59], v6 offset:18560
s_waitcnt lgkmcnt(6)
v_mfma_f32_16x16x32_bf16 v[184:187], v[60:63], v[16:19], v[184:187]
v_mfma_f32_16x16x32_bf16 v[188:191], v[60:63], v[20:23], v[188:191]
ds_read_b64_tr_b16 v[60:61], v7 offset:12416
ds_read_b64_tr_b16 v[62:63], v7 offset:18560
s_waitcnt lgkmcnt(6)
v_mfma_f32_16x16x32_bf16 v[192:195], v[48:51], v[16:19], v[192:195]
v_mfma_f32_16x16x32_bf16 v[196:199], v[48:51], v[20:23], v[196:199]
ds_read_b64_tr_b16 v[48:49], v4 offset:12544
ds_read_b64_tr_b16 v[50:51], v4 offset:18688
s_waitcnt lgkmcnt(6)
v_mfma_f32_16x16x32_bf16 v[200:203], v[52:55], v[16:19], v[200:203]
v_mfma_f32_16x16x32_bf16 v[204:207], v[52:55], v[20:23], v[204:207]
ds_read_b64_tr_b16 v[52:53], v5 offset:12544
ds_read_b64_tr_b16 v[54:55], v5 offset:18688
s_waitcnt lgkmcnt(6)
v_mfma_f32_16x16x32_bf16 v[208:211], v[56:59], v[16:19], v[208:211]
v_mfma_f32_16x16x32_bf16 v[212:215], v[56:59], v[20:23], v[212:215]
ds_read_b64_tr_b16 v[56:57], v6 offset:12544
ds_read_b64_tr_b16 v[58:59], v6 offset:18688
s_waitcnt lgkmcnt(6)
v_mfma_f32_16x16x32_bf16 v[216:219], v[60:63], v[16:19], v[216:219]
v_mfma_f32_16x16x32_bf16 v[220:223], v[60:63], v[20:23], v[220:223]
ds_read_b64_tr_b16 v[60:61], v7 offset:12544
ds_read_b64_tr_b16 v[62:63], v7 offset:18688
v_add_u32 v4, s76, v4
v_add_u32 v5, s76, v5
v_add_u32 v6, s76, v6
v_add_u32 v7, s76, v7
s_waitcnt lgkmcnt(6)
v_mfma_f32_16x16x32_bf16 v[224:227], v[48:51], v[16:19], v[224:227]
v_mfma_f32_16x16x32_bf16 v[228:231], v[48:51], v[20:23], v[228:231]
s_waitcnt lgkmcnt(4)
v_mfma_f32_16x16x32_bf16 v[232:235], v[52:55], v[16:19], v[232:235]
v_mfma_f32_16x16x32_bf16 v[236:239], v[52:55], v[20:23], v[236:239]
s_waitcnt lgkmcnt(2)
v_mfma_f32_16x16x32_bf16 v[240:243], v[56:59], v[16:19], v[240:243]
v_mfma_f32_16x16x32_bf16 v[244:247], v[56:59], v[20:23], v[244:247]
s_waitcnt lgkmcnt(0)
v_mfma_f32_16x16x32_bf16 v[248:251], v[60:63], v[16:19], v[248:251]
v_mfma_f32_16x16x32_bf16 v[252:255], v[60:63], v[20:23], v[252:255]
s_add_u32 s73, s73, 1
s_barrier
s_cmp_lt_u32 s73, 16
s_cbranch_scc1 L_attn_loop
s_cmp_ge_u32 s74, 2
s_cbranch_scc1 L_xy_end
v_mov_b32 v12, v8
v_mov_b32 v13, v9
s_nop 1
v_permlane32_swap_b32 v12, v13
v_add_f32 v12, v12, v13
v_mov_b32 v13, v12
s_nop 1
v_permlane16_swap_b32 v12, v13
v_add_f32 v12, v12, v13
v_rcp_f32 v12, v12
s_nop 0
v_mov_b32 v14, v12
s_nop 1
v_permlane32_swap_b32 v12, v14
v_mov_b32 v13, v12
v_mov_b32 v15, v14
v_pk_mul_f32 v[160:161], v[160:161], v[12:13]
v_pk_mul_f32 v[162:163], v[162:163], v[12:13]
v_pk_mul_f32 v[164:165], v[164:165], v[14:15]
v_pk_mul_f32 v[166:167], v[166:167], v[14:15]
v_pk_mul_f32 v[168:169], v[168:169], v[12:13]
v_pk_mul_f32 v[170:171], v[170:171], v[12:13]
v_pk_mul_f32 v[172:173], v[172:173], v[14:15]
v_pk_mul_f32 v[174:175], v[174:175], v[14:15]
v_cvt_pk_bf16_f32 v64, v160, v161
v_cvt_pk_bf16_f32 v65, v162, v163
v_cvt_pk_bf16_f32 v66, v168, v169
v_cvt_pk_bf16_f32 v67, v170, v171
v_cvt_pk_bf16_f32 v68, v164, v165
v_cvt_pk_bf16_f32 v69, v166, v167
v_cvt_pk_bf16_f32 v70, v172, v173
v_cvt_pk_bf16_f32 v71, v174, v175
v_pk_mul_f32 v[176:177], v[176:177], v[12:13]
v_pk_mul_f32 v[178:179], v[178:179], v[12:13]
v_pk_mul_f32 v[180:181], v[180:181], v[14:15]
v_pk_mul_f32 v[182:183], v[182:183], v[14:15]
v_pk_mul_f32 v[184:185], v[184:185], v[12:13]
v_pk_mul_f32 v[186:187], v[186:187], v[12:13]
v_pk_mul_f32 v[188:189], v[188:189], v[14:15]
v_pk_mul_f32 v[190:191], v[190:191], v[14:15]
v_cvt_pk_bf16_f32 v72, v176, v177
v_cvt_pk_bf16_f32 v73, v178, v179
v_cvt_pk_bf16_f32 v74, v184, v185
v_cvt_pk_bf16_f32 v75, v186, v187
v_cvt_pk_bf16_f32 v76, v180, v181
v_cvt_pk_bf16_f32 v77, v182, v183
v_cvt_pk_bf16_f32 v78, v188, v189
v_cvt_pk_bf16_f32 v79, v190, v191
v_pk_mul_f32 v[192:193], v[192:193], v[12:13]
v_pk_mul_f32 v[194:195], v[194:195], v[12:13]
v_pk_mul_f32 v[196:197], v[196:197], v[14:15]
v_pk_mul_f32 v[198:199], v[198:199], v[14:15]
v_pk_mul_f32 v[200:201], v[200:201], v[12:13]
v_pk_mul_f32 v[202:203], v[202:203], v[12:13]
v_pk_mul_f32 v[204:205], v[204:205], v[14:15]
v_pk_mul_f32 v[206:207], v[206:207], v[14:15]
v_cvt_pk_bf16_f32 v80, v192, v193
v_cvt_pk_bf16_f32 v81, v194, v195
v_cvt_pk_bf16_f32 v82, v200, v201
v_cvt_pk_bf16_f32 v83, v202, v203
v_cvt_pk_bf16_f32 v84, v196, v197
v_cvt_pk_bf16_f32 v85, v198, v199
v_cvt_pk_bf16_f32 v86, v204, v205
v_cvt_pk_bf16_f32 v87, v206, v207
v_pk_mul_f32 v[208:209], v[208:209], v[12:13]
v_pk_mul_f32 v[210:211], v[210:211], v[12:13]
v_pk_mul_f32 v[212:213], v[212:213], v[14:15]
v_pk_mul_f32 v[214:215], v[214:215], v[14:15]
v_pk_mul_f32 v[216:217], v[216:217], v[12:13]
v_pk_mul_f32 v[218:219], v[218:219], v[12:13]
v_pk_mul_f32 v[220:221], v[220:221], v[14:15]
v_pk_mul_f32 v[222:223], v[222:223], v[14:15]
v_cvt_pk_bf16_f32 v88, v208, v209
v_cvt_pk_bf16_f32 v89, v210, v211
v_cvt_pk_bf16_f32 v90, v216, v217
v_cvt_pk_bf16_f32 v91, v218, v219
v_cvt_pk_bf16_f32 v92, v212, v213
v_cvt_pk_bf16_f32 v93, v214, v215
v_cvt_pk_bf16_f32 v94, v220, v221
v_cvt_pk_bf16_f32 v95, v222, v223
v_pk_mul_f32 v[224:225], v[224:225], v[12:13]
v_pk_mul_f32 v[226:227], v[226:227], v[12:13]
v_pk_mul_f32 v[228:229], v[228:229], v[14:15]
v_pk_mul_f32 v[230:231], v[230:231], v[14:15]
v_pk_mul_f32 v[232:233], v[232:233], v[12:13]
v_pk_mul_f32 v[234:235], v[234:235], v[12:13]
v_pk_mul_f32 v[236:237], v[236:237], v[14:15]
v_pk_mul_f32 v[238:239], v[238:239], v[14:15]
v_cvt_pk_bf16_f32 v96, v224, v225
v_cvt_pk_bf16_f32 v97, v226, v227
v_cvt_pk_bf16_f32 v98, v232, v233
v_cvt_pk_bf16_f32 v99, v234, v235
v_cvt_pk_bf16_f32 v100, v228, v229
v_cvt_pk_bf16_f32 v101, v230, v231
v_cvt_pk_bf16_f32 v102, v236, v237
v_cvt_pk_bf16_f32 v103, v238, v239
v_pk_mul_f32 v[240:241], v[240:241], v[12:13]
v_pk_mul_f32 v[242:243], v[242:243], v[12:13]
v_pk_mul_f32 v[244:245], v[244:245], v[14:15]
v_pk_mul_f32 v[246:247], v[246:247], v[14:15]
v_pk_mul_f32 v[248:249], v[248:249], v[12:13]
v_pk_mul_f32 v[250:251], v[250:251], v[12:13]
v_pk_mul_f32 v[252:253], v[252:253], v[14:15]
v_pk_mul_f32 v[254:255], v[254:255], v[14:15]
v_cvt_pk_bf16_f32 v104, v240, v241
v_cvt_pk_bf16_f32 v105, v242, v243
v_cvt_pk_bf16_f32 v106, v248, v249
v_cvt_pk_bf16_f32 v107, v250, v251
v_cvt_pk_bf16_f32 v108, v244, v245
v_cvt_pk_bf16_f32 v109, v246, v247
v_cvt_pk_bf16_f32 v110, v252, v253
v_cvt_pk_bf16_f32 v111, v254, v255
s_add_u32 s74, s74, 2
s_add_u32 s75, s75, 24576
s_cmp_eq_u32 s75, 73728
s_cselect_b32 s75, 0, s75
s_branch L_qround
L_xy_end:
s_setprio 0
s_cmp_eq_u32 s74, 3
s_cbranch_scc1 L_y_end
s_cmp_eq_u32 s67, 0
s_cbranch_scc1 L_x0
v_mov_b32 v12, v8
v_mov_b32 v13, v9
s_nop 1
v_permlane32_swap_b32 v12, v13
v_add_f32 v12, v12, v13
v_mov_b32 v13, v12
s_nop 1
v_permlane16_swap_b32 v12, v13
v_add_f32 v12, v12, v13
v_rcp_f32 v12, v12
s_nop 0
v_mov_b32 v14, v12
s_nop 1
v_permlane32_swap_b32 v12, v14
v_mov_b32 v13, v12
v_mov_b32 v15, v14
v_pk_mul_f32 v[160:161], v[160:161], v[12:13]
v_pk_mul_f32 v[162:163], v[162:163], v[12:13]
v_pk_mul_f32 v[164:165], v[164:165], v[14:15]
v_pk_mul_f32 v[166:167], v[166:167], v[14:15]
v_pk_mul_f32 v[168:169], v[168:169], v[12:13]
v_pk_mul_f32 v[170:171], v[170:171], v[12:13]
v_pk_mul_f32 v[172:173], v[172:173], v[14:15]
v_pk_mul_f32 v[174:175], v[174:175], v[14:15]
v_cvt_pk_bf16_f32 v112, v160, v161
v_cvt_pk_bf16_f32 v113, v162, v163
v_cvt_pk_bf16_f32 v114, v168, v169
v_cvt_pk_bf16_f32 v115, v170, v171
v_cvt_pk_bf16_f32 v116, v164, v165
v_cvt_pk_bf16_f32 v117, v166, v167
v_cvt_pk_bf16_f32 v118, v172, v173
v_cvt_pk_bf16_f32 v119, v174, v175
v_pk_mul_f32 v[176:177], v[176:177], v[12:13]
v_pk_mul_f32 v[178:179], v[178:179], v[12:13]
v_pk_mul_f32 v[180:181], v[180:181], v[14:15]
v_pk_mul_f32 v[182:183], v[182:183], v[14:15]
v_pk_mul_f32 v[184:185], v[184:185], v[12:13]
v_pk_mul_f32 v[186:187], v[186:187], v[12:13]
v_pk_mul_f32 v[188:189], v[188:189], v[14:15]
v_pk_mul_f32 v[190:191], v[190:191], v[14:15]
v_cvt_pk_bf16_f32 v120, v176, v177
v_cvt_pk_bf16_f32 v121, v178, v179
v_cvt_pk_bf16_f32 v122, v184, v185
v_cvt_pk_bf16_f32 v123, v186, v187
v_cvt_pk_bf16_f32 v124, v180, v181
v_cvt_pk_bf16_f32 v125, v182, v183
v_cvt_pk_bf16_f32 v126, v188, v189
v_cvt_pk_bf16_f32 v127, v190, v191
v_pk_mul_f32 v[192:193], v[192:193], v[12:13]
v_pk_mul_f32 v[194:195], v[194:195], v[12:13]
v_pk_mul_f32 v[196:197], v[196:197], v[14:15]
v_pk_mul_f32 v[198:199], v[198:199], v[14:15]
v_pk_mul_f32 v[200:201], v[200:201], v[12:13]
v_pk_mul_f32 v[202:203], v[202:203], v[12:13]
v_pk_mul_f32 v[204:205], v[204:205], v[14:15]
v_pk_mul_f32 v[206:207], v[206:207], v[14:15]
v_cvt_pk_bf16_f32 v128, v192, v193
v_cvt_pk_bf16_f32 v129, v194, v195
v_cvt_pk_bf16_f32 v130, v200, v201
v_cvt_pk_bf16_f32 v131, v202, v203
v_cvt_pk_bf16_f32 v132, v196, v197
v_cvt_pk_bf16_f32 v133, v198, v199
v_cvt_pk_bf16_f32 v134, v204, v205
v_cvt_pk_bf16_f32 v135, v206, v207
v_pk_mul_f32 v[208:209], v[208:209], v[12:13]
v_pk_mul_f32 v[210:211], v[210:211], v[12:13]
v_pk_mul_f32 v[212:213], v[212:213], v[14:15]
v_pk_mul_f32 v[214:215], v[214:215], v[14:15]
v_pk_mul_f32 v[216:217], v[216:217], v[12:13]
v_pk_mul_f32 v[218:219], v[218:219], v[12:13]
v_pk_mul_f32 v[220:221], v[220:221], v[14:15]
v_pk_mul_f32 v[222:223], v[222:223], v[14:15]
v_cvt_pk_bf16_f32 v136, v208, v209
v_cvt_pk_bf16_f32 v137, v210, v211
v_cvt_pk_bf16_f32 v138, v216, v217
v_cvt_pk_bf16_f32 v139, v218, v219
v_cvt_pk_bf16_f32 v140, v212, v213
v_cvt_pk_bf16_f32 v141, v214, v215
v_cvt_pk_bf16_f32 v142, v220, v221
v_cvt_pk_bf16_f32 v143, v222, v223
v_pk_mul_f32 v[224:225], v[224:225], v[12:13]
v_pk_mul_f32 v[226:227], v[226:227], v[12:13]
v_pk_mul_f32 v[228:229], v[228:229], v[14:15]
v_pk_mul_f32 v[230:231], v[230:231], v[14:15]
v_pk_mul_f32 v[232:233], v[232:233], v[12:13]
v_pk_mul_f32 v[234:235], v[234:235], v[12:13]
v_pk_mul_f32 v[236:237], v[236:237], v[14:15]
v_pk_mul_f32 v[238:239], v[238:239], v[14:15]
v_cvt_pk_bf16_f32 v144, v224, v225
v_cvt_pk_bf16_f32 v145, v226, v227
v_cvt_pk_bf16_f32 v146, v232, v233
v_cvt_pk_bf16_f32 v147, v234, v235
v_cvt_pk_bf16_f32 v148, v228, v229
v_cvt_pk_bf16_f32 v149, v230, v231
v_cvt_pk_bf16_f32 v150, v236, v237
v_cvt_pk_bf16_f32 v151, v238, v239
v_pk_mul_f32 v[240:241], v[240:241], v[12:13]
v_pk_mul_f32 v[242:243], v[242:243], v[12:13]
v_pk_mul_f32 v[244:245], v[244:245], v[14:15]
v_pk_mul_f32 v[246:247], v[246:247], v[14:15]
v_pk_mul_f32 v[248:249], v[248:249], v[12:13]
v_pk_mul_f32 v[250:251], v[250:251], v[12:13]
v_pk_mul_f32 v[252:253], v[252:253], v[14:15]
v_pk_mul_f32 v[254:255], v[254:255], v[14:15]
v_cvt_pk_bf16_f32 v152, v240, v241
v_cvt_pk_bf16_f32 v153, v242, v243
v_cvt_pk_bf16_f32 v154, v248, v249
v_cvt_pk_bf16_f32 v155, v250, v251
v_cvt_pk_bf16_f32 v156, v244, v245
v_cvt_pk_bf16_f32 v157, v246, v247
v_cvt_pk_bf16_f32 v158, v252, v253
v_cvt_pk_bf16_f32 v159, v254, v255
s_mov_b32 s68, s67
s_branch L_worker
L_x0:
v_lshlrev_b32 v1, 4, v0
v_add_u32 v1, 73728, v1
ds_write_b128 v1, v[64:67] offset:36864
ds_write_b128 v1, v[68:71] offset:37888
ds_write_b128 v1, v[72:75] offset:38912
ds_write_b128 v1, v[76:79] offset:39936
ds_write_b128 v1, v[80:83] offset:40960
ds_write_b128 v1, v[84:87] offset:41984
ds_write_b128 v1, v[88:91] offset:43008
ds_write_b128 v1, v[92:95] offset:44032
ds_write_b128 v1, v[96:99] offset:45056
ds_write_b128 v1, v[100:103] offset:46080
ds_write_b128 v1, v[104:107] offset:47104
ds_write_b128 v1, v[108:111] offset:48128
v_mov_b32 v12, v8
v_mov_b32 v13, v9
s_nop 1
v_permlane32_swap_b32 v12, v13
v_add_f32 v12, v12, v13
v_mov_b32 v13, v12
s_nop 1
v_permlane16_swap_b32 v12, v13
v_add_f32 v12, v12, v13
v_rcp_f32 v12, v12
s_nop 0
v_mov_b32 v14, v12
s_nop 1
v_permlane32_swap_b32 v12, v14
v_mov_b32 v13, v12
v_mov_b32 v15, v14
v_pk_mul_f32 v[160:161], v[160:161], v[12:13]
v_pk_mul_f32 v[162:163], v[162:163], v[12:13]
v_pk_mul_f32 v[164:165], v[164:165], v[14:15]
v_pk_mul_f32 v[166:167], v[166:167], v[14:15]
v_pk_mul_f32 v[168:169], v[168:169], v[12:13]
v_pk_mul_f32 v[170:171], v[170:171], v[12:13]
v_pk_mul_f32 v[172:173], v[172:173], v[14:15]
v_pk_mul_f32 v[174:175], v[174:175], v[14:15]
v_cvt_pk_bf16_f32 v112, v160, v161
v_cvt_pk_bf16_f32 v113, v162, v163
v_cvt_pk_bf16_f32 v114, v168, v169
v_cvt_pk_bf16_f32 v115, v170, v171
v_cvt_pk_bf16_f32 v116, v164, v165
v_cvt_pk_bf16_f32 v117, v166, v167
v_cvt_pk_bf16_f32 v118, v172, v173
v_cvt_pk_bf16_f32 v119, v174, v175
v_pk_mul_f32 v[176:177], v[176:177], v[12:13]
v_pk_mul_f32 v[178:179], v[178:179], v[12:13]
v_pk_mul_f32 v[180:181], v[180:181], v[14:15]
v_pk_mul_f32 v[182:183], v[182:183], v[14:15]
v_pk_mul_f32 v[184:185], v[184:185], v[12:13]
v_pk_mul_f32 v[186:187], v[186:187], v[12:13]
v_pk_mul_f32 v[188:189], v[188:189], v[14:15]
v_pk_mul_f32 v[190:191], v[190:191], v[14:15]
v_cvt_pk_bf16_f32 v120, v176, v177
v_cvt_pk_bf16_f32 v121, v178, v179
v_cvt_pk_bf16_f32 v122, v184, v185
v_cvt_pk_bf16_f32 v123, v186, v187
v_cvt_pk_bf16_f32 v124, v180, v181
v_cvt_pk_bf16_f32 v125, v182, v183
v_cvt_pk_bf16_f32 v126, v188, v189
v_cvt_pk_bf16_f32 v127, v190, v191
v_pk_mul_f32 v[192:193], v[192:193], v[12:13]
v_pk_mul_f32 v[194:195], v[194:195], v[12:13]
v_pk_mul_f32 v[196:197], v[196:197], v[14:15]
v_pk_mul_f32 v[198:199], v[198:199], v[14:15]
v_pk_mul_f32 v[200:201], v[200:201], v[12:13]
v_pk_mul_f32 v[202:203], v[202:203], v[12:13]
v_pk_mul_f32 v[204:205], v[204:205], v[14:15]
v_pk_mul_f32 v[206:207], v[206:207], v[14:15]
v_cvt_pk_bf16_f32 v128, v192, v193
v_cvt_pk_bf16_f32 v129, v194, v195
v_cvt_pk_bf16_f32 v130, v200, v201
v_cvt_pk_bf16_f32 v131, v202, v203
v_cvt_pk_bf16_f32 v132, v196, v197
v_cvt_pk_bf16_f32 v133, v198, v199
v_cvt_pk_bf16_f32 v134, v204, v205
v_cvt_pk_bf16_f32 v135, v206, v207
v_pk_mul_f32 v[208:209], v[208:209], v[12:13]
v_pk_mul_f32 v[210:211], v[210:211], v[12:13]
v_pk_mul_f32 v[212:213], v[212:213], v[14:15]
v_pk_mul_f32 v[214:215], v[214:215], v[14:15]
v_pk_mul_f32 v[216:217], v[216:217], v[12:13]
v_pk_mul_f32 v[218:219], v[218:219], v[12:13]
v_pk_mul_f32 v[220:221], v[220:221], v[14:15]
v_pk_mul_f32 v[222:223], v[222:223], v[14:15]
v_cvt_pk_bf16_f32 v136, v208, v209
v_cvt_pk_bf16_f32 v137, v210, v211
v_cvt_pk_bf16_f32 v138, v216, v217
v_cvt_pk_bf16_f32 v139, v218, v219
v_cvt_pk_bf16_f32 v140, v212, v213
v_cvt_pk_bf16_f32 v141, v214, v215
v_cvt_pk_bf16_f32 v142, v220, v221
v_cvt_pk_bf16_f32 v143, v222, v223
v_pk_mul_f32 v[224:225], v[224:225], v[12:13]
v_pk_mul_f32 v[226:227], v[226:227], v[12:13]
v_pk_mul_f32 v[228:229], v[228:229], v[14:15]
v_pk_mul_f32 v[230:231], v[230:231], v[14:15]
v_pk_mul_f32 v[232:233], v[232:233], v[12:13]
v_pk_mul_f32 v[234:235], v[234:235], v[12:13]
v_pk_mul_f32 v[236:237], v[236:237], v[14:15]
v_pk_mul_f32 v[238:239], v[238:239], v[14:15]
v_cvt_pk_bf16_f32 v144, v224, v225
v_cvt_pk_bf16_f32 v145, v226, v227
v_cvt_pk_bf16_f32 v146, v232, v233
v_cvt_pk_bf16_f32 v147, v234, v235
v_cvt_pk_bf16_f32 v148, v228, v229
v_cvt_pk_bf16_f32 v149, v230, v231
v_cvt_pk_bf16_f32 v150, v236, v237
v_cvt_pk_bf16_f32 v151, v238, v239
v_pk_mul_f32 v[240:241], v[240:241], v[12:13]
v_pk_mul_f32 v[242:243], v[242:243], v[12:13]
v_pk_mul_f32 v[244:245], v[244:245], v[14:15]
v_pk_mul_f32 v[246:247], v[246:247], v[14:15]
v_pk_mul_f32 v[248:249], v[248:249], v[12:13]
v_pk_mul_f32 v[250:251], v[250:251], v[12:13]
v_pk_mul_f32 v[252:253], v[252:253], v[14:15]
v_pk_mul_f32 v[254:255], v[254:255], v[14:15]
v_cvt_pk_bf16_f32 v152, v240, v241
v_cvt_pk_bf16_f32 v153, v242, v243
v_cvt_pk_bf16_f32 v154, v248, v249
v_cvt_pk_bf16_f32 v155, v250, v251
v_cvt_pk_bf16_f32 v156, v244, v245
v_cvt_pk_bf16_f32 v157, v246, v247
v_cvt_pk_bf16_f32 v158, v252, v253
v_cvt_pk_bf16_f32 v159, v254, v255
s_waitcnt lgkmcnt(0)
s_barrier
ds_write_b128 v1, v[112:115] offset:49152
ds_write_b128 v1, v[116:119] offset:50176
ds_write_b128 v1, v[120:123] offset:51200
ds_write_b128 v1, v[124:127] offset:52224
ds_write_b128 v1, v[128:131] offset:53248
ds_write_b128 v1, v[132:135] offset:54272
ds_write_b128 v1, v[136:139] offset:55296
ds_write_b128 v1, v[140:143] offset:56320
ds_write_b128 v1, v[144:147] offset:57344
ds_write_b128 v1, v[148:151] offset:58368
ds_write_b128 v1, v[152:155] offset:59392
ds_write_b128 v1, v[156:159] offset:60416
s_waitcnt lgkmcnt(0)
s_mov_b32 s73, 0
L_idle_x0a:
s_barrier
s_add_u32 s73, s73, 1
s_cmp_lt_u32 s73, 6
s_cbranch_scc1 L_idle_x0a
s_getpc_b64 s[4:5]
L_pc:
s_sub_u32 s4, s4, L_pc - concat_heads__mha_block_cached__gqa_block_cached__near_ridge_kernel
s_subb_u32 s5, s5, 0
s_lshr_b32 s6, s2, 3
s_mul_i32 s6, s6, 5120
s_add_u32 s4, s4, s6
s_addc_u32 s5, s5, 0
s_mov_b32 s7, 0
L_cp:
s_load_dword s8, s[4:5], 0
s_load_dword s9, s[4:5], 128
s_load_dword s10, s[4:5], 256
s_load_dword s11, s[4:5], 384
s_load_dword s12, s[4:5], 512
s_load_dword s13, s[4:5], 640
s_load_dword s14, s[4:5], 768
s_load_dword s15, s[4:5], 896
s_add_u32 s4, s4, 1024
s_addc_u32 s5, s5, 0
s_add_u32 s7, s7, 1024
s_cmp_lt_u32 s7, 5120
s_cbranch_scc1 L_cp
s_waitcnt lgkmcnt(0)
s_mov_b32 s73, 0
L_idle_x0:
s_barrier
s_add_u32 s73, s73, 1
s_cmp_lt_u32 s73, 9
s_cbranch_scc1 L_idle_x0
s_branch L_stage2_0
L_y_end:
s_setprio 3
s_and_b32 s68, s67, 3
s_mul_i32 s70, s68, 12288
s_add_u32 s70, s70, 24576
v_lshlrev_b32 v1, 4, v0
v_add_u32 v1, s70, v1
v_mov_b32 v12, v8
v_mov_b32 v13, v9
s_nop 1
v_permlane32_swap_b32 v12, v13
v_add_f32 v12, v12, v13
v_mov_b32 v13, v12
s_nop 1
v_permlane16_swap_b32 v12, v13
v_add_f32 v12, v12, v13
v_rcp_f32 v12, v12
s_nop 0
v_mov_b32 v14, v12
s_nop 1
v_permlane32_swap_b32 v12, v14
v_mov_b32 v13, v12
v_mov_b32 v15, v14
v_pk_mul_f32 v[160:161], v[160:161], v[12:13]
v_pk_mul_f32 v[162:163], v[162:163], v[12:13]
v_pk_mul_f32 v[164:165], v[164:165], v[14:15]
v_pk_mul_f32 v[166:167], v[166:167], v[14:15]
v_pk_mul_f32 v[168:169], v[168:169], v[12:13]
v_pk_mul_f32 v[170:171], v[170:171], v[12:13]
v_pk_mul_f32 v[172:173], v[172:173], v[14:15]
v_pk_mul_f32 v[174:175], v[174:175], v[14:15]
v_cvt_pk_bf16_f32 v112, v160, v161
v_cvt_pk_bf16_f32 v113, v162, v163
v_cvt_pk_bf16_f32 v114, v168, v169
v_cvt_pk_bf16_f32 v115, v170, v171
ds_write_b128 v1, v[112:115] offset:0
v_cvt_pk_bf16_f32 v116, v164, v165
v_cvt_pk_bf16_f32 v117, v166, v167
v_cvt_pk_bf16_f32 v118, v172, v173
v_cvt_pk_bf16_f32 v119, v174, v175
ds_write_b128 v1, v[116:119] offset:1024
v_pk_mul_f32 v[176:177], v[176:177], v[12:13]
v_pk_mul_f32 v[178:179], v[178:179], v[12:13]
v_pk_mul_f32 v[180:181], v[180:181], v[14:15]
v_pk_mul_f32 v[182:183], v[182:183], v[14:15]
v_pk_mul_f32 v[184:185], v[184:185], v[12:13]
v_pk_mul_f32 v[186:187], v[186:187], v[12:13]
v_pk_mul_f32 v[188:189], v[188:189], v[14:15]
v_pk_mul_f32 v[190:191], v[190:191], v[14:15]
v_cvt_pk_bf16_f32 v120, v176, v177
v_cvt_pk_bf16_f32 v121, v178, v179
v_cvt_pk_bf16_f32 v122, v184, v185
v_cvt_pk_bf16_f32 v123, v186, v187
ds_write_b128 v1, v[120:123] offset:2048
v_cvt_pk_bf16_f32 v124, v180, v181
v_cvt_pk_bf16_f32 v125, v182, v183
v_cvt_pk_bf16_f32 v126, v188, v189
v_cvt_pk_bf16_f32 v127, v190, v191
ds_write_b128 v1, v[124:127] offset:3072
v_pk_mul_f32 v[192:193], v[192:193], v[12:13]
v_pk_mul_f32 v[194:195], v[194:195], v[12:13]
v_pk_mul_f32 v[196:197], v[196:197], v[14:15]
v_pk_mul_f32 v[198:199], v[198:199], v[14:15]
v_pk_mul_f32 v[200:201], v[200:201], v[12:13]
v_pk_mul_f32 v[202:203], v[202:203], v[12:13]
v_pk_mul_f32 v[204:205], v[204:205], v[14:15]
v_pk_mul_f32 v[206:207], v[206:207], v[14:15]
v_cvt_pk_bf16_f32 v128, v192, v193
v_cvt_pk_bf16_f32 v129, v194, v195
v_cvt_pk_bf16_f32 v130, v200, v201
v_cvt_pk_bf16_f32 v131, v202, v203
ds_write_b128 v1, v[128:131] offset:4096
v_cvt_pk_bf16_f32 v132, v196, v197
v_cvt_pk_bf16_f32 v133, v198, v199
v_cvt_pk_bf16_f32 v134, v204, v205
v_cvt_pk_bf16_f32 v135, v206, v207
ds_write_b128 v1, v[132:135] offset:5120
v_pk_mul_f32 v[208:209], v[208:209], v[12:13]
v_pk_mul_f32 v[210:211], v[210:211], v[12:13]
v_pk_mul_f32 v[212:213], v[212:213], v[14:15]
v_pk_mul_f32 v[214:215], v[214:215], v[14:15]
v_pk_mul_f32 v[216:217], v[216:217], v[12:13]
v_pk_mul_f32 v[218:219], v[218:219], v[12:13]
v_pk_mul_f32 v[220:221], v[220:221], v[14:15]
v_pk_mul_f32 v[222:223], v[222:223], v[14:15]
v_cvt_pk_bf16_f32 v136, v208, v209
v_cvt_pk_bf16_f32 v137, v210, v211
v_cvt_pk_bf16_f32 v138, v216, v217
v_cvt_pk_bf16_f32 v139, v218, v219
ds_write_b128 v1, v[136:139] offset:6144
v_cvt_pk_bf16_f32 v140, v212, v213
v_cvt_pk_bf16_f32 v141, v214, v215
v_cvt_pk_bf16_f32 v142, v220, v221
v_cvt_pk_bf16_f32 v143, v222, v223
ds_write_b128 v1, v[140:143] offset:7168
v_pk_mul_f32 v[224:225], v[224:225], v[12:13]
v_pk_mul_f32 v[226:227], v[226:227], v[12:13]
v_pk_mul_f32 v[228:229], v[228:229], v[14:15]
v_pk_mul_f32 v[230:231], v[230:231], v[14:15]
v_pk_mul_f32 v[232:233], v[232:233], v[12:13]
v_pk_mul_f32 v[234:235], v[234:235], v[12:13]
v_pk_mul_f32 v[236:237], v[236:237], v[14:15]
v_pk_mul_f32 v[238:239], v[238:239], v[14:15]
v_cvt_pk_bf16_f32 v144, v224, v225
v_cvt_pk_bf16_f32 v145, v226, v227
v_cvt_pk_bf16_f32 v146, v232, v233
v_cvt_pk_bf16_f32 v147, v234, v235
ds_write_b128 v1, v[144:147] offset:8192
v_cvt_pk_bf16_f32 v148, v228, v229
v_cvt_pk_bf16_f32 v149, v230, v231
v_cvt_pk_bf16_f32 v150, v236, v237
v_cvt_pk_bf16_f32 v151, v238, v239
ds_write_b128 v1, v[148:151] offset:9216
v_pk_mul_f32 v[240:241], v[240:241], v[12:13]
v_pk_mul_f32 v[242:243], v[242:243], v[12:13]
v_pk_mul_f32 v[244:245], v[244:245], v[14:15]
v_pk_mul_f32 v[246:247], v[246:247], v[14:15]
v_pk_mul_f32 v[248:249], v[248:249], v[12:13]
v_pk_mul_f32 v[250:251], v[250:251], v[12:13]
v_pk_mul_f32 v[252:253], v[252:253], v[14:15]
v_pk_mul_f32 v[254:255], v[254:255], v[14:15]
v_cvt_pk_bf16_f32 v152, v240, v241
v_cvt_pk_bf16_f32 v153, v242, v243
v_cvt_pk_bf16_f32 v154, v248, v249
v_cvt_pk_bf16_f32 v155, v250, v251
ds_write_b128 v1, v[152:155] offset:10240
v_cvt_pk_bf16_f32 v156, v244, v245
v_cvt_pk_bf16_f32 v157, v246, v247
v_cvt_pk_bf16_f32 v158, v252, v253
v_cvt_pk_bf16_f32 v159, v254, v255
ds_write_b128 v1, v[156:159] offset:11264
s_waitcnt lgkmcnt(0)
s_cmp_eq_u32 s67, 4
s_cbranch_scc1 L_stage2_1
s_cmp_eq_u32 s67, 5
s_cbranch_scc1 L_shadow0
s_branch L_shadow1
L_rare_b:
v_max3_f32 v12, v24, v25, v26
v_max3_f32 v13, v32, v33, v34
v_max3_f32 v12, v12, v27, v28
v_max3_f32 v13, v13, v35, v36
v_max3_f32 v12, v12, v29, v30
v_max3_f32 v13, v13, v37, v38
v_max_f32 v12, v12, v31
v_max_f32 v13, v13, v39
s_nop 1
v_permlane32_swap_b32 v12, v13
v_max_f32 v12, v12, v13
v_mov_b32 v13, v12
s_nop 1
v_permlane16_swap_b32 v12, v13
v_max_f32 v12, v12, v13
v_mov_b32 v13, v12
s_nop 1
v_permlane32_swap_b32 v12, v13
v_max_f32 v12, 0, v12
v_max_f32 v13, 0, v13
v_sub_f32 v24, v24, v12
v_sub_f32 v25, v25, v12
v_sub_f32 v26, v26, v12
v_sub_f32 v27, v27, v12
v_sub_f32 v28, v28, v12
v_sub_f32 v29, v29, v12
v_sub_f32 v30, v30, v12
v_sub_f32 v31, v31, v12
v_sub_f32 v32, v32, v13
v_sub_f32 v33, v33, v13
v_sub_f32 v34, v34, v13
v_sub_f32 v35, v35, v13
v_sub_f32 v36, v36, v13
v_sub_f32 v37, v37, v13
v_sub_f32 v38, v38, v13
v_sub_f32 v39, v39, v13
v_sub_f32 v40, v40, v12
v_sub_f32 v41, v41, v12
v_sub_f32 v42, v42, v12
v_sub_f32 v43, v43, v12
v_sub_f32 v44, v44, v13
v_sub_f32 v45, v45, v13
v_sub_f32 v46, v46, v13
v_sub_f32 v47, v47, v13
v_exp_f32 v14, -v12
v_exp_f32 v15, -v13
s_nop 0
v_mul_f32 v8, v8, v14
v_mul_f32 v9, v9, v15
v_mul_f32 v160, v160, v14
v_mul_f32 v161, v161, v14
v_mul_f32 v162, v162, v14
v_mul_f32 v163, v163, v14
v_mul_f32 v164, v164, v15
v_mul_f32 v165, v165, v15
v_mul_f32 v166, v166, v15
v_mul_f32 v167, v167, v15
v_mul_f32 v168, v168, v14
v_mul_f32 v169, v169, v14
v_mul_f32 v170, v170, v14
v_mul_f32 v171, v171, v14
v_mul_f32 v172, v172, v15
v_mul_f32 v173, v173, v15
v_mul_f32 v174, v174, v15
v_mul_f32 v175, v175, v15
v_mul_f32 v176, v176, v14
v_mul_f32 v177, v177, v14
v_mul_f32 v178, v178, v14
v_mul_f32 v179, v179, v14
v_mul_f32 v180, v180, v15
v_mul_f32 v181, v181, v15
v_mul_f32 v182, v182, v15
v_mul_f32 v183, v183, v15
v_mul_f32 v184, v184, v14
v_mul_f32 v185, v185, v14
v_mul_f32 v186, v186, v14
v_mul_f32 v187, v187, v14
v_mul_f32 v188, v188, v15
v_mul_f32 v189, v189, v15
v_mul_f32 v190, v190, v15
v_mul_f32 v191, v191, v15
v_mul_f32 v192, v192, v14
v_mul_f32 v193, v193, v14
v_mul_f32 v194, v194, v14
v_mul_f32 v195, v195, v14
v_mul_f32 v196, v196, v15
v_mul_f32 v197, v197, v15
v_mul_f32 v198, v198, v15
v_mul_f32 v199, v199, v15
v_mul_f32 v200, v200, v14
v_mul_f32 v201, v201, v14
v_mul_f32 v202, v202, v14
v_mul_f32 v203, v203, v14
v_mul_f32 v204, v204, v15
v_mul_f32 v205, v205, v15
v_mul_f32 v206, v206, v15
v_mul_f32 v207, v207, v15
v_mul_f32 v208, v208, v14
v_mul_f32 v209, v209, v14
v_mul_f32 v210, v210, v14
v_mul_f32 v211, v211, v14
v_mul_f32 v212, v212, v15
v_mul_f32 v213, v213, v15
v_mul_f32 v214, v214, v15
v_mul_f32 v215, v215, v15
v_mul_f32 v216, v216, v14
v_mul_f32 v217, v217, v14
v_mul_f32 v218, v218, v14
v_mul_f32 v219, v219, v14
v_mul_f32 v220, v220, v15
v_mul_f32 v221, v221, v15
v_mul_f32 v222, v222, v15
v_mul_f32 v223, v223, v15
v_mul_f32 v224, v224, v14
v_mul_f32 v225, v225, v14
v_mul_f32 v226, v226, v14
v_mul_f32 v227, v227, v14
v_mul_f32 v228, v228, v15
v_mul_f32 v229, v229, v15
v_mul_f32 v230, v230, v15
v_mul_f32 v231, v231, v15
v_mul_f32 v232, v232, v14
v_mul_f32 v233, v233, v14
v_mul_f32 v234, v234, v14
v_mul_f32 v235, v235, v14
v_mul_f32 v236, v236, v15
v_mul_f32 v237, v237, v15
v_mul_f32 v238, v238, v15
v_mul_f32 v239, v239, v15
v_mul_f32 v240, v240, v14
v_mul_f32 v241, v241, v14
v_mul_f32 v242, v242, v14
v_mul_f32 v243, v243, v14
v_mul_f32 v244, v244, v15
v_mul_f32 v245, v245, v15
v_mul_f32 v246, v246, v15
v_mul_f32 v247, v247, v15
v_mul_f32 v248, v248, v14
v_mul_f32 v249, v249, v14
v_mul_f32 v250, v250, v14
v_mul_f32 v251, v251, v14
v_mul_f32 v252, v252, v15
v_mul_f32 v253, v253, v15
v_mul_f32 v254, v254, v15
v_mul_f32 v255, v255, v15
s_branch L_back_b
L_w7:
v_lshlrev_b32 v1, 4, v0
v_add_u32 v2, 122880, v1
s_barrier
ds_read_b128 v[16:19], v1 offset:0
ds_read_b128 v[20:23], v1 offset:1024
ds_read_b128 v[24:27], v1 offset:2048
ds_read_b128 v[28:31], v1 offset:3072
ds_read_b128 v[32:35], v1 offset:4096
ds_read_b128 v[36:39], v1 offset:5120
ds_read_b128 v[40:43], v1 offset:6144
ds_read_b128 v[44:47], v1 offset:7168
ds_read_b128 v[48:51], v1 offset:8192
ds_read_b128 v[52:55], v1 offset:9216
ds_read_b128 v[56:59], v1 offset:10240
ds_read_b128 v[60:63], v1 offset:11264
s_waitcnt lgkmcnt(0)
s_barrier
s_barrier
s_barrier
s_barrier
ds_read_b128 v[64:67], v1 offset:24576
ds_read_b128 v[68:71], v1 offset:25600
ds_read_b128 v[72:75], v1 offset:26624
ds_read_b128 v[76:79], v1 offset:27648
ds_read_b128 v[80:83], v1 offset:28672
ds_read_b128 v[84:87], v1 offset:29696
ds_read_b128 v[88:91], v1 offset:30720
ds_read_b128 v[92:95], v1 offset:31744
ds_read_b128 v[96:99], v1 offset:32768
ds_read_b128 v[100:103], v1 offset:33792
ds_read_b128 v[104:107], v1 offset:34816
ds_read_b128 v[108:111], v1 offset:35840
s_waitcnt lgkmcnt(0)
s_barrier
s_barrier
s_barrier
s_barrier
ds_read_b128 v[112:115], v1 offset:49152
ds_read_b128 v[116:119], v1 offset:50176
ds_read_b128 v[120:123], v1 offset:51200
ds_read_b128 v[124:127], v1 offset:52224
ds_read_b128 v[128:131], v1 offset:53248
ds_read_b128 v[132:135], v1 offset:54272
ds_read_b128 v[136:139], v1 offset:55296
ds_read_b128 v[140:143], v1 offset:56320
ds_read_b128 v[144:147], v1 offset:57344
ds_read_b128 v[148:151], v1 offset:58368
ds_read_b128 v[152:155], v1 offset:59392
ds_read_b128 v[156:159], v1 offset:60416
s_waitcnt lgkmcnt(0)
s_barrier
s_barrier
s_barrier
s_barrier
ds_read_b128 v[160:163], v1 offset:0
ds_read_b128 v[164:167], v1 offset:1024
ds_read_b128 v[168:171], v1 offset:2048
ds_read_b128 v[172:175], v1 offset:3072
ds_read_b128 v[176:179], v1 offset:4096
ds_read_b128 v[180:183], v1 offset:5120
ds_read_b128 v[184:187], v1 offset:6144
ds_read_b128 v[188:191], v1 offset:7168
ds_read_b128 v[192:195], v1 offset:8192
ds_read_b128 v[196:199], v1 offset:9216
ds_read_b128 v[200:203], v1 offset:10240
ds_read_b128 v[204:207], v1 offset:11264
s_waitcnt lgkmcnt(0)
s_barrier
s_barrier
s_barrier
s_barrier
ds_read_b128 v[208:211], v1 offset:24576
ds_read_b128 v[212:215], v1 offset:25600
ds_read_b128 v[216:219], v1 offset:26624
ds_read_b128 v[220:223], v1 offset:27648
ds_read_b128 v[224:227], v1 offset:28672
ds_read_b128 v[228:231], v1 offset:29696
ds_read_b128 v[232:235], v1 offset:30720
ds_read_b128 v[236:239], v1 offset:31744
ds_read_b128 v[240:243], v1 offset:32768
ds_read_b128 v[244:247], v1 offset:33792
ds_read_b128 v[248:251], v1 offset:34816
ds_read_b128 v[252:255], v1 offset:35840
s_waitcnt lgkmcnt(0)
s_barrier
s_barrier
s_barrier
s_barrier
s_mov_b32 s74, 0
L_w7_round:
ds_write_b128 v2, v[16:19] offset:0
ds_write_b128 v2, v[20:23] offset:1024
ds_write_b128 v2, v[24:27] offset:2048
ds_write_b128 v2, v[28:31] offset:3072
ds_write_b128 v2, v[32:35] offset:4096
ds_write_b128 v2, v[36:39] offset:5120
ds_write_b128 v2, v[40:43] offset:6144
ds_write_b128 v2, v[44:47] offset:7168
ds_write_b128 v2, v[48:51] offset:8192
ds_write_b128 v2, v[52:55] offset:9216
ds_write_b128 v2, v[56:59] offset:10240
ds_write_b128 v2, v[60:63] offset:11264
s_waitcnt lgkmcnt(0)
s_barrier
s_barrier
s_barrier
ds_write_b128 v2, v[64:67] offset:0
ds_write_b128 v2, v[68:71] offset:1024
ds_write_b128 v2, v[72:75] offset:2048
ds_write_b128 v2, v[76:79] offset:3072
ds_write_b128 v2, v[80:83] offset:4096
ds_write_b128 v2, v[84:87] offset:5120
ds_write_b128 v2, v[88:91] offset:6144
ds_write_b128 v2, v[92:95] offset:7168
ds_write_b128 v2, v[96:99] offset:8192
ds_write_b128 v2, v[100:103] offset:9216
ds_write_b128 v2, v[104:107] offset:10240
ds_write_b128 v2, v[108:111] offset:11264
s_waitcnt lgkmcnt(0)
s_barrier
s_barrier
s_barrier
ds_write_b128 v2, v[112:115] offset:0
ds_write_b128 v2, v[116:119] offset:1024
ds_write_b128 v2, v[120:123] offset:2048
ds_write_b128 v2, v[124:127] offset:3072
ds_write_b128 v2, v[128:131] offset:4096
ds_write_b128 v2, v[132:135] offset:5120
ds_write_b128 v2, v[136:139] offset:6144
ds_write_b128 v2, v[140:143] offset:7168
ds_write_b128 v2, v[144:147] offset:8192
ds_write_b128 v2, v[148:151] offset:9216
ds_write_b128 v2, v[152:155] offset:10240
ds_write_b128 v2, v[156:159] offset:11264
s_waitcnt lgkmcnt(0)
s_barrier
s_barrier
s_barrier
ds_write_b128 v2, v[160:163] offset:0
ds_write_b128 v2, v[164:167] offset:1024
ds_write_b128 v2, v[168:171] offset:2048
ds_write_b128 v2, v[172:175] offset:3072
ds_write_b128 v2, v[176:179] offset:4096
ds_write_b128 v2, v[180:183] offset:5120
ds_write_b128 v2, v[184:187] offset:6144
ds_write_b128 v2, v[188:191] offset:7168
ds_write_b128 v2, v[192:195] offset:8192
ds_write_b128 v2, v[196:199] offset:9216
ds_write_b128 v2, v[200:203] offset:10240
ds_write_b128 v2, v[204:207] offset:11264
s_waitcnt lgkmcnt(0)
s_barrier
s_barrier
s_barrier
ds_write_b128 v2, v[208:211] offset:0
ds_write_b128 v2, v[212:215] offset:1024
ds_write_b128 v2, v[216:219] offset:2048
ds_write_b128 v2, v[220:223] offset:3072
ds_write_b128 v2, v[224:227] offset:4096
ds_write_b128 v2, v[228:231] offset:5120
ds_write_b128 v2, v[232:235] offset:6144
ds_write_b128 v2, v[236:239] offset:7168
ds_write_b128 v2, v[240:243] offset:8192
ds_write_b128 v2, v[244:247] offset:9216
ds_write_b128 v2, v[248:251] offset:10240
ds_write_b128 v2, v[252:255] offset:11264
s_waitcnt lgkmcnt(0)
s_barrier
s_barrier
s_barrier
s_barrier
s_add_u32 s74, s74, 1
s_cmp_lt_u32 s74, 3
s_cbranch_scc1 L_w7_round
s_mov_b32 s68, 0
L_worker:
s_lshl_b32 s78, s64, 4
s_add_u32 s78, s78, s65
s_lshl_b32 s78, s78, 3
s_add_u32 s78, s78, s66
s_mul_i32 s78, s78, 122880
s_add_u32 s78, s78, 262144
s_mul_i32 s69, s68, 6144
s_add_u32 s78, s78, s69
s_lshl_b32 s69, s68, 11
s_add_u32 s69, s69, 0
v_lshlrev_b32 v2, 4, v0
v_add_u32 v1, s69, v2
s_mul_i32 s69, s68, 12288
v_add_u32 v2, s69, v2
v_add_u32 v3, 73728, v2
v_bfe_u32 v4, v0, 2, 2
v_mul_u32_u24 v4, 1088, v4
v_bfe_u32 v5, v0, 4, 1
v_mul_u32_u24 v5, 4384, v5
v_add_u32 v4, v4, v5
v_lshrrev_b32 v5, 5, v0
v_lshl_add_u32 v4, v5, 8, v4
v_and_b32 v5, 3, v0
v_lshl_add_u32 v4, v5, 3, v4
v_add_u32 v0, 102400, v4
s_barrier
s_cmp_lg_u32 s67, 7
s_cbranch_scc1 L_wk_b1
ds_read_b128 v[64:67], v3 offset:36864
ds_read_b128 v[68:71], v3 offset:37888
ds_read_b128 v[72:75], v3 offset:38912
ds_read_b128 v[76:79], v3 offset:39936
ds_read_b128 v[80:83], v3 offset:40960
ds_read_b128 v[84:87], v3 offset:41984
ds_read_b128 v[88:91], v3 offset:43008
ds_read_b128 v[92:95], v3 offset:44032
ds_read_b128 v[96:99], v3 offset:45056
ds_read_b128 v[100:103], v3 offset:46080
ds_read_b128 v[104:107], v3 offset:47104
ds_read_b128 v[108:111], v3 offset:48128
s_waitcnt lgkmcnt(0)
L_wk_b1:
ds_read_b128 v[160:163], v3 offset:0
ds_read_b128 v[164:167], v3 offset:1024
ds_read_b128 v[168:171], v3 offset:2048
ds_read_b128 v[172:175], v3 offset:3072
ds_read_b128 v[176:179], v3 offset:4096
ds_read_b128 v[180:183], v3 offset:5120
ds_read_b128 v[184:187], v3 offset:6144
ds_read_b128 v[188:191], v3 offset:7168
ds_read_b128 v[192:195], v3 offset:8192
ds_read_b128 v[196:199], v3 offset:9216
ds_read_b128 v[200:203], v3 offset:10240
ds_read_b128 v[204:207], v3 offset:11264
ds_read_b64_tr_b16 v[4:5], v0 offset:34944
ds_read_b64_tr_b16 v[6:7], v0 offset:35456
ds_read_b64_tr_b16 v[8:9], v0 offset:34976
ds_read_b64_tr_b16 v[10:11], v0 offset:35488
ds_read_b64_tr_b16 v[12:13], v0 offset:35008
ds_read_b64_tr_b16 v[14:15], v0 offset:35520
s_waitcnt lgkmcnt(4)
v_mfma_f32_16x16x32_bf16 v[48:51], v[4:7], v[64:67], 0
v_mfma_f32_16x16x32_bf16 v[56:59], v[4:7], v[68:71], 0
ds_read_b64_tr_b16 v[4:5], v0 offset:35040
ds_read_b64_tr_b16 v[6:7], v0 offset:35552
s_waitcnt lgkmcnt(4)
v_mfma_f32_16x16x32_bf16 v[52:55], v[8:11], v[64:67], 0
v_mfma_f32_16x16x32_bf16 v[60:63], v[8:11], v[68:71], 0
ds_read_b64_tr_b16 v[8:9], v0 offset:35072
ds_read_b64_tr_b16 v[10:11], v0 offset:35584
s_waitcnt lgkmcnt(4)
v_mfma_f32_16x16x32_bf16 v[208:211], v[12:15], v[64:67], 0
v_mfma_f32_16x16x32_bf16 v[216:219], v[12:15], v[68:71], 0
ds_read_b64_tr_b16 v[12:13], v0 offset:35104
ds_read_b64_tr_b16 v[14:15], v0 offset:35616
s_waitcnt lgkmcnt(4)
v_mfma_f32_16x16x32_bf16 v[212:215], v[4:7], v[64:67], 0
v_mfma_f32_16x16x32_bf16 v[220:223], v[4:7], v[68:71], 0
ds_read_b64_tr_b16 v[4:5], v0 offset:35136
ds_read_b64_tr_b16 v[6:7], v0 offset:35648
s_waitcnt lgkmcnt(4)
v_mfma_f32_16x16x32_bf16 v[224:227], v[8:11], v[64:67], 0
v_mfma_f32_16x16x32_bf16 v[232:235], v[8:11], v[68:71], 0
ds_read_b64_tr_b16 v[8:9], v0 offset:35168
ds_read_b64_tr_b16 v[10:11], v0 offset:35680
s_waitcnt lgkmcnt(4)
v_mfma_f32_16x16x32_bf16 v[228:231], v[12:15], v[64:67], 0
v_mfma_f32_16x16x32_bf16 v[236:239], v[12:15], v[68:71], 0
ds_read_b64_tr_b16 v[12:13], v0 offset:43680
ds_read_b64_tr_b16 v[14:15], v0 offset:44192
s_waitcnt lgkmcnt(4)
v_mfma_f32_16x16x32_bf16 v[240:243], v[4:7], v[64:67], 0
v_mfma_f32_16x16x32_bf16 v[248:251], v[4:7], v[68:71], 0
ds_read_b64_tr_b16 v[4:5], v0 offset:43712
ds_read_b64_tr_b16 v[6:7], v0 offset:44224
s_waitcnt lgkmcnt(4)
v_mfma_f32_16x16x32_bf16 v[244:247], v[8:11], v[64:67], 0
v_mfma_f32_16x16x32_bf16 v[252:255], v[8:11], v[68:71], 0
ds_read_b64_tr_b16 v[8:9], v0 offset:43744
ds_read_b64_tr_b16 v[10:11], v0 offset:44256
s_barrier
s_cmp_lg_u32 s67, 7
s_cbranch_scc1 L_wk_b2
ds_read_b128 v[112:115], v3 offset:49152
ds_read_b128 v[116:119], v3 offset:50176
ds_read_b128 v[120:123], v3 offset:51200
ds_read_b128 v[124:127], v3 offset:52224
ds_read_b128 v[128:131], v3 offset:53248
ds_read_b128 v[132:135], v3 offset:54272
ds_read_b128 v[136:139], v3 offset:55296
ds_read_b128 v[140:143], v3 offset:56320
ds_read_b128 v[144:147], v3 offset:57344
ds_read_b128 v[148:151], v3 offset:58368
ds_read_b128 v[152:155], v3 offset:59392
ds_read_b128 v[156:159], v3 offset:60416
s_waitcnt lgkmcnt(0)
L_wk_b2:
s_waitcnt lgkmcnt(4)
v_mfma_f32_16x16x32_bf16 v[48:51], v[12:15], v[72:75], v[48:51]
v_mfma_f32_16x16x32_bf16 v[56:59], v[12:15], v[76:79], v[56:59]
ds_read_b64_tr_b16 v[12:13], v0 offset:43776
ds_read_b64_tr_b16 v[14:15], v0 offset:44288
s_waitcnt lgkmcnt(4)
v_mfma_f32_16x16x32_bf16 v[52:55], v[4:7], v[72:75], v[52:55]
v_mfma_f32_16x16x32_bf16 v[60:63], v[4:7], v[76:79], v[60:63]
ds_read_b64_tr_b16 v[4:5], v0 offset:43808
ds_read_b64_tr_b16 v[6:7], v0 offset:44320
s_waitcnt lgkmcnt(4)
v_mfma_f32_16x16x32_bf16 v[208:211], v[8:11], v[72:75], v[208:211]
v_mfma_f32_16x16x32_bf16 v[216:219], v[8:11], v[76:79], v[216:219]
ds_read_b64_tr_b16 v[8:9], v0 offset:43840
ds_read_b64_tr_b16 v[10:11], v0 offset:44352
s_waitcnt lgkmcnt(4)
v_mfma_f32_16x16x32_bf16 v[212:215], v[12:15], v[72:75], v[212:215]
v_mfma_f32_16x16x32_bf16 v[220:223], v[12:15], v[76:79], v[220:223]
ds_read_b64_tr_b16 v[12:13], v0 offset:43872
ds_read_b64_tr_b16 v[14:15], v0 offset:44384
s_waitcnt lgkmcnt(4)
v_mfma_f32_16x16x32_bf16 v[224:227], v[4:7], v[72:75], v[224:227]
v_mfma_f32_16x16x32_bf16 v[232:235], v[4:7], v[76:79], v[232:235]
ds_read_b64_tr_b16 v[4:5], v0 offset:43904
ds_read_b64_tr_b16 v[6:7], v0 offset:44416
s_waitcnt lgkmcnt(4)
v_mfma_f32_16x16x32_bf16 v[228:231], v[8:11], v[72:75], v[228:231]
v_mfma_f32_16x16x32_bf16 v[236:239], v[8:11], v[76:79], v[236:239]
ds_read_b64_tr_b16 v[8:9], v0 offset:52416
ds_read_b64_tr_b16 v[10:11], v0 offset:52928
s_waitcnt lgkmcnt(4)
v_mfma_f32_16x16x32_bf16 v[240:243], v[12:15], v[72:75], v[240:243]
v_mfma_f32_16x16x32_bf16 v[248:251], v[12:15], v[76:79], v[248:251]
ds_read_b64_tr_b16 v[12:13], v0 offset:52448
ds_read_b64_tr_b16 v[14:15], v0 offset:52960
s_waitcnt lgkmcnt(4)
v_mfma_f32_16x16x32_bf16 v[244:247], v[4:7], v[72:75], v[244:247]
v_mfma_f32_16x16x32_bf16 v[252:255], v[4:7], v[76:79], v[252:255]
ds_read_b64_tr_b16 v[4:5], v0 offset:52480
ds_read_b64_tr_b16 v[6:7], v0 offset:52992
s_barrier
s_waitcnt lgkmcnt(4)
v_mfma_f32_16x16x32_bf16 v[48:51], v[8:11], v[80:83], v[48:51]
v_mfma_f32_16x16x32_bf16 v[56:59], v[8:11], v[84:87], v[56:59]
ds_read_b64_tr_b16 v[8:9], v0 offset:52512
ds_read_b64_tr_b16 v[10:11], v0 offset:53024
s_waitcnt lgkmcnt(4)
v_mfma_f32_16x16x32_bf16 v[52:55], v[12:15], v[80:83], v[52:55]
v_mfma_f32_16x16x32_bf16 v[60:63], v[12:15], v[84:87], v[60:63]
ds_read_b64_tr_b16 v[12:13], v0 offset:52544
ds_read_b64_tr_b16 v[14:15], v0 offset:53056
s_waitcnt lgkmcnt(4)
v_mfma_f32_16x16x32_bf16 v[208:211], v[4:7], v[80:83], v[208:211]
v_mfma_f32_16x16x32_bf16 v[216:219], v[4:7], v[84:87], v[216:219]
ds_read_b64_tr_b16 v[4:5], v0 offset:52576
ds_read_b64_tr_b16 v[6:7], v0 offset:53088
s_waitcnt lgkmcnt(4)
v_mfma_f32_16x16x32_bf16 v[212:215], v[8:11], v[80:83], v[212:215]
v_mfma_f32_16x16x32_bf16 v[220:223], v[8:11], v[84:87], v[220:223]
ds_read_b64_tr_b16 v[8:9], v0 offset:52608
ds_read_b64_tr_b16 v[10:11], v0 offset:53120
s_waitcnt lgkmcnt(4)
v_mfma_f32_16x16x32_bf16 v[224:227], v[12:15], v[80:83], v[224:227]
v_mfma_f32_16x16x32_bf16 v[232:235], v[12:15], v[84:87], v[232:235]
ds_read_b64_tr_b16 v[12:13], v0 offset:52640
ds_read_b64_tr_b16 v[14:15], v0 offset:53152
s_waitcnt lgkmcnt(4)
v_mfma_f32_16x16x32_bf16 v[228:231], v[4:7], v[80:83], v[228:231]
v_mfma_f32_16x16x32_bf16 v[236:239], v[4:7], v[84:87], v[236:239]
ds_read_b64_tr_b16 v[4:5], v0 offset:34944
ds_read_b64_tr_b16 v[6:7], v0 offset:35456
s_waitcnt lgkmcnt(4)
v_mfma_f32_16x16x32_bf16 v[240:243], v[8:11], v[80:83], v[240:243]
v_mfma_f32_16x16x32_bf16 v[248:251], v[8:11], v[84:87], v[248:251]
ds_read_b64_tr_b16 v[8:9], v0 offset:34976
ds_read_b64_tr_b16 v[10:11], v0 offset:35488
s_waitcnt lgkmcnt(4)
v_mfma_f32_16x16x32_bf16 v[244:247], v[12:15], v[80:83], v[244:247]
v_mfma_f32_16x16x32_bf16 v[252:255], v[12:15], v[84:87], v[252:255]
ds_read_b64_tr_b16 v[12:13], v0 offset:35008
ds_read_b64_tr_b16 v[14:15], v0 offset:35520
s_barrier
v_subrev_u32 v3, 77824, v0
s_waitcnt lgkmcnt(4)
v_mfma_f32_16x16x32_bf16 v[48:51], v[4:7], v[88:91], v[48:51]
v_mfma_f32_16x16x32_bf16 v[56:59], v[4:7], v[92:95], v[56:59]
ds_read_b64_tr_b16 v[4:5], v0 offset:35040
ds_read_b64_tr_b16 v[6:7], v0 offset:35552
s_waitcnt lgkmcnt(4)
v_mfma_f32_16x16x32_bf16 v[52:55], v[8:11], v[88:91], v[52:55]
v_mfma_f32_16x16x32_bf16 v[60:63], v[8:11], v[92:95], v[60:63]
ds_read_b64_tr_b16 v[8:9], v0 offset:35072
ds_read_b64_tr_b16 v[10:11], v0 offset:35584
s_waitcnt lgkmcnt(4)
v_mfma_f32_16x16x32_bf16 v[208:211], v[12:15], v[88:91], v[208:211]
v_mfma_f32_16x16x32_bf16 v[216:219], v[12:15], v[92:95], v[216:219]
ds_read_b64_tr_b16 v[12:13], v0 offset:35104
ds_read_b64_tr_b16 v[14:15], v0 offset:35616
s_waitcnt lgkmcnt(4)
v_mfma_f32_16x16x32_bf16 v[212:215], v[4:7], v[88:91], v[212:215]
v_mfma_f32_16x16x32_bf16 v[220:223], v[4:7], v[92:95], v[220:223]
ds_read_b64_tr_b16 v[4:5], v0 offset:35136
ds_read_b64_tr_b16 v[6:7], v0 offset:35648
s_waitcnt lgkmcnt(4)
v_mfma_f32_16x16x32_bf16 v[224:227], v[8:11], v[88:91], v[224:227]
v_mfma_f32_16x16x32_bf16 v[232:235], v[8:11], v[92:95], v[232:235]
ds_read_b64_tr_b16 v[8:9], v0 offset:35168
ds_read_b64_tr_b16 v[10:11], v0 offset:35680
s_waitcnt lgkmcnt(4)
v_mfma_f32_16x16x32_bf16 v[228:231], v[12:15], v[88:91], v[228:231]
v_mfma_f32_16x16x32_bf16 v[236:239], v[12:15], v[92:95], v[236:239]
ds_read_b64_tr_b16 v[12:13], v0 offset:0
ds_read_b64_tr_b16 v[14:15], v0 offset:512
s_waitcnt lgkmcnt(4)
v_mfma_f32_16x16x32_bf16 v[240:243], v[4:7], v[88:91], v[240:243]
v_mfma_f32_16x16x32_bf16 v[248:251], v[4:7], v[92:95], v[248:251]
ds_read_b64_tr_b16 v[4:5], v0 offset:32
ds_read_b64_tr_b16 v[6:7], v0 offset:544
s_waitcnt lgkmcnt(4)
v_mfma_f32_16x16x32_bf16 v[244:247], v[8:11], v[88:91], v[244:247]
v_mfma_f32_16x16x32_bf16 v[252:255], v[8:11], v[92:95], v[252:255]
ds_read_b64_tr_b16 v[8:9], v0 offset:64
ds_read_b64_tr_b16 v[10:11], v0 offset:576
s_waitcnt lgkmcnt(4)
v_mfma_f32_16x16x32_bf16 v[48:51], v[12:15], v[96:99], v[48:51]
v_mfma_f32_16x16x32_bf16 v[56:59], v[12:15], v[100:103], v[56:59]
ds_read_b64_tr_b16 v[12:13], v0 offset:96
ds_read_b64_tr_b16 v[14:15], v0 offset:608
s_waitcnt lgkmcnt(4)
v_mfma_f32_16x16x32_bf16 v[52:55], v[4:7], v[96:99], v[52:55]
v_mfma_f32_16x16x32_bf16 v[60:63], v[4:7], v[100:103], v[60:63]
ds_read_b64_tr_b16 v[4:5], v0 offset:128
ds_read_b64_tr_b16 v[6:7], v0 offset:640
s_waitcnt lgkmcnt(4)
v_mfma_f32_16x16x32_bf16 v[208:211], v[8:11], v[96:99], v[208:211]
v_mfma_f32_16x16x32_bf16 v[216:219], v[8:11], v[100:103], v[216:219]
ds_read_b64_tr_b16 v[8:9], v0 offset:160
ds_read_b64_tr_b16 v[10:11], v0 offset:672
s_waitcnt lgkmcnt(4)
v_mfma_f32_16x16x32_bf16 v[212:215], v[12:15], v[96:99], v[212:215]
v_mfma_f32_16x16x32_bf16 v[220:223], v[12:15], v[100:103], v[220:223]
ds_read_b64_tr_b16 v[12:13], v0 offset:192
ds_read_b64_tr_b16 v[14:15], v0 offset:704
s_waitcnt lgkmcnt(4)
v_mfma_f32_16x16x32_bf16 v[224:227], v[4:7], v[96:99], v[224:227]
v_mfma_f32_16x16x32_bf16 v[232:235], v[4:7], v[100:103], v[232:235]
ds_read_b64_tr_b16 v[4:5], v0 offset:224
ds_read_b64_tr_b16 v[6:7], v0 offset:736
s_waitcnt lgkmcnt(4)
v_mfma_f32_16x16x32_bf16 v[228:231], v[8:11], v[96:99], v[228:231]
v_mfma_f32_16x16x32_bf16 v[236:239], v[8:11], v[100:103], v[236:239]
ds_read_b64_tr_b16 v[8:9], v0 offset:8736
ds_read_b64_tr_b16 v[10:11], v0 offset:9248
s_waitcnt lgkmcnt(4)
v_mfma_f32_16x16x32_bf16 v[240:243], v[12:15], v[96:99], v[240:243]
v_mfma_f32_16x16x32_bf16 v[248:251], v[12:15], v[100:103], v[248:251]
ds_read_b64_tr_b16 v[12:13], v0 offset:8768
ds_read_b64_tr_b16 v[14:15], v0 offset:9280
s_waitcnt lgkmcnt(4)
v_mfma_f32_16x16x32_bf16 v[244:247], v[4:7], v[96:99], v[244:247]
v_mfma_f32_16x16x32_bf16 v[252:255], v[4:7], v[100:103], v[252:255]
ds_read_b64_tr_b16 v[4:5], v0 offset:8800
ds_read_b64_tr_b16 v[6:7], v0 offset:9312
s_barrier
s_waitcnt lgkmcnt(4)
v_mfma_f32_16x16x32_bf16 v[48:51], v[8:11], v[104:107], v[48:51]
v_mfma_f32_16x16x32_bf16 v[56:59], v[8:11], v[108:111], v[56:59]
ds_read_b64_tr_b16 v[8:9], v0 offset:8832
ds_read_b64_tr_b16 v[10:11], v0 offset:9344
s_waitcnt lgkmcnt(4)
v_mfma_f32_16x16x32_bf16 v[52:55], v[12:15], v[104:107], v[52:55]
v_mfma_f32_16x16x32_bf16 v[60:63], v[12:15], v[108:111], v[60:63]
ds_read_b64_tr_b16 v[12:13], v0 offset:8864
ds_read_b64_tr_b16 v[14:15], v0 offset:9376
s_waitcnt lgkmcnt(4)
v_mfma_f32_16x16x32_bf16 v[208:211], v[4:7], v[104:107], v[208:211]
v_mfma_f32_16x16x32_bf16 v[216:219], v[4:7], v[108:111], v[216:219]
ds_read_b64_tr_b16 v[4:5], v0 offset:8896
ds_read_b64_tr_b16 v[6:7], v0 offset:9408
s_waitcnt lgkmcnt(4)
v_mfma_f32_16x16x32_bf16 v[212:215], v[8:11], v[104:107], v[212:215]
v_mfma_f32_16x16x32_bf16 v[220:223], v[8:11], v[108:111], v[220:223]
ds_read_b64_tr_b16 v[8:9], v0 offset:8928
ds_read_b64_tr_b16 v[10:11], v0 offset:9440
s_waitcnt lgkmcnt(4)
v_mfma_f32_16x16x32_bf16 v[224:227], v[12:15], v[104:107], v[224:227]
v_mfma_f32_16x16x32_bf16 v[232:235], v[12:15], v[108:111], v[232:235]
ds_read_b64_tr_b16 v[12:13], v0 offset:8960
ds_read_b64_tr_b16 v[14:15], v0 offset:9472
s_waitcnt lgkmcnt(4)
v_mfma_f32_16x16x32_bf16 v[228:231], v[4:7], v[104:107], v[228:231]
v_mfma_f32_16x16x32_bf16 v[236:239], v[4:7], v[108:111], v[236:239]
ds_read_b64_tr_b16 v[4:5], v0 offset:43680
ds_read_b64_tr_b16 v[6:7], v0 offset:44192
s_waitcnt lgkmcnt(4)
v_mfma_f32_16x16x32_bf16 v[240:243], v[8:11], v[104:107], v[240:243]
v_mfma_f32_16x16x32_bf16 v[248:251], v[8:11], v[108:111], v[248:251]
ds_read_b64_tr_b16 v[8:9], v0 offset:43712
ds_read_b64_tr_b16 v[10:11], v0 offset:44224
s_waitcnt lgkmcnt(4)
v_mfma_f32_16x16x32_bf16 v[244:247], v[12:15], v[104:107], v[244:247]
v_mfma_f32_16x16x32_bf16 v[252:255], v[12:15], v[108:111], v[252:255]
ds_read_b64_tr_b16 v[12:13], v0 offset:43744
ds_read_b64_tr_b16 v[14:15], v0 offset:44256
s_waitcnt lgkmcnt(4)
v_mfma_f32_16x16x32_bf16 v[48:51], v[4:7], v[112:115], v[48:51]
v_mfma_f32_16x16x32_bf16 v[56:59], v[4:7], v[116:119], v[56:59]
ds_read_b64_tr_b16 v[4:5], v0 offset:43776
ds_read_b64_tr_b16 v[6:7], v0 offset:44288
s_waitcnt lgkmcnt(4)
v_mfma_f32_16x16x32_bf16 v[52:55], v[8:11], v[112:115], v[52:55]
v_mfma_f32_16x16x32_bf16 v[60:63], v[8:11], v[116:119], v[60:63]
ds_read_b64_tr_b16 v[8:9], v0 offset:43808
ds_read_b64_tr_b16 v[10:11], v0 offset:44320
s_waitcnt lgkmcnt(4)
v_mfma_f32_16x16x32_bf16 v[208:211], v[12:15], v[112:115], v[208:211]
v_mfma_f32_16x16x32_bf16 v[216:219], v[12:15], v[116:119], v[216:219]
ds_read_b64_tr_b16 v[12:13], v0 offset:43840
ds_read_b64_tr_b16 v[14:15], v0 offset:44352
s_waitcnt lgkmcnt(4)
v_mfma_f32_16x16x32_bf16 v[212:215], v[4:7], v[112:115], v[212:215]
v_mfma_f32_16x16x32_bf16 v[220:223], v[4:7], v[116:119], v[220:223]
ds_read_b64_tr_b16 v[4:5], v0 offset:43872
ds_read_b64_tr_b16 v[6:7], v0 offset:44384
s_waitcnt lgkmcnt(4)
v_mfma_f32_16x16x32_bf16 v[224:227], v[8:11], v[112:115], v[224:227]
v_mfma_f32_16x16x32_bf16 v[232:235], v[8:11], v[116:119], v[232:235]
ds_read_b64_tr_b16 v[8:9], v0 offset:43904
ds_read_b64_tr_b16 v[10:11], v0 offset:44416
s_waitcnt lgkmcnt(4)
v_mfma_f32_16x16x32_bf16 v[228:231], v[12:15], v[112:115], v[228:231]
v_mfma_f32_16x16x32_bf16 v[236:239], v[12:15], v[116:119], v[236:239]
ds_read_b64_tr_b16 v[12:13], v0 offset:17472
ds_read_b64_tr_b16 v[14:15], v0 offset:17984
s_waitcnt lgkmcnt(4)
v_mfma_f32_16x16x32_bf16 v[240:243], v[4:7], v[112:115], v[240:243]
v_mfma_f32_16x16x32_bf16 v[248:251], v[4:7], v[116:119], v[248:251]
ds_read_b64_tr_b16 v[4:5], v0 offset:17504
ds_read_b64_tr_b16 v[6:7], v0 offset:18016
s_waitcnt lgkmcnt(4)
v_mfma_f32_16x16x32_bf16 v[244:247], v[8:11], v[112:115], v[244:247]
v_mfma_f32_16x16x32_bf16 v[252:255], v[8:11], v[116:119], v[252:255]
ds_read_b64_tr_b16 v[8:9], v0 offset:17536
ds_read_b64_tr_b16 v[10:11], v0 offset:18048
s_barrier
s_waitcnt lgkmcnt(4)
v_mfma_f32_16x16x32_bf16 v[48:51], v[12:15], v[120:123], v[48:51]
v_mfma_f32_16x16x32_bf16 v[56:59], v[12:15], v[124:127], v[56:59]
ds_read_b64_tr_b16 v[12:13], v0 offset:17568
ds_read_b64_tr_b16 v[14:15], v0 offset:18080
s_waitcnt lgkmcnt(4)
v_mfma_f32_16x16x32_bf16 v[52:55], v[4:7], v[120:123], v[52:55]
v_mfma_f32_16x16x32_bf16 v[60:63], v[4:7], v[124:127], v[60:63]
ds_read_b64_tr_b16 v[4:5], v0 offset:17600
ds_read_b64_tr_b16 v[6:7], v0 offset:18112
s_waitcnt lgkmcnt(4)
v_mfma_f32_16x16x32_bf16 v[208:211], v[8:11], v[120:123], v[208:211]
v_mfma_f32_16x16x32_bf16 v[216:219], v[8:11], v[124:127], v[216:219]
ds_read_b64_tr_b16 v[8:9], v0 offset:17632
ds_read_b64_tr_b16 v[10:11], v0 offset:18144
s_waitcnt lgkmcnt(4)
v_mfma_f32_16x16x32_bf16 v[212:215], v[12:15], v[120:123], v[212:215]
v_mfma_f32_16x16x32_bf16 v[220:223], v[12:15], v[124:127], v[220:223]
ds_read_b64_tr_b16 v[12:13], v0 offset:17664
ds_read_b64_tr_b16 v[14:15], v0 offset:18176
s_waitcnt lgkmcnt(4)
v_mfma_f32_16x16x32_bf16 v[224:227], v[4:7], v[120:123], v[224:227]
v_mfma_f32_16x16x32_bf16 v[232:235], v[4:7], v[124:127], v[232:235]
ds_read_b64_tr_b16 v[4:5], v0 offset:17696
ds_read_b64_tr_b16 v[6:7], v0 offset:18208
s_waitcnt lgkmcnt(4)
v_mfma_f32_16x16x32_bf16 v[228:231], v[8:11], v[120:123], v[228:231]
v_mfma_f32_16x16x32_bf16 v[236:239], v[8:11], v[124:127], v[236:239]
ds_read_b64_tr_b16 v[8:9], v0 offset:26208
ds_read_b64_tr_b16 v[10:11], v0 offset:26720
s_waitcnt lgkmcnt(4)
v_mfma_f32_16x16x32_bf16 v[240:243], v[12:15], v[120:123], v[240:243]
v_mfma_f32_16x16x32_bf16 v[248:251], v[12:15], v[124:127], v[248:251]
ds_read_b64_tr_b16 v[12:13], v0 offset:26240
ds_read_b64_tr_b16 v[14:15], v0 offset:26752
s_waitcnt lgkmcnt(4)
v_mfma_f32_16x16x32_bf16 v[244:247], v[4:7], v[120:123], v[244:247]
v_mfma_f32_16x16x32_bf16 v[252:255], v[4:7], v[124:127], v[252:255]
ds_read_b64_tr_b16 v[4:5], v0 offset:26272
ds_read_b64_tr_b16 v[6:7], v0 offset:26784
s_waitcnt lgkmcnt(4)
v_mfma_f32_16x16x32_bf16 v[48:51], v[8:11], v[128:131], v[48:51]
v_mfma_f32_16x16x32_bf16 v[56:59], v[8:11], v[132:135], v[56:59]
ds_read_b64_tr_b16 v[8:9], v0 offset:26304
ds_read_b64_tr_b16 v[10:11], v0 offset:26816
s_waitcnt lgkmcnt(4)
v_mfma_f32_16x16x32_bf16 v[52:55], v[12:15], v[128:131], v[52:55]
v_mfma_f32_16x16x32_bf16 v[60:63], v[12:15], v[132:135], v[60:63]
ds_read_b64_tr_b16 v[12:13], v0 offset:26336
ds_read_b64_tr_b16 v[14:15], v0 offset:26848
s_waitcnt lgkmcnt(4)
v_mfma_f32_16x16x32_bf16 v[208:211], v[4:7], v[128:131], v[208:211]
v_mfma_f32_16x16x32_bf16 v[216:219], v[4:7], v[132:135], v[216:219]
ds_read_b64_tr_b16 v[4:5], v0 offset:26368
ds_read_b64_tr_b16 v[6:7], v0 offset:26880
s_waitcnt lgkmcnt(4)
v_mfma_f32_16x16x32_bf16 v[212:215], v[8:11], v[128:131], v[212:215]
v_mfma_f32_16x16x32_bf16 v[220:223], v[8:11], v[132:135], v[220:223]
ds_read_b64_tr_b16 v[8:9], v0 offset:26400
ds_read_b64_tr_b16 v[10:11], v0 offset:26912
s_waitcnt lgkmcnt(4)
v_mfma_f32_16x16x32_bf16 v[224:227], v[12:15], v[128:131], v[224:227]
v_mfma_f32_16x16x32_bf16 v[232:235], v[12:15], v[132:135], v[232:235]
ds_read_b64_tr_b16 v[12:13], v0 offset:26432
ds_read_b64_tr_b16 v[14:15], v0 offset:26944
s_waitcnt lgkmcnt(4)
v_mfma_f32_16x16x32_bf16 v[228:231], v[4:7], v[128:131], v[228:231]
v_mfma_f32_16x16x32_bf16 v[236:239], v[4:7], v[132:135], v[236:239]
ds_read_b64_tr_b16 v[4:5], v0 offset:52416
ds_read_b64_tr_b16 v[6:7], v0 offset:52928
s_waitcnt lgkmcnt(4)
v_mfma_f32_16x16x32_bf16 v[240:243], v[8:11], v[128:131], v[240:243]
v_mfma_f32_16x16x32_bf16 v[248:251], v[8:11], v[132:135], v[248:251]
ds_read_b64_tr_b16 v[8:9], v0 offset:52448
ds_read_b64_tr_b16 v[10:11], v0 offset:52960
s_waitcnt lgkmcnt(4)
v_mfma_f32_16x16x32_bf16 v[244:247], v[12:15], v[128:131], v[244:247]
v_mfma_f32_16x16x32_bf16 v[252:255], v[12:15], v[132:135], v[252:255]
ds_read_b64_tr_b16 v[12:13], v0 offset:52480
ds_read_b64_tr_b16 v[14:15], v0 offset:52992
s_barrier
s_waitcnt lgkmcnt(4)
v_mfma_f32_16x16x32_bf16 v[48:51], v[4:7], v[136:139], v[48:51]
v_mfma_f32_16x16x32_bf16 v[56:59], v[4:7], v[140:143], v[56:59]
ds_read_b64_tr_b16 v[4:5], v0 offset:52512
ds_read_b64_tr_b16 v[6:7], v0 offset:53024
s_waitcnt lgkmcnt(4)
v_mfma_f32_16x16x32_bf16 v[52:55], v[8:11], v[136:139], v[52:55]
v_mfma_f32_16x16x32_bf16 v[60:63], v[8:11], v[140:143], v[60:63]
ds_read_b64_tr_b16 v[8:9], v0 offset:52544
ds_read_b64_tr_b16 v[10:11], v0 offset:53056
s_waitcnt lgkmcnt(4)
v_mfma_f32_16x16x32_bf16 v[208:211], v[12:15], v[136:139], v[208:211]
v_mfma_f32_16x16x32_bf16 v[216:219], v[12:15], v[140:143], v[216:219]
ds_read_b64_tr_b16 v[12:13], v0 offset:52576
ds_read_b64_tr_b16 v[14:15], v0 offset:53088
s_waitcnt lgkmcnt(4)
v_mfma_f32_16x16x32_bf16 v[212:215], v[4:7], v[136:139], v[212:215]
v_mfma_f32_16x16x32_bf16 v[220:223], v[4:7], v[140:143], v[220:223]
ds_read_b64_tr_b16 v[4:5], v0 offset:52608
ds_read_b64_tr_b16 v[6:7], v0 offset:53120
s_waitcnt lgkmcnt(4)
v_mfma_f32_16x16x32_bf16 v[224:227], v[8:11], v[136:139], v[224:227]
v_mfma_f32_16x16x32_bf16 v[232:235], v[8:11], v[140:143], v[232:235]
ds_read_b64_tr_b16 v[8:9], v0 offset:52640
ds_read_b64_tr_b16 v[10:11], v0 offset:53152
s_waitcnt lgkmcnt(4)
v_mfma_f32_16x16x32_bf16 v[228:231], v[12:15], v[136:139], v[228:231]
v_mfma_f32_16x16x32_bf16 v[236:239], v[12:15], v[140:143], v[236:239]
ds_read_b64_tr_b16 v[12:13], v0 offset:34944
ds_read_b64_tr_b16 v[14:15], v0 offset:35456
s_waitcnt lgkmcnt(4)
v_mfma_f32_16x16x32_bf16 v[240:243], v[4:7], v[136:139], v[240:243]
v_mfma_f32_16x16x32_bf16 v[248:251], v[4:7], v[140:143], v[248:251]
ds_read_b64_tr_b16 v[4:5], v0 offset:34976
ds_read_b64_tr_b16 v[6:7], v0 offset:35488
s_waitcnt lgkmcnt(4)
v_mfma_f32_16x16x32_bf16 v[244:247], v[8:11], v[136:139], v[244:247]
v_mfma_f32_16x16x32_bf16 v[252:255], v[8:11], v[140:143], v[252:255]
ds_read_b64_tr_b16 v[8:9], v0 offset:35008
ds_read_b64_tr_b16 v[10:11], v0 offset:35520
s_waitcnt lgkmcnt(4)
v_mfma_f32_16x16x32_bf16 v[48:51], v[12:15], v[144:147], v[48:51]
v_mfma_f32_16x16x32_bf16 v[56:59], v[12:15], v[148:151], v[56:59]
ds_read_b64_tr_b16 v[12:13], v0 offset:35040
ds_read_b64_tr_b16 v[14:15], v0 offset:35552
s_waitcnt lgkmcnt(4)
v_mfma_f32_16x16x32_bf16 v[52:55], v[4:7], v[144:147], v[52:55]
v_mfma_f32_16x16x32_bf16 v[60:63], v[4:7], v[148:151], v[60:63]
ds_read_b64_tr_b16 v[4:5], v0 offset:35072
ds_read_b64_tr_b16 v[6:7], v0 offset:35584
s_waitcnt lgkmcnt(4)
v_mfma_f32_16x16x32_bf16 v[208:211], v[8:11], v[144:147], v[208:211]
v_mfma_f32_16x16x32_bf16 v[216:219], v[8:11], v[148:151], v[216:219]
ds_read_b64_tr_b16 v[8:9], v0 offset:35104
ds_read_b64_tr_b16 v[10:11], v0 offset:35616
s_waitcnt lgkmcnt(4)
v_mfma_f32_16x16x32_bf16 v[212:215], v[12:15], v[144:147], v[212:215]
v_mfma_f32_16x16x32_bf16 v[220:223], v[12:15], v[148:151], v[220:223]
ds_read_b64_tr_b16 v[12:13], v0 offset:35136
ds_read_b64_tr_b16 v[14:15], v0 offset:35648
s_waitcnt lgkmcnt(4)
v_mfma_f32_16x16x32_bf16 v[224:227], v[4:7], v[144:147], v[224:227]
v_mfma_f32_16x16x32_bf16 v[232:235], v[4:7], v[148:151], v[232:235]
ds_read_b64_tr_b16 v[4:5], v0 offset:35168
ds_read_b64_tr_b16 v[6:7], v0 offset:35680
s_waitcnt lgkmcnt(4)
v_mfma_f32_16x16x32_bf16 v[228:231], v[8:11], v[144:147], v[228:231]
v_mfma_f32_16x16x32_bf16 v[236:239], v[8:11], v[148:151], v[236:239]
ds_read_b64_tr_b16 v[8:9], v0 offset:0
ds_read_b64_tr_b16 v[10:11], v0 offset:512
s_waitcnt lgkmcnt(4)
v_mfma_f32_16x16x32_bf16 v[240:243], v[12:15], v[144:147], v[240:243]
v_mfma_f32_16x16x32_bf16 v[248:251], v[12:15], v[148:151], v[248:251]
ds_read_b64_tr_b16 v[12:13], v0 offset:32
ds_read_b64_tr_b16 v[14:15], v0 offset:544
s_waitcnt lgkmcnt(4)
v_mfma_f32_16x16x32_bf16 v[244:247], v[4:7], v[144:147], v[244:247]
v_mfma_f32_16x16x32_bf16 v[252:255], v[4:7], v[148:151], v[252:255]
ds_read_b64_tr_b16 v[4:5], v0 offset:64
ds_read_b64_tr_b16 v[6:7], v0 offset:576
s_waitcnt lgkmcnt(4)
v_mfma_f32_16x16x32_bf16 v[48:51], v[8:11], v[152:155], v[48:51]
v_mfma_f32_16x16x32_bf16 v[56:59], v[8:11], v[156:159], v[56:59]
ds_read_b64_tr_b16 v[8:9], v0 offset:96
ds_read_b64_tr_b16 v[10:11], v0 offset:608
s_waitcnt lgkmcnt(4)
v_mfma_f32_16x16x32_bf16 v[52:55], v[12:15], v[152:155], v[52:55]
v_mfma_f32_16x16x32_bf16 v[60:63], v[12:15], v[156:159], v[60:63]
ds_read_b64_tr_b16 v[12:13], v0 offset:128
ds_read_b64_tr_b16 v[14:15], v0 offset:640
s_waitcnt lgkmcnt(4)
v_mfma_f32_16x16x32_bf16 v[208:211], v[4:7], v[152:155], v[208:211]
v_mfma_f32_16x16x32_bf16 v[216:219], v[4:7], v[156:159], v[216:219]
ds_read_b64_tr_b16 v[4:5], v0 offset:160
ds_read_b64_tr_b16 v[6:7], v0 offset:672
s_waitcnt lgkmcnt(4)
v_mfma_f32_16x16x32_bf16 v[212:215], v[8:11], v[152:155], v[212:215]
v_mfma_f32_16x16x32_bf16 v[220:223], v[8:11], v[156:159], v[220:223]
ds_read_b64_tr_b16 v[8:9], v0 offset:192
ds_read_b64_tr_b16 v[10:11], v0 offset:704
s_waitcnt lgkmcnt(4)
v_mfma_f32_16x16x32_bf16 v[224:227], v[12:15], v[152:155], v[224:227]
v_mfma_f32_16x16x32_bf16 v[232:235], v[12:15], v[156:159], v[232:235]
ds_read_b64_tr_b16 v[12:13], v0 offset:224
ds_read_b64_tr_b16 v[14:15], v0 offset:736
s_waitcnt lgkmcnt(4)
v_mfma_f32_16x16x32_bf16 v[228:231], v[4:7], v[152:155], v[228:231]
v_mfma_f32_16x16x32_bf16 v[236:239], v[4:7], v[156:159], v[236:239]
ds_read_b64_tr_b16 v[4:5], v0 offset:43680
ds_read_b64_tr_b16 v[6:7], v0 offset:44192
s_waitcnt lgkmcnt(4)
v_mfma_f32_16x16x32_bf16 v[240:243], v[8:11], v[152:155], v[240:243]
v_mfma_f32_16x16x32_bf16 v[248:251], v[8:11], v[156:159], v[248:251]
ds_read_b64_tr_b16 v[8:9], v0 offset:43712
ds_read_b64_tr_b16 v[10:11], v0 offset:44224
s_waitcnt lgkmcnt(4)
v_mfma_f32_16x16x32_bf16 v[244:247], v[12:15], v[152:155], v[244:247]
v_mfma_f32_16x16x32_bf16 v[252:255], v[12:15], v[156:159], v[252:255]
ds_read_b64_tr_b16 v[12:13], v0 offset:43744
ds_read_b64_tr_b16 v[14:15], v0 offset:44256
s_barrier
s_waitcnt lgkmcnt(4)
v_mfma_f32_16x16x32_bf16 v[48:51], v[4:7], v[160:163], v[48:51]
v_mfma_f32_16x16x32_bf16 v[56:59], v[4:7], v[164:167], v[56:59]
ds_read_b64_tr_b16 v[4:5], v0 offset:43776
ds_read_b64_tr_b16 v[6:7], v0 offset:44288
s_waitcnt lgkmcnt(4)
v_mfma_f32_16x16x32_bf16 v[52:55], v[8:11], v[160:163], v[52:55]
v_mfma_f32_16x16x32_bf16 v[60:63], v[8:11], v[164:167], v[60:63]
ds_read_b64_tr_b16 v[8:9], v0 offset:43808
ds_read_b64_tr_b16 v[10:11], v0 offset:44320
s_waitcnt lgkmcnt(4)
v_mfma_f32_16x16x32_bf16 v[208:211], v[12:15], v[160:163], v[208:211]
v_mfma_f32_16x16x32_bf16 v[216:219], v[12:15], v[164:167], v[216:219]
ds_read_b64_tr_b16 v[12:13], v0 offset:43840
ds_read_b64_tr_b16 v[14:15], v0 offset:44352
s_waitcnt lgkmcnt(4)
v_mfma_f32_16x16x32_bf16 v[212:215], v[4:7], v[160:163], v[212:215]
v_mfma_f32_16x16x32_bf16 v[220:223], v[4:7], v[164:167], v[220:223]
ds_read_b64_tr_b16 v[4:5], v0 offset:43872
ds_read_b64_tr_b16 v[6:7], v0 offset:44384
s_waitcnt lgkmcnt(4)
v_mfma_f32_16x16x32_bf16 v[224:227], v[8:11], v[160:163], v[224:227]
v_mfma_f32_16x16x32_bf16 v[232:235], v[8:11], v[164:167], v[232:235]
ds_read_b64_tr_b16 v[8:9], v0 offset:43904
ds_read_b64_tr_b16 v[10:11], v0 offset:44416
s_waitcnt lgkmcnt(4)
v_mfma_f32_16x16x32_bf16 v[228:231], v[12:15], v[160:163], v[228:231]
v_mfma_f32_16x16x32_bf16 v[236:239], v[12:15], v[164:167], v[236:239]
ds_read_b64_tr_b16 v[12:13], v0 offset:8736
ds_read_b64_tr_b16 v[14:15], v0 offset:9248
s_waitcnt lgkmcnt(4)
v_mfma_f32_16x16x32_bf16 v[240:243], v[4:7], v[160:163], v[240:243]
v_mfma_f32_16x16x32_bf16 v[248:251], v[4:7], v[164:167], v[248:251]
ds_read_b64_tr_b16 v[4:5], v0 offset:8768
ds_read_b64_tr_b16 v[6:7], v0 offset:9280
s_waitcnt lgkmcnt(4)
v_mfma_f32_16x16x32_bf16 v[244:247], v[8:11], v[160:163], v[244:247]
v_mfma_f32_16x16x32_bf16 v[252:255], v[8:11], v[164:167], v[252:255]
ds_read_b64_tr_b16 v[8:9], v0 offset:8800
ds_read_b64_tr_b16 v[10:11], v0 offset:9312
s_waitcnt lgkmcnt(4)
v_mfma_f32_16x16x32_bf16 v[48:51], v[12:15], v[168:171], v[48:51]
v_mfma_f32_16x16x32_bf16 v[56:59], v[12:15], v[172:175], v[56:59]
ds_read_b64_tr_b16 v[12:13], v0 offset:8832
ds_read_b64_tr_b16 v[14:15], v0 offset:9344
s_waitcnt lgkmcnt(4)
v_mfma_f32_16x16x32_bf16 v[52:55], v[4:7], v[168:171], v[52:55]
v_mfma_f32_16x16x32_bf16 v[60:63], v[4:7], v[172:175], v[60:63]
ds_read_b64_tr_b16 v[4:5], v0 offset:8864
ds_read_b64_tr_b16 v[6:7], v0 offset:9376
s_waitcnt lgkmcnt(4)
v_mfma_f32_16x16x32_bf16 v[208:211], v[8:11], v[168:171], v[208:211]
v_mfma_f32_16x16x32_bf16 v[216:219], v[8:11], v[172:175], v[216:219]
ds_read_b64_tr_b16 v[8:9], v0 offset:8896
ds_read_b64_tr_b16 v[10:11], v0 offset:9408
s_waitcnt lgkmcnt(4)
v_mfma_f32_16x16x32_bf16 v[212:215], v[12:15], v[168:171], v[212:215]
v_mfma_f32_16x16x32_bf16 v[220:223], v[12:15], v[172:175], v[220:223]
ds_read_b64_tr_b16 v[12:13], v0 offset:8928
ds_read_b64_tr_b16 v[14:15], v0 offset:9440
s_waitcnt lgkmcnt(4)
v_mfma_f32_16x16x32_bf16 v[224:227], v[4:7], v[168:171], v[224:227]
v_mfma_f32_16x16x32_bf16 v[232:235], v[4:7], v[172:175], v[232:235]
ds_read_b64_tr_b16 v[4:5], v0 offset:8960
ds_read_b64_tr_b16 v[6:7], v0 offset:9472
s_waitcnt lgkmcnt(4)
v_mfma_f32_16x16x32_bf16 v[228:231], v[8:11], v[168:171], v[228:231]
v_mfma_f32_16x16x32_bf16 v[236:239], v[8:11], v[172:175], v[236:239]
ds_read_b64_tr_b16 v[8:9], v0 offset:17472
ds_read_b64_tr_b16 v[10:11], v0 offset:17984
s_waitcnt lgkmcnt(4)
v_mfma_f32_16x16x32_bf16 v[240:243], v[12:15], v[168:171], v[240:243]
v_mfma_f32_16x16x32_bf16 v[248:251], v[12:15], v[172:175], v[248:251]
ds_read_b64_tr_b16 v[12:13], v0 offset:17504
ds_read_b64_tr_b16 v[14:15], v0 offset:18016
s_waitcnt lgkmcnt(4)
v_mfma_f32_16x16x32_bf16 v[244:247], v[4:7], v[168:171], v[244:247]
v_mfma_f32_16x16x32_bf16 v[252:255], v[4:7], v[172:175], v[252:255]
ds_read_b64_tr_b16 v[4:5], v0 offset:17536
ds_read_b64_tr_b16 v[6:7], v0 offset:18048
s_waitcnt lgkmcnt(4)
v_mfma_f32_16x16x32_bf16 v[48:51], v[8:11], v[176:179], v[48:51]
v_mfma_f32_16x16x32_bf16 v[56:59], v[8:11], v[180:183], v[56:59]
ds_read_b64_tr_b16 v[8:9], v0 offset:17568
ds_read_b64_tr_b16 v[10:11], v0 offset:18080
s_waitcnt lgkmcnt(4)
v_mfma_f32_16x16x32_bf16 v[52:55], v[12:15], v[176:179], v[52:55]
v_mfma_f32_16x16x32_bf16 v[60:63], v[12:15], v[180:183], v[60:63]
ds_read_b64_tr_b16 v[12:13], v0 offset:17600
ds_read_b64_tr_b16 v[14:15], v0 offset:18112
s_waitcnt lgkmcnt(4)
v_mfma_f32_16x16x32_bf16 v[208:211], v[4:7], v[176:179], v[208:211]
v_mfma_f32_16x16x32_bf16 v[216:219], v[4:7], v[180:183], v[216:219]
ds_read_b64_tr_b16 v[4:5], v0 offset:17632
ds_read_b64_tr_b16 v[6:7], v0 offset:18144
s_waitcnt lgkmcnt(4)
v_mfma_f32_16x16x32_bf16 v[212:215], v[8:11], v[176:179], v[212:215]
v_mfma_f32_16x16x32_bf16 v[220:223], v[8:11], v[180:183], v[220:223]
ds_read_b64_tr_b16 v[8:9], v0 offset:17664
ds_read_b64_tr_b16 v[10:11], v0 offset:18176
s_waitcnt lgkmcnt(4)
v_mfma_f32_16x16x32_bf16 v[224:227], v[12:15], v[176:179], v[224:227]
v_mfma_f32_16x16x32_bf16 v[232:235], v[12:15], v[180:183], v[232:235]
ds_read_b64_tr_b16 v[12:13], v0 offset:17696
ds_read_b64_tr_b16 v[14:15], v0 offset:18208
s_waitcnt lgkmcnt(4)
v_mfma_f32_16x16x32_bf16 v[228:231], v[4:7], v[176:179], v[228:231]
v_mfma_f32_16x16x32_bf16 v[236:239], v[4:7], v[180:183], v[236:239]
ds_read_b64_tr_b16 v[4:5], v0 offset:26208
ds_read_b64_tr_b16 v[6:7], v0 offset:26720
s_waitcnt lgkmcnt(4)
v_mfma_f32_16x16x32_bf16 v[240:243], v[8:11], v[176:179], v[240:243]
v_mfma_f32_16x16x32_bf16 v[248:251], v[8:11], v[180:183], v[248:251]
ds_read_b64_tr_b16 v[8:9], v0 offset:26240
ds_read_b64_tr_b16 v[10:11], v0 offset:26752
s_waitcnt lgkmcnt(4)
v_mfma_f32_16x16x32_bf16 v[244:247], v[12:15], v[176:179], v[244:247]
v_mfma_f32_16x16x32_bf16 v[252:255], v[12:15], v[180:183], v[252:255]
ds_read_b64_tr_b16 v[12:13], v0 offset:26272
ds_read_b64_tr_b16 v[14:15], v0 offset:26784
s_barrier
s_waitcnt lgkmcnt(4)
v_mfma_f32_16x16x32_bf16 v[48:51], v[4:7], v[184:187], v[48:51]
v_mfma_f32_16x16x32_bf16 v[56:59], v[4:7], v[188:191], v[56:59]
ds_read_b64_tr_b16 v[4:5], v0 offset:26304
ds_read_b64_tr_b16 v[6:7], v0 offset:26816
s_waitcnt lgkmcnt(4)
v_mfma_f32_16x16x32_bf16 v[52:55], v[8:11], v[184:187], v[52:55]
v_mfma_f32_16x16x32_bf16 v[60:63], v[8:11], v[188:191], v[60:63]
ds_read_b64_tr_b16 v[8:9], v0 offset:26336
ds_read_b64_tr_b16 v[10:11], v0 offset:26848
s_waitcnt lgkmcnt(4)
v_mfma_f32_16x16x32_bf16 v[208:211], v[12:15], v[184:187], v[208:211]
v_mfma_f32_16x16x32_bf16 v[216:219], v[12:15], v[188:191], v[216:219]
ds_read_b64_tr_b16 v[12:13], v0 offset:26368
ds_read_b64_tr_b16 v[14:15], v0 offset:26880
s_waitcnt lgkmcnt(4)
v_mfma_f32_16x16x32_bf16 v[212:215], v[4:7], v[184:187], v[212:215]
v_mfma_f32_16x16x32_bf16 v[220:223], v[4:7], v[188:191], v[220:223]
ds_read_b64_tr_b16 v[4:5], v0 offset:26400
ds_read_b64_tr_b16 v[6:7], v0 offset:26912
s_waitcnt lgkmcnt(4)
v_mfma_f32_16x16x32_bf16 v[224:227], v[8:11], v[184:187], v[224:227]
v_mfma_f32_16x16x32_bf16 v[232:235], v[8:11], v[188:191], v[232:235]
ds_read_b64_tr_b16 v[8:9], v0 offset:26432
ds_read_b64_tr_b16 v[10:11], v0 offset:26944
s_waitcnt lgkmcnt(4)
v_mfma_f32_16x16x32_bf16 v[228:231], v[12:15], v[184:187], v[228:231]
v_mfma_f32_16x16x32_bf16 v[236:239], v[12:15], v[188:191], v[236:239]
ds_read_b64_tr_b16 v[12:13], v0 offset:34944
ds_read_b64_tr_b16 v[14:15], v0 offset:35456
s_waitcnt lgkmcnt(4)
v_mfma_f32_16x16x32_bf16 v[240:243], v[4:7], v[184:187], v[240:243]
v_mfma_f32_16x16x32_bf16 v[248:251], v[4:7], v[188:191], v[248:251]
ds_read_b64_tr_b16 v[4:5], v0 offset:34976
ds_read_b64_tr_b16 v[6:7], v0 offset:35488
s_waitcnt lgkmcnt(4)
v_mfma_f32_16x16x32_bf16 v[244:247], v[8:11], v[184:187], v[244:247]
v_mfma_f32_16x16x32_bf16 v[252:255], v[8:11], v[188:191], v[252:255]
ds_read_b64_tr_b16 v[8:9], v0 offset:35008
ds_read_b64_tr_b16 v[10:11], v0 offset:35520
s_waitcnt lgkmcnt(4)
v_mfma_f32_16x16x32_bf16 v[48:51], v[12:15], v[192:195], v[48:51]
v_mfma_f32_16x16x32_bf16 v[56:59], v[12:15], v[196:199], v[56:59]
ds_read_b64_tr_b16 v[12:13], v0 offset:35040
ds_read_b64_tr_b16 v[14:15], v0 offset:35552
s_waitcnt lgkmcnt(4)
v_mfma_f32_16x16x32_bf16 v[52:55], v[4:7], v[192:195], v[52:55]
v_mfma_f32_16x16x32_bf16 v[60:63], v[4:7], v[196:199], v[60:63]
ds_read_b64_tr_b16 v[4:5], v0 offset:35072
ds_read_b64_tr_b16 v[6:7], v0 offset:35584
s_waitcnt lgkmcnt(4)
v_mfma_f32_16x16x32_bf16 v[208:211], v[8:11], v[192:195], v[208:211]
v_mfma_f32_16x16x32_bf16 v[216:219], v[8:11], v[196:199], v[216:219]
ds_read_b64_tr_b16 v[8:9], v0 offset:35104
ds_read_b64_tr_b16 v[10:11], v0 offset:35616
s_waitcnt lgkmcnt(4)
v_mfma_f32_16x16x32_bf16 v[212:215], v[12:15], v[192:195], v[212:215]
v_mfma_f32_16x16x32_bf16 v[220:223], v[12:15], v[196:199], v[220:223]
ds_read_b64_tr_b16 v[12:13], v0 offset:35136
ds_read_b64_tr_b16 v[14:15], v0 offset:35648
s_waitcnt lgkmcnt(4)
v_mfma_f32_16x16x32_bf16 v[224:227], v[4:7], v[192:195], v[224:227]
v_mfma_f32_16x16x32_bf16 v[232:235], v[4:7], v[196:199], v[232:235]
ds_read_b64_tr_b16 v[4:5], v0 offset:35168
ds_read_b64_tr_b16 v[6:7], v0 offset:35680
s_waitcnt lgkmcnt(4)
v_mfma_f32_16x16x32_bf16 v[228:231], v[8:11], v[192:195], v[228:231]
v_mfma_f32_16x16x32_bf16 v[236:239], v[8:11], v[196:199], v[236:239]
ds_read_b64_tr_b16 v[8:9], v0 offset:52416
ds_read_b64_tr_b16 v[10:11], v0 offset:52928
s_waitcnt lgkmcnt(4)
v_mfma_f32_16x16x32_bf16 v[240:243], v[12:15], v[192:195], v[240:243]
v_mfma_f32_16x16x32_bf16 v[248:251], v[12:15], v[196:199], v[248:251]
ds_read_b64_tr_b16 v[12:13], v0 offset:52448
ds_read_b64_tr_b16 v[14:15], v0 offset:52960
s_waitcnt lgkmcnt(4)
v_mfma_f32_16x16x32_bf16 v[244:247], v[4:7], v[192:195], v[244:247]
v_mfma_f32_16x16x32_bf16 v[252:255], v[4:7], v[196:199], v[252:255]
ds_read_b64_tr_b16 v[4:5], v0 offset:52480
ds_read_b64_tr_b16 v[6:7], v0 offset:52992
s_waitcnt lgkmcnt(4)
v_mfma_f32_16x16x32_bf16 v[48:51], v[8:11], v[200:203], v[48:51]
v_mfma_f32_16x16x32_bf16 v[56:59], v[8:11], v[204:207], v[56:59]
ds_read_b64_tr_b16 v[8:9], v0 offset:52512
ds_read_b64_tr_b16 v[10:11], v0 offset:53024
s_waitcnt lgkmcnt(4)
v_mfma_f32_16x16x32_bf16 v[52:55], v[12:15], v[200:203], v[52:55]
v_mfma_f32_16x16x32_bf16 v[60:63], v[12:15], v[204:207], v[60:63]
ds_read_b64_tr_b16 v[12:13], v0 offset:52544
ds_read_b64_tr_b16 v[14:15], v0 offset:53056
s_waitcnt lgkmcnt(4)
v_mfma_f32_16x16x32_bf16 v[208:211], v[4:7], v[200:203], v[208:211]
v_mfma_f32_16x16x32_bf16 v[216:219], v[4:7], v[204:207], v[216:219]
ds_read_b64_tr_b16 v[4:5], v0 offset:52576
ds_read_b64_tr_b16 v[6:7], v0 offset:53088
s_waitcnt lgkmcnt(4)
v_mfma_f32_16x16x32_bf16 v[212:215], v[8:11], v[200:203], v[212:215]
v_mfma_f32_16x16x32_bf16 v[220:223], v[8:11], v[204:207], v[220:223]
ds_read_b64_tr_b16 v[8:9], v0 offset:52608
ds_read_b64_tr_b16 v[10:11], v0 offset:53120
v_cvt_pk_bf16_f32 v16, v48, v49
v_cvt_pk_bf16_f32 v17, v50, v51
v_cvt_pk_bf16_f32 v18, v52, v53
v_cvt_pk_bf16_f32 v19, v54, v55
v_cvt_pk_bf16_f32 v20, v56, v57
v_cvt_pk_bf16_f32 v21, v58, v59
v_cvt_pk_bf16_f32 v22, v60, v61
v_cvt_pk_bf16_f32 v23, v62, v63
s_waitcnt lgkmcnt(4)
v_mfma_f32_16x16x32_bf16 v[224:227], v[12:15], v[200:203], v[224:227]
v_mfma_f32_16x16x32_bf16 v[232:235], v[12:15], v[204:207], v[232:235]
ds_read_b64_tr_b16 v[12:13], v0 offset:52640
ds_read_b64_tr_b16 v[14:15], v0 offset:53152
s_waitcnt lgkmcnt(4)
v_mfma_f32_16x16x32_bf16 v[228:231], v[4:7], v[200:203], v[228:231]
v_mfma_f32_16x16x32_bf16 v[236:239], v[4:7], v[204:207], v[236:239]
ds_read_b64_tr_b16 v[4:5], v0 offset:0
ds_read_b64_tr_b16 v[6:7], v0 offset:512
v_cvt_pk_bf16_f32 v24, v208, v209
v_cvt_pk_bf16_f32 v25, v210, v211
v_cvt_pk_bf16_f32 v26, v212, v213
v_cvt_pk_bf16_f32 v27, v214, v215
v_cvt_pk_bf16_f32 v28, v216, v217
v_cvt_pk_bf16_f32 v29, v218, v219
v_cvt_pk_bf16_f32 v30, v220, v221
v_cvt_pk_bf16_f32 v31, v222, v223
s_waitcnt lgkmcnt(4)
v_mfma_f32_16x16x32_bf16 v[240:243], v[8:11], v[200:203], v[240:243]
v_mfma_f32_16x16x32_bf16 v[248:251], v[8:11], v[204:207], v[248:251]
ds_read_b64_tr_b16 v[8:9], v0 offset:32
ds_read_b64_tr_b16 v[10:11], v0 offset:544
s_waitcnt lgkmcnt(4)
v_mfma_f32_16x16x32_bf16 v[244:247], v[12:15], v[200:203], v[244:247]
v_mfma_f32_16x16x32_bf16 v[252:255], v[12:15], v[204:207], v[252:255]
ds_read_b64_tr_b16 v[12:13], v0 offset:64
ds_read_b64_tr_b16 v[14:15], v0 offset:576
v_cvt_pk_bf16_f32 v32, v224, v225
v_cvt_pk_bf16_f32 v33, v226, v227
v_cvt_pk_bf16_f32 v34, v228, v229
v_cvt_pk_bf16_f32 v35, v230, v231
v_cvt_pk_bf16_f32 v36, v232, v233
v_cvt_pk_bf16_f32 v37, v234, v235
v_cvt_pk_bf16_f32 v38, v236, v237
v_cvt_pk_bf16_f32 v39, v238, v239
s_barrier
s_waitcnt lgkmcnt(4)
v_mfma_f32_16x16x32_bf16 v[48:51], v[4:7], v[64:67], 0
v_mfma_f32_16x16x32_bf16 v[56:59], v[4:7], v[68:71], 0
ds_read_b64_tr_b16 v[4:5], v0 offset:96
ds_read_b64_tr_b16 v[6:7], v0 offset:608
s_waitcnt lgkmcnt(4)
v_mfma_f32_16x16x32_bf16 v[52:55], v[8:11], v[64:67], 0
v_mfma_f32_16x16x32_bf16 v[60:63], v[8:11], v[68:71], 0
ds_read_b64_tr_b16 v[8:9], v0 offset:128
ds_read_b64_tr_b16 v[10:11], v0 offset:640
v_cvt_pk_bf16_f32 v40, v240, v241
v_cvt_pk_bf16_f32 v41, v242, v243
v_cvt_pk_bf16_f32 v42, v244, v245
v_cvt_pk_bf16_f32 v43, v246, v247
v_cvt_pk_bf16_f32 v44, v248, v249
v_cvt_pk_bf16_f32 v45, v250, v251
v_cvt_pk_bf16_f32 v46, v252, v253
v_cvt_pk_bf16_f32 v47, v254, v255
s_waitcnt lgkmcnt(4)
v_mfma_f32_16x16x32_bf16 v[208:211], v[12:15], v[64:67], 0
v_mfma_f32_16x16x32_bf16 v[216:219], v[12:15], v[68:71], 0
ds_read_b64_tr_b16 v[12:13], v0 offset:160
ds_read_b64_tr_b16 v[14:15], v0 offset:672
s_waitcnt lgkmcnt(4)
v_mfma_f32_16x16x32_bf16 v[212:215], v[4:7], v[64:67], 0
v_mfma_f32_16x16x32_bf16 v[220:223], v[4:7], v[68:71], 0
ds_read_b64_tr_b16 v[4:5], v0 offset:192
ds_read_b64_tr_b16 v[6:7], v0 offset:704
s_waitcnt lgkmcnt(4)
v_mfma_f32_16x16x32_bf16 v[224:227], v[8:11], v[64:67], 0
v_mfma_f32_16x16x32_bf16 v[232:235], v[8:11], v[68:71], 0
ds_read_b64_tr_b16 v[8:9], v0 offset:224
ds_read_b64_tr_b16 v[10:11], v0 offset:736
s_waitcnt lgkmcnt(4)
v_mfma_f32_16x16x32_bf16 v[228:231], v[12:15], v[64:67], 0
v_mfma_f32_16x16x32_bf16 v[236:239], v[12:15], v[68:71], 0
ds_read_b64_tr_b16 v[12:13], v0 offset:43680
ds_read_b64_tr_b16 v[14:15], v0 offset:44192
s_waitcnt lgkmcnt(4)
v_mfma_f32_16x16x32_bf16 v[240:243], v[4:7], v[64:67], 0
v_mfma_f32_16x16x32_bf16 v[248:251], v[4:7], v[68:71], 0
ds_read_b64_tr_b16 v[4:5], v0 offset:43712
ds_read_b64_tr_b16 v[6:7], v0 offset:44224
s_waitcnt lgkmcnt(4)
v_mfma_f32_16x16x32_bf16 v[244:247], v[8:11], v[64:67], 0
v_mfma_f32_16x16x32_bf16 v[252:255], v[8:11], v[68:71], 0
ds_read_b64_tr_b16 v[8:9], v0 offset:43744
ds_read_b64_tr_b16 v[10:11], v0 offset:44256
s_waitcnt lgkmcnt(4)
v_mfma_f32_16x16x32_bf16 v[48:51], v[12:15], v[72:75], v[48:51]
v_mfma_f32_16x16x32_bf16 v[56:59], v[12:15], v[76:79], v[56:59]
ds_read_b64_tr_b16 v[12:13], v0 offset:43776
ds_read_b64_tr_b16 v[14:15], v0 offset:44288
s_waitcnt lgkmcnt(4)
v_mfma_f32_16x16x32_bf16 v[52:55], v[4:7], v[72:75], v[52:55]
v_mfma_f32_16x16x32_bf16 v[60:63], v[4:7], v[76:79], v[60:63]
ds_read_b64_tr_b16 v[4:5], v0 offset:43808
ds_read_b64_tr_b16 v[6:7], v0 offset:44320
s_waitcnt lgkmcnt(4)
v_mfma_f32_16x16x32_bf16 v[208:211], v[8:11], v[72:75], v[208:211]
v_mfma_f32_16x16x32_bf16 v[216:219], v[8:11], v[76:79], v[216:219]
ds_read_b64_tr_b16 v[8:9], v0 offset:43840
ds_read_b64_tr_b16 v[10:11], v0 offset:44352
s_waitcnt lgkmcnt(4)
v_mfma_f32_16x16x32_bf16 v[212:215], v[12:15], v[72:75], v[212:215]
v_mfma_f32_16x16x32_bf16 v[220:223], v[12:15], v[76:79], v[220:223]
ds_read_b64_tr_b16 v[12:13], v0 offset:43872
ds_read_b64_tr_b16 v[14:15], v0 offset:44384
s_waitcnt lgkmcnt(4)
v_mfma_f32_16x16x32_bf16 v[224:227], v[4:7], v[72:75], v[224:227]
v_mfma_f32_16x16x32_bf16 v[232:235], v[4:7], v[76:79], v[232:235]
ds_read_b64_tr_b16 v[4:5], v0 offset:43904
ds_read_b64_tr_b16 v[6:7], v0 offset:44416
s_waitcnt lgkmcnt(4)
v_mfma_f32_16x16x32_bf16 v[228:231], v[8:11], v[72:75], v[228:231]
v_mfma_f32_16x16x32_bf16 v[236:239], v[8:11], v[76:79], v[236:239]
ds_read_b64_tr_b16 v[8:9], v0 offset:8736
ds_read_b64_tr_b16 v[10:11], v0 offset:9248
s_waitcnt lgkmcnt(4)
v_mfma_f32_16x16x32_bf16 v[240:243], v[12:15], v[72:75], v[240:243]
v_mfma_f32_16x16x32_bf16 v[248:251], v[12:15], v[76:79], v[248:251]
ds_read_b64_tr_b16 v[12:13], v0 offset:8768
ds_read_b64_tr_b16 v[14:15], v0 offset:9280
s_waitcnt lgkmcnt(4)
v_mfma_f32_16x16x32_bf16 v[244:247], v[4:7], v[72:75], v[244:247]
v_mfma_f32_16x16x32_bf16 v[252:255], v[4:7], v[76:79], v[252:255]
ds_read_b64_tr_b16 v[4:5], v0 offset:8800
ds_read_b64_tr_b16 v[6:7], v0 offset:9312
s_waitcnt lgkmcnt(4)
v_mfma_f32_16x16x32_bf16 v[48:51], v[8:11], v[80:83], v[48:51]
v_mfma_f32_16x16x32_bf16 v[56:59], v[8:11], v[84:87], v[56:59]
ds_read_b64_tr_b16 v[8:9], v0 offset:8832
ds_read_b64_tr_b16 v[10:11], v0 offset:9344
s_waitcnt lgkmcnt(4)
v_mfma_f32_16x16x32_bf16 v[52:55], v[12:15], v[80:83], v[52:55]
v_mfma_f32_16x16x32_bf16 v[60:63], v[12:15], v[84:87], v[60:63]
ds_read_b64_tr_b16 v[12:13], v0 offset:8864
ds_read_b64_tr_b16 v[14:15], v0 offset:9376
s_waitcnt lgkmcnt(4)
v_mfma_f32_16x16x32_bf16 v[208:211], v[4:7], v[80:83], v[208:211]
v_mfma_f32_16x16x32_bf16 v[216:219], v[4:7], v[84:87], v[216:219]
ds_read_b64_tr_b16 v[4:5], v0 offset:8896
ds_read_b64_tr_b16 v[6:7], v0 offset:9408
s_waitcnt lgkmcnt(4)
v_mfma_f32_16x16x32_bf16 v[212:215], v[8:11], v[80:83], v[212:215]
v_mfma_f32_16x16x32_bf16 v[220:223], v[8:11], v[84:87], v[220:223]
ds_read_b64_tr_b16 v[8:9], v0 offset:8928
ds_read_b64_tr_b16 v[10:11], v0 offset:9440
s_waitcnt lgkmcnt(4)
v_mfma_f32_16x16x32_bf16 v[224:227], v[12:15], v[80:83], v[224:227]
v_mfma_f32_16x16x32_bf16 v[232:235], v[12:15], v[84:87], v[232:235]
ds_read_b64_tr_b16 v[12:13], v0 offset:8960
ds_read_b64_tr_b16 v[14:15], v0 offset:9472
s_waitcnt lgkmcnt(4)
v_mfma_f32_16x16x32_bf16 v[228:231], v[4:7], v[80:83], v[228:231]
v_mfma_f32_16x16x32_bf16 v[236:239], v[4:7], v[84:87], v[236:239]
ds_read_b64_tr_b16 v[4:5], v0 offset:17472
ds_read_b64_tr_b16 v[6:7], v0 offset:17984
s_waitcnt lgkmcnt(4)
v_mfma_f32_16x16x32_bf16 v[240:243], v[8:11], v[80:83], v[240:243]
v_mfma_f32_16x16x32_bf16 v[248:251], v[8:11], v[84:87], v[248:251]
ds_read_b64_tr_b16 v[8:9], v0 offset:17504
ds_read_b64_tr_b16 v[10:11], v0 offset:18016
s_waitcnt lgkmcnt(4)
v_mfma_f32_16x16x32_bf16 v[244:247], v[12:15], v[80:83], v[244:247]
v_mfma_f32_16x16x32_bf16 v[252:255], v[12:15], v[84:87], v[252:255]
ds_read_b64_tr_b16 v[12:13], v0 offset:17536
ds_read_b64_tr_b16 v[14:15], v0 offset:18048
s_barrier
s_waitcnt lgkmcnt(4)
v_mfma_f32_16x16x32_bf16 v[48:51], v[4:7], v[88:91], v[48:51]
v_mfma_f32_16x16x32_bf16 v[56:59], v[4:7], v[92:95], v[56:59]
ds_read_b64_tr_b16 v[4:5], v0 offset:17568
ds_read_b64_tr_b16 v[6:7], v0 offset:18080
s_waitcnt lgkmcnt(4)
v_mfma_f32_16x16x32_bf16 v[52:55], v[8:11], v[88:91], v[52:55]
v_mfma_f32_16x16x32_bf16 v[60:63], v[8:11], v[92:95], v[60:63]
ds_read_b64_tr_b16 v[8:9], v0 offset:17600
ds_read_b64_tr_b16 v[10:11], v0 offset:18112
s_waitcnt lgkmcnt(4)
v_mfma_f32_16x16x32_bf16 v[208:211], v[12:15], v[88:91], v[208:211]
v_mfma_f32_16x16x32_bf16 v[216:219], v[12:15], v[92:95], v[216:219]
ds_read_b64_tr_b16 v[12:13], v0 offset:17632
ds_read_b64_tr_b16 v[14:15], v0 offset:18144
s_waitcnt lgkmcnt(4)
v_mfma_f32_16x16x32_bf16 v[212:215], v[4:7], v[88:91], v[212:215]
v_mfma_f32_16x16x32_bf16 v[220:223], v[4:7], v[92:95], v[220:223]
ds_read_b64_tr_b16 v[4:5], v0 offset:17664
ds_read_b64_tr_b16 v[6:7], v0 offset:18176
s_waitcnt lgkmcnt(4)
v_mfma_f32_16x16x32_bf16 v[224:227], v[8:11], v[88:91], v[224:227]
v_mfma_f32_16x16x32_bf16 v[232:235], v[8:11], v[92:95], v[232:235]
ds_read_b64_tr_b16 v[8:9], v0 offset:17696
ds_read_b64_tr_b16 v[10:11], v0 offset:18208
s_waitcnt lgkmcnt(4)
v_mfma_f32_16x16x32_bf16 v[228:231], v[12:15], v[88:91], v[228:231]
v_mfma_f32_16x16x32_bf16 v[236:239], v[12:15], v[92:95], v[236:239]
ds_read_b64_tr_b16 v[12:13], v0 offset:34944
ds_read_b64_tr_b16 v[14:15], v0 offset:35456
s_waitcnt lgkmcnt(4)
v_mfma_f32_16x16x32_bf16 v[240:243], v[4:7], v[88:91], v[240:243]
v_mfma_f32_16x16x32_bf16 v[248:251], v[4:7], v[92:95], v[248:251]
ds_read_b64_tr_b16 v[4:5], v0 offset:34976
ds_read_b64_tr_b16 v[6:7], v0 offset:35488
s_waitcnt lgkmcnt(4)
v_mfma_f32_16x16x32_bf16 v[244:247], v[8:11], v[88:91], v[244:247]
v_mfma_f32_16x16x32_bf16 v[252:255], v[8:11], v[92:95], v[252:255]
ds_read_b64_tr_b16 v[8:9], v0 offset:35008
ds_read_b64_tr_b16 v[10:11], v0 offset:35520
s_waitcnt lgkmcnt(4)
v_mfma_f32_16x16x32_bf16 v[48:51], v[12:15], v[96:99], v[48:51]
v_mfma_f32_16x16x32_bf16 v[56:59], v[12:15], v[100:103], v[56:59]
ds_read_b64_tr_b16 v[12:13], v0 offset:35040
ds_read_b64_tr_b16 v[14:15], v0 offset:35552
s_waitcnt lgkmcnt(4)
v_mfma_f32_16x16x32_bf16 v[52:55], v[4:7], v[96:99], v[52:55]
v_mfma_f32_16x16x32_bf16 v[60:63], v[4:7], v[100:103], v[60:63]
ds_read_b64_tr_b16 v[4:5], v0 offset:35072
ds_read_b64_tr_b16 v[6:7], v0 offset:35584
s_waitcnt lgkmcnt(4)
v_mfma_f32_16x16x32_bf16 v[208:211], v[8:11], v[96:99], v[208:211]
v_mfma_f32_16x16x32_bf16 v[216:219], v[8:11], v[100:103], v[216:219]
ds_read_b64_tr_b16 v[8:9], v0 offset:35104
ds_read_b64_tr_b16 v[10:11], v0 offset:35616
s_waitcnt lgkmcnt(4)
v_mfma_f32_16x16x32_bf16 v[212:215], v[12:15], v[96:99], v[212:215]
v_mfma_f32_16x16x32_bf16 v[220:223], v[12:15], v[100:103], v[220:223]
ds_read_b64_tr_b16 v[12:13], v0 offset:35136
ds_read_b64_tr_b16 v[14:15], v0 offset:35648
s_waitcnt lgkmcnt(4)
v_mfma_f32_16x16x32_bf16 v[224:227], v[4:7], v[96:99], v[224:227]
v_mfma_f32_16x16x32_bf16 v[232:235], v[4:7], v[100:103], v[232:235]
ds_read_b64_tr_b16 v[4:5], v0 offset:35168
ds_read_b64_tr_b16 v[6:7], v0 offset:35680
s_waitcnt lgkmcnt(4)
v_mfma_f32_16x16x32_bf16 v[228:231], v[8:11], v[96:99], v[228:231]
v_mfma_f32_16x16x32_bf16 v[236:239], v[8:11], v[100:103], v[236:239]
ds_read_b64_tr_b16 v[8:9], v0 offset:52416
ds_read_b64_tr_b16 v[10:11], v0 offset:52928
s_waitcnt lgkmcnt(4)
v_mfma_f32_16x16x32_bf16 v[240:243], v[12:15], v[96:99], v[240:243]
v_mfma_f32_16x16x32_bf16 v[248:251], v[12:15], v[100:103], v[248:251]
ds_read_b64_tr_b16 v[12:13], v0 offset:52448
ds_read_b64_tr_b16 v[14:15], v0 offset:52960
s_waitcnt lgkmcnt(4)
v_mfma_f32_16x16x32_bf16 v[244:247], v[4:7], v[96:99], v[244:247]
v_mfma_f32_16x16x32_bf16 v[252:255], v[4:7], v[100:103], v[252:255]
ds_read_b64_tr_b16 v[4:5], v0 offset:52480
ds_read_b64_tr_b16 v[6:7], v0 offset:52992
s_waitcnt lgkmcnt(4)
v_mfma_f32_16x16x32_bf16 v[48:51], v[8:11], v[104:107], v[48:51]
v_mfma_f32_16x16x32_bf16 v[56:59], v[8:11], v[108:111], v[56:59]
ds_read_b64_tr_b16 v[8:9], v0 offset:52512
ds_read_b64_tr_b16 v[10:11], v0 offset:53024
s_waitcnt lgkmcnt(4)
v_mfma_f32_16x16x32_bf16 v[52:55], v[12:15], v[104:107], v[52:55]
v_mfma_f32_16x16x32_bf16 v[60:63], v[12:15], v[108:111], v[60:63]
ds_read_b64_tr_b16 v[12:13], v0 offset:52544
ds_read_b64_tr_b16 v[14:15], v0 offset:53056
s_waitcnt lgkmcnt(4)
v_mfma_f32_16x16x32_bf16 v[208:211], v[4:7], v[104:107], v[208:211]
v_mfma_f32_16x16x32_bf16 v[216:219], v[4:7], v[108:111], v[216:219]
ds_read_b64_tr_b16 v[4:5], v0 offset:52576
ds_read_b64_tr_b16 v[6:7], v0 offset:53088
s_waitcnt lgkmcnt(4)
v_mfma_f32_16x16x32_bf16 v[212:215], v[8:11], v[104:107], v[212:215]
v_mfma_f32_16x16x32_bf16 v[220:223], v[8:11], v[108:111], v[220:223]
ds_read_b64_tr_b16 v[8:9], v0 offset:52608
ds_read_b64_tr_b16 v[10:11], v0 offset:53120
s_waitcnt lgkmcnt(4)
v_mfma_f32_16x16x32_bf16 v[224:227], v[12:15], v[104:107], v[224:227]
v_mfma_f32_16x16x32_bf16 v[232:235], v[12:15], v[108:111], v[232:235]
ds_read_b64_tr_b16 v[12:13], v0 offset:52640
ds_read_b64_tr_b16 v[14:15], v0 offset:53152
s_waitcnt lgkmcnt(4)
v_mfma_f32_16x16x32_bf16 v[228:231], v[4:7], v[104:107], v[228:231]
v_mfma_f32_16x16x32_bf16 v[236:239], v[4:7], v[108:111], v[236:239]
ds_read_b64_tr_b16 v[4:5], v0 offset:26208
ds_read_b64_tr_b16 v[6:7], v0 offset:26720
s_waitcnt lgkmcnt(4)
v_mfma_f32_16x16x32_bf16 v[240:243], v[8:11], v[104:107], v[240:243]
v_mfma_f32_16x16x32_bf16 v[248:251], v[8:11], v[108:111], v[248:251]
ds_read_b64_tr_b16 v[8:9], v0 offset:26240
ds_read_b64_tr_b16 v[10:11], v0 offset:26752
s_waitcnt lgkmcnt(4)
v_mfma_f32_16x16x32_bf16 v[244:247], v[12:15], v[104:107], v[244:247]
v_mfma_f32_16x16x32_bf16 v[252:255], v[12:15], v[108:111], v[252:255]
ds_read_b64_tr_b16 v[12:13], v0 offset:26272
ds_read_b64_tr_b16 v[14:15], v0 offset:26784
s_barrier
s_waitcnt lgkmcnt(4)
v_mfma_f32_16x16x32_bf16 v[48:51], v[4:7], v[112:115], v[48:51]
v_mfma_f32_16x16x32_bf16 v[56:59], v[4:7], v[116:119], v[56:59]
ds_read_b64_tr_b16 v[4:5], v0 offset:26304
ds_read_b64_tr_b16 v[6:7], v0 offset:26816
s_waitcnt lgkmcnt(4)
v_mfma_f32_16x16x32_bf16 v[52:55], v[8:11], v[112:115], v[52:55]
v_mfma_f32_16x16x32_bf16 v[60:63], v[8:11], v[116:119], v[60:63]
ds_read_b64_tr_b16 v[8:9], v0 offset:26336
ds_read_b64_tr_b16 v[10:11], v0 offset:26848
s_waitcnt lgkmcnt(4)
v_mfma_f32_16x16x32_bf16 v[208:211], v[12:15], v[112:115], v[208:211]
v_mfma_f32_16x16x32_bf16 v[216:219], v[12:15], v[116:119], v[216:219]
ds_read_b64_tr_b16 v[12:13], v0 offset:26368
ds_read_b64_tr_b16 v[14:15], v0 offset:26880
s_waitcnt lgkmcnt(4)
v_mfma_f32_16x16x32_bf16 v[212:215], v[4:7], v[112:115], v[212:215]
v_mfma_f32_16x16x32_bf16 v[220:223], v[4:7], v[116:119], v[220:223]
ds_read_b64_tr_b16 v[4:5], v0 offset:26400
ds_read_b64_tr_b16 v[6:7], v0 offset:26912
s_waitcnt lgkmcnt(4)
v_mfma_f32_16x16x32_bf16 v[224:227], v[8:11], v[112:115], v[224:227]
v_mfma_f32_16x16x32_bf16 v[232:235], v[8:11], v[116:119], v[232:235]
ds_read_b64_tr_b16 v[8:9], v0 offset:26432
ds_read_b64_tr_b16 v[10:11], v0 offset:26944
s_waitcnt lgkmcnt(4)
v_mfma_f32_16x16x32_bf16 v[228:231], v[12:15], v[112:115], v[228:231]
v_mfma_f32_16x16x32_bf16 v[236:239], v[12:15], v[116:119], v[236:239]
ds_read_b64_tr_b16 v[12:13], v0 offset:43680
ds_read_b64_tr_b16 v[14:15], v0 offset:44192
s_waitcnt lgkmcnt(4)
v_mfma_f32_16x16x32_bf16 v[240:243], v[4:7], v[112:115], v[240:243]
v_mfma_f32_16x16x32_bf16 v[248:251], v[4:7], v[116:119], v[248:251]
ds_read_b64_tr_b16 v[4:5], v0 offset:43712
ds_read_b64_tr_b16 v[6:7], v0 offset:44224
s_waitcnt lgkmcnt(4)
v_mfma_f32_16x16x32_bf16 v[244:247], v[8:11], v[112:115], v[244:247]
v_mfma_f32_16x16x32_bf16 v[252:255], v[8:11], v[116:119], v[252:255]
ds_read_b64_tr_b16 v[8:9], v0 offset:43744
ds_read_b64_tr_b16 v[10:11], v0 offset:44256
s_waitcnt lgkmcnt(4)
v_mfma_f32_16x16x32_bf16 v[48:51], v[12:15], v[120:123], v[48:51]
v_mfma_f32_16x16x32_bf16 v[56:59], v[12:15], v[124:127], v[56:59]
ds_read_b64_tr_b16 v[12:13], v0 offset:43776
ds_read_b64_tr_b16 v[14:15], v0 offset:44288
s_waitcnt lgkmcnt(4)
v_mfma_f32_16x16x32_bf16 v[52:55], v[4:7], v[120:123], v[52:55]
v_mfma_f32_16x16x32_bf16 v[60:63], v[4:7], v[124:127], v[60:63]
ds_read_b64_tr_b16 v[4:5], v0 offset:43808
ds_read_b64_tr_b16 v[6:7], v0 offset:44320
s_waitcnt lgkmcnt(4)
v_mfma_f32_16x16x32_bf16 v[208:211], v[8:11], v[120:123], v[208:211]
v_mfma_f32_16x16x32_bf16 v[216:219], v[8:11], v[124:127], v[216:219]
ds_read_b64_tr_b16 v[8:9], v0 offset:43840
ds_read_b64_tr_b16 v[10:11], v0 offset:44352
s_waitcnt lgkmcnt(4)
v_mfma_f32_16x16x32_bf16 v[212:215], v[12:15], v[120:123], v[212:215]
v_mfma_f32_16x16x32_bf16 v[220:223], v[12:15], v[124:127], v[220:223]
ds_read_b64_tr_b16 v[12:13], v0 offset:43872
ds_read_b64_tr_b16 v[14:15], v0 offset:44384
s_waitcnt lgkmcnt(4)
v_mfma_f32_16x16x32_bf16 v[224:227], v[4:7], v[120:123], v[224:227]
v_mfma_f32_16x16x32_bf16 v[232:235], v[4:7], v[124:127], v[232:235]
ds_read_b64_tr_b16 v[4:5], v0 offset:43904
ds_read_b64_tr_b16 v[6:7], v0 offset:44416
s_waitcnt lgkmcnt(4)
v_mfma_f32_16x16x32_bf16 v[228:231], v[8:11], v[120:123], v[228:231]
v_mfma_f32_16x16x32_bf16 v[236:239], v[8:11], v[124:127], v[236:239]
ds_read_b64_tr_b16 v[8:9], v0 offset:0
ds_read_b64_tr_b16 v[10:11], v0 offset:512
s_waitcnt lgkmcnt(4)
v_mfma_f32_16x16x32_bf16 v[240:243], v[12:15], v[120:123], v[240:243]
v_mfma_f32_16x16x32_bf16 v[248:251], v[12:15], v[124:127], v[248:251]
ds_read_b64_tr_b16 v[12:13], v0 offset:32
ds_read_b64_tr_b16 v[14:15], v0 offset:544
s_waitcnt lgkmcnt(4)
v_mfma_f32_16x16x32_bf16 v[244:247], v[4:7], v[120:123], v[244:247]
v_mfma_f32_16x16x32_bf16 v[252:255], v[4:7], v[124:127], v[252:255]
ds_read_b64_tr_b16 v[4:5], v0 offset:64
ds_read_b64_tr_b16 v[6:7], v0 offset:576
s_waitcnt lgkmcnt(4)
v_mfma_f32_16x16x32_bf16 v[48:51], v[8:11], v[128:131], v[48:51]
v_mfma_f32_16x16x32_bf16 v[56:59], v[8:11], v[132:135], v[56:59]
ds_read_b64_tr_b16 v[8:9], v0 offset:96
ds_read_b64_tr_b16 v[10:11], v0 offset:608
s_waitcnt lgkmcnt(4)
v_mfma_f32_16x16x32_bf16 v[52:55], v[12:15], v[128:131], v[52:55]
v_mfma_f32_16x16x32_bf16 v[60:63], v[12:15], v[132:135], v[60:63]
ds_read_b64_tr_b16 v[12:13], v0 offset:128
ds_read_b64_tr_b16 v[14:15], v0 offset:640
s_waitcnt lgkmcnt(4)
v_mfma_f32_16x16x32_bf16 v[208:211], v[4:7], v[128:131], v[208:211]
v_mfma_f32_16x16x32_bf16 v[216:219], v[4:7], v[132:135], v[216:219]
ds_read_b64_tr_b16 v[4:5], v0 offset:160
ds_read_b64_tr_b16 v[6:7], v0 offset:672
s_waitcnt lgkmcnt(4)
v_mfma_f32_16x16x32_bf16 v[212:215], v[8:11], v[128:131], v[212:215]
v_mfma_f32_16x16x32_bf16 v[220:223], v[8:11], v[132:135], v[220:223]
ds_read_b64_tr_b16 v[8:9], v0 offset:192
ds_read_b64_tr_b16 v[10:11], v0 offset:704
s_waitcnt lgkmcnt(4)
v_mfma_f32_16x16x32_bf16 v[224:227], v[12:15], v[128:131], v[224:227]
v_mfma_f32_16x16x32_bf16 v[232:235], v[12:15], v[132:135], v[232:235]
ds_read_b64_tr_b16 v[12:13], v0 offset:224
ds_read_b64_tr_b16 v[14:15], v0 offset:736
s_waitcnt lgkmcnt(4)
v_mfma_f32_16x16x32_bf16 v[228:231], v[4:7], v[128:131], v[228:231]
v_mfma_f32_16x16x32_bf16 v[236:239], v[4:7], v[132:135], v[236:239]
ds_read_b64_tr_b16 v[4:5], v0 offset:8736
ds_read_b64_tr_b16 v[6:7], v0 offset:9248
s_waitcnt lgkmcnt(4)
v_mfma_f32_16x16x32_bf16 v[240:243], v[8:11], v[128:131], v[240:243]
v_mfma_f32_16x16x32_bf16 v[248:251], v[8:11], v[132:135], v[248:251]
ds_read_b64_tr_b16 v[8:9], v0 offset:8768
ds_read_b64_tr_b16 v[10:11], v0 offset:9280
s_waitcnt lgkmcnt(4)
v_mfma_f32_16x16x32_bf16 v[244:247], v[12:15], v[128:131], v[244:247]
v_mfma_f32_16x16x32_bf16 v[252:255], v[12:15], v[132:135], v[252:255]
ds_read_b64_tr_b16 v[12:13], v0 offset:8800
ds_read_b64_tr_b16 v[14:15], v0 offset:9312
s_barrier
s_waitcnt lgkmcnt(4)
v_mfma_f32_16x16x32_bf16 v[48:51], v[4:7], v[136:139], v[48:51]
v_mfma_f32_16x16x32_bf16 v[56:59], v[4:7], v[140:143], v[56:59]
ds_read_b64_tr_b16 v[4:5], v0 offset:8832
ds_read_b64_tr_b16 v[6:7], v0 offset:9344
s_waitcnt lgkmcnt(4)
v_mfma_f32_16x16x32_bf16 v[52:55], v[8:11], v[136:139], v[52:55]
v_mfma_f32_16x16x32_bf16 v[60:63], v[8:11], v[140:143], v[60:63]
ds_read_b64_tr_b16 v[8:9], v0 offset:8864
ds_read_b64_tr_b16 v[10:11], v0 offset:9376
s_waitcnt lgkmcnt(4)
v_mfma_f32_16x16x32_bf16 v[208:211], v[12:15], v[136:139], v[208:211]
v_mfma_f32_16x16x32_bf16 v[216:219], v[12:15], v[140:143], v[216:219]
ds_read_b64_tr_b16 v[12:13], v0 offset:8896
ds_read_b64_tr_b16 v[14:15], v0 offset:9408
s_waitcnt lgkmcnt(4)
v_mfma_f32_16x16x32_bf16 v[212:215], v[4:7], v[136:139], v[212:215]
v_mfma_f32_16x16x32_bf16 v[220:223], v[4:7], v[140:143], v[220:223]
ds_read_b64_tr_b16 v[4:5], v0 offset:8928
ds_read_b64_tr_b16 v[6:7], v0 offset:9440
s_waitcnt lgkmcnt(4)
v_mfma_f32_16x16x32_bf16 v[224:227], v[8:11], v[136:139], v[224:227]
v_mfma_f32_16x16x32_bf16 v[232:235], v[8:11], v[140:143], v[232:235]
ds_read_b64_tr_b16 v[8:9], v0 offset:8960
ds_read_b64_tr_b16 v[10:11], v0 offset:9472
s_waitcnt lgkmcnt(4)
v_mfma_f32_16x16x32_bf16 v[228:231], v[12:15], v[136:139], v[228:231]
v_mfma_f32_16x16x32_bf16 v[236:239], v[12:15], v[140:143], v[236:239]
ds_read_b64_tr_b16 v[12:13], v0 offset:34944
ds_read_b64_tr_b16 v[14:15], v0 offset:35456
s_waitcnt lgkmcnt(4)
v_mfma_f32_16x16x32_bf16 v[240:243], v[4:7], v[136:139], v[240:243]
v_mfma_f32_16x16x32_bf16 v[248:251], v[4:7], v[140:143], v[248:251]
ds_read_b64_tr_b16 v[4:5], v0 offset:34976
ds_read_b64_tr_b16 v[6:7], v0 offset:35488
s_waitcnt lgkmcnt(4)
v_mfma_f32_16x16x32_bf16 v[244:247], v[8:11], v[136:139], v[244:247]
v_mfma_f32_16x16x32_bf16 v[252:255], v[8:11], v[140:143], v[252:255]
ds_read_b64_tr_b16 v[8:9], v0 offset:35008
ds_read_b64_tr_b16 v[10:11], v0 offset:35520
s_waitcnt lgkmcnt(4)
v_mfma_f32_16x16x32_bf16 v[48:51], v[12:15], v[144:147], v[48:51]
v_mfma_f32_16x16x32_bf16 v[56:59], v[12:15], v[148:151], v[56:59]
ds_read_b64_tr_b16 v[12:13], v0 offset:35040
ds_read_b64_tr_b16 v[14:15], v0 offset:35552
s_waitcnt lgkmcnt(4)
v_mfma_f32_16x16x32_bf16 v[52:55], v[4:7], v[144:147], v[52:55]
v_mfma_f32_16x16x32_bf16 v[60:63], v[4:7], v[148:151], v[60:63]
ds_read_b64_tr_b16 v[4:5], v0 offset:35072
ds_read_b64_tr_b16 v[6:7], v0 offset:35584
s_waitcnt lgkmcnt(4)
v_mfma_f32_16x16x32_bf16 v[208:211], v[8:11], v[144:147], v[208:211]
v_mfma_f32_16x16x32_bf16 v[216:219], v[8:11], v[148:151], v[216:219]
ds_read_b64_tr_b16 v[8:9], v0 offset:35104
ds_read_b64_tr_b16 v[10:11], v0 offset:35616
s_waitcnt lgkmcnt(4)
v_mfma_f32_16x16x32_bf16 v[212:215], v[12:15], v[144:147], v[212:215]
v_mfma_f32_16x16x32_bf16 v[220:223], v[12:15], v[148:151], v[220:223]
ds_read_b64_tr_b16 v[12:13], v0 offset:35136
ds_read_b64_tr_b16 v[14:15], v0 offset:35648
s_waitcnt lgkmcnt(4)
v_mfma_f32_16x16x32_bf16 v[224:227], v[4:7], v[144:147], v[224:227]
v_mfma_f32_16x16x32_bf16 v[232:235], v[4:7], v[148:151], v[232:235]
ds_read_b64_tr_b16 v[4:5], v0 offset:35168
ds_read_b64_tr_b16 v[6:7], v0 offset:35680
s_waitcnt lgkmcnt(4)
v_mfma_f32_16x16x32_bf16 v[228:231], v[8:11], v[144:147], v[228:231]
v_mfma_f32_16x16x32_bf16 v[236:239], v[8:11], v[148:151], v[236:239]
ds_read_b64_tr_b16 v[8:9], v0 offset:52416
ds_read_b64_tr_b16 v[10:11], v0 offset:52928
s_waitcnt lgkmcnt(4)
v_mfma_f32_16x16x32_bf16 v[240:243], v[12:15], v[144:147], v[240:243]
v_mfma_f32_16x16x32_bf16 v[248:251], v[12:15], v[148:151], v[248:251]
ds_read_b64_tr_b16 v[12:13], v0 offset:52448
ds_read_b64_tr_b16 v[14:15], v0 offset:52960
s_waitcnt lgkmcnt(4)
v_mfma_f32_16x16x32_bf16 v[244:247], v[4:7], v[144:147], v[244:247]
v_mfma_f32_16x16x32_bf16 v[252:255], v[4:7], v[148:151], v[252:255]
ds_read_b64_tr_b16 v[4:5], v0 offset:52480
ds_read_b64_tr_b16 v[6:7], v0 offset:52992
s_waitcnt lgkmcnt(4)
v_mfma_f32_16x16x32_bf16 v[48:51], v[8:11], v[152:155], v[48:51]
v_mfma_f32_16x16x32_bf16 v[56:59], v[8:11], v[156:159], v[56:59]
ds_read_b64_tr_b16 v[8:9], v0 offset:52512
ds_read_b64_tr_b16 v[10:11], v0 offset:53024
s_waitcnt lgkmcnt(4)
v_mfma_f32_16x16x32_bf16 v[52:55], v[12:15], v[152:155], v[52:55]
v_mfma_f32_16x16x32_bf16 v[60:63], v[12:15], v[156:159], v[60:63]
ds_read_b64_tr_b16 v[12:13], v0 offset:52544
ds_read_b64_tr_b16 v[14:15], v0 offset:53056
s_waitcnt lgkmcnt(4)
v_mfma_f32_16x16x32_bf16 v[208:211], v[4:7], v[152:155], v[208:211]
v_mfma_f32_16x16x32_bf16 v[216:219], v[4:7], v[156:159], v[216:219]
ds_read_b64_tr_b16 v[4:5], v0 offset:52576
ds_read_b64_tr_b16 v[6:7], v0 offset:53088
s_waitcnt lgkmcnt(4)
v_mfma_f32_16x16x32_bf16 v[212:215], v[8:11], v[152:155], v[212:215]
v_mfma_f32_16x16x32_bf16 v[220:223], v[8:11], v[156:159], v[220:223]
ds_read_b64_tr_b16 v[8:9], v0 offset:52608
ds_read_b64_tr_b16 v[10:11], v0 offset:53120
s_waitcnt lgkmcnt(4)
v_mfma_f32_16x16x32_bf16 v[224:227], v[12:15], v[152:155], v[224:227]
v_mfma_f32_16x16x32_bf16 v[232:235], v[12:15], v[156:159], v[232:235]
ds_read_b64_tr_b16 v[12:13], v0 offset:52640
ds_read_b64_tr_b16 v[14:15], v0 offset:53152
s_waitcnt lgkmcnt(4)
v_mfma_f32_16x16x32_bf16 v[228:231], v[4:7], v[152:155], v[228:231]
v_mfma_f32_16x16x32_bf16 v[236:239], v[4:7], v[156:159], v[236:239]
ds_read_b64_tr_b16 v[4:5], v0 offset:17472
ds_read_b64_tr_b16 v[6:7], v0 offset:17984
s_waitcnt lgkmcnt(4)
v_mfma_f32_16x16x32_bf16 v[240:243], v[8:11], v[152:155], v[240:243]
v_mfma_f32_16x16x32_bf16 v[248:251], v[8:11], v[156:159], v[248:251]
ds_read_b64_tr_b16 v[8:9], v0 offset:17504
ds_read_b64_tr_b16 v[10:11], v0 offset:18016
s_waitcnt lgkmcnt(4)
v_mfma_f32_16x16x32_bf16 v[244:247], v[12:15], v[152:155], v[244:247]
v_mfma_f32_16x16x32_bf16 v[252:255], v[12:15], v[156:159], v[252:255]
ds_read_b64_tr_b16 v[12:13], v0 offset:17536
ds_read_b64_tr_b16 v[14:15], v0 offset:18048
s_barrier
s_waitcnt lgkmcnt(4)
v_mfma_f32_16x16x32_bf16 v[48:51], v[4:7], v[160:163], v[48:51]
v_mfma_f32_16x16x32_bf16 v[56:59], v[4:7], v[164:167], v[56:59]
ds_read_b64_tr_b16 v[4:5], v0 offset:17568
ds_read_b64_tr_b16 v[6:7], v0 offset:18080
s_waitcnt lgkmcnt(4)
v_mfma_f32_16x16x32_bf16 v[52:55], v[8:11], v[160:163], v[52:55]
v_mfma_f32_16x16x32_bf16 v[60:63], v[8:11], v[164:167], v[60:63]
ds_read_b64_tr_b16 v[8:9], v0 offset:17600
ds_read_b64_tr_b16 v[10:11], v0 offset:18112
s_waitcnt lgkmcnt(4)
v_mfma_f32_16x16x32_bf16 v[208:211], v[12:15], v[160:163], v[208:211]
v_mfma_f32_16x16x32_bf16 v[216:219], v[12:15], v[164:167], v[216:219]
ds_read_b64_tr_b16 v[12:13], v0 offset:17632
ds_read_b64_tr_b16 v[14:15], v0 offset:18144
ds_write_b128 v1, v[16:19] offset:0
s_waitcnt lgkmcnt(5)
v_mfma_f32_16x16x32_bf16 v[212:215], v[4:7], v[160:163], v[212:215]
v_mfma_f32_16x16x32_bf16 v[220:223], v[4:7], v[164:167], v[220:223]
ds_read_b64_tr_b16 v[4:5], v0 offset:17664
ds_read_b64_tr_b16 v[6:7], v0 offset:18176
ds_write_b128 v1, v[32:35] offset:12288
s_waitcnt lgkmcnt(6)
v_mfma_f32_16x16x32_bf16 v[224:227], v[8:11], v[160:163], v[224:227]
v_mfma_f32_16x16x32_bf16 v[232:235], v[8:11], v[164:167], v[232:235]
ds_read_b64_tr_b16 v[8:9], v0 offset:17696
ds_read_b64_tr_b16 v[10:11], v0 offset:18208
s_waitcnt lgkmcnt(6)
v_mfma_f32_16x16x32_bf16 v[228:231], v[12:15], v[160:163], v[228:231]
v_mfma_f32_16x16x32_bf16 v[236:239], v[12:15], v[164:167], v[236:239]
ds_read_b64_tr_b16 v[12:13], v0 offset:43680
ds_read_b64_tr_b16 v[14:15], v0 offset:44192
ds_write_b128 v1, v[20:23] offset:1024
s_waitcnt lgkmcnt(6)
v_mfma_f32_16x16x32_bf16 v[240:243], v[4:7], v[160:163], v[240:243]
v_mfma_f32_16x16x32_bf16 v[248:251], v[4:7], v[164:167], v[248:251]
ds_read_b64_tr_b16 v[4:5], v0 offset:43712
ds_read_b64_tr_b16 v[6:7], v0 offset:44224
ds_write_b128 v1, v[36:39] offset:13312
s_waitcnt lgkmcnt(6)
v_mfma_f32_16x16x32_bf16 v[244:247], v[8:11], v[160:163], v[244:247]
v_mfma_f32_16x16x32_bf16 v[252:255], v[8:11], v[164:167], v[252:255]
ds_read_b64_tr_b16 v[8:9], v0 offset:43744
ds_read_b64_tr_b16 v[10:11], v0 offset:44256
s_waitcnt lgkmcnt(6)
v_mfma_f32_16x16x32_bf16 v[48:51], v[12:15], v[168:171], v[48:51]
v_mfma_f32_16x16x32_bf16 v[56:59], v[12:15], v[172:175], v[56:59]
ds_read_b64_tr_b16 v[12:13], v0 offset:43776
ds_read_b64_tr_b16 v[14:15], v0 offset:44288
ds_write_b128 v1, v[24:27] offset:6144
s_waitcnt lgkmcnt(6)
v_mfma_f32_16x16x32_bf16 v[52:55], v[4:7], v[168:171], v[52:55]
v_mfma_f32_16x16x32_bf16 v[60:63], v[4:7], v[172:175], v[60:63]
ds_read_b64_tr_b16 v[4:5], v0 offset:43808
ds_read_b64_tr_b16 v[6:7], v0 offset:44320
ds_write_b128 v1, v[40:43] offset:18432
s_waitcnt lgkmcnt(6)
v_mfma_f32_16x16x32_bf16 v[208:211], v[8:11], v[168:171], v[208:211]
v_mfma_f32_16x16x32_bf16 v[216:219], v[8:11], v[172:175], v[216:219]
ds_read_b64_tr_b16 v[8:9], v0 offset:43840
ds_read_b64_tr_b16 v[10:11], v0 offset:44352
s_waitcnt lgkmcnt(6)
v_mfma_f32_16x16x32_bf16 v[212:215], v[12:15], v[168:171], v[212:215]
v_mfma_f32_16x16x32_bf16 v[220:223], v[12:15], v[172:175], v[220:223]
ds_read_b64_tr_b16 v[12:13], v0 offset:43872
ds_read_b64_tr_b16 v[14:15], v0 offset:44384
ds_write_b128 v1, v[28:31] offset:7168
s_waitcnt lgkmcnt(6)
v_mfma_f32_16x16x32_bf16 v[224:227], v[4:7], v[168:171], v[224:227]
v_mfma_f32_16x16x32_bf16 v[232:235], v[4:7], v[172:175], v[232:235]
ds_read_b64_tr_b16 v[4:5], v0 offset:43904
ds_read_b64_tr_b16 v[6:7], v0 offset:44416
ds_write_b128 v1, v[44:47] offset:19456
s_waitcnt lgkmcnt(6)
v_mfma_f32_16x16x32_bf16 v[228:231], v[8:11], v[168:171], v[228:231]
v_mfma_f32_16x16x32_bf16 v[236:239], v[8:11], v[172:175], v[236:239]
ds_read_b64_tr_b16 v[8:9], v0 offset:0
ds_read_b64_tr_b16 v[10:11], v0 offset:512
s_waitcnt lgkmcnt(6)
v_mfma_f32_16x16x32_bf16 v[240:243], v[12:15], v[168:171], v[240:243]
v_mfma_f32_16x16x32_bf16 v[248:251], v[12:15], v[172:175], v[248:251]
ds_read_b64_tr_b16 v[12:13], v0 offset:32
ds_read_b64_tr_b16 v[14:15], v0 offset:544
s_waitcnt lgkmcnt(5)
v_mfma_f32_16x16x32_bf16 v[244:247], v[4:7], v[168:171], v[244:247]
v_mfma_f32_16x16x32_bf16 v[252:255], v[4:7], v[172:175], v[252:255]
ds_read_b64_tr_b16 v[4:5], v0 offset:64
ds_read_b64_tr_b16 v[6:7], v0 offset:576
s_waitcnt lgkmcnt(4)
v_mfma_f32_16x16x32_bf16 v[48:51], v[8:11], v[176:179], v[48:51]
v_mfma_f32_16x16x32_bf16 v[56:59], v[8:11], v[180:183], v[56:59]
ds_read_b64_tr_b16 v[8:9], v0 offset:96
ds_read_b64_tr_b16 v[10:11], v0 offset:608
s_waitcnt lgkmcnt(4)
v_mfma_f32_16x16x32_bf16 v[52:55], v[12:15], v[176:179], v[52:55]
v_mfma_f32_16x16x32_bf16 v[60:63], v[12:15], v[180:183], v[60:63]
ds_read_b64_tr_b16 v[12:13], v0 offset:128
ds_read_b64_tr_b16 v[14:15], v0 offset:640
s_waitcnt lgkmcnt(4)
v_mfma_f32_16x16x32_bf16 v[208:211], v[4:7], v[176:179], v[208:211]
v_mfma_f32_16x16x32_bf16 v[216:219], v[4:7], v[180:183], v[216:219]
ds_read_b64_tr_b16 v[4:5], v0 offset:160
ds_read_b64_tr_b16 v[6:7], v0 offset:672
s_waitcnt lgkmcnt(4)
v_mfma_f32_16x16x32_bf16 v[212:215], v[8:11], v[176:179], v[212:215]
v_mfma_f32_16x16x32_bf16 v[220:223], v[8:11], v[180:183], v[220:223]
ds_read_b64_tr_b16 v[8:9], v0 offset:192
ds_read_b64_tr_b16 v[10:11], v0 offset:704
s_waitcnt lgkmcnt(4)
v_mfma_f32_16x16x32_bf16 v[224:227], v[12:15], v[176:179], v[224:227]
v_mfma_f32_16x16x32_bf16 v[232:235], v[12:15], v[180:183], v[232:235]
ds_read_b64_tr_b16 v[12:13], v0 offset:224
ds_read_b64_tr_b16 v[14:15], v0 offset:736
s_waitcnt lgkmcnt(4)
v_mfma_f32_16x16x32_bf16 v[228:231], v[4:7], v[176:179], v[228:231]
v_mfma_f32_16x16x32_bf16 v[236:239], v[4:7], v[180:183], v[236:239]
ds_read_b64_tr_b16 v[4:5], v0 offset:26208
ds_read_b64_tr_b16 v[6:7], v0 offset:26720
s_waitcnt lgkmcnt(4)
v_mfma_f32_16x16x32_bf16 v[240:243], v[8:11], v[176:179], v[240:243]
v_mfma_f32_16x16x32_bf16 v[248:251], v[8:11], v[180:183], v[248:251]
ds_read_b64_tr_b16 v[8:9], v0 offset:26240
ds_read_b64_tr_b16 v[10:11], v0 offset:26752
s_waitcnt lgkmcnt(4)
v_mfma_f32_16x16x32_bf16 v[244:247], v[12:15], v[176:179], v[244:247]
v_mfma_f32_16x16x32_bf16 v[252:255], v[12:15], v[180:183], v[252:255]
ds_read_b64_tr_b16 v[12:13], v0 offset:26272
ds_read_b64_tr_b16 v[14:15], v0 offset:26784
s_barrier
s_waitcnt lgkmcnt(4)
v_mfma_f32_16x16x32_bf16 v[48:51], v[4:7], v[184:187], v[48:51]
v_mfma_f32_16x16x32_bf16 v[56:59], v[4:7], v[188:191], v[56:59]
ds_read_b64_tr_b16 v[4:5], v0 offset:26304
ds_read_b64_tr_b16 v[6:7], v0 offset:26816
s_waitcnt lgkmcnt(4)
v_mfma_f32_16x16x32_bf16 v[52:55], v[8:11], v[184:187], v[52:55]
v_mfma_f32_16x16x32_bf16 v[60:63], v[8:11], v[188:191], v[60:63]
ds_read_b64_tr_b16 v[8:9], v0 offset:26336
ds_read_b64_tr_b16 v[10:11], v0 offset:26848
s_waitcnt lgkmcnt(4)
v_mfma_f32_16x16x32_bf16 v[208:211], v[12:15], v[184:187], v[208:211]
v_mfma_f32_16x16x32_bf16 v[216:219], v[12:15], v[188:191], v[216:219]
ds_read_b64_tr_b16 v[12:13], v0 offset:26368
ds_read_b64_tr_b16 v[14:15], v0 offset:26880
s_waitcnt lgkmcnt(4)
v_mfma_f32_16x16x32_bf16 v[212:215], v[4:7], v[184:187], v[212:215]
v_mfma_f32_16x16x32_bf16 v[220:223], v[4:7], v[188:191], v[220:223]
ds_read_b64_tr_b16 v[4:5], v0 offset:26400
ds_read_b64_tr_b16 v[6:7], v0 offset:26912
s_waitcnt lgkmcnt(4)
v_mfma_f32_16x16x32_bf16 v[224:227], v[8:11], v[184:187], v[224:227]
v_mfma_f32_16x16x32_bf16 v[232:235], v[8:11], v[188:191], v[232:235]
ds_read_b64_tr_b16 v[8:9], v0 offset:26432
ds_read_b64_tr_b16 v[10:11], v0 offset:26944
s_waitcnt lgkmcnt(4)
v_mfma_f32_16x16x32_bf16 v[228:231], v[12:15], v[184:187], v[228:231]
v_mfma_f32_16x16x32_bf16 v[236:239], v[12:15], v[188:191], v[236:239]
ds_read_b64_tr_b16 v[12:13], v0 offset:34944
ds_read_b64_tr_b16 v[14:15], v0 offset:35456
s_waitcnt lgkmcnt(4)
v_mfma_f32_16x16x32_bf16 v[240:243], v[4:7], v[184:187], v[240:243]
v_mfma_f32_16x16x32_bf16 v[248:251], v[4:7], v[188:191], v[248:251]
ds_read_b64_tr_b16 v[4:5], v0 offset:34976
ds_read_b64_tr_b16 v[6:7], v0 offset:35488
s_waitcnt lgkmcnt(4)
v_mfma_f32_16x16x32_bf16 v[244:247], v[8:11], v[184:187], v[244:247]
v_mfma_f32_16x16x32_bf16 v[252:255], v[8:11], v[188:191], v[252:255]
ds_read_b64_tr_b16 v[8:9], v0 offset:35008
ds_read_b64_tr_b16 v[10:11], v0 offset:35520
s_waitcnt lgkmcnt(4)
v_mfma_f32_16x16x32_bf16 v[48:51], v[12:15], v[192:195], v[48:51]
v_mfma_f32_16x16x32_bf16 v[56:59], v[12:15], v[196:199], v[56:59]
ds_read_b64_tr_b16 v[12:13], v0 offset:35040
ds_read_b64_tr_b16 v[14:15], v0 offset:35552
s_waitcnt lgkmcnt(4)
v_mfma_f32_16x16x32_bf16 v[52:55], v[4:7], v[192:195], v[52:55]
v_mfma_f32_16x16x32_bf16 v[60:63], v[4:7], v[196:199], v[60:63]
ds_read_b64_tr_b16 v[4:5], v0 offset:35072
ds_read_b64_tr_b16 v[6:7], v0 offset:35584
s_waitcnt lgkmcnt(4)
v_mfma_f32_16x16x32_bf16 v[208:211], v[8:11], v[192:195], v[208:211]
v_mfma_f32_16x16x32_bf16 v[216:219], v[8:11], v[196:199], v[216:219]
ds_read_b64_tr_b16 v[8:9], v0 offset:35104
ds_read_b64_tr_b16 v[10:11], v0 offset:35616
s_waitcnt lgkmcnt(4)
v_mfma_f32_16x16x32_bf16 v[212:215], v[12:15], v[192:195], v[212:215]
v_mfma_f32_16x16x32_bf16 v[220:223], v[12:15], v[196:199], v[220:223]
ds_read_b64_tr_b16 v[12:13], v0 offset:35136
ds_read_b64_tr_b16 v[14:15], v0 offset:35648
s_waitcnt lgkmcnt(4)
v_mfma_f32_16x16x32_bf16 v[224:227], v[4:7], v[192:195], v[224:227]
v_mfma_f32_16x16x32_bf16 v[232:235], v[4:7], v[196:199], v[232:235]
ds_read_b64_tr_b16 v[4:5], v0 offset:35168
ds_read_b64_tr_b16 v[6:7], v0 offset:35680
s_waitcnt lgkmcnt(4)
v_mfma_f32_16x16x32_bf16 v[228:231], v[8:11], v[192:195], v[228:231]
v_mfma_f32_16x16x32_bf16 v[236:239], v[8:11], v[196:199], v[236:239]
ds_read_b64_tr_b16 v[8:9], v0 offset:52416
ds_read_b64_tr_b16 v[10:11], v0 offset:52928
s_waitcnt lgkmcnt(4)
v_mfma_f32_16x16x32_bf16 v[240:243], v[12:15], v[192:195], v[240:243]
v_mfma_f32_16x16x32_bf16 v[248:251], v[12:15], v[196:199], v[248:251]
ds_read_b64_tr_b16 v[12:13], v0 offset:52448
ds_read_b64_tr_b16 v[14:15], v0 offset:52960
s_waitcnt lgkmcnt(4)
v_mfma_f32_16x16x32_bf16 v[244:247], v[4:7], v[192:195], v[244:247]
v_mfma_f32_16x16x32_bf16 v[252:255], v[4:7], v[196:199], v[252:255]
ds_read_b64_tr_b16 v[4:5], v0 offset:52480
ds_read_b64_tr_b16 v[6:7], v0 offset:52992
s_waitcnt lgkmcnt(4)
v_mfma_f32_16x16x32_bf16 v[48:51], v[8:11], v[200:203], v[48:51]
v_mfma_f32_16x16x32_bf16 v[56:59], v[8:11], v[204:207], v[56:59]
ds_read_b64_tr_b16 v[8:9], v0 offset:52512
ds_read_b64_tr_b16 v[10:11], v0 offset:53024
s_waitcnt lgkmcnt(4)
v_mfma_f32_16x16x32_bf16 v[52:55], v[12:15], v[200:203], v[52:55]
v_mfma_f32_16x16x32_bf16 v[60:63], v[12:15], v[204:207], v[60:63]
ds_read_b64_tr_b16 v[12:13], v0 offset:52544
ds_read_b64_tr_b16 v[14:15], v0 offset:53056
s_waitcnt lgkmcnt(4)
v_mfma_f32_16x16x32_bf16 v[208:211], v[4:7], v[200:203], v[208:211]
v_mfma_f32_16x16x32_bf16 v[216:219], v[4:7], v[204:207], v[216:219]
ds_read_b64_tr_b16 v[4:5], v0 offset:52576
ds_read_b64_tr_b16 v[6:7], v0 offset:53088
s_waitcnt lgkmcnt(4)
v_mfma_f32_16x16x32_bf16 v[212:215], v[8:11], v[200:203], v[212:215]
v_mfma_f32_16x16x32_bf16 v[220:223], v[8:11], v[204:207], v[220:223]
ds_read_b64_tr_b16 v[8:9], v0 offset:52608
ds_read_b64_tr_b16 v[10:11], v0 offset:53120
v_cvt_pk_bf16_f32 v16, v48, v49
v_cvt_pk_bf16_f32 v17, v50, v51
v_cvt_pk_bf16_f32 v18, v52, v53
v_cvt_pk_bf16_f32 v19, v54, v55
v_cvt_pk_bf16_f32 v20, v56, v57
v_cvt_pk_bf16_f32 v21, v58, v59
v_cvt_pk_bf16_f32 v22, v60, v61
v_cvt_pk_bf16_f32 v23, v62, v63
s_waitcnt lgkmcnt(4)
v_mfma_f32_16x16x32_bf16 v[224:227], v[12:15], v[200:203], v[224:227]
v_mfma_f32_16x16x32_bf16 v[232:235], v[12:15], v[204:207], v[232:235]
ds_read_b64_tr_b16 v[12:13], v0 offset:52640
ds_read_b64_tr_b16 v[14:15], v0 offset:53152
s_waitcnt lgkmcnt(4)
v_mfma_f32_16x16x32_bf16 v[228:231], v[4:7], v[200:203], v[228:231]
v_mfma_f32_16x16x32_bf16 v[236:239], v[4:7], v[204:207], v[236:239]
ds_read_b64_tr_b16 v[4:5], v0 offset:8736
ds_read_b64_tr_b16 v[6:7], v0 offset:9248
v_cvt_pk_bf16_f32 v24, v208, v209
v_cvt_pk_bf16_f32 v25, v210, v211
v_cvt_pk_bf16_f32 v26, v212, v213
v_cvt_pk_bf16_f32 v27, v214, v215
v_cvt_pk_bf16_f32 v28, v216, v217
v_cvt_pk_bf16_f32 v29, v218, v219
v_cvt_pk_bf16_f32 v30, v220, v221
v_cvt_pk_bf16_f32 v31, v222, v223
s_waitcnt lgkmcnt(4)
v_mfma_f32_16x16x32_bf16 v[240:243], v[8:11], v[200:203], v[240:243]
v_mfma_f32_16x16x32_bf16 v[248:251], v[8:11], v[204:207], v[248:251]
ds_read_b64_tr_b16 v[8:9], v0 offset:8768
ds_read_b64_tr_b16 v[10:11], v0 offset:9280
s_waitcnt lgkmcnt(4)
v_mfma_f32_16x16x32_bf16 v[244:247], v[12:15], v[200:203], v[244:247]
v_mfma_f32_16x16x32_bf16 v[252:255], v[12:15], v[204:207], v[252:255]
ds_read_b64_tr_b16 v[12:13], v0 offset:8800
ds_read_b64_tr_b16 v[14:15], v0 offset:9312
v_cvt_pk_bf16_f32 v32, v224, v225
v_cvt_pk_bf16_f32 v33, v226, v227
v_cvt_pk_bf16_f32 v34, v228, v229
v_cvt_pk_bf16_f32 v35, v230, v231
v_cvt_pk_bf16_f32 v36, v232, v233
v_cvt_pk_bf16_f32 v37, v234, v235
v_cvt_pk_bf16_f32 v38, v236, v237
v_cvt_pk_bf16_f32 v39, v238, v239
s_barrier
s_waitcnt lgkmcnt(4)
v_mfma_f32_16x16x32_bf16 v[48:51], v[4:7], v[64:67], 0
v_mfma_f32_16x16x32_bf16 v[56:59], v[4:7], v[68:71], 0
ds_read_b64_tr_b16 v[4:5], v0 offset:8832
ds_read_b64_tr_b16 v[6:7], v0 offset:9344
s_waitcnt lgkmcnt(4)
v_mfma_f32_16x16x32_bf16 v[52:55], v[8:11], v[64:67], 0
v_mfma_f32_16x16x32_bf16 v[60:63], v[8:11], v[68:71], 0
ds_read_b64_tr_b16 v[8:9], v0 offset:8864
ds_read_b64_tr_b16 v[10:11], v0 offset:9376
v_cvt_pk_bf16_f32 v40, v240, v241
v_cvt_pk_bf16_f32 v41, v242, v243
v_cvt_pk_bf16_f32 v42, v244, v245
v_cvt_pk_bf16_f32 v43, v246, v247
v_cvt_pk_bf16_f32 v44, v248, v249
v_cvt_pk_bf16_f32 v45, v250, v251
v_cvt_pk_bf16_f32 v46, v252, v253
v_cvt_pk_bf16_f32 v47, v254, v255
s_waitcnt lgkmcnt(4)
v_mfma_f32_16x16x32_bf16 v[208:211], v[12:15], v[64:67], 0
v_mfma_f32_16x16x32_bf16 v[216:219], v[12:15], v[68:71], 0
ds_read_b64_tr_b16 v[12:13], v0 offset:8896
ds_read_b64_tr_b16 v[14:15], v0 offset:9408
s_waitcnt lgkmcnt(4)
v_mfma_f32_16x16x32_bf16 v[212:215], v[4:7], v[64:67], 0
v_mfma_f32_16x16x32_bf16 v[220:223], v[4:7], v[68:71], 0
ds_read_b64_tr_b16 v[4:5], v0 offset:8928
ds_read_b64_tr_b16 v[6:7], v0 offset:9440
s_waitcnt lgkmcnt(4)
v_mfma_f32_16x16x32_bf16 v[224:227], v[8:11], v[64:67], 0
v_mfma_f32_16x16x32_bf16 v[232:235], v[8:11], v[68:71], 0
ds_read_b64_tr_b16 v[8:9], v0 offset:8960
ds_read_b64_tr_b16 v[10:11], v0 offset:9472
s_waitcnt lgkmcnt(4)
v_mfma_f32_16x16x32_bf16 v[228:231], v[12:15], v[64:67], 0
v_mfma_f32_16x16x32_bf16 v[236:239], v[12:15], v[68:71], 0
ds_read_b64_tr_b16 v[12:13], v0 offset:43680
ds_read_b64_tr_b16 v[14:15], v0 offset:44192
s_waitcnt lgkmcnt(4)
v_mfma_f32_16x16x32_bf16 v[240:243], v[4:7], v[64:67], 0
v_mfma_f32_16x16x32_bf16 v[248:251], v[4:7], v[68:71], 0
ds_read_b64_tr_b16 v[4:5], v0 offset:43712
ds_read_b64_tr_b16 v[6:7], v0 offset:44224
s_waitcnt lgkmcnt(4)
v_mfma_f32_16x16x32_bf16 v[244:247], v[8:11], v[64:67], 0
v_mfma_f32_16x16x32_bf16 v[252:255], v[8:11], v[68:71], 0
ds_read_b64_tr_b16 v[8:9], v0 offset:43744
ds_read_b64_tr_b16 v[10:11], v0 offset:44256
s_barrier
s_waitcnt lgkmcnt(4)
v_mfma_f32_16x16x32_bf16 v[48:51], v[12:15], v[72:75], v[48:51]
v_mfma_f32_16x16x32_bf16 v[56:59], v[12:15], v[76:79], v[56:59]
ds_read_b64_tr_b16 v[12:13], v0 offset:43776
ds_read_b64_tr_b16 v[14:15], v0 offset:44288
s_waitcnt lgkmcnt(4)
v_mfma_f32_16x16x32_bf16 v[52:55], v[4:7], v[72:75], v[52:55]
v_mfma_f32_16x16x32_bf16 v[60:63], v[4:7], v[76:79], v[60:63]
ds_read_b64_tr_b16 v[4:5], v0 offset:43808
ds_read_b64_tr_b16 v[6:7], v0 offset:44320
s_waitcnt lgkmcnt(4)
v_mfma_f32_16x16x32_bf16 v[208:211], v[8:11], v[72:75], v[208:211]
v_mfma_f32_16x16x32_bf16 v[216:219], v[8:11], v[76:79], v[216:219]
ds_read_b64_tr_b16 v[8:9], v0 offset:43840
ds_read_b64_tr_b16 v[10:11], v0 offset:44352
s_waitcnt lgkmcnt(4)
v_mfma_f32_16x16x32_bf16 v[212:215], v[12:15], v[72:75], v[212:215]
v_mfma_f32_16x16x32_bf16 v[220:223], v[12:15], v[76:79], v[220:223]
ds_read_b64_tr_b16 v[12:13], v0 offset:43872
ds_read_b64_tr_b16 v[14:15], v0 offset:44384
s_waitcnt lgkmcnt(4)
v_mfma_f32_16x16x32_bf16 v[224:227], v[4:7], v[72:75], v[224:227]
v_mfma_f32_16x16x32_bf16 v[232:235], v[4:7], v[76:79], v[232:235]
ds_read_b64_tr_b16 v[4:5], v0 offset:43904
ds_read_b64_tr_b16 v[6:7], v0 offset:44416
s_waitcnt lgkmcnt(4)
v_mfma_f32_16x16x32_bf16 v[228:231], v[8:11], v[72:75], v[228:231]
v_mfma_f32_16x16x32_bf16 v[236:239], v[8:11], v[76:79], v[236:239]
ds_read_b64_tr_b16 v[8:9], v0 offset:0
ds_read_b64_tr_b16 v[10:11], v0 offset:512
s_waitcnt lgkmcnt(4)
v_mfma_f32_16x16x32_bf16 v[240:243], v[12:15], v[72:75], v[240:243]
v_mfma_f32_16x16x32_bf16 v[248:251], v[12:15], v[76:79], v[248:251]
ds_read_b64_tr_b16 v[12:13], v0 offset:32
ds_read_b64_tr_b16 v[14:15], v0 offset:544
s_waitcnt lgkmcnt(4)
v_mfma_f32_16x16x32_bf16 v[244:247], v[4:7], v[72:75], v[244:247]
v_mfma_f32_16x16x32_bf16 v[252:255], v[4:7], v[76:79], v[252:255]
ds_read_b64_tr_b16 v[4:5], v0 offset:64
ds_read_b64_tr_b16 v[6:7], v0 offset:576
s_waitcnt lgkmcnt(4)
v_mfma_f32_16x16x32_bf16 v[48:51], v[8:11], v[80:83], v[48:51]
v_mfma_f32_16x16x32_bf16 v[56:59], v[8:11], v[84:87], v[56:59]
ds_read_b64_tr_b16 v[8:9], v0 offset:96
ds_read_b64_tr_b16 v[10:11], v0 offset:608
s_waitcnt lgkmcnt(4)
v_mfma_f32_16x16x32_bf16 v[52:55], v[12:15], v[80:83], v[52:55]
v_mfma_f32_16x16x32_bf16 v[60:63], v[12:15], v[84:87], v[60:63]
ds_read_b64_tr_b16 v[12:13], v0 offset:128
ds_read_b64_tr_b16 v[14:15], v0 offset:640
s_waitcnt lgkmcnt(4)
v_mfma_f32_16x16x32_bf16 v[208:211], v[4:7], v[80:83], v[208:211]
v_mfma_f32_16x16x32_bf16 v[216:219], v[4:7], v[84:87], v[216:219]
ds_read_b64_tr_b16 v[4:5], v0 offset:160
ds_read_b64_tr_b16 v[6:7], v0 offset:672
s_waitcnt lgkmcnt(4)
v_mfma_f32_16x16x32_bf16 v[212:215], v[8:11], v[80:83], v[212:215]
v_mfma_f32_16x16x32_bf16 v[220:223], v[8:11], v[84:87], v[220:223]
ds_read_b64_tr_b16 v[8:9], v0 offset:192
ds_read_b64_tr_b16 v[10:11], v0 offset:704
s_waitcnt lgkmcnt(4)
v_mfma_f32_16x16x32_bf16 v[224:227], v[12:15], v[80:83], v[224:227]
v_mfma_f32_16x16x32_bf16 v[232:235], v[12:15], v[84:87], v[232:235]
ds_read_b64_tr_b16 v[12:13], v0 offset:224
ds_read_b64_tr_b16 v[14:15], v0 offset:736
s_waitcnt lgkmcnt(4)
v_mfma_f32_16x16x32_bf16 v[228:231], v[4:7], v[80:83], v[228:231]
v_mfma_f32_16x16x32_bf16 v[236:239], v[4:7], v[84:87], v[236:239]
ds_read_b64_tr_b16 v[4:5], v0 offset:17472
ds_read_b64_tr_b16 v[6:7], v0 offset:17984
s_waitcnt lgkmcnt(4)
v_mfma_f32_16x16x32_bf16 v[240:243], v[8:11], v[80:83], v[240:243]
v_mfma_f32_16x16x32_bf16 v[248:251], v[8:11], v[84:87], v[248:251]
ds_read_b64_tr_b16 v[8:9], v0 offset:17504
ds_read_b64_tr_b16 v[10:11], v0 offset:18016
s_waitcnt lgkmcnt(4)
v_mfma_f32_16x16x32_bf16 v[244:247], v[12:15], v[80:83], v[244:247]
v_mfma_f32_16x16x32_bf16 v[252:255], v[12:15], v[84:87], v[252:255]
ds_read_b64_tr_b16 v[12:13], v0 offset:17536
ds_read_b64_tr_b16 v[14:15], v0 offset:18048
s_barrier
s_waitcnt lgkmcnt(4)
v_mfma_f32_16x16x32_bf16 v[48:51], v[4:7], v[88:91], v[48:51]
v_mfma_f32_16x16x32_bf16 v[56:59], v[4:7], v[92:95], v[56:59]
ds_read_b64_tr_b16 v[4:5], v0 offset:17568
ds_read_b64_tr_b16 v[6:7], v0 offset:18080
s_waitcnt lgkmcnt(4)
v_mfma_f32_16x16x32_bf16 v[52:55], v[8:11], v[88:91], v[52:55]
v_mfma_f32_16x16x32_bf16 v[60:63], v[8:11], v[92:95], v[60:63]
ds_read_b64_tr_b16 v[8:9], v0 offset:17600
ds_read_b64_tr_b16 v[10:11], v0 offset:18112
s_waitcnt lgkmcnt(4)
v_mfma_f32_16x16x32_bf16 v[208:211], v[12:15], v[88:91], v[208:211]
v_mfma_f32_16x16x32_bf16 v[216:219], v[12:15], v[92:95], v[216:219]
ds_read_b64_tr_b16 v[12:13], v0 offset:17632
ds_read_b64_tr_b16 v[14:15], v0 offset:18144
s_waitcnt lgkmcnt(4)
v_mfma_f32_16x16x32_bf16 v[212:215], v[4:7], v[88:91], v[212:215]
v_mfma_f32_16x16x32_bf16 v[220:223], v[4:7], v[92:95], v[220:223]
ds_read_b64_tr_b16 v[4:5], v0 offset:17664
ds_read_b64_tr_b16 v[6:7], v0 offset:18176
s_waitcnt lgkmcnt(4)
v_mfma_f32_16x16x32_bf16 v[224:227], v[8:11], v[88:91], v[224:227]
v_mfma_f32_16x16x32_bf16 v[232:235], v[8:11], v[92:95], v[232:235]
ds_read_b64_tr_b16 v[8:9], v0 offset:17696
ds_read_b64_tr_b16 v[10:11], v0 offset:18208
s_waitcnt lgkmcnt(4)
v_mfma_f32_16x16x32_bf16 v[228:231], v[12:15], v[88:91], v[228:231]
v_mfma_f32_16x16x32_bf16 v[236:239], v[12:15], v[92:95], v[236:239]
ds_read_b64_tr_b16 v[12:13], v0 offset:34944
ds_read_b64_tr_b16 v[14:15], v0 offset:35456
s_waitcnt lgkmcnt(4)
v_mfma_f32_16x16x32_bf16 v[240:243], v[4:7], v[88:91], v[240:243]
v_mfma_f32_16x16x32_bf16 v[248:251], v[4:7], v[92:95], v[248:251]
ds_read_b64_tr_b16 v[4:5], v0 offset:34976
ds_read_b64_tr_b16 v[6:7], v0 offset:35488
s_waitcnt lgkmcnt(4)
v_mfma_f32_16x16x32_bf16 v[244:247], v[8:11], v[88:91], v[244:247]
v_mfma_f32_16x16x32_bf16 v[252:255], v[8:11], v[92:95], v[252:255]
ds_read_b64_tr_b16 v[8:9], v0 offset:35008
ds_read_b64_tr_b16 v[10:11], v0 offset:35520
s_waitcnt lgkmcnt(4)
v_mfma_f32_16x16x32_bf16 v[48:51], v[12:15], v[96:99], v[48:51]
v_mfma_f32_16x16x32_bf16 v[56:59], v[12:15], v[100:103], v[56:59]
ds_read_b64_tr_b16 v[12:13], v0 offset:35040
ds_read_b64_tr_b16 v[14:15], v0 offset:35552
s_waitcnt lgkmcnt(4)
v_mfma_f32_16x16x32_bf16 v[52:55], v[4:7], v[96:99], v[52:55]
v_mfma_f32_16x16x32_bf16 v[60:63], v[4:7], v[100:103], v[60:63]
ds_read_b64_tr_b16 v[4:5], v0 offset:35072
ds_read_b64_tr_b16 v[6:7], v0 offset:35584
s_waitcnt lgkmcnt(4)
v_mfma_f32_16x16x32_bf16 v[208:211], v[8:11], v[96:99], v[208:211]
v_mfma_f32_16x16x32_bf16 v[216:219], v[8:11], v[100:103], v[216:219]
ds_read_b64_tr_b16 v[8:9], v0 offset:35104
ds_read_b64_tr_b16 v[10:11], v0 offset:35616
s_waitcnt lgkmcnt(4)
v_mfma_f32_16x16x32_bf16 v[212:215], v[12:15], v[96:99], v[212:215]
v_mfma_f32_16x16x32_bf16 v[220:223], v[12:15], v[100:103], v[220:223]
ds_read_b64_tr_b16 v[12:13], v0 offset:35136
ds_read_b64_tr_b16 v[14:15], v0 offset:35648
s_waitcnt lgkmcnt(4)
v_mfma_f32_16x16x32_bf16 v[224:227], v[4:7], v[96:99], v[224:227]
v_mfma_f32_16x16x32_bf16 v[232:235], v[4:7], v[100:103], v[232:235]
ds_read_b64_tr_b16 v[4:5], v0 offset:35168
ds_read_b64_tr_b16 v[6:7], v0 offset:35680
s_waitcnt lgkmcnt(4)
v_mfma_f32_16x16x32_bf16 v[228:231], v[8:11], v[96:99], v[228:231]
v_mfma_f32_16x16x32_bf16 v[236:239], v[8:11], v[100:103], v[236:239]
ds_read_b64_tr_b16 v[8:9], v0 offset:52416
ds_read_b64_tr_b16 v[10:11], v0 offset:52928
s_waitcnt lgkmcnt(4)
v_mfma_f32_16x16x32_bf16 v[240:243], v[12:15], v[96:99], v[240:243]
v_mfma_f32_16x16x32_bf16 v[248:251], v[12:15], v[100:103], v[248:251]
ds_read_b64_tr_b16 v[12:13], v0 offset:52448
ds_read_b64_tr_b16 v[14:15], v0 offset:52960
s_waitcnt lgkmcnt(4)
v_mfma_f32_16x16x32_bf16 v[244:247], v[4:7], v[96:99], v[244:247]
v_mfma_f32_16x16x32_bf16 v[252:255], v[4:7], v[100:103], v[252:255]
ds_read_b64_tr_b16 v[4:5], v0 offset:52480
ds_read_b64_tr_b16 v[6:7], v0 offset:52992
s_waitcnt lgkmcnt(4)
v_mfma_f32_16x16x32_bf16 v[48:51], v[8:11], v[104:107], v[48:51]
v_mfma_f32_16x16x32_bf16 v[56:59], v[8:11], v[108:111], v[56:59]
ds_read_b64_tr_b16 v[8:9], v0 offset:52512
ds_read_b64_tr_b16 v[10:11], v0 offset:53024
s_waitcnt lgkmcnt(4)
v_mfma_f32_16x16x32_bf16 v[52:55], v[12:15], v[104:107], v[52:55]
v_mfma_f32_16x16x32_bf16 v[60:63], v[12:15], v[108:111], v[60:63]
ds_read_b64_tr_b16 v[12:13], v0 offset:52544
ds_read_b64_tr_b16 v[14:15], v0 offset:53056
s_waitcnt lgkmcnt(4)
v_mfma_f32_16x16x32_bf16 v[208:211], v[4:7], v[104:107], v[208:211]
v_mfma_f32_16x16x32_bf16 v[216:219], v[4:7], v[108:111], v[216:219]
ds_read_b64_tr_b16 v[4:5], v0 offset:52576
ds_read_b64_tr_b16 v[6:7], v0 offset:53088
s_waitcnt lgkmcnt(4)
v_mfma_f32_16x16x32_bf16 v[212:215], v[8:11], v[104:107], v[212:215]
v_mfma_f32_16x16x32_bf16 v[220:223], v[8:11], v[108:111], v[220:223]
ds_read_b64_tr_b16 v[8:9], v0 offset:52608
ds_read_b64_tr_b16 v[10:11], v0 offset:53120
s_waitcnt lgkmcnt(4)
v_mfma_f32_16x16x32_bf16 v[224:227], v[12:15], v[104:107], v[224:227]
v_mfma_f32_16x16x32_bf16 v[232:235], v[12:15], v[108:111], v[232:235]
ds_read_b64_tr_b16 v[12:13], v0 offset:52640
ds_read_b64_tr_b16 v[14:15], v0 offset:53152
s_waitcnt lgkmcnt(4)
v_mfma_f32_16x16x32_bf16 v[228:231], v[4:7], v[104:107], v[228:231]
v_mfma_f32_16x16x32_bf16 v[236:239], v[4:7], v[108:111], v[236:239]
ds_read_b64_tr_b16 v[4:5], v0 offset:26208
ds_read_b64_tr_b16 v[6:7], v0 offset:26720
s_waitcnt lgkmcnt(4)
v_mfma_f32_16x16x32_bf16 v[240:243], v[8:11], v[104:107], v[240:243]
v_mfma_f32_16x16x32_bf16 v[248:251], v[8:11], v[108:111], v[248:251]
ds_read_b64_tr_b16 v[8:9], v0 offset:26240
ds_read_b64_tr_b16 v[10:11], v0 offset:26752
s_waitcnt lgkmcnt(4)
v_mfma_f32_16x16x32_bf16 v[244:247], v[12:15], v[104:107], v[244:247]
v_mfma_f32_16x16x32_bf16 v[252:255], v[12:15], v[108:111], v[252:255]
ds_read_b64_tr_b16 v[12:13], v0 offset:26272
ds_read_b64_tr_b16 v[14:15], v0 offset:26784
s_barrier
s_waitcnt lgkmcnt(4)
v_mfma_f32_16x16x32_bf16 v[48:51], v[4:7], v[112:115], v[48:51]
v_mfma_f32_16x16x32_bf16 v[56:59], v[4:7], v[116:119], v[56:59]
ds_read_b64_tr_b16 v[4:5], v0 offset:26304
ds_read_b64_tr_b16 v[6:7], v0 offset:26816
s_waitcnt lgkmcnt(4)
v_mfma_f32_16x16x32_bf16 v[52:55], v[8:11], v[112:115], v[52:55]
v_mfma_f32_16x16x32_bf16 v[60:63], v[8:11], v[116:119], v[60:63]
ds_read_b64_tr_b16 v[8:9], v0 offset:26336
ds_read_b64_tr_b16 v[10:11], v0 offset:26848
s_waitcnt lgkmcnt(4)
v_mfma_f32_16x16x32_bf16 v[208:211], v[12:15], v[112:115], v[208:211]
v_mfma_f32_16x16x32_bf16 v[216:219], v[12:15], v[116:119], v[216:219]
ds_read_b64_tr_b16 v[12:13], v0 offset:26368
ds_read_b64_tr_b16 v[14:15], v0 offset:26880
ds_write_b128 v1, v[16:19] offset:0
s_waitcnt lgkmcnt(5)
v_mfma_f32_16x16x32_bf16 v[212:215], v[4:7], v[112:115], v[212:215]
v_mfma_f32_16x16x32_bf16 v[220:223], v[4:7], v[116:119], v[220:223]
ds_read_b64_tr_b16 v[4:5], v0 offset:26400
ds_read_b64_tr_b16 v[6:7], v0 offset:26912
s_waitcnt lgkmcnt(5)
v_mfma_f32_16x16x32_bf16 v[224:227], v[8:11], v[112:115], v[224:227]
v_mfma_f32_16x16x32_bf16 v[232:235], v[8:11], v[116:119], v[232:235]
ds_read_b64_tr_b16 v[8:9], v0 offset:26432
ds_read_b64_tr_b16 v[10:11], v0 offset:26944
s_waitcnt lgkmcnt(5)
v_mfma_f32_16x16x32_bf16 v[228:231], v[12:15], v[112:115], v[228:231]
v_mfma_f32_16x16x32_bf16 v[236:239], v[12:15], v[116:119], v[236:239]
ds_read_b64_tr_b16 v[12:13], v0 offset:8736
ds_read_b64_tr_b16 v[14:15], v0 offset:9248
ds_write_b128 v1, v[20:23] offset:1024
s_waitcnt lgkmcnt(5)
v_mfma_f32_16x16x32_bf16 v[240:243], v[4:7], v[112:115], v[240:243]
v_mfma_f32_16x16x32_bf16 v[248:251], v[4:7], v[116:119], v[248:251]
ds_read_b64_tr_b16 v[4:5], v0 offset:8768
ds_read_b64_tr_b16 v[6:7], v0 offset:9280
s_waitcnt lgkmcnt(5)
v_mfma_f32_16x16x32_bf16 v[244:247], v[8:11], v[112:115], v[244:247]
v_mfma_f32_16x16x32_bf16 v[252:255], v[8:11], v[116:119], v[252:255]
ds_read_b64_tr_b16 v[8:9], v0 offset:8800
ds_read_b64_tr_b16 v[10:11], v0 offset:9312
s_waitcnt lgkmcnt(5)
v_mfma_f32_16x16x32_bf16 v[48:51], v[12:15], v[120:123], v[48:51]
v_mfma_f32_16x16x32_bf16 v[56:59], v[12:15], v[124:127], v[56:59]
ds_read_b64_tr_b16 v[12:13], v0 offset:8832
ds_read_b64_tr_b16 v[14:15], v0 offset:9344
ds_write_b128 v1, v[24:27] offset:6144
s_waitcnt lgkmcnt(5)
v_mfma_f32_16x16x32_bf16 v[52:55], v[4:7], v[120:123], v[52:55]
v_mfma_f32_16x16x32_bf16 v[60:63], v[4:7], v[124:127], v[60:63]
ds_read_b64_tr_b16 v[4:5], v0 offset:8864
ds_read_b64_tr_b16 v[6:7], v0 offset:9376
s_waitcnt lgkmcnt(5)
v_mfma_f32_16x16x32_bf16 v[208:211], v[8:11], v[120:123], v[208:211]
v_mfma_f32_16x16x32_bf16 v[216:219], v[8:11], v[124:127], v[216:219]
ds_read_b64_tr_b16 v[8:9], v0 offset:8896
ds_read_b64_tr_b16 v[10:11], v0 offset:9408
s_waitcnt lgkmcnt(5)
v_mfma_f32_16x16x32_bf16 v[212:215], v[12:15], v[120:123], v[212:215]
v_mfma_f32_16x16x32_bf16 v[220:223], v[12:15], v[124:127], v[220:223]
ds_read_b64_tr_b16 v[12:13], v0 offset:8928
ds_read_b64_tr_b16 v[14:15], v0 offset:9440
ds_write_b128 v1, v[28:31] offset:7168
s_waitcnt lgkmcnt(5)
v_mfma_f32_16x16x32_bf16 v[224:227], v[4:7], v[120:123], v[224:227]
v_mfma_f32_16x16x32_bf16 v[232:235], v[4:7], v[124:127], v[232:235]
ds_read_b64_tr_b16 v[4:5], v0 offset:8960
ds_read_b64_tr_b16 v[6:7], v0 offset:9472
s_waitcnt lgkmcnt(5)
v_mfma_f32_16x16x32_bf16 v[228:231], v[8:11], v[120:123], v[228:231]
v_mfma_f32_16x16x32_bf16 v[236:239], v[8:11], v[124:127], v[236:239]
ds_read_b64_tr_b16 v[8:9], v0 offset:43680
ds_read_b64_tr_b16 v[10:11], v0 offset:44192
s_waitcnt lgkmcnt(5)
v_mfma_f32_16x16x32_bf16 v[240:243], v[12:15], v[120:123], v[240:243]
v_mfma_f32_16x16x32_bf16 v[248:251], v[12:15], v[124:127], v[248:251]
ds_read_b64_tr_b16 v[12:13], v0 offset:43712
ds_read_b64_tr_b16 v[14:15], v0 offset:44224
s_waitcnt lgkmcnt(4)
v_mfma_f32_16x16x32_bf16 v[244:247], v[4:7], v[120:123], v[244:247]
v_mfma_f32_16x16x32_bf16 v[252:255], v[4:7], v[124:127], v[252:255]
ds_read_b64_tr_b16 v[4:5], v0 offset:43744
ds_read_b64_tr_b16 v[6:7], v0 offset:44256
s_barrier
s_waitcnt lgkmcnt(4)
v_mfma_f32_16x16x32_bf16 v[48:51], v[8:11], v[128:131], v[48:51]
v_mfma_f32_16x16x32_bf16 v[56:59], v[8:11], v[132:135], v[56:59]
ds_read_b64_tr_b16 v[8:9], v0 offset:43776
ds_read_b64_tr_b16 v[10:11], v0 offset:44288
s_waitcnt lgkmcnt(4)
v_mfma_f32_16x16x32_bf16 v[52:55], v[12:15], v[128:131], v[52:55]
v_mfma_f32_16x16x32_bf16 v[60:63], v[12:15], v[132:135], v[60:63]
ds_read_b64_tr_b16 v[12:13], v0 offset:43808
ds_read_b64_tr_b16 v[14:15], v0 offset:44320
s_waitcnt lgkmcnt(4)
v_mfma_f32_16x16x32_bf16 v[208:211], v[4:7], v[128:131], v[208:211]
v_mfma_f32_16x16x32_bf16 v[216:219], v[4:7], v[132:135], v[216:219]
ds_read_b64_tr_b16 v[4:5], v0 offset:43840
ds_read_b64_tr_b16 v[6:7], v0 offset:44352
s_waitcnt lgkmcnt(4)
v_mfma_f32_16x16x32_bf16 v[212:215], v[8:11], v[128:131], v[212:215]
v_mfma_f32_16x16x32_bf16 v[220:223], v[8:11], v[132:135], v[220:223]
ds_read_b64_tr_b16 v[8:9], v0 offset:43872
ds_read_b64_tr_b16 v[10:11], v0 offset:44384
s_waitcnt lgkmcnt(4)
v_mfma_f32_16x16x32_bf16 v[224:227], v[12:15], v[128:131], v[224:227]
v_mfma_f32_16x16x32_bf16 v[232:235], v[12:15], v[132:135], v[232:235]
ds_read_b64_tr_b16 v[12:13], v0 offset:43904
ds_read_b64_tr_b16 v[14:15], v0 offset:44416
s_waitcnt lgkmcnt(4)
v_mfma_f32_16x16x32_bf16 v[228:231], v[4:7], v[128:131], v[228:231]
v_mfma_f32_16x16x32_bf16 v[236:239], v[4:7], v[132:135], v[236:239]
ds_read_b64_tr_b16 v[4:5], v0 offset:0
ds_read_b64_tr_b16 v[6:7], v0 offset:512
s_waitcnt lgkmcnt(4)
v_mfma_f32_16x16x32_bf16 v[240:243], v[8:11], v[128:131], v[240:243]
v_mfma_f32_16x16x32_bf16 v[248:251], v[8:11], v[132:135], v[248:251]
ds_read_b64_tr_b16 v[8:9], v0 offset:32
ds_read_b64_tr_b16 v[10:11], v0 offset:544
s_waitcnt lgkmcnt(4)
v_mfma_f32_16x16x32_bf16 v[244:247], v[12:15], v[128:131], v[244:247]
v_mfma_f32_16x16x32_bf16 v[252:255], v[12:15], v[132:135], v[252:255]
ds_read_b64_tr_b16 v[12:13], v0 offset:64
ds_read_b64_tr_b16 v[14:15], v0 offset:576
s_waitcnt lgkmcnt(4)
v_mfma_f32_16x16x32_bf16 v[48:51], v[4:7], v[136:139], v[48:51]
v_mfma_f32_16x16x32_bf16 v[56:59], v[4:7], v[140:143], v[56:59]
ds_read_b64_tr_b16 v[4:5], v0 offset:96
ds_read_b64_tr_b16 v[6:7], v0 offset:608
s_waitcnt lgkmcnt(4)
v_mfma_f32_16x16x32_bf16 v[52:55], v[8:11], v[136:139], v[52:55]
v_mfma_f32_16x16x32_bf16 v[60:63], v[8:11], v[140:143], v[60:63]
ds_read_b64_tr_b16 v[8:9], v0 offset:128
ds_read_b64_tr_b16 v[10:11], v0 offset:640
s_waitcnt lgkmcnt(4)
v_mfma_f32_16x16x32_bf16 v[208:211], v[12:15], v[136:139], v[208:211]
v_mfma_f32_16x16x32_bf16 v[216:219], v[12:15], v[140:143], v[216:219]
ds_read_b64_tr_b16 v[12:13], v0 offset:160
ds_read_b64_tr_b16 v[14:15], v0 offset:672
s_waitcnt lgkmcnt(4)
v_mfma_f32_16x16x32_bf16 v[212:215], v[4:7], v[136:139], v[212:215]
v_mfma_f32_16x16x32_bf16 v[220:223], v[4:7], v[140:143], v[220:223]
ds_read_b64_tr_b16 v[4:5], v0 offset:192
ds_read_b64_tr_b16 v[6:7], v0 offset:704
s_waitcnt lgkmcnt(4)
v_mfma_f32_16x16x32_bf16 v[224:227], v[8:11], v[136:139], v[224:227]
v_mfma_f32_16x16x32_bf16 v[232:235], v[8:11], v[140:143], v[232:235]
ds_read_b64_tr_b16 v[8:9], v0 offset:224
ds_read_b64_tr_b16 v[10:11], v0 offset:736
s_waitcnt lgkmcnt(4)
v_mfma_f32_16x16x32_bf16 v[228:231], v[12:15], v[136:139], v[228:231]
v_mfma_f32_16x16x32_bf16 v[236:239], v[12:15], v[140:143], v[236:239]
ds_read_b64_tr_b16 v[12:13], v3 offset:0
ds_read_b64_tr_b16 v[14:15], v3 offset:512
s_waitcnt lgkmcnt(4)
v_mfma_f32_16x16x32_bf16 v[240:243], v[4:7], v[136:139], v[240:243]
v_mfma_f32_16x16x32_bf16 v[248:251], v[4:7], v[140:143], v[248:251]
ds_read_b64_tr_b16 v[4:5], v3 offset:32
ds_read_b64_tr_b16 v[6:7], v3 offset:544
s_waitcnt lgkmcnt(4)
v_mfma_f32_16x16x32_bf16 v[244:247], v[8:11], v[136:139], v[244:247]
v_mfma_f32_16x16x32_bf16 v[252:255], v[8:11], v[140:143], v[252:255]
ds_read_b64_tr_b16 v[8:9], v3 offset:64
ds_read_b64_tr_b16 v[10:11], v3 offset:576
s_waitcnt lgkmcnt(4)
v_mfma_f32_16x16x32_bf16 v[48:51], v[12:15], v[144:147], v[48:51]
v_mfma_f32_16x16x32_bf16 v[56:59], v[12:15], v[148:151], v[56:59]
ds_read_b64_tr_b16 v[12:13], v3 offset:96
ds_read_b64_tr_b16 v[14:15], v3 offset:608
s_waitcnt lgkmcnt(4)
v_mfma_f32_16x16x32_bf16 v[52:55], v[4:7], v[144:147], v[52:55]
v_mfma_f32_16x16x32_bf16 v[60:63], v[4:7], v[148:151], v[60:63]
ds_read_b64_tr_b16 v[4:5], v3 offset:128
ds_read_b64_tr_b16 v[6:7], v3 offset:640
s_waitcnt lgkmcnt(4)
v_mfma_f32_16x16x32_bf16 v[208:211], v[8:11], v[144:147], v[208:211]
v_mfma_f32_16x16x32_bf16 v[216:219], v[8:11], v[148:151], v[216:219]
ds_read_b64_tr_b16 v[8:9], v3 offset:160
ds_read_b64_tr_b16 v[10:11], v3 offset:672
s_waitcnt lgkmcnt(4)
v_mfma_f32_16x16x32_bf16 v[212:215], v[12:15], v[144:147], v[212:215]
v_mfma_f32_16x16x32_bf16 v[220:223], v[12:15], v[148:151], v[220:223]
ds_read_b64_tr_b16 v[12:13], v3 offset:192
ds_read_b64_tr_b16 v[14:15], v3 offset:704
s_waitcnt lgkmcnt(4)
v_mfma_f32_16x16x32_bf16 v[224:227], v[4:7], v[144:147], v[224:227]
v_mfma_f32_16x16x32_bf16 v[232:235], v[4:7], v[148:151], v[232:235]
ds_read_b64_tr_b16 v[4:5], v3 offset:224
ds_read_b64_tr_b16 v[6:7], v3 offset:736
s_waitcnt lgkmcnt(4)
v_mfma_f32_16x16x32_bf16 v[228:231], v[8:11], v[144:147], v[228:231]
v_mfma_f32_16x16x32_bf16 v[236:239], v[8:11], v[148:151], v[236:239]
ds_read_b64_tr_b16 v[8:9], v3 offset:8736
ds_read_b64_tr_b16 v[10:11], v3 offset:9248
s_waitcnt lgkmcnt(4)
v_mfma_f32_16x16x32_bf16 v[240:243], v[12:15], v[144:147], v[240:243]
v_mfma_f32_16x16x32_bf16 v[248:251], v[12:15], v[148:151], v[248:251]
ds_read_b64_tr_b16 v[12:13], v3 offset:8768
ds_read_b64_tr_b16 v[14:15], v3 offset:9280
s_barrier
s_waitcnt lgkmcnt(4)
v_mfma_f32_16x16x32_bf16 v[244:247], v[4:7], v[144:147], v[244:247]
v_mfma_f32_16x16x32_bf16 v[252:255], v[4:7], v[148:151], v[252:255]
ds_read_b64_tr_b16 v[4:5], v3 offset:8800
ds_read_b64_tr_b16 v[6:7], v3 offset:9312
s_waitcnt lgkmcnt(4)
v_mfma_f32_16x16x32_bf16 v[48:51], v[8:11], v[152:155], v[48:51]
v_mfma_f32_16x16x32_bf16 v[56:59], v[8:11], v[156:159], v[56:59]
ds_read_b64_tr_b16 v[8:9], v3 offset:8832
ds_read_b64_tr_b16 v[10:11], v3 offset:9344
s_waitcnt lgkmcnt(4)
v_mfma_f32_16x16x32_bf16 v[52:55], v[12:15], v[152:155], v[52:55]
v_mfma_f32_16x16x32_bf16 v[60:63], v[12:15], v[156:159], v[60:63]
ds_read_b64_tr_b16 v[12:13], v3 offset:8864
ds_read_b64_tr_b16 v[14:15], v3 offset:9376
s_waitcnt lgkmcnt(4)
v_mfma_f32_16x16x32_bf16 v[208:211], v[4:7], v[152:155], v[208:211]
v_mfma_f32_16x16x32_bf16 v[216:219], v[4:7], v[156:159], v[216:219]
ds_read_b64_tr_b16 v[4:5], v3 offset:8896
ds_read_b64_tr_b16 v[6:7], v3 offset:9408
ds_write_b128 v1, v[32:35] offset:12288
s_waitcnt lgkmcnt(5)
v_mfma_f32_16x16x32_bf16 v[212:215], v[8:11], v[152:155], v[212:215]
v_mfma_f32_16x16x32_bf16 v[220:223], v[8:11], v[156:159], v[220:223]
ds_read_b64_tr_b16 v[8:9], v3 offset:8928
ds_read_b64_tr_b16 v[10:11], v3 offset:9440
s_waitcnt lgkmcnt(5)
v_mfma_f32_16x16x32_bf16 v[224:227], v[12:15], v[152:155], v[224:227]
v_mfma_f32_16x16x32_bf16 v[232:235], v[12:15], v[156:159], v[232:235]
ds_read_b64_tr_b16 v[12:13], v3 offset:8960
ds_read_b64_tr_b16 v[14:15], v3 offset:9472
s_waitcnt lgkmcnt(5)
v_mfma_f32_16x16x32_bf16 v[228:231], v[4:7], v[152:155], v[228:231]
v_mfma_f32_16x16x32_bf16 v[236:239], v[4:7], v[156:159], v[236:239]
ds_read_b64_tr_b16 v[4:5], v3 offset:17472
ds_read_b64_tr_b16 v[6:7], v3 offset:17984
ds_write_b128 v1, v[36:39] offset:13312
s_waitcnt lgkmcnt(5)
v_mfma_f32_16x16x32_bf16 v[240:243], v[8:11], v[152:155], v[240:243]
v_mfma_f32_16x16x32_bf16 v[248:251], v[8:11], v[156:159], v[248:251]
ds_read_b64_tr_b16 v[8:9], v3 offset:17504
ds_read_b64_tr_b16 v[10:11], v3 offset:18016
s_waitcnt lgkmcnt(5)
v_mfma_f32_16x16x32_bf16 v[244:247], v[12:15], v[152:155], v[244:247]
v_mfma_f32_16x16x32_bf16 v[252:255], v[12:15], v[156:159], v[252:255]
ds_read_b64_tr_b16 v[12:13], v3 offset:17536
ds_read_b64_tr_b16 v[14:15], v3 offset:18048
s_waitcnt lgkmcnt(5)
v_mfma_f32_16x16x32_bf16 v[48:51], v[4:7], v[160:163], v[48:51]
v_mfma_f32_16x16x32_bf16 v[56:59], v[4:7], v[164:167], v[56:59]
ds_read_b64_tr_b16 v[4:5], v3 offset:17568
ds_read_b64_tr_b16 v[6:7], v3 offset:18080
ds_write_b128 v1, v[40:43] offset:18432
s_waitcnt lgkmcnt(5)
v_mfma_f32_16x16x32_bf16 v[52:55], v[8:11], v[160:163], v[52:55]
v_mfma_f32_16x16x32_bf16 v[60:63], v[8:11], v[164:167], v[60:63]
ds_read_b64_tr_b16 v[8:9], v3 offset:17600
ds_read_b64_tr_b16 v[10:11], v3 offset:18112
s_waitcnt lgkmcnt(5)
v_mfma_f32_16x16x32_bf16 v[208:211], v[12:15], v[160:163], v[208:211]
v_mfma_f32_16x16x32_bf16 v[216:219], v[12:15], v[164:167], v[216:219]
ds_read_b64_tr_b16 v[12:13], v3 offset:17632
ds_read_b64_tr_b16 v[14:15], v3 offset:18144
s_waitcnt lgkmcnt(5)
v_mfma_f32_16x16x32_bf16 v[212:215], v[4:7], v[160:163], v[212:215]
v_mfma_f32_16x16x32_bf16 v[220:223], v[4:7], v[164:167], v[220:223]
ds_read_b64_tr_b16 v[4:5], v3 offset:17664
ds_read_b64_tr_b16 v[6:7], v3 offset:18176
ds_write_b128 v1, v[44:47] offset:19456
s_waitcnt lgkmcnt(5)
v_mfma_f32_16x16x32_bf16 v[224:227], v[8:11], v[160:163], v[224:227]
v_mfma_f32_16x16x32_bf16 v[232:235], v[8:11], v[164:167], v[232:235]
ds_read_b64_tr_b16 v[8:9], v3 offset:17696
ds_read_b64_tr_b16 v[10:11], v3 offset:18208
s_waitcnt lgkmcnt(5)
v_mfma_f32_16x16x32_bf16 v[228:231], v[12:15], v[160:163], v[228:231]
v_mfma_f32_16x16x32_bf16 v[236:239], v[12:15], v[164:167], v[236:239]
ds_read_b64_tr_b16 v[12:13], v0 offset:34944
ds_read_b64_tr_b16 v[14:15], v0 offset:35456
s_waitcnt lgkmcnt(5)
v_mfma_f32_16x16x32_bf16 v[240:243], v[4:7], v[160:163], v[240:243]
v_mfma_f32_16x16x32_bf16 v[248:251], v[4:7], v[164:167], v[248:251]
ds_read_b64_tr_b16 v[4:5], v0 offset:34976
ds_read_b64_tr_b16 v[6:7], v0 offset:35488
s_waitcnt lgkmcnt(4)
v_mfma_f32_16x16x32_bf16 v[244:247], v[8:11], v[160:163], v[244:247]
v_mfma_f32_16x16x32_bf16 v[252:255], v[8:11], v[164:167], v[252:255]
ds_read_b64_tr_b16 v[8:9], v0 offset:35008
ds_read_b64_tr_b16 v[10:11], v0 offset:35520
s_barrier
s_waitcnt lgkmcnt(4)
v_mfma_f32_16x16x32_bf16 v[48:51], v[12:15], v[168:171], v[48:51]
v_mfma_f32_16x16x32_bf16 v[56:59], v[12:15], v[172:175], v[56:59]
ds_read_b64_tr_b16 v[12:13], v0 offset:35040
ds_read_b64_tr_b16 v[14:15], v0 offset:35552
s_waitcnt lgkmcnt(4)
v_mfma_f32_16x16x32_bf16 v[52:55], v[4:7], v[168:171], v[52:55]
v_mfma_f32_16x16x32_bf16 v[60:63], v[4:7], v[172:175], v[60:63]
ds_read_b64_tr_b16 v[4:5], v0 offset:35072
ds_read_b64_tr_b16 v[6:7], v0 offset:35584
s_waitcnt lgkmcnt(4)
v_mfma_f32_16x16x32_bf16 v[208:211], v[8:11], v[168:171], v[208:211]
v_mfma_f32_16x16x32_bf16 v[216:219], v[8:11], v[172:175], v[216:219]
ds_read_b64_tr_b16 v[8:9], v0 offset:35104
ds_read_b64_tr_b16 v[10:11], v0 offset:35616
s_waitcnt lgkmcnt(4)
v_mfma_f32_16x16x32_bf16 v[212:215], v[12:15], v[168:171], v[212:215]
v_mfma_f32_16x16x32_bf16 v[220:223], v[12:15], v[172:175], v[220:223]
ds_read_b64_tr_b16 v[12:13], v0 offset:35136
ds_read_b64_tr_b16 v[14:15], v0 offset:35648
s_waitcnt lgkmcnt(4)
v_mfma_f32_16x16x32_bf16 v[224:227], v[4:7], v[168:171], v[224:227]
v_mfma_f32_16x16x32_bf16 v[232:235], v[4:7], v[172:175], v[232:235]
ds_read_b64_tr_b16 v[4:5], v0 offset:35168
ds_read_b64_tr_b16 v[6:7], v0 offset:35680
s_waitcnt lgkmcnt(4)
v_mfma_f32_16x16x32_bf16 v[228:231], v[8:11], v[168:171], v[228:231]
v_mfma_f32_16x16x32_bf16 v[236:239], v[8:11], v[172:175], v[236:239]
ds_read_b64_tr_b16 v[8:9], v0 offset:52416
ds_read_b64_tr_b16 v[10:11], v0 offset:52928
s_waitcnt lgkmcnt(4)
v_mfma_f32_16x16x32_bf16 v[240:243], v[12:15], v[168:171], v[240:243]
v_mfma_f32_16x16x32_bf16 v[248:251], v[12:15], v[172:175], v[248:251]
ds_read_b64_tr_b16 v[12:13], v0 offset:52448
ds_read_b64_tr_b16 v[14:15], v0 offset:52960
s_waitcnt lgkmcnt(4)
v_mfma_f32_16x16x32_bf16 v[244:247], v[4:7], v[168:171], v[244:247]
v_mfma_f32_16x16x32_bf16 v[252:255], v[4:7], v[172:175], v[252:255]
ds_read_b64_tr_b16 v[4:5], v0 offset:52480
ds_read_b64_tr_b16 v[6:7], v0 offset:52992
s_waitcnt lgkmcnt(4)
v_mfma_f32_16x16x32_bf16 v[48:51], v[8:11], v[176:179], v[48:51]
v_mfma_f32_16x16x32_bf16 v[56:59], v[8:11], v[180:183], v[56:59]
ds_read_b64_tr_b16 v[8:9], v0 offset:52512
ds_read_b64_tr_b16 v[10:11], v0 offset:53024
s_waitcnt lgkmcnt(4)
v_mfma_f32_16x16x32_bf16 v[52:55], v[12:15], v[176:179], v[52:55]
v_mfma_f32_16x16x32_bf16 v[60:63], v[12:15], v[180:183], v[60:63]
ds_read_b64_tr_b16 v[12:13], v0 offset:52544
ds_read_b64_tr_b16 v[14:15], v0 offset:53056
s_waitcnt lgkmcnt(4)
v_mfma_f32_16x16x32_bf16 v[208:211], v[4:7], v[176:179], v[208:211]
v_mfma_f32_16x16x32_bf16 v[216:219], v[4:7], v[180:183], v[216:219]
ds_read_b64_tr_b16 v[4:5], v0 offset:52576
ds_read_b64_tr_b16 v[6:7], v0 offset:53088
s_waitcnt lgkmcnt(4)
v_mfma_f32_16x16x32_bf16 v[212:215], v[8:11], v[176:179], v[212:215]
v_mfma_f32_16x16x32_bf16 v[220:223], v[8:11], v[180:183], v[220:223]
ds_read_b64_tr_b16 v[8:9], v0 offset:52608
ds_read_b64_tr_b16 v[10:11], v0 offset:53120
s_waitcnt lgkmcnt(4)
v_mfma_f32_16x16x32_bf16 v[224:227], v[12:15], v[176:179], v[224:227]
v_mfma_f32_16x16x32_bf16 v[232:235], v[12:15], v[180:183], v[232:235]
ds_read_b64_tr_b16 v[12:13], v0 offset:52640
ds_read_b64_tr_b16 v[14:15], v0 offset:53152
s_waitcnt lgkmcnt(4)
v_mfma_f32_16x16x32_bf16 v[228:231], v[4:7], v[176:179], v[228:231]
v_mfma_f32_16x16x32_bf16 v[236:239], v[4:7], v[180:183], v[236:239]
ds_read_b64_tr_b16 v[4:5], v0 offset:17472
ds_read_b64_tr_b16 v[6:7], v0 offset:17984
s_waitcnt lgkmcnt(4)
v_mfma_f32_16x16x32_bf16 v[240:243], v[8:11], v[176:179], v[240:243]
v_mfma_f32_16x16x32_bf16 v[248:251], v[8:11], v[180:183], v[248:251]
ds_read_b64_tr_b16 v[8:9], v0 offset:17504
ds_read_b64_tr_b16 v[10:11], v0 offset:18016
s_waitcnt lgkmcnt(4)
v_mfma_f32_16x16x32_bf16 v[244:247], v[12:15], v[176:179], v[244:247]
v_mfma_f32_16x16x32_bf16 v[252:255], v[12:15], v[180:183], v[252:255]
ds_read_b64_tr_b16 v[12:13], v0 offset:17536
ds_read_b64_tr_b16 v[14:15], v0 offset:18048
s_waitcnt lgkmcnt(4)
v_mfma_f32_16x16x32_bf16 v[48:51], v[4:7], v[184:187], v[48:51]
v_mfma_f32_16x16x32_bf16 v[56:59], v[4:7], v[188:191], v[56:59]
ds_read_b64_tr_b16 v[4:5], v0 offset:17568
ds_read_b64_tr_b16 v[6:7], v0 offset:18080
s_waitcnt lgkmcnt(4)
v_mfma_f32_16x16x32_bf16 v[52:55], v[8:11], v[184:187], v[52:55]
v_mfma_f32_16x16x32_bf16 v[60:63], v[8:11], v[188:191], v[60:63]
ds_read_b64_tr_b16 v[8:9], v0 offset:17600
ds_read_b64_tr_b16 v[10:11], v0 offset:18112
s_waitcnt lgkmcnt(4)
v_mfma_f32_16x16x32_bf16 v[208:211], v[12:15], v[184:187], v[208:211]
v_mfma_f32_16x16x32_bf16 v[216:219], v[12:15], v[188:191], v[216:219]
ds_read_b64_tr_b16 v[12:13], v0 offset:17632
ds_read_b64_tr_b16 v[14:15], v0 offset:18144
s_waitcnt lgkmcnt(4)
v_mfma_f32_16x16x32_bf16 v[212:215], v[4:7], v[184:187], v[212:215]
v_mfma_f32_16x16x32_bf16 v[220:223], v[4:7], v[188:191], v[220:223]
ds_read_b64_tr_b16 v[4:5], v0 offset:17664
ds_read_b64_tr_b16 v[6:7], v0 offset:18176
s_waitcnt lgkmcnt(4)
v_mfma_f32_16x16x32_bf16 v[224:227], v[8:11], v[184:187], v[224:227]
v_mfma_f32_16x16x32_bf16 v[232:235], v[8:11], v[188:191], v[232:235]
ds_read_b64_tr_b16 v[8:9], v0 offset:17696
ds_read_b64_tr_b16 v[10:11], v0 offset:18208
s_waitcnt lgkmcnt(4)
v_mfma_f32_16x16x32_bf16 v[228:231], v[12:15], v[184:187], v[228:231]
v_mfma_f32_16x16x32_bf16 v[236:239], v[12:15], v[188:191], v[236:239]
ds_read_b64_tr_b16 v[12:13], v0 offset:8736
ds_read_b64_tr_b16 v[14:15], v0 offset:9248
s_waitcnt lgkmcnt(4)
v_mfma_f32_16x16x32_bf16 v[240:243], v[4:7], v[184:187], v[240:243]
v_mfma_f32_16x16x32_bf16 v[248:251], v[4:7], v[188:191], v[248:251]
ds_read_b64_tr_b16 v[4:5], v0 offset:8768
ds_read_b64_tr_b16 v[6:7], v0 offset:9280
s_barrier
s_waitcnt lgkmcnt(4)
v_mfma_f32_16x16x32_bf16 v[244:247], v[8:11], v[184:187], v[244:247]
v_mfma_f32_16x16x32_bf16 v[252:255], v[8:11], v[188:191], v[252:255]
ds_read_b64_tr_b16 v[8:9], v0 offset:8800
ds_read_b64_tr_b16 v[10:11], v0 offset:9312
s_waitcnt lgkmcnt(4)
v_mfma_f32_16x16x32_bf16 v[48:51], v[12:15], v[192:195], v[48:51]
v_mfma_f32_16x16x32_bf16 v[56:59], v[12:15], v[196:199], v[56:59]
ds_read_b64_tr_b16 v[12:13], v0 offset:8832
ds_read_b64_tr_b16 v[14:15], v0 offset:9344
s_waitcnt lgkmcnt(4)
v_mfma_f32_16x16x32_bf16 v[52:55], v[4:7], v[192:195], v[52:55]
v_mfma_f32_16x16x32_bf16 v[60:63], v[4:7], v[196:199], v[60:63]
ds_read_b64_tr_b16 v[4:5], v0 offset:8864
ds_read_b64_tr_b16 v[6:7], v0 offset:9376
s_waitcnt lgkmcnt(4)
v_mfma_f32_16x16x32_bf16 v[208:211], v[8:11], v[192:195], v[208:211]
v_mfma_f32_16x16x32_bf16 v[216:219], v[8:11], v[196:199], v[216:219]
ds_read_b64_tr_b16 v[8:9], v0 offset:8896
ds_read_b64_tr_b16 v[10:11], v0 offset:9408
s_waitcnt lgkmcnt(4)
v_mfma_f32_16x16x32_bf16 v[212:215], v[12:15], v[192:195], v[212:215]
v_mfma_f32_16x16x32_bf16 v[220:223], v[12:15], v[196:199], v[220:223]
ds_read_b64_tr_b16 v[12:13], v0 offset:8928
ds_read_b64_tr_b16 v[14:15], v0 offset:9440
s_waitcnt lgkmcnt(4)
v_mfma_f32_16x16x32_bf16 v[224:227], v[4:7], v[192:195], v[224:227]
v_mfma_f32_16x16x32_bf16 v[232:235], v[4:7], v[196:199], v[232:235]
ds_read_b64_tr_b16 v[4:5], v0 offset:8960
ds_read_b64_tr_b16 v[6:7], v0 offset:9472
s_waitcnt lgkmcnt(4)
v_mfma_f32_16x16x32_bf16 v[228:231], v[8:11], v[192:195], v[228:231]
v_mfma_f32_16x16x32_bf16 v[236:239], v[8:11], v[196:199], v[236:239]
ds_read_b64_tr_b16 v[8:9], v0 offset:26208
ds_read_b64_tr_b16 v[10:11], v0 offset:26720
s_waitcnt lgkmcnt(4)
v_mfma_f32_16x16x32_bf16 v[240:243], v[12:15], v[192:195], v[240:243]
v_mfma_f32_16x16x32_bf16 v[248:251], v[12:15], v[196:199], v[248:251]
ds_read_b64_tr_b16 v[12:13], v0 offset:26240
ds_read_b64_tr_b16 v[14:15], v0 offset:26752
s_waitcnt lgkmcnt(4)
v_mfma_f32_16x16x32_bf16 v[244:247], v[4:7], v[192:195], v[244:247]
v_mfma_f32_16x16x32_bf16 v[252:255], v[4:7], v[196:199], v[252:255]
ds_read_b64_tr_b16 v[4:5], v0 offset:26272
ds_read_b64_tr_b16 v[6:7], v0 offset:26784
s_waitcnt lgkmcnt(4)
v_mfma_f32_16x16x32_bf16 v[48:51], v[8:11], v[200:203], v[48:51]
v_mfma_f32_16x16x32_bf16 v[56:59], v[8:11], v[204:207], v[56:59]
ds_read_b64_tr_b16 v[8:9], v0 offset:26304
ds_read_b64_tr_b16 v[10:11], v0 offset:26816
s_waitcnt lgkmcnt(4)
v_mfma_f32_16x16x32_bf16 v[52:55], v[12:15], v[200:203], v[52:55]
v_mfma_f32_16x16x32_bf16 v[60:63], v[12:15], v[204:207], v[60:63]
ds_read_b64_tr_b16 v[12:13], v0 offset:26336
ds_read_b64_tr_b16 v[14:15], v0 offset:26848
s_waitcnt lgkmcnt(4)
v_mfma_f32_16x16x32_bf16 v[208:211], v[4:7], v[200:203], v[208:211]
v_mfma_f32_16x16x32_bf16 v[216:219], v[4:7], v[204:207], v[216:219]
ds_read_b64_tr_b16 v[4:5], v0 offset:26368
ds_read_b64_tr_b16 v[6:7], v0 offset:26880
s_waitcnt lgkmcnt(4)
v_mfma_f32_16x16x32_bf16 v[212:215], v[8:11], v[200:203], v[212:215]
v_mfma_f32_16x16x32_bf16 v[220:223], v[8:11], v[204:207], v[220:223]
ds_read_b64_tr_b16 v[8:9], v0 offset:26400
ds_read_b64_tr_b16 v[10:11], v0 offset:26912
v_cvt_pk_bf16_f32 v16, v48, v49
v_cvt_pk_bf16_f32 v17, v50, v51
v_cvt_pk_bf16_f32 v18, v52, v53
v_cvt_pk_bf16_f32 v19, v54, v55
v_cvt_pk_bf16_f32 v20, v56, v57
v_cvt_pk_bf16_f32 v21, v58, v59
v_cvt_pk_bf16_f32 v22, v60, v61
v_cvt_pk_bf16_f32 v23, v62, v63
s_waitcnt lgkmcnt(4)
v_mfma_f32_16x16x32_bf16 v[224:227], v[12:15], v[200:203], v[224:227]
v_mfma_f32_16x16x32_bf16 v[232:235], v[12:15], v[204:207], v[232:235]
ds_read_b64_tr_b16 v[12:13], v0 offset:26432
ds_read_b64_tr_b16 v[14:15], v0 offset:26944
s_waitcnt lgkmcnt(4)
v_mfma_f32_16x16x32_bf16 v[228:231], v[4:7], v[200:203], v[228:231]
v_mfma_f32_16x16x32_bf16 v[236:239], v[4:7], v[204:207], v[236:239]
ds_read_b64_tr_b16 v[4:5], v0 offset:43680
ds_read_b64_tr_b16 v[6:7], v0 offset:44192
v_cvt_pk_bf16_f32 v24, v208, v209
v_cvt_pk_bf16_f32 v25, v210, v211
v_cvt_pk_bf16_f32 v26, v212, v213
v_cvt_pk_bf16_f32 v27, v214, v215
v_cvt_pk_bf16_f32 v28, v216, v217
v_cvt_pk_bf16_f32 v29, v218, v219
v_cvt_pk_bf16_f32 v30, v220, v221
v_cvt_pk_bf16_f32 v31, v222, v223
s_waitcnt lgkmcnt(4)
v_mfma_f32_16x16x32_bf16 v[240:243], v[8:11], v[200:203], v[240:243]
v_mfma_f32_16x16x32_bf16 v[248:251], v[8:11], v[204:207], v[248:251]
ds_read_b64_tr_b16 v[8:9], v0 offset:43712
ds_read_b64_tr_b16 v[10:11], v0 offset:44224
s_waitcnt lgkmcnt(4)
v_mfma_f32_16x16x32_bf16 v[244:247], v[12:15], v[200:203], v[244:247]
v_mfma_f32_16x16x32_bf16 v[252:255], v[12:15], v[204:207], v[252:255]
ds_read_b64_tr_b16 v[12:13], v0 offset:43744
ds_read_b64_tr_b16 v[14:15], v0 offset:44256
v_cvt_pk_bf16_f32 v32, v224, v225
v_cvt_pk_bf16_f32 v33, v226, v227
v_cvt_pk_bf16_f32 v34, v228, v229
v_cvt_pk_bf16_f32 v35, v230, v231
v_cvt_pk_bf16_f32 v36, v232, v233
v_cvt_pk_bf16_f32 v37, v234, v235
v_cvt_pk_bf16_f32 v38, v236, v237
v_cvt_pk_bf16_f32 v39, v238, v239
s_waitcnt lgkmcnt(4)
v_mfma_f32_16x16x32_bf16 v[48:51], v[4:7], v[64:67], 0
v_mfma_f32_16x16x32_bf16 v[56:59], v[4:7], v[68:71], 0
ds_read_b64_tr_b16 v[4:5], v0 offset:43776
ds_read_b64_tr_b16 v[6:7], v0 offset:44288
s_waitcnt lgkmcnt(4)
v_mfma_f32_16x16x32_bf16 v[52:55], v[8:11], v[64:67], 0
v_mfma_f32_16x16x32_bf16 v[60:63], v[8:11], v[68:71], 0
ds_read_b64_tr_b16 v[8:9], v0 offset:43808
ds_read_b64_tr_b16 v[10:11], v0 offset:44320
v_cvt_pk_bf16_f32 v40, v240, v241
v_cvt_pk_bf16_f32 v41, v242, v243
v_cvt_pk_bf16_f32 v42, v244, v245
v_cvt_pk_bf16_f32 v43, v246, v247
v_cvt_pk_bf16_f32 v44, v248, v249
v_cvt_pk_bf16_f32 v45, v250, v251
v_cvt_pk_bf16_f32 v46, v252, v253
v_cvt_pk_bf16_f32 v47, v254, v255
s_barrier
s_waitcnt lgkmcnt(4)
v_mfma_f32_16x16x32_bf16 v[208:211], v[12:15], v[64:67], 0
v_mfma_f32_16x16x32_bf16 v[216:219], v[12:15], v[68:71], 0
ds_read_b64_tr_b16 v[12:13], v0 offset:43840
ds_read_b64_tr_b16 v[14:15], v0 offset:44352
s_waitcnt lgkmcnt(4)
v_mfma_f32_16x16x32_bf16 v[212:215], v[4:7], v[64:67], 0
v_mfma_f32_16x16x32_bf16 v[220:223], v[4:7], v[68:71], 0
ds_read_b64_tr_b16 v[4:5], v0 offset:43872
ds_read_b64_tr_b16 v[6:7], v0 offset:44384
s_waitcnt lgkmcnt(4)
v_mfma_f32_16x16x32_bf16 v[224:227], v[8:11], v[64:67], 0
v_mfma_f32_16x16x32_bf16 v[232:235], v[8:11], v[68:71], 0
ds_read_b64_tr_b16 v[8:9], v0 offset:43904
ds_read_b64_tr_b16 v[10:11], v0 offset:44416
ds_write_b128 v1, v[16:19] offset:0
s_waitcnt lgkmcnt(5)
v_mfma_f32_16x16x32_bf16 v[228:231], v[12:15], v[64:67], 0
v_mfma_f32_16x16x32_bf16 v[236:239], v[12:15], v[68:71], 0
ds_read_b64_tr_b16 v[12:13], v0 offset:0
ds_read_b64_tr_b16 v[14:15], v0 offset:512
s_waitcnt lgkmcnt(5)
v_mfma_f32_16x16x32_bf16 v[240:243], v[4:7], v[64:67], 0
v_mfma_f32_16x16x32_bf16 v[248:251], v[4:7], v[68:71], 0
ds_read_b64_tr_b16 v[4:5], v0 offset:32
ds_read_b64_tr_b16 v[6:7], v0 offset:544
s_waitcnt lgkmcnt(5)
v_mfma_f32_16x16x32_bf16 v[244:247], v[8:11], v[64:67], 0
v_mfma_f32_16x16x32_bf16 v[252:255], v[8:11], v[68:71], 0
ds_read_b64_tr_b16 v[8:9], v0 offset:64
ds_read_b64_tr_b16 v[10:11], v0 offset:576
ds_write_b128 v1, v[20:23] offset:1024
s_waitcnt lgkmcnt(5)
v_mfma_f32_16x16x32_bf16 v[48:51], v[12:15], v[72:75], v[48:51]
v_mfma_f32_16x16x32_bf16 v[56:59], v[12:15], v[76:79], v[56:59]
ds_read_b64_tr_b16 v[12:13], v0 offset:96
ds_read_b64_tr_b16 v[14:15], v0 offset:608
s_waitcnt lgkmcnt(5)
v_mfma_f32_16x16x32_bf16 v[52:55], v[4:7], v[72:75], v[52:55]
v_mfma_f32_16x16x32_bf16 v[60:63], v[4:7], v[76:79], v[60:63]
ds_read_b64_tr_b16 v[4:5], v0 offset:128
ds_read_b64_tr_b16 v[6:7], v0 offset:640
s_waitcnt lgkmcnt(5)
v_mfma_f32_16x16x32_bf16 v[208:211], v[8:11], v[72:75], v[208:211]
v_mfma_f32_16x16x32_bf16 v[216:219], v[8:11], v[76:79], v[216:219]
ds_read_b64_tr_b16 v[8:9], v0 offset:160
ds_read_b64_tr_b16 v[10:11], v0 offset:672
ds_write_b128 v1, v[24:27] offset:6144
s_waitcnt lgkmcnt(5)
v_mfma_f32_16x16x32_bf16 v[212:215], v[12:15], v[72:75], v[212:215]
v_mfma_f32_16x16x32_bf16 v[220:223], v[12:15], v[76:79], v[220:223]
ds_read_b64_tr_b16 v[12:13], v0 offset:192
ds_read_b64_tr_b16 v[14:15], v0 offset:704
s_waitcnt lgkmcnt(5)
v_mfma_f32_16x16x32_bf16 v[224:227], v[4:7], v[72:75], v[224:227]
v_mfma_f32_16x16x32_bf16 v[232:235], v[4:7], v[76:79], v[232:235]
ds_read_b64_tr_b16 v[4:5], v0 offset:224
ds_read_b64_tr_b16 v[6:7], v0 offset:736
s_waitcnt lgkmcnt(5)
v_mfma_f32_16x16x32_bf16 v[228:231], v[8:11], v[72:75], v[228:231]
v_mfma_f32_16x16x32_bf16 v[236:239], v[8:11], v[76:79], v[236:239]
ds_read_b64_tr_b16 v[8:9], v3 offset:0
ds_read_b64_tr_b16 v[10:11], v3 offset:512
ds_write_b128 v1, v[28:31] offset:7168
s_waitcnt lgkmcnt(5)
v_mfma_f32_16x16x32_bf16 v[240:243], v[12:15], v[72:75], v[240:243]
v_mfma_f32_16x16x32_bf16 v[248:251], v[12:15], v[76:79], v[248:251]
ds_read_b64_tr_b16 v[12:13], v3 offset:32
ds_read_b64_tr_b16 v[14:15], v3 offset:544
s_waitcnt lgkmcnt(5)
v_mfma_f32_16x16x32_bf16 v[244:247], v[4:7], v[72:75], v[244:247]
v_mfma_f32_16x16x32_bf16 v[252:255], v[4:7], v[76:79], v[252:255]
ds_read_b64_tr_b16 v[4:5], v3 offset:64
ds_read_b64_tr_b16 v[6:7], v3 offset:576
s_waitcnt lgkmcnt(5)
v_mfma_f32_16x16x32_bf16 v[48:51], v[8:11], v[80:83], v[48:51]
v_mfma_f32_16x16x32_bf16 v[56:59], v[8:11], v[84:87], v[56:59]
ds_read_b64_tr_b16 v[8:9], v3 offset:96
ds_read_b64_tr_b16 v[10:11], v3 offset:608
s_waitcnt lgkmcnt(4)
v_mfma_f32_16x16x32_bf16 v[52:55], v[12:15], v[80:83], v[52:55]
v_mfma_f32_16x16x32_bf16 v[60:63], v[12:15], v[84:87], v[60:63]
ds_read_b64_tr_b16 v[12:13], v3 offset:128
ds_read_b64_tr_b16 v[14:15], v3 offset:640
s_waitcnt lgkmcnt(4)
v_mfma_f32_16x16x32_bf16 v[208:211], v[4:7], v[80:83], v[208:211]
v_mfma_f32_16x16x32_bf16 v[216:219], v[4:7], v[84:87], v[216:219]
ds_read_b64_tr_b16 v[4:5], v3 offset:160
ds_read_b64_tr_b16 v[6:7], v3 offset:672
s_waitcnt lgkmcnt(4)
v_mfma_f32_16x16x32_bf16 v[212:215], v[8:11], v[80:83], v[212:215]
v_mfma_f32_16x16x32_bf16 v[220:223], v[8:11], v[84:87], v[220:223]
ds_read_b64_tr_b16 v[8:9], v3 offset:192
ds_read_b64_tr_b16 v[10:11], v3 offset:704
s_waitcnt lgkmcnt(4)
v_mfma_f32_16x16x32_bf16 v[224:227], v[12:15], v[80:83], v[224:227]
v_mfma_f32_16x16x32_bf16 v[232:235], v[12:15], v[84:87], v[232:235]
ds_read_b64_tr_b16 v[12:13], v3 offset:224
ds_read_b64_tr_b16 v[14:15], v3 offset:736
s_waitcnt lgkmcnt(4)
v_mfma_f32_16x16x32_bf16 v[228:231], v[4:7], v[80:83], v[228:231]
v_mfma_f32_16x16x32_bf16 v[236:239], v[4:7], v[84:87], v[236:239]
ds_read_b64_tr_b16 v[4:5], v3 offset:8736
ds_read_b64_tr_b16 v[6:7], v3 offset:9248
s_waitcnt lgkmcnt(4)
v_mfma_f32_16x16x32_bf16 v[240:243], v[8:11], v[80:83], v[240:243]
v_mfma_f32_16x16x32_bf16 v[248:251], v[8:11], v[84:87], v[248:251]
ds_read_b64_tr_b16 v[8:9], v3 offset:8768
ds_read_b64_tr_b16 v[10:11], v3 offset:9280
s_waitcnt lgkmcnt(4)
v_mfma_f32_16x16x32_bf16 v[244:247], v[12:15], v[80:83], v[244:247]
v_mfma_f32_16x16x32_bf16 v[252:255], v[12:15], v[84:87], v[252:255]
ds_read_b64_tr_b16 v[12:13], v3 offset:8800
ds_read_b64_tr_b16 v[14:15], v3 offset:9312
s_waitcnt lgkmcnt(4)
v_mfma_f32_16x16x32_bf16 v[48:51], v[4:7], v[88:91], v[48:51]
v_mfma_f32_16x16x32_bf16 v[56:59], v[4:7], v[92:95], v[56:59]
ds_read_b64_tr_b16 v[4:5], v3 offset:8832
ds_read_b64_tr_b16 v[6:7], v3 offset:9344
s_barrier
s_waitcnt lgkmcnt(4)
v_mfma_f32_16x16x32_bf16 v[52:55], v[8:11], v[88:91], v[52:55]
v_mfma_f32_16x16x32_bf16 v[60:63], v[8:11], v[92:95], v[60:63]
ds_read_b64_tr_b16 v[8:9], v3 offset:8864
ds_read_b64_tr_b16 v[10:11], v3 offset:9376
s_waitcnt lgkmcnt(4)
v_mfma_f32_16x16x32_bf16 v[208:211], v[12:15], v[88:91], v[208:211]
v_mfma_f32_16x16x32_bf16 v[216:219], v[12:15], v[92:95], v[216:219]
ds_read_b64_tr_b16 v[12:13], v3 offset:8896
ds_read_b64_tr_b16 v[14:15], v3 offset:9408
s_waitcnt lgkmcnt(4)
v_mfma_f32_16x16x32_bf16 v[212:215], v[4:7], v[88:91], v[212:215]
v_mfma_f32_16x16x32_bf16 v[220:223], v[4:7], v[92:95], v[220:223]
ds_read_b64_tr_b16 v[4:5], v3 offset:8928
ds_read_b64_tr_b16 v[6:7], v3 offset:9440
s_waitcnt lgkmcnt(4)
v_mfma_f32_16x16x32_bf16 v[224:227], v[8:11], v[88:91], v[224:227]
v_mfma_f32_16x16x32_bf16 v[232:235], v[8:11], v[92:95], v[232:235]
ds_read_b64_tr_b16 v[8:9], v3 offset:8960
ds_read_b64_tr_b16 v[10:11], v3 offset:9472
s_waitcnt lgkmcnt(4)
v_mfma_f32_16x16x32_bf16 v[228:231], v[12:15], v[88:91], v[228:231]
v_mfma_f32_16x16x32_bf16 v[236:239], v[12:15], v[92:95], v[236:239]
ds_read_b64_tr_b16 v[12:13], v3 offset:17472
ds_read_b64_tr_b16 v[14:15], v3 offset:17984
s_waitcnt lgkmcnt(4)
v_mfma_f32_16x16x32_bf16 v[240:243], v[4:7], v[88:91], v[240:243]
v_mfma_f32_16x16x32_bf16 v[248:251], v[4:7], v[92:95], v[248:251]
ds_read_b64_tr_b16 v[4:5], v3 offset:17504
ds_read_b64_tr_b16 v[6:7], v3 offset:18016
s_waitcnt lgkmcnt(4)
v_mfma_f32_16x16x32_bf16 v[244:247], v[8:11], v[88:91], v[244:247]
v_mfma_f32_16x16x32_bf16 v[252:255], v[8:11], v[92:95], v[252:255]
ds_read_b64_tr_b16 v[8:9], v3 offset:17536
ds_read_b64_tr_b16 v[10:11], v3 offset:18048
s_waitcnt lgkmcnt(4)
v_mfma_f32_16x16x32_bf16 v[48:51], v[12:15], v[96:99], v[48:51]
v_mfma_f32_16x16x32_bf16 v[56:59], v[12:15], v[100:103], v[56:59]
ds_read_b64_tr_b16 v[12:13], v3 offset:17568
ds_read_b64_tr_b16 v[14:15], v3 offset:18080
s_waitcnt lgkmcnt(4)
v_mfma_f32_16x16x32_bf16 v[52:55], v[4:7], v[96:99], v[52:55]
v_mfma_f32_16x16x32_bf16 v[60:63], v[4:7], v[100:103], v[60:63]
ds_read_b64_tr_b16 v[4:5], v3 offset:17600
ds_read_b64_tr_b16 v[6:7], v3 offset:18112
s_waitcnt lgkmcnt(4)
v_mfma_f32_16x16x32_bf16 v[208:211], v[8:11], v[96:99], v[208:211]
v_mfma_f32_16x16x32_bf16 v[216:219], v[8:11], v[100:103], v[216:219]
ds_read_b64_tr_b16 v[8:9], v3 offset:17632
ds_read_b64_tr_b16 v[10:11], v3 offset:18144
s_waitcnt lgkmcnt(4)
v_mfma_f32_16x16x32_bf16 v[212:215], v[12:15], v[96:99], v[212:215]
v_mfma_f32_16x16x32_bf16 v[220:223], v[12:15], v[100:103], v[220:223]
ds_read_b64_tr_b16 v[12:13], v3 offset:17664
ds_read_b64_tr_b16 v[14:15], v3 offset:18176
s_waitcnt lgkmcnt(4)
v_mfma_f32_16x16x32_bf16 v[224:227], v[4:7], v[96:99], v[224:227]
v_mfma_f32_16x16x32_bf16 v[232:235], v[4:7], v[100:103], v[232:235]
ds_read_b64_tr_b16 v[4:5], v3 offset:17696
ds_read_b64_tr_b16 v[6:7], v3 offset:18208
s_waitcnt lgkmcnt(4)
v_mfma_f32_16x16x32_bf16 v[228:231], v[8:11], v[96:99], v[228:231]
v_mfma_f32_16x16x32_bf16 v[236:239], v[8:11], v[100:103], v[236:239]
ds_read_b64_tr_b16 v[8:9], v0 offset:34944
ds_read_b64_tr_b16 v[10:11], v0 offset:35456
s_waitcnt lgkmcnt(4)
v_mfma_f32_16x16x32_bf16 v[240:243], v[12:15], v[96:99], v[240:243]
v_mfma_f32_16x16x32_bf16 v[248:251], v[12:15], v[100:103], v[248:251]
ds_read_b64_tr_b16 v[12:13], v0 offset:34976
ds_read_b64_tr_b16 v[14:15], v0 offset:35488
s_waitcnt lgkmcnt(4)
v_mfma_f32_16x16x32_bf16 v[244:247], v[4:7], v[96:99], v[244:247]
v_mfma_f32_16x16x32_bf16 v[252:255], v[4:7], v[100:103], v[252:255]
ds_read_b64_tr_b16 v[4:5], v0 offset:35008
ds_read_b64_tr_b16 v[6:7], v0 offset:35520
s_waitcnt lgkmcnt(4)
v_mfma_f32_16x16x32_bf16 v[48:51], v[8:11], v[104:107], v[48:51]
v_mfma_f32_16x16x32_bf16 v[56:59], v[8:11], v[108:111], v[56:59]
ds_read_b64_tr_b16 v[8:9], v0 offset:35040
ds_read_b64_tr_b16 v[10:11], v0 offset:35552
s_waitcnt lgkmcnt(4)
v_mfma_f32_16x16x32_bf16 v[52:55], v[12:15], v[104:107], v[52:55]
v_mfma_f32_16x16x32_bf16 v[60:63], v[12:15], v[108:111], v[60:63]
ds_read_b64_tr_b16 v[12:13], v0 offset:35072
ds_read_b64_tr_b16 v[14:15], v0 offset:35584
s_barrier
s_waitcnt lgkmcnt(4)
v_mfma_f32_16x16x32_bf16 v[208:211], v[4:7], v[104:107], v[208:211]
v_mfma_f32_16x16x32_bf16 v[216:219], v[4:7], v[108:111], v[216:219]
ds_read_b64_tr_b16 v[4:5], v0 offset:35104
ds_read_b64_tr_b16 v[6:7], v0 offset:35616
s_waitcnt lgkmcnt(4)
v_mfma_f32_16x16x32_bf16 v[212:215], v[8:11], v[104:107], v[212:215]
v_mfma_f32_16x16x32_bf16 v[220:223], v[8:11], v[108:111], v[220:223]
ds_read_b64_tr_b16 v[8:9], v0 offset:35136
ds_read_b64_tr_b16 v[10:11], v0 offset:35648
s_waitcnt lgkmcnt(4)
v_mfma_f32_16x16x32_bf16 v[224:227], v[12:15], v[104:107], v[224:227]
v_mfma_f32_16x16x32_bf16 v[232:235], v[12:15], v[108:111], v[232:235]
ds_read_b64_tr_b16 v[12:13], v0 offset:35168
ds_read_b64_tr_b16 v[14:15], v0 offset:35680
s_waitcnt lgkmcnt(4)
v_mfma_f32_16x16x32_bf16 v[228:231], v[4:7], v[104:107], v[228:231]
v_mfma_f32_16x16x32_bf16 v[236:239], v[4:7], v[108:111], v[236:239]
ds_read_b64_tr_b16 v[4:5], v0 offset:52416
ds_read_b64_tr_b16 v[6:7], v0 offset:52928
ds_write_b128 v1, v[32:35] offset:12288
s_waitcnt lgkmcnt(5)
v_mfma_f32_16x16x32_bf16 v[240:243], v[8:11], v[104:107], v[240:243]
v_mfma_f32_16x16x32_bf16 v[248:251], v[8:11], v[108:111], v[248:251]
ds_read_b64_tr_b16 v[8:9], v0 offset:52448
ds_read_b64_tr_b16 v[10:11], v0 offset:52960
s_waitcnt lgkmcnt(5)
v_mfma_f32_16x16x32_bf16 v[244:247], v[12:15], v[104:107], v[244:247]
v_mfma_f32_16x16x32_bf16 v[252:255], v[12:15], v[108:111], v[252:255]
ds_read_b64_tr_b16 v[12:13], v0 offset:52480
ds_read_b64_tr_b16 v[14:15], v0 offset:52992
s_waitcnt lgkmcnt(5)
v_mfma_f32_16x16x32_bf16 v[48:51], v[4:7], v[112:115], v[48:51]
v_mfma_f32_16x16x32_bf16 v[56:59], v[4:7], v[116:119], v[56:59]
ds_read_b64_tr_b16 v[4:5], v0 offset:52512
ds_read_b64_tr_b16 v[6:7], v0 offset:53024
ds_write_b128 v1, v[36:39] offset:13312
s_waitcnt lgkmcnt(5)
v_mfma_f32_16x16x32_bf16 v[52:55], v[8:11], v[112:115], v[52:55]
v_mfma_f32_16x16x32_bf16 v[60:63], v[8:11], v[116:119], v[60:63]
ds_read_b64_tr_b16 v[8:9], v0 offset:52544
ds_read_b64_tr_b16 v[10:11], v0 offset:53056
s_waitcnt lgkmcnt(5)
v_mfma_f32_16x16x32_bf16 v[208:211], v[12:15], v[112:115], v[208:211]
v_mfma_f32_16x16x32_bf16 v[216:219], v[12:15], v[116:119], v[216:219]
ds_read_b64_tr_b16 v[12:13], v0 offset:52576
ds_read_b64_tr_b16 v[14:15], v0 offset:53088
s_waitcnt lgkmcnt(5)
v_mfma_f32_16x16x32_bf16 v[212:215], v[4:7], v[112:115], v[212:215]
v_mfma_f32_16x16x32_bf16 v[220:223], v[4:7], v[116:119], v[220:223]
ds_read_b64_tr_b16 v[4:5], v0 offset:52608
ds_read_b64_tr_b16 v[6:7], v0 offset:53120
ds_write_b128 v1, v[40:43] offset:18432
s_waitcnt lgkmcnt(5)
v_mfma_f32_16x16x32_bf16 v[224:227], v[8:11], v[112:115], v[224:227]
v_mfma_f32_16x16x32_bf16 v[232:235], v[8:11], v[116:119], v[232:235]
ds_read_b64_tr_b16 v[8:9], v0 offset:52640
ds_read_b64_tr_b16 v[10:11], v0 offset:53152
s_waitcnt lgkmcnt(5)
v_mfma_f32_16x16x32_bf16 v[228:231], v[12:15], v[112:115], v[228:231]
v_mfma_f32_16x16x32_bf16 v[236:239], v[12:15], v[116:119], v[236:239]
ds_read_b64_tr_b16 v[12:13], v0 offset:8736
ds_read_b64_tr_b16 v[14:15], v0 offset:9248
s_waitcnt lgkmcnt(5)
v_mfma_f32_16x16x32_bf16 v[240:243], v[4:7], v[112:115], v[240:243]
v_mfma_f32_16x16x32_bf16 v[248:251], v[4:7], v[116:119], v[248:251]
ds_read_b64_tr_b16 v[4:5], v0 offset:8768
ds_read_b64_tr_b16 v[6:7], v0 offset:9280
ds_write_b128 v1, v[44:47] offset:19456
s_waitcnt lgkmcnt(5)
v_mfma_f32_16x16x32_bf16 v[244:247], v[8:11], v[112:115], v[244:247]
v_mfma_f32_16x16x32_bf16 v[252:255], v[8:11], v[116:119], v[252:255]
ds_read_b64_tr_b16 v[8:9], v0 offset:8800
ds_read_b64_tr_b16 v[10:11], v0 offset:9312
s_waitcnt lgkmcnt(5)
v_mfma_f32_16x16x32_bf16 v[48:51], v[12:15], v[120:123], v[48:51]
v_mfma_f32_16x16x32_bf16 v[56:59], v[12:15], v[124:127], v[56:59]
ds_read_b64_tr_b16 v[12:13], v0 offset:8832
ds_read_b64_tr_b16 v[14:15], v0 offset:9344
s_waitcnt lgkmcnt(5)
v_mfma_f32_16x16x32_bf16 v[52:55], v[4:7], v[120:123], v[52:55]
v_mfma_f32_16x16x32_bf16 v[60:63], v[4:7], v[124:127], v[60:63]
ds_read_b64_tr_b16 v[4:5], v0 offset:8864
ds_read_b64_tr_b16 v[6:7], v0 offset:9376
s_waitcnt lgkmcnt(4)
v_mfma_f32_16x16x32_bf16 v[208:211], v[8:11], v[120:123], v[208:211]
v_mfma_f32_16x16x32_bf16 v[216:219], v[8:11], v[124:127], v[216:219]
ds_read_b64_tr_b16 v[8:9], v0 offset:8896
ds_read_b64_tr_b16 v[10:11], v0 offset:9408
s_waitcnt lgkmcnt(4)
v_mfma_f32_16x16x32_bf16 v[212:215], v[12:15], v[120:123], v[212:215]
v_mfma_f32_16x16x32_bf16 v[220:223], v[12:15], v[124:127], v[220:223]
ds_read_b64_tr_b16 v[12:13], v0 offset:8928
ds_read_b64_tr_b16 v[14:15], v0 offset:9440
s_waitcnt lgkmcnt(4)
v_mfma_f32_16x16x32_bf16 v[224:227], v[4:7], v[120:123], v[224:227]
v_mfma_f32_16x16x32_bf16 v[232:235], v[4:7], v[124:127], v[232:235]
ds_read_b64_tr_b16 v[4:5], v0 offset:8960
ds_read_b64_tr_b16 v[6:7], v0 offset:9472
s_waitcnt lgkmcnt(4)
v_mfma_f32_16x16x32_bf16 v[228:231], v[8:11], v[120:123], v[228:231]
v_mfma_f32_16x16x32_bf16 v[236:239], v[8:11], v[124:127], v[236:239]
ds_read_b64_tr_b16 v[8:9], v0 offset:17472
ds_read_b64_tr_b16 v[10:11], v0 offset:17984
s_waitcnt lgkmcnt(4)
v_mfma_f32_16x16x32_bf16 v[240:243], v[12:15], v[120:123], v[240:243]
v_mfma_f32_16x16x32_bf16 v[248:251], v[12:15], v[124:127], v[248:251]
ds_read_b64_tr_b16 v[12:13], v0 offset:17504
ds_read_b64_tr_b16 v[14:15], v0 offset:18016
s_waitcnt lgkmcnt(4)
v_mfma_f32_16x16x32_bf16 v[244:247], v[4:7], v[120:123], v[244:247]
v_mfma_f32_16x16x32_bf16 v[252:255], v[4:7], v[124:127], v[252:255]
ds_read_b64_tr_b16 v[4:5], v0 offset:17536
ds_read_b64_tr_b16 v[6:7], v0 offset:18048
s_waitcnt lgkmcnt(4)
v_mfma_f32_16x16x32_bf16 v[48:51], v[8:11], v[128:131], v[48:51]
v_mfma_f32_16x16x32_bf16 v[56:59], v[8:11], v[132:135], v[56:59]
ds_read_b64_tr_b16 v[8:9], v0 offset:17568
ds_read_b64_tr_b16 v[10:11], v0 offset:18080
s_barrier
s_waitcnt lgkmcnt(4)
v_mfma_f32_16x16x32_bf16 v[52:55], v[12:15], v[128:131], v[52:55]
v_mfma_f32_16x16x32_bf16 v[60:63], v[12:15], v[132:135], v[60:63]
ds_read_b64_tr_b16 v[12:13], v0 offset:17600
ds_read_b64_tr_b16 v[14:15], v0 offset:18112
s_waitcnt lgkmcnt(4)
v_mfma_f32_16x16x32_bf16 v[208:211], v[4:7], v[128:131], v[208:211]
v_mfma_f32_16x16x32_bf16 v[216:219], v[4:7], v[132:135], v[216:219]
ds_read_b64_tr_b16 v[4:5], v0 offset:17632
ds_read_b64_tr_b16 v[6:7], v0 offset:18144
s_waitcnt lgkmcnt(4)
v_mfma_f32_16x16x32_bf16 v[212:215], v[8:11], v[128:131], v[212:215]
v_mfma_f32_16x16x32_bf16 v[220:223], v[8:11], v[132:135], v[220:223]
ds_read_b64_tr_b16 v[8:9], v0 offset:17664
ds_read_b64_tr_b16 v[10:11], v0 offset:18176
s_waitcnt lgkmcnt(4)
v_mfma_f32_16x16x32_bf16 v[224:227], v[12:15], v[128:131], v[224:227]
v_mfma_f32_16x16x32_bf16 v[232:235], v[12:15], v[132:135], v[232:235]
ds_read_b64_tr_b16 v[12:13], v0 offset:17696
ds_read_b64_tr_b16 v[14:15], v0 offset:18208
s_waitcnt lgkmcnt(4)
v_mfma_f32_16x16x32_bf16 v[228:231], v[4:7], v[128:131], v[228:231]
v_mfma_f32_16x16x32_bf16 v[236:239], v[4:7], v[132:135], v[236:239]
ds_read_b64_tr_b16 v[4:5], v0 offset:26208
ds_read_b64_tr_b16 v[6:7], v0 offset:26720
s_waitcnt lgkmcnt(4)
v_mfma_f32_16x16x32_bf16 v[240:243], v[8:11], v[128:131], v[240:243]
v_mfma_f32_16x16x32_bf16 v[248:251], v[8:11], v[132:135], v[248:251]
ds_read_b64_tr_b16 v[8:9], v0 offset:26240
ds_read_b64_tr_b16 v[10:11], v0 offset:26752
s_waitcnt lgkmcnt(4)
v_mfma_f32_16x16x32_bf16 v[244:247], v[12:15], v[128:131], v[244:247]
v_mfma_f32_16x16x32_bf16 v[252:255], v[12:15], v[132:135], v[252:255]
ds_read_b64_tr_b16 v[12:13], v0 offset:26272
ds_read_b64_tr_b16 v[14:15], v0 offset:26784
s_waitcnt lgkmcnt(4)
v_mfma_f32_16x16x32_bf16 v[48:51], v[4:7], v[136:139], v[48:51]
v_mfma_f32_16x16x32_bf16 v[56:59], v[4:7], v[140:143], v[56:59]
ds_read_b64_tr_b16 v[4:5], v0 offset:26304
ds_read_b64_tr_b16 v[6:7], v0 offset:26816
s_waitcnt lgkmcnt(4)
v_mfma_f32_16x16x32_bf16 v[52:55], v[8:11], v[136:139], v[52:55]
v_mfma_f32_16x16x32_bf16 v[60:63], v[8:11], v[140:143], v[60:63]
ds_read_b64_tr_b16 v[8:9], v0 offset:26336
ds_read_b64_tr_b16 v[10:11], v0 offset:26848
s_waitcnt lgkmcnt(4)
v_mfma_f32_16x16x32_bf16 v[208:211], v[12:15], v[136:139], v[208:211]
v_mfma_f32_16x16x32_bf16 v[216:219], v[12:15], v[140:143], v[216:219]
ds_read_b64_tr_b16 v[12:13], v0 offset:26368
ds_read_b64_tr_b16 v[14:15], v0 offset:26880
s_waitcnt lgkmcnt(4)
v_mfma_f32_16x16x32_bf16 v[212:215], v[4:7], v[136:139], v[212:215]
v_mfma_f32_16x16x32_bf16 v[220:223], v[4:7], v[140:143], v[220:223]
ds_read_b64_tr_b16 v[4:5], v0 offset:26400
ds_read_b64_tr_b16 v[6:7], v0 offset:26912
s_waitcnt lgkmcnt(4)
v_mfma_f32_16x16x32_bf16 v[224:227], v[8:11], v[136:139], v[224:227]
v_mfma_f32_16x16x32_bf16 v[232:235], v[8:11], v[140:143], v[232:235]
ds_read_b64_tr_b16 v[8:9], v0 offset:26432
ds_read_b64_tr_b16 v[10:11], v0 offset:26944
s_waitcnt lgkmcnt(4)
v_mfma_f32_16x16x32_bf16 v[228:231], v[12:15], v[136:139], v[228:231]
v_mfma_f32_16x16x32_bf16 v[236:239], v[12:15], v[140:143], v[236:239]
ds_read_b64_tr_b16 v[12:13], v0 offset:43680
ds_read_b64_tr_b16 v[14:15], v0 offset:44192
s_waitcnt lgkmcnt(4)
v_mfma_f32_16x16x32_bf16 v[240:243], v[4:7], v[136:139], v[240:243]
v_mfma_f32_16x16x32_bf16 v[248:251], v[4:7], v[140:143], v[248:251]
ds_read_b64_tr_b16 v[4:5], v0 offset:43712
ds_read_b64_tr_b16 v[6:7], v0 offset:44224
s_waitcnt lgkmcnt(4)
v_mfma_f32_16x16x32_bf16 v[244:247], v[8:11], v[136:139], v[244:247]
v_mfma_f32_16x16x32_bf16 v[252:255], v[8:11], v[140:143], v[252:255]
ds_read_b64_tr_b16 v[8:9], v0 offset:43744
ds_read_b64_tr_b16 v[10:11], v0 offset:44256
s_waitcnt lgkmcnt(4)
v_mfma_f32_16x16x32_bf16 v[48:51], v[12:15], v[144:147], v[48:51]
v_mfma_f32_16x16x32_bf16 v[56:59], v[12:15], v[148:151], v[56:59]
ds_read_b64_tr_b16 v[12:13], v0 offset:43776
ds_read_b64_tr_b16 v[14:15], v0 offset:44288
s_barrier
s_waitcnt lgkmcnt(4)
v_mfma_f32_16x16x32_bf16 v[52:55], v[4:7], v[144:147], v[52:55]
v_mfma_f32_16x16x32_bf16 v[60:63], v[4:7], v[148:151], v[60:63]
ds_read_b64_tr_b16 v[4:5], v0 offset:43808
ds_read_b64_tr_b16 v[6:7], v0 offset:44320
s_waitcnt lgkmcnt(4)
v_mfma_f32_16x16x32_bf16 v[208:211], v[8:11], v[144:147], v[208:211]
v_mfma_f32_16x16x32_bf16 v[216:219], v[8:11], v[148:151], v[216:219]
ds_read_b64_tr_b16 v[8:9], v0 offset:43840
ds_read_b64_tr_b16 v[10:11], v0 offset:44352
s_waitcnt lgkmcnt(4)
v_mfma_f32_16x16x32_bf16 v[212:215], v[12:15], v[144:147], v[212:215]
v_mfma_f32_16x16x32_bf16 v[220:223], v[12:15], v[148:151], v[220:223]
ds_read_b64_tr_b16 v[12:13], v0 offset:43872
ds_read_b64_tr_b16 v[14:15], v0 offset:44384
s_waitcnt lgkmcnt(4)
v_mfma_f32_16x16x32_bf16 v[224:227], v[4:7], v[144:147], v[224:227]
v_mfma_f32_16x16x32_bf16 v[232:235], v[4:7], v[148:151], v[232:235]
ds_read_b64_tr_b16 v[4:5], v0 offset:43904
ds_read_b64_tr_b16 v[6:7], v0 offset:44416
s_waitcnt lgkmcnt(4)
v_mfma_f32_16x16x32_bf16 v[228:231], v[8:11], v[144:147], v[228:231]
v_mfma_f32_16x16x32_bf16 v[236:239], v[8:11], v[148:151], v[236:239]
ds_read_b64_tr_b16 v[8:9], v0 offset:0
ds_read_b64_tr_b16 v[10:11], v0 offset:512
s_waitcnt lgkmcnt(4)
v_mfma_f32_16x16x32_bf16 v[240:243], v[12:15], v[144:147], v[240:243]
v_mfma_f32_16x16x32_bf16 v[248:251], v[12:15], v[148:151], v[248:251]
ds_read_b64_tr_b16 v[12:13], v0 offset:32
ds_read_b64_tr_b16 v[14:15], v0 offset:544
s_waitcnt lgkmcnt(4)
v_mfma_f32_16x16x32_bf16 v[244:247], v[4:7], v[144:147], v[244:247]
v_mfma_f32_16x16x32_bf16 v[252:255], v[4:7], v[148:151], v[252:255]
ds_read_b64_tr_b16 v[4:5], v0 offset:64
ds_read_b64_tr_b16 v[6:7], v0 offset:576
s_waitcnt lgkmcnt(4)
v_mfma_f32_16x16x32_bf16 v[48:51], v[8:11], v[152:155], v[48:51]
v_mfma_f32_16x16x32_bf16 v[56:59], v[8:11], v[156:159], v[56:59]
ds_read_b64_tr_b16 v[8:9], v0 offset:96
ds_read_b64_tr_b16 v[10:11], v0 offset:608
s_waitcnt lgkmcnt(4)
v_mfma_f32_16x16x32_bf16 v[52:55], v[12:15], v[152:155], v[52:55]
v_mfma_f32_16x16x32_bf16 v[60:63], v[12:15], v[156:159], v[60:63]
ds_read_b64_tr_b16 v[12:13], v0 offset:128
ds_read_b64_tr_b16 v[14:15], v0 offset:640
s_waitcnt lgkmcnt(4)
v_mfma_f32_16x16x32_bf16 v[208:211], v[4:7], v[152:155], v[208:211]
v_mfma_f32_16x16x32_bf16 v[216:219], v[4:7], v[156:159], v[216:219]
ds_read_b64_tr_b16 v[4:5], v0 offset:160
ds_read_b64_tr_b16 v[6:7], v0 offset:672
s_waitcnt lgkmcnt(4)
v_mfma_f32_16x16x32_bf16 v[212:215], v[8:11], v[152:155], v[212:215]
v_mfma_f32_16x16x32_bf16 v[220:223], v[8:11], v[156:159], v[220:223]
ds_read_b64_tr_b16 v[8:9], v0 offset:192
ds_read_b64_tr_b16 v[10:11], v0 offset:704
s_waitcnt lgkmcnt(4)
v_mfma_f32_16x16x32_bf16 v[224:227], v[12:15], v[152:155], v[224:227]
v_mfma_f32_16x16x32_bf16 v[232:235], v[12:15], v[156:159], v[232:235]
ds_read_b64_tr_b16 v[12:13], v0 offset:224
ds_read_b64_tr_b16 v[14:15], v0 offset:736
s_waitcnt lgkmcnt(4)
v_mfma_f32_16x16x32_bf16 v[228:231], v[4:7], v[152:155], v[228:231]
v_mfma_f32_16x16x32_bf16 v[236:239], v[4:7], v[156:159], v[236:239]
ds_read_b64_tr_b16 v[4:5], v3 offset:0
ds_read_b64_tr_b16 v[6:7], v3 offset:512
s_waitcnt lgkmcnt(4)
v_mfma_f32_16x16x32_bf16 v[240:243], v[8:11], v[152:155], v[240:243]
v_mfma_f32_16x16x32_bf16 v[248:251], v[8:11], v[156:159], v[248:251]
ds_read_b64_tr_b16 v[8:9], v3 offset:32
ds_read_b64_tr_b16 v[10:11], v3 offset:544
s_waitcnt lgkmcnt(4)
v_mfma_f32_16x16x32_bf16 v[244:247], v[12:15], v[152:155], v[244:247]
v_mfma_f32_16x16x32_bf16 v[252:255], v[12:15], v[156:159], v[252:255]
ds_read_b64_tr_b16 v[12:13], v3 offset:64
ds_read_b64_tr_b16 v[14:15], v3 offset:576
s_waitcnt lgkmcnt(4)
v_mfma_f32_16x16x32_bf16 v[48:51], v[4:7], v[160:163], v[48:51]
v_mfma_f32_16x16x32_bf16 v[56:59], v[4:7], v[164:167], v[56:59]
ds_read_b64_tr_b16 v[4:5], v3 offset:96
ds_read_b64_tr_b16 v[6:7], v3 offset:608
s_waitcnt lgkmcnt(4)
v_mfma_f32_16x16x32_bf16 v[52:55], v[8:11], v[160:163], v[52:55]
v_mfma_f32_16x16x32_bf16 v[60:63], v[8:11], v[164:167], v[60:63]
ds_read_b64_tr_b16 v[8:9], v3 offset:128
ds_read_b64_tr_b16 v[10:11], v3 offset:640
s_waitcnt lgkmcnt(4)
v_mfma_f32_16x16x32_bf16 v[208:211], v[12:15], v[160:163], v[208:211]
v_mfma_f32_16x16x32_bf16 v[216:219], v[12:15], v[164:167], v[216:219]
ds_read_b64_tr_b16 v[12:13], v3 offset:160
ds_read_b64_tr_b16 v[14:15], v3 offset:672
s_waitcnt lgkmcnt(4)
v_mfma_f32_16x16x32_bf16 v[212:215], v[4:7], v[160:163], v[212:215]
v_mfma_f32_16x16x32_bf16 v[220:223], v[4:7], v[164:167], v[220:223]
ds_read_b64_tr_b16 v[4:5], v3 offset:192
ds_read_b64_tr_b16 v[6:7], v3 offset:704
s_waitcnt lgkmcnt(4)
v_mfma_f32_16x16x32_bf16 v[224:227], v[8:11], v[160:163], v[224:227]
v_mfma_f32_16x16x32_bf16 v[232:235], v[8:11], v[164:167], v[232:235]
ds_read_b64_tr_b16 v[8:9], v3 offset:224
ds_read_b64_tr_b16 v[10:11], v3 offset:736
s_waitcnt lgkmcnt(4)
v_mfma_f32_16x16x32_bf16 v[228:231], v[12:15], v[160:163], v[228:231]
v_mfma_f32_16x16x32_bf16 v[236:239], v[12:15], v[164:167], v[236:239]
ds_read_b64_tr_b16 v[12:13], v3 offset:8736
ds_read_b64_tr_b16 v[14:15], v3 offset:9248
s_waitcnt lgkmcnt(4)
v_mfma_f32_16x16x32_bf16 v[240:243], v[4:7], v[160:163], v[240:243]
v_mfma_f32_16x16x32_bf16 v[248:251], v[4:7], v[164:167], v[248:251]
ds_read_b64_tr_b16 v[4:5], v3 offset:8768
ds_read_b64_tr_b16 v[6:7], v3 offset:9280
s_waitcnt lgkmcnt(4)
v_mfma_f32_16x16x32_bf16 v[244:247], v[8:11], v[160:163], v[244:247]
v_mfma_f32_16x16x32_bf16 v[252:255], v[8:11], v[164:167], v[252:255]
ds_read_b64_tr_b16 v[8:9], v3 offset:8800
ds_read_b64_tr_b16 v[10:11], v3 offset:9312
s_barrier
s_waitcnt lgkmcnt(4)
v_mfma_f32_16x16x32_bf16 v[48:51], v[12:15], v[168:171], v[48:51]
v_mfma_f32_16x16x32_bf16 v[56:59], v[12:15], v[172:175], v[56:59]
ds_read_b64_tr_b16 v[12:13], v3 offset:8832
ds_read_b64_tr_b16 v[14:15], v3 offset:9344
s_waitcnt lgkmcnt(4)
v_mfma_f32_16x16x32_bf16 v[52:55], v[4:7], v[168:171], v[52:55]
v_mfma_f32_16x16x32_bf16 v[60:63], v[4:7], v[172:175], v[60:63]
ds_read_b64_tr_b16 v[4:5], v3 offset:8864
ds_read_b64_tr_b16 v[6:7], v3 offset:9376
s_waitcnt lgkmcnt(4)
v_mfma_f32_16x16x32_bf16 v[208:211], v[8:11], v[168:171], v[208:211]
v_mfma_f32_16x16x32_bf16 v[216:219], v[8:11], v[172:175], v[216:219]
ds_read_b64_tr_b16 v[8:9], v3 offset:8896
ds_read_b64_tr_b16 v[10:11], v3 offset:9408
s_waitcnt lgkmcnt(4)
v_mfma_f32_16x16x32_bf16 v[212:215], v[12:15], v[168:171], v[212:215]
v_mfma_f32_16x16x32_bf16 v[220:223], v[12:15], v[172:175], v[220:223]
ds_read_b64_tr_b16 v[12:13], v3 offset:8928
ds_read_b64_tr_b16 v[14:15], v3 offset:9440
s_waitcnt lgkmcnt(4)
v_mfma_f32_16x16x32_bf16 v[224:227], v[4:7], v[168:171], v[224:227]
v_mfma_f32_16x16x32_bf16 v[232:235], v[4:7], v[172:175], v[232:235]
ds_read_b64_tr_b16 v[4:5], v3 offset:8960
ds_read_b64_tr_b16 v[6:7], v3 offset:9472
s_waitcnt lgkmcnt(4)
v_mfma_f32_16x16x32_bf16 v[228:231], v[8:11], v[168:171], v[228:231]
v_mfma_f32_16x16x32_bf16 v[236:239], v[8:11], v[172:175], v[236:239]
ds_read_b64_tr_b16 v[8:9], v3 offset:17472
ds_read_b64_tr_b16 v[10:11], v3 offset:17984
s_waitcnt lgkmcnt(4)
v_mfma_f32_16x16x32_bf16 v[240:243], v[12:15], v[168:171], v[240:243]
v_mfma_f32_16x16x32_bf16 v[248:251], v[12:15], v[172:175], v[248:251]
ds_read_b64_tr_b16 v[12:13], v3 offset:17504
ds_read_b64_tr_b16 v[14:15], v3 offset:18016
s_waitcnt lgkmcnt(4)
v_mfma_f32_16x16x32_bf16 v[244:247], v[4:7], v[168:171], v[244:247]
v_mfma_f32_16x16x32_bf16 v[252:255], v[4:7], v[172:175], v[252:255]
ds_read_b64_tr_b16 v[4:5], v3 offset:17536
ds_read_b64_tr_b16 v[6:7], v3 offset:18048
s_waitcnt lgkmcnt(4)
v_mfma_f32_16x16x32_bf16 v[48:51], v[8:11], v[176:179], v[48:51]
v_mfma_f32_16x16x32_bf16 v[56:59], v[8:11], v[180:183], v[56:59]
ds_read_b64_tr_b16 v[8:9], v3 offset:17568
ds_read_b64_tr_b16 v[10:11], v3 offset:18080
s_waitcnt lgkmcnt(4)
v_mfma_f32_16x16x32_bf16 v[52:55], v[12:15], v[176:179], v[52:55]
v_mfma_f32_16x16x32_bf16 v[60:63], v[12:15], v[180:183], v[60:63]
ds_read_b64_tr_b16 v[12:13], v3 offset:17600
ds_read_b64_tr_b16 v[14:15], v3 offset:18112
s_waitcnt lgkmcnt(4)
v_mfma_f32_16x16x32_bf16 v[208:211], v[4:7], v[176:179], v[208:211]
v_mfma_f32_16x16x32_bf16 v[216:219], v[4:7], v[180:183], v[216:219]
ds_read_b64_tr_b16 v[4:5], v3 offset:17632
ds_read_b64_tr_b16 v[6:7], v3 offset:18144
s_waitcnt lgkmcnt(4)
v_mfma_f32_16x16x32_bf16 v[212:215], v[8:11], v[176:179], v[212:215]
v_mfma_f32_16x16x32_bf16 v[220:223], v[8:11], v[180:183], v[220:223]
ds_read_b64_tr_b16 v[8:9], v3 offset:17664
ds_read_b64_tr_b16 v[10:11], v3 offset:18176
s_waitcnt lgkmcnt(4)
v_mfma_f32_16x16x32_bf16 v[224:227], v[12:15], v[176:179], v[224:227]
v_mfma_f32_16x16x32_bf16 v[232:235], v[12:15], v[180:183], v[232:235]
ds_read_b64_tr_b16 v[12:13], v3 offset:17696
ds_read_b64_tr_b16 v[14:15], v3 offset:18208
s_waitcnt lgkmcnt(4)
v_mfma_f32_16x16x32_bf16 v[228:231], v[4:7], v[176:179], v[228:231]
v_mfma_f32_16x16x32_bf16 v[236:239], v[4:7], v[180:183], v[236:239]
ds_read_b64_tr_b16 v[4:5], v0 offset:34944
ds_read_b64_tr_b16 v[6:7], v0 offset:35456
s_waitcnt lgkmcnt(4)
v_mfma_f32_16x16x32_bf16 v[240:243], v[8:11], v[176:179], v[240:243]
v_mfma_f32_16x16x32_bf16 v[248:251], v[8:11], v[180:183], v[248:251]
ds_read_b64_tr_b16 v[8:9], v0 offset:34976
ds_read_b64_tr_b16 v[10:11], v0 offset:35488
s_waitcnt lgkmcnt(4)
v_mfma_f32_16x16x32_bf16 v[244:247], v[12:15], v[176:179], v[244:247]
v_mfma_f32_16x16x32_bf16 v[252:255], v[12:15], v[180:183], v[252:255]
ds_read_b64_tr_b16 v[12:13], v0 offset:35008
ds_read_b64_tr_b16 v[14:15], v0 offset:35520
s_waitcnt lgkmcnt(4)
v_mfma_f32_16x16x32_bf16 v[48:51], v[4:7], v[184:187], v[48:51]
v_mfma_f32_16x16x32_bf16 v[56:59], v[4:7], v[188:191], v[56:59]
ds_read_b64_tr_b16 v[4:5], v0 offset:35040
ds_read_b64_tr_b16 v[6:7], v0 offset:35552
s_waitcnt lgkmcnt(4)
v_mfma_f32_16x16x32_bf16 v[52:55], v[8:11], v[184:187], v[52:55]
v_mfma_f32_16x16x32_bf16 v[60:63], v[8:11], v[188:191], v[60:63]
ds_read_b64_tr_b16 v[8:9], v0 offset:35072
ds_read_b64_tr_b16 v[10:11], v0 offset:35584
s_waitcnt lgkmcnt(4)
v_mfma_f32_16x16x32_bf16 v[208:211], v[12:15], v[184:187], v[208:211]
v_mfma_f32_16x16x32_bf16 v[216:219], v[12:15], v[188:191], v[216:219]
ds_read_b64_tr_b16 v[12:13], v0 offset:35104
ds_read_b64_tr_b16 v[14:15], v0 offset:35616
s_waitcnt lgkmcnt(4)
v_mfma_f32_16x16x32_bf16 v[212:215], v[4:7], v[184:187], v[212:215]
v_mfma_f32_16x16x32_bf16 v[220:223], v[4:7], v[188:191], v[220:223]
ds_read_b64_tr_b16 v[4:5], v0 offset:35136
ds_read_b64_tr_b16 v[6:7], v0 offset:35648
s_waitcnt lgkmcnt(4)
v_mfma_f32_16x16x32_bf16 v[224:227], v[8:11], v[184:187], v[224:227]
v_mfma_f32_16x16x32_bf16 v[232:235], v[8:11], v[188:191], v[232:235]
ds_read_b64_tr_b16 v[8:9], v0 offset:35168
ds_read_b64_tr_b16 v[10:11], v0 offset:35680
s_waitcnt lgkmcnt(4)
v_mfma_f32_16x16x32_bf16 v[228:231], v[12:15], v[184:187], v[228:231]
v_mfma_f32_16x16x32_bf16 v[236:239], v[12:15], v[188:191], v[236:239]
ds_read_b64_tr_b16 v[12:13], v0 offset:52416
ds_read_b64_tr_b16 v[14:15], v0 offset:52928
s_waitcnt lgkmcnt(4)
v_mfma_f32_16x16x32_bf16 v[240:243], v[4:7], v[184:187], v[240:243]
v_mfma_f32_16x16x32_bf16 v[248:251], v[4:7], v[188:191], v[248:251]
ds_read_b64_tr_b16 v[4:5], v0 offset:52448
ds_read_b64_tr_b16 v[6:7], v0 offset:52960
s_barrier
s_waitcnt lgkmcnt(4)
v_mfma_f32_16x16x32_bf16 v[244:247], v[8:11], v[184:187], v[244:247]
v_mfma_f32_16x16x32_bf16 v[252:255], v[8:11], v[188:191], v[252:255]
ds_read_b64_tr_b16 v[8:9], v0 offset:52480
ds_read_b64_tr_b16 v[10:11], v0 offset:52992
s_waitcnt lgkmcnt(4)
v_mfma_f32_16x16x32_bf16 v[48:51], v[12:15], v[192:195], v[48:51]
v_mfma_f32_16x16x32_bf16 v[56:59], v[12:15], v[196:199], v[56:59]
ds_read_b64_tr_b16 v[12:13], v0 offset:52512
ds_read_b64_tr_b16 v[14:15], v0 offset:53024
s_waitcnt lgkmcnt(4)
v_mfma_f32_16x16x32_bf16 v[52:55], v[4:7], v[192:195], v[52:55]
v_mfma_f32_16x16x32_bf16 v[60:63], v[4:7], v[196:199], v[60:63]
ds_read_b64_tr_b16 v[4:5], v0 offset:52544
ds_read_b64_tr_b16 v[6:7], v0 offset:53056
s_waitcnt lgkmcnt(4)
v_mfma_f32_16x16x32_bf16 v[208:211], v[8:11], v[192:195], v[208:211]
v_mfma_f32_16x16x32_bf16 v[216:219], v[8:11], v[196:199], v[216:219]
ds_read_b64_tr_b16 v[8:9], v0 offset:52576
ds_read_b64_tr_b16 v[10:11], v0 offset:53088
s_waitcnt lgkmcnt(4)
v_mfma_f32_16x16x32_bf16 v[212:215], v[12:15], v[192:195], v[212:215]
v_mfma_f32_16x16x32_bf16 v[220:223], v[12:15], v[196:199], v[220:223]
ds_read_b64_tr_b16 v[12:13], v0 offset:52608
ds_read_b64_tr_b16 v[14:15], v0 offset:53120
s_waitcnt lgkmcnt(4)
v_mfma_f32_16x16x32_bf16 v[224:227], v[4:7], v[192:195], v[224:227]
v_mfma_f32_16x16x32_bf16 v[232:235], v[4:7], v[196:199], v[232:235]
ds_read_b64_tr_b16 v[4:5], v0 offset:52640
ds_read_b64_tr_b16 v[6:7], v0 offset:53152
s_waitcnt lgkmcnt(4)
v_mfma_f32_16x16x32_bf16 v[228:231], v[8:11], v[192:195], v[228:231]
v_mfma_f32_16x16x32_bf16 v[236:239], v[8:11], v[196:199], v[236:239]
ds_read_b64_tr_b16 v[8:9], v0 offset:8736
ds_read_b64_tr_b16 v[10:11], v0 offset:9248
s_waitcnt lgkmcnt(4)
v_mfma_f32_16x16x32_bf16 v[240:243], v[12:15], v[192:195], v[240:243]
v_mfma_f32_16x16x32_bf16 v[248:251], v[12:15], v[196:199], v[248:251]
ds_read_b64_tr_b16 v[12:13], v0 offset:8768
ds_read_b64_tr_b16 v[14:15], v0 offset:9280
s_waitcnt lgkmcnt(4)
v_mfma_f32_16x16x32_bf16 v[244:247], v[4:7], v[192:195], v[244:247]
v_mfma_f32_16x16x32_bf16 v[252:255], v[4:7], v[196:199], v[252:255]
ds_read_b64_tr_b16 v[4:5], v0 offset:8800
ds_read_b64_tr_b16 v[6:7], v0 offset:9312
s_waitcnt lgkmcnt(4)
v_mfma_f32_16x16x32_bf16 v[48:51], v[8:11], v[200:203], v[48:51]
v_mfma_f32_16x16x32_bf16 v[56:59], v[8:11], v[204:207], v[56:59]
ds_read_b64_tr_b16 v[8:9], v0 offset:8832
ds_read_b64_tr_b16 v[10:11], v0 offset:9344
s_waitcnt lgkmcnt(4)
v_mfma_f32_16x16x32_bf16 v[52:55], v[12:15], v[200:203], v[52:55]
v_mfma_f32_16x16x32_bf16 v[60:63], v[12:15], v[204:207], v[60:63]
ds_read_b64_tr_b16 v[12:13], v0 offset:8864
ds_read_b64_tr_b16 v[14:15], v0 offset:9376
s_waitcnt lgkmcnt(4)
v_mfma_f32_16x16x32_bf16 v[208:211], v[4:7], v[200:203], v[208:211]
v_mfma_f32_16x16x32_bf16 v[216:219], v[4:7], v[204:207], v[216:219]
ds_read_b64_tr_b16 v[4:5], v0 offset:8896
ds_read_b64_tr_b16 v[6:7], v0 offset:9408
s_waitcnt lgkmcnt(4)
v_mfma_f32_16x16x32_bf16 v[212:215], v[8:11], v[200:203], v[212:215]
v_mfma_f32_16x16x32_bf16 v[220:223], v[8:11], v[204:207], v[220:223]
ds_read_b64_tr_b16 v[8:9], v0 offset:8928
ds_read_b64_tr_b16 v[10:11], v0 offset:9440
v_cvt_pk_bf16_f32 v16, v48, v49
v_cvt_pk_bf16_f32 v17, v50, v51
v_cvt_pk_bf16_f32 v18, v52, v53
v_cvt_pk_bf16_f32 v19, v54, v55
v_cvt_pk_bf16_f32 v20, v56, v57
v_cvt_pk_bf16_f32 v21, v58, v59
v_cvt_pk_bf16_f32 v22, v60, v61
v_cvt_pk_bf16_f32 v23, v62, v63
s_waitcnt lgkmcnt(4)
v_mfma_f32_16x16x32_bf16 v[224:227], v[12:15], v[200:203], v[224:227]
v_mfma_f32_16x16x32_bf16 v[232:235], v[12:15], v[204:207], v[232:235]
ds_read_b64_tr_b16 v[12:13], v0 offset:8960
ds_read_b64_tr_b16 v[14:15], v0 offset:9472
s_waitcnt lgkmcnt(4)
v_mfma_f32_16x16x32_bf16 v[228:231], v[4:7], v[200:203], v[228:231]
v_mfma_f32_16x16x32_bf16 v[236:239], v[4:7], v[204:207], v[236:239]
ds_read_b64_tr_b16 v[4:5], v0 offset:17472
ds_read_b64_tr_b16 v[6:7], v0 offset:17984
v_cvt_pk_bf16_f32 v24, v208, v209
v_cvt_pk_bf16_f32 v25, v210, v211
v_cvt_pk_bf16_f32 v26, v212, v213
v_cvt_pk_bf16_f32 v27, v214, v215
v_cvt_pk_bf16_f32 v28, v216, v217
v_cvt_pk_bf16_f32 v29, v218, v219
v_cvt_pk_bf16_f32 v30, v220, v221
v_cvt_pk_bf16_f32 v31, v222, v223
s_waitcnt lgkmcnt(4)
v_mfma_f32_16x16x32_bf16 v[240:243], v[8:11], v[200:203], v[240:243]
v_mfma_f32_16x16x32_bf16 v[248:251], v[8:11], v[204:207], v[248:251]
ds_read_b64_tr_b16 v[8:9], v0 offset:17504
ds_read_b64_tr_b16 v[10:11], v0 offset:18016
s_waitcnt lgkmcnt(4)
v_mfma_f32_16x16x32_bf16 v[244:247], v[12:15], v[200:203], v[244:247]
v_mfma_f32_16x16x32_bf16 v[252:255], v[12:15], v[204:207], v[252:255]
ds_read_b64_tr_b16 v[12:13], v0 offset:17536
ds_read_b64_tr_b16 v[14:15], v0 offset:18048
v_cvt_pk_bf16_f32 v32, v224, v225
v_cvt_pk_bf16_f32 v33, v226, v227
v_cvt_pk_bf16_f32 v34, v228, v229
v_cvt_pk_bf16_f32 v35, v230, v231
v_cvt_pk_bf16_f32 v36, v232, v233
v_cvt_pk_bf16_f32 v37, v234, v235
v_cvt_pk_bf16_f32 v38, v236, v237
v_cvt_pk_bf16_f32 v39, v238, v239
s_waitcnt lgkmcnt(4)
v_mfma_f32_16x16x32_bf16 v[48:51], v[4:7], v[64:67], 0
v_mfma_f32_16x16x32_bf16 v[56:59], v[4:7], v[68:71], 0
ds_read_b64_tr_b16 v[4:5], v0 offset:17568
ds_read_b64_tr_b16 v[6:7], v0 offset:18080
s_waitcnt lgkmcnt(4)
v_mfma_f32_16x16x32_bf16 v[52:55], v[8:11], v[64:67], 0
v_mfma_f32_16x16x32_bf16 v[60:63], v[8:11], v[68:71], 0
ds_read_b64_tr_b16 v[8:9], v0 offset:17600
ds_read_b64_tr_b16 v[10:11], v0 offset:18112
v_cvt_pk_bf16_f32 v40, v240, v241
v_cvt_pk_bf16_f32 v41, v242, v243
v_cvt_pk_bf16_f32 v42, v244, v245
v_cvt_pk_bf16_f32 v43, v246, v247
v_cvt_pk_bf16_f32 v44, v248, v249
v_cvt_pk_bf16_f32 v45, v250, v251
v_cvt_pk_bf16_f32 v46, v252, v253
v_cvt_pk_bf16_f32 v47, v254, v255
s_barrier
s_waitcnt lgkmcnt(4)
v_mfma_f32_16x16x32_bf16 v[208:211], v[12:15], v[64:67], 0
v_mfma_f32_16x16x32_bf16 v[216:219], v[12:15], v[68:71], 0
ds_read_b64_tr_b16 v[12:13], v0 offset:17632
ds_read_b64_tr_b16 v[14:15], v0 offset:18144
s_waitcnt lgkmcnt(4)
v_mfma_f32_16x16x32_bf16 v[212:215], v[4:7], v[64:67], 0
v_mfma_f32_16x16x32_bf16 v[220:223], v[4:7], v[68:71], 0
ds_read_b64_tr_b16 v[4:5], v0 offset:17664
ds_read_b64_tr_b16 v[6:7], v0 offset:18176
s_waitcnt lgkmcnt(4)
v_mfma_f32_16x16x32_bf16 v[224:227], v[8:11], v[64:67], 0
v_mfma_f32_16x16x32_bf16 v[232:235], v[8:11], v[68:71], 0
ds_read_b64_tr_b16 v[8:9], v0 offset:17696
ds_read_b64_tr_b16 v[10:11], v0 offset:18208
ds_write_b128 v1, v[16:19] offset:0
s_waitcnt lgkmcnt(5)
v_mfma_f32_16x16x32_bf16 v[228:231], v[12:15], v[64:67], 0
v_mfma_f32_16x16x32_bf16 v[236:239], v[12:15], v[68:71], 0
ds_read_b64_tr_b16 v[12:13], v0 offset:26208
ds_read_b64_tr_b16 v[14:15], v0 offset:26720
s_waitcnt lgkmcnt(5)
v_mfma_f32_16x16x32_bf16 v[240:243], v[4:7], v[64:67], 0
v_mfma_f32_16x16x32_bf16 v[248:251], v[4:7], v[68:71], 0
ds_read_b64_tr_b16 v[4:5], v0 offset:26240
ds_read_b64_tr_b16 v[6:7], v0 offset:26752
s_waitcnt lgkmcnt(5)
v_mfma_f32_16x16x32_bf16 v[244:247], v[8:11], v[64:67], 0
v_mfma_f32_16x16x32_bf16 v[252:255], v[8:11], v[68:71], 0
ds_read_b64_tr_b16 v[8:9], v0 offset:26272
ds_read_b64_tr_b16 v[10:11], v0 offset:26784
ds_write_b128 v1, v[20:23] offset:1024
s_waitcnt lgkmcnt(5)
v_mfma_f32_16x16x32_bf16 v[48:51], v[12:15], v[72:75], v[48:51]
v_mfma_f32_16x16x32_bf16 v[56:59], v[12:15], v[76:79], v[56:59]
ds_read_b64_tr_b16 v[12:13], v0 offset:26304
ds_read_b64_tr_b16 v[14:15], v0 offset:26816
s_waitcnt lgkmcnt(5)
v_mfma_f32_16x16x32_bf16 v[52:55], v[4:7], v[72:75], v[52:55]
v_mfma_f32_16x16x32_bf16 v[60:63], v[4:7], v[76:79], v[60:63]
ds_read_b64_tr_b16 v[4:5], v0 offset:26336
ds_read_b64_tr_b16 v[6:7], v0 offset:26848
s_waitcnt lgkmcnt(5)
v_mfma_f32_16x16x32_bf16 v[208:211], v[8:11], v[72:75], v[208:211]
v_mfma_f32_16x16x32_bf16 v[216:219], v[8:11], v[76:79], v[216:219]
ds_read_b64_tr_b16 v[8:9], v0 offset:26368
ds_read_b64_tr_b16 v[10:11], v0 offset:26880
ds_write_b128 v1, v[24:27] offset:6144
s_waitcnt lgkmcnt(5)
v_mfma_f32_16x16x32_bf16 v[212:215], v[12:15], v[72:75], v[212:215]
v_mfma_f32_16x16x32_bf16 v[220:223], v[12:15], v[76:79], v[220:223]
ds_read_b64_tr_b16 v[12:13], v0 offset:26400
ds_read_b64_tr_b16 v[14:15], v0 offset:26912
s_waitcnt lgkmcnt(5)
v_mfma_f32_16x16x32_bf16 v[224:227], v[4:7], v[72:75], v[224:227]
v_mfma_f32_16x16x32_bf16 v[232:235], v[4:7], v[76:79], v[232:235]
ds_read_b64_tr_b16 v[4:5], v0 offset:26432
ds_read_b64_tr_b16 v[6:7], v0 offset:26944
s_waitcnt lgkmcnt(5)
v_mfma_f32_16x16x32_bf16 v[228:231], v[8:11], v[72:75], v[228:231]
v_mfma_f32_16x16x32_bf16 v[236:239], v[8:11], v[76:79], v[236:239]
ds_read_b64_tr_b16 v[8:9], v0 offset:43680
ds_read_b64_tr_b16 v[10:11], v0 offset:44192
ds_write_b128 v1, v[28:31] offset:7168
s_waitcnt lgkmcnt(5)
v_mfma_f32_16x16x32_bf16 v[240:243], v[12:15], v[72:75], v[240:243]
v_mfma_f32_16x16x32_bf16 v[248:251], v[12:15], v[76:79], v[248:251]
ds_read_b64_tr_b16 v[12:13], v0 offset:43712
ds_read_b64_tr_b16 v[14:15], v0 offset:44224
s_waitcnt lgkmcnt(5)
v_mfma_f32_16x16x32_bf16 v[244:247], v[4:7], v[72:75], v[244:247]
v_mfma_f32_16x16x32_bf16 v[252:255], v[4:7], v[76:79], v[252:255]
ds_read_b64_tr_b16 v[4:5], v0 offset:43744
ds_read_b64_tr_b16 v[6:7], v0 offset:44256
s_waitcnt lgkmcnt(5)
v_mfma_f32_16x16x32_bf16 v[48:51], v[8:11], v[80:83], v[48:51]
v_mfma_f32_16x16x32_bf16 v[56:59], v[8:11], v[84:87], v[56:59]
ds_read_b64_tr_b16 v[8:9], v0 offset:43776
ds_read_b64_tr_b16 v[10:11], v0 offset:44288
s_waitcnt lgkmcnt(4)
v_mfma_f32_16x16x32_bf16 v[52:55], v[12:15], v[80:83], v[52:55]
v_mfma_f32_16x16x32_bf16 v[60:63], v[12:15], v[84:87], v[60:63]
ds_read_b64_tr_b16 v[12:13], v0 offset:43808
ds_read_b64_tr_b16 v[14:15], v0 offset:44320
s_waitcnt lgkmcnt(4)
v_mfma_f32_16x16x32_bf16 v[208:211], v[4:7], v[80:83], v[208:211]
v_mfma_f32_16x16x32_bf16 v[216:219], v[4:7], v[84:87], v[216:219]
ds_read_b64_tr_b16 v[4:5], v0 offset:43840
ds_read_b64_tr_b16 v[6:7], v0 offset:44352
s_barrier
s_waitcnt lgkmcnt(4)
v_mfma_f32_16x16x32_bf16 v[212:215], v[8:11], v[80:83], v[212:215]
v_mfma_f32_16x16x32_bf16 v[220:223], v[8:11], v[84:87], v[220:223]
ds_read_b64_tr_b16 v[8:9], v0 offset:43872
ds_read_b64_tr_b16 v[10:11], v0 offset:44384
s_waitcnt lgkmcnt(4)
v_mfma_f32_16x16x32_bf16 v[224:227], v[12:15], v[80:83], v[224:227]
v_mfma_f32_16x16x32_bf16 v[232:235], v[12:15], v[84:87], v[232:235]
ds_read_b64_tr_b16 v[12:13], v0 offset:43904
ds_read_b64_tr_b16 v[14:15], v0 offset:44416
s_waitcnt lgkmcnt(4)
v_mfma_f32_16x16x32_bf16 v[228:231], v[4:7], v[80:83], v[228:231]
v_mfma_f32_16x16x32_bf16 v[236:239], v[4:7], v[84:87], v[236:239]
ds_read_b64_tr_b16 v[4:5], v0 offset:0
ds_read_b64_tr_b16 v[6:7], v0 offset:512
s_waitcnt lgkmcnt(4)
v_mfma_f32_16x16x32_bf16 v[240:243], v[8:11], v[80:83], v[240:243]
v_mfma_f32_16x16x32_bf16 v[248:251], v[8:11], v[84:87], v[248:251]
ds_read_b64_tr_b16 v[8:9], v0 offset:32
ds_read_b64_tr_b16 v[10:11], v0 offset:544
ds_write_b128 v1, v[32:35] offset:12288
s_waitcnt lgkmcnt(5)
v_mfma_f32_16x16x32_bf16 v[244:247], v[12:15], v[80:83], v[244:247]
v_mfma_f32_16x16x32_bf16 v[252:255], v[12:15], v[84:87], v[252:255]
ds_read_b64_tr_b16 v[12:13], v0 offset:64
ds_read_b64_tr_b16 v[14:15], v0 offset:576
s_waitcnt lgkmcnt(5)
v_mfma_f32_16x16x32_bf16 v[48:51], v[4:7], v[88:91], v[48:51]
v_mfma_f32_16x16x32_bf16 v[56:59], v[4:7], v[92:95], v[56:59]
ds_read_b64_tr_b16 v[4:5], v0 offset:96
ds_read_b64_tr_b16 v[6:7], v0 offset:608
s_waitcnt lgkmcnt(5)
v_mfma_f32_16x16x32_bf16 v[52:55], v[8:11], v[88:91], v[52:55]
v_mfma_f32_16x16x32_bf16 v[60:63], v[8:11], v[92:95], v[60:63]
ds_read_b64_tr_b16 v[8:9], v0 offset:128
ds_read_b64_tr_b16 v[10:11], v0 offset:640
ds_write_b128 v1, v[36:39] offset:13312
s_waitcnt lgkmcnt(5)
v_mfma_f32_16x16x32_bf16 v[208:211], v[12:15], v[88:91], v[208:211]
v_mfma_f32_16x16x32_bf16 v[216:219], v[12:15], v[92:95], v[216:219]
ds_read_b64_tr_b16 v[12:13], v0 offset:160
ds_read_b64_tr_b16 v[14:15], v0 offset:672
s_waitcnt lgkmcnt(5)
v_mfma_f32_16x16x32_bf16 v[212:215], v[4:7], v[88:91], v[212:215]
v_mfma_f32_16x16x32_bf16 v[220:223], v[4:7], v[92:95], v[220:223]
ds_read_b64_tr_b16 v[4:5], v0 offset:192
ds_read_b64_tr_b16 v[6:7], v0 offset:704
s_waitcnt lgkmcnt(5)
v_mfma_f32_16x16x32_bf16 v[224:227], v[8:11], v[88:91], v[224:227]
v_mfma_f32_16x16x32_bf16 v[232:235], v[8:11], v[92:95], v[232:235]
ds_read_b64_tr_b16 v[8:9], v0 offset:224
ds_read_b64_tr_b16 v[10:11], v0 offset:736
ds_write_b128 v1, v[40:43] offset:18432
s_waitcnt lgkmcnt(5)
v_mfma_f32_16x16x32_bf16 v[228:231], v[12:15], v[88:91], v[228:231]
v_mfma_f32_16x16x32_bf16 v[236:239], v[12:15], v[92:95], v[236:239]
ds_read_b64_tr_b16 v[12:13], v3 offset:0
ds_read_b64_tr_b16 v[14:15], v3 offset:512
s_waitcnt lgkmcnt(5)
v_mfma_f32_16x16x32_bf16 v[240:243], v[4:7], v[88:91], v[240:243]
v_mfma_f32_16x16x32_bf16 v[248:251], v[4:7], v[92:95], v[248:251]
ds_read_b64_tr_b16 v[4:5], v3 offset:32
ds_read_b64_tr_b16 v[6:7], v3 offset:544
s_waitcnt lgkmcnt(5)
v_mfma_f32_16x16x32_bf16 v[244:247], v[8:11], v[88:91], v[244:247]
v_mfma_f32_16x16x32_bf16 v[252:255], v[8:11], v[92:95], v[252:255]
ds_read_b64_tr_b16 v[8:9], v3 offset:64
ds_read_b64_tr_b16 v[10:11], v3 offset:576
ds_write_b128 v1, v[44:47] offset:19456
s_waitcnt lgkmcnt(5)
v_mfma_f32_16x16x32_bf16 v[48:51], v[12:15], v[96:99], v[48:51]
v_mfma_f32_16x16x32_bf16 v[56:59], v[12:15], v[100:103], v[56:59]
ds_read_b64_tr_b16 v[12:13], v3 offset:96
ds_read_b64_tr_b16 v[14:15], v3 offset:608
s_waitcnt lgkmcnt(5)
v_mfma_f32_16x16x32_bf16 v[52:55], v[4:7], v[96:99], v[52:55]
v_mfma_f32_16x16x32_bf16 v[60:63], v[4:7], v[100:103], v[60:63]
ds_read_b64_tr_b16 v[4:5], v3 offset:128
ds_read_b64_tr_b16 v[6:7], v3 offset:640
s_waitcnt lgkmcnt(5)
v_mfma_f32_16x16x32_bf16 v[208:211], v[8:11], v[96:99], v[208:211]
v_mfma_f32_16x16x32_bf16 v[216:219], v[8:11], v[100:103], v[216:219]
ds_read_b64_tr_b16 v[8:9], v3 offset:160
ds_read_b64_tr_b16 v[10:11], v3 offset:672
s_waitcnt lgkmcnt(4)
v_mfma_f32_16x16x32_bf16 v[212:215], v[12:15], v[96:99], v[212:215]
v_mfma_f32_16x16x32_bf16 v[220:223], v[12:15], v[100:103], v[220:223]
ds_read_b64_tr_b16 v[12:13], v3 offset:192
ds_read_b64_tr_b16 v[14:15], v3 offset:704
s_barrier
s_waitcnt lgkmcnt(4)
v_mfma_f32_16x16x32_bf16 v[224:227], v[4:7], v[96:99], v[224:227]
v_mfma_f32_16x16x32_bf16 v[232:235], v[4:7], v[100:103], v[232:235]
ds_read_b64_tr_b16 v[4:5], v3 offset:224
ds_read_b64_tr_b16 v[6:7], v3 offset:736
s_waitcnt lgkmcnt(4)
v_mfma_f32_16x16x32_bf16 v[228:231], v[8:11], v[96:99], v[228:231]
v_mfma_f32_16x16x32_bf16 v[236:239], v[8:11], v[100:103], v[236:239]
ds_read_b64_tr_b16 v[8:9], v3 offset:8736
ds_read_b64_tr_b16 v[10:11], v3 offset:9248
s_waitcnt lgkmcnt(4)
v_mfma_f32_16x16x32_bf16 v[240:243], v[12:15], v[96:99], v[240:243]
v_mfma_f32_16x16x32_bf16 v[248:251], v[12:15], v[100:103], v[248:251]
ds_read_b64_tr_b16 v[12:13], v3 offset:8768
ds_read_b64_tr_b16 v[14:15], v3 offset:9280
s_waitcnt lgkmcnt(4)
v_mfma_f32_16x16x32_bf16 v[244:247], v[4:7], v[96:99], v[244:247]
v_mfma_f32_16x16x32_bf16 v[252:255], v[4:7], v[100:103], v[252:255]
ds_read_b64_tr_b16 v[4:5], v3 offset:8800
ds_read_b64_tr_b16 v[6:7], v3 offset:9312
s_waitcnt lgkmcnt(4)
v_mfma_f32_16x16x32_bf16 v[48:51], v[8:11], v[104:107], v[48:51]
v_mfma_f32_16x16x32_bf16 v[56:59], v[8:11], v[108:111], v[56:59]
ds_read_b64_tr_b16 v[8:9], v3 offset:8832
ds_read_b64_tr_b16 v[10:11], v3 offset:9344
s_waitcnt lgkmcnt(4)
v_mfma_f32_16x16x32_bf16 v[52:55], v[12:15], v[104:107], v[52:55]
v_mfma_f32_16x16x32_bf16 v[60:63], v[12:15], v[108:111], v[60:63]
ds_read_b64_tr_b16 v[12:13], v3 offset:8864
ds_read_b64_tr_b16 v[14:15], v3 offset:9376
s_waitcnt lgkmcnt(4)
v_mfma_f32_16x16x32_bf16 v[208:211], v[4:7], v[104:107], v[208:211]
v_mfma_f32_16x16x32_bf16 v[216:219], v[4:7], v[108:111], v[216:219]
ds_read_b64_tr_b16 v[4:5], v3 offset:8896
ds_read_b64_tr_b16 v[6:7], v3 offset:9408
s_waitcnt lgkmcnt(4)
v_mfma_f32_16x16x32_bf16 v[212:215], v[8:11], v[104:107], v[212:215]
v_mfma_f32_16x16x32_bf16 v[220:223], v[8:11], v[108:111], v[220:223]
ds_read_b64_tr_b16 v[8:9], v3 offset:8928
ds_read_b64_tr_b16 v[10:11], v3 offset:9440
s_waitcnt lgkmcnt(4)
v_mfma_f32_16x16x32_bf16 v[224:227], v[12:15], v[104:107], v[224:227]
v_mfma_f32_16x16x32_bf16 v[232:235], v[12:15], v[108:111], v[232:235]
ds_read_b64_tr_b16 v[12:13], v3 offset:8960
ds_read_b64_tr_b16 v[14:15], v3 offset:9472
s_waitcnt lgkmcnt(4)
v_mfma_f32_16x16x32_bf16 v[228:231], v[4:7], v[104:107], v[228:231]
v_mfma_f32_16x16x32_bf16 v[236:239], v[4:7], v[108:111], v[236:239]
ds_read_b64_tr_b16 v[4:5], v3 offset:17472
ds_read_b64_tr_b16 v[6:7], v3 offset:17984
s_waitcnt lgkmcnt(4)
v_mfma_f32_16x16x32_bf16 v[240:243], v[8:11], v[104:107], v[240:243]
v_mfma_f32_16x16x32_bf16 v[248:251], v[8:11], v[108:111], v[248:251]
ds_read_b64_tr_b16 v[8:9], v3 offset:17504
ds_read_b64_tr_b16 v[10:11], v3 offset:18016
s_waitcnt lgkmcnt(4)
v_mfma_f32_16x16x32_bf16 v[244:247], v[12:15], v[104:107], v[244:247]
v_mfma_f32_16x16x32_bf16 v[252:255], v[12:15], v[108:111], v[252:255]
ds_read_b64_tr_b16 v[12:13], v3 offset:17536
ds_read_b64_tr_b16 v[14:15], v3 offset:18048
s_waitcnt lgkmcnt(4)
v_mfma_f32_16x16x32_bf16 v[48:51], v[4:7], v[112:115], v[48:51]
v_mfma_f32_16x16x32_bf16 v[56:59], v[4:7], v[116:119], v[56:59]
ds_read_b64_tr_b16 v[4:5], v3 offset:17568
ds_read_b64_tr_b16 v[6:7], v3 offset:18080
s_waitcnt lgkmcnt(4)
v_mfma_f32_16x16x32_bf16 v[52:55], v[8:11], v[112:115], v[52:55]
v_mfma_f32_16x16x32_bf16 v[60:63], v[8:11], v[116:119], v[60:63]
ds_read_b64_tr_b16 v[8:9], v3 offset:17600
ds_read_b64_tr_b16 v[10:11], v3 offset:18112
s_waitcnt lgkmcnt(4)
v_mfma_f32_16x16x32_bf16 v[208:211], v[12:15], v[112:115], v[208:211]
v_mfma_f32_16x16x32_bf16 v[216:219], v[12:15], v[116:119], v[216:219]
ds_read_b64_tr_b16 v[12:13], v3 offset:17632
ds_read_b64_tr_b16 v[14:15], v3 offset:18144
s_waitcnt lgkmcnt(4)
v_mfma_f32_16x16x32_bf16 v[212:215], v[4:7], v[112:115], v[212:215]
v_mfma_f32_16x16x32_bf16 v[220:223], v[4:7], v[116:119], v[220:223]
ds_read_b64_tr_b16 v[4:5], v3 offset:17664
ds_read_b64_tr_b16 v[6:7], v3 offset:18176
s_waitcnt lgkmcnt(4)
v_mfma_f32_16x16x32_bf16 v[224:227], v[8:11], v[112:115], v[224:227]
v_mfma_f32_16x16x32_bf16 v[232:235], v[8:11], v[116:119], v[232:235]
ds_read_b64_tr_b16 v[8:9], v3 offset:17696
ds_read_b64_tr_b16 v[10:11], v3 offset:18208
s_waitcnt lgkmcnt(4)
v_mfma_f32_16x16x32_bf16 v[228:231], v[12:15], v[112:115], v[228:231]
v_mfma_f32_16x16x32_bf16 v[236:239], v[12:15], v[116:119], v[236:239]
ds_read_b64_tr_b16 v[12:13], v0 offset:34944
ds_read_b64_tr_b16 v[14:15], v0 offset:35456
s_waitcnt lgkmcnt(4)
v_mfma_f32_16x16x32_bf16 v[240:243], v[4:7], v[112:115], v[240:243]
v_mfma_f32_16x16x32_bf16 v[248:251], v[4:7], v[116:119], v[248:251]
ds_read_b64_tr_b16 v[4:5], v0 offset:34976
ds_read_b64_tr_b16 v[6:7], v0 offset:35488
s_waitcnt lgkmcnt(4)
v_mfma_f32_16x16x32_bf16 v[244:247], v[8:11], v[112:115], v[244:247]
v_mfma_f32_16x16x32_bf16 v[252:255], v[8:11], v[116:119], v[252:255]
ds_read_b64_tr_b16 v[8:9], v0 offset:35008
ds_read_b64_tr_b16 v[10:11], v0 offset:35520
s_waitcnt lgkmcnt(4)
v_mfma_f32_16x16x32_bf16 v[48:51], v[12:15], v[120:123], v[48:51]
v_mfma_f32_16x16x32_bf16 v[56:59], v[12:15], v[124:127], v[56:59]
ds_read_b64_tr_b16 v[12:13], v0 offset:35040
ds_read_b64_tr_b16 v[14:15], v0 offset:35552
s_waitcnt lgkmcnt(4)
v_mfma_f32_16x16x32_bf16 v[52:55], v[4:7], v[120:123], v[52:55]
v_mfma_f32_16x16x32_bf16 v[60:63], v[4:7], v[124:127], v[60:63]
ds_read_b64_tr_b16 v[4:5], v0 offset:35072
ds_read_b64_tr_b16 v[6:7], v0 offset:35584
s_waitcnt lgkmcnt(4)
v_mfma_f32_16x16x32_bf16 v[208:211], v[8:11], v[120:123], v[208:211]
v_mfma_f32_16x16x32_bf16 v[216:219], v[8:11], v[124:127], v[216:219]
ds_read_b64_tr_b16 v[8:9], v0 offset:35104
ds_read_b64_tr_b16 v[10:11], v0 offset:35616
s_barrier
s_waitcnt lgkmcnt(4)
v_mfma_f32_16x16x32_bf16 v[212:215], v[12:15], v[120:123], v[212:215]
v_mfma_f32_16x16x32_bf16 v[220:223], v[12:15], v[124:127], v[220:223]
ds_read_b64_tr_b16 v[12:13], v0 offset:35136
ds_read_b64_tr_b16 v[14:15], v0 offset:35648
s_waitcnt lgkmcnt(4)
v_mfma_f32_16x16x32_bf16 v[224:227], v[4:7], v[120:123], v[224:227]
v_mfma_f32_16x16x32_bf16 v[232:235], v[4:7], v[124:127], v[232:235]
ds_read_b64_tr_b16 v[4:5], v0 offset:35168
ds_read_b64_tr_b16 v[6:7], v0 offset:35680
s_waitcnt lgkmcnt(4)
v_mfma_f32_16x16x32_bf16 v[228:231], v[8:11], v[120:123], v[228:231]
v_mfma_f32_16x16x32_bf16 v[236:239], v[8:11], v[124:127], v[236:239]
ds_read_b64_tr_b16 v[8:9], v0 offset:52416
ds_read_b64_tr_b16 v[10:11], v0 offset:52928
s_waitcnt lgkmcnt(4)
v_mfma_f32_16x16x32_bf16 v[240:243], v[12:15], v[120:123], v[240:243]
v_mfma_f32_16x16x32_bf16 v[248:251], v[12:15], v[124:127], v[248:251]
ds_read_b64_tr_b16 v[12:13], v0 offset:52448
ds_read_b64_tr_b16 v[14:15], v0 offset:52960
s_waitcnt lgkmcnt(4)
v_mfma_f32_16x16x32_bf16 v[244:247], v[4:7], v[120:123], v[244:247]
v_mfma_f32_16x16x32_bf16 v[252:255], v[4:7], v[124:127], v[252:255]
ds_read_b64_tr_b16 v[4:5], v0 offset:52480
ds_read_b64_tr_b16 v[6:7], v0 offset:52992
s_waitcnt lgkmcnt(4)
v_mfma_f32_16x16x32_bf16 v[48:51], v[8:11], v[128:131], v[48:51]
v_mfma_f32_16x16x32_bf16 v[56:59], v[8:11], v[132:135], v[56:59]
ds_read_b64_tr_b16 v[8:9], v0 offset:52512
ds_read_b64_tr_b16 v[10:11], v0 offset:53024
s_waitcnt lgkmcnt(4)
v_mfma_f32_16x16x32_bf16 v[52:55], v[12:15], v[128:131], v[52:55]
v_mfma_f32_16x16x32_bf16 v[60:63], v[12:15], v[132:135], v[60:63]
ds_read_b64_tr_b16 v[12:13], v0 offset:52544
ds_read_b64_tr_b16 v[14:15], v0 offset:53056
s_waitcnt lgkmcnt(4)
v_mfma_f32_16x16x32_bf16 v[208:211], v[4:7], v[128:131], v[208:211]
v_mfma_f32_16x16x32_bf16 v[216:219], v[4:7], v[132:135], v[216:219]
ds_read_b64_tr_b16 v[4:5], v0 offset:52576
ds_read_b64_tr_b16 v[6:7], v0 offset:53088
s_waitcnt lgkmcnt(4)
v_mfma_f32_16x16x32_bf16 v[212:215], v[8:11], v[128:131], v[212:215]
v_mfma_f32_16x16x32_bf16 v[220:223], v[8:11], v[132:135], v[220:223]
ds_read_b64_tr_b16 v[8:9], v0 offset:52608
ds_read_b64_tr_b16 v[10:11], v0 offset:53120
s_waitcnt lgkmcnt(4)
v_mfma_f32_16x16x32_bf16 v[224:227], v[12:15], v[128:131], v[224:227]
v_mfma_f32_16x16x32_bf16 v[232:235], v[12:15], v[132:135], v[232:235]
ds_read_b64_tr_b16 v[12:13], v0 offset:52640
ds_read_b64_tr_b16 v[14:15], v0 offset:53152
s_waitcnt lgkmcnt(4)
v_mfma_f32_16x16x32_bf16 v[228:231], v[4:7], v[128:131], v[228:231]
v_mfma_f32_16x16x32_bf16 v[236:239], v[4:7], v[132:135], v[236:239]
ds_read_b64_tr_b16 v[4:5], v0 offset:8736
ds_read_b64_tr_b16 v[6:7], v0 offset:9248
s_waitcnt lgkmcnt(4)
v_mfma_f32_16x16x32_bf16 v[240:243], v[8:11], v[128:131], v[240:243]
v_mfma_f32_16x16x32_bf16 v[248:251], v[8:11], v[132:135], v[248:251]
ds_read_b64_tr_b16 v[8:9], v0 offset:8768
ds_read_b64_tr_b16 v[10:11], v0 offset:9280
s_waitcnt lgkmcnt(4)
v_mfma_f32_16x16x32_bf16 v[244:247], v[12:15], v[128:131], v[244:247]
v_mfma_f32_16x16x32_bf16 v[252:255], v[12:15], v[132:135], v[252:255]
ds_read_b64_tr_b16 v[12:13], v0 offset:8800
ds_read_b64_tr_b16 v[14:15], v0 offset:9312
s_waitcnt lgkmcnt(4)
v_mfma_f32_16x16x32_bf16 v[48:51], v[4:7], v[136:139], v[48:51]
v_mfma_f32_16x16x32_bf16 v[56:59], v[4:7], v[140:143], v[56:59]
ds_read_b64_tr_b16 v[4:5], v0 offset:8832
ds_read_b64_tr_b16 v[6:7], v0 offset:9344
s_waitcnt lgkmcnt(4)
v_mfma_f32_16x16x32_bf16 v[52:55], v[8:11], v[136:139], v[52:55]
v_mfma_f32_16x16x32_bf16 v[60:63], v[8:11], v[140:143], v[60:63]
ds_read_b64_tr_b16 v[8:9], v0 offset:8864
ds_read_b64_tr_b16 v[10:11], v0 offset:9376
s_waitcnt lgkmcnt(4)
v_mfma_f32_16x16x32_bf16 v[208:211], v[12:15], v[136:139], v[208:211]
v_mfma_f32_16x16x32_bf16 v[216:219], v[12:15], v[140:143], v[216:219]
ds_read_b64_tr_b16 v[12:13], v0 offset:8896
ds_read_b64_tr_b16 v[14:15], v0 offset:9408
s_waitcnt lgkmcnt(4)
v_mfma_f32_16x16x32_bf16 v[212:215], v[4:7], v[136:139], v[212:215]
v_mfma_f32_16x16x32_bf16 v[220:223], v[4:7], v[140:143], v[220:223]
ds_read_b64_tr_b16 v[4:5], v0 offset:8928
ds_read_b64_tr_b16 v[6:7], v0 offset:9440
s_waitcnt lgkmcnt(4)
v_mfma_f32_16x16x32_bf16 v[224:227], v[8:11], v[136:139], v[224:227]
v_mfma_f32_16x16x32_bf16 v[232:235], v[8:11], v[140:143], v[232:235]
ds_read_b64_tr_b16 v[8:9], v0 offset:8960
ds_read_b64_tr_b16 v[10:11], v0 offset:9472
s_waitcnt lgkmcnt(4)
v_mfma_f32_16x16x32_bf16 v[228:231], v[12:15], v[136:139], v[228:231]
v_mfma_f32_16x16x32_bf16 v[236:239], v[12:15], v[140:143], v[236:239]
ds_read_b64_tr_b16 v[12:13], v0 offset:17472
ds_read_b64_tr_b16 v[14:15], v0 offset:17984
s_waitcnt lgkmcnt(4)
v_mfma_f32_16x16x32_bf16 v[240:243], v[4:7], v[136:139], v[240:243]
v_mfma_f32_16x16x32_bf16 v[248:251], v[4:7], v[140:143], v[248:251]
ds_read_b64_tr_b16 v[4:5], v0 offset:17504
ds_read_b64_tr_b16 v[6:7], v0 offset:18016
s_waitcnt lgkmcnt(4)
v_mfma_f32_16x16x32_bf16 v[244:247], v[8:11], v[136:139], v[244:247]
v_mfma_f32_16x16x32_bf16 v[252:255], v[8:11], v[140:143], v[252:255]
ds_read_b64_tr_b16 v[8:9], v0 offset:17536
ds_read_b64_tr_b16 v[10:11], v0 offset:18048
s_waitcnt lgkmcnt(4)
v_mfma_f32_16x16x32_bf16 v[48:51], v[12:15], v[144:147], v[48:51]
v_mfma_f32_16x16x32_bf16 v[56:59], v[12:15], v[148:151], v[56:59]
ds_read_b64_tr_b16 v[12:13], v0 offset:17568
ds_read_b64_tr_b16 v[14:15], v0 offset:18080
s_waitcnt lgkmcnt(4)
v_mfma_f32_16x16x32_bf16 v[52:55], v[4:7], v[144:147], v[52:55]
v_mfma_f32_16x16x32_bf16 v[60:63], v[4:7], v[148:151], v[60:63]
ds_read_b64_tr_b16 v[4:5], v0 offset:17600
ds_read_b64_tr_b16 v[6:7], v0 offset:18112
s_barrier
s_waitcnt lgkmcnt(4)
v_mfma_f32_16x16x32_bf16 v[208:211], v[8:11], v[144:147], v[208:211]
v_mfma_f32_16x16x32_bf16 v[216:219], v[8:11], v[148:151], v[216:219]
ds_read_b64_tr_b16 v[8:9], v0 offset:17632
ds_read_b64_tr_b16 v[10:11], v0 offset:18144
s_waitcnt lgkmcnt(4)
v_mfma_f32_16x16x32_bf16 v[212:215], v[12:15], v[144:147], v[212:215]
v_mfma_f32_16x16x32_bf16 v[220:223], v[12:15], v[148:151], v[220:223]
ds_read_b64_tr_b16 v[12:13], v0 offset:17664
ds_read_b64_tr_b16 v[14:15], v0 offset:18176
s_waitcnt lgkmcnt(4)
v_mfma_f32_16x16x32_bf16 v[224:227], v[4:7], v[144:147], v[224:227]
v_mfma_f32_16x16x32_bf16 v[232:235], v[4:7], v[148:151], v[232:235]
ds_read_b64_tr_b16 v[4:5], v0 offset:17696
ds_read_b64_tr_b16 v[6:7], v0 offset:18208
s_waitcnt lgkmcnt(4)
v_mfma_f32_16x16x32_bf16 v[228:231], v[8:11], v[144:147], v[228:231]
v_mfma_f32_16x16x32_bf16 v[236:239], v[8:11], v[148:151], v[236:239]
ds_read_b64_tr_b16 v[8:9], v0 offset:26208
ds_read_b64_tr_b16 v[10:11], v0 offset:26720
s_waitcnt lgkmcnt(4)
v_mfma_f32_16x16x32_bf16 v[240:243], v[12:15], v[144:147], v[240:243]
v_mfma_f32_16x16x32_bf16 v[248:251], v[12:15], v[148:151], v[248:251]
ds_read_b64_tr_b16 v[12:13], v0 offset:26240
ds_read_b64_tr_b16 v[14:15], v0 offset:26752
s_waitcnt lgkmcnt(4)
v_mfma_f32_16x16x32_bf16 v[244:247], v[4:7], v[144:147], v[244:247]
v_mfma_f32_16x16x32_bf16 v[252:255], v[4:7], v[148:151], v[252:255]
ds_read_b64_tr_b16 v[4:5], v0 offset:26272
ds_read_b64_tr_b16 v[6:7], v0 offset:26784
s_waitcnt lgkmcnt(4)
v_mfma_f32_16x16x32_bf16 v[48:51], v[8:11], v[152:155], v[48:51]
v_mfma_f32_16x16x32_bf16 v[56:59], v[8:11], v[156:159], v[56:59]
ds_read_b64_tr_b16 v[8:9], v0 offset:26304
ds_read_b64_tr_b16 v[10:11], v0 offset:26816
s_waitcnt lgkmcnt(4)
v_mfma_f32_16x16x32_bf16 v[52:55], v[12:15], v[152:155], v[52:55]
v_mfma_f32_16x16x32_bf16 v[60:63], v[12:15], v[156:159], v[60:63]
ds_read_b64_tr_b16 v[12:13], v0 offset:26336
ds_read_b64_tr_b16 v[14:15], v0 offset:26848
s_waitcnt lgkmcnt(4)
v_mfma_f32_16x16x32_bf16 v[208:211], v[4:7], v[152:155], v[208:211]
v_mfma_f32_16x16x32_bf16 v[216:219], v[4:7], v[156:159], v[216:219]
ds_read_b64_tr_b16 v[4:5], v0 offset:26368
ds_read_b64_tr_b16 v[6:7], v0 offset:26880
s_waitcnt lgkmcnt(4)
v_mfma_f32_16x16x32_bf16 v[212:215], v[8:11], v[152:155], v[212:215]
v_mfma_f32_16x16x32_bf16 v[220:223], v[8:11], v[156:159], v[220:223]
ds_read_b64_tr_b16 v[8:9], v0 offset:26400
ds_read_b64_tr_b16 v[10:11], v0 offset:26912
s_waitcnt lgkmcnt(4)
v_mfma_f32_16x16x32_bf16 v[224:227], v[12:15], v[152:155], v[224:227]
v_mfma_f32_16x16x32_bf16 v[232:235], v[12:15], v[156:159], v[232:235]
ds_read_b64_tr_b16 v[12:13], v0 offset:26432
ds_read_b64_tr_b16 v[14:15], v0 offset:26944
s_waitcnt lgkmcnt(4)
v_mfma_f32_16x16x32_bf16 v[228:231], v[4:7], v[152:155], v[228:231]
v_mfma_f32_16x16x32_bf16 v[236:239], v[4:7], v[156:159], v[236:239]
ds_read_b64_tr_b16 v[4:5], v0 offset:43680
ds_read_b64_tr_b16 v[6:7], v0 offset:44192
s_waitcnt lgkmcnt(4)
v_mfma_f32_16x16x32_bf16 v[240:243], v[8:11], v[152:155], v[240:243]
v_mfma_f32_16x16x32_bf16 v[248:251], v[8:11], v[156:159], v[248:251]
ds_read_b64_tr_b16 v[8:9], v0 offset:43712
ds_read_b64_tr_b16 v[10:11], v0 offset:44224
s_waitcnt lgkmcnt(4)
v_mfma_f32_16x16x32_bf16 v[244:247], v[12:15], v[152:155], v[244:247]
v_mfma_f32_16x16x32_bf16 v[252:255], v[12:15], v[156:159], v[252:255]
ds_read_b64_tr_b16 v[12:13], v0 offset:43744
ds_read_b64_tr_b16 v[14:15], v0 offset:44256
s_waitcnt lgkmcnt(4)
v_mfma_f32_16x16x32_bf16 v[48:51], v[4:7], v[160:163], v[48:51]
v_mfma_f32_16x16x32_bf16 v[56:59], v[4:7], v[164:167], v[56:59]
ds_read_b64_tr_b16 v[4:5], v0 offset:43776
ds_read_b64_tr_b16 v[6:7], v0 offset:44288
s_waitcnt lgkmcnt(4)
v_mfma_f32_16x16x32_bf16 v[52:55], v[8:11], v[160:163], v[52:55]
v_mfma_f32_16x16x32_bf16 v[60:63], v[8:11], v[164:167], v[60:63]
ds_read_b64_tr_b16 v[8:9], v0 offset:43808
ds_read_b64_tr_b16 v[10:11], v0 offset:44320
s_waitcnt lgkmcnt(4)
v_mfma_f32_16x16x32_bf16 v[208:211], v[12:15], v[160:163], v[208:211]
v_mfma_f32_16x16x32_bf16 v[216:219], v[12:15], v[164:167], v[216:219]
ds_read_b64_tr_b16 v[12:13], v0 offset:43840
ds_read_b64_tr_b16 v[14:15], v0 offset:44352
s_waitcnt lgkmcnt(4)
v_mfma_f32_16x16x32_bf16 v[212:215], v[4:7], v[160:163], v[212:215]
v_mfma_f32_16x16x32_bf16 v[220:223], v[4:7], v[164:167], v[220:223]
ds_read_b64_tr_b16 v[4:5], v0 offset:43872
ds_read_b64_tr_b16 v[6:7], v0 offset:44384
s_waitcnt lgkmcnt(4)
v_mfma_f32_16x16x32_bf16 v[224:227], v[8:11], v[160:163], v[224:227]
v_mfma_f32_16x16x32_bf16 v[232:235], v[8:11], v[164:167], v[232:235]
ds_read_b64_tr_b16 v[8:9], v0 offset:43904
ds_read_b64_tr_b16 v[10:11], v0 offset:44416
s_waitcnt lgkmcnt(4)
v_mfma_f32_16x16x32_bf16 v[228:231], v[12:15], v[160:163], v[228:231]
v_mfma_f32_16x16x32_bf16 v[236:239], v[12:15], v[164:167], v[236:239]
ds_read_b64_tr_b16 v[12:13], v0 offset:0
ds_read_b64_tr_b16 v[14:15], v0 offset:512
s_waitcnt lgkmcnt(4)
v_mfma_f32_16x16x32_bf16 v[240:243], v[4:7], v[160:163], v[240:243]
v_mfma_f32_16x16x32_bf16 v[248:251], v[4:7], v[164:167], v[248:251]
ds_read_b64_tr_b16 v[4:5], v0 offset:32
ds_read_b64_tr_b16 v[6:7], v0 offset:544
s_waitcnt lgkmcnt(4)
v_mfma_f32_16x16x32_bf16 v[244:247], v[8:11], v[160:163], v[244:247]
v_mfma_f32_16x16x32_bf16 v[252:255], v[8:11], v[164:167], v[252:255]
ds_read_b64_tr_b16 v[8:9], v0 offset:64
ds_read_b64_tr_b16 v[10:11], v0 offset:576
s_waitcnt lgkmcnt(4)
v_mfma_f32_16x16x32_bf16 v[48:51], v[12:15], v[168:171], v[48:51]
v_mfma_f32_16x16x32_bf16 v[56:59], v[12:15], v[172:175], v[56:59]
ds_read_b64_tr_b16 v[12:13], v0 offset:96
ds_read_b64_tr_b16 v[14:15], v0 offset:608
s_barrier
s_waitcnt lgkmcnt(4)
v_mfma_f32_16x16x32_bf16 v[52:55], v[4:7], v[168:171], v[52:55]
v_mfma_f32_16x16x32_bf16 v[60:63], v[4:7], v[172:175], v[60:63]
ds_read_b64_tr_b16 v[4:5], v0 offset:128
ds_read_b64_tr_b16 v[6:7], v0 offset:640
s_waitcnt lgkmcnt(4)
v_mfma_f32_16x16x32_bf16 v[208:211], v[8:11], v[168:171], v[208:211]
v_mfma_f32_16x16x32_bf16 v[216:219], v[8:11], v[172:175], v[216:219]
ds_read_b64_tr_b16 v[8:9], v0 offset:160
ds_read_b64_tr_b16 v[10:11], v0 offset:672
s_waitcnt lgkmcnt(4)
v_mfma_f32_16x16x32_bf16 v[212:215], v[12:15], v[168:171], v[212:215]
v_mfma_f32_16x16x32_bf16 v[220:223], v[12:15], v[172:175], v[220:223]
ds_read_b64_tr_b16 v[12:13], v0 offset:192
ds_read_b64_tr_b16 v[14:15], v0 offset:704
s_waitcnt lgkmcnt(4)
v_mfma_f32_16x16x32_bf16 v[224:227], v[4:7], v[168:171], v[224:227]
v_mfma_f32_16x16x32_bf16 v[232:235], v[4:7], v[172:175], v[232:235]
ds_read_b64_tr_b16 v[4:5], v0 offset:224
ds_read_b64_tr_b16 v[6:7], v0 offset:736
s_waitcnt lgkmcnt(4)
v_mfma_f32_16x16x32_bf16 v[228:231], v[8:11], v[168:171], v[228:231]
v_mfma_f32_16x16x32_bf16 v[236:239], v[8:11], v[172:175], v[236:239]
ds_read_b64_tr_b16 v[8:9], v0 offset:34944
ds_read_b64_tr_b16 v[10:11], v0 offset:35456
s_waitcnt lgkmcnt(4)
v_mfma_f32_16x16x32_bf16 v[240:243], v[12:15], v[168:171], v[240:243]
v_mfma_f32_16x16x32_bf16 v[248:251], v[12:15], v[172:175], v[248:251]
ds_read_b64_tr_b16 v[12:13], v0 offset:34976
ds_read_b64_tr_b16 v[14:15], v0 offset:35488
s_waitcnt lgkmcnt(4)
v_mfma_f32_16x16x32_bf16 v[244:247], v[4:7], v[168:171], v[244:247]
v_mfma_f32_16x16x32_bf16 v[252:255], v[4:7], v[172:175], v[252:255]
ds_read_b64_tr_b16 v[4:5], v0 offset:35008
ds_read_b64_tr_b16 v[6:7], v0 offset:35520
s_waitcnt lgkmcnt(4)
v_mfma_f32_16x16x32_bf16 v[48:51], v[8:11], v[176:179], v[48:51]
v_mfma_f32_16x16x32_bf16 v[56:59], v[8:11], v[180:183], v[56:59]
ds_read_b64_tr_b16 v[8:9], v0 offset:35040
ds_read_b64_tr_b16 v[10:11], v0 offset:35552
s_waitcnt lgkmcnt(4)
v_mfma_f32_16x16x32_bf16 v[52:55], v[12:15], v[176:179], v[52:55]
v_mfma_f32_16x16x32_bf16 v[60:63], v[12:15], v[180:183], v[60:63]
ds_read_b64_tr_b16 v[12:13], v0 offset:35072
ds_read_b64_tr_b16 v[14:15], v0 offset:35584
s_waitcnt lgkmcnt(4)
v_mfma_f32_16x16x32_bf16 v[208:211], v[4:7], v[176:179], v[208:211]
v_mfma_f32_16x16x32_bf16 v[216:219], v[4:7], v[180:183], v[216:219]
ds_read_b64_tr_b16 v[4:5], v0 offset:35104
ds_read_b64_tr_b16 v[6:7], v0 offset:35616
s_waitcnt lgkmcnt(4)
v_mfma_f32_16x16x32_bf16 v[212:215], v[8:11], v[176:179], v[212:215]
v_mfma_f32_16x16x32_bf16 v[220:223], v[8:11], v[180:183], v[220:223]
ds_read_b64_tr_b16 v[8:9], v0 offset:35136
ds_read_b64_tr_b16 v[10:11], v0 offset:35648
s_waitcnt lgkmcnt(4)
v_mfma_f32_16x16x32_bf16 v[224:227], v[12:15], v[176:179], v[224:227]
v_mfma_f32_16x16x32_bf16 v[232:235], v[12:15], v[180:183], v[232:235]
ds_read_b64_tr_b16 v[12:13], v0 offset:35168
ds_read_b64_tr_b16 v[14:15], v0 offset:35680
s_waitcnt lgkmcnt(4)
v_mfma_f32_16x16x32_bf16 v[228:231], v[4:7], v[176:179], v[228:231]
v_mfma_f32_16x16x32_bf16 v[236:239], v[4:7], v[180:183], v[236:239]
ds_read_b64_tr_b16 v[4:5], v0 offset:52416
ds_read_b64_tr_b16 v[6:7], v0 offset:52928
s_waitcnt lgkmcnt(4)
v_mfma_f32_16x16x32_bf16 v[240:243], v[8:11], v[176:179], v[240:243]
v_mfma_f32_16x16x32_bf16 v[248:251], v[8:11], v[180:183], v[248:251]
ds_read_b64_tr_b16 v[8:9], v0 offset:52448
ds_read_b64_tr_b16 v[10:11], v0 offset:52960
s_waitcnt lgkmcnt(4)
v_mfma_f32_16x16x32_bf16 v[244:247], v[12:15], v[176:179], v[244:247]
v_mfma_f32_16x16x32_bf16 v[252:255], v[12:15], v[180:183], v[252:255]
ds_read_b64_tr_b16 v[12:13], v0 offset:52480
ds_read_b64_tr_b16 v[14:15], v0 offset:52992
s_waitcnt lgkmcnt(4)
v_mfma_f32_16x16x32_bf16 v[48:51], v[4:7], v[184:187], v[48:51]
v_mfma_f32_16x16x32_bf16 v[56:59], v[4:7], v[188:191], v[56:59]
ds_read_b64_tr_b16 v[4:5], v0 offset:52512
ds_read_b64_tr_b16 v[6:7], v0 offset:53024
s_waitcnt lgkmcnt(4)
v_mfma_f32_16x16x32_bf16 v[52:55], v[8:11], v[184:187], v[52:55]
v_mfma_f32_16x16x32_bf16 v[60:63], v[8:11], v[188:191], v[60:63]
ds_read_b64_tr_b16 v[8:9], v0 offset:52544
ds_read_b64_tr_b16 v[10:11], v0 offset:53056
s_waitcnt lgkmcnt(4)
v_mfma_f32_16x16x32_bf16 v[208:211], v[12:15], v[184:187], v[208:211]
v_mfma_f32_16x16x32_bf16 v[216:219], v[12:15], v[188:191], v[216:219]
ds_read_b64_tr_b16 v[12:13], v0 offset:52576
ds_read_b64_tr_b16 v[14:15], v0 offset:53088
s_waitcnt lgkmcnt(4)
v_mfma_f32_16x16x32_bf16 v[212:215], v[4:7], v[184:187], v[212:215]
v_mfma_f32_16x16x32_bf16 v[220:223], v[4:7], v[188:191], v[220:223]
ds_read_b64_tr_b16 v[4:5], v0 offset:52608
ds_read_b64_tr_b16 v[6:7], v0 offset:53120
s_waitcnt lgkmcnt(4)
v_mfma_f32_16x16x32_bf16 v[224:227], v[8:11], v[184:187], v[224:227]
v_mfma_f32_16x16x32_bf16 v[232:235], v[8:11], v[188:191], v[232:235]
ds_read_b64_tr_b16 v[8:9], v0 offset:52640
ds_read_b64_tr_b16 v[10:11], v0 offset:53152
s_waitcnt lgkmcnt(4)
v_mfma_f32_16x16x32_bf16 v[228:231], v[12:15], v[184:187], v[228:231]
v_mfma_f32_16x16x32_bf16 v[236:239], v[12:15], v[188:191], v[236:239]
ds_read_b64_tr_b16 v[12:13], v0 offset:8736
ds_read_b64_tr_b16 v[14:15], v0 offset:9248
s_waitcnt lgkmcnt(4)
v_mfma_f32_16x16x32_bf16 v[240:243], v[4:7], v[184:187], v[240:243]
v_mfma_f32_16x16x32_bf16 v[248:251], v[4:7], v[188:191], v[248:251]
ds_read_b64_tr_b16 v[4:5], v0 offset:8768
ds_read_b64_tr_b16 v[6:7], v0 offset:9280
s_waitcnt lgkmcnt(4)
v_mfma_f32_16x16x32_bf16 v[244:247], v[8:11], v[184:187], v[244:247]
v_mfma_f32_16x16x32_bf16 v[252:255], v[8:11], v[188:191], v[252:255]
ds_read_b64_tr_b16 v[8:9], v0 offset:8800
ds_read_b64_tr_b16 v[10:11], v0 offset:9312
s_barrier
s_waitcnt lgkmcnt(4)
v_mfma_f32_16x16x32_bf16 v[48:51], v[12:15], v[192:195], v[48:51]
v_mfma_f32_16x16x32_bf16 v[56:59], v[12:15], v[196:199], v[56:59]
ds_read_b64_tr_b16 v[12:13], v0 offset:8832
ds_read_b64_tr_b16 v[14:15], v0 offset:9344
s_waitcnt lgkmcnt(4)
v_mfma_f32_16x16x32_bf16 v[52:55], v[4:7], v[192:195], v[52:55]
v_mfma_f32_16x16x32_bf16 v[60:63], v[4:7], v[196:199], v[60:63]
ds_read_b64_tr_b16 v[4:5], v0 offset:8864
ds_read_b64_tr_b16 v[6:7], v0 offset:9376
ds_read_b128 v[64:67], v2 offset:24576
s_waitcnt lgkmcnt(5)
v_mfma_f32_16x16x32_bf16 v[208:211], v[8:11], v[192:195], v[208:211]
v_mfma_f32_16x16x32_bf16 v[216:219], v[8:11], v[196:199], v[216:219]
ds_read_b64_tr_b16 v[8:9], v0 offset:8896
ds_read_b64_tr_b16 v[10:11], v0 offset:9408
ds_read_b128 v[68:71], v2 offset:25600
s_waitcnt lgkmcnt(6)
v_mfma_f32_16x16x32_bf16 v[212:215], v[12:15], v[192:195], v[212:215]
v_mfma_f32_16x16x32_bf16 v[220:223], v[12:15], v[196:199], v[220:223]
ds_read_b64_tr_b16 v[12:13], v0 offset:8928
ds_read_b64_tr_b16 v[14:15], v0 offset:9440
ds_read_b128 v[72:75], v2 offset:26624
s_waitcnt lgkmcnt(7)
v_mfma_f32_16x16x32_bf16 v[224:227], v[4:7], v[192:195], v[224:227]
v_mfma_f32_16x16x32_bf16 v[232:235], v[4:7], v[196:199], v[232:235]
ds_read_b64_tr_b16 v[4:5], v0 offset:8960
ds_read_b64_tr_b16 v[6:7], v0 offset:9472
ds_read_b128 v[76:79], v2 offset:27648
s_waitcnt lgkmcnt(7)
v_mfma_f32_16x16x32_bf16 v[228:231], v[8:11], v[192:195], v[228:231]
v_mfma_f32_16x16x32_bf16 v[236:239], v[8:11], v[196:199], v[236:239]
ds_read_b64_tr_b16 v[8:9], v0 offset:43680
ds_read_b64_tr_b16 v[10:11], v0 offset:44192
ds_read_b128 v[80:83], v2 offset:28672
s_waitcnt lgkmcnt(7)
v_mfma_f32_16x16x32_bf16 v[240:243], v[12:15], v[192:195], v[240:243]
v_mfma_f32_16x16x32_bf16 v[248:251], v[12:15], v[196:199], v[248:251]
ds_read_b64_tr_b16 v[12:13], v0 offset:43712
ds_read_b64_tr_b16 v[14:15], v0 offset:44224
ds_read_b128 v[84:87], v2 offset:29696
s_waitcnt lgkmcnt(7)
v_mfma_f32_16x16x32_bf16 v[244:247], v[4:7], v[192:195], v[244:247]
v_mfma_f32_16x16x32_bf16 v[252:255], v[4:7], v[196:199], v[252:255]
ds_read_b64_tr_b16 v[4:5], v0 offset:43744
ds_read_b64_tr_b16 v[6:7], v0 offset:44256
ds_read_b128 v[88:91], v2 offset:30720
s_waitcnt lgkmcnt(7)
v_mfma_f32_16x16x32_bf16 v[48:51], v[8:11], v[200:203], v[48:51]
v_mfma_f32_16x16x32_bf16 v[56:59], v[8:11], v[204:207], v[56:59]
ds_read_b64_tr_b16 v[8:9], v0 offset:43776
ds_read_b64_tr_b16 v[10:11], v0 offset:44288
ds_read_b128 v[92:95], v2 offset:31744
s_waitcnt lgkmcnt(7)
v_mfma_f32_16x16x32_bf16 v[52:55], v[12:15], v[200:203], v[52:55]
v_mfma_f32_16x16x32_bf16 v[60:63], v[12:15], v[204:207], v[60:63]
ds_read_b64_tr_b16 v[12:13], v0 offset:43808
ds_read_b64_tr_b16 v[14:15], v0 offset:44320
ds_read_b128 v[96:99], v2 offset:32768
s_waitcnt lgkmcnt(7)
v_mfma_f32_16x16x32_bf16 v[208:211], v[4:7], v[200:203], v[208:211]
v_mfma_f32_16x16x32_bf16 v[216:219], v[4:7], v[204:207], v[216:219]
ds_read_b64_tr_b16 v[4:5], v0 offset:43840
ds_read_b64_tr_b16 v[6:7], v0 offset:44352
ds_read_b128 v[100:103], v2 offset:33792
s_waitcnt lgkmcnt(7)
v_mfma_f32_16x16x32_bf16 v[212:215], v[8:11], v[200:203], v[212:215]
v_mfma_f32_16x16x32_bf16 v[220:223], v[8:11], v[204:207], v[220:223]
ds_read_b64_tr_b16 v[8:9], v0 offset:43872
ds_read_b64_tr_b16 v[10:11], v0 offset:44384
ds_read_b128 v[104:107], v2 offset:34816
s_waitcnt lgkmcnt(7)
v_mfma_f32_16x16x32_bf16 v[224:227], v[12:15], v[200:203], v[224:227]
v_mfma_f32_16x16x32_bf16 v[232:235], v[12:15], v[204:207], v[232:235]
ds_read_b64_tr_b16 v[12:13], v0 offset:43904
ds_read_b64_tr_b16 v[14:15], v0 offset:44416
ds_read_b128 v[108:111], v2 offset:35840
s_waitcnt lgkmcnt(7)
v_mfma_f32_16x16x32_bf16 v[228:231], v[4:7], v[200:203], v[228:231]
v_mfma_f32_16x16x32_bf16 v[236:239], v[4:7], v[204:207], v[236:239]
ds_read_b64_tr_b16 v[4:5], v0 offset:17472
ds_read_b64_tr_b16 v[6:7], v0 offset:17984
s_waitcnt lgkmcnt(6)
v_mfma_f32_16x16x32_bf16 v[240:243], v[8:11], v[200:203], v[240:243]
v_mfma_f32_16x16x32_bf16 v[248:251], v[8:11], v[204:207], v[248:251]
ds_read_b64_tr_b16 v[8:9], v0 offset:17504
ds_read_b64_tr_b16 v[10:11], v0 offset:18016
s_waitcnt lgkmcnt(5)
v_mfma_f32_16x16x32_bf16 v[244:247], v[12:15], v[200:203], v[244:247]
v_mfma_f32_16x16x32_bf16 v[252:255], v[12:15], v[204:207], v[252:255]
ds_read_b64_tr_b16 v[12:13], v0 offset:17536
ds_read_b64_tr_b16 v[14:15], v0 offset:18048
s_waitcnt lgkmcnt(6)
s_waitcnt lgkmcnt(4)
v_mfma_f32_16x16x32_bf16 v[48:51], v[4:7], v[64:67], v[48:51]
v_mfma_f32_16x16x32_bf16 v[56:59], v[4:7], v[68:71], v[56:59]
ds_read_b64_tr_b16 v[4:5], v0 offset:17568
ds_read_b64_tr_b16 v[6:7], v0 offset:18080
s_waitcnt lgkmcnt(4)
v_mfma_f32_16x16x32_bf16 v[52:55], v[8:11], v[64:67], v[52:55]
v_mfma_f32_16x16x32_bf16 v[60:63], v[8:11], v[68:71], v[60:63]
ds_read_b64_tr_b16 v[8:9], v0 offset:17600
ds_read_b64_tr_b16 v[10:11], v0 offset:18112
s_barrier
s_waitcnt lgkmcnt(4)
v_mfma_f32_16x16x32_bf16 v[208:211], v[12:15], v[64:67], v[208:211]
v_mfma_f32_16x16x32_bf16 v[216:219], v[12:15], v[68:71], v[216:219]
ds_read_b64_tr_b16 v[12:13], v0 offset:17632
ds_read_b64_tr_b16 v[14:15], v0 offset:18144
s_waitcnt lgkmcnt(4)
v_mfma_f32_16x16x32_bf16 v[212:215], v[4:7], v[64:67], v[212:215]
v_mfma_f32_16x16x32_bf16 v[220:223], v[4:7], v[68:71], v[220:223]
ds_read_b64_tr_b16 v[4:5], v0 offset:17664
ds_read_b64_tr_b16 v[6:7], v0 offset:18176
s_waitcnt lgkmcnt(4)
v_mfma_f32_16x16x32_bf16 v[224:227], v[8:11], v[64:67], v[224:227]
v_mfma_f32_16x16x32_bf16 v[232:235], v[8:11], v[68:71], v[232:235]
ds_read_b64_tr_b16 v[8:9], v0 offset:17696
ds_read_b64_tr_b16 v[10:11], v0 offset:18208
s_waitcnt lgkmcnt(4)
v_mfma_f32_16x16x32_bf16 v[228:231], v[12:15], v[64:67], v[228:231]
v_mfma_f32_16x16x32_bf16 v[236:239], v[12:15], v[68:71], v[236:239]
ds_read_b64_tr_b16 v[12:13], v0 offset:26208
ds_read_b64_tr_b16 v[14:15], v0 offset:26720
s_waitcnt lgkmcnt(4)
v_mfma_f32_16x16x32_bf16 v[240:243], v[4:7], v[64:67], v[240:243]
v_mfma_f32_16x16x32_bf16 v[248:251], v[4:7], v[68:71], v[248:251]
ds_read_b64_tr_b16 v[4:5], v0 offset:26240
ds_read_b64_tr_b16 v[6:7], v0 offset:26752
s_waitcnt lgkmcnt(4)
v_mfma_f32_16x16x32_bf16 v[244:247], v[8:11], v[64:67], v[244:247]
v_mfma_f32_16x16x32_bf16 v[252:255], v[8:11], v[68:71], v[252:255]
ds_read_b64_tr_b16 v[8:9], v0 offset:26272
ds_read_b64_tr_b16 v[10:11], v0 offset:26784
s_waitcnt lgkmcnt(4)
v_mfma_f32_16x16x32_bf16 v[48:51], v[12:15], v[72:75], v[48:51]
v_mfma_f32_16x16x32_bf16 v[56:59], v[12:15], v[76:79], v[56:59]
ds_read_b64_tr_b16 v[12:13], v0 offset:26304
ds_read_b64_tr_b16 v[14:15], v0 offset:26816
s_waitcnt lgkmcnt(4)
v_mfma_f32_16x16x32_bf16 v[52:55], v[4:7], v[72:75], v[52:55]
v_mfma_f32_16x16x32_bf16 v[60:63], v[4:7], v[76:79], v[60:63]
ds_read_b64_tr_b16 v[4:5], v0 offset:26336
ds_read_b64_tr_b16 v[6:7], v0 offset:26848
s_waitcnt lgkmcnt(4)
v_mfma_f32_16x16x32_bf16 v[208:211], v[8:11], v[72:75], v[208:211]
v_mfma_f32_16x16x32_bf16 v[216:219], v[8:11], v[76:79], v[216:219]
ds_read_b64_tr_b16 v[8:9], v0 offset:26368
ds_read_b64_tr_b16 v[10:11], v0 offset:26880
s_waitcnt lgkmcnt(4)
v_mfma_f32_16x16x32_bf16 v[212:215], v[12:15], v[72:75], v[212:215]
v_mfma_f32_16x16x32_bf16 v[220:223], v[12:15], v[76:79], v[220:223]
ds_read_b64_tr_b16 v[12:13], v0 offset:26400
ds_read_b64_tr_b16 v[14:15], v0 offset:26912
s_waitcnt lgkmcnt(4)
v_mfma_f32_16x16x32_bf16 v[224:227], v[4:7], v[72:75], v[224:227]
v_mfma_f32_16x16x32_bf16 v[232:235], v[4:7], v[76:79], v[232:235]
ds_read_b64_tr_b16 v[4:5], v0 offset:26432
ds_read_b64_tr_b16 v[6:7], v0 offset:26944
s_waitcnt lgkmcnt(4)
v_mfma_f32_16x16x32_bf16 v[228:231], v[8:11], v[72:75], v[228:231]
v_mfma_f32_16x16x32_bf16 v[236:239], v[8:11], v[76:79], v[236:239]
ds_read_b64_tr_b16 v[8:9], v0 offset:34944
ds_read_b64_tr_b16 v[10:11], v0 offset:35456
s_waitcnt lgkmcnt(4)
v_mfma_f32_16x16x32_bf16 v[240:243], v[12:15], v[72:75], v[240:243]
v_mfma_f32_16x16x32_bf16 v[248:251], v[12:15], v[76:79], v[248:251]
ds_read_b64_tr_b16 v[12:13], v0 offset:34976
ds_read_b64_tr_b16 v[14:15], v0 offset:35488
s_waitcnt lgkmcnt(4)
v_mfma_f32_16x16x32_bf16 v[244:247], v[4:7], v[72:75], v[244:247]
v_mfma_f32_16x16x32_bf16 v[252:255], v[4:7], v[76:79], v[252:255]
ds_read_b64_tr_b16 v[4:5], v0 offset:35008
ds_read_b64_tr_b16 v[6:7], v0 offset:35520
s_waitcnt lgkmcnt(4)
v_mfma_f32_16x16x32_bf16 v[48:51], v[8:11], v[80:83], v[48:51]
v_mfma_f32_16x16x32_bf16 v[56:59], v[8:11], v[84:87], v[56:59]
ds_read_b64_tr_b16 v[8:9], v0 offset:35040
ds_read_b64_tr_b16 v[10:11], v0 offset:35552
s_waitcnt lgkmcnt(4)
v_mfma_f32_16x16x32_bf16 v[52:55], v[12:15], v[80:83], v[52:55]
v_mfma_f32_16x16x32_bf16 v[60:63], v[12:15], v[84:87], v[60:63]
ds_read_b64_tr_b16 v[12:13], v0 offset:35072
ds_read_b64_tr_b16 v[14:15], v0 offset:35584
s_waitcnt lgkmcnt(4)
v_mfma_f32_16x16x32_bf16 v[208:211], v[4:7], v[80:83], v[208:211]
v_mfma_f32_16x16x32_bf16 v[216:219], v[4:7], v[84:87], v[216:219]
ds_read_b64_tr_b16 v[4:5], v0 offset:35104
ds_read_b64_tr_b16 v[6:7], v0 offset:35616
s_waitcnt lgkmcnt(4)
v_mfma_f32_16x16x32_bf16 v[212:215], v[8:11], v[80:83], v[212:215]
v_mfma_f32_16x16x32_bf16 v[220:223], v[8:11], v[84:87], v[220:223]
ds_read_b64_tr_b16 v[8:9], v0 offset:35136
ds_read_b64_tr_b16 v[10:11], v0 offset:35648
s_waitcnt lgkmcnt(4)
v_mfma_f32_16x16x32_bf16 v[224:227], v[12:15], v[80:83], v[224:227]
v_mfma_f32_16x16x32_bf16 v[232:235], v[12:15], v[84:87], v[232:235]
ds_read_b64_tr_b16 v[12:13], v0 offset:35168
ds_read_b64_tr_b16 v[14:15], v0 offset:35680
s_waitcnt lgkmcnt(4)
v_mfma_f32_16x16x32_bf16 v[228:231], v[4:7], v[80:83], v[228:231]
v_mfma_f32_16x16x32_bf16 v[236:239], v[4:7], v[84:87], v[236:239]
ds_read_b64_tr_b16 v[4:5], v0 offset:52416
ds_read_b64_tr_b16 v[6:7], v0 offset:52928
s_waitcnt lgkmcnt(4)
v_mfma_f32_16x16x32_bf16 v[240:243], v[8:11], v[80:83], v[240:243]
v_mfma_f32_16x16x32_bf16 v[248:251], v[8:11], v[84:87], v[248:251]
ds_read_b64_tr_b16 v[8:9], v0 offset:52448
ds_read_b64_tr_b16 v[10:11], v0 offset:52960
s_waitcnt lgkmcnt(4)
v_mfma_f32_16x16x32_bf16 v[244:247], v[12:15], v[80:83], v[244:247]
v_mfma_f32_16x16x32_bf16 v[252:255], v[12:15], v[84:87], v[252:255]
ds_read_b64_tr_b16 v[12:13], v0 offset:52480
ds_read_b64_tr_b16 v[14:15], v0 offset:52992
s_waitcnt lgkmcnt(4)
v_mfma_f32_16x16x32_bf16 v[48:51], v[4:7], v[88:91], v[48:51]
v_mfma_f32_16x16x32_bf16 v[56:59], v[4:7], v[92:95], v[56:59]
ds_read_b64_tr_b16 v[4:5], v0 offset:52512
ds_read_b64_tr_b16 v[6:7], v0 offset:53024
s_barrier
s_waitcnt lgkmcnt(4)
v_mfma_f32_16x16x32_bf16 v[52:55], v[8:11], v[88:91], v[52:55]
v_mfma_f32_16x16x32_bf16 v[60:63], v[8:11], v[92:95], v[60:63]
ds_read_b64_tr_b16 v[8:9], v0 offset:52544
ds_read_b64_tr_b16 v[10:11], v0 offset:53056
s_waitcnt lgkmcnt(4)
v_mfma_f32_16x16x32_bf16 v[208:211], v[12:15], v[88:91], v[208:211]
v_mfma_f32_16x16x32_bf16 v[216:219], v[12:15], v[92:95], v[216:219]
ds_read_b64_tr_b16 v[12:13], v0 offset:52576
ds_read_b64_tr_b16 v[14:15], v0 offset:53088
s_waitcnt lgkmcnt(4)
v_mfma_f32_16x16x32_bf16 v[212:215], v[4:7], v[88:91], v[212:215]
v_mfma_f32_16x16x32_bf16 v[220:223], v[4:7], v[92:95], v[220:223]
ds_read_b64_tr_b16 v[4:5], v0 offset:52608
ds_read_b64_tr_b16 v[6:7], v0 offset:53120
s_waitcnt lgkmcnt(4)
v_mfma_f32_16x16x32_bf16 v[224:227], v[8:11], v[88:91], v[224:227]
v_mfma_f32_16x16x32_bf16 v[232:235], v[8:11], v[92:95], v[232:235]
ds_read_b64_tr_b16 v[8:9], v0 offset:52640
ds_read_b64_tr_b16 v[10:11], v0 offset:53152
s_waitcnt lgkmcnt(4)
v_mfma_f32_16x16x32_bf16 v[228:231], v[12:15], v[88:91], v[228:231]
v_mfma_f32_16x16x32_bf16 v[236:239], v[12:15], v[92:95], v[236:239]
ds_read_b64_tr_b16 v[12:13], v0 offset:0
ds_read_b64_tr_b16 v[14:15], v0 offset:512
s_waitcnt lgkmcnt(4)
v_mfma_f32_16x16x32_bf16 v[240:243], v[4:7], v[88:91], v[240:243]
v_mfma_f32_16x16x32_bf16 v[248:251], v[4:7], v[92:95], v[248:251]
ds_read_b64_tr_b16 v[4:5], v0 offset:32
ds_read_b64_tr_b16 v[6:7], v0 offset:544
s_waitcnt lgkmcnt(4)
v_mfma_f32_16x16x32_bf16 v[244:247], v[8:11], v[88:91], v[244:247]
v_mfma_f32_16x16x32_bf16 v[252:255], v[8:11], v[92:95], v[252:255]
ds_read_b64_tr_b16 v[8:9], v0 offset:64
ds_read_b64_tr_b16 v[10:11], v0 offset:576
s_waitcnt lgkmcnt(4)
v_mfma_f32_16x16x32_bf16 v[48:51], v[12:15], v[96:99], v[48:51]
v_mfma_f32_16x16x32_bf16 v[56:59], v[12:15], v[100:103], v[56:59]
ds_read_b64_tr_b16 v[12:13], v0 offset:96
ds_read_b64_tr_b16 v[14:15], v0 offset:608
s_waitcnt lgkmcnt(4)
v_mfma_f32_16x16x32_bf16 v[52:55], v[4:7], v[96:99], v[52:55]
v_mfma_f32_16x16x32_bf16 v[60:63], v[4:7], v[100:103], v[60:63]
ds_read_b64_tr_b16 v[4:5], v0 offset:128
ds_read_b64_tr_b16 v[6:7], v0 offset:640
s_waitcnt lgkmcnt(4)
v_mfma_f32_16x16x32_bf16 v[208:211], v[8:11], v[96:99], v[208:211]
v_mfma_f32_16x16x32_bf16 v[216:219], v[8:11], v[100:103], v[216:219]
ds_read_b64_tr_b16 v[8:9], v0 offset:160
ds_read_b64_tr_b16 v[10:11], v0 offset:672
s_waitcnt lgkmcnt(4)
v_mfma_f32_16x16x32_bf16 v[212:215], v[12:15], v[96:99], v[212:215]
v_mfma_f32_16x16x32_bf16 v[220:223], v[12:15], v[100:103], v[220:223]
ds_read_b64_tr_b16 v[12:13], v0 offset:192
ds_read_b64_tr_b16 v[14:15], v0 offset:704
s_waitcnt lgkmcnt(4)
v_mfma_f32_16x16x32_bf16 v[224:227], v[4:7], v[96:99], v[224:227]
v_mfma_f32_16x16x32_bf16 v[232:235], v[4:7], v[100:103], v[232:235]
ds_read_b64_tr_b16 v[4:5], v0 offset:224
ds_read_b64_tr_b16 v[6:7], v0 offset:736
s_waitcnt lgkmcnt(4)
v_mfma_f32_16x16x32_bf16 v[228:231], v[8:11], v[96:99], v[228:231]
v_mfma_f32_16x16x32_bf16 v[236:239], v[8:11], v[100:103], v[236:239]
ds_read_b64_tr_b16 v[8:9], v0 offset:43680
ds_read_b64_tr_b16 v[10:11], v0 offset:44192
s_waitcnt lgkmcnt(4)
v_mfma_f32_16x16x32_bf16 v[240:243], v[12:15], v[96:99], v[240:243]
v_mfma_f32_16x16x32_bf16 v[248:251], v[12:15], v[100:103], v[248:251]
ds_read_b64_tr_b16 v[12:13], v0 offset:43712
ds_read_b64_tr_b16 v[14:15], v0 offset:44224
s_waitcnt lgkmcnt(4)
v_mfma_f32_16x16x32_bf16 v[244:247], v[4:7], v[96:99], v[244:247]
v_mfma_f32_16x16x32_bf16 v[252:255], v[4:7], v[100:103], v[252:255]
ds_read_b64_tr_b16 v[4:5], v0 offset:43744
ds_read_b64_tr_b16 v[6:7], v0 offset:44256
s_waitcnt lgkmcnt(4)
v_mfma_f32_16x16x32_bf16 v[48:51], v[8:11], v[104:107], v[48:51]
v_mfma_f32_16x16x32_bf16 v[56:59], v[8:11], v[108:111], v[56:59]
ds_read_b64_tr_b16 v[8:9], v0 offset:43776
ds_read_b64_tr_b16 v[10:11], v0 offset:44288
s_waitcnt lgkmcnt(4)
v_mfma_f32_16x16x32_bf16 v[52:55], v[12:15], v[104:107], v[52:55]
v_mfma_f32_16x16x32_bf16 v[60:63], v[12:15], v[108:111], v[60:63]
ds_read_b64_tr_b16 v[12:13], v0 offset:43808
ds_read_b64_tr_b16 v[14:15], v0 offset:44320
s_waitcnt lgkmcnt(4)
v_mfma_f32_16x16x32_bf16 v[208:211], v[4:7], v[104:107], v[208:211]
v_mfma_f32_16x16x32_bf16 v[216:219], v[4:7], v[108:111], v[216:219]
ds_read_b64_tr_b16 v[4:5], v0 offset:43840
ds_read_b64_tr_b16 v[6:7], v0 offset:44352
s_waitcnt lgkmcnt(4)
v_mfma_f32_16x16x32_bf16 v[212:215], v[8:11], v[104:107], v[212:215]
v_mfma_f32_16x16x32_bf16 v[220:223], v[8:11], v[108:111], v[220:223]
ds_read_b64_tr_b16 v[8:9], v0 offset:43872
ds_read_b64_tr_b16 v[10:11], v0 offset:44384
v_cvt_pk_bf16_f32 v16, v48, v49
v_cvt_pk_bf16_f32 v17, v50, v51
v_cvt_pk_bf16_f32 v18, v52, v53
v_cvt_pk_bf16_f32 v19, v54, v55
v_cvt_pk_bf16_f32 v20, v56, v57
v_cvt_pk_bf16_f32 v21, v58, v59
v_cvt_pk_bf16_f32 v22, v60, v61
v_cvt_pk_bf16_f32 v23, v62, v63
s_add_u32 s68, s78, 98304
buffer_store_dwordx4 v[16:19], v1, s[48:51], s68 offen offset:0 sc1
s_add_u32 s68, s78, 98304
buffer_store_dwordx4 v[20:23], v1, s[48:51], s68 offen offset:1024 sc1
s_waitcnt lgkmcnt(4)
v_mfma_f32_16x16x32_bf16 v[224:227], v[12:15], v[104:107], v[224:227]
v_mfma_f32_16x16x32_bf16 v[232:235], v[12:15], v[108:111], v[232:235]
ds_read_b64_tr_b16 v[12:13], v0 offset:43904
ds_read_b64_tr_b16 v[14:15], v0 offset:44416
s_waitcnt lgkmcnt(4)
v_mfma_f32_16x16x32_bf16 v[228:231], v[4:7], v[104:107], v[228:231]
v_mfma_f32_16x16x32_bf16 v[236:239], v[4:7], v[108:111], v[236:239]
v_cvt_pk_bf16_f32 v24, v208, v209
v_cvt_pk_bf16_f32 v25, v210, v211
v_cvt_pk_bf16_f32 v26, v212, v213
v_cvt_pk_bf16_f32 v27, v214, v215
v_cvt_pk_bf16_f32 v28, v216, v217
v_cvt_pk_bf16_f32 v29, v218, v219
v_cvt_pk_bf16_f32 v30, v220, v221
v_cvt_pk_bf16_f32 v31, v222, v223
s_add_u32 s68, s78, 98304
buffer_store_dwordx4 v[24:27], v1, s[48:51], s68 offen offset:2048 sc1
s_add_u32 s68, s78, 98304
buffer_store_dwordx4 v[28:31], v1, s[48:51], s68 offen offset:3072 sc1
s_waitcnt lgkmcnt(2)
v_mfma_f32_16x16x32_bf16 v[240:243], v[8:11], v[104:107], v[240:243]
v_mfma_f32_16x16x32_bf16 v[248:251], v[8:11], v[108:111], v[248:251]
s_waitcnt lgkmcnt(0)
v_mfma_f32_16x16x32_bf16 v[244:247], v[12:15], v[104:107], v[244:247]
v_mfma_f32_16x16x32_bf16 v[252:255], v[12:15], v[108:111], v[252:255]
v_cvt_pk_bf16_f32 v32, v224, v225
v_cvt_pk_bf16_f32 v33, v226, v227
v_cvt_pk_bf16_f32 v34, v228, v229
v_cvt_pk_bf16_f32 v35, v230, v231
v_cvt_pk_bf16_f32 v36, v232, v233
v_cvt_pk_bf16_f32 v37, v234, v235
v_cvt_pk_bf16_f32 v38, v236, v237
v_cvt_pk_bf16_f32 v39, v238, v239
s_add_u32 s68, s78, 102400
buffer_store_dwordx4 v[32:35], v1, s[48:51], s68 offen offset:0 sc1
s_add_u32 s68, s78, 102400
buffer_store_dwordx4 v[36:39], v1, s[48:51], s68 offen offset:1024 sc1
v_cvt_pk_bf16_f32 v40, v240, v241
v_cvt_pk_bf16_f32 v41, v242, v243
v_cvt_pk_bf16_f32 v42, v244, v245
v_cvt_pk_bf16_f32 v43, v246, v247
v_cvt_pk_bf16_f32 v44, v248, v249
v_cvt_pk_bf16_f32 v45, v250, v251
v_cvt_pk_bf16_f32 v46, v252, v253
v_cvt_pk_bf16_f32 v47, v254, v255
s_add_u32 s68, s78, 102400
buffer_store_dwordx4 v[40:43], v1, s[48:51], s68 offen offset:2048 sc1
s_add_u32 s68, s78, 102400
buffer_store_dwordx4 v[44:47], v1, s[48:51], s68 offen offset:3072 sc1
s_branch L_reduce
L_stage2_0:
s_lshl_b32 s78, s64, 4
s_add_u32 s78, s78, s65
s_lshl_b32 s78, s78, 3
s_add_u32 s78, s78, s66
s_mul_i32 s78, s78, 122880
s_add_u32 s78, s78, 262144
v_lshlrev_b32 v3, 4, v0
v_lshrrev_b32 v4, 2, v0
v_lshlrev_b32 v5, 7, v4
v_bfe_u32 v4, v4, 1, 2
v_and_b32 v6, 3, v0
v_lshl_add_u32 v5, v6, 3, v5
v_xor_b32 v6, 0, v4
v_lshl_add_u32 v1, v6, 5, v5
v_add_u32 v1, 53248, v1
v_xor_b32 v6, 1, v4
v_lshl_add_u32 v2, v6, 5, v5
v_add_u32 v2, 53248, v2
v_mov_b32 v0, v3
s_barrier
ds_read_b128 v[64:67], v0 offset:24576
ds_read_b128 v[68:71], v0 offset:25600
ds_read_b128 v[72:75], v0 offset:26624
ds_read_b128 v[76:79], v0 offset:27648
ds_read_b128 v[80:83], v0 offset:28672
ds_read_b128 v[84:87], v0 offset:29696
ds_read_b128 v[88:91], v0 offset:30720
ds_read_b128 v[92:95], v0 offset:31744
ds_read_b128 v[96:99], v0 offset:32768
ds_read_b128 v[100:103], v0 offset:33792
ds_read_b128 v[104:107], v0 offset:34816
ds_read_b128 v[108:111], v0 offset:35840
ds_read_b128 v[112:115], v0 offset:36864
ds_read_b128 v[116:119], v0 offset:37888
ds_read_b128 v[120:123], v0 offset:38912
ds_read_b128 v[124:127], v0 offset:39936
ds_read_b128 v[128:131], v0 offset:40960
ds_read_b128 v[132:135], v0 offset:41984
ds_read_b128 v[136:139], v0 offset:43008
ds_read_b128 v[140:143], v0 offset:44032
ds_read_b128 v[144:147], v0 offset:45056
ds_read_b128 v[148:151], v0 offset:46080
ds_read_b128 v[152:155], v0 offset:47104
ds_read_b128 v[156:159], v0 offset:48128
ds_read_b128 v[160:163], v0 offset:49152
ds_read_b128 v[164:167], v0 offset:50176
ds_read_b128 v[168:171], v0 offset:51200
ds_read_b128 v[172:175], v0 offset:52224
ds_read_b128 v[176:179], v0 offset:53248
ds_read_b128 v[180:183], v0 offset:54272
ds_read_b128 v[184:187], v0 offset:55296
ds_read_b128 v[188:191], v0 offset:56320
ds_read_b128 v[192:195], v0 offset:57344
ds_read_b128 v[196:199], v0 offset:58368
ds_read_b128 v[200:203], v0 offset:59392
ds_read_b128 v[204:207], v0 offset:60416
s_waitcnt lgkmcnt(0)
s_setprio 0
s_barrier
ds_read_b128 v[16:19], v0 offset:0
ds_read_b128 v[20:23], v0 offset:1024
ds_read_b128 v[24:27], v0 offset:2048
ds_read_b128 v[28:31], v0 offset:3072
ds_read_b128 v[32:35], v0 offset:4096
ds_read_b128 v[36:39], v0 offset:5120
ds_read_b64_tr_b16 v[4:5], v1 offset:24576
ds_read_b64_tr_b16 v[6:7], v1 offset:26624
ds_read_b64_tr_b16 v[8:9], v2 offset:24576
ds_read_b64_tr_b16 v[10:11], v2 offset:26624
ds_read_b64_tr_b16 v[12:13], v1 offset:28672
ds_read_b64_tr_b16 v[14:15], v1 offset:30720
s_waitcnt lgkmcnt(6)
v_lshlrev_b32 v208, 16, v16
v_and_b32 v209, 0xffff0000, v16
v_lshlrev_b32 v210, 16, v17
v_and_b32 v211, 0xffff0000, v17
v_lshlrev_b32 v212, 16, v18
v_and_b32 v213, 0xffff0000, v18
v_lshlrev_b32 v214, 16, v19
v_and_b32 v215, 0xffff0000, v19
v_lshlrev_b32 v216, 16, v20
v_and_b32 v217, 0xffff0000, v20
v_lshlrev_b32 v218, 16, v21
v_and_b32 v219, 0xffff0000, v21
v_lshlrev_b32 v220, 16, v22
v_and_b32 v221, 0xffff0000, v22
v_lshlrev_b32 v222, 16, v23
v_and_b32 v223, 0xffff0000, v23
v_lshlrev_b32 v224, 16, v24
v_and_b32 v225, 0xffff0000, v24
v_lshlrev_b32 v226, 16, v25
v_and_b32 v227, 0xffff0000, v25
v_lshlrev_b32 v228, 16, v26
v_and_b32 v229, 0xffff0000, v26
v_lshlrev_b32 v230, 16, v27
v_and_b32 v231, 0xffff0000, v27
v_lshlrev_b32 v232, 16, v28
v_and_b32 v233, 0xffff0000, v28
v_lshlrev_b32 v234, 16, v29
v_and_b32 v235, 0xffff0000, v29
v_lshlrev_b32 v236, 16, v30
v_and_b32 v237, 0xffff0000, v30
v_lshlrev_b32 v238, 16, v31
v_and_b32 v239, 0xffff0000, v31
v_lshlrev_b32 v240, 16, v32
v_and_b32 v241, 0xffff0000, v32
v_lshlrev_b32 v242, 16, v33
v_and_b32 v243, 0xffff0000, v33
v_lshlrev_b32 v244, 16, v34
v_and_b32 v245, 0xffff0000, v34
v_lshlrev_b32 v246, 16, v35
v_and_b32 v247, 0xffff0000, v35
v_lshlrev_b32 v248, 16, v36
v_and_b32 v249, 0xffff0000, v36
v_lshlrev_b32 v250, 16, v37
v_and_b32 v251, 0xffff0000, v37
v_lshlrev_b32 v252, 16, v38
v_and_b32 v253, 0xffff0000, v38
v_lshlrev_b32 v254, 16, v39
v_and_b32 v255, 0xffff0000, v39
s_waitcnt lgkmcnt(4)
v_mfma_f32_16x16x32_bf16 v[208:211], v[4:7], v[64:67], v[208:211]
v_mfma_f32_16x16x32_bf16 v[216:219], v[4:7], v[68:71], v[216:219]
v_mfma_f32_16x16x32_bf16 v[224:227], v[4:7], v[112:115], v[224:227]
v_mfma_f32_16x16x32_bf16 v[232:235], v[4:7], v[116:119], v[232:235]
v_mfma_f32_16x16x32_bf16 v[240:243], v[4:7], v[160:163], v[240:243]
v_mfma_f32_16x16x32_bf16 v[248:251], v[4:7], v[164:167], v[248:251]
ds_read_b64_tr_b16 v[4:5], v2 offset:28672
ds_read_b64_tr_b16 v[6:7], v2 offset:30720
s_waitcnt lgkmcnt(4)
v_mfma_f32_16x16x32_bf16 v[212:215], v[8:11], v[64:67], v[212:215]
v_mfma_f32_16x16x32_bf16 v[220:223], v[8:11], v[68:71], v[220:223]
v_mfma_f32_16x16x32_bf16 v[228:231], v[8:11], v[112:115], v[228:231]
v_mfma_f32_16x16x32_bf16 v[236:239], v[8:11], v[116:119], v[236:239]
v_mfma_f32_16x16x32_bf16 v[244:247], v[8:11], v[160:163], v[244:247]
v_mfma_f32_16x16x32_bf16 v[252:255], v[8:11], v[164:167], v[252:255]
ds_read_b64_tr_b16 v[8:9], v1 offset:32768
ds_read_b64_tr_b16 v[10:11], v1 offset:34816
s_waitcnt lgkmcnt(4)
v_mfma_f32_16x16x32_bf16 v[208:211], v[12:15], v[72:75], v[208:211]
v_mfma_f32_16x16x32_bf16 v[216:219], v[12:15], v[76:79], v[216:219]
v_mfma_f32_16x16x32_bf16 v[224:227], v[12:15], v[120:123], v[224:227]
v_mfma_f32_16x16x32_bf16 v[232:235], v[12:15], v[124:127], v[232:235]
v_mfma_f32_16x16x32_bf16 v[240:243], v[12:15], v[168:171], v[240:243]
v_mfma_f32_16x16x32_bf16 v[248:251], v[12:15], v[172:175], v[248:251]
ds_read_b64_tr_b16 v[12:13], v2 offset:32768
ds_read_b64_tr_b16 v[14:15], v2 offset:34816
s_waitcnt lgkmcnt(4)
v_mfma_f32_16x16x32_bf16 v[212:215], v[4:7], v[72:75], v[212:215]
v_mfma_f32_16x16x32_bf16 v[220:223], v[4:7], v[76:79], v[220:223]
v_mfma_f32_16x16x32_bf16 v[228:231], v[4:7], v[120:123], v[228:231]
v_mfma_f32_16x16x32_bf16 v[236:239], v[4:7], v[124:127], v[236:239]
v_mfma_f32_16x16x32_bf16 v[244:247], v[4:7], v[168:171], v[244:247]
v_mfma_f32_16x16x32_bf16 v[252:255], v[4:7], v[172:175], v[252:255]
ds_read_b64_tr_b16 v[4:5], v1 offset:36864
ds_read_b64_tr_b16 v[6:7], v1 offset:38912
s_waitcnt lgkmcnt(4)
v_mfma_f32_16x16x32_bf16 v[208:211], v[8:11], v[80:83], v[208:211]
v_mfma_f32_16x16x32_bf16 v[216:219], v[8:11], v[84:87], v[216:219]
v_mfma_f32_16x16x32_bf16 v[224:227], v[8:11], v[128:131], v[224:227]
v_mfma_f32_16x16x32_bf16 v[232:235], v[8:11], v[132:135], v[232:235]
v_mfma_f32_16x16x32_bf16 v[240:243], v[8:11], v[176:179], v[240:243]
v_mfma_f32_16x16x32_bf16 v[248:251], v[8:11], v[180:183], v[248:251]
ds_read_b64_tr_b16 v[8:9], v2 offset:36864
ds_read_b64_tr_b16 v[10:11], v2 offset:38912
s_waitcnt lgkmcnt(4)
v_mfma_f32_16x16x32_bf16 v[212:215], v[12:15], v[80:83], v[212:215]
v_mfma_f32_16x16x32_bf16 v[220:223], v[12:15], v[84:87], v[220:223]
v_mfma_f32_16x16x32_bf16 v[228:231], v[12:15], v[128:131], v[228:231]
v_mfma_f32_16x16x32_bf16 v[236:239], v[12:15], v[132:135], v[236:239]
v_mfma_f32_16x16x32_bf16 v[244:247], v[12:15], v[176:179], v[244:247]
v_mfma_f32_16x16x32_bf16 v[252:255], v[12:15], v[180:183], v[252:255]
ds_read_b64_tr_b16 v[12:13], v1 offset:40960
ds_read_b64_tr_b16 v[14:15], v1 offset:43008
s_barrier
s_waitcnt lgkmcnt(4)
v_mfma_f32_16x16x32_bf16 v[208:211], v[4:7], v[88:91], v[208:211]
v_mfma_f32_16x16x32_bf16 v[216:219], v[4:7], v[92:95], v[216:219]
v_mfma_f32_16x16x32_bf16 v[224:227], v[4:7], v[136:139], v[224:227]
v_mfma_f32_16x16x32_bf16 v[232:235], v[4:7], v[140:143], v[232:235]
v_mfma_f32_16x16x32_bf16 v[240:243], v[4:7], v[184:187], v[240:243]
v_mfma_f32_16x16x32_bf16 v[248:251], v[4:7], v[188:191], v[248:251]
ds_read_b64_tr_b16 v[4:5], v2 offset:40960
ds_read_b64_tr_b16 v[6:7], v2 offset:43008
s_waitcnt lgkmcnt(4)
v_mfma_f32_16x16x32_bf16 v[212:215], v[8:11], v[88:91], v[212:215]
v_mfma_f32_16x16x32_bf16 v[220:223], v[8:11], v[92:95], v[220:223]
v_mfma_f32_16x16x32_bf16 v[228:231], v[8:11], v[136:139], v[228:231]
v_mfma_f32_16x16x32_bf16 v[236:239], v[8:11], v[140:143], v[236:239]
v_mfma_f32_16x16x32_bf16 v[244:247], v[8:11], v[184:187], v[244:247]
v_mfma_f32_16x16x32_bf16 v[252:255], v[8:11], v[188:191], v[252:255]
ds_read_b64_tr_b16 v[8:9], v1 offset:45056
ds_read_b64_tr_b16 v[10:11], v1 offset:47104
ds_read_b128 v[16:19], v0 offset:12288
ds_read_b128 v[20:23], v0 offset:13312
ds_read_b128 v[24:27], v0 offset:14336
ds_read_b128 v[28:31], v0 offset:15360
ds_read_b128 v[32:35], v0 offset:16384
ds_read_b128 v[36:39], v0 offset:17408
s_waitcnt lgkmcnt(10)
v_mfma_f32_16x16x32_bf16 v[208:211], v[12:15], v[96:99], v[208:211]
v_mfma_f32_16x16x32_bf16 v[216:219], v[12:15], v[100:103], v[216:219]
v_mfma_f32_16x16x32_bf16 v[224:227], v[12:15], v[144:147], v[224:227]
v_mfma_f32_16x16x32_bf16 v[232:235], v[12:15], v[148:151], v[232:235]
v_mfma_f32_16x16x32_bf16 v[240:243], v[12:15], v[192:195], v[240:243]
v_mfma_f32_16x16x32_bf16 v[248:251], v[12:15], v[196:199], v[248:251]
ds_read_b64_tr_b16 v[12:13], v2 offset:45056
ds_read_b64_tr_b16 v[14:15], v2 offset:47104
s_waitcnt lgkmcnt(10)
v_mfma_f32_16x16x32_bf16 v[212:215], v[4:7], v[96:99], v[212:215]
v_mfma_f32_16x16x32_bf16 v[220:223], v[4:7], v[100:103], v[220:223]
v_mfma_f32_16x16x32_bf16 v[228:231], v[4:7], v[144:147], v[228:231]
v_mfma_f32_16x16x32_bf16 v[236:239], v[4:7], v[148:151], v[236:239]
v_mfma_f32_16x16x32_bf16 v[244:247], v[4:7], v[192:195], v[244:247]
v_mfma_f32_16x16x32_bf16 v[252:255], v[4:7], v[196:199], v[252:255]
ds_read_b64_tr_b16 v[4:5], v1 offset:8192
ds_read_b64_tr_b16 v[6:7], v1 offset:10240
s_waitcnt lgkmcnt(10)
v_mfma_f32_16x16x32_bf16 v[208:211], v[8:11], v[104:107], v[208:211]
v_mfma_f32_16x16x32_bf16 v[216:219], v[8:11], v[108:111], v[216:219]
v_mfma_f32_16x16x32_bf16 v[224:227], v[8:11], v[152:155], v[224:227]
v_mfma_f32_16x16x32_bf16 v[232:235], v[8:11], v[156:159], v[232:235]
v_mfma_f32_16x16x32_bf16 v[240:243], v[8:11], v[200:203], v[240:243]
v_mfma_f32_16x16x32_bf16 v[248:251], v[8:11], v[204:207], v[248:251]
ds_read_b64_tr_b16 v[8:9], v2 offset:8192
ds_read_b64_tr_b16 v[10:11], v2 offset:10240
s_waitcnt lgkmcnt(6)
s_barrier
s_waitcnt lgkmcnt(4)
v_mfma_f32_16x16x32_bf16 v[212:215], v[12:15], v[104:107], v[212:215]
v_mfma_f32_16x16x32_bf16 v[220:223], v[12:15], v[108:111], v[220:223]
v_mfma_f32_16x16x32_bf16 v[228:231], v[12:15], v[152:155], v[228:231]
v_mfma_f32_16x16x32_bf16 v[236:239], v[12:15], v[156:159], v[236:239]
v_mfma_f32_16x16x32_bf16 v[244:247], v[12:15], v[200:203], v[244:247]
v_mfma_f32_16x16x32_bf16 v[252:255], v[12:15], v[204:207], v[252:255]
ds_read_b64_tr_b16 v[12:13], v1 offset:12288
ds_read_b64_tr_b16 v[14:15], v1 offset:14336
v_cvt_pk_bf16_f32 v40, v208, v209
v_cvt_pk_bf16_f32 v41, v210, v211
v_cvt_pk_bf16_f32 v42, v212, v213
v_cvt_pk_bf16_f32 v43, v214, v215
v_cvt_pk_bf16_f32 v44, v216, v217
v_cvt_pk_bf16_f32 v45, v218, v219
v_cvt_pk_bf16_f32 v46, v220, v221
v_cvt_pk_bf16_f32 v47, v222, v223
v_cvt_pk_bf16_f32 v48, v224, v225
v_cvt_pk_bf16_f32 v49, v226, v227
v_cvt_pk_bf16_f32 v50, v228, v229
v_cvt_pk_bf16_f32 v51, v230, v231
v_cvt_pk_bf16_f32 v52, v232, v233
v_cvt_pk_bf16_f32 v53, v234, v235
v_cvt_pk_bf16_f32 v54, v236, v237
v_cvt_pk_bf16_f32 v55, v238, v239
v_cvt_pk_bf16_f32 v56, v240, v241
v_cvt_pk_bf16_f32 v57, v242, v243
v_cvt_pk_bf16_f32 v58, v244, v245
v_cvt_pk_bf16_f32 v59, v246, v247
v_cvt_pk_bf16_f32 v60, v248, v249
v_cvt_pk_bf16_f32 v61, v250, v251
v_cvt_pk_bf16_f32 v62, v252, v253
v_cvt_pk_bf16_f32 v63, v254, v255
s_add_u32 s68, s78, 0
buffer_store_dwordx4 v[40:43], v0, s[48:51], s68 offen offset:0 sc1
v_lshlrev_b32 v208, 16, v16
v_and_b32 v209, 0xffff0000, v16
v_lshlrev_b32 v210, 16, v17
v_and_b32 v211, 0xffff0000, v17
v_lshlrev_b32 v212, 16, v18
v_and_b32 v213, 0xffff0000, v18
v_lshlrev_b32 v214, 16, v19
v_and_b32 v215, 0xffff0000, v19
v_lshlrev_b32 v216, 16, v20
v_and_b32 v217, 0xffff0000, v20
v_lshlrev_b32 v218, 16, v21
v_and_b32 v219, 0xffff0000, v21
v_lshlrev_b32 v220, 16, v22
v_and_b32 v221, 0xffff0000, v22
v_lshlrev_b32 v222, 16, v23
v_and_b32 v223, 0xffff0000, v23
v_lshlrev_b32 v224, 16, v24
v_and_b32 v225, 0xffff0000, v24
v_lshlrev_b32 v226, 16, v25
v_and_b32 v227, 0xffff0000, v25
v_lshlrev_b32 v228, 16, v26
v_and_b32 v229, 0xffff0000, v26
v_lshlrev_b32 v230, 16, v27
v_and_b32 v231, 0xffff0000, v27
v_lshlrev_b32 v232, 16, v28
v_and_b32 v233, 0xffff0000, v28
v_lshlrev_b32 v234, 16, v29
v_and_b32 v235, 0xffff0000, v29
v_lshlrev_b32 v236, 16, v30
v_and_b32 v237, 0xffff0000, v30
v_lshlrev_b32 v238, 16, v31
v_and_b32 v239, 0xffff0000, v31
v_lshlrev_b32 v240, 16, v32
v_and_b32 v241, 0xffff0000, v32
v_lshlrev_b32 v242, 16, v33
v_and_b32 v243, 0xffff0000, v33
v_lshlrev_b32 v244, 16, v34
v_and_b32 v245, 0xffff0000, v34
v_lshlrev_b32 v246, 16, v35
v_and_b32 v247, 0xffff0000, v35
v_lshlrev_b32 v248, 16, v36
v_and_b32 v249, 0xffff0000, v36
v_lshlrev_b32 v250, 16, v37
v_and_b32 v251, 0xffff0000, v37
v_lshlrev_b32 v252, 16, v38
v_and_b32 v253, 0xffff0000, v38
v_lshlrev_b32 v254, 16, v39
v_and_b32 v255, 0xffff0000, v39
s_waitcnt lgkmcnt(4)
v_mfma_f32_16x16x32_bf16 v[208:211], v[4:7], v[64:67], v[208:211]
v_mfma_f32_16x16x32_bf16 v[216:219], v[4:7], v[68:71], v[216:219]
v_mfma_f32_16x16x32_bf16 v[224:227], v[4:7], v[112:115], v[224:227]
v_mfma_f32_16x16x32_bf16 v[232:235], v[4:7], v[116:119], v[232:235]
v_mfma_f32_16x16x32_bf16 v[240:243], v[4:7], v[160:163], v[240:243]
v_mfma_f32_16x16x32_bf16 v[248:251], v[4:7], v[164:167], v[248:251]
ds_read_b64_tr_b16 v[4:5], v2 offset:12288
ds_read_b64_tr_b16 v[6:7], v2 offset:14336
s_add_u32 s68, s78, 0
buffer_store_dwordx4 v[44:47], v0, s[48:51], s68 offen offset:1024 sc1
s_barrier
s_waitcnt lgkmcnt(4)
v_mfma_f32_16x16x32_bf16 v[212:215], v[8:11], v[64:67], v[212:215]
v_mfma_f32_16x16x32_bf16 v[220:223], v[8:11], v[68:71], v[220:223]
v_mfma_f32_16x16x32_bf16 v[228:231], v[8:11], v[112:115], v[228:231]
v_mfma_f32_16x16x32_bf16 v[236:239], v[8:11], v[116:119], v[236:239]
v_mfma_f32_16x16x32_bf16 v[244:247], v[8:11], v[160:163], v[244:247]
v_mfma_f32_16x16x32_bf16 v[252:255], v[8:11], v[164:167], v[252:255]
ds_read_b64_tr_b16 v[8:9], v1 offset:16384
ds_read_b64_tr_b16 v[10:11], v1 offset:18432
s_waitcnt lgkmcnt(4)
v_mfma_f32_16x16x32_bf16 v[208:211], v[12:15], v[72:75], v[208:211]
v_mfma_f32_16x16x32_bf16 v[216:219], v[12:15], v[76:79], v[216:219]
v_mfma_f32_16x16x32_bf16 v[224:227], v[12:15], v[120:123], v[224:227]
v_mfma_f32_16x16x32_bf16 v[232:235], v[12:15], v[124:127], v[232:235]
v_mfma_f32_16x16x32_bf16 v[240:243], v[12:15], v[168:171], v[240:243]
v_mfma_f32_16x16x32_bf16 v[248:251], v[12:15], v[172:175], v[248:251]
ds_read_b64_tr_b16 v[12:13], v2 offset:16384
ds_read_b64_tr_b16 v[14:15], v2 offset:18432
s_waitcnt lgkmcnt(4)
v_mfma_f32_16x16x32_bf16 v[212:215], v[4:7], v[72:75], v[212:215]
v_mfma_f32_16x16x32_bf16 v[220:223], v[4:7], v[76:79], v[220:223]
v_mfma_f32_16x16x32_bf16 v[228:231], v[4:7], v[120:123], v[228:231]
v_mfma_f32_16x16x32_bf16 v[236:239], v[4:7], v[124:127], v[236:239]
v_mfma_f32_16x16x32_bf16 v[244:247], v[4:7], v[168:171], v[244:247]
v_mfma_f32_16x16x32_bf16 v[252:255], v[4:7], v[172:175], v[252:255]
ds_read_b64_tr_b16 v[4:5], v1 offset:20480
ds_read_b64_tr_b16 v[6:7], v1 offset:22528
s_waitcnt lgkmcnt(4)
v_mfma_f32_16x16x32_bf16 v[208:211], v[8:11], v[80:83], v[208:211]
v_mfma_f32_16x16x32_bf16 v[216:219], v[8:11], v[84:87], v[216:219]
v_mfma_f32_16x16x32_bf16 v[224:227], v[8:11], v[128:131], v[224:227]
v_mfma_f32_16x16x32_bf16 v[232:235], v[8:11], v[132:135], v[232:235]
v_mfma_f32_16x16x32_bf16 v[240:243], v[8:11], v[176:179], v[240:243]
v_mfma_f32_16x16x32_bf16 v[248:251], v[8:11], v[180:183], v[248:251]
ds_read_b64_tr_b16 v[8:9], v2 offset:20480
ds_read_b64_tr_b16 v[10:11], v2 offset:22528
s_add_u32 s68, s78, 8192
buffer_store_dwordx4 v[48:51], v0, s[48:51], s68 offen offset:0 sc1
s_waitcnt lgkmcnt(4)
v_mfma_f32_16x16x32_bf16 v[212:215], v[12:15], v[80:83], v[212:215]
v_mfma_f32_16x16x32_bf16 v[220:223], v[12:15], v[84:87], v[220:223]
v_mfma_f32_16x16x32_bf16 v[228:231], v[12:15], v[128:131], v[228:231]
v_mfma_f32_16x16x32_bf16 v[236:239], v[12:15], v[132:135], v[236:239]
v_mfma_f32_16x16x32_bf16 v[244:247], v[12:15], v[176:179], v[244:247]
v_mfma_f32_16x16x32_bf16 v[252:255], v[12:15], v[180:183], v[252:255]
ds_read_b64_tr_b16 v[12:13], v1 offset:0
ds_read_b64_tr_b16 v[14:15], v1 offset:2048
s_waitcnt lgkmcnt(4)
v_mfma_f32_16x16x32_bf16 v[208:211], v[4:7], v[88:91], v[208:211]
v_mfma_f32_16x16x32_bf16 v[216:219], v[4:7], v[92:95], v[216:219]
v_mfma_f32_16x16x32_bf16 v[224:227], v[4:7], v[136:139], v[224:227]
v_mfma_f32_16x16x32_bf16 v[232:235], v[4:7], v[140:143], v[232:235]
v_mfma_f32_16x16x32_bf16 v[240:243], v[4:7], v[184:187], v[240:243]
v_mfma_f32_16x16x32_bf16 v[248:251], v[4:7], v[188:191], v[248:251]
ds_read_b64_tr_b16 v[4:5], v2 offset:0
ds_read_b64_tr_b16 v[6:7], v2 offset:2048
s_add_u32 s68, s78, 8192
buffer_store_dwordx4 v[52:55], v0, s[48:51], s68 offen offset:1024 sc1
s_waitcnt lgkmcnt(4)
v_mfma_f32_16x16x32_bf16 v[212:215], v[8:11], v[88:91], v[212:215]
v_mfma_f32_16x16x32_bf16 v[220:223], v[8:11], v[92:95], v[220:223]
v_mfma_f32_16x16x32_bf16 v[228:231], v[8:11], v[136:139], v[228:231]
v_mfma_f32_16x16x32_bf16 v[236:239], v[8:11], v[140:143], v[236:239]
v_mfma_f32_16x16x32_bf16 v[244:247], v[8:11], v[184:187], v[244:247]
v_mfma_f32_16x16x32_bf16 v[252:255], v[8:11], v[188:191], v[252:255]
ds_read_b64_tr_b16 v[8:9], v1 offset:4096
ds_read_b64_tr_b16 v[10:11], v1 offset:6144
ds_read_b128 v[16:19], v0 offset:0
ds_read_b128 v[20:23], v0 offset:1024
ds_read_b128 v[24:27], v0 offset:2048
ds_read_b128 v[28:31], v0 offset:3072
ds_read_b128 v[32:35], v0 offset:4096
ds_read_b128 v[36:39], v0 offset:5120
s_add_u32 s68, s78, 16384
buffer_store_dwordx4 v[56:59], v0, s[48:51], s68 offen offset:0 sc1
s_waitcnt lgkmcnt(0)
s_barrier
v_mfma_f32_16x16x32_bf16 v[208:211], v[12:15], v[96:99], v[208:211]
v_mfma_f32_16x16x32_bf16 v[216:219], v[12:15], v[100:103], v[216:219]
v_mfma_f32_16x16x32_bf16 v[224:227], v[12:15], v[144:147], v[224:227]
v_mfma_f32_16x16x32_bf16 v[232:235], v[12:15], v[148:151], v[232:235]
v_mfma_f32_16x16x32_bf16 v[240:243], v[12:15], v[192:195], v[240:243]
v_mfma_f32_16x16x32_bf16 v[248:251], v[12:15], v[196:199], v[248:251]
ds_read_b64_tr_b16 v[12:13], v2 offset:4096
ds_read_b64_tr_b16 v[14:15], v2 offset:6144
v_mfma_f32_16x16x32_bf16 v[212:215], v[4:7], v[96:99], v[212:215]
v_mfma_f32_16x16x32_bf16 v[220:223], v[4:7], v[100:103], v[220:223]
v_mfma_f32_16x16x32_bf16 v[228:231], v[4:7], v[144:147], v[228:231]
v_mfma_f32_16x16x32_bf16 v[236:239], v[4:7], v[148:151], v[236:239]
v_mfma_f32_16x16x32_bf16 v[244:247], v[4:7], v[192:195], v[244:247]
v_mfma_f32_16x16x32_bf16 v[252:255], v[4:7], v[196:199], v[252:255]
ds_read_b64_tr_b16 v[4:5], v1 offset:24576
ds_read_b64_tr_b16 v[6:7], v1 offset:26624
s_add_u32 s68, s78, 16384
buffer_store_dwordx4 v[60:63], v0, s[48:51], s68 offen offset:1024 sc1
v_mfma_f32_16x16x32_bf16 v[208:211], v[8:11], v[104:107], v[208:211]
v_mfma_f32_16x16x32_bf16 v[216:219], v[8:11], v[108:111], v[216:219]
v_mfma_f32_16x16x32_bf16 v[224:227], v[8:11], v[152:155], v[224:227]
v_mfma_f32_16x16x32_bf16 v[232:235], v[8:11], v[156:159], v[232:235]
v_mfma_f32_16x16x32_bf16 v[240:243], v[8:11], v[200:203], v[240:243]
v_mfma_f32_16x16x32_bf16 v[248:251], v[8:11], v[204:207], v[248:251]
ds_read_b64_tr_b16 v[8:9], v2 offset:24576
ds_read_b64_tr_b16 v[10:11], v2 offset:26624
s_waitcnt lgkmcnt(4)
v_mfma_f32_16x16x32_bf16 v[212:215], v[12:15], v[104:107], v[212:215]
v_mfma_f32_16x16x32_bf16 v[220:223], v[12:15], v[108:111], v[220:223]
v_mfma_f32_16x16x32_bf16 v[228:231], v[12:15], v[152:155], v[228:231]
v_mfma_f32_16x16x32_bf16 v[236:239], v[12:15], v[156:159], v[236:239]
v_mfma_f32_16x16x32_bf16 v[244:247], v[12:15], v[200:203], v[244:247]
v_mfma_f32_16x16x32_bf16 v[252:255], v[12:15], v[204:207], v[252:255]
ds_read_b64_tr_b16 v[12:13], v1 offset:28672
ds_read_b64_tr_b16 v[14:15], v1 offset:30720
v_cvt_pk_bf16_f32 v40, v208, v209
v_cvt_pk_bf16_f32 v41, v210, v211
v_cvt_pk_bf16_f32 v42, v212, v213
v_cvt_pk_bf16_f32 v43, v214, v215
v_cvt_pk_bf16_f32 v44, v216, v217
v_cvt_pk_bf16_f32 v45, v218, v219
v_cvt_pk_bf16_f32 v46, v220, v221
v_cvt_pk_bf16_f32 v47, v222, v223
v_cvt_pk_bf16_f32 v48, v224, v225
v_cvt_pk_bf16_f32 v49, v226, v227
v_cvt_pk_bf16_f32 v50, v228, v229
v_cvt_pk_bf16_f32 v51, v230, v231
v_cvt_pk_bf16_f32 v52, v232, v233
v_cvt_pk_bf16_f32 v53, v234, v235
v_cvt_pk_bf16_f32 v54, v236, v237
v_cvt_pk_bf16_f32 v55, v238, v239
v_cvt_pk_bf16_f32 v56, v240, v241
v_cvt_pk_bf16_f32 v57, v242, v243
v_cvt_pk_bf16_f32 v58, v244, v245
v_cvt_pk_bf16_f32 v59, v246, v247
v_cvt_pk_bf16_f32 v60, v248, v249
v_cvt_pk_bf16_f32 v61, v250, v251
v_cvt_pk_bf16_f32 v62, v252, v253
v_cvt_pk_bf16_f32 v63, v254, v255
s_add_u32 s68, s78, 4096
buffer_store_dwordx4 v[40:43], v0, s[48:51], s68 offen offset:0 sc1
s_barrier
v_lshlrev_b32 v208, 16, v16
v_and_b32 v209, 0xffff0000, v16
v_lshlrev_b32 v210, 16, v17
v_and_b32 v211, 0xffff0000, v17
v_lshlrev_b32 v212, 16, v18
v_and_b32 v213, 0xffff0000, v18
v_lshlrev_b32 v214, 16, v19
v_and_b32 v215, 0xffff0000, v19
v_lshlrev_b32 v216, 16, v20
v_and_b32 v217, 0xffff0000, v20
v_lshlrev_b32 v218, 16, v21
v_and_b32 v219, 0xffff0000, v21
v_lshlrev_b32 v220, 16, v22
v_and_b32 v221, 0xffff0000, v22
v_lshlrev_b32 v222, 16, v23
v_and_b32 v223, 0xffff0000, v23
v_lshlrev_b32 v224, 16, v24
v_and_b32 v225, 0xffff0000, v24
v_lshlrev_b32 v226, 16, v25
v_and_b32 v227, 0xffff0000, v25
v_lshlrev_b32 v228, 16, v26
v_and_b32 v229, 0xffff0000, v26
v_lshlrev_b32 v230, 16, v27
v_and_b32 v231, 0xffff0000, v27
v_lshlrev_b32 v232, 16, v28
v_and_b32 v233, 0xffff0000, v28
v_lshlrev_b32 v234, 16, v29
v_and_b32 v235, 0xffff0000, v29
v_lshlrev_b32 v236, 16, v30
v_and_b32 v237, 0xffff0000, v30
v_lshlrev_b32 v238, 16, v31
v_and_b32 v239, 0xffff0000, v31
v_lshlrev_b32 v240, 16, v32
v_and_b32 v241, 0xffff0000, v32
v_lshlrev_b32 v242, 16, v33
v_and_b32 v243, 0xffff0000, v33
v_lshlrev_b32 v244, 16, v34
v_and_b32 v245, 0xffff0000, v34
v_lshlrev_b32 v246, 16, v35
v_and_b32 v247, 0xffff0000, v35
v_lshlrev_b32 v248, 16, v36
v_and_b32 v249, 0xffff0000, v36
v_lshlrev_b32 v250, 16, v37
v_and_b32 v251, 0xffff0000, v37
v_lshlrev_b32 v252, 16, v38
v_and_b32 v253, 0xffff0000, v38
v_lshlrev_b32 v254, 16, v39
v_and_b32 v255, 0xffff0000, v39
s_waitcnt lgkmcnt(4)
v_mfma_f32_16x16x32_bf16 v[208:211], v[4:7], v[64:67], v[208:211]
v_mfma_f32_16x16x32_bf16 v[216:219], v[4:7], v[68:71], v[216:219]
v_mfma_f32_16x16x32_bf16 v[224:227], v[4:7], v[112:115], v[224:227]
v_mfma_f32_16x16x32_bf16 v[232:235], v[4:7], v[116:119], v[232:235]
v_mfma_f32_16x16x32_bf16 v[240:243], v[4:7], v[160:163], v[240:243]
v_mfma_f32_16x16x32_bf16 v[248:251], v[4:7], v[164:167], v[248:251]
ds_read_b64_tr_b16 v[4:5], v2 offset:28672
ds_read_b64_tr_b16 v[6:7], v2 offset:30720
s_waitcnt lgkmcnt(4)
v_mfma_f32_16x16x32_bf16 v[212:215], v[8:11], v[64:67], v[212:215]
v_mfma_f32_16x16x32_bf16 v[220:223], v[8:11], v[68:71], v[220:223]
v_mfma_f32_16x16x32_bf16 v[228:231], v[8:11], v[112:115], v[228:231]
v_mfma_f32_16x16x32_bf16 v[236:239], v[8:11], v[116:119], v[236:239]
v_mfma_f32_16x16x32_bf16 v[244:247], v[8:11], v[160:163], v[244:247]
v_mfma_f32_16x16x32_bf16 v[252:255], v[8:11], v[164:167], v[252:255]
ds_read_b64_tr_b16 v[8:9], v1 offset:32768
ds_read_b64_tr_b16 v[10:11], v1 offset:34816
s_add_u32 s68, s78, 4096
buffer_store_dwordx4 v[44:47], v0, s[48:51], s68 offen offset:1024 sc1
s_waitcnt lgkmcnt(4)
v_mfma_f32_16x16x32_bf16 v[208:211], v[12:15], v[72:75], v[208:211]
v_mfma_f32_16x16x32_bf16 v[216:219], v[12:15], v[76:79], v[216:219]
v_mfma_f32_16x16x32_bf16 v[224:227], v[12:15], v[120:123], v[224:227]
v_mfma_f32_16x16x32_bf16 v[232:235], v[12:15], v[124:127], v[232:235]
v_mfma_f32_16x16x32_bf16 v[240:243], v[12:15], v[168:171], v[240:243]
v_mfma_f32_16x16x32_bf16 v[248:251], v[12:15], v[172:175], v[248:251]
ds_read_b64_tr_b16 v[12:13], v2 offset:32768
ds_read_b64_tr_b16 v[14:15], v2 offset:34816
s_add_u32 s68, s78, 12288
buffer_store_dwordx4 v[48:51], v0, s[48:51], s68 offen offset:0 sc1
s_barrier
s_waitcnt lgkmcnt(4)
v_mfma_f32_16x16x32_bf16 v[212:215], v[4:7], v[72:75], v[212:215]
v_mfma_f32_16x16x32_bf16 v[220:223], v[4:7], v[76:79], v[220:223]
v_mfma_f32_16x16x32_bf16 v[228:231], v[4:7], v[120:123], v[228:231]
v_mfma_f32_16x16x32_bf16 v[236:239], v[4:7], v[124:127], v[236:239]
v_mfma_f32_16x16x32_bf16 v[244:247], v[4:7], v[168:171], v[244:247]
v_mfma_f32_16x16x32_bf16 v[252:255], v[4:7], v[172:175], v[252:255]
ds_read_b64_tr_b16 v[4:5], v1 offset:36864
ds_read_b64_tr_b16 v[6:7], v1 offset:38912
s_waitcnt lgkmcnt(4)
v_mfma_f32_16x16x32_bf16 v[208:211], v[8:11], v[80:83], v[208:211]
v_mfma_f32_16x16x32_bf16 v[216:219], v[8:11], v[84:87], v[216:219]
v_mfma_f32_16x16x32_bf16 v[224:227], v[8:11], v[128:131], v[224:227]
v_mfma_f32_16x16x32_bf16 v[232:235], v[8:11], v[132:135], v[232:235]
v_mfma_f32_16x16x32_bf16 v[240:243], v[8:11], v[176:179], v[240:243]
v_mfma_f32_16x16x32_bf16 v[248:251], v[8:11], v[180:183], v[248:251]
ds_read_b64_tr_b16 v[8:9], v2 offset:36864
ds_read_b64_tr_b16 v[10:11], v2 offset:38912
s_waitcnt lgkmcnt(4)
v_mfma_f32_16x16x32_bf16 v[212:215], v[12:15], v[80:83], v[212:215]
v_mfma_f32_16x16x32_bf16 v[220:223], v[12:15], v[84:87], v[220:223]
v_mfma_f32_16x16x32_bf16 v[228:231], v[12:15], v[128:131], v[228:231]
v_mfma_f32_16x16x32_bf16 v[236:239], v[12:15], v[132:135], v[236:239]
v_mfma_f32_16x16x32_bf16 v[244:247], v[12:15], v[176:179], v[244:247]
v_mfma_f32_16x16x32_bf16 v[252:255], v[12:15], v[180:183], v[252:255]
ds_read_b64_tr_b16 v[12:13], v1 offset:40960
ds_read_b64_tr_b16 v[14:15], v1 offset:43008
s_waitcnt lgkmcnt(4)
v_mfma_f32_16x16x32_bf16 v[208:211], v[4:7], v[88:91], v[208:211]
v_mfma_f32_16x16x32_bf16 v[216:219], v[4:7], v[92:95], v[216:219]
v_mfma_f32_16x16x32_bf16 v[224:227], v[4:7], v[136:139], v[224:227]
v_mfma_f32_16x16x32_bf16 v[232:235], v[4:7], v[140:143], v[232:235]
v_mfma_f32_16x16x32_bf16 v[240:243], v[4:7], v[184:187], v[240:243]
v_mfma_f32_16x16x32_bf16 v[248:251], v[4:7], v[188:191], v[248:251]
ds_read_b64_tr_b16 v[4:5], v2 offset:40960
ds_read_b64_tr_b16 v[6:7], v2 offset:43008
s_add_u32 s68, s78, 12288
buffer_store_dwordx4 v[52:55], v0, s[48:51], s68 offen offset:1024 sc1
s_waitcnt lgkmcnt(4)
v_mfma_f32_16x16x32_bf16 v[212:215], v[8:11], v[88:91], v[212:215]
v_mfma_f32_16x16x32_bf16 v[220:223], v[8:11], v[92:95], v[220:223]
v_mfma_f32_16x16x32_bf16 v[228:231], v[8:11], v[136:139], v[228:231]
v_mfma_f32_16x16x32_bf16 v[236:239], v[8:11], v[140:143], v[236:239]
v_mfma_f32_16x16x32_bf16 v[244:247], v[8:11], v[184:187], v[244:247]
v_mfma_f32_16x16x32_bf16 v[252:255], v[8:11], v[188:191], v[252:255]
ds_read_b64_tr_b16 v[8:9], v1 offset:45056
ds_read_b64_tr_b16 v[10:11], v1 offset:47104
ds_read_b128 v[16:19], v0 offset:12288
ds_read_b128 v[20:23], v0 offset:13312
ds_read_b128 v[24:27], v0 offset:14336
ds_read_b128 v[28:31], v0 offset:15360
ds_read_b128 v[32:35], v0 offset:16384
ds_read_b128 v[36:39], v0 offset:17408
s_add_u32 s68, s78, 20480
buffer_store_dwordx4 v[56:59], v0, s[48:51], s68 offen offset:0 sc1
s_waitcnt lgkmcnt(10)
v_mfma_f32_16x16x32_bf16 v[208:211], v[12:15], v[96:99], v[208:211]
v_mfma_f32_16x16x32_bf16 v[216:219], v[12:15], v[100:103], v[216:219]
v_mfma_f32_16x16x32_bf16 v[224:227], v[12:15], v[144:147], v[224:227]
v_mfma_f32_16x16x32_bf16 v[232:235], v[12:15], v[148:151], v[232:235]
v_mfma_f32_16x16x32_bf16 v[240:243], v[12:15], v[192:195], v[240:243]
v_mfma_f32_16x16x32_bf16 v[248:251], v[12:15], v[196:199], v[248:251]
ds_read_b64_tr_b16 v[12:13], v2 offset:45056
ds_read_b64_tr_b16 v[14:15], v2 offset:47104
s_add_u32 s68, s78, 20480
buffer_store_dwordx4 v[60:63], v0, s[48:51], s68 offen offset:1024 sc1
s_waitcnt lgkmcnt(2)
s_barrier
v_mfma_f32_16x16x32_bf16 v[212:215], v[4:7], v[96:99], v[212:215]
v_mfma_f32_16x16x32_bf16 v[220:223], v[4:7], v[100:103], v[220:223]
v_mfma_f32_16x16x32_bf16 v[228:231], v[4:7], v[144:147], v[228:231]
v_mfma_f32_16x16x32_bf16 v[236:239], v[4:7], v[148:151], v[236:239]
v_mfma_f32_16x16x32_bf16 v[244:247], v[4:7], v[192:195], v[244:247]
v_mfma_f32_16x16x32_bf16 v[252:255], v[4:7], v[196:199], v[252:255]
ds_read_b64_tr_b16 v[4:5], v1 offset:8192
ds_read_b64_tr_b16 v[6:7], v1 offset:10240
v_mfma_f32_16x16x32_bf16 v[208:211], v[8:11], v[104:107], v[208:211]
v_mfma_f32_16x16x32_bf16 v[216:219], v[8:11], v[108:111], v[216:219]
v_mfma_f32_16x16x32_bf16 v[224:227], v[8:11], v[152:155], v[224:227]
v_mfma_f32_16x16x32_bf16 v[232:235], v[8:11], v[156:159], v[232:235]
v_mfma_f32_16x16x32_bf16 v[240:243], v[8:11], v[200:203], v[240:243]
v_mfma_f32_16x16x32_bf16 v[248:251], v[8:11], v[204:207], v[248:251]
ds_read_b64_tr_b16 v[8:9], v2 offset:8192
ds_read_b64_tr_b16 v[10:11], v2 offset:10240
s_waitcnt lgkmcnt(4)
v_mfma_f32_16x16x32_bf16 v[212:215], v[12:15], v[104:107], v[212:215]
v_mfma_f32_16x16x32_bf16 v[220:223], v[12:15], v[108:111], v[220:223]
v_mfma_f32_16x16x32_bf16 v[228:231], v[12:15], v[152:155], v[228:231]
v_mfma_f32_16x16x32_bf16 v[236:239], v[12:15], v[156:159], v[236:239]
v_mfma_f32_16x16x32_bf16 v[244:247], v[12:15], v[200:203], v[244:247]
v_mfma_f32_16x16x32_bf16 v[252:255], v[12:15], v[204:207], v[252:255]
ds_read_b64_tr_b16 v[12:13], v1 offset:12288
ds_read_b64_tr_b16 v[14:15], v1 offset:14336
v_cvt_pk_bf16_f32 v40, v208, v209
v_cvt_pk_bf16_f32 v41, v210, v211
v_cvt_pk_bf16_f32 v42, v212, v213
v_cvt_pk_bf16_f32 v43, v214, v215
v_cvt_pk_bf16_f32 v44, v216, v217
v_cvt_pk_bf16_f32 v45, v218, v219
v_cvt_pk_bf16_f32 v46, v220, v221
v_cvt_pk_bf16_f32 v47, v222, v223
v_cvt_pk_bf16_f32 v48, v224, v225
v_cvt_pk_bf16_f32 v49, v226, v227
v_cvt_pk_bf16_f32 v50, v228, v229
v_cvt_pk_bf16_f32 v51, v230, v231
v_cvt_pk_bf16_f32 v52, v232, v233
v_cvt_pk_bf16_f32 v53, v234, v235
v_cvt_pk_bf16_f32 v54, v236, v237
v_cvt_pk_bf16_f32 v55, v238, v239
v_cvt_pk_bf16_f32 v56, v240, v241
v_cvt_pk_bf16_f32 v57, v242, v243
v_cvt_pk_bf16_f32 v58, v244, v245
v_cvt_pk_bf16_f32 v59, v246, v247
v_cvt_pk_bf16_f32 v60, v248, v249
v_cvt_pk_bf16_f32 v61, v250, v251
v_cvt_pk_bf16_f32 v62, v252, v253
v_cvt_pk_bf16_f32 v63, v254, v255
s_add_u32 s68, s78, 24576
buffer_store_dwordx4 v[40:43], v0, s[48:51], s68 offen offset:0 sc1
v_lshlrev_b32 v208, 16, v16
v_and_b32 v209, 0xffff0000, v16
v_lshlrev_b32 v210, 16, v17
v_and_b32 v211, 0xffff0000, v17
v_lshlrev_b32 v212, 16, v18
v_and_b32 v213, 0xffff0000, v18
v_lshlrev_b32 v214, 16, v19
v_and_b32 v215, 0xffff0000, v19
v_lshlrev_b32 v216, 16, v20
v_and_b32 v217, 0xffff0000, v20
v_lshlrev_b32 v218, 16, v21
v_and_b32 v219, 0xffff0000, v21
v_lshlrev_b32 v220, 16, v22
v_and_b32 v221, 0xffff0000, v22
v_lshlrev_b32 v222, 16, v23
v_and_b32 v223, 0xffff0000, v23
v_lshlrev_b32 v224, 16, v24
v_and_b32 v225, 0xffff0000, v24
v_lshlrev_b32 v226, 16, v25
v_and_b32 v227, 0xffff0000, v25
v_lshlrev_b32 v228, 16, v26
v_and_b32 v229, 0xffff0000, v26
v_lshlrev_b32 v230, 16, v27
v_and_b32 v231, 0xffff0000, v27
v_lshlrev_b32 v232, 16, v28
v_and_b32 v233, 0xffff0000, v28
v_lshlrev_b32 v234, 16, v29
v_and_b32 v235, 0xffff0000, v29
v_lshlrev_b32 v236, 16, v30
v_and_b32 v237, 0xffff0000, v30
v_lshlrev_b32 v238, 16, v31
v_and_b32 v239, 0xffff0000, v31
v_lshlrev_b32 v240, 16, v32
v_and_b32 v241, 0xffff0000, v32
v_lshlrev_b32 v242, 16, v33
v_and_b32 v243, 0xffff0000, v33
v_lshlrev_b32 v244, 16, v34
v_and_b32 v245, 0xffff0000, v34
v_lshlrev_b32 v246, 16, v35
v_and_b32 v247, 0xffff0000, v35
v_lshlrev_b32 v248, 16, v36
v_and_b32 v249, 0xffff0000, v36
v_lshlrev_b32 v250, 16, v37
v_and_b32 v251, 0xffff0000, v37
v_lshlrev_b32 v252, 16, v38
v_and_b32 v253, 0xffff0000, v38
v_lshlrev_b32 v254, 16, v39
v_and_b32 v255, 0xffff0000, v39
s_waitcnt lgkmcnt(4)
v_mfma_f32_16x16x32_bf16 v[208:211], v[4:7], v[64:67], v[208:211]
v_mfma_f32_16x16x32_bf16 v[216:219], v[4:7], v[68:71], v[216:219]
v_mfma_f32_16x16x32_bf16 v[224:227], v[4:7], v[112:115], v[224:227]
v_mfma_f32_16x16x32_bf16 v[232:235], v[4:7], v[116:119], v[232:235]
v_mfma_f32_16x16x32_bf16 v[240:243], v[4:7], v[160:163], v[240:243]
v_mfma_f32_16x16x32_bf16 v[248:251], v[4:7], v[164:167], v[248:251]
ds_read_b64_tr_b16 v[4:5], v2 offset:12288
ds_read_b64_tr_b16 v[6:7], v2 offset:14336
s_add_u32 s68, s78, 24576
buffer_store_dwordx4 v[44:47], v0, s[48:51], s68 offen offset:1024 sc1
s_barrier
s_waitcnt lgkmcnt(4)
v_mfma_f32_16x16x32_bf16 v[212:215], v[8:11], v[64:67], v[212:215]
v_mfma_f32_16x16x32_bf16 v[220:223], v[8:11], v[68:71], v[220:223]
v_mfma_f32_16x16x32_bf16 v[228:231], v[8:11], v[112:115], v[228:231]
v_mfma_f32_16x16x32_bf16 v[236:239], v[8:11], v[116:119], v[236:239]
v_mfma_f32_16x16x32_bf16 v[244:247], v[8:11], v[160:163], v[244:247]
v_mfma_f32_16x16x32_bf16 v[252:255], v[8:11], v[164:167], v[252:255]
ds_read_b64_tr_b16 v[8:9], v1 offset:16384
ds_read_b64_tr_b16 v[10:11], v1 offset:18432
s_waitcnt lgkmcnt(4)
v_mfma_f32_16x16x32_bf16 v[208:211], v[12:15], v[72:75], v[208:211]
v_mfma_f32_16x16x32_bf16 v[216:219], v[12:15], v[76:79], v[216:219]
v_mfma_f32_16x16x32_bf16 v[224:227], v[12:15], v[120:123], v[224:227]
v_mfma_f32_16x16x32_bf16 v[232:235], v[12:15], v[124:127], v[232:235]
v_mfma_f32_16x16x32_bf16 v[240:243], v[12:15], v[168:171], v[240:243]
v_mfma_f32_16x16x32_bf16 v[248:251], v[12:15], v[172:175], v[248:251]
ds_read_b64_tr_b16 v[12:13], v2 offset:16384
ds_read_b64_tr_b16 v[14:15], v2 offset:18432
s_waitcnt lgkmcnt(4)
v_mfma_f32_16x16x32_bf16 v[212:215], v[4:7], v[72:75], v[212:215]
v_mfma_f32_16x16x32_bf16 v[220:223], v[4:7], v[76:79], v[220:223]
v_mfma_f32_16x16x32_bf16 v[228:231], v[4:7], v[120:123], v[228:231]
v_mfma_f32_16x16x32_bf16 v[236:239], v[4:7], v[124:127], v[236:239]
v_mfma_f32_16x16x32_bf16 v[244:247], v[4:7], v[168:171], v[244:247]
v_mfma_f32_16x16x32_bf16 v[252:255], v[4:7], v[172:175], v[252:255]
ds_read_b64_tr_b16 v[4:5], v1 offset:20480
ds_read_b64_tr_b16 v[6:7], v1 offset:22528
s_add_u32 s68, s78, 32768
buffer_store_dwordx4 v[48:51], v0, s[48:51], s68 offen offset:0 sc1
s_waitcnt lgkmcnt(4)
v_mfma_f32_16x16x32_bf16 v[208:211], v[8:11], v[80:83], v[208:211]
v_mfma_f32_16x16x32_bf16 v[216:219], v[8:11], v[84:87], v[216:219]
v_mfma_f32_16x16x32_bf16 v[224:227], v[8:11], v[128:131], v[224:227]
v_mfma_f32_16x16x32_bf16 v[232:235], v[8:11], v[132:135], v[232:235]
v_mfma_f32_16x16x32_bf16 v[240:243], v[8:11], v[176:179], v[240:243]
v_mfma_f32_16x16x32_bf16 v[248:251], v[8:11], v[180:183], v[248:251]
ds_read_b64_tr_b16 v[8:9], v2 offset:20480
ds_read_b64_tr_b16 v[10:11], v2 offset:22528
s_waitcnt lgkmcnt(4)
v_mfma_f32_16x16x32_bf16 v[212:215], v[12:15], v[80:83], v[212:215]
v_mfma_f32_16x16x32_bf16 v[220:223], v[12:15], v[84:87], v[220:223]
v_mfma_f32_16x16x32_bf16 v[228:231], v[12:15], v[128:131], v[228:231]
v_mfma_f32_16x16x32_bf16 v[236:239], v[12:15], v[132:135], v[236:239]
v_mfma_f32_16x16x32_bf16 v[244:247], v[12:15], v[176:179], v[244:247]
v_mfma_f32_16x16x32_bf16 v[252:255], v[12:15], v[180:183], v[252:255]
ds_read_b64_tr_b16 v[12:13], v1 offset:0
ds_read_b64_tr_b16 v[14:15], v1 offset:2048
s_add_u32 s68, s78, 32768
buffer_store_dwordx4 v[52:55], v0, s[48:51], s68 offen offset:1024 sc1
s_barrier
s_waitcnt lgkmcnt(4)
v_mfma_f32_16x16x32_bf16 v[208:211], v[4:7], v[88:91], v[208:211]
v_mfma_f32_16x16x32_bf16 v[216:219], v[4:7], v[92:95], v[216:219]
v_mfma_f32_16x16x32_bf16 v[224:227], v[4:7], v[136:139], v[224:227]
v_mfma_f32_16x16x32_bf16 v[232:235], v[4:7], v[140:143], v[232:235]
v_mfma_f32_16x16x32_bf16 v[240:243], v[4:7], v[184:187], v[240:243]
v_mfma_f32_16x16x32_bf16 v[248:251], v[4:7], v[188:191], v[248:251]
ds_read_b64_tr_b16 v[4:5], v2 offset:0
ds_read_b64_tr_b16 v[6:7], v2 offset:2048
s_waitcnt lgkmcnt(4)
v_mfma_f32_16x16x32_bf16 v[212:215], v[8:11], v[88:91], v[212:215]
v_mfma_f32_16x16x32_bf16 v[220:223], v[8:11], v[92:95], v[220:223]
v_mfma_f32_16x16x32_bf16 v[228:231], v[8:11], v[136:139], v[228:231]
v_mfma_f32_16x16x32_bf16 v[236:239], v[8:11], v[140:143], v[236:239]
v_mfma_f32_16x16x32_bf16 v[244:247], v[8:11], v[184:187], v[244:247]
v_mfma_f32_16x16x32_bf16 v[252:255], v[8:11], v[188:191], v[252:255]
ds_read_b64_tr_b16 v[8:9], v1 offset:4096
ds_read_b64_tr_b16 v[10:11], v1 offset:6144
ds_read_b128 v[16:19], v0 offset:0
ds_read_b128 v[20:23], v0 offset:1024
ds_read_b128 v[24:27], v0 offset:2048
ds_read_b128 v[28:31], v0 offset:3072
ds_read_b128 v[32:35], v0 offset:4096
ds_read_b128 v[36:39], v0 offset:5120
s_add_u32 s68, s78, 40960
buffer_store_dwordx4 v[56:59], v0, s[48:51], s68 offen offset:0 sc1
s_waitcnt lgkmcnt(10)
v_mfma_f32_16x16x32_bf16 v[208:211], v[12:15], v[96:99], v[208:211]
v_mfma_f32_16x16x32_bf16 v[216:219], v[12:15], v[100:103], v[216:219]
v_mfma_f32_16x16x32_bf16 v[224:227], v[12:15], v[144:147], v[224:227]
v_mfma_f32_16x16x32_bf16 v[232:235], v[12:15], v[148:151], v[232:235]
v_mfma_f32_16x16x32_bf16 v[240:243], v[12:15], v[192:195], v[240:243]
v_mfma_f32_16x16x32_bf16 v[248:251], v[12:15], v[196:199], v[248:251]
ds_read_b64_tr_b16 v[12:13], v2 offset:4096
ds_read_b64_tr_b16 v[14:15], v2 offset:6144
s_add_u32 s68, s78, 40960
buffer_store_dwordx4 v[60:63], v0, s[48:51], s68 offen offset:1024 sc1
s_waitcnt lgkmcnt(10)
v_mfma_f32_16x16x32_bf16 v[212:215], v[4:7], v[96:99], v[212:215]
v_mfma_f32_16x16x32_bf16 v[220:223], v[4:7], v[100:103], v[220:223]
v_mfma_f32_16x16x32_bf16 v[228:231], v[4:7], v[144:147], v[228:231]
v_mfma_f32_16x16x32_bf16 v[236:239], v[4:7], v[148:151], v[236:239]
v_mfma_f32_16x16x32_bf16 v[244:247], v[4:7], v[192:195], v[244:247]
v_mfma_f32_16x16x32_bf16 v[252:255], v[4:7], v[196:199], v[252:255]
ds_read_b64_tr_b16 v[4:5], v1 offset:24576
ds_read_b64_tr_b16 v[6:7], v1 offset:26624
s_waitcnt vmcnt(6)
s_waitcnt lgkmcnt(4)
s_barrier
v_mfma_f32_16x16x32_bf16 v[208:211], v[8:11], v[104:107], v[208:211]
v_mfma_f32_16x16x32_bf16 v[216:219], v[8:11], v[108:111], v[216:219]
v_mfma_f32_16x16x32_bf16 v[224:227], v[8:11], v[152:155], v[224:227]
v_mfma_f32_16x16x32_bf16 v[232:235], v[8:11], v[156:159], v[232:235]
v_mfma_f32_16x16x32_bf16 v[240:243], v[8:11], v[200:203], v[240:243]
v_mfma_f32_16x16x32_bf16 v[248:251], v[8:11], v[204:207], v[248:251]
ds_read_b64_tr_b16 v[8:9], v2 offset:24576
ds_read_b64_tr_b16 v[10:11], v2 offset:26624
s_waitcnt lgkmcnt(4)
v_mfma_f32_16x16x32_bf16 v[212:215], v[12:15], v[104:107], v[212:215]
v_mfma_f32_16x16x32_bf16 v[220:223], v[12:15], v[108:111], v[220:223]
v_mfma_f32_16x16x32_bf16 v[228:231], v[12:15], v[152:155], v[228:231]
v_mfma_f32_16x16x32_bf16 v[236:239], v[12:15], v[156:159], v[236:239]
v_mfma_f32_16x16x32_bf16 v[244:247], v[12:15], v[200:203], v[244:247]
v_mfma_f32_16x16x32_bf16 v[252:255], v[12:15], v[204:207], v[252:255]
ds_read_b64_tr_b16 v[12:13], v1 offset:28672
ds_read_b64_tr_b16 v[14:15], v1 offset:30720
v_cvt_pk_bf16_f32 v40, v208, v209
v_cvt_pk_bf16_f32 v41, v210, v211
v_cvt_pk_bf16_f32 v42, v212, v213
v_cvt_pk_bf16_f32 v43, v214, v215
v_cvt_pk_bf16_f32 v44, v216, v217
v_cvt_pk_bf16_f32 v45, v218, v219
v_cvt_pk_bf16_f32 v46, v220, v221
v_cvt_pk_bf16_f32 v47, v222, v223
v_cvt_pk_bf16_f32 v48, v224, v225
v_cvt_pk_bf16_f32 v49, v226, v227
v_cvt_pk_bf16_f32 v50, v228, v229
v_cvt_pk_bf16_f32 v51, v230, v231
v_cvt_pk_bf16_f32 v52, v232, v233
v_cvt_pk_bf16_f32 v53, v234, v235
v_cvt_pk_bf16_f32 v54, v236, v237
v_cvt_pk_bf16_f32 v55, v238, v239
v_cvt_pk_bf16_f32 v56, v240, v241
v_cvt_pk_bf16_f32 v57, v242, v243
v_cvt_pk_bf16_f32 v58, v244, v245
v_cvt_pk_bf16_f32 v59, v246, v247
v_cvt_pk_bf16_f32 v60, v248, v249
v_cvt_pk_bf16_f32 v61, v250, v251
v_cvt_pk_bf16_f32 v62, v252, v253
v_cvt_pk_bf16_f32 v63, v254, v255
s_add_u32 s68, s78, 28672
buffer_store_dwordx4 v[40:43], v0, s[48:51], s68 offen offset:0 sc1
v_lshlrev_b32 v208, 16, v16
v_and_b32 v209, 0xffff0000, v16
v_lshlrev_b32 v210, 16, v17
v_and_b32 v211, 0xffff0000, v17
v_lshlrev_b32 v212, 16, v18
v_and_b32 v213, 0xffff0000, v18
v_lshlrev_b32 v214, 16, v19
v_and_b32 v215, 0xffff0000, v19
v_lshlrev_b32 v216, 16, v20
v_and_b32 v217, 0xffff0000, v20
v_lshlrev_b32 v218, 16, v21
v_and_b32 v219, 0xffff0000, v21
v_lshlrev_b32 v220, 16, v22
v_and_b32 v221, 0xffff0000, v22
v_lshlrev_b32 v222, 16, v23
v_and_b32 v223, 0xffff0000, v23
v_lshlrev_b32 v224, 16, v24
v_and_b32 v225, 0xffff0000, v24
v_lshlrev_b32 v226, 16, v25
v_and_b32 v227, 0xffff0000, v25
v_lshlrev_b32 v228, 16, v26
v_and_b32 v229, 0xffff0000, v26
v_lshlrev_b32 v230, 16, v27
v_and_b32 v231, 0xffff0000, v27
v_lshlrev_b32 v232, 16, v28
v_and_b32 v233, 0xffff0000, v28
v_lshlrev_b32 v234, 16, v29
v_and_b32 v235, 0xffff0000, v29
v_lshlrev_b32 v236, 16, v30
v_and_b32 v237, 0xffff0000, v30
v_lshlrev_b32 v238, 16, v31
v_and_b32 v239, 0xffff0000, v31
v_lshlrev_b32 v240, 16, v32
v_and_b32 v241, 0xffff0000, v32
v_lshlrev_b32 v242, 16, v33
v_and_b32 v243, 0xffff0000, v33
v_lshlrev_b32 v244, 16, v34
v_and_b32 v245, 0xffff0000, v34
v_lshlrev_b32 v246, 16, v35
v_and_b32 v247, 0xffff0000, v35
v_lshlrev_b32 v248, 16, v36
v_and_b32 v249, 0xffff0000, v36
v_lshlrev_b32 v250, 16, v37
v_and_b32 v251, 0xffff0000, v37
v_lshlrev_b32 v252, 16, v38
v_and_b32 v253, 0xffff0000, v38
v_lshlrev_b32 v254, 16, v39
v_and_b32 v255, 0xffff0000, v39
s_waitcnt lgkmcnt(4)
v_mfma_f32_16x16x32_bf16 v[208:211], v[4:7], v[64:67], v[208:211]
v_mfma_f32_16x16x32_bf16 v[216:219], v[4:7], v[68:71], v[216:219]
v_mfma_f32_16x16x32_bf16 v[224:227], v[4:7], v[112:115], v[224:227]
v_mfma_f32_16x16x32_bf16 v[232:235], v[4:7], v[116:119], v[232:235]
v_mfma_f32_16x16x32_bf16 v[240:243], v[4:7], v[160:163], v[240:243]
v_mfma_f32_16x16x32_bf16 v[248:251], v[4:7], v[164:167], v[248:251]
ds_read_b64_tr_b16 v[4:5], v2 offset:28672
ds_read_b64_tr_b16 v[6:7], v2 offset:30720
s_add_u32 s68, s78, 28672
buffer_store_dwordx4 v[44:47], v0, s[48:51], s68 offen offset:1024 sc1
s_barrier
s_waitcnt lgkmcnt(4)
v_mfma_f32_16x16x32_bf16 v[212:215], v[8:11], v[64:67], v[212:215]
v_mfma_f32_16x16x32_bf16 v[220:223], v[8:11], v[68:71], v[220:223]
v_mfma_f32_16x16x32_bf16 v[228:231], v[8:11], v[112:115], v[228:231]
v_mfma_f32_16x16x32_bf16 v[236:239], v[8:11], v[116:119], v[236:239]
v_mfma_f32_16x16x32_bf16 v[244:247], v[8:11], v[160:163], v[244:247]
v_mfma_f32_16x16x32_bf16 v[252:255], v[8:11], v[164:167], v[252:255]
ds_read_b64_tr_b16 v[8:9], v1 offset:32768
ds_read_b64_tr_b16 v[10:11], v1 offset:34816
s_waitcnt lgkmcnt(4)
v_mfma_f32_16x16x32_bf16 v[208:211], v[12:15], v[72:75], v[208:211]
v_mfma_f32_16x16x32_bf16 v[216:219], v[12:15], v[76:79], v[216:219]
v_mfma_f32_16x16x32_bf16 v[224:227], v[12:15], v[120:123], v[224:227]
v_mfma_f32_16x16x32_bf16 v[232:235], v[12:15], v[124:127], v[232:235]
v_mfma_f32_16x16x32_bf16 v[240:243], v[12:15], v[168:171], v[240:243]
v_mfma_f32_16x16x32_bf16 v[248:251], v[12:15], v[172:175], v[248:251]
ds_read_b64_tr_b16 v[12:13], v2 offset:32768
ds_read_b64_tr_b16 v[14:15], v2 offset:34816
s_waitcnt lgkmcnt(4)
v_mfma_f32_16x16x32_bf16 v[212:215], v[4:7], v[72:75], v[212:215]
v_mfma_f32_16x16x32_bf16 v[220:223], v[4:7], v[76:79], v[220:223]
v_mfma_f32_16x16x32_bf16 v[228:231], v[4:7], v[120:123], v[228:231]
v_mfma_f32_16x16x32_bf16 v[236:239], v[4:7], v[124:127], v[236:239]
v_mfma_f32_16x16x32_bf16 v[244:247], v[4:7], v[168:171], v[244:247]
v_mfma_f32_16x16x32_bf16 v[252:255], v[4:7], v[172:175], v[252:255]
ds_read_b64_tr_b16 v[4:5], v1 offset:36864
ds_read_b64_tr_b16 v[6:7], v1 offset:38912
s_add_u32 s68, s78, 36864
buffer_store_dwordx4 v[48:51], v0, s[48:51], s68 offen offset:0 sc1
s_waitcnt lgkmcnt(4)
v_mfma_f32_16x16x32_bf16 v[208:211], v[8:11], v[80:83], v[208:211]
v_mfma_f32_16x16x32_bf16 v[216:219], v[8:11], v[84:87], v[216:219]
v_mfma_f32_16x16x32_bf16 v[224:227], v[8:11], v[128:131], v[224:227]
v_mfma_f32_16x16x32_bf16 v[232:235], v[8:11], v[132:135], v[232:235]
v_mfma_f32_16x16x32_bf16 v[240:243], v[8:11], v[176:179], v[240:243]
v_mfma_f32_16x16x32_bf16 v[248:251], v[8:11], v[180:183], v[248:251]
ds_read_b64_tr_b16 v[8:9], v2 offset:36864
ds_read_b64_tr_b16 v[10:11], v2 offset:38912
s_waitcnt lgkmcnt(4)
v_mfma_f32_16x16x32_bf16 v[212:215], v[12:15], v[80:83], v[212:215]
v_mfma_f32_16x16x32_bf16 v[220:223], v[12:15], v[84:87], v[220:223]
v_mfma_f32_16x16x32_bf16 v[228:231], v[12:15], v[128:131], v[228:231]
v_mfma_f32_16x16x32_bf16 v[236:239], v[12:15], v[132:135], v[236:239]
v_mfma_f32_16x16x32_bf16 v[244:247], v[12:15], v[176:179], v[244:247]
v_mfma_f32_16x16x32_bf16 v[252:255], v[12:15], v[180:183], v[252:255]
ds_read_b64_tr_b16 v[12:13], v1 offset:40960
ds_read_b64_tr_b16 v[14:15], v1 offset:43008
s_add_u32 s68, s78, 36864
buffer_store_dwordx4 v[52:55], v0, s[48:51], s68 offen offset:1024 sc1
s_waitcnt lgkmcnt(4)
v_mfma_f32_16x16x32_bf16 v[208:211], v[4:7], v[88:91], v[208:211]
v_mfma_f32_16x16x32_bf16 v[216:219], v[4:7], v[92:95], v[216:219]
v_mfma_f32_16x16x32_bf16 v[224:227], v[4:7], v[136:139], v[224:227]
v_mfma_f32_16x16x32_bf16 v[232:235], v[4:7], v[140:143], v[232:235]
v_mfma_f32_16x16x32_bf16 v[240:243], v[4:7], v[184:187], v[240:243]
v_mfma_f32_16x16x32_bf16 v[248:251], v[4:7], v[188:191], v[248:251]
ds_read_b64_tr_b16 v[4:5], v2 offset:40960
ds_read_b64_tr_b16 v[6:7], v2 offset:43008
s_add_u32 s68, s78, 45056
buffer_store_dwordx4 v[56:59], v0, s[48:51], s68 offen offset:0 sc1
s_barrier
s_waitcnt lgkmcnt(4)
v_mfma_f32_16x16x32_bf16 v[212:215], v[8:11], v[88:91], v[212:215]
v_mfma_f32_16x16x32_bf16 v[220:223], v[8:11], v[92:95], v[220:223]
v_mfma_f32_16x16x32_bf16 v[228:231], v[8:11], v[136:139], v[228:231]
v_mfma_f32_16x16x32_bf16 v[236:239], v[8:11], v[140:143], v[236:239]
v_mfma_f32_16x16x32_bf16 v[244:247], v[8:11], v[184:187], v[244:247]
v_mfma_f32_16x16x32_bf16 v[252:255], v[8:11], v[188:191], v[252:255]
ds_read_b64_tr_b16 v[8:9], v1 offset:45056
ds_read_b64_tr_b16 v[10:11], v1 offset:47104
ds_read_b128 v[16:19], v0 offset:12288
ds_read_b128 v[20:23], v0 offset:13312
ds_read_b128 v[24:27], v0 offset:14336
ds_read_b128 v[28:31], v0 offset:15360
ds_read_b128 v[32:35], v0 offset:16384
ds_read_b128 v[36:39], v0 offset:17408
s_waitcnt lgkmcnt(10)
v_mfma_f32_16x16x32_bf16 v[208:211], v[12:15], v[96:99], v[208:211]
v_mfma_f32_16x16x32_bf16 v[216:219], v[12:15], v[100:103], v[216:219]
v_mfma_f32_16x16x32_bf16 v[224:227], v[12:15], v[144:147], v[224:227]
v_mfma_f32_16x16x32_bf16 v[232:235], v[12:15], v[148:151], v[232:235]
v_mfma_f32_16x16x32_bf16 v[240:243], v[12:15], v[192:195], v[240:243]
v_mfma_f32_16x16x32_bf16 v[248:251], v[12:15], v[196:199], v[248:251]
ds_read_b64_tr_b16 v[12:13], v2 offset:45056
ds_read_b64_tr_b16 v[14:15], v2 offset:47104
s_waitcnt lgkmcnt(10)
v_mfma_f32_16x16x32_bf16 v[212:215], v[4:7], v[96:99], v[212:215]
v_mfma_f32_16x16x32_bf16 v[220:223], v[4:7], v[100:103], v[220:223]
v_mfma_f32_16x16x32_bf16 v[228:231], v[4:7], v[144:147], v[228:231]
v_mfma_f32_16x16x32_bf16 v[236:239], v[4:7], v[148:151], v[236:239]
v_mfma_f32_16x16x32_bf16 v[244:247], v[4:7], v[192:195], v[244:247]
v_mfma_f32_16x16x32_bf16 v[252:255], v[4:7], v[196:199], v[252:255]
ds_read_b64_tr_b16 v[4:5], v1 offset:8192
ds_read_b64_tr_b16 v[6:7], v1 offset:10240
s_add_u32 s68, s78, 45056
buffer_store_dwordx4 v[60:63], v0, s[48:51], s68 offen offset:1024 sc1
s_waitcnt lgkmcnt(10)
v_mfma_f32_16x16x32_bf16 v[208:211], v[8:11], v[104:107], v[208:211]
v_mfma_f32_16x16x32_bf16 v[216:219], v[8:11], v[108:111], v[216:219]
v_mfma_f32_16x16x32_bf16 v[224:227], v[8:11], v[152:155], v[224:227]
v_mfma_f32_16x16x32_bf16 v[232:235], v[8:11], v[156:159], v[232:235]
v_mfma_f32_16x16x32_bf16 v[240:243], v[8:11], v[200:203], v[240:243]
v_mfma_f32_16x16x32_bf16 v[248:251], v[8:11], v[204:207], v[248:251]
ds_read_b64_tr_b16 v[8:9], v2 offset:8192
ds_read_b64_tr_b16 v[10:11], v2 offset:10240
s_waitcnt lgkmcnt(4)
v_mfma_f32_16x16x32_bf16 v[212:215], v[12:15], v[104:107], v[212:215]
v_mfma_f32_16x16x32_bf16 v[220:223], v[12:15], v[108:111], v[220:223]
v_mfma_f32_16x16x32_bf16 v[228:231], v[12:15], v[152:155], v[228:231]
v_mfma_f32_16x16x32_bf16 v[236:239], v[12:15], v[156:159], v[236:239]
v_mfma_f32_16x16x32_bf16 v[244:247], v[12:15], v[200:203], v[244:247]
v_mfma_f32_16x16x32_bf16 v[252:255], v[12:15], v[204:207], v[252:255]
ds_read_b64_tr_b16 v[12:13], v1 offset:12288
ds_read_b64_tr_b16 v[14:15], v1 offset:14336
v_cvt_pk_bf16_f32 v40, v208, v209
v_cvt_pk_bf16_f32 v41, v210, v211
v_cvt_pk_bf16_f32 v42, v212, v213
v_cvt_pk_bf16_f32 v43, v214, v215
v_cvt_pk_bf16_f32 v44, v216, v217
v_cvt_pk_bf16_f32 v45, v218, v219
v_cvt_pk_bf16_f32 v46, v220, v221
v_cvt_pk_bf16_f32 v47, v222, v223
v_cvt_pk_bf16_f32 v48, v224, v225
v_cvt_pk_bf16_f32 v49, v226, v227
v_cvt_pk_bf16_f32 v50, v228, v229
v_cvt_pk_bf16_f32 v51, v230, v231
v_cvt_pk_bf16_f32 v52, v232, v233
v_cvt_pk_bf16_f32 v53, v234, v235
v_cvt_pk_bf16_f32 v54, v236, v237
v_cvt_pk_bf16_f32 v55, v238, v239
v_cvt_pk_bf16_f32 v56, v240, v241
v_cvt_pk_bf16_f32 v57, v242, v243
v_cvt_pk_bf16_f32 v58, v244, v245
v_cvt_pk_bf16_f32 v59, v246, v247
v_cvt_pk_bf16_f32 v60, v248, v249
v_cvt_pk_bf16_f32 v61, v250, v251
v_cvt_pk_bf16_f32 v62, v252, v253
v_cvt_pk_bf16_f32 v63, v254, v255
s_add_u32 s68, s78, 49152
buffer_store_dwordx4 v[40:43], v0, s[48:51], s68 offen offset:0 sc1
s_barrier
v_lshlrev_b32 v208, 16, v16
v_and_b32 v209, 0xffff0000, v16
v_lshlrev_b32 v210, 16, v17
v_and_b32 v211, 0xffff0000, v17
v_lshlrev_b32 v212, 16, v18
v_and_b32 v213, 0xffff0000, v18
v_lshlrev_b32 v214, 16, v19
v_and_b32 v215, 0xffff0000, v19
v_lshlrev_b32 v216, 16, v20
v_and_b32 v217, 0xffff0000, v20
v_lshlrev_b32 v218, 16, v21
v_and_b32 v219, 0xffff0000, v21
v_lshlrev_b32 v220, 16, v22
v_and_b32 v221, 0xffff0000, v22
v_lshlrev_b32 v222, 16, v23
v_and_b32 v223, 0xffff0000, v23
v_lshlrev_b32 v224, 16, v24
v_and_b32 v225, 0xffff0000, v24
v_lshlrev_b32 v226, 16, v25
v_and_b32 v227, 0xffff0000, v25
v_lshlrev_b32 v228, 16, v26
v_and_b32 v229, 0xffff0000, v26
v_lshlrev_b32 v230, 16, v27
v_and_b32 v231, 0xffff0000, v27
v_lshlrev_b32 v232, 16, v28
v_and_b32 v233, 0xffff0000, v28
v_lshlrev_b32 v234, 16, v29
v_and_b32 v235, 0xffff0000, v29
v_lshlrev_b32 v236, 16, v30
v_and_b32 v237, 0xffff0000, v30
v_lshlrev_b32 v238, 16, v31
v_and_b32 v239, 0xffff0000, v31
v_lshlrev_b32 v240, 16, v32
v_and_b32 v241, 0xffff0000, v32
v_lshlrev_b32 v242, 16, v33
v_and_b32 v243, 0xffff0000, v33
v_lshlrev_b32 v244, 16, v34
v_and_b32 v245, 0xffff0000, v34
v_lshlrev_b32 v246, 16, v35
v_and_b32 v247, 0xffff0000, v35
v_lshlrev_b32 v248, 16, v36
v_and_b32 v249, 0xffff0000, v36
v_lshlrev_b32 v250, 16, v37
v_and_b32 v251, 0xffff0000, v37
v_lshlrev_b32 v252, 16, v38
v_and_b32 v253, 0xffff0000, v38
v_lshlrev_b32 v254, 16, v39
v_and_b32 v255, 0xffff0000, v39
s_waitcnt lgkmcnt(4)
v_mfma_f32_16x16x32_bf16 v[208:211], v[4:7], v[64:67], v[208:211]
v_mfma_f32_16x16x32_bf16 v[216:219], v[4:7], v[68:71], v[216:219]
v_mfma_f32_16x16x32_bf16 v[224:227], v[4:7], v[112:115], v[224:227]
v_mfma_f32_16x16x32_bf16 v[232:235], v[4:7], v[116:119], v[232:235]
v_mfma_f32_16x16x32_bf16 v[240:243], v[4:7], v[160:163], v[240:243]
v_mfma_f32_16x16x32_bf16 v[248:251], v[4:7], v[164:167], v[248:251]
ds_read_b64_tr_b16 v[4:5], v2 offset:12288
ds_read_b64_tr_b16 v[6:7], v2 offset:14336
s_waitcnt lgkmcnt(4)
v_mfma_f32_16x16x32_bf16 v[212:215], v[8:11], v[64:67], v[212:215]
v_mfma_f32_16x16x32_bf16 v[220:223], v[8:11], v[68:71], v[220:223]
v_mfma_f32_16x16x32_bf16 v[228:231], v[8:11], v[112:115], v[228:231]
v_mfma_f32_16x16x32_bf16 v[236:239], v[8:11], v[116:119], v[236:239]
v_mfma_f32_16x16x32_bf16 v[244:247], v[8:11], v[160:163], v[244:247]
v_mfma_f32_16x16x32_bf16 v[252:255], v[8:11], v[164:167], v[252:255]
ds_read_b64_tr_b16 v[8:9], v1 offset:16384
ds_read_b64_tr_b16 v[10:11], v1 offset:18432
s_add_u32 s68, s78, 49152
buffer_store_dwordx4 v[44:47], v0, s[48:51], s68 offen offset:1024 sc1
s_waitcnt lgkmcnt(4)
v_mfma_f32_16x16x32_bf16 v[208:211], v[12:15], v[72:75], v[208:211]
v_mfma_f32_16x16x32_bf16 v[216:219], v[12:15], v[76:79], v[216:219]
v_mfma_f32_16x16x32_bf16 v[224:227], v[12:15], v[120:123], v[224:227]
v_mfma_f32_16x16x32_bf16 v[232:235], v[12:15], v[124:127], v[232:235]
v_mfma_f32_16x16x32_bf16 v[240:243], v[12:15], v[168:171], v[240:243]
v_mfma_f32_16x16x32_bf16 v[248:251], v[12:15], v[172:175], v[248:251]
ds_read_b64_tr_b16 v[12:13], v2 offset:16384
ds_read_b64_tr_b16 v[14:15], v2 offset:18432
s_add_u32 s68, s78, 57344
buffer_store_dwordx4 v[48:51], v0, s[48:51], s68 offen offset:0 sc1
s_barrier
s_waitcnt lgkmcnt(4)
v_mfma_f32_16x16x32_bf16 v[212:215], v[4:7], v[72:75], v[212:215]
v_mfma_f32_16x16x32_bf16 v[220:223], v[4:7], v[76:79], v[220:223]
v_mfma_f32_16x16x32_bf16 v[228:231], v[4:7], v[120:123], v[228:231]
v_mfma_f32_16x16x32_bf16 v[236:239], v[4:7], v[124:127], v[236:239]
v_mfma_f32_16x16x32_bf16 v[244:247], v[4:7], v[168:171], v[244:247]
v_mfma_f32_16x16x32_bf16 v[252:255], v[4:7], v[172:175], v[252:255]
ds_read_b64_tr_b16 v[4:5], v1 offset:20480
ds_read_b64_tr_b16 v[6:7], v1 offset:22528
s_waitcnt lgkmcnt(4)
v_mfma_f32_16x16x32_bf16 v[208:211], v[8:11], v[80:83], v[208:211]
v_mfma_f32_16x16x32_bf16 v[216:219], v[8:11], v[84:87], v[216:219]
v_mfma_f32_16x16x32_bf16 v[224:227], v[8:11], v[128:131], v[224:227]
v_mfma_f32_16x16x32_bf16 v[232:235], v[8:11], v[132:135], v[232:235]
v_mfma_f32_16x16x32_bf16 v[240:243], v[8:11], v[176:179], v[240:243]
v_mfma_f32_16x16x32_bf16 v[248:251], v[8:11], v[180:183], v[248:251]
ds_read_b64_tr_b16 v[8:9], v2 offset:20480
ds_read_b64_tr_b16 v[10:11], v2 offset:22528
s_waitcnt lgkmcnt(4)
v_mfma_f32_16x16x32_bf16 v[212:215], v[12:15], v[80:83], v[212:215]
v_mfma_f32_16x16x32_bf16 v[220:223], v[12:15], v[84:87], v[220:223]
v_mfma_f32_16x16x32_bf16 v[228:231], v[12:15], v[128:131], v[228:231]
v_mfma_f32_16x16x32_bf16 v[236:239], v[12:15], v[132:135], v[236:239]
v_mfma_f32_16x16x32_bf16 v[244:247], v[12:15], v[176:179], v[244:247]
v_mfma_f32_16x16x32_bf16 v[252:255], v[12:15], v[180:183], v[252:255]
ds_read_b64_tr_b16 v[12:13], v1 offset:0
ds_read_b64_tr_b16 v[14:15], v1 offset:2048
s_waitcnt lgkmcnt(4)
v_mfma_f32_16x16x32_bf16 v[208:211], v[4:7], v[88:91], v[208:211]
v_mfma_f32_16x16x32_bf16 v[216:219], v[4:7], v[92:95], v[216:219]
v_mfma_f32_16x16x32_bf16 v[224:227], v[4:7], v[136:139], v[224:227]
v_mfma_f32_16x16x32_bf16 v[232:235], v[4:7], v[140:143], v[232:235]
v_mfma_f32_16x16x32_bf16 v[240:243], v[4:7], v[184:187], v[240:243]
v_mfma_f32_16x16x32_bf16 v[248:251], v[4:7], v[188:191], v[248:251]
ds_read_b64_tr_b16 v[4:5], v2 offset:0
ds_read_b64_tr_b16 v[6:7], v2 offset:2048
s_add_u32 s68, s78, 57344
buffer_store_dwordx4 v[52:55], v0, s[48:51], s68 offen offset:1024 sc1
s_waitcnt lgkmcnt(4)
v_mfma_f32_16x16x32_bf16 v[212:215], v[8:11], v[88:91], v[212:215]
v_mfma_f32_16x16x32_bf16 v[220:223], v[8:11], v[92:95], v[220:223]
v_mfma_f32_16x16x32_bf16 v[228:231], v[8:11], v[136:139], v[228:231]
v_mfma_f32_16x16x32_bf16 v[236:239], v[8:11], v[140:143], v[236:239]
v_mfma_f32_16x16x32_bf16 v[244:247], v[8:11], v[184:187], v[244:247]
v_mfma_f32_16x16x32_bf16 v[252:255], v[8:11], v[188:191], v[252:255]
ds_read_b64_tr_b16 v[8:9], v1 offset:4096
ds_read_b64_tr_b16 v[10:11], v1 offset:6144
ds_read_b128 v[16:19], v0 offset:0
ds_read_b128 v[20:23], v0 offset:1024
ds_read_b128 v[24:27], v0 offset:2048
ds_read_b128 v[28:31], v0 offset:3072
ds_read_b128 v[32:35], v0 offset:4096
ds_read_b128 v[36:39], v0 offset:5120
s_add_u32 s68, s78, 65536
buffer_store_dwordx4 v[56:59], v0, s[48:51], s68 offen offset:0 sc1
s_waitcnt lgkmcnt(10)
v_mfma_f32_16x16x32_bf16 v[208:211], v[12:15], v[96:99], v[208:211]
v_mfma_f32_16x16x32_bf16 v[216:219], v[12:15], v[100:103], v[216:219]
v_mfma_f32_16x16x32_bf16 v[224:227], v[12:15], v[144:147], v[224:227]
v_mfma_f32_16x16x32_bf16 v[232:235], v[12:15], v[148:151], v[232:235]
v_mfma_f32_16x16x32_bf16 v[240:243], v[12:15], v[192:195], v[240:243]
v_mfma_f32_16x16x32_bf16 v[248:251], v[12:15], v[196:199], v[248:251]
ds_read_b64_tr_b16 v[12:13], v2 offset:4096
ds_read_b64_tr_b16 v[14:15], v2 offset:6144
s_add_u32 s68, s78, 65536
buffer_store_dwordx4 v[60:63], v0, s[48:51], s68 offen offset:1024 sc1
s_waitcnt lgkmcnt(2)
s_barrier
v_mfma_f32_16x16x32_bf16 v[212:215], v[4:7], v[96:99], v[212:215]
v_mfma_f32_16x16x32_bf16 v[220:223], v[4:7], v[100:103], v[220:223]
v_mfma_f32_16x16x32_bf16 v[228:231], v[4:7], v[144:147], v[228:231]
v_mfma_f32_16x16x32_bf16 v[236:239], v[4:7], v[148:151], v[236:239]
v_mfma_f32_16x16x32_bf16 v[244:247], v[4:7], v[192:195], v[244:247]
v_mfma_f32_16x16x32_bf16 v[252:255], v[4:7], v[196:199], v[252:255]
ds_read_b64_tr_b16 v[4:5], v1 offset:24576
ds_read_b64_tr_b16 v[6:7], v1 offset:26624
v_mfma_f32_16x16x32_bf16 v[208:211], v[8:11], v[104:107], v[208:211]
v_mfma_f32_16x16x32_bf16 v[216:219], v[8:11], v[108:111], v[216:219]
v_mfma_f32_16x16x32_bf16 v[224:227], v[8:11], v[152:155], v[224:227]
v_mfma_f32_16x16x32_bf16 v[232:235], v[8:11], v[156:159], v[232:235]
v_mfma_f32_16x16x32_bf16 v[240:243], v[8:11], v[200:203], v[240:243]
v_mfma_f32_16x16x32_bf16 v[248:251], v[8:11], v[204:207], v[248:251]
ds_read_b64_tr_b16 v[8:9], v2 offset:24576
ds_read_b64_tr_b16 v[10:11], v2 offset:26624
s_waitcnt lgkmcnt(4)
v_mfma_f32_16x16x32_bf16 v[212:215], v[12:15], v[104:107], v[212:215]
v_mfma_f32_16x16x32_bf16 v[220:223], v[12:15], v[108:111], v[220:223]
v_mfma_f32_16x16x32_bf16 v[228:231], v[12:15], v[152:155], v[228:231]
v_mfma_f32_16x16x32_bf16 v[236:239], v[12:15], v[156:159], v[236:239]
v_mfma_f32_16x16x32_bf16 v[244:247], v[12:15], v[200:203], v[244:247]
v_mfma_f32_16x16x32_bf16 v[252:255], v[12:15], v[204:207], v[252:255]
ds_read_b64_tr_b16 v[12:13], v1 offset:28672
ds_read_b64_tr_b16 v[14:15], v1 offset:30720
v_cvt_pk_bf16_f32 v40, v208, v209
v_cvt_pk_bf16_f32 v41, v210, v211
v_cvt_pk_bf16_f32 v42, v212, v213
v_cvt_pk_bf16_f32 v43, v214, v215
v_cvt_pk_bf16_f32 v44, v216, v217
v_cvt_pk_bf16_f32 v45, v218, v219
v_cvt_pk_bf16_f32 v46, v220, v221
v_cvt_pk_bf16_f32 v47, v222, v223
v_cvt_pk_bf16_f32 v48, v224, v225
v_cvt_pk_bf16_f32 v49, v226, v227
v_cvt_pk_bf16_f32 v50, v228, v229
v_cvt_pk_bf16_f32 v51, v230, v231
v_cvt_pk_bf16_f32 v52, v232, v233
v_cvt_pk_bf16_f32 v53, v234, v235
v_cvt_pk_bf16_f32 v54, v236, v237
v_cvt_pk_bf16_f32 v55, v238, v239
v_cvt_pk_bf16_f32 v56, v240, v241
v_cvt_pk_bf16_f32 v57, v242, v243
v_cvt_pk_bf16_f32 v58, v244, v245
v_cvt_pk_bf16_f32 v59, v246, v247
v_cvt_pk_bf16_f32 v60, v248, v249
v_cvt_pk_bf16_f32 v61, v250, v251
v_cvt_pk_bf16_f32 v62, v252, v253
v_cvt_pk_bf16_f32 v63, v254, v255
s_add_u32 s68, s78, 53248
buffer_store_dwordx4 v[40:43], v0, s[48:51], s68 offen offset:0 sc1
s_waitcnt vmcnt(7)
s_barrier
v_lshlrev_b32 v208, 16, v16
v_and_b32 v209, 0xffff0000, v16
v_lshlrev_b32 v210, 16, v17
v_and_b32 v211, 0xffff0000, v17
v_lshlrev_b32 v212, 16, v18
v_and_b32 v213, 0xffff0000, v18
v_lshlrev_b32 v214, 16, v19
v_and_b32 v215, 0xffff0000, v19
v_lshlrev_b32 v216, 16, v20
v_and_b32 v217, 0xffff0000, v20
v_lshlrev_b32 v218, 16, v21
v_and_b32 v219, 0xffff0000, v21
v_lshlrev_b32 v220, 16, v22
v_and_b32 v221, 0xffff0000, v22
v_lshlrev_b32 v222, 16, v23
v_and_b32 v223, 0xffff0000, v23
v_lshlrev_b32 v224, 16, v24
v_and_b32 v225, 0xffff0000, v24
v_lshlrev_b32 v226, 16, v25
v_and_b32 v227, 0xffff0000, v25
v_lshlrev_b32 v228, 16, v26
v_and_b32 v229, 0xffff0000, v26
v_lshlrev_b32 v230, 16, v27
v_and_b32 v231, 0xffff0000, v27
v_lshlrev_b32 v232, 16, v28
v_and_b32 v233, 0xffff0000, v28
v_lshlrev_b32 v234, 16, v29
v_and_b32 v235, 0xffff0000, v29
v_lshlrev_b32 v236, 16, v30
v_and_b32 v237, 0xffff0000, v30
v_lshlrev_b32 v238, 16, v31
v_and_b32 v239, 0xffff0000, v31
v_lshlrev_b32 v240, 16, v32
v_and_b32 v241, 0xffff0000, v32
v_lshlrev_b32 v242, 16, v33
v_and_b32 v243, 0xffff0000, v33
v_lshlrev_b32 v244, 16, v34
v_and_b32 v245, 0xffff0000, v34
v_lshlrev_b32 v246, 16, v35
v_and_b32 v247, 0xffff0000, v35
v_lshlrev_b32 v248, 16, v36
v_and_b32 v249, 0xffff0000, v36
v_lshlrev_b32 v250, 16, v37
v_and_b32 v251, 0xffff0000, v37
v_lshlrev_b32 v252, 16, v38
v_and_b32 v253, 0xffff0000, v38
v_lshlrev_b32 v254, 16, v39
v_and_b32 v255, 0xffff0000, v39
s_waitcnt lgkmcnt(4)
v_mfma_f32_16x16x32_bf16 v[208:211], v[4:7], v[64:67], v[208:211]
v_mfma_f32_16x16x32_bf16 v[216:219], v[4:7], v[68:71], v[216:219]
v_mfma_f32_16x16x32_bf16 v[224:227], v[4:7], v[112:115], v[224:227]
v_mfma_f32_16x16x32_bf16 v[232:235], v[4:7], v[116:119], v[232:235]
v_mfma_f32_16x16x32_bf16 v[240:243], v[4:7], v[160:163], v[240:243]
v_mfma_f32_16x16x32_bf16 v[248:251], v[4:7], v[164:167], v[248:251]
ds_read_b64_tr_b16 v[4:5], v2 offset:28672
ds_read_b64_tr_b16 v[6:7], v2 offset:30720
s_waitcnt lgkmcnt(4)
v_mfma_f32_16x16x32_bf16 v[212:215], v[8:11], v[64:67], v[212:215]
v_mfma_f32_16x16x32_bf16 v[220:223], v[8:11], v[68:71], v[220:223]
v_mfma_f32_16x16x32_bf16 v[228:231], v[8:11], v[112:115], v[228:231]
v_mfma_f32_16x16x32_bf16 v[236:239], v[8:11], v[116:119], v[236:239]
v_mfma_f32_16x16x32_bf16 v[244:247], v[8:11], v[160:163], v[244:247]
v_mfma_f32_16x16x32_bf16 v[252:255], v[8:11], v[164:167], v[252:255]
ds_read_b64_tr_b16 v[8:9], v1 offset:32768
ds_read_b64_tr_b16 v[10:11], v1 offset:34816
s_waitcnt lgkmcnt(4)
v_mfma_f32_16x16x32_bf16 v[208:211], v[12:15], v[72:75], v[208:211]
v_mfma_f32_16x16x32_bf16 v[216:219], v[12:15], v[76:79], v[216:219]
v_mfma_f32_16x16x32_bf16 v[224:227], v[12:15], v[120:123], v[224:227]
v_mfma_f32_16x16x32_bf16 v[232:235], v[12:15], v[124:127], v[232:235]
v_mfma_f32_16x16x32_bf16 v[240:243], v[12:15], v[168:171], v[240:243]
v_mfma_f32_16x16x32_bf16 v[248:251], v[12:15], v[172:175], v[248:251]
ds_read_b64_tr_b16 v[12:13], v2 offset:32768
ds_read_b64_tr_b16 v[14:15], v2 offset:34816
s_add_u32 s68, s78, 53248
buffer_store_dwordx4 v[44:47], v0, s[48:51], s68 offen offset:1024 sc1
s_waitcnt lgkmcnt(4)
v_mfma_f32_16x16x32_bf16 v[212:215], v[4:7], v[72:75], v[212:215]
v_mfma_f32_16x16x32_bf16 v[220:223], v[4:7], v[76:79], v[220:223]
v_mfma_f32_16x16x32_bf16 v[228:231], v[4:7], v[120:123], v[228:231]
v_mfma_f32_16x16x32_bf16 v[236:239], v[4:7], v[124:127], v[236:239]
v_mfma_f32_16x16x32_bf16 v[244:247], v[4:7], v[168:171], v[244:247]
v_mfma_f32_16x16x32_bf16 v[252:255], v[4:7], v[172:175], v[252:255]
ds_read_b64_tr_b16 v[4:5], v1 offset:36864
ds_read_b64_tr_b16 v[6:7], v1 offset:38912
s_add_u32 s68, s78, 61440
buffer_store_dwordx4 v[48:51], v0, s[48:51], s68 offen offset:0 sc1
s_waitcnt lgkmcnt(4)
v_mfma_f32_16x16x32_bf16 v[208:211], v[8:11], v[80:83], v[208:211]
v_mfma_f32_16x16x32_bf16 v[216:219], v[8:11], v[84:87], v[216:219]
v_mfma_f32_16x16x32_bf16 v[224:227], v[8:11], v[128:131], v[224:227]
v_mfma_f32_16x16x32_bf16 v[232:235], v[8:11], v[132:135], v[232:235]
v_mfma_f32_16x16x32_bf16 v[240:243], v[8:11], v[176:179], v[240:243]
v_mfma_f32_16x16x32_bf16 v[248:251], v[8:11], v[180:183], v[248:251]
ds_read_b64_tr_b16 v[8:9], v2 offset:36864
ds_read_b64_tr_b16 v[10:11], v2 offset:38912
s_waitcnt lgkmcnt(4)
v_mfma_f32_16x16x32_bf16 v[212:215], v[12:15], v[80:83], v[212:215]
v_mfma_f32_16x16x32_bf16 v[220:223], v[12:15], v[84:87], v[220:223]
v_mfma_f32_16x16x32_bf16 v[228:231], v[12:15], v[128:131], v[228:231]
v_mfma_f32_16x16x32_bf16 v[236:239], v[12:15], v[132:135], v[236:239]
v_mfma_f32_16x16x32_bf16 v[244:247], v[12:15], v[176:179], v[244:247]
v_mfma_f32_16x16x32_bf16 v[252:255], v[12:15], v[180:183], v[252:255]
ds_read_b64_tr_b16 v[12:13], v1 offset:40960
ds_read_b64_tr_b16 v[14:15], v1 offset:43008
s_add_u32 s68, s78, 61440
buffer_store_dwordx4 v[52:55], v0, s[48:51], s68 offen offset:1024 sc1
s_barrier
s_waitcnt lgkmcnt(4)
v_mfma_f32_16x16x32_bf16 v[208:211], v[4:7], v[88:91], v[208:211]
v_mfma_f32_16x16x32_bf16 v[216:219], v[4:7], v[92:95], v[216:219]
v_mfma_f32_16x16x32_bf16 v[224:227], v[4:7], v[136:139], v[224:227]
v_mfma_f32_16x16x32_bf16 v[232:235], v[4:7], v[140:143], v[232:235]
v_mfma_f32_16x16x32_bf16 v[240:243], v[4:7], v[184:187], v[240:243]
v_mfma_f32_16x16x32_bf16 v[248:251], v[4:7], v[188:191], v[248:251]
ds_read_b64_tr_b16 v[4:5], v2 offset:40960
ds_read_b64_tr_b16 v[6:7], v2 offset:43008
s_waitcnt lgkmcnt(4)
v_mfma_f32_16x16x32_bf16 v[212:215], v[8:11], v[88:91], v[212:215]
v_mfma_f32_16x16x32_bf16 v[220:223], v[8:11], v[92:95], v[220:223]
v_mfma_f32_16x16x32_bf16 v[228:231], v[8:11], v[136:139], v[228:231]
v_mfma_f32_16x16x32_bf16 v[236:239], v[8:11], v[140:143], v[236:239]
v_mfma_f32_16x16x32_bf16 v[244:247], v[8:11], v[184:187], v[244:247]
v_mfma_f32_16x16x32_bf16 v[252:255], v[8:11], v[188:191], v[252:255]
ds_read_b64_tr_b16 v[8:9], v1 offset:45056
ds_read_b64_tr_b16 v[10:11], v1 offset:47104
ds_read_b128 v[16:19], v0 offset:12288
ds_read_b128 v[20:23], v0 offset:13312
ds_read_b128 v[24:27], v0 offset:14336
ds_read_b128 v[28:31], v0 offset:15360
ds_read_b128 v[32:35], v0 offset:16384
ds_read_b128 v[36:39], v0 offset:17408
s_add_u32 s68, s78, 69632
buffer_store_dwordx4 v[56:59], v0, s[48:51], s68 offen offset:0 sc1
s_waitcnt lgkmcnt(10)
v_mfma_f32_16x16x32_bf16 v[208:211], v[12:15], v[96:99], v[208:211]
v_mfma_f32_16x16x32_bf16 v[216:219], v[12:15], v[100:103], v[216:219]
v_mfma_f32_16x16x32_bf16 v[224:227], v[12:15], v[144:147], v[224:227]
v_mfma_f32_16x16x32_bf16 v[232:235], v[12:15], v[148:151], v[232:235]
v_mfma_f32_16x16x32_bf16 v[240:243], v[12:15], v[192:195], v[240:243]
v_mfma_f32_16x16x32_bf16 v[248:251], v[12:15], v[196:199], v[248:251]
ds_read_b64_tr_b16 v[12:13], v2 offset:45056
ds_read_b64_tr_b16 v[14:15], v2 offset:47104
s_add_u32 s68, s78, 69632
buffer_store_dwordx4 v[60:63], v0, s[48:51], s68 offen offset:1024 sc1
s_waitcnt lgkmcnt(10)
v_mfma_f32_16x16x32_bf16 v[212:215], v[4:7], v[96:99], v[212:215]
v_mfma_f32_16x16x32_bf16 v[220:223], v[4:7], v[100:103], v[220:223]
v_mfma_f32_16x16x32_bf16 v[228:231], v[4:7], v[144:147], v[228:231]
v_mfma_f32_16x16x32_bf16 v[236:239], v[4:7], v[148:151], v[236:239]
v_mfma_f32_16x16x32_bf16 v[244:247], v[4:7], v[192:195], v[244:247]
v_mfma_f32_16x16x32_bf16 v[252:255], v[4:7], v[196:199], v[252:255]
ds_read_b64_tr_b16 v[4:5], v1 offset:8192
ds_read_b64_tr_b16 v[6:7], v1 offset:10240
s_waitcnt lgkmcnt(4)
s_barrier
ds_write_b128 v0, v[64:67] offset:24576
ds_write_b128 v0, v[68:71] offset:25600
ds_write_b128 v0, v[72:75] offset:26624
ds_write_b128 v0, v[76:79] offset:27648
ds_write_b128 v0, v[80:83] offset:28672
ds_write_b128 v0, v[84:87] offset:29696
ds_write_b128 v0, v[88:91] offset:30720
ds_write_b128 v0, v[92:95] offset:31744
ds_write_b128 v0, v[96:99] offset:32768
ds_write_b128 v0, v[100:103] offset:33792
ds_write_b128 v0, v[104:107] offset:34816
ds_write_b128 v0, v[108:111] offset:35840
v_mfma_f32_16x16x32_bf16 v[208:211], v[8:11], v[104:107], v[208:211]
v_mfma_f32_16x16x32_bf16 v[216:219], v[8:11], v[108:111], v[216:219]
v_mfma_f32_16x16x32_bf16 v[224:227], v[8:11], v[152:155], v[224:227]
v_mfma_f32_16x16x32_bf16 v[232:235], v[8:11], v[156:159], v[232:235]
v_mfma_f32_16x16x32_bf16 v[240:243], v[8:11], v[200:203], v[240:243]
v_mfma_f32_16x16x32_bf16 v[248:251], v[8:11], v[204:207], v[248:251]
ds_read_b64_tr_b16 v[8:9], v2 offset:8192
ds_read_b64_tr_b16 v[10:11], v2 offset:10240
s_waitcnt lgkmcnt(15)
v_mfma_f32_16x16x32_bf16 v[212:215], v[12:15], v[104:107], v[212:215]
v_mfma_f32_16x16x32_bf16 v[220:223], v[12:15], v[108:111], v[220:223]
v_mfma_f32_16x16x32_bf16 v[228:231], v[12:15], v[152:155], v[228:231]
v_mfma_f32_16x16x32_bf16 v[236:239], v[12:15], v[156:159], v[236:239]
v_mfma_f32_16x16x32_bf16 v[244:247], v[12:15], v[200:203], v[244:247]
v_mfma_f32_16x16x32_bf16 v[252:255], v[12:15], v[204:207], v[252:255]
ds_read_b64_tr_b16 v[12:13], v1 offset:12288
ds_read_b64_tr_b16 v[14:15], v1 offset:14336
v_cvt_pk_bf16_f32 v40, v208, v209
v_cvt_pk_bf16_f32 v41, v210, v211
v_cvt_pk_bf16_f32 v42, v212, v213
v_cvt_pk_bf16_f32 v43, v214, v215
v_cvt_pk_bf16_f32 v44, v216, v217
v_cvt_pk_bf16_f32 v45, v218, v219
v_cvt_pk_bf16_f32 v46, v220, v221
v_cvt_pk_bf16_f32 v47, v222, v223
v_cvt_pk_bf16_f32 v48, v224, v225
v_cvt_pk_bf16_f32 v49, v226, v227
v_cvt_pk_bf16_f32 v50, v228, v229
v_cvt_pk_bf16_f32 v51, v230, v231
v_cvt_pk_bf16_f32 v52, v232, v233
v_cvt_pk_bf16_f32 v53, v234, v235
v_cvt_pk_bf16_f32 v54, v236, v237
v_cvt_pk_bf16_f32 v55, v238, v239
v_cvt_pk_bf16_f32 v56, v240, v241
v_cvt_pk_bf16_f32 v57, v242, v243
v_cvt_pk_bf16_f32 v58, v244, v245
v_cvt_pk_bf16_f32 v59, v246, v247
v_cvt_pk_bf16_f32 v60, v248, v249
v_cvt_pk_bf16_f32 v61, v250, v251
v_cvt_pk_bf16_f32 v62, v252, v253
v_cvt_pk_bf16_f32 v63, v254, v255
s_add_u32 s68, s78, 73728
buffer_store_dwordx4 v[40:43], v0, s[48:51], s68 offen offset:0 sc1
v_lshlrev_b32 v208, 16, v16
v_and_b32 v209, 0xffff0000, v16
v_lshlrev_b32 v210, 16, v17
v_and_b32 v211, 0xffff0000, v17
v_lshlrev_b32 v212, 16, v18
v_and_b32 v213, 0xffff0000, v18
v_lshlrev_b32 v214, 16, v19
v_and_b32 v215, 0xffff0000, v19
v_lshlrev_b32 v216, 16, v20
v_and_b32 v217, 0xffff0000, v20
v_lshlrev_b32 v218, 16, v21
v_and_b32 v219, 0xffff0000, v21
v_lshlrev_b32 v220, 16, v22
v_and_b32 v221, 0xffff0000, v22
v_lshlrev_b32 v222, 16, v23
v_and_b32 v223, 0xffff0000, v23
v_lshlrev_b32 v224, 16, v24
v_and_b32 v225, 0xffff0000, v24
v_lshlrev_b32 v226, 16, v25
v_and_b32 v227, 0xffff0000, v25
v_lshlrev_b32 v228, 16, v26
v_and_b32 v229, 0xffff0000, v26
v_lshlrev_b32 v230, 16, v27
v_and_b32 v231, 0xffff0000, v27
v_lshlrev_b32 v232, 16, v28
v_and_b32 v233, 0xffff0000, v28
v_lshlrev_b32 v234, 16, v29
v_and_b32 v235, 0xffff0000, v29
v_lshlrev_b32 v236, 16, v30
v_and_b32 v237, 0xffff0000, v30
v_lshlrev_b32 v238, 16, v31
v_and_b32 v239, 0xffff0000, v31
v_lshlrev_b32 v240, 16, v32
v_and_b32 v241, 0xffff0000, v32
v_lshlrev_b32 v242, 16, v33
v_and_b32 v243, 0xffff0000, v33
v_lshlrev_b32 v244, 16, v34
v_and_b32 v245, 0xffff0000, v34
v_lshlrev_b32 v246, 16, v35
v_and_b32 v247, 0xffff0000, v35
v_lshlrev_b32 v248, 16, v36
v_and_b32 v249, 0xffff0000, v36
v_lshlrev_b32 v250, 16, v37
v_and_b32 v251, 0xffff0000, v37
v_lshlrev_b32 v252, 16, v38
v_and_b32 v253, 0xffff0000, v38
v_lshlrev_b32 v254, 16, v39
v_and_b32 v255, 0xffff0000, v39
s_waitcnt lgkmcnt(15)
v_mfma_f32_16x16x32_bf16 v[208:211], v[4:7], v[64:67], v[208:211]
v_mfma_f32_16x16x32_bf16 v[216:219], v[4:7], v[68:71], v[216:219]
v_mfma_f32_16x16x32_bf16 v[224:227], v[4:7], v[112:115], v[224:227]
v_mfma_f32_16x16x32_bf16 v[232:235], v[4:7], v[116:119], v[232:235]
v_mfma_f32_16x16x32_bf16 v[240:243], v[4:7], v[160:163], v[240:243]
v_mfma_f32_16x16x32_bf16 v[248:251], v[4:7], v[164:167], v[248:251]
ds_read_b64_tr_b16 v[4:5], v2 offset:12288
ds_read_b64_tr_b16 v[6:7], v2 offset:14336
s_add_u32 s68, s78, 73728
buffer_store_dwordx4 v[44:47], v0, s[48:51], s68 offen offset:1024 sc1
s_waitcnt lgkmcnt(6)
s_barrier
s_waitcnt lgkmcnt(4)
v_mfma_f32_16x16x32_bf16 v[212:215], v[8:11], v[64:67], v[212:215]
v_mfma_f32_16x16x32_bf16 v[220:223], v[8:11], v[68:71], v[220:223]
v_mfma_f32_16x16x32_bf16 v[228:231], v[8:11], v[112:115], v[228:231]
v_mfma_f32_16x16x32_bf16 v[236:239], v[8:11], v[116:119], v[236:239]
v_mfma_f32_16x16x32_bf16 v[244:247], v[8:11], v[160:163], v[244:247]
v_mfma_f32_16x16x32_bf16 v[252:255], v[8:11], v[164:167], v[252:255]
ds_read_b64_tr_b16 v[8:9], v1 offset:16384
ds_read_b64_tr_b16 v[10:11], v1 offset:18432
s_waitcnt lgkmcnt(4)
v_mfma_f32_16x16x32_bf16 v[208:211], v[12:15], v[72:75], v[208:211]
v_mfma_f32_16x16x32_bf16 v[216:219], v[12:15], v[76:79], v[216:219]
v_mfma_f32_16x16x32_bf16 v[224:227], v[12:15], v[120:123], v[224:227]
v_mfma_f32_16x16x32_bf16 v[232:235], v[12:15], v[124:127], v[232:235]
v_mfma_f32_16x16x32_bf16 v[240:243], v[12:15], v[168:171], v[240:243]
v_mfma_f32_16x16x32_bf16 v[248:251], v[12:15], v[172:175], v[248:251]
ds_read_b64_tr_b16 v[12:13], v2 offset:16384
ds_read_b64_tr_b16 v[14:15], v2 offset:18432
s_waitcnt lgkmcnt(4)
v_mfma_f32_16x16x32_bf16 v[212:215], v[4:7], v[72:75], v[212:215]
v_mfma_f32_16x16x32_bf16 v[220:223], v[4:7], v[76:79], v[220:223]
v_mfma_f32_16x16x32_bf16 v[228:231], v[4:7], v[120:123], v[228:231]
v_mfma_f32_16x16x32_bf16 v[236:239], v[4:7], v[124:127], v[236:239]
v_mfma_f32_16x16x32_bf16 v[244:247], v[4:7], v[168:171], v[244:247]
v_mfma_f32_16x16x32_bf16 v[252:255], v[4:7], v[172:175], v[252:255]
ds_read_b64_tr_b16 v[4:5], v1 offset:20480
ds_read_b64_tr_b16 v[6:7], v1 offset:22528
s_waitcnt lgkmcnt(4)
v_mfma_f32_16x16x32_bf16 v[208:211], v[8:11], v[80:83], v[208:211]
v_mfma_f32_16x16x32_bf16 v[216:219], v[8:11], v[84:87], v[216:219]
v_mfma_f32_16x16x32_bf16 v[224:227], v[8:11], v[128:131], v[224:227]
v_mfma_f32_16x16x32_bf16 v[232:235], v[8:11], v[132:135], v[232:235]
v_mfma_f32_16x16x32_bf16 v[240:243], v[8:11], v[176:179], v[240:243]
v_mfma_f32_16x16x32_bf16 v[248:251], v[8:11], v[180:183], v[248:251]
ds_read_b64_tr_b16 v[8:9], v2 offset:20480
ds_read_b64_tr_b16 v[10:11], v2 offset:22528
s_add_u32 s68, s78, 81920
buffer_store_dwordx4 v[48:51], v0, s[48:51], s68 offen offset:0 sc1
s_waitcnt lgkmcnt(4)
v_mfma_f32_16x16x32_bf16 v[212:215], v[12:15], v[80:83], v[212:215]
v_mfma_f32_16x16x32_bf16 v[220:223], v[12:15], v[84:87], v[220:223]
v_mfma_f32_16x16x32_bf16 v[228:231], v[12:15], v[128:131], v[228:231]
v_mfma_f32_16x16x32_bf16 v[236:239], v[12:15], v[132:135], v[236:239]
v_mfma_f32_16x16x32_bf16 v[244:247], v[12:15], v[176:179], v[244:247]
v_mfma_f32_16x16x32_bf16 v[252:255], v[12:15], v[180:183], v[252:255]
ds_read_b64_tr_b16 v[12:13], v1 offset:24576
ds_read_b64_tr_b16 v[14:15], v1 offset:26624
s_add_u32 s68, s78, 81920
buffer_store_dwordx4 v[52:55], v0, s[48:51], s68 offen offset:1024 sc1
s_waitcnt lgkmcnt(4)
v_mfma_f32_16x16x32_bf16 v[208:211], v[4:7], v[88:91], v[208:211]
v_mfma_f32_16x16x32_bf16 v[216:219], v[4:7], v[92:95], v[216:219]
v_mfma_f32_16x16x32_bf16 v[224:227], v[4:7], v[136:139], v[224:227]
v_mfma_f32_16x16x32_bf16 v[232:235], v[4:7], v[140:143], v[232:235]
v_mfma_f32_16x16x32_bf16 v[240:243], v[4:7], v[184:187], v[240:243]
v_mfma_f32_16x16x32_bf16 v[248:251], v[4:7], v[188:191], v[248:251]
ds_read_b64_tr_b16 v[4:5], v2 offset:24576
ds_read_b64_tr_b16 v[6:7], v2 offset:26624
s_barrier
s_waitcnt lgkmcnt(4)
v_mfma_f32_16x16x32_bf16 v[212:215], v[8:11], v[88:91], v[212:215]
v_mfma_f32_16x16x32_bf16 v[220:223], v[8:11], v[92:95], v[220:223]
v_mfma_f32_16x16x32_bf16 v[228:231], v[8:11], v[136:139], v[228:231]
v_mfma_f32_16x16x32_bf16 v[236:239], v[8:11], v[140:143], v[236:239]
v_mfma_f32_16x16x32_bf16 v[244:247], v[8:11], v[184:187], v[244:247]
v_mfma_f32_16x16x32_bf16 v[252:255], v[8:11], v[188:191], v[252:255]
ds_read_b64_tr_b16 v[8:9], v1 offset:28672
ds_read_b64_tr_b16 v[10:11], v1 offset:30720
s_waitcnt lgkmcnt(4)
v_mfma_f32_16x16x32_bf16 v[208:211], v[12:15], v[96:99], v[208:211]
v_mfma_f32_16x16x32_bf16 v[216:219], v[12:15], v[100:103], v[216:219]
v_mfma_f32_16x16x32_bf16 v[224:227], v[12:15], v[144:147], v[224:227]
v_mfma_f32_16x16x32_bf16 v[232:235], v[12:15], v[148:151], v[232:235]
v_mfma_f32_16x16x32_bf16 v[240:243], v[12:15], v[192:195], v[240:243]
v_mfma_f32_16x16x32_bf16 v[248:251], v[12:15], v[196:199], v[248:251]
ds_read_b64_tr_b16 v[12:13], v2 offset:28672
ds_read_b64_tr_b16 v[14:15], v2 offset:30720
s_add_u32 s68, s78, 90112
buffer_store_dwordx4 v[56:59], v0, s[48:51], s68 offen offset:0 sc1
s_waitcnt lgkmcnt(4)
v_mfma_f32_16x16x32_bf16 v[212:215], v[4:7], v[96:99], v[212:215]
v_mfma_f32_16x16x32_bf16 v[220:223], v[4:7], v[100:103], v[220:223]
v_mfma_f32_16x16x32_bf16 v[228:231], v[4:7], v[144:147], v[228:231]
v_mfma_f32_16x16x32_bf16 v[236:239], v[4:7], v[148:151], v[236:239]
v_mfma_f32_16x16x32_bf16 v[244:247], v[4:7], v[192:195], v[244:247]
v_mfma_f32_16x16x32_bf16 v[252:255], v[4:7], v[196:199], v[252:255]
s_add_u32 s68, s78, 90112
buffer_store_dwordx4 v[60:63], v0, s[48:51], s68 offen offset:1024 sc1
s_waitcnt lgkmcnt(2)
v_mfma_f32_16x16x32_bf16 v[208:211], v[8:11], v[104:107], v[208:211]
v_mfma_f32_16x16x32_bf16 v[216:219], v[8:11], v[108:111], v[216:219]
v_mfma_f32_16x16x32_bf16 v[224:227], v[8:11], v[152:155], v[224:227]
v_mfma_f32_16x16x32_bf16 v[232:235], v[8:11], v[156:159], v[232:235]
v_mfma_f32_16x16x32_bf16 v[240:243], v[8:11], v[200:203], v[240:243]
v_mfma_f32_16x16x32_bf16 v[248:251], v[8:11], v[204:207], v[248:251]
s_barrier
s_waitcnt lgkmcnt(0)
v_mfma_f32_16x16x32_bf16 v[212:215], v[12:15], v[104:107], v[212:215]
v_mfma_f32_16x16x32_bf16 v[220:223], v[12:15], v[108:111], v[220:223]
v_mfma_f32_16x16x32_bf16 v[228:231], v[12:15], v[152:155], v[228:231]
v_mfma_f32_16x16x32_bf16 v[236:239], v[12:15], v[156:159], v[236:239]
v_mfma_f32_16x16x32_bf16 v[244:247], v[12:15], v[200:203], v[244:247]
v_mfma_f32_16x16x32_bf16 v[252:255], v[12:15], v[204:207], v[252:255]
v_cvt_pk_bf16_f32 v40, v208, v209
v_cvt_pk_bf16_f32 v41, v210, v211
s_nop 0
v_cvt_pk_bf16_f32 v42, v212, v213
v_cvt_pk_bf16_f32 v43, v214, v215
v_cvt_pk_bf16_f32 v44, v216, v217
v_cvt_pk_bf16_f32 v45, v218, v219
v_cvt_pk_bf16_f32 v46, v220, v221
v_cvt_pk_bf16_f32 v47, v222, v223
v_cvt_pk_bf16_f32 v48, v224, v225
v_cvt_pk_bf16_f32 v49, v226, v227
v_cvt_pk_bf16_f32 v50, v228, v229
v_cvt_pk_bf16_f32 v51, v230, v231
v_cvt_pk_bf16_f32 v52, v232, v233
v_cvt_pk_bf16_f32 v53, v234, v235
v_cvt_pk_bf16_f32 v54, v236, v237
v_cvt_pk_bf16_f32 v55, v238, v239
v_cvt_pk_bf16_f32 v56, v240, v241
v_cvt_pk_bf16_f32 v57, v242, v243
v_cvt_pk_bf16_f32 v58, v244, v245
v_cvt_pk_bf16_f32 v59, v246, v247
v_cvt_pk_bf16_f32 v60, v248, v249
v_cvt_pk_bf16_f32 v61, v250, v251
v_cvt_pk_bf16_f32 v62, v252, v253
v_cvt_pk_bf16_f32 v63, v254, v255
s_add_u32 s68, s78, 77824
buffer_store_dwordx4 v[40:43], v0, s[48:51], s68 offen offset:0 sc1
s_add_u32 s68, s78, 77824
buffer_store_dwordx4 v[44:47], v0, s[48:51], s68 offen offset:1024 sc1
s_add_u32 s68, s78, 86016
buffer_store_dwordx4 v[48:51], v0, s[48:51], s68 offen offset:0 sc1
s_add_u32 s68, s78, 86016
buffer_store_dwordx4 v[52:55], v0, s[48:51], s68 offen offset:1024 sc1
s_add_u32 s68, s78, 94208
buffer_store_dwordx4 v[56:59], v0, s[48:51], s68 offen offset:0 sc1
s_add_u32 s68, s78, 94208
buffer_store_dwordx4 v[60:63], v0, s[48:51], s68 offen offset:1024 sc1
s_branch L_reduce
L_stage2_1:
s_lshl_b32 s78, s64, 4
s_add_u32 s78, s78, s65
s_lshl_b32 s78, s78, 3
s_add_u32 s78, s78, s66
s_mul_i32 s78, s78, 122880
s_add_u32 s78, s78, 262144
v_lshlrev_b32 v3, 4, v0
v_lshrrev_b32 v4, 2, v0
v_lshlrev_b32 v5, 7, v4
v_bfe_u32 v4, v4, 1, 2
v_and_b32 v6, 3, v0
v_lshl_add_u32 v5, v6, 3, v5
v_xor_b32 v6, 2, v4
v_lshl_add_u32 v1, v6, 5, v5
v_add_u32 v1, 53248, v1
v_xor_b32 v6, 3, v4
v_lshl_add_u32 v2, v6, 5, v5
v_add_u32 v2, 53248, v2
v_mov_b32 v0, v3
s_barrier
ds_read_b128 v[64:67], v0 offset:24576
ds_read_b128 v[68:71], v0 offset:25600
ds_read_b128 v[72:75], v0 offset:26624
ds_read_b128 v[76:79], v0 offset:27648
ds_read_b128 v[80:83], v0 offset:28672
ds_read_b128 v[84:87], v0 offset:29696
ds_read_b128 v[88:91], v0 offset:30720
ds_read_b128 v[92:95], v0 offset:31744
ds_read_b128 v[96:99], v0 offset:32768
ds_read_b128 v[100:103], v0 offset:33792
ds_read_b128 v[104:107], v0 offset:34816
ds_read_b128 v[108:111], v0 offset:35840
ds_read_b128 v[112:115], v0 offset:36864
ds_read_b128 v[116:119], v0 offset:37888
ds_read_b128 v[120:123], v0 offset:38912
ds_read_b128 v[124:127], v0 offset:39936
ds_read_b128 v[128:131], v0 offset:40960
ds_read_b128 v[132:135], v0 offset:41984
ds_read_b128 v[136:139], v0 offset:43008
ds_read_b128 v[140:143], v0 offset:44032
ds_read_b128 v[144:147], v0 offset:45056
ds_read_b128 v[148:151], v0 offset:46080
ds_read_b128 v[152:155], v0 offset:47104
ds_read_b128 v[156:159], v0 offset:48128
ds_read_b128 v[160:163], v0 offset:49152
ds_read_b128 v[164:167], v0 offset:50176
ds_read_b128 v[168:171], v0 offset:51200
ds_read_b128 v[172:175], v0 offset:52224
ds_read_b128 v[176:179], v0 offset:53248
ds_read_b128 v[180:183], v0 offset:54272
ds_read_b128 v[184:187], v0 offset:55296
ds_read_b128 v[188:191], v0 offset:56320
ds_read_b128 v[192:195], v0 offset:57344
ds_read_b128 v[196:199], v0 offset:58368
ds_read_b128 v[200:203], v0 offset:59392
ds_read_b128 v[204:207], v0 offset:60416
s_waitcnt lgkmcnt(0)
s_setprio 0
s_barrier
ds_read_b128 v[16:19], v0 offset:6144
ds_read_b128 v[20:23], v0 offset:7168
ds_read_b128 v[24:27], v0 offset:8192
ds_read_b128 v[28:31], v0 offset:9216
ds_read_b128 v[32:35], v0 offset:10240
ds_read_b128 v[36:39], v0 offset:11264
ds_read_b64_tr_b16 v[4:5], v1 offset:24576
ds_read_b64_tr_b16 v[6:7], v1 offset:26624
ds_read_b64_tr_b16 v[8:9], v2 offset:24576
ds_read_b64_tr_b16 v[10:11], v2 offset:26624
ds_read_b64_tr_b16 v[12:13], v1 offset:28672
ds_read_b64_tr_b16 v[14:15], v1 offset:30720
s_waitcnt lgkmcnt(6)
v_lshlrev_b32 v208, 16, v16
v_and_b32 v209, 0xffff0000, v16
v_lshlrev_b32 v210, 16, v17
v_and_b32 v211, 0xffff0000, v17
v_lshlrev_b32 v212, 16, v18
v_and_b32 v213, 0xffff0000, v18
v_lshlrev_b32 v214, 16, v19
v_and_b32 v215, 0xffff0000, v19
v_lshlrev_b32 v216, 16, v20
v_and_b32 v217, 0xffff0000, v20
v_lshlrev_b32 v218, 16, v21
v_and_b32 v219, 0xffff0000, v21
v_lshlrev_b32 v220, 16, v22
v_and_b32 v221, 0xffff0000, v22
v_lshlrev_b32 v222, 16, v23
v_and_b32 v223, 0xffff0000, v23
v_lshlrev_b32 v224, 16, v24
v_and_b32 v225, 0xffff0000, v24
v_lshlrev_b32 v226, 16, v25
v_and_b32 v227, 0xffff0000, v25
v_lshlrev_b32 v228, 16, v26
v_and_b32 v229, 0xffff0000, v26
v_lshlrev_b32 v230, 16, v27
v_and_b32 v231, 0xffff0000, v27
v_lshlrev_b32 v232, 16, v28
v_and_b32 v233, 0xffff0000, v28
v_lshlrev_b32 v234, 16, v29
v_and_b32 v235, 0xffff0000, v29
v_lshlrev_b32 v236, 16, v30
v_and_b32 v237, 0xffff0000, v30
v_lshlrev_b32 v238, 16, v31
v_and_b32 v239, 0xffff0000, v31
v_lshlrev_b32 v240, 16, v32
v_and_b32 v241, 0xffff0000, v32
v_lshlrev_b32 v242, 16, v33
v_and_b32 v243, 0xffff0000, v33
v_lshlrev_b32 v244, 16, v34
v_and_b32 v245, 0xffff0000, v34
v_lshlrev_b32 v246, 16, v35
v_and_b32 v247, 0xffff0000, v35
v_lshlrev_b32 v248, 16, v36
v_and_b32 v249, 0xffff0000, v36
v_lshlrev_b32 v250, 16, v37
v_and_b32 v251, 0xffff0000, v37
v_lshlrev_b32 v252, 16, v38
v_and_b32 v253, 0xffff0000, v38
v_lshlrev_b32 v254, 16, v39
v_and_b32 v255, 0xffff0000, v39
s_waitcnt lgkmcnt(4)
v_mfma_f32_16x16x32_bf16 v[208:211], v[4:7], v[64:67], v[208:211]
v_mfma_f32_16x16x32_bf16 v[216:219], v[4:7], v[68:71], v[216:219]
v_mfma_f32_16x16x32_bf16 v[224:227], v[4:7], v[112:115], v[224:227]
v_mfma_f32_16x16x32_bf16 v[232:235], v[4:7], v[116:119], v[232:235]
v_mfma_f32_16x16x32_bf16 v[240:243], v[4:7], v[160:163], v[240:243]
v_mfma_f32_16x16x32_bf16 v[248:251], v[4:7], v[164:167], v[248:251]
ds_read_b64_tr_b16 v[4:5], v2 offset:28672
ds_read_b64_tr_b16 v[6:7], v2 offset:30720
s_barrier
s_waitcnt lgkmcnt(4)
v_mfma_f32_16x16x32_bf16 v[212:215], v[8:11], v[64:67], v[212:215]
v_mfma_f32_16x16x32_bf16 v[220:223], v[8:11], v[68:71], v[220:223]
v_mfma_f32_16x16x32_bf16 v[228:231], v[8:11], v[112:115], v[228:231]
v_mfma_f32_16x16x32_bf16 v[236:239], v[8:11], v[116:119], v[236:239]
v_mfma_f32_16x16x32_bf16 v[244:247], v[8:11], v[160:163], v[244:247]
v_mfma_f32_16x16x32_bf16 v[252:255], v[8:11], v[164:167], v[252:255]
ds_read_b64_tr_b16 v[8:9], v1 offset:32768
ds_read_b64_tr_b16 v[10:11], v1 offset:34816
s_waitcnt lgkmcnt(4)
v_mfma_f32_16x16x32_bf16 v[208:211], v[12:15], v[72:75], v[208:211]
v_mfma_f32_16x16x32_bf16 v[216:219], v[12:15], v[76:79], v[216:219]
v_mfma_f32_16x16x32_bf16 v[224:227], v[12:15], v[120:123], v[224:227]
v_mfma_f32_16x16x32_bf16 v[232:235], v[12:15], v[124:127], v[232:235]
v_mfma_f32_16x16x32_bf16 v[240:243], v[12:15], v[168:171], v[240:243]
v_mfma_f32_16x16x32_bf16 v[248:251], v[12:15], v[172:175], v[248:251]
ds_read_b64_tr_b16 v[12:13], v2 offset:32768
ds_read_b64_tr_b16 v[14:15], v2 offset:34816
s_waitcnt lgkmcnt(4)
v_mfma_f32_16x16x32_bf16 v[212:215], v[4:7], v[72:75], v[212:215]
v_mfma_f32_16x16x32_bf16 v[220:223], v[4:7], v[76:79], v[220:223]
v_mfma_f32_16x16x32_bf16 v[228:231], v[4:7], v[120:123], v[228:231]
v_mfma_f32_16x16x32_bf16 v[236:239], v[4:7], v[124:127], v[236:239]
v_mfma_f32_16x16x32_bf16 v[244:247], v[4:7], v[168:171], v[244:247]
v_mfma_f32_16x16x32_bf16 v[252:255], v[4:7], v[172:175], v[252:255]
ds_read_b64_tr_b16 v[4:5], v1 offset:36864
ds_read_b64_tr_b16 v[6:7], v1 offset:38912
s_waitcnt lgkmcnt(4)
v_mfma_f32_16x16x32_bf16 v[208:211], v[8:11], v[80:83], v[208:211]
v_mfma_f32_16x16x32_bf16 v[216:219], v[8:11], v[84:87], v[216:219]
v_mfma_f32_16x16x32_bf16 v[224:227], v[8:11], v[128:131], v[224:227]
v_mfma_f32_16x16x32_bf16 v[232:235], v[8:11], v[132:135], v[232:235]
v_mfma_f32_16x16x32_bf16 v[240:243], v[8:11], v[176:179], v[240:243]
v_mfma_f32_16x16x32_bf16 v[248:251], v[8:11], v[180:183], v[248:251]
ds_read_b64_tr_b16 v[8:9], v2 offset:36864
ds_read_b64_tr_b16 v[10:11], v2 offset:38912
s_barrier
s_waitcnt lgkmcnt(4)
v_mfma_f32_16x16x32_bf16 v[212:215], v[12:15], v[80:83], v[212:215]
v_mfma_f32_16x16x32_bf16 v[220:223], v[12:15], v[84:87], v[220:223]
v_mfma_f32_16x16x32_bf16 v[228:231], v[12:15], v[128:131], v[228:231]
v_mfma_f32_16x16x32_bf16 v[236:239], v[12:15], v[132:135], v[236:239]
v_mfma_f32_16x16x32_bf16 v[244:247], v[12:15], v[176:179], v[244:247]
v_mfma_f32_16x16x32_bf16 v[252:255], v[12:15], v[180:183], v[252:255]
ds_read_b64_tr_b16 v[12:13], v1 offset:40960
ds_read_b64_tr_b16 v[14:15], v1 offset:43008
s_waitcnt lgkmcnt(4)
v_mfma_f32_16x16x32_bf16 v[208:211], v[4:7], v[88:91], v[208:211]
v_mfma_f32_16x16x32_bf16 v[216:219], v[4:7], v[92:95], v[216:219]
v_mfma_f32_16x16x32_bf16 v[224:227], v[4:7], v[136:139], v[224:227]
v_mfma_f32_16x16x32_bf16 v[232:235], v[4:7], v[140:143], v[232:235]
v_mfma_f32_16x16x32_bf16 v[240:243], v[4:7], v[184:187], v[240:243]
v_mfma_f32_16x16x32_bf16 v[248:251], v[4:7], v[188:191], v[248:251]
ds_read_b64_tr_b16 v[4:5], v2 offset:40960
ds_read_b64_tr_b16 v[6:7], v2 offset:43008
s_waitcnt lgkmcnt(4)
v_mfma_f32_16x16x32_bf16 v[212:215], v[8:11], v[88:91], v[212:215]
v_mfma_f32_16x16x32_bf16 v[220:223], v[8:11], v[92:95], v[220:223]
v_mfma_f32_16x16x32_bf16 v[228:231], v[8:11], v[136:139], v[228:231]
v_mfma_f32_16x16x32_bf16 v[236:239], v[8:11], v[140:143], v[236:239]
v_mfma_f32_16x16x32_bf16 v[244:247], v[8:11], v[184:187], v[244:247]
v_mfma_f32_16x16x32_bf16 v[252:255], v[8:11], v[188:191], v[252:255]
ds_read_b64_tr_b16 v[8:9], v1 offset:45056
ds_read_b64_tr_b16 v[10:11], v1 offset:47104
ds_read_b128 v[16:19], v0 offset:18432
ds_read_b128 v[20:23], v0 offset:19456
ds_read_b128 v[24:27], v0 offset:20480
ds_read_b128 v[28:31], v0 offset:21504
ds_read_b128 v[32:35], v0 offset:22528
ds_read_b128 v[36:39], v0 offset:23552
s_waitcnt lgkmcnt(10)
v_mfma_f32_16x16x32_bf16 v[208:211], v[12:15], v[96:99], v[208:211]
v_mfma_f32_16x16x32_bf16 v[216:219], v[12:15], v[100:103], v[216:219]
v_mfma_f32_16x16x32_bf16 v[224:227], v[12:15], v[144:147], v[224:227]
v_mfma_f32_16x16x32_bf16 v[232:235], v[12:15], v[148:151], v[232:235]
v_mfma_f32_16x16x32_bf16 v[240:243], v[12:15], v[192:195], v[240:243]
v_mfma_f32_16x16x32_bf16 v[248:251], v[12:15], v[196:199], v[248:251]
ds_read_b64_tr_b16 v[12:13], v2 offset:45056
ds_read_b64_tr_b16 v[14:15], v2 offset:47104
s_waitcnt lgkmcnt(10)
v_mfma_f32_16x16x32_bf16 v[212:215], v[4:7], v[96:99], v[212:215]
v_mfma_f32_16x16x32_bf16 v[220:223], v[4:7], v[100:103], v[220:223]
v_mfma_f32_16x16x32_bf16 v[228:231], v[4:7], v[144:147], v[228:231]
v_mfma_f32_16x16x32_bf16 v[236:239], v[4:7], v[148:151], v[236:239]
v_mfma_f32_16x16x32_bf16 v[244:247], v[4:7], v[192:195], v[244:247]
v_mfma_f32_16x16x32_bf16 v[252:255], v[4:7], v[196:199], v[252:255]
ds_read_b64_tr_b16 v[4:5], v1 offset:8192
ds_read_b64_tr_b16 v[6:7], v1 offset:10240
s_waitcnt lgkmcnt(10)
v_mfma_f32_16x16x32_bf16 v[208:211], v[8:11], v[104:107], v[208:211]
v_mfma_f32_16x16x32_bf16 v[216:219], v[8:11], v[108:111], v[216:219]
v_mfma_f32_16x16x32_bf16 v[224:227], v[8:11], v[152:155], v[224:227]
v_mfma_f32_16x16x32_bf16 v[232:235], v[8:11], v[156:159], v[232:235]
v_mfma_f32_16x16x32_bf16 v[240:243], v[8:11], v[200:203], v[240:243]
v_mfma_f32_16x16x32_bf16 v[248:251], v[8:11], v[204:207], v[248:251]
ds_read_b64_tr_b16 v[8:9], v2 offset:8192
ds_read_b64_tr_b16 v[10:11], v2 offset:10240
s_waitcnt lgkmcnt(4)
v_mfma_f32_16x16x32_bf16 v[212:215], v[12:15], v[104:107], v[212:215]
v_mfma_f32_16x16x32_bf16 v[220:223], v[12:15], v[108:111], v[220:223]
v_mfma_f32_16x16x32_bf16 v[228:231], v[12:15], v[152:155], v[228:231]
v_mfma_f32_16x16x32_bf16 v[236:239], v[12:15], v[156:159], v[236:239]
v_mfma_f32_16x16x32_bf16 v[244:247], v[12:15], v[200:203], v[244:247]
v_mfma_f32_16x16x32_bf16 v[252:255], v[12:15], v[204:207], v[252:255]
ds_read_b64_tr_b16 v[12:13], v1 offset:12288
ds_read_b64_tr_b16 v[14:15], v1 offset:14336
v_cvt_pk_bf16_f32 v40, v208, v209
v_cvt_pk_bf16_f32 v41, v210, v211
v_cvt_pk_bf16_f32 v42, v212, v213
v_cvt_pk_bf16_f32 v43, v214, v215
v_cvt_pk_bf16_f32 v44, v216, v217
v_cvt_pk_bf16_f32 v45, v218, v219
v_cvt_pk_bf16_f32 v46, v220, v221
v_cvt_pk_bf16_f32 v47, v222, v223
v_cvt_pk_bf16_f32 v48, v224, v225
v_cvt_pk_bf16_f32 v49, v226, v227
v_cvt_pk_bf16_f32 v50, v228, v229
v_cvt_pk_bf16_f32 v51, v230, v231
v_cvt_pk_bf16_f32 v52, v232, v233
v_cvt_pk_bf16_f32 v53, v234, v235
v_cvt_pk_bf16_f32 v54, v236, v237
v_cvt_pk_bf16_f32 v55, v238, v239
v_cvt_pk_bf16_f32 v56, v240, v241
v_cvt_pk_bf16_f32 v57, v242, v243
v_cvt_pk_bf16_f32 v58, v244, v245
v_cvt_pk_bf16_f32 v59, v246, v247
v_cvt_pk_bf16_f32 v60, v248, v249
v_cvt_pk_bf16_f32 v61, v250, v251
v_cvt_pk_bf16_f32 v62, v252, v253
v_cvt_pk_bf16_f32 v63, v254, v255
s_add_u32 s68, s78, 0
buffer_store_dwordx4 v[40:43], v0, s[48:51], s68 offen offset:2048 sc1
s_barrier
v_lshlrev_b32 v208, 16, v16
v_and_b32 v209, 0xffff0000, v16
v_lshlrev_b32 v210, 16, v17
v_and_b32 v211, 0xffff0000, v17
v_lshlrev_b32 v212, 16, v18
v_and_b32 v213, 0xffff0000, v18
v_lshlrev_b32 v214, 16, v19
v_and_b32 v215, 0xffff0000, v19
v_lshlrev_b32 v216, 16, v20
v_and_b32 v217, 0xffff0000, v20
v_lshlrev_b32 v218, 16, v21
v_and_b32 v219, 0xffff0000, v21
v_lshlrev_b32 v220, 16, v22
v_and_b32 v221, 0xffff0000, v22
v_lshlrev_b32 v222, 16, v23
v_and_b32 v223, 0xffff0000, v23
v_lshlrev_b32 v224, 16, v24
v_and_b32 v225, 0xffff0000, v24
v_lshlrev_b32 v226, 16, v25
v_and_b32 v227, 0xffff0000, v25
v_lshlrev_b32 v228, 16, v26
v_and_b32 v229, 0xffff0000, v26
v_lshlrev_b32 v230, 16, v27
v_and_b32 v231, 0xffff0000, v27
v_lshlrev_b32 v232, 16, v28
v_and_b32 v233, 0xffff0000, v28
v_lshlrev_b32 v234, 16, v29
v_and_b32 v235, 0xffff0000, v29
v_lshlrev_b32 v236, 16, v30
v_and_b32 v237, 0xffff0000, v30
v_lshlrev_b32 v238, 16, v31
v_and_b32 v239, 0xffff0000, v31
v_lshlrev_b32 v240, 16, v32
v_and_b32 v241, 0xffff0000, v32
v_lshlrev_b32 v242, 16, v33
v_and_b32 v243, 0xffff0000, v33
v_lshlrev_b32 v244, 16, v34
v_and_b32 v245, 0xffff0000, v34
v_lshlrev_b32 v246, 16, v35
v_and_b32 v247, 0xffff0000, v35
v_lshlrev_b32 v248, 16, v36
v_and_b32 v249, 0xffff0000, v36
v_lshlrev_b32 v250, 16, v37
v_and_b32 v251, 0xffff0000, v37
v_lshlrev_b32 v252, 16, v38
v_and_b32 v253, 0xffff0000, v38
v_lshlrev_b32 v254, 16, v39
v_and_b32 v255, 0xffff0000, v39
s_waitcnt lgkmcnt(4)
v_mfma_f32_16x16x32_bf16 v[208:211], v[4:7], v[64:67], v[208:211]
v_mfma_f32_16x16x32_bf16 v[216:219], v[4:7], v[68:71], v[216:219]
v_mfma_f32_16x16x32_bf16 v[224:227], v[4:7], v[112:115], v[224:227]
v_mfma_f32_16x16x32_bf16 v[232:235], v[4:7], v[116:119], v[232:235]
v_mfma_f32_16x16x32_bf16 v[240:243], v[4:7], v[160:163], v[240:243]
v_mfma_f32_16x16x32_bf16 v[248:251], v[4:7], v[164:167], v[248:251]
ds_read_b64_tr_b16 v[4:5], v2 offset:12288
ds_read_b64_tr_b16 v[6:7], v2 offset:14336
s_add_u32 s68, s78, 0
buffer_store_dwordx4 v[44:47], v0, s[48:51], s68 offen offset:3072 sc1
s_waitcnt lgkmcnt(4)
v_mfma_f32_16x16x32_bf16 v[212:215], v[8:11], v[64:67], v[212:215]
v_mfma_f32_16x16x32_bf16 v[220:223], v[8:11], v[68:71], v[220:223]
v_mfma_f32_16x16x32_bf16 v[228:231], v[8:11], v[112:115], v[228:231]
v_mfma_f32_16x16x32_bf16 v[236:239], v[8:11], v[116:119], v[236:239]
v_mfma_f32_16x16x32_bf16 v[244:247], v[8:11], v[160:163], v[244:247]
v_mfma_f32_16x16x32_bf16 v[252:255], v[8:11], v[164:167], v[252:255]
ds_read_b64_tr_b16 v[8:9], v1 offset:16384
ds_read_b64_tr_b16 v[10:11], v1 offset:18432
s_add_u32 s68, s78, 8192
buffer_store_dwordx4 v[48:51], v0, s[48:51], s68 offen offset:2048 sc1
s_barrier
s_waitcnt lgkmcnt(4)
v_mfma_f32_16x16x32_bf16 v[208:211], v[12:15], v[72:75], v[208:211]
v_mfma_f32_16x16x32_bf16 v[216:219], v[12:15], v[76:79], v[216:219]
v_mfma_f32_16x16x32_bf16 v[224:227], v[12:15], v[120:123], v[224:227]
v_mfma_f32_16x16x32_bf16 v[232:235], v[12:15], v[124:127], v[232:235]
v_mfma_f32_16x16x32_bf16 v[240:243], v[12:15], v[168:171], v[240:243]
v_mfma_f32_16x16x32_bf16 v[248:251], v[12:15], v[172:175], v[248:251]
ds_read_b64_tr_b16 v[12:13], v2 offset:16384
ds_read_b64_tr_b16 v[14:15], v2 offset:18432
s_waitcnt lgkmcnt(4)
v_mfma_f32_16x16x32_bf16 v[212:215], v[4:7], v[72:75], v[212:215]
v_mfma_f32_16x16x32_bf16 v[220:223], v[4:7], v[76:79], v[220:223]
v_mfma_f32_16x16x32_bf16 v[228:231], v[4:7], v[120:123], v[228:231]
v_mfma_f32_16x16x32_bf16 v[236:239], v[4:7], v[124:127], v[236:239]
v_mfma_f32_16x16x32_bf16 v[244:247], v[4:7], v[168:171], v[244:247]
v_mfma_f32_16x16x32_bf16 v[252:255], v[4:7], v[172:175], v[252:255]
ds_read_b64_tr_b16 v[4:5], v1 offset:20480
ds_read_b64_tr_b16 v[6:7], v1 offset:22528
s_waitcnt lgkmcnt(4)
v_mfma_f32_16x16x32_bf16 v[208:211], v[8:11], v[80:83], v[208:211]
v_mfma_f32_16x16x32_bf16 v[216:219], v[8:11], v[84:87], v[216:219]
v_mfma_f32_16x16x32_bf16 v[224:227], v[8:11], v[128:131], v[224:227]
v_mfma_f32_16x16x32_bf16 v[232:235], v[8:11], v[132:135], v[232:235]
v_mfma_f32_16x16x32_bf16 v[240:243], v[8:11], v[176:179], v[240:243]
v_mfma_f32_16x16x32_bf16 v[248:251], v[8:11], v[180:183], v[248:251]
ds_read_b64_tr_b16 v[8:9], v2 offset:20480
ds_read_b64_tr_b16 v[10:11], v2 offset:22528
s_waitcnt lgkmcnt(4)
v_mfma_f32_16x16x32_bf16 v[212:215], v[12:15], v[80:83], v[212:215]
v_mfma_f32_16x16x32_bf16 v[220:223], v[12:15], v[84:87], v[220:223]
v_mfma_f32_16x16x32_bf16 v[228:231], v[12:15], v[128:131], v[228:231]
v_mfma_f32_16x16x32_bf16 v[236:239], v[12:15], v[132:135], v[236:239]
v_mfma_f32_16x16x32_bf16 v[244:247], v[12:15], v[176:179], v[244:247]
v_mfma_f32_16x16x32_bf16 v[252:255], v[12:15], v[180:183], v[252:255]
ds_read_b64_tr_b16 v[12:13], v1 offset:0
ds_read_b64_tr_b16 v[14:15], v1 offset:2048
s_add_u32 s68, s78, 8192
buffer_store_dwordx4 v[52:55], v0, s[48:51], s68 offen offset:3072 sc1
s_waitcnt lgkmcnt(4)
v_mfma_f32_16x16x32_bf16 v[208:211], v[4:7], v[88:91], v[208:211]
v_mfma_f32_16x16x32_bf16 v[216:219], v[4:7], v[92:95], v[216:219]
v_mfma_f32_16x16x32_bf16 v[224:227], v[4:7], v[136:139], v[224:227]
v_mfma_f32_16x16x32_bf16 v[232:235], v[4:7], v[140:143], v[232:235]
v_mfma_f32_16x16x32_bf16 v[240:243], v[4:7], v[184:187], v[240:243]
v_mfma_f32_16x16x32_bf16 v[248:251], v[4:7], v[188:191], v[248:251]
ds_read_b64_tr_b16 v[4:5], v2 offset:0
ds_read_b64_tr_b16 v[6:7], v2 offset:2048
s_add_u32 s68, s78, 16384
buffer_store_dwordx4 v[56:59], v0, s[48:51], s68 offen offset:2048 sc1
s_barrier
s_waitcnt lgkmcnt(4)
v_mfma_f32_16x16x32_bf16 v[212:215], v[8:11], v[88:91], v[212:215]
v_mfma_f32_16x16x32_bf16 v[220:223], v[8:11], v[92:95], v[220:223]
v_mfma_f32_16x16x32_bf16 v[228:231], v[8:11], v[136:139], v[228:231]
v_mfma_f32_16x16x32_bf16 v[236:239], v[8:11], v[140:143], v[236:239]
v_mfma_f32_16x16x32_bf16 v[244:247], v[8:11], v[184:187], v[244:247]
v_mfma_f32_16x16x32_bf16 v[252:255], v[8:11], v[188:191], v[252:255]
ds_read_b64_tr_b16 v[8:9], v1 offset:4096
ds_read_b64_tr_b16 v[10:11], v1 offset:6144
ds_read_b128 v[16:19], v0 offset:6144
ds_read_b128 v[20:23], v0 offset:7168
ds_read_b128 v[24:27], v0 offset:8192
ds_read_b128 v[28:31], v0 offset:9216
ds_read_b128 v[32:35], v0 offset:10240
ds_read_b128 v[36:39], v0 offset:11264
s_waitcnt lgkmcnt(10)
v_mfma_f32_16x16x32_bf16 v[208:211], v[12:15], v[96:99], v[208:211]
v_mfma_f32_16x16x32_bf16 v[216:219], v[12:15], v[100:103], v[216:219]
v_mfma_f32_16x16x32_bf16 v[224:227], v[12:15], v[144:147], v[224:227]
v_mfma_f32_16x16x32_bf16 v[232:235], v[12:15], v[148:151], v[232:235]
v_mfma_f32_16x16x32_bf16 v[240:243], v[12:15], v[192:195], v[240:243]
v_mfma_f32_16x16x32_bf16 v[248:251], v[12:15], v[196:199], v[248:251]
ds_read_b64_tr_b16 v[12:13], v2 offset:4096
ds_read_b64_tr_b16 v[14:15], v2 offset:6144
s_waitcnt lgkmcnt(10)
v_mfma_f32_16x16x32_bf16 v[212:215], v[4:7], v[96:99], v[212:215]
v_mfma_f32_16x16x32_bf16 v[220:223], v[4:7], v[100:103], v[220:223]
v_mfma_f32_16x16x32_bf16 v[228:231], v[4:7], v[144:147], v[228:231]
v_mfma_f32_16x16x32_bf16 v[236:239], v[4:7], v[148:151], v[236:239]
v_mfma_f32_16x16x32_bf16 v[244:247], v[4:7], v[192:195], v[244:247]
v_mfma_f32_16x16x32_bf16 v[252:255], v[4:7], v[196:199], v[252:255]
ds_read_b64_tr_b16 v[4:5], v1 offset:24576
ds_read_b64_tr_b16 v[6:7], v1 offset:26624
s_add_u32 s68, s78, 16384
buffer_store_dwordx4 v[60:63], v0, s[48:51], s68 offen offset:3072 sc1
s_waitcnt lgkmcnt(10)
v_mfma_f32_16x16x32_bf16 v[208:211], v[8:11], v[104:107], v[208:211]
v_mfma_f32_16x16x32_bf16 v[216:219], v[8:11], v[108:111], v[216:219]
v_mfma_f32_16x16x32_bf16 v[224:227], v[8:11], v[152:155], v[224:227]
v_mfma_f32_16x16x32_bf16 v[232:235], v[8:11], v[156:159], v[232:235]
v_mfma_f32_16x16x32_bf16 v[240:243], v[8:11], v[200:203], v[240:243]
v_mfma_f32_16x16x32_bf16 v[248:251], v[8:11], v[204:207], v[248:251]
ds_read_b64_tr_b16 v[8:9], v2 offset:24576
ds_read_b64_tr_b16 v[10:11], v2 offset:26624
s_waitcnt lgkmcnt(4)
v_mfma_f32_16x16x32_bf16 v[212:215], v[12:15], v[104:107], v[212:215]
v_mfma_f32_16x16x32_bf16 v[220:223], v[12:15], v[108:111], v[220:223]
v_mfma_f32_16x16x32_bf16 v[228:231], v[12:15], v[152:155], v[228:231]
v_mfma_f32_16x16x32_bf16 v[236:239], v[12:15], v[156:159], v[236:239]
v_mfma_f32_16x16x32_bf16 v[244:247], v[12:15], v[200:203], v[244:247]
v_mfma_f32_16x16x32_bf16 v[252:255], v[12:15], v[204:207], v[252:255]
ds_read_b64_tr_b16 v[12:13], v1 offset:28672
ds_read_b64_tr_b16 v[14:15], v1 offset:30720
v_cvt_pk_bf16_f32 v40, v208, v209
v_cvt_pk_bf16_f32 v41, v210, v211
v_cvt_pk_bf16_f32 v42, v212, v213
v_cvt_pk_bf16_f32 v43, v214, v215
v_cvt_pk_bf16_f32 v44, v216, v217
v_cvt_pk_bf16_f32 v45, v218, v219
v_cvt_pk_bf16_f32 v46, v220, v221
v_cvt_pk_bf16_f32 v47, v222, v223
v_cvt_pk_bf16_f32 v48, v224, v225
v_cvt_pk_bf16_f32 v49, v226, v227
v_cvt_pk_bf16_f32 v50, v228, v229
v_cvt_pk_bf16_f32 v51, v230, v231
v_cvt_pk_bf16_f32 v52, v232, v233
v_cvt_pk_bf16_f32 v53, v234, v235
v_cvt_pk_bf16_f32 v54, v236, v237
v_cvt_pk_bf16_f32 v55, v238, v239
v_cvt_pk_bf16_f32 v56, v240, v241
v_cvt_pk_bf16_f32 v57, v242, v243
v_cvt_pk_bf16_f32 v58, v244, v245
v_cvt_pk_bf16_f32 v59, v246, v247
v_cvt_pk_bf16_f32 v60, v248, v249
v_cvt_pk_bf16_f32 v61, v250, v251
v_cvt_pk_bf16_f32 v62, v252, v253
v_cvt_pk_bf16_f32 v63, v254, v255
s_add_u32 s68, s78, 4096
buffer_store_dwordx4 v[40:43], v0, s[48:51], s68 offen offset:2048 sc1
s_barrier
v_lshlrev_b32 v208, 16, v16
v_and_b32 v209, 0xffff0000, v16
v_lshlrev_b32 v210, 16, v17
v_and_b32 v211, 0xffff0000, v17
v_lshlrev_b32 v212, 16, v18
v_and_b32 v213, 0xffff0000, v18
v_lshlrev_b32 v214, 16, v19
v_and_b32 v215, 0xffff0000, v19
v_lshlrev_b32 v216, 16, v20
v_and_b32 v217, 0xffff0000, v20
v_lshlrev_b32 v218, 16, v21
v_and_b32 v219, 0xffff0000, v21
v_lshlrev_b32 v220, 16, v22
v_and_b32 v221, 0xffff0000, v22
v_lshlrev_b32 v222, 16, v23
v_and_b32 v223, 0xffff0000, v23
v_lshlrev_b32 v224, 16, v24
v_and_b32 v225, 0xffff0000, v24
v_lshlrev_b32 v226, 16, v25
v_and_b32 v227, 0xffff0000, v25
v_lshlrev_b32 v228, 16, v26
v_and_b32 v229, 0xffff0000, v26
v_lshlrev_b32 v230, 16, v27
v_and_b32 v231, 0xffff0000, v27
v_lshlrev_b32 v232, 16, v28
v_and_b32 v233, 0xffff0000, v28
v_lshlrev_b32 v234, 16, v29
v_and_b32 v235, 0xffff0000, v29
v_lshlrev_b32 v236, 16, v30
v_and_b32 v237, 0xffff0000, v30
v_lshlrev_b32 v238, 16, v31
v_and_b32 v239, 0xffff0000, v31
v_lshlrev_b32 v240, 16, v32
v_and_b32 v241, 0xffff0000, v32
v_lshlrev_b32 v242, 16, v33
v_and_b32 v243, 0xffff0000, v33
v_lshlrev_b32 v244, 16, v34
v_and_b32 v245, 0xffff0000, v34
v_lshlrev_b32 v246, 16, v35
v_and_b32 v247, 0xffff0000, v35
v_lshlrev_b32 v248, 16, v36
v_and_b32 v249, 0xffff0000, v36
v_lshlrev_b32 v250, 16, v37
v_and_b32 v251, 0xffff0000, v37
v_lshlrev_b32 v252, 16, v38
v_and_b32 v253, 0xffff0000, v38
v_lshlrev_b32 v254, 16, v39
v_and_b32 v255, 0xffff0000, v39
s_waitcnt lgkmcnt(4)
v_mfma_f32_16x16x32_bf16 v[208:211], v[4:7], v[64:67], v[208:211]
v_mfma_f32_16x16x32_bf16 v[216:219], v[4:7], v[68:71], v[216:219]
v_mfma_f32_16x16x32_bf16 v[224:227], v[4:7], v[112:115], v[224:227]
v_mfma_f32_16x16x32_bf16 v[232:235], v[4:7], v[116:119], v[232:235]
v_mfma_f32_16x16x32_bf16 v[240:243], v[4:7], v[160:163], v[240:243]
v_mfma_f32_16x16x32_bf16 v[248:251], v[4:7], v[164:167], v[248:251]
ds_read_b64_tr_b16 v[4:5], v2 offset:28672
ds_read_b64_tr_b16 v[6:7], v2 offset:30720
s_waitcnt lgkmcnt(4)
v_mfma_f32_16x16x32_bf16 v[212:215], v[8:11], v[64:67], v[212:215]
v_mfma_f32_16x16x32_bf16 v[220:223], v[8:11], v[68:71], v[220:223]
v_mfma_f32_16x16x32_bf16 v[228:231], v[8:11], v[112:115], v[228:231]
v_mfma_f32_16x16x32_bf16 v[236:239], v[8:11], v[116:119], v[236:239]
v_mfma_f32_16x16x32_bf16 v[244:247], v[8:11], v[160:163], v[244:247]
v_mfma_f32_16x16x32_bf16 v[252:255], v[8:11], v[164:167], v[252:255]
ds_read_b64_tr_b16 v[8:9], v1 offset:32768
ds_read_b64_tr_b16 v[10:11], v1 offset:34816
s_add_u32 s68, s78, 4096
buffer_store_dwordx4 v[44:47], v0, s[48:51], s68 offen offset:3072 sc1
s_waitcnt lgkmcnt(4)
v_mfma_f32_16x16x32_bf16 v[208:211], v[12:15], v[72:75], v[208:211]
v_mfma_f32_16x16x32_bf16 v[216:219], v[12:15], v[76:79], v[216:219]
v_mfma_f32_16x16x32_bf16 v[224:227], v[12:15], v[120:123], v[224:227]
v_mfma_f32_16x16x32_bf16 v[232:235], v[12:15], v[124:127], v[232:235]
v_mfma_f32_16x16x32_bf16 v[240:243], v[12:15], v[168:171], v[240:243]
v_mfma_f32_16x16x32_bf16 v[248:251], v[12:15], v[172:175], v[248:251]
ds_read_b64_tr_b16 v[12:13], v2 offset:32768
ds_read_b64_tr_b16 v[14:15], v2 offset:34816
s_add_u32 s68, s78, 12288
buffer_store_dwordx4 v[48:51], v0, s[48:51], s68 offen offset:2048 sc1
s_barrier
s_waitcnt lgkmcnt(4)
v_mfma_f32_16x16x32_bf16 v[212:215], v[4:7], v[72:75], v[212:215]
v_mfma_f32_16x16x32_bf16 v[220:223], v[4:7], v[76:79], v[220:223]
v_mfma_f32_16x16x32_bf16 v[228:231], v[4:7], v[120:123], v[228:231]
v_mfma_f32_16x16x32_bf16 v[236:239], v[4:7], v[124:127], v[236:239]
v_mfma_f32_16x16x32_bf16 v[244:247], v[4:7], v[168:171], v[244:247]
v_mfma_f32_16x16x32_bf16 v[252:255], v[4:7], v[172:175], v[252:255]
ds_read_b64_tr_b16 v[4:5], v1 offset:36864
ds_read_b64_tr_b16 v[6:7], v1 offset:38912
s_waitcnt lgkmcnt(4)
v_mfma_f32_16x16x32_bf16 v[208:211], v[8:11], v[80:83], v[208:211]
v_mfma_f32_16x16x32_bf16 v[216:219], v[8:11], v[84:87], v[216:219]
v_mfma_f32_16x16x32_bf16 v[224:227], v[8:11], v[128:131], v[224:227]
v_mfma_f32_16x16x32_bf16 v[232:235], v[8:11], v[132:135], v[232:235]
v_mfma_f32_16x16x32_bf16 v[240:243], v[8:11], v[176:179], v[240:243]
v_mfma_f32_16x16x32_bf16 v[248:251], v[8:11], v[180:183], v[248:251]
ds_read_b64_tr_b16 v[8:9], v2 offset:36864
ds_read_b64_tr_b16 v[10:11], v2 offset:38912
s_waitcnt lgkmcnt(4)
v_mfma_f32_16x16x32_bf16 v[212:215], v[12:15], v[80:83], v[212:215]
v_mfma_f32_16x16x32_bf16 v[220:223], v[12:15], v[84:87], v[220:223]
v_mfma_f32_16x16x32_bf16 v[228:231], v[12:15], v[128:131], v[228:231]
v_mfma_f32_16x16x32_bf16 v[236:239], v[12:15], v[132:135], v[236:239]
v_mfma_f32_16x16x32_bf16 v[244:247], v[12:15], v[176:179], v[244:247]
v_mfma_f32_16x16x32_bf16 v[252:255], v[12:15], v[180:183], v[252:255]
ds_read_b64_tr_b16 v[12:13], v1 offset:40960
ds_read_b64_tr_b16 v[14:15], v1 offset:43008
s_waitcnt lgkmcnt(4)
v_mfma_f32_16x16x32_bf16 v[208:211], v[4:7], v[88:91], v[208:211]
v_mfma_f32_16x16x32_bf16 v[216:219], v[4:7], v[92:95], v[216:219]
v_mfma_f32_16x16x32_bf16 v[224:227], v[4:7], v[136:139], v[224:227]
v_mfma_f32_16x16x32_bf16 v[232:235], v[4:7], v[140:143], v[232:235]
v_mfma_f32_16x16x32_bf16 v[240:243], v[4:7], v[184:187], v[240:243]
v_mfma_f32_16x16x32_bf16 v[248:251], v[4:7], v[188:191], v[248:251]
ds_read_b64_tr_b16 v[4:5], v2 offset:40960
ds_read_b64_tr_b16 v[6:7], v2 offset:43008
s_add_u32 s68, s78, 12288
buffer_store_dwordx4 v[52:55], v0, s[48:51], s68 offen offset:3072 sc1
s_waitcnt lgkmcnt(4)
v_mfma_f32_16x16x32_bf16 v[212:215], v[8:11], v[88:91], v[212:215]
v_mfma_f32_16x16x32_bf16 v[220:223], v[8:11], v[92:95], v[220:223]
v_mfma_f32_16x16x32_bf16 v[228:231], v[8:11], v[136:139], v[228:231]
v_mfma_f32_16x16x32_bf16 v[236:239], v[8:11], v[140:143], v[236:239]
v_mfma_f32_16x16x32_bf16 v[244:247], v[8:11], v[184:187], v[244:247]
v_mfma_f32_16x16x32_bf16 v[252:255], v[8:11], v[188:191], v[252:255]
ds_read_b64_tr_b16 v[8:9], v1 offset:45056
ds_read_b64_tr_b16 v[10:11], v1 offset:47104
ds_read_b128 v[16:19], v0 offset:18432
ds_read_b128 v[20:23], v0 offset:19456
ds_read_b128 v[24:27], v0 offset:20480
ds_read_b128 v[28:31], v0 offset:21504
ds_read_b128 v[32:35], v0 offset:22528
ds_read_b128 v[36:39], v0 offset:23552
s_add_u32 s68, s78, 20480
buffer_store_dwordx4 v[56:59], v0, s[48:51], s68 offen offset:2048 sc1
s_waitcnt lgkmcnt(10)
v_mfma_f32_16x16x32_bf16 v[208:211], v[12:15], v[96:99], v[208:211]
v_mfma_f32_16x16x32_bf16 v[216:219], v[12:15], v[100:103], v[216:219]
v_mfma_f32_16x16x32_bf16 v[224:227], v[12:15], v[144:147], v[224:227]
v_mfma_f32_16x16x32_bf16 v[232:235], v[12:15], v[148:151], v[232:235]
v_mfma_f32_16x16x32_bf16 v[240:243], v[12:15], v[192:195], v[240:243]
v_mfma_f32_16x16x32_bf16 v[248:251], v[12:15], v[196:199], v[248:251]
ds_read_b64_tr_b16 v[12:13], v2 offset:45056
ds_read_b64_tr_b16 v[14:15], v2 offset:47104
s_add_u32 s68, s78, 20480
buffer_store_dwordx4 v[60:63], v0, s[48:51], s68 offen offset:3072 sc1
s_waitcnt lgkmcnt(2)
s_barrier
v_mfma_f32_16x16x32_bf16 v[212:215], v[4:7], v[96:99], v[212:215]
v_mfma_f32_16x16x32_bf16 v[220:223], v[4:7], v[100:103], v[220:223]
v_mfma_f32_16x16x32_bf16 v[228:231], v[4:7], v[144:147], v[228:231]
v_mfma_f32_16x16x32_bf16 v[236:239], v[4:7], v[148:151], v[236:239]
v_mfma_f32_16x16x32_bf16 v[244:247], v[4:7], v[192:195], v[244:247]
v_mfma_f32_16x16x32_bf16 v[252:255], v[4:7], v[196:199], v[252:255]
ds_read_b64_tr_b16 v[4:5], v1 offset:8192
ds_read_b64_tr_b16 v[6:7], v1 offset:10240
v_mfma_f32_16x16x32_bf16 v[208:211], v[8:11], v[104:107], v[208:211]
v_mfma_f32_16x16x32_bf16 v[216:219], v[8:11], v[108:111], v[216:219]
v_mfma_f32_16x16x32_bf16 v[224:227], v[8:11], v[152:155], v[224:227]
v_mfma_f32_16x16x32_bf16 v[232:235], v[8:11], v[156:159], v[232:235]
v_mfma_f32_16x16x32_bf16 v[240:243], v[8:11], v[200:203], v[240:243]
v_mfma_f32_16x16x32_bf16 v[248:251], v[8:11], v[204:207], v[248:251]
ds_read_b64_tr_b16 v[8:9], v2 offset:8192
ds_read_b64_tr_b16 v[10:11], v2 offset:10240
s_waitcnt lgkmcnt(4)
v_mfma_f32_16x16x32_bf16 v[212:215], v[12:15], v[104:107], v[212:215]
v_mfma_f32_16x16x32_bf16 v[220:223], v[12:15], v[108:111], v[220:223]
v_mfma_f32_16x16x32_bf16 v[228:231], v[12:15], v[152:155], v[228:231]
v_mfma_f32_16x16x32_bf16 v[236:239], v[12:15], v[156:159], v[236:239]
v_mfma_f32_16x16x32_bf16 v[244:247], v[12:15], v[200:203], v[244:247]
v_mfma_f32_16x16x32_bf16 v[252:255], v[12:15], v[204:207], v[252:255]
ds_read_b64_tr_b16 v[12:13], v1 offset:12288
ds_read_b64_tr_b16 v[14:15], v1 offset:14336
v_cvt_pk_bf16_f32 v40, v208, v209
v_cvt_pk_bf16_f32 v41, v210, v211
v_cvt_pk_bf16_f32 v42, v212, v213
v_cvt_pk_bf16_f32 v43, v214, v215
v_cvt_pk_bf16_f32 v44, v216, v217
v_cvt_pk_bf16_f32 v45, v218, v219
v_cvt_pk_bf16_f32 v46, v220, v221
v_cvt_pk_bf16_f32 v47, v222, v223
v_cvt_pk_bf16_f32 v48, v224, v225
v_cvt_pk_bf16_f32 v49, v226, v227
v_cvt_pk_bf16_f32 v50, v228, v229
v_cvt_pk_bf16_f32 v51, v230, v231
v_cvt_pk_bf16_f32 v52, v232, v233
v_cvt_pk_bf16_f32 v53, v234, v235
v_cvt_pk_bf16_f32 v54, v236, v237
v_cvt_pk_bf16_f32 v55, v238, v239
v_cvt_pk_bf16_f32 v56, v240, v241
v_cvt_pk_bf16_f32 v57, v242, v243
v_cvt_pk_bf16_f32 v58, v244, v245
v_cvt_pk_bf16_f32 v59, v246, v247
v_cvt_pk_bf16_f32 v60, v248, v249
v_cvt_pk_bf16_f32 v61, v250, v251
v_cvt_pk_bf16_f32 v62, v252, v253
v_cvt_pk_bf16_f32 v63, v254, v255
s_add_u32 s68, s78, 24576
buffer_store_dwordx4 v[40:43], v0, s[48:51], s68 offen offset:2048 sc1
v_lshlrev_b32 v208, 16, v16
v_and_b32 v209, 0xffff0000, v16
v_lshlrev_b32 v210, 16, v17
v_and_b32 v211, 0xffff0000, v17
v_lshlrev_b32 v212, 16, v18
v_and_b32 v213, 0xffff0000, v18
v_lshlrev_b32 v214, 16, v19
v_and_b32 v215, 0xffff0000, v19
v_lshlrev_b32 v216, 16, v20
v_and_b32 v217, 0xffff0000, v20
v_lshlrev_b32 v218, 16, v21
v_and_b32 v219, 0xffff0000, v21
v_lshlrev_b32 v220, 16, v22
v_and_b32 v221, 0xffff0000, v22
v_lshlrev_b32 v222, 16, v23
v_and_b32 v223, 0xffff0000, v23
v_lshlrev_b32 v224, 16, v24
v_and_b32 v225, 0xffff0000, v24
v_lshlrev_b32 v226, 16, v25
v_and_b32 v227, 0xffff0000, v25
v_lshlrev_b32 v228, 16, v26
v_and_b32 v229, 0xffff0000, v26
v_lshlrev_b32 v230, 16, v27
v_and_b32 v231, 0xffff0000, v27
v_lshlrev_b32 v232, 16, v28
v_and_b32 v233, 0xffff0000, v28
v_lshlrev_b32 v234, 16, v29
v_and_b32 v235, 0xffff0000, v29
v_lshlrev_b32 v236, 16, v30
v_and_b32 v237, 0xffff0000, v30
v_lshlrev_b32 v238, 16, v31
v_and_b32 v239, 0xffff0000, v31
v_lshlrev_b32 v240, 16, v32
v_and_b32 v241, 0xffff0000, v32
v_lshlrev_b32 v242, 16, v33
v_and_b32 v243, 0xffff0000, v33
v_lshlrev_b32 v244, 16, v34
v_and_b32 v245, 0xffff0000, v34
v_lshlrev_b32 v246, 16, v35
v_and_b32 v247, 0xffff0000, v35
v_lshlrev_b32 v248, 16, v36
v_and_b32 v249, 0xffff0000, v36
v_lshlrev_b32 v250, 16, v37
v_and_b32 v251, 0xffff0000, v37
v_lshlrev_b32 v252, 16, v38
v_and_b32 v253, 0xffff0000, v38
v_lshlrev_b32 v254, 16, v39
v_and_b32 v255, 0xffff0000, v39
s_waitcnt lgkmcnt(4)
v_mfma_f32_16x16x32_bf16 v[208:211], v[4:7], v[64:67], v[208:211]
v_mfma_f32_16x16x32_bf16 v[216:219], v[4:7], v[68:71], v[216:219]
v_mfma_f32_16x16x32_bf16 v[224:227], v[4:7], v[112:115], v[224:227]
v_mfma_f32_16x16x32_bf16 v[232:235], v[4:7], v[116:119], v[232:235]
v_mfma_f32_16x16x32_bf16 v[240:243], v[4:7], v[160:163], v[240:243]
v_mfma_f32_16x16x32_bf16 v[248:251], v[4:7], v[164:167], v[248:251]
ds_read_b64_tr_b16 v[4:5], v2 offset:12288
ds_read_b64_tr_b16 v[6:7], v2 offset:14336
s_add_u32 s68, s78, 24576
buffer_store_dwordx4 v[44:47], v0, s[48:51], s68 offen offset:3072 sc1
s_barrier
s_waitcnt lgkmcnt(4)
v_mfma_f32_16x16x32_bf16 v[212:215], v[8:11], v[64:67], v[212:215]
v_mfma_f32_16x16x32_bf16 v[220:223], v[8:11], v[68:71], v[220:223]
v_mfma_f32_16x16x32_bf16 v[228:231], v[8:11], v[112:115], v[228:231]
v_mfma_f32_16x16x32_bf16 v[236:239], v[8:11], v[116:119], v[236:239]
v_mfma_f32_16x16x32_bf16 v[244:247], v[8:11], v[160:163], v[244:247]
v_mfma_f32_16x16x32_bf16 v[252:255], v[8:11], v[164:167], v[252:255]
ds_read_b64_tr_b16 v[8:9], v1 offset:16384
ds_read_b64_tr_b16 v[10:11], v1 offset:18432
s_waitcnt lgkmcnt(4)
v_mfma_f32_16x16x32_bf16 v[208:211], v[12:15], v[72:75], v[208:211]
v_mfma_f32_16x16x32_bf16 v[216:219], v[12:15], v[76:79], v[216:219]
v_mfma_f32_16x16x32_bf16 v[224:227], v[12:15], v[120:123], v[224:227]
v_mfma_f32_16x16x32_bf16 v[232:235], v[12:15], v[124:127], v[232:235]
v_mfma_f32_16x16x32_bf16 v[240:243], v[12:15], v[168:171], v[240:243]
v_mfma_f32_16x16x32_bf16 v[248:251], v[12:15], v[172:175], v[248:251]
ds_read_b64_tr_b16 v[12:13], v2 offset:16384
ds_read_b64_tr_b16 v[14:15], v2 offset:18432
s_waitcnt lgkmcnt(4)
v_mfma_f32_16x16x32_bf16 v[212:215], v[4:7], v[72:75], v[212:215]
v_mfma_f32_16x16x32_bf16 v[220:223], v[4:7], v[76:79], v[220:223]
v_mfma_f32_16x16x32_bf16 v[228:231], v[4:7], v[120:123], v[228:231]
v_mfma_f32_16x16x32_bf16 v[236:239], v[4:7], v[124:127], v[236:239]
v_mfma_f32_16x16x32_bf16 v[244:247], v[4:7], v[168:171], v[244:247]
v_mfma_f32_16x16x32_bf16 v[252:255], v[4:7], v[172:175], v[252:255]
ds_read_b64_tr_b16 v[4:5], v1 offset:20480
ds_read_b64_tr_b16 v[6:7], v1 offset:22528
s_add_u32 s68, s78, 32768
buffer_store_dwordx4 v[48:51], v0, s[48:51], s68 offen offset:2048 sc1
s_waitcnt lgkmcnt(4)
v_mfma_f32_16x16x32_bf16 v[208:211], v[8:11], v[80:83], v[208:211]
v_mfma_f32_16x16x32_bf16 v[216:219], v[8:11], v[84:87], v[216:219]
v_mfma_f32_16x16x32_bf16 v[224:227], v[8:11], v[128:131], v[224:227]
v_mfma_f32_16x16x32_bf16 v[232:235], v[8:11], v[132:135], v[232:235]
v_mfma_f32_16x16x32_bf16 v[240:243], v[8:11], v[176:179], v[240:243]
v_mfma_f32_16x16x32_bf16 v[248:251], v[8:11], v[180:183], v[248:251]
ds_read_b64_tr_b16 v[8:9], v2 offset:20480
ds_read_b64_tr_b16 v[10:11], v2 offset:22528
s_add_u32 s68, s78, 32768
buffer_store_dwordx4 v[52:55], v0, s[48:51], s68 offen offset:3072 sc1
s_waitcnt vmcnt(4)
s_barrier
s_waitcnt lgkmcnt(4)
v_mfma_f32_16x16x32_bf16 v[212:215], v[12:15], v[80:83], v[212:215]
v_mfma_f32_16x16x32_bf16 v[220:223], v[12:15], v[84:87], v[220:223]
v_mfma_f32_16x16x32_bf16 v[228:231], v[12:15], v[128:131], v[228:231]
v_mfma_f32_16x16x32_bf16 v[236:239], v[12:15], v[132:135], v[236:239]
v_mfma_f32_16x16x32_bf16 v[244:247], v[12:15], v[176:179], v[244:247]
v_mfma_f32_16x16x32_bf16 v[252:255], v[12:15], v[180:183], v[252:255]
ds_read_b64_tr_b16 v[12:13], v1 offset:0
ds_read_b64_tr_b16 v[14:15], v1 offset:2048
s_waitcnt lgkmcnt(4)
v_mfma_f32_16x16x32_bf16 v[208:211], v[4:7], v[88:91], v[208:211]
v_mfma_f32_16x16x32_bf16 v[216:219], v[4:7], v[92:95], v[216:219]
v_mfma_f32_16x16x32_bf16 v[224:227], v[4:7], v[136:139], v[224:227]
v_mfma_f32_16x16x32_bf16 v[232:235], v[4:7], v[140:143], v[232:235]
v_mfma_f32_16x16x32_bf16 v[240:243], v[4:7], v[184:187], v[240:243]
v_mfma_f32_16x16x32_bf16 v[248:251], v[4:7], v[188:191], v[248:251]
ds_read_b64_tr_b16 v[4:5], v2 offset:0
ds_read_b64_tr_b16 v[6:7], v2 offset:2048
s_waitcnt lgkmcnt(4)
v_mfma_f32_16x16x32_bf16 v[212:215], v[8:11], v[88:91], v[212:215]
v_mfma_f32_16x16x32_bf16 v[220:223], v[8:11], v[92:95], v[220:223]
v_mfma_f32_16x16x32_bf16 v[228:231], v[8:11], v[136:139], v[228:231]
v_mfma_f32_16x16x32_bf16 v[236:239], v[8:11], v[140:143], v[236:239]
v_mfma_f32_16x16x32_bf16 v[244:247], v[8:11], v[184:187], v[244:247]
v_mfma_f32_16x16x32_bf16 v[252:255], v[8:11], v[188:191], v[252:255]
ds_read_b64_tr_b16 v[8:9], v1 offset:4096
ds_read_b64_tr_b16 v[10:11], v1 offset:6144
ds_read_b128 v[16:19], v0 offset:6144
ds_read_b128 v[20:23], v0 offset:7168
ds_read_b128 v[24:27], v0 offset:8192
ds_read_b128 v[28:31], v0 offset:9216
ds_read_b128 v[32:35], v0 offset:10240
ds_read_b128 v[36:39], v0 offset:11264
s_waitcnt lgkmcnt(10)
v_mfma_f32_16x16x32_bf16 v[208:211], v[12:15], v[96:99], v[208:211]
v_mfma_f32_16x16x32_bf16 v[216:219], v[12:15], v[100:103], v[216:219]
v_mfma_f32_16x16x32_bf16 v[224:227], v[12:15], v[144:147], v[224:227]
v_mfma_f32_16x16x32_bf16 v[232:235], v[12:15], v[148:151], v[232:235]
v_mfma_f32_16x16x32_bf16 v[240:243], v[12:15], v[192:195], v[240:243]
v_mfma_f32_16x16x32_bf16 v[248:251], v[12:15], v[196:199], v[248:251]
ds_read_b64_tr_b16 v[12:13], v2 offset:4096
ds_read_b64_tr_b16 v[14:15], v2 offset:6144
s_add_u32 s68, s78, 40960
buffer_store_dwordx4 v[56:59], v0, s[48:51], s68 offen offset:2048 sc1
s_waitcnt lgkmcnt(10)
v_mfma_f32_16x16x32_bf16 v[212:215], v[4:7], v[96:99], v[212:215]
v_mfma_f32_16x16x32_bf16 v[220:223], v[4:7], v[100:103], v[220:223]
v_mfma_f32_16x16x32_bf16 v[228:231], v[4:7], v[144:147], v[228:231]
v_mfma_f32_16x16x32_bf16 v[236:239], v[4:7], v[148:151], v[236:239]
v_mfma_f32_16x16x32_bf16 v[244:247], v[4:7], v[192:195], v[244:247]
v_mfma_f32_16x16x32_bf16 v[252:255], v[4:7], v[196:199], v[252:255]
ds_read_b64_tr_b16 v[4:5], v1 offset:24576
ds_read_b64_tr_b16 v[6:7], v1 offset:26624
s_add_u32 s68, s78, 40960
buffer_store_dwordx4 v[60:63], v0, s[48:51], s68 offen offset:3072 sc1
s_waitcnt lgkmcnt(10)
v_mfma_f32_16x16x32_bf16 v[208:211], v[8:11], v[104:107], v[208:211]
v_mfma_f32_16x16x32_bf16 v[216:219], v[8:11], v[108:111], v[216:219]
v_mfma_f32_16x16x32_bf16 v[224:227], v[8:11], v[152:155], v[224:227]
v_mfma_f32_16x16x32_bf16 v[232:235], v[8:11], v[156:159], v[232:235]
v_mfma_f32_16x16x32_bf16 v[240:243], v[8:11], v[200:203], v[240:243]
v_mfma_f32_16x16x32_bf16 v[248:251], v[8:11], v[204:207], v[248:251]
ds_read_b64_tr_b16 v[8:9], v2 offset:24576
ds_read_b64_tr_b16 v[10:11], v2 offset:26624
s_waitcnt lgkmcnt(6)
s_barrier
s_waitcnt lgkmcnt(4)
v_mfma_f32_16x16x32_bf16 v[212:215], v[12:15], v[104:107], v[212:215]
v_mfma_f32_16x16x32_bf16 v[220:223], v[12:15], v[108:111], v[220:223]
v_mfma_f32_16x16x32_bf16 v[228:231], v[12:15], v[152:155], v[228:231]
v_mfma_f32_16x16x32_bf16 v[236:239], v[12:15], v[156:159], v[236:239]
v_mfma_f32_16x16x32_bf16 v[244:247], v[12:15], v[200:203], v[244:247]
v_mfma_f32_16x16x32_bf16 v[252:255], v[12:15], v[204:207], v[252:255]
ds_read_b64_tr_b16 v[12:13], v1 offset:28672
ds_read_b64_tr_b16 v[14:15], v1 offset:30720
v_cvt_pk_bf16_f32 v40, v208, v209
v_cvt_pk_bf16_f32 v41, v210, v211
v_cvt_pk_bf16_f32 v42, v212, v213
v_cvt_pk_bf16_f32 v43, v214, v215
v_cvt_pk_bf16_f32 v44, v216, v217
v_cvt_pk_bf16_f32 v45, v218, v219
v_cvt_pk_bf16_f32 v46, v220, v221
v_cvt_pk_bf16_f32 v47, v222, v223
v_cvt_pk_bf16_f32 v48, v224, v225
v_cvt_pk_bf16_f32 v49, v226, v227
v_cvt_pk_bf16_f32 v50, v228, v229
v_cvt_pk_bf16_f32 v51, v230, v231
v_cvt_pk_bf16_f32 v52, v232, v233
v_cvt_pk_bf16_f32 v53, v234, v235
v_cvt_pk_bf16_f32 v54, v236, v237
v_cvt_pk_bf16_f32 v55, v238, v239
v_cvt_pk_bf16_f32 v56, v240, v241
v_cvt_pk_bf16_f32 v57, v242, v243
v_cvt_pk_bf16_f32 v58, v244, v245
v_cvt_pk_bf16_f32 v59, v246, v247
v_cvt_pk_bf16_f32 v60, v248, v249
v_cvt_pk_bf16_f32 v61, v250, v251
v_cvt_pk_bf16_f32 v62, v252, v253
v_cvt_pk_bf16_f32 v63, v254, v255
v_lshlrev_b32 v208, 16, v16
v_and_b32 v209, 0xffff0000, v16
v_lshlrev_b32 v210, 16, v17
v_and_b32 v211, 0xffff0000, v17
v_lshlrev_b32 v212, 16, v18
v_and_b32 v213, 0xffff0000, v18
v_lshlrev_b32 v214, 16, v19
v_and_b32 v215, 0xffff0000, v19
v_lshlrev_b32 v216, 16, v20
v_and_b32 v217, 0xffff0000, v20
v_lshlrev_b32 v218, 16, v21
v_and_b32 v219, 0xffff0000, v21
v_lshlrev_b32 v220, 16, v22
v_and_b32 v221, 0xffff0000, v22
v_lshlrev_b32 v222, 16, v23
v_and_b32 v223, 0xffff0000, v23
v_lshlrev_b32 v224, 16, v24
v_and_b32 v225, 0xffff0000, v24
v_lshlrev_b32 v226, 16, v25
v_and_b32 v227, 0xffff0000, v25
v_lshlrev_b32 v228, 16, v26
v_and_b32 v229, 0xffff0000, v26
v_lshlrev_b32 v230, 16, v27
v_and_b32 v231, 0xffff0000, v27
v_lshlrev_b32 v232, 16, v28
v_and_b32 v233, 0xffff0000, v28
v_lshlrev_b32 v234, 16, v29
v_and_b32 v235, 0xffff0000, v29
v_lshlrev_b32 v236, 16, v30
v_and_b32 v237, 0xffff0000, v30
v_lshlrev_b32 v238, 16, v31
v_and_b32 v239, 0xffff0000, v31
v_lshlrev_b32 v240, 16, v32
v_and_b32 v241, 0xffff0000, v32
v_lshlrev_b32 v242, 16, v33
v_and_b32 v243, 0xffff0000, v33
v_lshlrev_b32 v244, 16, v34
v_and_b32 v245, 0xffff0000, v34
v_lshlrev_b32 v246, 16, v35
v_and_b32 v247, 0xffff0000, v35
v_lshlrev_b32 v248, 16, v36
v_and_b32 v249, 0xffff0000, v36
v_lshlrev_b32 v250, 16, v37
v_and_b32 v251, 0xffff0000, v37
v_lshlrev_b32 v252, 16, v38
v_and_b32 v253, 0xffff0000, v38
v_lshlrev_b32 v254, 16, v39
v_and_b32 v255, 0xffff0000, v39
s_waitcnt lgkmcnt(4)
v_mfma_f32_16x16x32_bf16 v[208:211], v[4:7], v[64:67], v[208:211]
v_mfma_f32_16x16x32_bf16 v[216:219], v[4:7], v[68:71], v[216:219]
v_mfma_f32_16x16x32_bf16 v[224:227], v[4:7], v[112:115], v[224:227]
v_mfma_f32_16x16x32_bf16 v[232:235], v[4:7], v[116:119], v[232:235]
v_mfma_f32_16x16x32_bf16 v[240:243], v[4:7], v[160:163], v[240:243]
v_mfma_f32_16x16x32_bf16 v[248:251], v[4:7], v[164:167], v[248:251]
ds_read_b64_tr_b16 v[4:5], v2 offset:28672
ds_read_b64_tr_b16 v[6:7], v2 offset:30720
s_add_u32 s68, s78, 28672
buffer_store_dwordx4 v[40:43], v0, s[48:51], s68 offen offset:2048 sc1
s_waitcnt lgkmcnt(4)
v_mfma_f32_16x16x32_bf16 v[212:215], v[8:11], v[64:67], v[212:215]
v_mfma_f32_16x16x32_bf16 v[220:223], v[8:11], v[68:71], v[220:223]
v_mfma_f32_16x16x32_bf16 v[228:231], v[8:11], v[112:115], v[228:231]
v_mfma_f32_16x16x32_bf16 v[236:239], v[8:11], v[116:119], v[236:239]
v_mfma_f32_16x16x32_bf16 v[244:247], v[8:11], v[160:163], v[244:247]
v_mfma_f32_16x16x32_bf16 v[252:255], v[8:11], v[164:167], v[252:255]
ds_read_b64_tr_b16 v[8:9], v1 offset:32768
ds_read_b64_tr_b16 v[10:11], v1 offset:34816
s_add_u32 s68, s78, 28672
buffer_store_dwordx4 v[44:47], v0, s[48:51], s68 offen offset:3072 sc1
s_barrier
s_waitcnt lgkmcnt(4)
v_mfma_f32_16x16x32_bf16 v[208:211], v[12:15], v[72:75], v[208:211]
v_mfma_f32_16x16x32_bf16 v[216:219], v[12:15], v[76:79], v[216:219]
v_mfma_f32_16x16x32_bf16 v[224:227], v[12:15], v[120:123], v[224:227]
v_mfma_f32_16x16x32_bf16 v[232:235], v[12:15], v[124:127], v[232:235]
v_mfma_f32_16x16x32_bf16 v[240:243], v[12:15], v[168:171], v[240:243]
v_mfma_f32_16x16x32_bf16 v[248:251], v[12:15], v[172:175], v[248:251]
ds_read_b64_tr_b16 v[12:13], v2 offset:32768
ds_read_b64_tr_b16 v[14:15], v2 offset:34816
s_waitcnt lgkmcnt(4)
v_mfma_f32_16x16x32_bf16 v[212:215], v[4:7], v[72:75], v[212:215]
v_mfma_f32_16x16x32_bf16 v[220:223], v[4:7], v[76:79], v[220:223]
v_mfma_f32_16x16x32_bf16 v[228:231], v[4:7], v[120:123], v[228:231]
v_mfma_f32_16x16x32_bf16 v[236:239], v[4:7], v[124:127], v[236:239]
v_mfma_f32_16x16x32_bf16 v[244:247], v[4:7], v[168:171], v[244:247]
v_mfma_f32_16x16x32_bf16 v[252:255], v[4:7], v[172:175], v[252:255]
ds_read_b64_tr_b16 v[4:5], v1 offset:36864
ds_read_b64_tr_b16 v[6:7], v1 offset:38912
s_add_u32 s68, s78, 36864
buffer_store_dwordx4 v[48:51], v0, s[48:51], s68 offen offset:2048 sc1
s_waitcnt lgkmcnt(4)
v_mfma_f32_16x16x32_bf16 v[208:211], v[8:11], v[80:83], v[208:211]
v_mfma_f32_16x16x32_bf16 v[216:219], v[8:11], v[84:87], v[216:219]
v_mfma_f32_16x16x32_bf16 v[224:227], v[8:11], v[128:131], v[224:227]
v_mfma_f32_16x16x32_bf16 v[232:235], v[8:11], v[132:135], v[232:235]
v_mfma_f32_16x16x32_bf16 v[240:243], v[8:11], v[176:179], v[240:243]
v_mfma_f32_16x16x32_bf16 v[248:251], v[8:11], v[180:183], v[248:251]
ds_read_b64_tr_b16 v[8:9], v2 offset:36864
ds_read_b64_tr_b16 v[10:11], v2 offset:38912
s_waitcnt lgkmcnt(4)
v_mfma_f32_16x16x32_bf16 v[212:215], v[12:15], v[80:83], v[212:215]
v_mfma_f32_16x16x32_bf16 v[220:223], v[12:15], v[84:87], v[220:223]
v_mfma_f32_16x16x32_bf16 v[228:231], v[12:15], v[128:131], v[228:231]
v_mfma_f32_16x16x32_bf16 v[236:239], v[12:15], v[132:135], v[236:239]
v_mfma_f32_16x16x32_bf16 v[244:247], v[12:15], v[176:179], v[244:247]
v_mfma_f32_16x16x32_bf16 v[252:255], v[12:15], v[180:183], v[252:255]
ds_read_b64_tr_b16 v[12:13], v1 offset:40960
ds_read_b64_tr_b16 v[14:15], v1 offset:43008
s_add_u32 s68, s78, 36864
buffer_store_dwordx4 v[52:55], v0, s[48:51], s68 offen offset:3072 sc1
s_barrier
s_waitcnt lgkmcnt(4)
v_mfma_f32_16x16x32_bf16 v[208:211], v[4:7], v[88:91], v[208:211]
v_mfma_f32_16x16x32_bf16 v[216:219], v[4:7], v[92:95], v[216:219]
v_mfma_f32_16x16x32_bf16 v[224:227], v[4:7], v[136:139], v[224:227]
v_mfma_f32_16x16x32_bf16 v[232:235], v[4:7], v[140:143], v[232:235]
v_mfma_f32_16x16x32_bf16 v[240:243], v[4:7], v[184:187], v[240:243]
v_mfma_f32_16x16x32_bf16 v[248:251], v[4:7], v[188:191], v[248:251]
ds_read_b64_tr_b16 v[4:5], v2 offset:40960
ds_read_b64_tr_b16 v[6:7], v2 offset:43008
s_waitcnt lgkmcnt(4)
v_mfma_f32_16x16x32_bf16 v[212:215], v[8:11], v[88:91], v[212:215]
v_mfma_f32_16x16x32_bf16 v[220:223], v[8:11], v[92:95], v[220:223]
v_mfma_f32_16x16x32_bf16 v[228:231], v[8:11], v[136:139], v[228:231]
v_mfma_f32_16x16x32_bf16 v[236:239], v[8:11], v[140:143], v[236:239]
v_mfma_f32_16x16x32_bf16 v[244:247], v[8:11], v[184:187], v[244:247]
v_mfma_f32_16x16x32_bf16 v[252:255], v[8:11], v[188:191], v[252:255]
ds_read_b64_tr_b16 v[8:9], v1 offset:45056
ds_read_b64_tr_b16 v[10:11], v1 offset:47104
ds_read_b128 v[16:19], v0 offset:18432
ds_read_b128 v[20:23], v0 offset:19456
ds_read_b128 v[24:27], v0 offset:20480
ds_read_b128 v[28:31], v0 offset:21504
ds_read_b128 v[32:35], v0 offset:22528
ds_read_b128 v[36:39], v0 offset:23552
s_waitcnt lgkmcnt(10)
v_mfma_f32_16x16x32_bf16 v[208:211], v[12:15], v[96:99], v[208:211]
v_mfma_f32_16x16x32_bf16 v[216:219], v[12:15], v[100:103], v[216:219]
v_mfma_f32_16x16x32_bf16 v[224:227], v[12:15], v[144:147], v[224:227]
v_mfma_f32_16x16x32_bf16 v[232:235], v[12:15], v[148:151], v[232:235]
v_mfma_f32_16x16x32_bf16 v[240:243], v[12:15], v[192:195], v[240:243]
v_mfma_f32_16x16x32_bf16 v[248:251], v[12:15], v[196:199], v[248:251]
ds_read_b64_tr_b16 v[12:13], v2 offset:45056
ds_read_b64_tr_b16 v[14:15], v2 offset:47104
s_add_u32 s68, s78, 45056
buffer_store_dwordx4 v[56:59], v0, s[48:51], s68 offen offset:2048 sc1
s_waitcnt lgkmcnt(10)
v_mfma_f32_16x16x32_bf16 v[212:215], v[4:7], v[96:99], v[212:215]
v_mfma_f32_16x16x32_bf16 v[220:223], v[4:7], v[100:103], v[220:223]
v_mfma_f32_16x16x32_bf16 v[228:231], v[4:7], v[144:147], v[228:231]
v_mfma_f32_16x16x32_bf16 v[236:239], v[4:7], v[148:151], v[236:239]
v_mfma_f32_16x16x32_bf16 v[244:247], v[4:7], v[192:195], v[244:247]
v_mfma_f32_16x16x32_bf16 v[252:255], v[4:7], v[196:199], v[252:255]
ds_read_b64_tr_b16 v[4:5], v1 offset:8192
ds_read_b64_tr_b16 v[6:7], v1 offset:10240
s_add_u32 s68, s78, 45056
buffer_store_dwordx4 v[60:63], v0, s[48:51], s68 offen offset:3072 sc1
s_waitcnt lgkmcnt(10)
v_mfma_f32_16x16x32_bf16 v[208:211], v[8:11], v[104:107], v[208:211]
v_mfma_f32_16x16x32_bf16 v[216:219], v[8:11], v[108:111], v[216:219]
v_mfma_f32_16x16x32_bf16 v[224:227], v[8:11], v[152:155], v[224:227]
v_mfma_f32_16x16x32_bf16 v[232:235], v[8:11], v[156:159], v[232:235]
v_mfma_f32_16x16x32_bf16 v[240:243], v[8:11], v[200:203], v[240:243]
v_mfma_f32_16x16x32_bf16 v[248:251], v[8:11], v[204:207], v[248:251]
ds_read_b64_tr_b16 v[8:9], v2 offset:8192
ds_read_b64_tr_b16 v[10:11], v2 offset:10240
s_waitcnt lgkmcnt(4)
v_mfma_f32_16x16x32_bf16 v[212:215], v[12:15], v[104:107], v[212:215]
v_mfma_f32_16x16x32_bf16 v[220:223], v[12:15], v[108:111], v[220:223]
v_mfma_f32_16x16x32_bf16 v[228:231], v[12:15], v[152:155], v[228:231]
v_mfma_f32_16x16x32_bf16 v[236:239], v[12:15], v[156:159], v[236:239]
v_mfma_f32_16x16x32_bf16 v[244:247], v[12:15], v[200:203], v[244:247]
v_mfma_f32_16x16x32_bf16 v[252:255], v[12:15], v[204:207], v[252:255]
ds_read_b64_tr_b16 v[12:13], v1 offset:12288
ds_read_b64_tr_b16 v[14:15], v1 offset:14336
v_cvt_pk_bf16_f32 v40, v208, v209
v_cvt_pk_bf16_f32 v41, v210, v211
v_cvt_pk_bf16_f32 v42, v212, v213
v_cvt_pk_bf16_f32 v43, v214, v215
v_cvt_pk_bf16_f32 v44, v216, v217
v_cvt_pk_bf16_f32 v45, v218, v219
v_cvt_pk_bf16_f32 v46, v220, v221
v_cvt_pk_bf16_f32 v47, v222, v223
v_cvt_pk_bf16_f32 v48, v224, v225
v_cvt_pk_bf16_f32 v49, v226, v227
v_cvt_pk_bf16_f32 v50, v228, v229
v_cvt_pk_bf16_f32 v51, v230, v231
v_cvt_pk_bf16_f32 v52, v232, v233
v_cvt_pk_bf16_f32 v53, v234, v235
v_cvt_pk_bf16_f32 v54, v236, v237
v_cvt_pk_bf16_f32 v55, v238, v239
v_cvt_pk_bf16_f32 v56, v240, v241
v_cvt_pk_bf16_f32 v57, v242, v243
v_cvt_pk_bf16_f32 v58, v244, v245
v_cvt_pk_bf16_f32 v59, v246, v247
v_cvt_pk_bf16_f32 v60, v248, v249
v_cvt_pk_bf16_f32 v61, v250, v251
v_cvt_pk_bf16_f32 v62, v252, v253
v_cvt_pk_bf16_f32 v63, v254, v255
s_add_u32 s68, s78, 49152
buffer_store_dwordx4 v[40:43], v0, s[48:51], s68 offen offset:2048 sc1
s_barrier
v_lshlrev_b32 v208, 16, v16
v_and_b32 v209, 0xffff0000, v16
v_lshlrev_b32 v210, 16, v17
v_and_b32 v211, 0xffff0000, v17
v_lshlrev_b32 v212, 16, v18
v_and_b32 v213, 0xffff0000, v18
v_lshlrev_b32 v214, 16, v19
v_and_b32 v215, 0xffff0000, v19
v_lshlrev_b32 v216, 16, v20
v_and_b32 v217, 0xffff0000, v20
v_lshlrev_b32 v218, 16, v21
v_and_b32 v219, 0xffff0000, v21
v_lshlrev_b32 v220, 16, v22
v_and_b32 v221, 0xffff0000, v22
v_lshlrev_b32 v222, 16, v23
v_and_b32 v223, 0xffff0000, v23
v_lshlrev_b32 v224, 16, v24
v_and_b32 v225, 0xffff0000, v24
v_lshlrev_b32 v226, 16, v25
v_and_b32 v227, 0xffff0000, v25
v_lshlrev_b32 v228, 16, v26
v_and_b32 v229, 0xffff0000, v26
v_lshlrev_b32 v230, 16, v27
v_and_b32 v231, 0xffff0000, v27
v_lshlrev_b32 v232, 16, v28
v_and_b32 v233, 0xffff0000, v28
v_lshlrev_b32 v234, 16, v29
v_and_b32 v235, 0xffff0000, v29
v_lshlrev_b32 v236, 16, v30
v_and_b32 v237, 0xffff0000, v30
v_lshlrev_b32 v238, 16, v31
v_and_b32 v239, 0xffff0000, v31
v_lshlrev_b32 v240, 16, v32
v_and_b32 v241, 0xffff0000, v32
v_lshlrev_b32 v242, 16, v33
v_and_b32 v243, 0xffff0000, v33
v_lshlrev_b32 v244, 16, v34
v_and_b32 v245, 0xffff0000, v34
v_lshlrev_b32 v246, 16, v35
v_and_b32 v247, 0xffff0000, v35
v_lshlrev_b32 v248, 16, v36
v_and_b32 v249, 0xffff0000, v36
v_lshlrev_b32 v250, 16, v37
v_and_b32 v251, 0xffff0000, v37
v_lshlrev_b32 v252, 16, v38
v_and_b32 v253, 0xffff0000, v38
v_lshlrev_b32 v254, 16, v39
v_and_b32 v255, 0xffff0000, v39
s_waitcnt lgkmcnt(4)
v_mfma_f32_16x16x32_bf16 v[208:211], v[4:7], v[64:67], v[208:211]
v_mfma_f32_16x16x32_bf16 v[216:219], v[4:7], v[68:71], v[216:219]
v_mfma_f32_16x16x32_bf16 v[224:227], v[4:7], v[112:115], v[224:227]
v_mfma_f32_16x16x32_bf16 v[232:235], v[4:7], v[116:119], v[232:235]
v_mfma_f32_16x16x32_bf16 v[240:243], v[4:7], v[160:163], v[240:243]
v_mfma_f32_16x16x32_bf16 v[248:251], v[4:7], v[164:167], v[248:251]
ds_read_b64_tr_b16 v[4:5], v2 offset:12288
ds_read_b64_tr_b16 v[6:7], v2 offset:14336
s_waitcnt lgkmcnt(4)
v_mfma_f32_16x16x32_bf16 v[212:215], v[8:11], v[64:67], v[212:215]
v_mfma_f32_16x16x32_bf16 v[220:223], v[8:11], v[68:71], v[220:223]
v_mfma_f32_16x16x32_bf16 v[228:231], v[8:11], v[112:115], v[228:231]
v_mfma_f32_16x16x32_bf16 v[236:239], v[8:11], v[116:119], v[236:239]
v_mfma_f32_16x16x32_bf16 v[244:247], v[8:11], v[160:163], v[244:247]
v_mfma_f32_16x16x32_bf16 v[252:255], v[8:11], v[164:167], v[252:255]
ds_read_b64_tr_b16 v[8:9], v1 offset:16384
ds_read_b64_tr_b16 v[10:11], v1 offset:18432
s_add_u32 s68, s78, 49152
buffer_store_dwordx4 v[44:47], v0, s[48:51], s68 offen offset:3072 sc1
s_waitcnt lgkmcnt(4)
v_mfma_f32_16x16x32_bf16 v[208:211], v[12:15], v[72:75], v[208:211]
v_mfma_f32_16x16x32_bf16 v[216:219], v[12:15], v[76:79], v[216:219]
v_mfma_f32_16x16x32_bf16 v[224:227], v[12:15], v[120:123], v[224:227]
v_mfma_f32_16x16x32_bf16 v[232:235], v[12:15], v[124:127], v[232:235]
v_mfma_f32_16x16x32_bf16 v[240:243], v[12:15], v[168:171], v[240:243]
v_mfma_f32_16x16x32_bf16 v[248:251], v[12:15], v[172:175], v[248:251]
ds_read_b64_tr_b16 v[12:13], v2 offset:16384
ds_read_b64_tr_b16 v[14:15], v2 offset:18432
s_add_u32 s68, s78, 57344
buffer_store_dwordx4 v[48:51], v0, s[48:51], s68 offen offset:2048 sc1
s_barrier
s_waitcnt lgkmcnt(4)
v_mfma_f32_16x16x32_bf16 v[212:215], v[4:7], v[72:75], v[212:215]
v_mfma_f32_16x16x32_bf16 v[220:223], v[4:7], v[76:79], v[220:223]
v_mfma_f32_16x16x32_bf16 v[228:231], v[4:7], v[120:123], v[228:231]
v_mfma_f32_16x16x32_bf16 v[236:239], v[4:7], v[124:127], v[236:239]
v_mfma_f32_16x16x32_bf16 v[244:247], v[4:7], v[168:171], v[244:247]
v_mfma_f32_16x16x32_bf16 v[252:255], v[4:7], v[172:175], v[252:255]
ds_read_b64_tr_b16 v[4:5], v1 offset:20480
ds_read_b64_tr_b16 v[6:7], v1 offset:22528
s_waitcnt lgkmcnt(4)
v_mfma_f32_16x16x32_bf16 v[208:211], v[8:11], v[80:83], v[208:211]
v_mfma_f32_16x16x32_bf16 v[216:219], v[8:11], v[84:87], v[216:219]
v_mfma_f32_16x16x32_bf16 v[224:227], v[8:11], v[128:131], v[224:227]
v_mfma_f32_16x16x32_bf16 v[232:235], v[8:11], v[132:135], v[232:235]
v_mfma_f32_16x16x32_bf16 v[240:243], v[8:11], v[176:179], v[240:243]
v_mfma_f32_16x16x32_bf16 v[248:251], v[8:11], v[180:183], v[248:251]
ds_read_b64_tr_b16 v[8:9], v2 offset:20480
ds_read_b64_tr_b16 v[10:11], v2 offset:22528
s_waitcnt lgkmcnt(4)
v_mfma_f32_16x16x32_bf16 v[212:215], v[12:15], v[80:83], v[212:215]
v_mfma_f32_16x16x32_bf16 v[220:223], v[12:15], v[84:87], v[220:223]
v_mfma_f32_16x16x32_bf16 v[228:231], v[12:15], v[128:131], v[228:231]
v_mfma_f32_16x16x32_bf16 v[236:239], v[12:15], v[132:135], v[236:239]
v_mfma_f32_16x16x32_bf16 v[244:247], v[12:15], v[176:179], v[244:247]
v_mfma_f32_16x16x32_bf16 v[252:255], v[12:15], v[180:183], v[252:255]
ds_read_b64_tr_b16 v[12:13], v1 offset:0
ds_read_b64_tr_b16 v[14:15], v1 offset:2048
s_waitcnt lgkmcnt(4)
v_mfma_f32_16x16x32_bf16 v[208:211], v[4:7], v[88:91], v[208:211]
v_mfma_f32_16x16x32_bf16 v[216:219], v[4:7], v[92:95], v[216:219]
v_mfma_f32_16x16x32_bf16 v[224:227], v[4:7], v[136:139], v[224:227]
v_mfma_f32_16x16x32_bf16 v[232:235], v[4:7], v[140:143], v[232:235]
v_mfma_f32_16x16x32_bf16 v[240:243], v[4:7], v[184:187], v[240:243]
v_mfma_f32_16x16x32_bf16 v[248:251], v[4:7], v[188:191], v[248:251]
ds_read_b64_tr_b16 v[4:5], v2 offset:0
ds_read_b64_tr_b16 v[6:7], v2 offset:2048
s_add_u32 s68, s78, 57344
buffer_store_dwordx4 v[52:55], v0, s[48:51], s68 offen offset:3072 sc1
s_waitcnt lgkmcnt(4)
v_mfma_f32_16x16x32_bf16 v[212:215], v[8:11], v[88:91], v[212:215]
v_mfma_f32_16x16x32_bf16 v[220:223], v[8:11], v[92:95], v[220:223]
v_mfma_f32_16x16x32_bf16 v[228:231], v[8:11], v[136:139], v[228:231]
v_mfma_f32_16x16x32_bf16 v[236:239], v[8:11], v[140:143], v[236:239]
v_mfma_f32_16x16x32_bf16 v[244:247], v[8:11], v[184:187], v[244:247]
v_mfma_f32_16x16x32_bf16 v[252:255], v[8:11], v[188:191], v[252:255]
ds_read_b64_tr_b16 v[8:9], v1 offset:4096
ds_read_b64_tr_b16 v[10:11], v1 offset:6144
ds_read_b128 v[16:19], v0 offset:6144
ds_read_b128 v[20:23], v0 offset:7168
ds_read_b128 v[24:27], v0 offset:8192
ds_read_b128 v[28:31], v0 offset:9216
ds_read_b128 v[32:35], v0 offset:10240
ds_read_b128 v[36:39], v0 offset:11264
s_add_u32 s68, s78, 65536
buffer_store_dwordx4 v[56:59], v0, s[48:51], s68 offen offset:2048 sc1
s_waitcnt lgkmcnt(10)
v_mfma_f32_16x16x32_bf16 v[208:211], v[12:15], v[96:99], v[208:211]
v_mfma_f32_16x16x32_bf16 v[216:219], v[12:15], v[100:103], v[216:219]
v_mfma_f32_16x16x32_bf16 v[224:227], v[12:15], v[144:147], v[224:227]
v_mfma_f32_16x16x32_bf16 v[232:235], v[12:15], v[148:151], v[232:235]
v_mfma_f32_16x16x32_bf16 v[240:243], v[12:15], v[192:195], v[240:243]
v_mfma_f32_16x16x32_bf16 v[248:251], v[12:15], v[196:199], v[248:251]
ds_read_b64_tr_b16 v[12:13], v2 offset:4096
ds_read_b64_tr_b16 v[14:15], v2 offset:6144
s_add_u32 s68, s78, 65536
buffer_store_dwordx4 v[60:63], v0, s[48:51], s68 offen offset:3072 sc1
s_waitcnt vmcnt(6)
s_waitcnt lgkmcnt(2)
s_barrier
v_mfma_f32_16x16x32_bf16 v[212:215], v[4:7], v[96:99], v[212:215]
v_mfma_f32_16x16x32_bf16 v[220:223], v[4:7], v[100:103], v[220:223]
v_mfma_f32_16x16x32_bf16 v[228:231], v[4:7], v[144:147], v[228:231]
v_mfma_f32_16x16x32_bf16 v[236:239], v[4:7], v[148:151], v[236:239]
v_mfma_f32_16x16x32_bf16 v[244:247], v[4:7], v[192:195], v[244:247]
v_mfma_f32_16x16x32_bf16 v[252:255], v[4:7], v[196:199], v[252:255]
ds_read_b64_tr_b16 v[4:5], v1 offset:24576
ds_read_b64_tr_b16 v[6:7], v1 offset:26624
v_mfma_f32_16x16x32_bf16 v[208:211], v[8:11], v[104:107], v[208:211]
v_mfma_f32_16x16x32_bf16 v[216:219], v[8:11], v[108:111], v[216:219]
v_mfma_f32_16x16x32_bf16 v[224:227], v[8:11], v[152:155], v[224:227]
v_mfma_f32_16x16x32_bf16 v[232:235], v[8:11], v[156:159], v[232:235]
v_mfma_f32_16x16x32_bf16 v[240:243], v[8:11], v[200:203], v[240:243]
v_mfma_f32_16x16x32_bf16 v[248:251], v[8:11], v[204:207], v[248:251]
ds_read_b64_tr_b16 v[8:9], v2 offset:24576
ds_read_b64_tr_b16 v[10:11], v2 offset:26624
s_waitcnt lgkmcnt(4)
v_mfma_f32_16x16x32_bf16 v[212:215], v[12:15], v[104:107], v[212:215]
v_mfma_f32_16x16x32_bf16 v[220:223], v[12:15], v[108:111], v[220:223]
v_mfma_f32_16x16x32_bf16 v[228:231], v[12:15], v[152:155], v[228:231]
v_mfma_f32_16x16x32_bf16 v[236:239], v[12:15], v[156:159], v[236:239]
v_mfma_f32_16x16x32_bf16 v[244:247], v[12:15], v[200:203], v[244:247]
v_mfma_f32_16x16x32_bf16 v[252:255], v[12:15], v[204:207], v[252:255]
ds_read_b64_tr_b16 v[12:13], v1 offset:28672
ds_read_b64_tr_b16 v[14:15], v1 offset:30720
v_cvt_pk_bf16_f32 v40, v208, v209
v_cvt_pk_bf16_f32 v41, v210, v211
v_cvt_pk_bf16_f32 v42, v212, v213
v_cvt_pk_bf16_f32 v43, v214, v215
v_cvt_pk_bf16_f32 v44, v216, v217
v_cvt_pk_bf16_f32 v45, v218, v219
v_cvt_pk_bf16_f32 v46, v220, v221
v_cvt_pk_bf16_f32 v47, v222, v223
v_cvt_pk_bf16_f32 v48, v224, v225
v_cvt_pk_bf16_f32 v49, v226, v227
v_cvt_pk_bf16_f32 v50, v228, v229
v_cvt_pk_bf16_f32 v51, v230, v231
v_cvt_pk_bf16_f32 v52, v232, v233
v_cvt_pk_bf16_f32 v53, v234, v235
v_cvt_pk_bf16_f32 v54, v236, v237
v_cvt_pk_bf16_f32 v55, v238, v239
v_cvt_pk_bf16_f32 v56, v240, v241
v_cvt_pk_bf16_f32 v57, v242, v243
v_cvt_pk_bf16_f32 v58, v244, v245
v_cvt_pk_bf16_f32 v59, v246, v247
v_cvt_pk_bf16_f32 v60, v248, v249
v_cvt_pk_bf16_f32 v61, v250, v251
v_cvt_pk_bf16_f32 v62, v252, v253
v_cvt_pk_bf16_f32 v63, v254, v255
s_add_u32 s68, s78, 53248
buffer_store_dwordx4 v[40:43], v0, s[48:51], s68 offen offset:2048 sc1
v_lshlrev_b32 v208, 16, v16
v_and_b32 v209, 0xffff0000, v16
v_lshlrev_b32 v210, 16, v17
v_and_b32 v211, 0xffff0000, v17
v_lshlrev_b32 v212, 16, v18
v_and_b32 v213, 0xffff0000, v18
v_lshlrev_b32 v214, 16, v19
v_and_b32 v215, 0xffff0000, v19
v_lshlrev_b32 v216, 16, v20
v_and_b32 v217, 0xffff0000, v20
v_lshlrev_b32 v218, 16, v21
v_and_b32 v219, 0xffff0000, v21
v_lshlrev_b32 v220, 16, v22
v_and_b32 v221, 0xffff0000, v22
v_lshlrev_b32 v222, 16, v23
v_and_b32 v223, 0xffff0000, v23
v_lshlrev_b32 v224, 16, v24
v_and_b32 v225, 0xffff0000, v24
v_lshlrev_b32 v226, 16, v25
v_and_b32 v227, 0xffff0000, v25
v_lshlrev_b32 v228, 16, v26
v_and_b32 v229, 0xffff0000, v26
v_lshlrev_b32 v230, 16, v27
v_and_b32 v231, 0xffff0000, v27
v_lshlrev_b32 v232, 16, v28
v_and_b32 v233, 0xffff0000, v28
v_lshlrev_b32 v234, 16, v29
v_and_b32 v235, 0xffff0000, v29
v_lshlrev_b32 v236, 16, v30
v_and_b32 v237, 0xffff0000, v30
v_lshlrev_b32 v238, 16, v31
v_and_b32 v239, 0xffff0000, v31
v_lshlrev_b32 v240, 16, v32
v_and_b32 v241, 0xffff0000, v32
v_lshlrev_b32 v242, 16, v33
v_and_b32 v243, 0xffff0000, v33
v_lshlrev_b32 v244, 16, v34
v_and_b32 v245, 0xffff0000, v34
v_lshlrev_b32 v246, 16, v35
v_and_b32 v247, 0xffff0000, v35
v_lshlrev_b32 v248, 16, v36
v_and_b32 v249, 0xffff0000, v36
v_lshlrev_b32 v250, 16, v37
v_and_b32 v251, 0xffff0000, v37
v_lshlrev_b32 v252, 16, v38
v_and_b32 v253, 0xffff0000, v38
v_lshlrev_b32 v254, 16, v39
v_and_b32 v255, 0xffff0000, v39
s_waitcnt lgkmcnt(4)
v_mfma_f32_16x16x32_bf16 v[208:211], v[4:7], v[64:67], v[208:211]
v_mfma_f32_16x16x32_bf16 v[216:219], v[4:7], v[68:71], v[216:219]
v_mfma_f32_16x16x32_bf16 v[224:227], v[4:7], v[112:115], v[224:227]
v_mfma_f32_16x16x32_bf16 v[232:235], v[4:7], v[116:119], v[232:235]
v_mfma_f32_16x16x32_bf16 v[240:243], v[4:7], v[160:163], v[240:243]
v_mfma_f32_16x16x32_bf16 v[248:251], v[4:7], v[164:167], v[248:251]
ds_read_b64_tr_b16 v[4:5], v2 offset:28672
ds_read_b64_tr_b16 v[6:7], v2 offset:30720
s_add_u32 s68, s78, 53248
buffer_store_dwordx4 v[44:47], v0, s[48:51], s68 offen offset:3072 sc1
s_barrier
s_waitcnt lgkmcnt(4)
v_mfma_f32_16x16x32_bf16 v[212:215], v[8:11], v[64:67], v[212:215]
v_mfma_f32_16x16x32_bf16 v[220:223], v[8:11], v[68:71], v[220:223]
v_mfma_f32_16x16x32_bf16 v[228:231], v[8:11], v[112:115], v[228:231]
v_mfma_f32_16x16x32_bf16 v[236:239], v[8:11], v[116:119], v[236:239]
v_mfma_f32_16x16x32_bf16 v[244:247], v[8:11], v[160:163], v[244:247]
v_mfma_f32_16x16x32_bf16 v[252:255], v[8:11], v[164:167], v[252:255]
ds_read_b64_tr_b16 v[8:9], v1 offset:32768
ds_read_b64_tr_b16 v[10:11], v1 offset:34816
s_waitcnt lgkmcnt(4)
v_mfma_f32_16x16x32_bf16 v[208:211], v[12:15], v[72:75], v[208:211]
v_mfma_f32_16x16x32_bf16 v[216:219], v[12:15], v[76:79], v[216:219]
v_mfma_f32_16x16x32_bf16 v[224:227], v[12:15], v[120:123], v[224:227]
v_mfma_f32_16x16x32_bf16 v[232:235], v[12:15], v[124:127], v[232:235]
v_mfma_f32_16x16x32_bf16 v[240:243], v[12:15], v[168:171], v[240:243]
v_mfma_f32_16x16x32_bf16 v[248:251], v[12:15], v[172:175], v[248:251]
ds_read_b64_tr_b16 v[12:13], v2 offset:32768
ds_read_b64_tr_b16 v[14:15], v2 offset:34816
s_waitcnt lgkmcnt(4)
v_mfma_f32_16x16x32_bf16 v[212:215], v[4:7], v[72:75], v[212:215]
v_mfma_f32_16x16x32_bf16 v[220:223], v[4:7], v[76:79], v[220:223]
v_mfma_f32_16x16x32_bf16 v[228:231], v[4:7], v[120:123], v[228:231]
v_mfma_f32_16x16x32_bf16 v[236:239], v[4:7], v[124:127], v[236:239]
v_mfma_f32_16x16x32_bf16 v[244:247], v[4:7], v[168:171], v[244:247]
v_mfma_f32_16x16x32_bf16 v[252:255], v[4:7], v[172:175], v[252:255]
ds_read_b64_tr_b16 v[4:5], v1 offset:36864
ds_read_b64_tr_b16 v[6:7], v1 offset:38912
s_add_u32 s68, s78, 61440
buffer_store_dwordx4 v[48:51], v0, s[48:51], s68 offen offset:2048 sc1
s_waitcnt lgkmcnt(4)
v_mfma_f32_16x16x32_bf16 v[208:211], v[8:11], v[80:83], v[208:211]
v_mfma_f32_16x16x32_bf16 v[216:219], v[8:11], v[84:87], v[216:219]
v_mfma_f32_16x16x32_bf16 v[224:227], v[8:11], v[128:131], v[224:227]
v_mfma_f32_16x16x32_bf16 v[232:235], v[8:11], v[132:135], v[232:235]
v_mfma_f32_16x16x32_bf16 v[240:243], v[8:11], v[176:179], v[240:243]
v_mfma_f32_16x16x32_bf16 v[248:251], v[8:11], v[180:183], v[248:251]
ds_read_b64_tr_b16 v[8:9], v2 offset:36864
ds_read_b64_tr_b16 v[10:11], v2 offset:38912
s_add_u32 s68, s78, 61440
buffer_store_dwordx4 v[52:55], v0, s[48:51], s68 offen offset:3072 sc1
s_barrier
s_waitcnt lgkmcnt(4)
v_mfma_f32_16x16x32_bf16 v[212:215], v[12:15], v[80:83], v[212:215]
v_mfma_f32_16x16x32_bf16 v[220:223], v[12:15], v[84:87], v[220:223]
v_mfma_f32_16x16x32_bf16 v[228:231], v[12:15], v[128:131], v[228:231]
v_mfma_f32_16x16x32_bf16 v[236:239], v[12:15], v[132:135], v[236:239]
v_mfma_f32_16x16x32_bf16 v[244:247], v[12:15], v[176:179], v[244:247]
v_mfma_f32_16x16x32_bf16 v[252:255], v[12:15], v[180:183], v[252:255]
ds_read_b64_tr_b16 v[12:13], v1 offset:40960
ds_read_b64_tr_b16 v[14:15], v1 offset:43008
s_waitcnt lgkmcnt(4)
v_mfma_f32_16x16x32_bf16 v[208:211], v[4:7], v[88:91], v[208:211]
v_mfma_f32_16x16x32_bf16 v[216:219], v[4:7], v[92:95], v[216:219]
v_mfma_f32_16x16x32_bf16 v[224:227], v[4:7], v[136:139], v[224:227]
v_mfma_f32_16x16x32_bf16 v[232:235], v[4:7], v[140:143], v[232:235]
v_mfma_f32_16x16x32_bf16 v[240:243], v[4:7], v[184:187], v[240:243]
v_mfma_f32_16x16x32_bf16 v[248:251], v[4:7], v[188:191], v[248:251]
ds_read_b64_tr_b16 v[4:5], v2 offset:40960
ds_read_b64_tr_b16 v[6:7], v2 offset:43008
s_waitcnt lgkmcnt(4)
v_mfma_f32_16x16x32_bf16 v[212:215], v[8:11], v[88:91], v[212:215]
v_mfma_f32_16x16x32_bf16 v[220:223], v[8:11], v[92:95], v[220:223]
v_mfma_f32_16x16x32_bf16 v[228:231], v[8:11], v[136:139], v[228:231]
v_mfma_f32_16x16x32_bf16 v[236:239], v[8:11], v[140:143], v[236:239]
v_mfma_f32_16x16x32_bf16 v[244:247], v[8:11], v[184:187], v[244:247]
v_mfma_f32_16x16x32_bf16 v[252:255], v[8:11], v[188:191], v[252:255]
ds_read_b64_tr_b16 v[8:9], v1 offset:45056
ds_read_b64_tr_b16 v[10:11], v1 offset:47104
ds_read_b128 v[16:19], v0 offset:18432
ds_read_b128 v[20:23], v0 offset:19456
ds_read_b128 v[24:27], v0 offset:20480
ds_read_b128 v[28:31], v0 offset:21504
ds_read_b128 v[32:35], v0 offset:22528
ds_read_b128 v[36:39], v0 offset:23552
s_waitcnt lgkmcnt(10)
v_mfma_f32_16x16x32_bf16 v[208:211], v[12:15], v[96:99], v[208:211]
v_mfma_f32_16x16x32_bf16 v[216:219], v[12:15], v[100:103], v[216:219]
v_mfma_f32_16x16x32_bf16 v[224:227], v[12:15], v[144:147], v[224:227]
v_mfma_f32_16x16x32_bf16 v[232:235], v[12:15], v[148:151], v[232:235]
v_mfma_f32_16x16x32_bf16 v[240:243], v[12:15], v[192:195], v[240:243]
v_mfma_f32_16x16x32_bf16 v[248:251], v[12:15], v[196:199], v[248:251]
ds_read_b64_tr_b16 v[12:13], v2 offset:45056
ds_read_b64_tr_b16 v[14:15], v2 offset:47104
s_add_u32 s68, s78, 69632
buffer_store_dwordx4 v[56:59], v0, s[48:51], s68 offen offset:2048 sc1
s_waitcnt lgkmcnt(10)
v_mfma_f32_16x16x32_bf16 v[212:215], v[4:7], v[96:99], v[212:215]
v_mfma_f32_16x16x32_bf16 v[220:223], v[4:7], v[100:103], v[220:223]
v_mfma_f32_16x16x32_bf16 v[228:231], v[4:7], v[144:147], v[228:231]
v_mfma_f32_16x16x32_bf16 v[236:239], v[4:7], v[148:151], v[236:239]
v_mfma_f32_16x16x32_bf16 v[244:247], v[4:7], v[192:195], v[244:247]
v_mfma_f32_16x16x32_bf16 v[252:255], v[4:7], v[196:199], v[252:255]
ds_read_b64_tr_b16 v[4:5], v1 offset:8192
ds_read_b64_tr_b16 v[6:7], v1 offset:10240
s_add_u32 s68, s78, 69632
buffer_store_dwordx4 v[60:63], v0, s[48:51], s68 offen offset:3072 sc1
s_waitcnt lgkmcnt(10)
v_mfma_f32_16x16x32_bf16 v[208:211], v[8:11], v[104:107], v[208:211]
v_mfma_f32_16x16x32_bf16 v[216:219], v[8:11], v[108:111], v[216:219]
v_mfma_f32_16x16x32_bf16 v[224:227], v[8:11], v[152:155], v[224:227]
v_mfma_f32_16x16x32_bf16 v[232:235], v[8:11], v[156:159], v[232:235]
v_mfma_f32_16x16x32_bf16 v[240:243], v[8:11], v[200:203], v[240:243]
v_mfma_f32_16x16x32_bf16 v[248:251], v[8:11], v[204:207], v[248:251]
ds_read_b64_tr_b16 v[8:9], v2 offset:8192
ds_read_b64_tr_b16 v[10:11], v2 offset:10240
s_waitcnt lgkmcnt(6)
s_barrier
s_waitcnt lgkmcnt(4)
v_mfma_f32_16x16x32_bf16 v[212:215], v[12:15], v[104:107], v[212:215]
v_mfma_f32_16x16x32_bf16 v[220:223], v[12:15], v[108:111], v[220:223]
v_mfma_f32_16x16x32_bf16 v[228:231], v[12:15], v[152:155], v[228:231]
v_mfma_f32_16x16x32_bf16 v[236:239], v[12:15], v[156:159], v[236:239]
v_mfma_f32_16x16x32_bf16 v[244:247], v[12:15], v[200:203], v[244:247]
v_mfma_f32_16x16x32_bf16 v[252:255], v[12:15], v[204:207], v[252:255]
ds_read_b64_tr_b16 v[12:13], v1 offset:12288
ds_read_b64_tr_b16 v[14:15], v1 offset:14336
v_cvt_pk_bf16_f32 v40, v208, v209
v_cvt_pk_bf16_f32 v41, v210, v211
v_cvt_pk_bf16_f32 v42, v212, v213
v_cvt_pk_bf16_f32 v43, v214, v215
v_cvt_pk_bf16_f32 v44, v216, v217
v_cvt_pk_bf16_f32 v45, v218, v219
v_cvt_pk_bf16_f32 v46, v220, v221
v_cvt_pk_bf16_f32 v47, v222, v223
v_cvt_pk_bf16_f32 v48, v224, v225
v_cvt_pk_bf16_f32 v49, v226, v227
v_cvt_pk_bf16_f32 v50, v228, v229
v_cvt_pk_bf16_f32 v51, v230, v231
v_cvt_pk_bf16_f32 v52, v232, v233
v_cvt_pk_bf16_f32 v53, v234, v235
v_cvt_pk_bf16_f32 v54, v236, v237
v_cvt_pk_bf16_f32 v55, v238, v239
v_cvt_pk_bf16_f32 v56, v240, v241
v_cvt_pk_bf16_f32 v57, v242, v243
v_cvt_pk_bf16_f32 v58, v244, v245
v_cvt_pk_bf16_f32 v59, v246, v247
v_cvt_pk_bf16_f32 v60, v248, v249
v_cvt_pk_bf16_f32 v61, v250, v251
v_cvt_pk_bf16_f32 v62, v252, v253
v_cvt_pk_bf16_f32 v63, v254, v255
s_add_u32 s68, s78, 73728
buffer_store_dwordx4 v[40:43], v0, s[48:51], s68 offen offset:2048 sc1
v_lshlrev_b32 v208, 16, v16
v_and_b32 v209, 0xffff0000, v16
v_lshlrev_b32 v210, 16, v17
v_and_b32 v211, 0xffff0000, v17
v_lshlrev_b32 v212, 16, v18
v_and_b32 v213, 0xffff0000, v18
v_lshlrev_b32 v214, 16, v19
v_and_b32 v215, 0xffff0000, v19
v_lshlrev_b32 v216, 16, v20
v_and_b32 v217, 0xffff0000, v20
v_lshlrev_b32 v218, 16, v21
v_and_b32 v219, 0xffff0000, v21
v_lshlrev_b32 v220, 16, v22
v_and_b32 v221, 0xffff0000, v22
v_lshlrev_b32 v222, 16, v23
v_and_b32 v223, 0xffff0000, v23
v_lshlrev_b32 v224, 16, v24
v_and_b32 v225, 0xffff0000, v24
v_lshlrev_b32 v226, 16, v25
v_and_b32 v227, 0xffff0000, v25
v_lshlrev_b32 v228, 16, v26
v_and_b32 v229, 0xffff0000, v26
v_lshlrev_b32 v230, 16, v27
v_and_b32 v231, 0xffff0000, v27
v_lshlrev_b32 v232, 16, v28
v_and_b32 v233, 0xffff0000, v28
v_lshlrev_b32 v234, 16, v29
v_and_b32 v235, 0xffff0000, v29
v_lshlrev_b32 v236, 16, v30
v_and_b32 v237, 0xffff0000, v30
v_lshlrev_b32 v238, 16, v31
v_and_b32 v239, 0xffff0000, v31
v_lshlrev_b32 v240, 16, v32
v_and_b32 v241, 0xffff0000, v32
v_lshlrev_b32 v242, 16, v33
v_and_b32 v243, 0xffff0000, v33
v_lshlrev_b32 v244, 16, v34
v_and_b32 v245, 0xffff0000, v34
v_lshlrev_b32 v246, 16, v35
v_and_b32 v247, 0xffff0000, v35
v_lshlrev_b32 v248, 16, v36
v_and_b32 v249, 0xffff0000, v36
v_lshlrev_b32 v250, 16, v37
v_and_b32 v251, 0xffff0000, v37
v_lshlrev_b32 v252, 16, v38
v_and_b32 v253, 0xffff0000, v38
v_lshlrev_b32 v254, 16, v39
v_and_b32 v255, 0xffff0000, v39
s_waitcnt lgkmcnt(4)
v_mfma_f32_16x16x32_bf16 v[208:211], v[4:7], v[64:67], v[208:211]
v_mfma_f32_16x16x32_bf16 v[216:219], v[4:7], v[68:71], v[216:219]
v_mfma_f32_16x16x32_bf16 v[224:227], v[4:7], v[112:115], v[224:227]
v_mfma_f32_16x16x32_bf16 v[232:235], v[4:7], v[116:119], v[232:235]
v_mfma_f32_16x16x32_bf16 v[240:243], v[4:7], v[160:163], v[240:243]
v_mfma_f32_16x16x32_bf16 v[248:251], v[4:7], v[164:167], v[248:251]
ds_read_b64_tr_b16 v[4:5], v2 offset:12288
ds_read_b64_tr_b16 v[6:7], v2 offset:14336
s_add_u32 s68, s78, 73728
buffer_store_dwordx4 v[44:47], v0, s[48:51], s68 offen offset:3072 sc1
s_barrier
s_waitcnt lgkmcnt(4)
v_mfma_f32_16x16x32_bf16 v[212:215], v[8:11], v[64:67], v[212:215]
v_mfma_f32_16x16x32_bf16 v[220:223], v[8:11], v[68:71], v[220:223]
v_mfma_f32_16x16x32_bf16 v[228:231], v[8:11], v[112:115], v[228:231]
v_mfma_f32_16x16x32_bf16 v[236:239], v[8:11], v[116:119], v[236:239]
v_mfma_f32_16x16x32_bf16 v[244:247], v[8:11], v[160:163], v[244:247]
v_mfma_f32_16x16x32_bf16 v[252:255], v[8:11], v[164:167], v[252:255]
ds_read_b64_tr_b16 v[8:9], v1 offset:16384
ds_read_b64_tr_b16 v[10:11], v1 offset:18432
s_waitcnt lgkmcnt(4)
v_mfma_f32_16x16x32_bf16 v[208:211], v[12:15], v[72:75], v[208:211]
v_mfma_f32_16x16x32_bf16 v[216:219], v[12:15], v[76:79], v[216:219]
v_mfma_f32_16x16x32_bf16 v[224:227], v[12:15], v[120:123], v[224:227]
v_mfma_f32_16x16x32_bf16 v[232:235], v[12:15], v[124:127], v[232:235]
v_mfma_f32_16x16x32_bf16 v[240:243], v[12:15], v[168:171], v[240:243]
v_mfma_f32_16x16x32_bf16 v[248:251], v[12:15], v[172:175], v[248:251]
ds_read_b64_tr_b16 v[12:13], v2 offset:16384
ds_read_b64_tr_b16 v[14:15], v2 offset:18432
s_waitcnt lgkmcnt(4)
v_mfma_f32_16x16x32_bf16 v[212:215], v[4:7], v[72:75], v[212:215]
v_mfma_f32_16x16x32_bf16 v[220:223], v[4:7], v[76:79], v[220:223]
v_mfma_f32_16x16x32_bf16 v[228:231], v[4:7], v[120:123], v[228:231]
v_mfma_f32_16x16x32_bf16 v[236:239], v[4:7], v[124:127], v[236:239]
v_mfma_f32_16x16x32_bf16 v[244:247], v[4:7], v[168:171], v[244:247]
v_mfma_f32_16x16x32_bf16 v[252:255], v[4:7], v[172:175], v[252:255]
ds_read_b64_tr_b16 v[4:5], v1 offset:20480
ds_read_b64_tr_b16 v[6:7], v1 offset:22528
s_add_u32 s68, s78, 81920
buffer_store_dwordx4 v[48:51], v0, s[48:51], s68 offen offset:2048 sc1
s_waitcnt lgkmcnt(4)
v_mfma_f32_16x16x32_bf16 v[208:211], v[8:11], v[80:83], v[208:211]
v_mfma_f32_16x16x32_bf16 v[216:219], v[8:11], v[84:87], v[216:219]
v_mfma_f32_16x16x32_bf16 v[224:227], v[8:11], v[128:131], v[224:227]
v_mfma_f32_16x16x32_bf16 v[232:235], v[8:11], v[132:135], v[232:235]
v_mfma_f32_16x16x32_bf16 v[240:243], v[8:11], v[176:179], v[240:243]
v_mfma_f32_16x16x32_bf16 v[248:251], v[8:11], v[180:183], v[248:251]
ds_read_b64_tr_b16 v[8:9], v2 offset:20480
ds_read_b64_tr_b16 v[10:11], v2 offset:22528
s_waitcnt lgkmcnt(4)
v_mfma_f32_16x16x32_bf16 v[212:215], v[12:15], v[80:83], v[212:215]
v_mfma_f32_16x16x32_bf16 v[220:223], v[12:15], v[84:87], v[220:223]
v_mfma_f32_16x16x32_bf16 v[228:231], v[12:15], v[128:131], v[228:231]
v_mfma_f32_16x16x32_bf16 v[236:239], v[12:15], v[132:135], v[236:239]
v_mfma_f32_16x16x32_bf16 v[244:247], v[12:15], v[176:179], v[244:247]
v_mfma_f32_16x16x32_bf16 v[252:255], v[12:15], v[180:183], v[252:255]
ds_read_b64_tr_b16 v[12:13], v1 offset:24576
ds_read_b64_tr_b16 v[14:15], v1 offset:26624
s_add_u32 s68, s78, 81920
buffer_store_dwordx4 v[52:55], v0, s[48:51], s68 offen offset:3072 sc1
s_barrier
s_waitcnt lgkmcnt(4)
v_mfma_f32_16x16x32_bf16 v[208:211], v[4:7], v[88:91], v[208:211]
v_mfma_f32_16x16x32_bf16 v[216:219], v[4:7], v[92:95], v[216:219]
v_mfma_f32_16x16x32_bf16 v[224:227], v[4:7], v[136:139], v[224:227]
v_mfma_f32_16x16x32_bf16 v[232:235], v[4:7], v[140:143], v[232:235]
v_mfma_f32_16x16x32_bf16 v[240:243], v[4:7], v[184:187], v[240:243]
v_mfma_f32_16x16x32_bf16 v[248:251], v[4:7], v[188:191], v[248:251]
ds_read_b64_tr_b16 v[4:5], v2 offset:24576
ds_read_b64_tr_b16 v[6:7], v2 offset:26624
s_waitcnt lgkmcnt(4)
v_mfma_f32_16x16x32_bf16 v[212:215], v[8:11], v[88:91], v[212:215]
v_mfma_f32_16x16x32_bf16 v[220:223], v[8:11], v[92:95], v[220:223]
v_mfma_f32_16x16x32_bf16 v[228:231], v[8:11], v[136:139], v[228:231]
v_mfma_f32_16x16x32_bf16 v[236:239], v[8:11], v[140:143], v[236:239]
v_mfma_f32_16x16x32_bf16 v[244:247], v[8:11], v[184:187], v[244:247]
v_mfma_f32_16x16x32_bf16 v[252:255], v[8:11], v[188:191], v[252:255]
ds_read_b64_tr_b16 v[8:9], v1 offset:28672
ds_read_b64_tr_b16 v[10:11], v1 offset:30720
s_waitcnt lgkmcnt(4)
v_mfma_f32_16x16x32_bf16 v[208:211], v[12:15], v[96:99], v[208:211]
v_mfma_f32_16x16x32_bf16 v[216:219], v[12:15], v[100:103], v[216:219]
v_mfma_f32_16x16x32_bf16 v[224:227], v[12:15], v[144:147], v[224:227]
v_mfma_f32_16x16x32_bf16 v[232:235], v[12:15], v[148:151], v[232:235]
v_mfma_f32_16x16x32_bf16 v[240:243], v[12:15], v[192:195], v[240:243]
v_mfma_f32_16x16x32_bf16 v[248:251], v[12:15], v[196:199], v[248:251]
ds_read_b64_tr_b16 v[12:13], v2 offset:28672
ds_read_b64_tr_b16 v[14:15], v2 offset:30720
s_add_u32 s68, s78, 90112
buffer_store_dwordx4 v[56:59], v0, s[48:51], s68 offen offset:2048 sc1
s_waitcnt lgkmcnt(4)
v_mfma_f32_16x16x32_bf16 v[212:215], v[4:7], v[96:99], v[212:215]
v_mfma_f32_16x16x32_bf16 v[220:223], v[4:7], v[100:103], v[220:223]
v_mfma_f32_16x16x32_bf16 v[228:231], v[4:7], v[144:147], v[228:231]
v_mfma_f32_16x16x32_bf16 v[236:239], v[4:7], v[148:151], v[236:239]
v_mfma_f32_16x16x32_bf16 v[244:247], v[4:7], v[192:195], v[244:247]
v_mfma_f32_16x16x32_bf16 v[252:255], v[4:7], v[196:199], v[252:255]
s_add_u32 s68, s78, 90112
buffer_store_dwordx4 v[60:63], v0, s[48:51], s68 offen offset:3072 sc1
s_waitcnt lgkmcnt(2)
v_mfma_f32_16x16x32_bf16 v[208:211], v[8:11], v[104:107], v[208:211]
v_mfma_f32_16x16x32_bf16 v[216:219], v[8:11], v[108:111], v[216:219]
v_mfma_f32_16x16x32_bf16 v[224:227], v[8:11], v[152:155], v[224:227]
v_mfma_f32_16x16x32_bf16 v[232:235], v[8:11], v[156:159], v[232:235]
v_mfma_f32_16x16x32_bf16 v[240:243], v[8:11], v[200:203], v[240:243]
v_mfma_f32_16x16x32_bf16 v[248:251], v[8:11], v[204:207], v[248:251]
s_waitcnt lgkmcnt(0)
v_mfma_f32_16x16x32_bf16 v[212:215], v[12:15], v[104:107], v[212:215]
v_mfma_f32_16x16x32_bf16 v[220:223], v[12:15], v[108:111], v[220:223]
v_mfma_f32_16x16x32_bf16 v[228:231], v[12:15], v[152:155], v[228:231]
v_mfma_f32_16x16x32_bf16 v[236:239], v[12:15], v[156:159], v[236:239]
v_mfma_f32_16x16x32_bf16 v[244:247], v[12:15], v[200:203], v[244:247]
v_mfma_f32_16x16x32_bf16 v[252:255], v[12:15], v[204:207], v[252:255]
v_cvt_pk_bf16_f32 v40, v208, v209
v_cvt_pk_bf16_f32 v41, v210, v211
s_nop 0
v_cvt_pk_bf16_f32 v42, v212, v213
v_cvt_pk_bf16_f32 v43, v214, v215
v_cvt_pk_bf16_f32 v44, v216, v217
v_cvt_pk_bf16_f32 v45, v218, v219
v_cvt_pk_bf16_f32 v46, v220, v221
v_cvt_pk_bf16_f32 v47, v222, v223
v_cvt_pk_bf16_f32 v48, v224, v225
v_cvt_pk_bf16_f32 v49, v226, v227
v_cvt_pk_bf16_f32 v50, v228, v229
v_cvt_pk_bf16_f32 v51, v230, v231
v_cvt_pk_bf16_f32 v52, v232, v233
v_cvt_pk_bf16_f32 v53, v234, v235
v_cvt_pk_bf16_f32 v54, v236, v237
v_cvt_pk_bf16_f32 v55, v238, v239
v_cvt_pk_bf16_f32 v56, v240, v241
v_cvt_pk_bf16_f32 v57, v242, v243
v_cvt_pk_bf16_f32 v58, v244, v245
v_cvt_pk_bf16_f32 v59, v246, v247
v_cvt_pk_bf16_f32 v60, v248, v249
v_cvt_pk_bf16_f32 v61, v250, v251
v_cvt_pk_bf16_f32 v62, v252, v253
v_cvt_pk_bf16_f32 v63, v254, v255
s_add_u32 s68, s78, 77824
buffer_store_dwordx4 v[40:43], v0, s[48:51], s68 offen offset:2048 sc1
s_add_u32 s68, s78, 77824
buffer_store_dwordx4 v[44:47], v0, s[48:51], s68 offen offset:3072 sc1
s_add_u32 s68, s78, 86016
buffer_store_dwordx4 v[48:51], v0, s[48:51], s68 offen offset:2048 sc1
s_add_u32 s68, s78, 86016
buffer_store_dwordx4 v[52:55], v0, s[48:51], s68 offen offset:3072 sc1
s_add_u32 s68, s78, 94208
buffer_store_dwordx4 v[56:59], v0, s[48:51], s68 offen offset:2048 sc1
s_add_u32 s68, s78, 94208
buffer_store_dwordx4 v[60:63], v0, s[48:51], s68 offen offset:3072 sc1
s_branch L_reduce
L_shadow0:
s_setprio 0
v_mbcnt_lo_u32_b32 v4, -1, 0
v_mbcnt_hi_u32_b32 v4, -1, v4
s_lshl_b32 s88, s64, 4
s_add_u32 s88, s88, s65
s_mul_i32 s88, s88, 983040
s_mul_i32 s73, s66, 3072
s_add_u32 s88, s88, s73
v_lshlrev_b32 v2, 4, v4
v_and_b32 v3, 15, v4
v_mul_u32_u24 v3, 2560, v3
v_lshrrev_b32 v4, 4, v4
v_lshl_add_u32 v3, v4, 3, v3
s_mul_i32 s80, s65, 245760
s_mul_i32 s69, s64, 1280
s_add_u32 s80, s80, s69
s_lshl_b32 s79, s64, 4
s_add_u32 s79, s79, s65
s_lshl_b32 s99, s79, 7
s_add_u32 s99, s99, 131072
s_lshl_b32 s79, s79, 2
s_add_u32 s79, s79, 128
s_mov_b32 s74, 0
v_mov_b32 v6, 0
v_lshrrev_b32 v5, 2, v2
v_and_b32 v5, 28, v5
s_barrier
s_barrier
s_barrier
s_barrier
s_barrier
s_barrier
s_barrier
s_barrier
s_barrier
s_barrier
s_barrier
s_barrier
s_barrier
s_barrier
s_barrier
s_barrier
s_barrier
s_barrier
s_barrier
s_barrier
ds_write_b128 v1, v[112:115] offset:0
ds_write_b128 v1, v[116:119] offset:1024
ds_write_b128 v1, v[120:123] offset:2048
ds_write_b128 v1, v[124:127] offset:3072
ds_write_b128 v1, v[128:131] offset:4096
ds_write_b128 v1, v[132:135] offset:5120
ds_write_b128 v1, v[136:139] offset:6144
ds_write_b128 v1, v[140:143] offset:7168
ds_write_b128 v1, v[144:147] offset:8192
ds_write_b128 v1, v[148:151] offset:9216
ds_write_b128 v1, v[152:155] offset:10240
ds_write_b128 v1, v[156:159] offset:11264
s_waitcnt lgkmcnt(0)
s_barrier
s_barrier
s_barrier
s_waitcnt vmcnt(0)
s_barrier
L_shf0:
s_barrier
s_add_u32 s69, s88, 262144
buffer_load_dwordx4 v[160:163], v2, s[48:51], s69 offen sc1
s_add_u32 s69, s88, 385024
buffer_load_dwordx4 v[164:167], v2, s[48:51], s69 offen sc1
s_add_u32 s69, s88, 507904
buffer_load_dwordx4 v[168:171], v2, s[48:51], s69 offen sc1
s_add_u32 s69, s88, 630784
buffer_load_dwordx4 v[172:175], v2, s[48:51], s69 offen sc1
s_add_u32 s69, s88, 753664
buffer_load_dwordx4 v[176:179], v2, s[48:51], s69 offen sc1
s_add_u32 s69, s88, 876544
buffer_load_dwordx4 v[180:183], v2, s[48:51], s69 offen sc1
s_add_u32 s69, s88, 999424
buffer_load_dwordx4 v[184:187], v2, s[48:51], s69 offen sc1
s_add_u32 s69, s88, 1122304
buffer_load_dwordx4 v[188:191], v2, s[48:51], s69 offen sc1
s_add_u32 s69, s88, 264192
buffer_load_dwordx4 v[192:195], v2, s[48:51], s69 offen sc1
s_add_u32 s69, s88, 387072
buffer_load_dwordx4 v[196:199], v2, s[48:51], s69 offen sc1
s_add_u32 s69, s88, 509952
buffer_load_dwordx4 v[200:203], v2, s[48:51], s69 offen sc1
s_add_u32 s69, s88, 632832
buffer_load_dwordx4 v[204:207], v2, s[48:51], s69 offen sc1
s_add_u32 s69, s88, 755712
buffer_load_dwordx4 v[208:211], v2, s[48:51], s69 offen sc1
s_add_u32 s69, s88, 878592
buffer_load_dwordx4 v[212:215], v2, s[48:51], s69 offen sc1
s_add_u32 s69, s88, 1001472
buffer_load_dwordx4 v[216:219], v2, s[48:51], s69 offen sc1
s_add_u32 s69, s88, 1124352
buffer_load_dwordx4 v[220:223], v2, s[48:51], s69 offen sc1
s_mul_i32 s68, s66, 3
s_add_u32 s68, s68, 0
s_lshr_b32 s69, s68, 3
s_mul_i32 s69, s69, 81920
s_bitcmp1_b32 s68, 0
s_cselect_b32 s73, 40960, 0
s_add_u32 s69, s69, s73
s_and_b32 s68, s68, 6
s_lshl_b32 s68, s68, 5
s_add_u32 s69, s69, s68
s_add_u32 s69, s69, s80
s_add_u32 s69, s69, 0
s_waitcnt vmcnt(15)
v_lshlrev_b32 v8, 16, v160
v_and_b32 v9, 0xffff0000, v160
v_lshlrev_b32 v10, 16, v161
v_and_b32 v11, 0xffff0000, v161
v_lshlrev_b32 v12, 16, v162
v_and_b32 v13, 0xffff0000, v162
v_lshlrev_b32 v14, 16, v163
v_and_b32 v15, 0xffff0000, v163
s_waitcnt vmcnt(14)
v_lshlrev_b32 v56, 16, v164
v_and_b32 v57, 0xffff0000, v164
v_lshlrev_b32 v58, 16, v165
v_and_b32 v59, 0xffff0000, v165
v_lshlrev_b32 v60, 16, v166
v_and_b32 v61, 0xffff0000, v166
v_lshlrev_b32 v62, 16, v167
v_and_b32 v63, 0xffff0000, v167
v_pk_add_f32 v[8:9], v[8:9], v[56:57]
v_pk_add_f32 v[10:11], v[10:11], v[58:59]
v_pk_add_f32 v[12:13], v[12:13], v[60:61]
v_pk_add_f32 v[14:15], v[14:15], v[62:63]
s_waitcnt vmcnt(13)
v_lshlrev_b32 v56, 16, v168
v_and_b32 v57, 0xffff0000, v168
v_lshlrev_b32 v58, 16, v169
v_and_b32 v59, 0xffff0000, v169
v_lshlrev_b32 v60, 16, v170
v_and_b32 v61, 0xffff0000, v170
v_lshlrev_b32 v62, 16, v171
v_and_b32 v63, 0xffff0000, v171
v_pk_add_f32 v[8:9], v[8:9], v[56:57]
v_pk_add_f32 v[10:11], v[10:11], v[58:59]
v_pk_add_f32 v[12:13], v[12:13], v[60:61]
v_pk_add_f32 v[14:15], v[14:15], v[62:63]
s_waitcnt vmcnt(12)
v_lshlrev_b32 v56, 16, v172
v_and_b32 v57, 0xffff0000, v172
v_lshlrev_b32 v58, 16, v173
v_and_b32 v59, 0xffff0000, v173
v_lshlrev_b32 v60, 16, v174
v_and_b32 v61, 0xffff0000, v174
v_lshlrev_b32 v62, 16, v175
v_and_b32 v63, 0xffff0000, v175
v_pk_add_f32 v[8:9], v[8:9], v[56:57]
v_pk_add_f32 v[10:11], v[10:11], v[58:59]
v_pk_add_f32 v[12:13], v[12:13], v[60:61]
v_pk_add_f32 v[14:15], v[14:15], v[62:63]
s_waitcnt vmcnt(11)
v_lshlrev_b32 v56, 16, v176
v_and_b32 v57, 0xffff0000, v176
v_lshlrev_b32 v58, 16, v177
v_and_b32 v59, 0xffff0000, v177
v_lshlrev_b32 v60, 16, v178
v_and_b32 v61, 0xffff0000, v178
v_lshlrev_b32 v62, 16, v179
v_and_b32 v63, 0xffff0000, v179
v_pk_add_f32 v[8:9], v[8:9], v[56:57]
v_pk_add_f32 v[10:11], v[10:11], v[58:59]
v_pk_add_f32 v[12:13], v[12:13], v[60:61]
v_pk_add_f32 v[14:15], v[14:15], v[62:63]
s_waitcnt vmcnt(10)
v_lshlrev_b32 v56, 16, v180
v_and_b32 v57, 0xffff0000, v180
v_lshlrev_b32 v58, 16, v181
v_and_b32 v59, 0xffff0000, v181
v_lshlrev_b32 v60, 16, v182
v_and_b32 v61, 0xffff0000, v182
v_lshlrev_b32 v62, 16, v183
v_and_b32 v63, 0xffff0000, v183
v_pk_add_f32 v[8:9], v[8:9], v[56:57]
v_pk_add_f32 v[10:11], v[10:11], v[58:59]
v_pk_add_f32 v[12:13], v[12:13], v[60:61]
v_pk_add_f32 v[14:15], v[14:15], v[62:63]
s_waitcnt vmcnt(9)
v_lshlrev_b32 v56, 16, v184
v_and_b32 v57, 0xffff0000, v184
v_lshlrev_b32 v58, 16, v185
v_and_b32 v59, 0xffff0000, v185
v_lshlrev_b32 v60, 16, v186
v_and_b32 v61, 0xffff0000, v186
v_lshlrev_b32 v62, 16, v187
v_and_b32 v63, 0xffff0000, v187
v_pk_add_f32 v[8:9], v[8:9], v[56:57]
v_pk_add_f32 v[10:11], v[10:11], v[58:59]
v_pk_add_f32 v[12:13], v[12:13], v[60:61]
v_pk_add_f32 v[14:15], v[14:15], v[62:63]
s_waitcnt vmcnt(8)
v_lshlrev_b32 v56, 16, v188
v_and_b32 v57, 0xffff0000, v188
v_lshlrev_b32 v58, 16, v189
v_and_b32 v59, 0xffff0000, v189
v_lshlrev_b32 v60, 16, v190
v_and_b32 v61, 0xffff0000, v190
v_lshlrev_b32 v62, 16, v191
v_and_b32 v63, 0xffff0000, v191
v_pk_add_f32 v[8:9], v[8:9], v[56:57]
v_pk_add_f32 v[10:11], v[10:11], v[58:59]
v_pk_add_f32 v[12:13], v[12:13], v[60:61]
v_pk_add_f32 v[14:15], v[14:15], v[62:63]
v_cvt_pk_bf16_f32 v160, v8, v9
v_cvt_pk_bf16_f32 v161, v10, v11
v_cvt_pk_bf16_f32 v162, v12, v13
v_cvt_pk_bf16_f32 v163, v14, v15
buffer_store_dwordx2 v[160:161], v3, s[60:63], s69 offen
buffer_store_dwordx2 v[162:163], v3, s[60:63], s69 offen offset:32
s_mul_i32 s68, s66, 3
s_add_u32 s68, s68, 2
s_lshr_b32 s69, s68, 3
s_mul_i32 s69, s69, 81920
s_bitcmp1_b32 s68, 0
s_cselect_b32 s73, 40960, 0
s_add_u32 s69, s69, s73
s_and_b32 s68, s68, 6
s_lshl_b32 s68, s68, 5
s_add_u32 s69, s69, s68
s_add_u32 s69, s69, s80
s_add_u32 s69, s69, 0
s_waitcnt vmcnt(9)
v_lshlrev_b32 v8, 16, v192
v_and_b32 v9, 0xffff0000, v192
v_lshlrev_b32 v10, 16, v193
v_and_b32 v11, 0xffff0000, v193
v_lshlrev_b32 v12, 16, v194
v_and_b32 v13, 0xffff0000, v194
v_lshlrev_b32 v14, 16, v195
v_and_b32 v15, 0xffff0000, v195
s_waitcnt vmcnt(8)
v_lshlrev_b32 v56, 16, v196
v_and_b32 v57, 0xffff0000, v196
v_lshlrev_b32 v58, 16, v197
v_and_b32 v59, 0xffff0000, v197
v_lshlrev_b32 v60, 16, v198
v_and_b32 v61, 0xffff0000, v198
v_lshlrev_b32 v62, 16, v199
v_and_b32 v63, 0xffff0000, v199
v_pk_add_f32 v[8:9], v[8:9], v[56:57]
v_pk_add_f32 v[10:11], v[10:11], v[58:59]
v_pk_add_f32 v[12:13], v[12:13], v[60:61]
v_pk_add_f32 v[14:15], v[14:15], v[62:63]
s_waitcnt vmcnt(7)
v_lshlrev_b32 v56, 16, v200
v_and_b32 v57, 0xffff0000, v200
v_lshlrev_b32 v58, 16, v201
v_and_b32 v59, 0xffff0000, v201
v_lshlrev_b32 v60, 16, v202
v_and_b32 v61, 0xffff0000, v202
v_lshlrev_b32 v62, 16, v203
v_and_b32 v63, 0xffff0000, v203
v_pk_add_f32 v[8:9], v[8:9], v[56:57]
v_pk_add_f32 v[10:11], v[10:11], v[58:59]
v_pk_add_f32 v[12:13], v[12:13], v[60:61]
v_pk_add_f32 v[14:15], v[14:15], v[62:63]
s_waitcnt vmcnt(6)
v_lshlrev_b32 v56, 16, v204
v_and_b32 v57, 0xffff0000, v204
v_lshlrev_b32 v58, 16, v205
v_and_b32 v59, 0xffff0000, v205
v_lshlrev_b32 v60, 16, v206
v_and_b32 v61, 0xffff0000, v206
v_lshlrev_b32 v62, 16, v207
v_and_b32 v63, 0xffff0000, v207
v_pk_add_f32 v[8:9], v[8:9], v[56:57]
v_pk_add_f32 v[10:11], v[10:11], v[58:59]
v_pk_add_f32 v[12:13], v[12:13], v[60:61]
v_pk_add_f32 v[14:15], v[14:15], v[62:63]
s_waitcnt vmcnt(5)
v_lshlrev_b32 v56, 16, v208
v_and_b32 v57, 0xffff0000, v208
v_lshlrev_b32 v58, 16, v209
v_and_b32 v59, 0xffff0000, v209
v_lshlrev_b32 v60, 16, v210
v_and_b32 v61, 0xffff0000, v210
v_lshlrev_b32 v62, 16, v211
v_and_b32 v63, 0xffff0000, v211
v_pk_add_f32 v[8:9], v[8:9], v[56:57]
v_pk_add_f32 v[10:11], v[10:11], v[58:59]
v_pk_add_f32 v[12:13], v[12:13], v[60:61]
v_pk_add_f32 v[14:15], v[14:15], v[62:63]
s_waitcnt vmcnt(4)
v_lshlrev_b32 v56, 16, v212
v_and_b32 v57, 0xffff0000, v212
v_lshlrev_b32 v58, 16, v213
v_and_b32 v59, 0xffff0000, v213
v_lshlrev_b32 v60, 16, v214
v_and_b32 v61, 0xffff0000, v214
v_lshlrev_b32 v62, 16, v215
v_and_b32 v63, 0xffff0000, v215
v_pk_add_f32 v[8:9], v[8:9], v[56:57]
v_pk_add_f32 v[10:11], v[10:11], v[58:59]
v_pk_add_f32 v[12:13], v[12:13], v[60:61]
v_pk_add_f32 v[14:15], v[14:15], v[62:63]
s_waitcnt vmcnt(3)
v_lshlrev_b32 v56, 16, v216
v_and_b32 v57, 0xffff0000, v216
v_lshlrev_b32 v58, 16, v217
v_and_b32 v59, 0xffff0000, v217
v_lshlrev_b32 v60, 16, v218
v_and_b32 v61, 0xffff0000, v218
v_lshlrev_b32 v62, 16, v219
v_and_b32 v63, 0xffff0000, v219
v_pk_add_f32 v[8:9], v[8:9], v[56:57]
v_pk_add_f32 v[10:11], v[10:11], v[58:59]
v_pk_add_f32 v[12:13], v[12:13], v[60:61]
v_pk_add_f32 v[14:15], v[14:15], v[62:63]
s_waitcnt vmcnt(2)
v_lshlrev_b32 v56, 16, v220
v_and_b32 v57, 0xffff0000, v220
v_lshlrev_b32 v58, 16, v221
v_and_b32 v59, 0xffff0000, v221
v_lshlrev_b32 v60, 16, v222
v_and_b32 v61, 0xffff0000, v222
v_lshlrev_b32 v62, 16, v223
v_and_b32 v63, 0xffff0000, v223
v_pk_add_f32 v[8:9], v[8:9], v[56:57]
v_pk_add_f32 v[10:11], v[10:11], v[58:59]
v_pk_add_f32 v[12:13], v[12:13], v[60:61]
v_pk_add_f32 v[14:15], v[14:15], v[62:63]
v_cvt_pk_bf16_f32 v192, v8, v9
v_cvt_pk_bf16_f32 v193, v10, v11
v_cvt_pk_bf16_f32 v194, v12, v13
v_cvt_pk_bf16_f32 v195, v14, v15
buffer_store_dwordx2 v[192:193], v3, s[60:63], s69 offen
buffer_store_dwordx2 v[194:195], v3, s[60:63], s69 offen offset:32
s_endpgm
L_shadow1:
s_setprio 0
v_mbcnt_lo_u32_b32 v4, -1, 0
v_mbcnt_hi_u32_b32 v4, -1, v4
s_lshl_b32 s88, s64, 4
s_add_u32 s88, s88, s65
s_mul_i32 s88, s88, 983040
s_mul_i32 s73, s66, 3072
s_add_u32 s88, s88, s73
v_lshlrev_b32 v2, 4, v4
v_and_b32 v3, 15, v4
v_mul_u32_u24 v3, 2560, v3
v_lshrrev_b32 v4, 4, v4
v_lshl_add_u32 v3, v4, 3, v3
s_mul_i32 s80, s65, 245760
s_mul_i32 s69, s64, 1280
s_add_u32 s80, s80, s69
s_lshl_b32 s79, s64, 4
s_add_u32 s79, s79, s65
s_lshl_b32 s99, s79, 7
s_add_u32 s99, s99, 131072
s_lshl_b32 s79, s79, 2
s_add_u32 s79, s79, 128
s_mov_b32 s74, 0
v_mov_b32 v6, 0
v_lshrrev_b32 v5, 2, v2
v_and_b32 v5, 28, v5
s_barrier
s_barrier
s_barrier
s_barrier
s_barrier
s_barrier
s_barrier
s_barrier
s_barrier
s_barrier
s_barrier
s_barrier
s_barrier
s_barrier
s_barrier
s_barrier
s_barrier
s_barrier
s_barrier
s_barrier
ds_write_b128 v1, v[112:115] offset:0
ds_write_b128 v1, v[116:119] offset:1024
ds_write_b128 v1, v[120:123] offset:2048
ds_write_b128 v1, v[124:127] offset:3072
ds_write_b128 v1, v[128:131] offset:4096
ds_write_b128 v1, v[132:135] offset:5120
ds_write_b128 v1, v[136:139] offset:6144
ds_write_b128 v1, v[140:143] offset:7168
ds_write_b128 v1, v[144:147] offset:8192
ds_write_b128 v1, v[148:151] offset:9216
ds_write_b128 v1, v[152:155] offset:10240
ds_write_b128 v1, v[156:159] offset:11264
s_waitcnt lgkmcnt(0)
s_barrier
s_barrier
s_barrier
s_waitcnt vmcnt(0)
s_barrier
L_shf1:
s_barrier
s_add_u32 s69, s88, 263168
buffer_load_dwordx4 v[160:163], v2, s[48:51], s69 offen sc1
s_add_u32 s69, s88, 386048
buffer_load_dwordx4 v[164:167], v2, s[48:51], s69 offen sc1
s_add_u32 s69, s88, 508928
buffer_load_dwordx4 v[168:171], v2, s[48:51], s69 offen sc1
s_add_u32 s69, s88, 631808
buffer_load_dwordx4 v[172:175], v2, s[48:51], s69 offen sc1
s_add_u32 s69, s88, 754688
buffer_load_dwordx4 v[176:179], v2, s[48:51], s69 offen sc1
s_add_u32 s69, s88, 877568
buffer_load_dwordx4 v[180:183], v2, s[48:51], s69 offen sc1
s_add_u32 s69, s88, 1000448
buffer_load_dwordx4 v[184:187], v2, s[48:51], s69 offen sc1
s_add_u32 s69, s88, 1123328
buffer_load_dwordx4 v[188:191], v2, s[48:51], s69 offen sc1
s_add_u32 s69, s88, 286720
buffer_load_dwordx4 v[192:195], v2, s[48:51], s69 offen sc1
s_add_u32 s69, s88, 409600
buffer_load_dwordx4 v[196:199], v2, s[48:51], s69 offen sc1
s_add_u32 s69, s88, 532480
buffer_load_dwordx4 v[200:203], v2, s[48:51], s69 offen sc1
s_add_u32 s69, s88, 655360
buffer_load_dwordx4 v[204:207], v2, s[48:51], s69 offen sc1
s_add_u32 s69, s88, 778240
buffer_load_dwordx4 v[208:211], v2, s[48:51], s69 offen sc1
s_add_u32 s69, s88, 901120
buffer_load_dwordx4 v[212:215], v2, s[48:51], s69 offen sc1
s_add_u32 s69, s88, 1024000
buffer_load_dwordx4 v[216:219], v2, s[48:51], s69 offen sc1
s_add_u32 s69, s88, 1146880
buffer_load_dwordx4 v[220:223], v2, s[48:51], s69 offen sc1
s_mul_i32 s68, s66, 3
s_add_u32 s68, s68, 1
s_lshr_b32 s69, s68, 3
s_mul_i32 s69, s69, 81920
s_bitcmp1_b32 s68, 0
s_cselect_b32 s73, 40960, 0
s_add_u32 s69, s69, s73
s_and_b32 s68, s68, 6
s_lshl_b32 s68, s68, 5
s_add_u32 s69, s69, s68
s_add_u32 s69, s69, s80
s_add_u32 s69, s69, 0
s_waitcnt vmcnt(15)
v_lshlrev_b32 v8, 16, v160
v_and_b32 v9, 0xffff0000, v160
v_lshlrev_b32 v10, 16, v161
v_and_b32 v11, 0xffff0000, v161
v_lshlrev_b32 v12, 16, v162
v_and_b32 v13, 0xffff0000, v162
v_lshlrev_b32 v14, 16, v163
v_and_b32 v15, 0xffff0000, v163
s_waitcnt vmcnt(14)
v_lshlrev_b32 v56, 16, v164
v_and_b32 v57, 0xffff0000, v164
v_lshlrev_b32 v58, 16, v165
v_and_b32 v59, 0xffff0000, v165
v_lshlrev_b32 v60, 16, v166
v_and_b32 v61, 0xffff0000, v166
v_lshlrev_b32 v62, 16, v167
v_and_b32 v63, 0xffff0000, v167
v_pk_add_f32 v[8:9], v[8:9], v[56:57]
v_pk_add_f32 v[10:11], v[10:11], v[58:59]
v_pk_add_f32 v[12:13], v[12:13], v[60:61]
v_pk_add_f32 v[14:15], v[14:15], v[62:63]
s_waitcnt vmcnt(13)
v_lshlrev_b32 v56, 16, v168
v_and_b32 v57, 0xffff0000, v168
v_lshlrev_b32 v58, 16, v169
v_and_b32 v59, 0xffff0000, v169
v_lshlrev_b32 v60, 16, v170
v_and_b32 v61, 0xffff0000, v170
v_lshlrev_b32 v62, 16, v171
v_and_b32 v63, 0xffff0000, v171
v_pk_add_f32 v[8:9], v[8:9], v[56:57]
v_pk_add_f32 v[10:11], v[10:11], v[58:59]
v_pk_add_f32 v[12:13], v[12:13], v[60:61]
v_pk_add_f32 v[14:15], v[14:15], v[62:63]
s_waitcnt vmcnt(12)
v_lshlrev_b32 v56, 16, v172
v_and_b32 v57, 0xffff0000, v172
v_lshlrev_b32 v58, 16, v173
v_and_b32 v59, 0xffff0000, v173
v_lshlrev_b32 v60, 16, v174
v_and_b32 v61, 0xffff0000, v174
v_lshlrev_b32 v62, 16, v175
v_and_b32 v63, 0xffff0000, v175
v_pk_add_f32 v[8:9], v[8:9], v[56:57]
v_pk_add_f32 v[10:11], v[10:11], v[58:59]
v_pk_add_f32 v[12:13], v[12:13], v[60:61]
v_pk_add_f32 v[14:15], v[14:15], v[62:63]
s_waitcnt vmcnt(11)
v_lshlrev_b32 v56, 16, v176
v_and_b32 v57, 0xffff0000, v176
v_lshlrev_b32 v58, 16, v177
v_and_b32 v59, 0xffff0000, v177
v_lshlrev_b32 v60, 16, v178
v_and_b32 v61, 0xffff0000, v178
v_lshlrev_b32 v62, 16, v179
v_and_b32 v63, 0xffff0000, v179
v_pk_add_f32 v[8:9], v[8:9], v[56:57]
v_pk_add_f32 v[10:11], v[10:11], v[58:59]
v_pk_add_f32 v[12:13], v[12:13], v[60:61]
v_pk_add_f32 v[14:15], v[14:15], v[62:63]
s_waitcnt vmcnt(10)
v_lshlrev_b32 v56, 16, v180
v_and_b32 v57, 0xffff0000, v180
v_lshlrev_b32 v58, 16, v181
v_and_b32 v59, 0xffff0000, v181
v_lshlrev_b32 v60, 16, v182
v_and_b32 v61, 0xffff0000, v182
v_lshlrev_b32 v62, 16, v183
v_and_b32 v63, 0xffff0000, v183
v_pk_add_f32 v[8:9], v[8:9], v[56:57]
v_pk_add_f32 v[10:11], v[10:11], v[58:59]
v_pk_add_f32 v[12:13], v[12:13], v[60:61]
v_pk_add_f32 v[14:15], v[14:15], v[62:63]
s_waitcnt vmcnt(9)
v_lshlrev_b32 v56, 16, v184
v_and_b32 v57, 0xffff0000, v184
v_lshlrev_b32 v58, 16, v185
v_and_b32 v59, 0xffff0000, v185
v_lshlrev_b32 v60, 16, v186
v_and_b32 v61, 0xffff0000, v186
v_lshlrev_b32 v62, 16, v187
v_and_b32 v63, 0xffff0000, v187
v_pk_add_f32 v[8:9], v[8:9], v[56:57]
v_pk_add_f32 v[10:11], v[10:11], v[58:59]
v_pk_add_f32 v[12:13], v[12:13], v[60:61]
v_pk_add_f32 v[14:15], v[14:15], v[62:63]
s_waitcnt vmcnt(8)
v_lshlrev_b32 v56, 16, v188
v_and_b32 v57, 0xffff0000, v188
v_lshlrev_b32 v58, 16, v189
v_and_b32 v59, 0xffff0000, v189
v_lshlrev_b32 v60, 16, v190
v_and_b32 v61, 0xffff0000, v190
v_lshlrev_b32 v62, 16, v191
v_and_b32 v63, 0xffff0000, v191
v_pk_add_f32 v[8:9], v[8:9], v[56:57]
v_pk_add_f32 v[10:11], v[10:11], v[58:59]
v_pk_add_f32 v[12:13], v[12:13], v[60:61]
v_pk_add_f32 v[14:15], v[14:15], v[62:63]
v_cvt_pk_bf16_f32 v160, v8, v9
v_cvt_pk_bf16_f32 v161, v10, v11
v_cvt_pk_bf16_f32 v162, v12, v13
v_cvt_pk_bf16_f32 v163, v14, v15
buffer_store_dwordx2 v[160:161], v3, s[60:63], s69 offen
buffer_store_dwordx2 v[162:163], v3, s[60:63], s69 offen offset:32
s_mul_i32 s68, s66, 3
s_add_u32 s68, s68, 0
s_lshr_b32 s69, s68, 3
s_mul_i32 s69, s69, 81920
s_bitcmp1_b32 s68, 0
s_cselect_b32 s73, 40960, 0
s_add_u32 s69, s69, s73
s_and_b32 s68, s68, 6
s_lshl_b32 s68, s68, 5
s_add_u32 s69, s69, s68
s_add_u32 s69, s69, s80
s_add_u32 s69, s69, 256
s_waitcnt vmcnt(9)
v_lshlrev_b32 v8, 16, v192
v_and_b32 v9, 0xffff0000, v192
v_lshlrev_b32 v10, 16, v193
v_and_b32 v11, 0xffff0000, v193
v_lshlrev_b32 v12, 16, v194
v_and_b32 v13, 0xffff0000, v194
v_lshlrev_b32 v14, 16, v195
v_and_b32 v15, 0xffff0000, v195
s_waitcnt vmcnt(8)
v_lshlrev_b32 v56, 16, v196
v_and_b32 v57, 0xffff0000, v196
v_lshlrev_b32 v58, 16, v197
v_and_b32 v59, 0xffff0000, v197
v_lshlrev_b32 v60, 16, v198
v_and_b32 v61, 0xffff0000, v198
v_lshlrev_b32 v62, 16, v199
v_and_b32 v63, 0xffff0000, v199
v_pk_add_f32 v[8:9], v[8:9], v[56:57]
v_pk_add_f32 v[10:11], v[10:11], v[58:59]
v_pk_add_f32 v[12:13], v[12:13], v[60:61]
v_pk_add_f32 v[14:15], v[14:15], v[62:63]
s_waitcnt vmcnt(7)
v_lshlrev_b32 v56, 16, v200
v_and_b32 v57, 0xffff0000, v200
v_lshlrev_b32 v58, 16, v201
v_and_b32 v59, 0xffff0000, v201
v_lshlrev_b32 v60, 16, v202
v_and_b32 v61, 0xffff0000, v202
v_lshlrev_b32 v62, 16, v203
v_and_b32 v63, 0xffff0000, v203
v_pk_add_f32 v[8:9], v[8:9], v[56:57]
v_pk_add_f32 v[10:11], v[10:11], v[58:59]
v_pk_add_f32 v[12:13], v[12:13], v[60:61]
v_pk_add_f32 v[14:15], v[14:15], v[62:63]
s_waitcnt vmcnt(6)
v_lshlrev_b32 v56, 16, v204
v_and_b32 v57, 0xffff0000, v204
v_lshlrev_b32 v58, 16, v205
v_and_b32 v59, 0xffff0000, v205
v_lshlrev_b32 v60, 16, v206
v_and_b32 v61, 0xffff0000, v206
v_lshlrev_b32 v62, 16, v207
v_and_b32 v63, 0xffff0000, v207
v_pk_add_f32 v[8:9], v[8:9], v[56:57]
v_pk_add_f32 v[10:11], v[10:11], v[58:59]
v_pk_add_f32 v[12:13], v[12:13], v[60:61]
v_pk_add_f32 v[14:15], v[14:15], v[62:63]
s_waitcnt vmcnt(5)
v_lshlrev_b32 v56, 16, v208
v_and_b32 v57, 0xffff0000, v208
v_lshlrev_b32 v58, 16, v209
v_and_b32 v59, 0xffff0000, v209
v_lshlrev_b32 v60, 16, v210
v_and_b32 v61, 0xffff0000, v210
v_lshlrev_b32 v62, 16, v211
v_and_b32 v63, 0xffff0000, v211
v_pk_add_f32 v[8:9], v[8:9], v[56:57]
v_pk_add_f32 v[10:11], v[10:11], v[58:59]
v_pk_add_f32 v[12:13], v[12:13], v[60:61]
v_pk_add_f32 v[14:15], v[14:15], v[62:63]
s_waitcnt vmcnt(4)
v_lshlrev_b32 v56, 16, v212
v_and_b32 v57, 0xffff0000, v212
v_lshlrev_b32 v58, 16, v213
v_and_b32 v59, 0xffff0000, v213
v_lshlrev_b32 v60, 16, v214
v_and_b32 v61, 0xffff0000, v214
v_lshlrev_b32 v62, 16, v215
v_and_b32 v63, 0xffff0000, v215
v_pk_add_f32 v[8:9], v[8:9], v[56:57]
v_pk_add_f32 v[10:11], v[10:11], v[58:59]
v_pk_add_f32 v[12:13], v[12:13], v[60:61]
v_pk_add_f32 v[14:15], v[14:15], v[62:63]
s_waitcnt vmcnt(3)
v_lshlrev_b32 v56, 16, v216
v_and_b32 v57, 0xffff0000, v216
v_lshlrev_b32 v58, 16, v217
v_and_b32 v59, 0xffff0000, v217
v_lshlrev_b32 v60, 16, v218
v_and_b32 v61, 0xffff0000, v218
v_lshlrev_b32 v62, 16, v219
v_and_b32 v63, 0xffff0000, v219
v_pk_add_f32 v[8:9], v[8:9], v[56:57]
v_pk_add_f32 v[10:11], v[10:11], v[58:59]
v_pk_add_f32 v[12:13], v[12:13], v[60:61]
v_pk_add_f32 v[14:15], v[14:15], v[62:63]
s_waitcnt vmcnt(2)
v_lshlrev_b32 v56, 16, v220
v_and_b32 v57, 0xffff0000, v220
v_lshlrev_b32 v58, 16, v221
v_and_b32 v59, 0xffff0000, v221
v_lshlrev_b32 v60, 16, v222
v_and_b32 v61, 0xffff0000, v222
v_lshlrev_b32 v62, 16, v223
v_and_b32 v63, 0xffff0000, v223
v_pk_add_f32 v[8:9], v[8:9], v[56:57]
v_pk_add_f32 v[10:11], v[10:11], v[58:59]
v_pk_add_f32 v[12:13], v[12:13], v[60:61]
v_pk_add_f32 v[14:15], v[14:15], v[62:63]
v_cvt_pk_bf16_f32 v192, v8, v9
v_cvt_pk_bf16_f32 v193, v10, v11
v_cvt_pk_bf16_f32 v194, v12, v13
v_cvt_pk_bf16_f32 v195, v14, v15
buffer_store_dwordx2 v[192:193], v3, s[60:63], s69 offen
buffer_store_dwordx2 v[194:195], v3, s[60:63], s69 offen offset:32
s_endpgm
L_reduce:
v_mbcnt_lo_u32_b32 v4, -1, 0
v_mbcnt_hi_u32_b32 v4, -1, v4
s_lshl_b32 s88, s64, 4
s_add_u32 s88, s88, s65
s_mul_i32 s88, s88, 983040
s_mul_i32 s73, s66, 3072
s_add_u32 s88, s88, s73
v_lshlrev_b32 v2, 4, v4
v_and_b32 v3, 15, v4
v_mul_u32_u24 v3, 2560, v3
v_lshrrev_b32 v4, 4, v4
v_lshl_add_u32 v3, v4, 3, v3
s_mul_i32 s80, s65, 245760
s_mul_i32 s69, s64, 1280
s_add_u32 s80, s80, s69
s_waitcnt vmcnt(0)
s_barrier
s_cmp_eq_u32 s67, 0
s_cbranch_scc1 L_red0
s_cmp_eq_u32 s67, 1
s_cbranch_scc1 L_red1
s_cmp_eq_u32 s67, 2
s_cbranch_scc1 L_red2
s_cmp_eq_u32 s67, 4
s_cbranch_scc1 L_red4
s_cmp_eq_u32 s67, 7
s_cbranch_scc1 L_red7
s_cmp_eq_u32 s67, 3
s_cbranch_scc1 L_red3
L_red0:
s_barrier
s_add_u32 s69, s88, 311296
buffer_load_dwordx4 v[160:163], v2, s[48:51], s69 offen sc1
s_add_u32 s69, s88, 434176
buffer_load_dwordx4 v[164:167], v2, s[48:51], s69 offen sc1
s_add_u32 s69, s88, 557056
buffer_load_dwordx4 v[168:171], v2, s[48:51], s69 offen sc1
s_add_u32 s69, s88, 679936
buffer_load_dwordx4 v[172:175], v2, s[48:51], s69 offen sc1
s_add_u32 s69, s88, 802816
buffer_load_dwordx4 v[176:179], v2, s[48:51], s69 offen sc1
s_add_u32 s69, s88, 925696
buffer_load_dwordx4 v[180:183], v2, s[48:51], s69 offen sc1
s_add_u32 s69, s88, 1048576
buffer_load_dwordx4 v[184:187], v2, s[48:51], s69 offen sc1
s_add_u32 s69, s88, 1171456
buffer_load_dwordx4 v[188:191], v2, s[48:51], s69 offen sc1
s_add_u32 s69, s88, 362496
buffer_load_dwordx4 v[192:195], v2, s[48:51], s69 offen sc1
s_add_u32 s69, s88, 485376
buffer_load_dwordx4 v[196:199], v2, s[48:51], s69 offen sc1
s_add_u32 s69, s88, 608256
buffer_load_dwordx4 v[200:203], v2, s[48:51], s69 offen sc1
s_add_u32 s69, s88, 731136
buffer_load_dwordx4 v[204:207], v2, s[48:51], s69 offen sc1
s_add_u32 s69, s88, 854016
buffer_load_dwordx4 v[208:211], v2, s[48:51], s69 offen sc1
s_add_u32 s69, s88, 976896
buffer_load_dwordx4 v[212:215], v2, s[48:51], s69 offen sc1
s_add_u32 s69, s88, 1099776
buffer_load_dwordx4 v[216:219], v2, s[48:51], s69 offen sc1
s_add_u32 s69, s88, 1222656
buffer_load_dwordx4 v[220:223], v2, s[48:51], s69 offen sc1
s_mul_i32 s68, s66, 3
s_add_u32 s68, s68, 0
s_lshr_b32 s69, s68, 3
s_mul_i32 s69, s69, 81920
s_bitcmp1_b32 s68, 0
s_cselect_b32 s73, 40960, 0
s_add_u32 s69, s69, s73
s_and_b32 s68, s68, 6
s_lshl_b32 s68, s68, 5
s_add_u32 s69, s69, s68
s_add_u32 s69, s69, s80
s_add_u32 s69, s69, 512
s_waitcnt vmcnt(15)
v_lshlrev_b32 v8, 16, v160
v_and_b32 v9, 0xffff0000, v160
v_lshlrev_b32 v10, 16, v161
v_and_b32 v11, 0xffff0000, v161
v_lshlrev_b32 v12, 16, v162
v_and_b32 v13, 0xffff0000, v162
v_lshlrev_b32 v14, 16, v163
v_and_b32 v15, 0xffff0000, v163
s_waitcnt vmcnt(14)
v_lshlrev_b32 v56, 16, v164
v_and_b32 v57, 0xffff0000, v164
v_lshlrev_b32 v58, 16, v165
v_and_b32 v59, 0xffff0000, v165
v_lshlrev_b32 v60, 16, v166
v_and_b32 v61, 0xffff0000, v166
v_lshlrev_b32 v62, 16, v167
v_and_b32 v63, 0xffff0000, v167
v_pk_add_f32 v[8:9], v[8:9], v[56:57]
v_pk_add_f32 v[10:11], v[10:11], v[58:59]
v_pk_add_f32 v[12:13], v[12:13], v[60:61]
v_pk_add_f32 v[14:15], v[14:15], v[62:63]
s_waitcnt vmcnt(13)
v_lshlrev_b32 v56, 16, v168
v_and_b32 v57, 0xffff0000, v168
v_lshlrev_b32 v58, 16, v169
v_and_b32 v59, 0xffff0000, v169
v_lshlrev_b32 v60, 16, v170
v_and_b32 v61, 0xffff0000, v170
v_lshlrev_b32 v62, 16, v171
v_and_b32 v63, 0xffff0000, v171
v_pk_add_f32 v[8:9], v[8:9], v[56:57]
v_pk_add_f32 v[10:11], v[10:11], v[58:59]
v_pk_add_f32 v[12:13], v[12:13], v[60:61]
v_pk_add_f32 v[14:15], v[14:15], v[62:63]
s_waitcnt vmcnt(12)
v_lshlrev_b32 v56, 16, v172
v_and_b32 v57, 0xffff0000, v172
v_lshlrev_b32 v58, 16, v173
v_and_b32 v59, 0xffff0000, v173
v_lshlrev_b32 v60, 16, v174
v_and_b32 v61, 0xffff0000, v174
v_lshlrev_b32 v62, 16, v175
v_and_b32 v63, 0xffff0000, v175
v_pk_add_f32 v[8:9], v[8:9], v[56:57]
v_pk_add_f32 v[10:11], v[10:11], v[58:59]
v_pk_add_f32 v[12:13], v[12:13], v[60:61]
v_pk_add_f32 v[14:15], v[14:15], v[62:63]
s_waitcnt vmcnt(11)
v_lshlrev_b32 v56, 16, v176
v_and_b32 v57, 0xffff0000, v176
v_lshlrev_b32 v58, 16, v177
v_and_b32 v59, 0xffff0000, v177
v_lshlrev_b32 v60, 16, v178
v_and_b32 v61, 0xffff0000, v178
v_lshlrev_b32 v62, 16, v179
v_and_b32 v63, 0xffff0000, v179
v_pk_add_f32 v[8:9], v[8:9], v[56:57]
v_pk_add_f32 v[10:11], v[10:11], v[58:59]
v_pk_add_f32 v[12:13], v[12:13], v[60:61]
v_pk_add_f32 v[14:15], v[14:15], v[62:63]
s_waitcnt vmcnt(10)
v_lshlrev_b32 v56, 16, v180
v_and_b32 v57, 0xffff0000, v180
v_lshlrev_b32 v58, 16, v181
v_and_b32 v59, 0xffff0000, v181
v_lshlrev_b32 v60, 16, v182
v_and_b32 v61, 0xffff0000, v182
v_lshlrev_b32 v62, 16, v183
v_and_b32 v63, 0xffff0000, v183
v_pk_add_f32 v[8:9], v[8:9], v[56:57]
v_pk_add_f32 v[10:11], v[10:11], v[58:59]
v_pk_add_f32 v[12:13], v[12:13], v[60:61]
v_pk_add_f32 v[14:15], v[14:15], v[62:63]
s_waitcnt vmcnt(9)
v_lshlrev_b32 v56, 16, v184
v_and_b32 v57, 0xffff0000, v184
v_lshlrev_b32 v58, 16, v185
v_and_b32 v59, 0xffff0000, v185
v_lshlrev_b32 v60, 16, v186
v_and_b32 v61, 0xffff0000, v186
v_lshlrev_b32 v62, 16, v187
v_and_b32 v63, 0xffff0000, v187
v_pk_add_f32 v[8:9], v[8:9], v[56:57]
v_pk_add_f32 v[10:11], v[10:11], v[58:59]
v_pk_add_f32 v[12:13], v[12:13], v[60:61]
v_pk_add_f32 v[14:15], v[14:15], v[62:63]
s_waitcnt vmcnt(8)
v_lshlrev_b32 v56, 16, v188
v_and_b32 v57, 0xffff0000, v188
v_lshlrev_b32 v58, 16, v189
v_and_b32 v59, 0xffff0000, v189
v_lshlrev_b32 v60, 16, v190
v_and_b32 v61, 0xffff0000, v190
v_lshlrev_b32 v62, 16, v191
v_and_b32 v63, 0xffff0000, v191
v_pk_add_f32 v[8:9], v[8:9], v[56:57]
v_pk_add_f32 v[10:11], v[10:11], v[58:59]
v_pk_add_f32 v[12:13], v[12:13], v[60:61]
v_pk_add_f32 v[14:15], v[14:15], v[62:63]
v_cvt_pk_bf16_f32 v160, v8, v9
v_cvt_pk_bf16_f32 v161, v10, v11
v_cvt_pk_bf16_f32 v162, v12, v13
v_cvt_pk_bf16_f32 v163, v14, v15
buffer_store_dwordx2 v[160:161], v3, s[60:63], s69 offen
buffer_store_dwordx2 v[162:163], v3, s[60:63], s69 offen offset:32
s_mul_i32 s68, s66, 3
s_add_u32 s68, s68, 2
s_lshr_b32 s69, s68, 3
s_mul_i32 s69, s69, 81920
s_bitcmp1_b32 s68, 0
s_cselect_b32 s73, 40960, 0
s_add_u32 s69, s69, s73
s_and_b32 s68, s68, 6
s_lshl_b32 s68, s68, 5
s_add_u32 s69, s69, s68
s_add_u32 s69, s69, s80
s_add_u32 s69, s69, 1024
s_waitcnt vmcnt(9)
v_lshlrev_b32 v8, 16, v192
v_and_b32 v9, 0xffff0000, v192
v_lshlrev_b32 v10, 16, v193
v_and_b32 v11, 0xffff0000, v193
v_lshlrev_b32 v12, 16, v194
v_and_b32 v13, 0xffff0000, v194
v_lshlrev_b32 v14, 16, v195
v_and_b32 v15, 0xffff0000, v195
s_waitcnt vmcnt(8)
v_lshlrev_b32 v56, 16, v196
v_and_b32 v57, 0xffff0000, v196
v_lshlrev_b32 v58, 16, v197
v_and_b32 v59, 0xffff0000, v197
v_lshlrev_b32 v60, 16, v198
v_and_b32 v61, 0xffff0000, v198
v_lshlrev_b32 v62, 16, v199
v_and_b32 v63, 0xffff0000, v199
v_pk_add_f32 v[8:9], v[8:9], v[56:57]
v_pk_add_f32 v[10:11], v[10:11], v[58:59]
v_pk_add_f32 v[12:13], v[12:13], v[60:61]
v_pk_add_f32 v[14:15], v[14:15], v[62:63]
s_waitcnt vmcnt(7)
v_lshlrev_b32 v56, 16, v200
v_and_b32 v57, 0xffff0000, v200
v_lshlrev_b32 v58, 16, v201
v_and_b32 v59, 0xffff0000, v201
v_lshlrev_b32 v60, 16, v202
v_and_b32 v61, 0xffff0000, v202
v_lshlrev_b32 v62, 16, v203
v_and_b32 v63, 0xffff0000, v203
v_pk_add_f32 v[8:9], v[8:9], v[56:57]
v_pk_add_f32 v[10:11], v[10:11], v[58:59]
v_pk_add_f32 v[12:13], v[12:13], v[60:61]
v_pk_add_f32 v[14:15], v[14:15], v[62:63]
s_waitcnt vmcnt(6)
v_lshlrev_b32 v56, 16, v204
v_and_b32 v57, 0xffff0000, v204
v_lshlrev_b32 v58, 16, v205
v_and_b32 v59, 0xffff0000, v205
v_lshlrev_b32 v60, 16, v206
v_and_b32 v61, 0xffff0000, v206
v_lshlrev_b32 v62, 16, v207
v_and_b32 v63, 0xffff0000, v207
v_pk_add_f32 v[8:9], v[8:9], v[56:57]
v_pk_add_f32 v[10:11], v[10:11], v[58:59]
v_pk_add_f32 v[12:13], v[12:13], v[60:61]
v_pk_add_f32 v[14:15], v[14:15], v[62:63]
s_waitcnt vmcnt(5)
v_lshlrev_b32 v56, 16, v208
v_and_b32 v57, 0xffff0000, v208
v_lshlrev_b32 v58, 16, v209
v_and_b32 v59, 0xffff0000, v209
v_lshlrev_b32 v60, 16, v210
v_and_b32 v61, 0xffff0000, v210
v_lshlrev_b32 v62, 16, v211
v_and_b32 v63, 0xffff0000, v211
v_pk_add_f32 v[8:9], v[8:9], v[56:57]
v_pk_add_f32 v[10:11], v[10:11], v[58:59]
v_pk_add_f32 v[12:13], v[12:13], v[60:61]
v_pk_add_f32 v[14:15], v[14:15], v[62:63]
s_waitcnt vmcnt(4)
v_lshlrev_b32 v56, 16, v212
v_and_b32 v57, 0xffff0000, v212
v_lshlrev_b32 v58, 16, v213
v_and_b32 v59, 0xffff0000, v213
v_lshlrev_b32 v60, 16, v214
v_and_b32 v61, 0xffff0000, v214
v_lshlrev_b32 v62, 16, v215
v_and_b32 v63, 0xffff0000, v215
v_pk_add_f32 v[8:9], v[8:9], v[56:57]
v_pk_add_f32 v[10:11], v[10:11], v[58:59]
v_pk_add_f32 v[12:13], v[12:13], v[60:61]
v_pk_add_f32 v[14:15], v[14:15], v[62:63]
s_waitcnt vmcnt(3)
v_lshlrev_b32 v56, 16, v216
v_and_b32 v57, 0xffff0000, v216
v_lshlrev_b32 v58, 16, v217
v_and_b32 v59, 0xffff0000, v217
v_lshlrev_b32 v60, 16, v218
v_and_b32 v61, 0xffff0000, v218
v_lshlrev_b32 v62, 16, v219
v_and_b32 v63, 0xffff0000, v219
v_pk_add_f32 v[8:9], v[8:9], v[56:57]
v_pk_add_f32 v[10:11], v[10:11], v[58:59]
v_pk_add_f32 v[12:13], v[12:13], v[60:61]
v_pk_add_f32 v[14:15], v[14:15], v[62:63]
s_waitcnt vmcnt(2)
v_lshlrev_b32 v56, 16, v220
v_and_b32 v57, 0xffff0000, v220
v_lshlrev_b32 v58, 16, v221
v_and_b32 v59, 0xffff0000, v221
v_lshlrev_b32 v60, 16, v222
v_and_b32 v61, 0xffff0000, v222
v_lshlrev_b32 v62, 16, v223
v_and_b32 v63, 0xffff0000, v223
v_pk_add_f32 v[8:9], v[8:9], v[56:57]
v_pk_add_f32 v[10:11], v[10:11], v[58:59]
v_pk_add_f32 v[12:13], v[12:13], v[60:61]
v_pk_add_f32 v[14:15], v[14:15], v[62:63]
v_cvt_pk_bf16_f32 v192, v8, v9
v_cvt_pk_bf16_f32 v193, v10, v11
v_cvt_pk_bf16_f32 v194, v12, v13
v_cvt_pk_bf16_f32 v195, v14, v15
buffer_store_dwordx2 v[192:193], v3, s[60:63], s69 offen
buffer_store_dwordx2 v[194:195], v3, s[60:63], s69 offen offset:32
s_endpgm
L_red1:
s_barrier
s_add_u32 s69, s88, 312320
buffer_load_dwordx4 v[160:163], v2, s[48:51], s69 offen sc1
s_add_u32 s69, s88, 435200
buffer_load_dwordx4 v[164:167], v2, s[48:51], s69 offen sc1
s_add_u32 s69, s88, 558080
buffer_load_dwordx4 v[168:171], v2, s[48:51], s69 offen sc1
s_add_u32 s69, s88, 680960
buffer_load_dwordx4 v[172:175], v2, s[48:51], s69 offen sc1
s_add_u32 s69, s88, 803840
buffer_load_dwordx4 v[176:179], v2, s[48:51], s69 offen sc1
s_add_u32 s69, s88, 926720
buffer_load_dwordx4 v[180:183], v2, s[48:51], s69 offen sc1
s_add_u32 s69, s88, 1049600
buffer_load_dwordx4 v[184:187], v2, s[48:51], s69 offen sc1
s_add_u32 s69, s88, 1172480
buffer_load_dwordx4 v[188:191], v2, s[48:51], s69 offen sc1
s_add_u32 s69, s88, 361472
buffer_load_dwordx4 v[192:195], v2, s[48:51], s69 offen sc1
s_add_u32 s69, s88, 484352
buffer_load_dwordx4 v[196:199], v2, s[48:51], s69 offen sc1
s_add_u32 s69, s88, 607232
buffer_load_dwordx4 v[200:203], v2, s[48:51], s69 offen sc1
s_add_u32 s69, s88, 730112
buffer_load_dwordx4 v[204:207], v2, s[48:51], s69 offen sc1
s_add_u32 s69, s88, 852992
buffer_load_dwordx4 v[208:211], v2, s[48:51], s69 offen sc1
s_add_u32 s69, s88, 975872
buffer_load_dwordx4 v[212:215], v2, s[48:51], s69 offen sc1
s_add_u32 s69, s88, 1098752
buffer_load_dwordx4 v[216:219], v2, s[48:51], s69 offen sc1
s_add_u32 s69, s88, 1221632
buffer_load_dwordx4 v[220:223], v2, s[48:51], s69 offen sc1
s_mul_i32 s68, s66, 3
s_add_u32 s68, s68, 1
s_lshr_b32 s69, s68, 3
s_mul_i32 s69, s69, 81920
s_bitcmp1_b32 s68, 0
s_cselect_b32 s73, 40960, 0
s_add_u32 s69, s69, s73
s_and_b32 s68, s68, 6
s_lshl_b32 s68, s68, 5
s_add_u32 s69, s69, s68
s_add_u32 s69, s69, s80
s_add_u32 s69, s69, 512
s_waitcnt vmcnt(15)
v_lshlrev_b32 v8, 16, v160
v_and_b32 v9, 0xffff0000, v160
v_lshlrev_b32 v10, 16, v161
v_and_b32 v11, 0xffff0000, v161
v_lshlrev_b32 v12, 16, v162
v_and_b32 v13, 0xffff0000, v162
v_lshlrev_b32 v14, 16, v163
v_and_b32 v15, 0xffff0000, v163
s_waitcnt vmcnt(14)
v_lshlrev_b32 v56, 16, v164
v_and_b32 v57, 0xffff0000, v164
v_lshlrev_b32 v58, 16, v165
v_and_b32 v59, 0xffff0000, v165
v_lshlrev_b32 v60, 16, v166
v_and_b32 v61, 0xffff0000, v166
v_lshlrev_b32 v62, 16, v167
v_and_b32 v63, 0xffff0000, v167
v_pk_add_f32 v[8:9], v[8:9], v[56:57]
v_pk_add_f32 v[10:11], v[10:11], v[58:59]
v_pk_add_f32 v[12:13], v[12:13], v[60:61]
v_pk_add_f32 v[14:15], v[14:15], v[62:63]
s_waitcnt vmcnt(13)
v_lshlrev_b32 v56, 16, v168
v_and_b32 v57, 0xffff0000, v168
v_lshlrev_b32 v58, 16, v169
v_and_b32 v59, 0xffff0000, v169
v_lshlrev_b32 v60, 16, v170
v_and_b32 v61, 0xffff0000, v170
v_lshlrev_b32 v62, 16, v171
v_and_b32 v63, 0xffff0000, v171
v_pk_add_f32 v[8:9], v[8:9], v[56:57]
v_pk_add_f32 v[10:11], v[10:11], v[58:59]
v_pk_add_f32 v[12:13], v[12:13], v[60:61]
v_pk_add_f32 v[14:15], v[14:15], v[62:63]
s_waitcnt vmcnt(12)
v_lshlrev_b32 v56, 16, v172
v_and_b32 v57, 0xffff0000, v172
v_lshlrev_b32 v58, 16, v173
v_and_b32 v59, 0xffff0000, v173
v_lshlrev_b32 v60, 16, v174
v_and_b32 v61, 0xffff0000, v174
v_lshlrev_b32 v62, 16, v175
v_and_b32 v63, 0xffff0000, v175
v_pk_add_f32 v[8:9], v[8:9], v[56:57]
v_pk_add_f32 v[10:11], v[10:11], v[58:59]
v_pk_add_f32 v[12:13], v[12:13], v[60:61]
v_pk_add_f32 v[14:15], v[14:15], v[62:63]
s_waitcnt vmcnt(11)
v_lshlrev_b32 v56, 16, v176
v_and_b32 v57, 0xffff0000, v176
v_lshlrev_b32 v58, 16, v177
v_and_b32 v59, 0xffff0000, v177
v_lshlrev_b32 v60, 16, v178
v_and_b32 v61, 0xffff0000, v178
v_lshlrev_b32 v62, 16, v179
v_and_b32 v63, 0xffff0000, v179
v_pk_add_f32 v[8:9], v[8:9], v[56:57]
v_pk_add_f32 v[10:11], v[10:11], v[58:59]
v_pk_add_f32 v[12:13], v[12:13], v[60:61]
v_pk_add_f32 v[14:15], v[14:15], v[62:63]
s_waitcnt vmcnt(10)
v_lshlrev_b32 v56, 16, v180
v_and_b32 v57, 0xffff0000, v180
v_lshlrev_b32 v58, 16, v181
v_and_b32 v59, 0xffff0000, v181
v_lshlrev_b32 v60, 16, v182
v_and_b32 v61, 0xffff0000, v182
v_lshlrev_b32 v62, 16, v183
v_and_b32 v63, 0xffff0000, v183
v_pk_add_f32 v[8:9], v[8:9], v[56:57]
v_pk_add_f32 v[10:11], v[10:11], v[58:59]
v_pk_add_f32 v[12:13], v[12:13], v[60:61]
v_pk_add_f32 v[14:15], v[14:15], v[62:63]
s_waitcnt vmcnt(9)
v_lshlrev_b32 v56, 16, v184
v_and_b32 v57, 0xffff0000, v184
v_lshlrev_b32 v58, 16, v185
v_and_b32 v59, 0xffff0000, v185
v_lshlrev_b32 v60, 16, v186
v_and_b32 v61, 0xffff0000, v186
v_lshlrev_b32 v62, 16, v187
v_and_b32 v63, 0xffff0000, v187
v_pk_add_f32 v[8:9], v[8:9], v[56:57]
v_pk_add_f32 v[10:11], v[10:11], v[58:59]
v_pk_add_f32 v[12:13], v[12:13], v[60:61]
v_pk_add_f32 v[14:15], v[14:15], v[62:63]
s_waitcnt vmcnt(8)
v_lshlrev_b32 v56, 16, v188
v_and_b32 v57, 0xffff0000, v188
v_lshlrev_b32 v58, 16, v189
v_and_b32 v59, 0xffff0000, v189
v_lshlrev_b32 v60, 16, v190
v_and_b32 v61, 0xffff0000, v190
v_lshlrev_b32 v62, 16, v191
v_and_b32 v63, 0xffff0000, v191
v_pk_add_f32 v[8:9], v[8:9], v[56:57]
v_pk_add_f32 v[10:11], v[10:11], v[58:59]
v_pk_add_f32 v[12:13], v[12:13], v[60:61]
v_pk_add_f32 v[14:15], v[14:15], v[62:63]
v_cvt_pk_bf16_f32 v160, v8, v9
v_cvt_pk_bf16_f32 v161, v10, v11
v_cvt_pk_bf16_f32 v162, v12, v13
v_cvt_pk_bf16_f32 v163, v14, v15
buffer_store_dwordx2 v[160:161], v3, s[60:63], s69 offen
buffer_store_dwordx2 v[162:163], v3, s[60:63], s69 offen offset:32
s_mul_i32 s68, s66, 3
s_add_u32 s68, s68, 1
s_lshr_b32 s69, s68, 3
s_mul_i32 s69, s69, 81920
s_bitcmp1_b32 s68, 0
s_cselect_b32 s73, 40960, 0
s_add_u32 s69, s69, s73
s_and_b32 s68, s68, 6
s_lshl_b32 s68, s68, 5
s_add_u32 s69, s69, s68
s_add_u32 s69, s69, s80
s_add_u32 s69, s69, 1024
s_waitcnt vmcnt(9)
v_lshlrev_b32 v8, 16, v192
v_and_b32 v9, 0xffff0000, v192
v_lshlrev_b32 v10, 16, v193
v_and_b32 v11, 0xffff0000, v193
v_lshlrev_b32 v12, 16, v194
v_and_b32 v13, 0xffff0000, v194
v_lshlrev_b32 v14, 16, v195
v_and_b32 v15, 0xffff0000, v195
s_waitcnt vmcnt(8)
v_lshlrev_b32 v56, 16, v196
v_and_b32 v57, 0xffff0000, v196
v_lshlrev_b32 v58, 16, v197
v_and_b32 v59, 0xffff0000, v197
v_lshlrev_b32 v60, 16, v198
v_and_b32 v61, 0xffff0000, v198
v_lshlrev_b32 v62, 16, v199
v_and_b32 v63, 0xffff0000, v199
v_pk_add_f32 v[8:9], v[8:9], v[56:57]
v_pk_add_f32 v[10:11], v[10:11], v[58:59]
v_pk_add_f32 v[12:13], v[12:13], v[60:61]
v_pk_add_f32 v[14:15], v[14:15], v[62:63]
s_waitcnt vmcnt(7)
v_lshlrev_b32 v56, 16, v200
v_and_b32 v57, 0xffff0000, v200
v_lshlrev_b32 v58, 16, v201
v_and_b32 v59, 0xffff0000, v201
v_lshlrev_b32 v60, 16, v202
v_and_b32 v61, 0xffff0000, v202
v_lshlrev_b32 v62, 16, v203
v_and_b32 v63, 0xffff0000, v203
v_pk_add_f32 v[8:9], v[8:9], v[56:57]
v_pk_add_f32 v[10:11], v[10:11], v[58:59]
v_pk_add_f32 v[12:13], v[12:13], v[60:61]
v_pk_add_f32 v[14:15], v[14:15], v[62:63]
s_waitcnt vmcnt(6)
v_lshlrev_b32 v56, 16, v204
v_and_b32 v57, 0xffff0000, v204
v_lshlrev_b32 v58, 16, v205
v_and_b32 v59, 0xffff0000, v205
v_lshlrev_b32 v60, 16, v206
v_and_b32 v61, 0xffff0000, v206
v_lshlrev_b32 v62, 16, v207
v_and_b32 v63, 0xffff0000, v207
v_pk_add_f32 v[8:9], v[8:9], v[56:57]
v_pk_add_f32 v[10:11], v[10:11], v[58:59]
v_pk_add_f32 v[12:13], v[12:13], v[60:61]
v_pk_add_f32 v[14:15], v[14:15], v[62:63]
s_waitcnt vmcnt(5)
v_lshlrev_b32 v56, 16, v208
v_and_b32 v57, 0xffff0000, v208
v_lshlrev_b32 v58, 16, v209
v_and_b32 v59, 0xffff0000, v209
v_lshlrev_b32 v60, 16, v210
v_and_b32 v61, 0xffff0000, v210
v_lshlrev_b32 v62, 16, v211
v_and_b32 v63, 0xffff0000, v211
v_pk_add_f32 v[8:9], v[8:9], v[56:57]
v_pk_add_f32 v[10:11], v[10:11], v[58:59]
v_pk_add_f32 v[12:13], v[12:13], v[60:61]
v_pk_add_f32 v[14:15], v[14:15], v[62:63]
s_waitcnt vmcnt(4)
v_lshlrev_b32 v56, 16, v212
v_and_b32 v57, 0xffff0000, v212
v_lshlrev_b32 v58, 16, v213
v_and_b32 v59, 0xffff0000, v213
v_lshlrev_b32 v60, 16, v214
v_and_b32 v61, 0xffff0000, v214
v_lshlrev_b32 v62, 16, v215
v_and_b32 v63, 0xffff0000, v215
v_pk_add_f32 v[8:9], v[8:9], v[56:57]
v_pk_add_f32 v[10:11], v[10:11], v[58:59]
v_pk_add_f32 v[12:13], v[12:13], v[60:61]
v_pk_add_f32 v[14:15], v[14:15], v[62:63]
s_waitcnt vmcnt(3)
v_lshlrev_b32 v56, 16, v216
v_and_b32 v57, 0xffff0000, v216
v_lshlrev_b32 v58, 16, v217
v_and_b32 v59, 0xffff0000, v217
v_lshlrev_b32 v60, 16, v218
v_and_b32 v61, 0xffff0000, v218
v_lshlrev_b32 v62, 16, v219
v_and_b32 v63, 0xffff0000, v219
v_pk_add_f32 v[8:9], v[8:9], v[56:57]
v_pk_add_f32 v[10:11], v[10:11], v[58:59]
v_pk_add_f32 v[12:13], v[12:13], v[60:61]
v_pk_add_f32 v[14:15], v[14:15], v[62:63]
s_waitcnt vmcnt(2)
v_lshlrev_b32 v56, 16, v220
v_and_b32 v57, 0xffff0000, v220
v_lshlrev_b32 v58, 16, v221
v_and_b32 v59, 0xffff0000, v221
v_lshlrev_b32 v60, 16, v222
v_and_b32 v61, 0xffff0000, v222
v_lshlrev_b32 v62, 16, v223
v_and_b32 v63, 0xffff0000, v223
v_pk_add_f32 v[8:9], v[8:9], v[56:57]
v_pk_add_f32 v[10:11], v[10:11], v[58:59]
v_pk_add_f32 v[12:13], v[12:13], v[60:61]
v_pk_add_f32 v[14:15], v[14:15], v[62:63]
v_cvt_pk_bf16_f32 v192, v8, v9
v_cvt_pk_bf16_f32 v193, v10, v11
v_cvt_pk_bf16_f32 v194, v12, v13
v_cvt_pk_bf16_f32 v195, v14, v15
buffer_store_dwordx2 v[192:193], v3, s[60:63], s69 offen
buffer_store_dwordx2 v[194:195], v3, s[60:63], s69 offen offset:32
s_endpgm
L_red2:
s_barrier
s_add_u32 s69, s88, 313344
buffer_load_dwordx4 v[160:163], v2, s[48:51], s69 offen sc1
s_add_u32 s69, s88, 436224
buffer_load_dwordx4 v[164:167], v2, s[48:51], s69 offen sc1
s_add_u32 s69, s88, 559104
buffer_load_dwordx4 v[168:171], v2, s[48:51], s69 offen sc1
s_add_u32 s69, s88, 681984
buffer_load_dwordx4 v[172:175], v2, s[48:51], s69 offen sc1
s_add_u32 s69, s88, 804864
buffer_load_dwordx4 v[176:179], v2, s[48:51], s69 offen sc1
s_add_u32 s69, s88, 927744
buffer_load_dwordx4 v[180:183], v2, s[48:51], s69 offen sc1
s_add_u32 s69, s88, 1050624
buffer_load_dwordx4 v[184:187], v2, s[48:51], s69 offen sc1
s_add_u32 s69, s88, 1173504
buffer_load_dwordx4 v[188:191], v2, s[48:51], s69 offen sc1
s_add_u32 s69, s88, 360448
buffer_load_dwordx4 v[192:195], v2, s[48:51], s69 offen sc1
s_add_u32 s69, s88, 483328
buffer_load_dwordx4 v[196:199], v2, s[48:51], s69 offen sc1
s_add_u32 s69, s88, 606208
buffer_load_dwordx4 v[200:203], v2, s[48:51], s69 offen sc1
s_add_u32 s69, s88, 729088
buffer_load_dwordx4 v[204:207], v2, s[48:51], s69 offen sc1
s_add_u32 s69, s88, 851968
buffer_load_dwordx4 v[208:211], v2, s[48:51], s69 offen sc1
s_add_u32 s69, s88, 974848
buffer_load_dwordx4 v[212:215], v2, s[48:51], s69 offen sc1
s_add_u32 s69, s88, 1097728
buffer_load_dwordx4 v[216:219], v2, s[48:51], s69 offen sc1
s_add_u32 s69, s88, 1220608
buffer_load_dwordx4 v[220:223], v2, s[48:51], s69 offen sc1
s_mul_i32 s68, s66, 3
s_add_u32 s68, s68, 2
s_lshr_b32 s69, s68, 3
s_mul_i32 s69, s69, 81920
s_bitcmp1_b32 s68, 0
s_cselect_b32 s73, 40960, 0
s_add_u32 s69, s69, s73
s_and_b32 s68, s68, 6
s_lshl_b32 s68, s68, 5
s_add_u32 s69, s69, s68
s_add_u32 s69, s69, s80
s_add_u32 s69, s69, 512
s_waitcnt vmcnt(15)
v_lshlrev_b32 v8, 16, v160
v_and_b32 v9, 0xffff0000, v160
v_lshlrev_b32 v10, 16, v161
v_and_b32 v11, 0xffff0000, v161
v_lshlrev_b32 v12, 16, v162
v_and_b32 v13, 0xffff0000, v162
v_lshlrev_b32 v14, 16, v163
v_and_b32 v15, 0xffff0000, v163
s_waitcnt vmcnt(14)
v_lshlrev_b32 v56, 16, v164
v_and_b32 v57, 0xffff0000, v164
v_lshlrev_b32 v58, 16, v165
v_and_b32 v59, 0xffff0000, v165
v_lshlrev_b32 v60, 16, v166
v_and_b32 v61, 0xffff0000, v166
v_lshlrev_b32 v62, 16, v167
v_and_b32 v63, 0xffff0000, v167
v_pk_add_f32 v[8:9], v[8:9], v[56:57]
v_pk_add_f32 v[10:11], v[10:11], v[58:59]
v_pk_add_f32 v[12:13], v[12:13], v[60:61]
v_pk_add_f32 v[14:15], v[14:15], v[62:63]
s_waitcnt vmcnt(13)
v_lshlrev_b32 v56, 16, v168
v_and_b32 v57, 0xffff0000, v168
v_lshlrev_b32 v58, 16, v169
v_and_b32 v59, 0xffff0000, v169
v_lshlrev_b32 v60, 16, v170
v_and_b32 v61, 0xffff0000, v170
v_lshlrev_b32 v62, 16, v171
v_and_b32 v63, 0xffff0000, v171
v_pk_add_f32 v[8:9], v[8:9], v[56:57]
v_pk_add_f32 v[10:11], v[10:11], v[58:59]
v_pk_add_f32 v[12:13], v[12:13], v[60:61]
v_pk_add_f32 v[14:15], v[14:15], v[62:63]
s_waitcnt vmcnt(12)
v_lshlrev_b32 v56, 16, v172
v_and_b32 v57, 0xffff0000, v172
v_lshlrev_b32 v58, 16, v173
v_and_b32 v59, 0xffff0000, v173
v_lshlrev_b32 v60, 16, v174
v_and_b32 v61, 0xffff0000, v174
v_lshlrev_b32 v62, 16, v175
v_and_b32 v63, 0xffff0000, v175
v_pk_add_f32 v[8:9], v[8:9], v[56:57]
v_pk_add_f32 v[10:11], v[10:11], v[58:59]
v_pk_add_f32 v[12:13], v[12:13], v[60:61]
v_pk_add_f32 v[14:15], v[14:15], v[62:63]
s_waitcnt vmcnt(11)
v_lshlrev_b32 v56, 16, v176
v_and_b32 v57, 0xffff0000, v176
v_lshlrev_b32 v58, 16, v177
v_and_b32 v59, 0xffff0000, v177
v_lshlrev_b32 v60, 16, v178
v_and_b32 v61, 0xffff0000, v178
v_lshlrev_b32 v62, 16, v179
v_and_b32 v63, 0xffff0000, v179
v_pk_add_f32 v[8:9], v[8:9], v[56:57]
v_pk_add_f32 v[10:11], v[10:11], v[58:59]
v_pk_add_f32 v[12:13], v[12:13], v[60:61]
v_pk_add_f32 v[14:15], v[14:15], v[62:63]
s_waitcnt vmcnt(10)
v_lshlrev_b32 v56, 16, v180
v_and_b32 v57, 0xffff0000, v180
v_lshlrev_b32 v58, 16, v181
v_and_b32 v59, 0xffff0000, v181
v_lshlrev_b32 v60, 16, v182
v_and_b32 v61, 0xffff0000, v182
v_lshlrev_b32 v62, 16, v183
v_and_b32 v63, 0xffff0000, v183
v_pk_add_f32 v[8:9], v[8:9], v[56:57]
v_pk_add_f32 v[10:11], v[10:11], v[58:59]
v_pk_add_f32 v[12:13], v[12:13], v[60:61]
v_pk_add_f32 v[14:15], v[14:15], v[62:63]
s_waitcnt vmcnt(9)
v_lshlrev_b32 v56, 16, v184
v_and_b32 v57, 0xffff0000, v184
v_lshlrev_b32 v58, 16, v185
v_and_b32 v59, 0xffff0000, v185
v_lshlrev_b32 v60, 16, v186
v_and_b32 v61, 0xffff0000, v186
v_lshlrev_b32 v62, 16, v187
v_and_b32 v63, 0xffff0000, v187
v_pk_add_f32 v[8:9], v[8:9], v[56:57]
v_pk_add_f32 v[10:11], v[10:11], v[58:59]
v_pk_add_f32 v[12:13], v[12:13], v[60:61]
v_pk_add_f32 v[14:15], v[14:15], v[62:63]
s_waitcnt vmcnt(8)
v_lshlrev_b32 v56, 16, v188
v_and_b32 v57, 0xffff0000, v188
v_lshlrev_b32 v58, 16, v189
v_and_b32 v59, 0xffff0000, v189
v_lshlrev_b32 v60, 16, v190
v_and_b32 v61, 0xffff0000, v190
v_lshlrev_b32 v62, 16, v191
v_and_b32 v63, 0xffff0000, v191
v_pk_add_f32 v[8:9], v[8:9], v[56:57]
v_pk_add_f32 v[10:11], v[10:11], v[58:59]
v_pk_add_f32 v[12:13], v[12:13], v[60:61]
v_pk_add_f32 v[14:15], v[14:15], v[62:63]
v_cvt_pk_bf16_f32 v160, v8, v9
v_cvt_pk_bf16_f32 v161, v10, v11
v_cvt_pk_bf16_f32 v162, v12, v13
v_cvt_pk_bf16_f32 v163, v14, v15
buffer_store_dwordx2 v[160:161], v3, s[60:63], s69 offen
buffer_store_dwordx2 v[162:163], v3, s[60:63], s69 offen offset:32
s_mul_i32 s68, s66, 3
s_add_u32 s68, s68, 0
s_lshr_b32 s69, s68, 3
s_mul_i32 s69, s69, 81920
s_bitcmp1_b32 s68, 0
s_cselect_b32 s73, 40960, 0
s_add_u32 s69, s69, s73
s_and_b32 s68, s68, 6
s_lshl_b32 s68, s68, 5
s_add_u32 s69, s69, s68
s_add_u32 s69, s69, s80
s_add_u32 s69, s69, 1024
s_waitcnt vmcnt(9)
v_lshlrev_b32 v8, 16, v192
v_and_b32 v9, 0xffff0000, v192
v_lshlrev_b32 v10, 16, v193
v_and_b32 v11, 0xffff0000, v193
v_lshlrev_b32 v12, 16, v194
v_and_b32 v13, 0xffff0000, v194
v_lshlrev_b32 v14, 16, v195
v_and_b32 v15, 0xffff0000, v195
s_waitcnt vmcnt(8)
v_lshlrev_b32 v56, 16, v196
v_and_b32 v57, 0xffff0000, v196
v_lshlrev_b32 v58, 16, v197
v_and_b32 v59, 0xffff0000, v197
v_lshlrev_b32 v60, 16, v198
v_and_b32 v61, 0xffff0000, v198
v_lshlrev_b32 v62, 16, v199
v_and_b32 v63, 0xffff0000, v199
v_pk_add_f32 v[8:9], v[8:9], v[56:57]
v_pk_add_f32 v[10:11], v[10:11], v[58:59]
v_pk_add_f32 v[12:13], v[12:13], v[60:61]
v_pk_add_f32 v[14:15], v[14:15], v[62:63]
s_waitcnt vmcnt(7)
v_lshlrev_b32 v56, 16, v200
v_and_b32 v57, 0xffff0000, v200
v_lshlrev_b32 v58, 16, v201
v_and_b32 v59, 0xffff0000, v201
v_lshlrev_b32 v60, 16, v202
v_and_b32 v61, 0xffff0000, v202
v_lshlrev_b32 v62, 16, v203
v_and_b32 v63, 0xffff0000, v203
v_pk_add_f32 v[8:9], v[8:9], v[56:57]
v_pk_add_f32 v[10:11], v[10:11], v[58:59]
v_pk_add_f32 v[12:13], v[12:13], v[60:61]
v_pk_add_f32 v[14:15], v[14:15], v[62:63]
s_waitcnt vmcnt(6)
v_lshlrev_b32 v56, 16, v204
v_and_b32 v57, 0xffff0000, v204
v_lshlrev_b32 v58, 16, v205
v_and_b32 v59, 0xffff0000, v205
v_lshlrev_b32 v60, 16, v206
v_and_b32 v61, 0xffff0000, v206
v_lshlrev_b32 v62, 16, v207
v_and_b32 v63, 0xffff0000, v207
v_pk_add_f32 v[8:9], v[8:9], v[56:57]
v_pk_add_f32 v[10:11], v[10:11], v[58:59]
v_pk_add_f32 v[12:13], v[12:13], v[60:61]
v_pk_add_f32 v[14:15], v[14:15], v[62:63]
s_waitcnt vmcnt(5)
v_lshlrev_b32 v56, 16, v208
v_and_b32 v57, 0xffff0000, v208
v_lshlrev_b32 v58, 16, v209
v_and_b32 v59, 0xffff0000, v209
v_lshlrev_b32 v60, 16, v210
v_and_b32 v61, 0xffff0000, v210
v_lshlrev_b32 v62, 16, v211
v_and_b32 v63, 0xffff0000, v211
v_pk_add_f32 v[8:9], v[8:9], v[56:57]
v_pk_add_f32 v[10:11], v[10:11], v[58:59]
v_pk_add_f32 v[12:13], v[12:13], v[60:61]
v_pk_add_f32 v[14:15], v[14:15], v[62:63]
s_waitcnt vmcnt(4)
v_lshlrev_b32 v56, 16, v212
v_and_b32 v57, 0xffff0000, v212
v_lshlrev_b32 v58, 16, v213
v_and_b32 v59, 0xffff0000, v213
v_lshlrev_b32 v60, 16, v214
v_and_b32 v61, 0xffff0000, v214
v_lshlrev_b32 v62, 16, v215
v_and_b32 v63, 0xffff0000, v215
v_pk_add_f32 v[8:9], v[8:9], v[56:57]
v_pk_add_f32 v[10:11], v[10:11], v[58:59]
v_pk_add_f32 v[12:13], v[12:13], v[60:61]
v_pk_add_f32 v[14:15], v[14:15], v[62:63]
s_waitcnt vmcnt(3)
v_lshlrev_b32 v56, 16, v216
v_and_b32 v57, 0xffff0000, v216
v_lshlrev_b32 v58, 16, v217
v_and_b32 v59, 0xffff0000, v217
v_lshlrev_b32 v60, 16, v218
v_and_b32 v61, 0xffff0000, v218
v_lshlrev_b32 v62, 16, v219
v_and_b32 v63, 0xffff0000, v219
v_pk_add_f32 v[8:9], v[8:9], v[56:57]
v_pk_add_f32 v[10:11], v[10:11], v[58:59]
v_pk_add_f32 v[12:13], v[12:13], v[60:61]
v_pk_add_f32 v[14:15], v[14:15], v[62:63]
s_waitcnt vmcnt(2)
v_lshlrev_b32 v56, 16, v220
v_and_b32 v57, 0xffff0000, v220
v_lshlrev_b32 v58, 16, v221
v_and_b32 v59, 0xffff0000, v221
v_lshlrev_b32 v60, 16, v222
v_and_b32 v61, 0xffff0000, v222
v_lshlrev_b32 v62, 16, v223
v_and_b32 v63, 0xffff0000, v223
v_pk_add_f32 v[8:9], v[8:9], v[56:57]
v_pk_add_f32 v[10:11], v[10:11], v[58:59]
v_pk_add_f32 v[12:13], v[12:13], v[60:61]
v_pk_add_f32 v[14:15], v[14:15], v[62:63]
v_cvt_pk_bf16_f32 v192, v8, v9
v_cvt_pk_bf16_f32 v193, v10, v11
v_cvt_pk_bf16_f32 v194, v12, v13
v_cvt_pk_bf16_f32 v195, v14, v15
buffer_store_dwordx2 v[192:193], v3, s[60:63], s69 offen
buffer_store_dwordx2 v[194:195], v3, s[60:63], s69 offen offset:32
s_endpgm
L_red4:
s_barrier
s_add_u32 s69, s88, 335872
buffer_load_dwordx4 v[160:163], v2, s[48:51], s69 offen sc1
s_add_u32 s69, s88, 458752
buffer_load_dwordx4 v[164:167], v2, s[48:51], s69 offen sc1
s_add_u32 s69, s88, 581632
buffer_load_dwordx4 v[168:171], v2, s[48:51], s69 offen sc1
s_add_u32 s69, s88, 704512
buffer_load_dwordx4 v[172:175], v2, s[48:51], s69 offen sc1
s_add_u32 s69, s88, 827392
buffer_load_dwordx4 v[176:179], v2, s[48:51], s69 offen sc1
s_add_u32 s69, s88, 950272
buffer_load_dwordx4 v[180:183], v2, s[48:51], s69 offen sc1
s_add_u32 s69, s88, 1073152
buffer_load_dwordx4 v[184:187], v2, s[48:51], s69 offen sc1
s_add_u32 s69, s88, 1196032
buffer_load_dwordx4 v[188:191], v2, s[48:51], s69 offen sc1
s_add_u32 s69, s88, 287744
buffer_load_dwordx4 v[192:195], v2, s[48:51], s69 offen sc1
s_add_u32 s69, s88, 410624
buffer_load_dwordx4 v[196:199], v2, s[48:51], s69 offen sc1
s_add_u32 s69, s88, 533504
buffer_load_dwordx4 v[200:203], v2, s[48:51], s69 offen sc1
s_add_u32 s69, s88, 656384
buffer_load_dwordx4 v[204:207], v2, s[48:51], s69 offen sc1
s_add_u32 s69, s88, 779264
buffer_load_dwordx4 v[208:211], v2, s[48:51], s69 offen sc1
s_add_u32 s69, s88, 902144
buffer_load_dwordx4 v[212:215], v2, s[48:51], s69 offen sc1
s_add_u32 s69, s88, 1025024
buffer_load_dwordx4 v[216:219], v2, s[48:51], s69 offen sc1
s_add_u32 s69, s88, 1147904
buffer_load_dwordx4 v[220:223], v2, s[48:51], s69 offen sc1
s_mul_i32 s68, s66, 3
s_add_u32 s68, s68, 0
s_lshr_b32 s69, s68, 3
s_mul_i32 s69, s69, 81920
s_bitcmp1_b32 s68, 0
s_cselect_b32 s73, 40960, 0
s_add_u32 s69, s69, s73
s_and_b32 s68, s68, 6
s_lshl_b32 s68, s68, 5
s_add_u32 s69, s69, s68
s_add_u32 s69, s69, s80
s_add_u32 s69, s69, 768
s_waitcnt vmcnt(15)
v_lshlrev_b32 v8, 16, v160
v_and_b32 v9, 0xffff0000, v160
v_lshlrev_b32 v10, 16, v161
v_and_b32 v11, 0xffff0000, v161
v_lshlrev_b32 v12, 16, v162
v_and_b32 v13, 0xffff0000, v162
v_lshlrev_b32 v14, 16, v163
v_and_b32 v15, 0xffff0000, v163
s_waitcnt vmcnt(14)
v_lshlrev_b32 v56, 16, v164
v_and_b32 v57, 0xffff0000, v164
v_lshlrev_b32 v58, 16, v165
v_and_b32 v59, 0xffff0000, v165
v_lshlrev_b32 v60, 16, v166
v_and_b32 v61, 0xffff0000, v166
v_lshlrev_b32 v62, 16, v167
v_and_b32 v63, 0xffff0000, v167
v_pk_add_f32 v[8:9], v[8:9], v[56:57]
v_pk_add_f32 v[10:11], v[10:11], v[58:59]
v_pk_add_f32 v[12:13], v[12:13], v[60:61]
v_pk_add_f32 v[14:15], v[14:15], v[62:63]
s_waitcnt vmcnt(13)
v_lshlrev_b32 v56, 16, v168
v_and_b32 v57, 0xffff0000, v168
v_lshlrev_b32 v58, 16, v169
v_and_b32 v59, 0xffff0000, v169
v_lshlrev_b32 v60, 16, v170
v_and_b32 v61, 0xffff0000, v170
v_lshlrev_b32 v62, 16, v171
v_and_b32 v63, 0xffff0000, v171
v_pk_add_f32 v[8:9], v[8:9], v[56:57]
v_pk_add_f32 v[10:11], v[10:11], v[58:59]
v_pk_add_f32 v[12:13], v[12:13], v[60:61]
v_pk_add_f32 v[14:15], v[14:15], v[62:63]
s_waitcnt vmcnt(12)
v_lshlrev_b32 v56, 16, v172
v_and_b32 v57, 0xffff0000, v172
v_lshlrev_b32 v58, 16, v173
v_and_b32 v59, 0xffff0000, v173
v_lshlrev_b32 v60, 16, v174
v_and_b32 v61, 0xffff0000, v174
v_lshlrev_b32 v62, 16, v175
v_and_b32 v63, 0xffff0000, v175
v_pk_add_f32 v[8:9], v[8:9], v[56:57]
v_pk_add_f32 v[10:11], v[10:11], v[58:59]
v_pk_add_f32 v[12:13], v[12:13], v[60:61]
v_pk_add_f32 v[14:15], v[14:15], v[62:63]
s_waitcnt vmcnt(11)
v_lshlrev_b32 v56, 16, v176
v_and_b32 v57, 0xffff0000, v176
v_lshlrev_b32 v58, 16, v177
v_and_b32 v59, 0xffff0000, v177
v_lshlrev_b32 v60, 16, v178
v_and_b32 v61, 0xffff0000, v178
v_lshlrev_b32 v62, 16, v179
v_and_b32 v63, 0xffff0000, v179
v_pk_add_f32 v[8:9], v[8:9], v[56:57]
v_pk_add_f32 v[10:11], v[10:11], v[58:59]
v_pk_add_f32 v[12:13], v[12:13], v[60:61]
v_pk_add_f32 v[14:15], v[14:15], v[62:63]
s_waitcnt vmcnt(10)
v_lshlrev_b32 v56, 16, v180
v_and_b32 v57, 0xffff0000, v180
v_lshlrev_b32 v58, 16, v181
v_and_b32 v59, 0xffff0000, v181
v_lshlrev_b32 v60, 16, v182
v_and_b32 v61, 0xffff0000, v182
v_lshlrev_b32 v62, 16, v183
v_and_b32 v63, 0xffff0000, v183
v_pk_add_f32 v[8:9], v[8:9], v[56:57]
v_pk_add_f32 v[10:11], v[10:11], v[58:59]
v_pk_add_f32 v[12:13], v[12:13], v[60:61]
v_pk_add_f32 v[14:15], v[14:15], v[62:63]
s_waitcnt vmcnt(9)
v_lshlrev_b32 v56, 16, v184
v_and_b32 v57, 0xffff0000, v184
v_lshlrev_b32 v58, 16, v185
v_and_b32 v59, 0xffff0000, v185
v_lshlrev_b32 v60, 16, v186
v_and_b32 v61, 0xffff0000, v186
v_lshlrev_b32 v62, 16, v187
v_and_b32 v63, 0xffff0000, v187
v_pk_add_f32 v[8:9], v[8:9], v[56:57]
v_pk_add_f32 v[10:11], v[10:11], v[58:59]
v_pk_add_f32 v[12:13], v[12:13], v[60:61]
v_pk_add_f32 v[14:15], v[14:15], v[62:63]
s_waitcnt vmcnt(8)
v_lshlrev_b32 v56, 16, v188
v_and_b32 v57, 0xffff0000, v188
v_lshlrev_b32 v58, 16, v189
v_and_b32 v59, 0xffff0000, v189
v_lshlrev_b32 v60, 16, v190
v_and_b32 v61, 0xffff0000, v190
v_lshlrev_b32 v62, 16, v191
v_and_b32 v63, 0xffff0000, v191
v_pk_add_f32 v[8:9], v[8:9], v[56:57]
v_pk_add_f32 v[10:11], v[10:11], v[58:59]
v_pk_add_f32 v[12:13], v[12:13], v[60:61]
v_pk_add_f32 v[14:15], v[14:15], v[62:63]
v_cvt_pk_bf16_f32 v160, v8, v9
v_cvt_pk_bf16_f32 v161, v10, v11
v_cvt_pk_bf16_f32 v162, v12, v13
v_cvt_pk_bf16_f32 v163, v14, v15
buffer_store_dwordx2 v[160:161], v3, s[60:63], s69 offen
buffer_store_dwordx2 v[162:163], v3, s[60:63], s69 offen offset:32
s_mul_i32 s68, s66, 3
s_add_u32 s68, s68, 1
s_lshr_b32 s69, s68, 3
s_mul_i32 s69, s69, 81920
s_bitcmp1_b32 s68, 0
s_cselect_b32 s73, 40960, 0
s_add_u32 s69, s69, s73
s_and_b32 s68, s68, 6
s_lshl_b32 s68, s68, 5
s_add_u32 s69, s69, s68
s_add_u32 s69, s69, s80
s_add_u32 s69, s69, 256
s_waitcnt vmcnt(9)
v_lshlrev_b32 v8, 16, v192
v_and_b32 v9, 0xffff0000, v192
v_lshlrev_b32 v10, 16, v193
v_and_b32 v11, 0xffff0000, v193
v_lshlrev_b32 v12, 16, v194
v_and_b32 v13, 0xffff0000, v194
v_lshlrev_b32 v14, 16, v195
v_and_b32 v15, 0xffff0000, v195
s_waitcnt vmcnt(8)
v_lshlrev_b32 v56, 16, v196
v_and_b32 v57, 0xffff0000, v196
v_lshlrev_b32 v58, 16, v197
v_and_b32 v59, 0xffff0000, v197
v_lshlrev_b32 v60, 16, v198
v_and_b32 v61, 0xffff0000, v198
v_lshlrev_b32 v62, 16, v199
v_and_b32 v63, 0xffff0000, v199
v_pk_add_f32 v[8:9], v[8:9], v[56:57]
v_pk_add_f32 v[10:11], v[10:11], v[58:59]
v_pk_add_f32 v[12:13], v[12:13], v[60:61]
v_pk_add_f32 v[14:15], v[14:15], v[62:63]
s_waitcnt vmcnt(7)
v_lshlrev_b32 v56, 16, v200
v_and_b32 v57, 0xffff0000, v200
v_lshlrev_b32 v58, 16, v201
v_and_b32 v59, 0xffff0000, v201
v_lshlrev_b32 v60, 16, v202
v_and_b32 v61, 0xffff0000, v202
v_lshlrev_b32 v62, 16, v203
v_and_b32 v63, 0xffff0000, v203
v_pk_add_f32 v[8:9], v[8:9], v[56:57]
v_pk_add_f32 v[10:11], v[10:11], v[58:59]
v_pk_add_f32 v[12:13], v[12:13], v[60:61]
v_pk_add_f32 v[14:15], v[14:15], v[62:63]
s_waitcnt vmcnt(6)
v_lshlrev_b32 v56, 16, v204
v_and_b32 v57, 0xffff0000, v204
v_lshlrev_b32 v58, 16, v205
v_and_b32 v59, 0xffff0000, v205
v_lshlrev_b32 v60, 16, v206
v_and_b32 v61, 0xffff0000, v206
v_lshlrev_b32 v62, 16, v207
v_and_b32 v63, 0xffff0000, v207
v_pk_add_f32 v[8:9], v[8:9], v[56:57]
v_pk_add_f32 v[10:11], v[10:11], v[58:59]
v_pk_add_f32 v[12:13], v[12:13], v[60:61]
v_pk_add_f32 v[14:15], v[14:15], v[62:63]
s_waitcnt vmcnt(5)
v_lshlrev_b32 v56, 16, v208
v_and_b32 v57, 0xffff0000, v208
v_lshlrev_b32 v58, 16, v209
v_and_b32 v59, 0xffff0000, v209
v_lshlrev_b32 v60, 16, v210
v_and_b32 v61, 0xffff0000, v210
v_lshlrev_b32 v62, 16, v211
v_and_b32 v63, 0xffff0000, v211
v_pk_add_f32 v[8:9], v[8:9], v[56:57]
v_pk_add_f32 v[10:11], v[10:11], v[58:59]
v_pk_add_f32 v[12:13], v[12:13], v[60:61]
v_pk_add_f32 v[14:15], v[14:15], v[62:63]
s_waitcnt vmcnt(4)
v_lshlrev_b32 v56, 16, v212
v_and_b32 v57, 0xffff0000, v212
v_lshlrev_b32 v58, 16, v213
v_and_b32 v59, 0xffff0000, v213
v_lshlrev_b32 v60, 16, v214
v_and_b32 v61, 0xffff0000, v214
v_lshlrev_b32 v62, 16, v215
v_and_b32 v63, 0xffff0000, v215
v_pk_add_f32 v[8:9], v[8:9], v[56:57]
v_pk_add_f32 v[10:11], v[10:11], v[58:59]
v_pk_add_f32 v[12:13], v[12:13], v[60:61]
v_pk_add_f32 v[14:15], v[14:15], v[62:63]
s_waitcnt vmcnt(3)
v_lshlrev_b32 v56, 16, v216
v_and_b32 v57, 0xffff0000, v216
v_lshlrev_b32 v58, 16, v217
v_and_b32 v59, 0xffff0000, v217
v_lshlrev_b32 v60, 16, v218
v_and_b32 v61, 0xffff0000, v218
v_lshlrev_b32 v62, 16, v219
v_and_b32 v63, 0xffff0000, v219
v_pk_add_f32 v[8:9], v[8:9], v[56:57]
v_pk_add_f32 v[10:11], v[10:11], v[58:59]
v_pk_add_f32 v[12:13], v[12:13], v[60:61]
v_pk_add_f32 v[14:15], v[14:15], v[62:63]
s_waitcnt vmcnt(2)
v_lshlrev_b32 v56, 16, v220
v_and_b32 v57, 0xffff0000, v220
v_lshlrev_b32 v58, 16, v221
v_and_b32 v59, 0xffff0000, v221
v_lshlrev_b32 v60, 16, v222
v_and_b32 v61, 0xffff0000, v222
v_lshlrev_b32 v62, 16, v223
v_and_b32 v63, 0xffff0000, v223
v_pk_add_f32 v[8:9], v[8:9], v[56:57]
v_pk_add_f32 v[10:11], v[10:11], v[58:59]
v_pk_add_f32 v[12:13], v[12:13], v[60:61]
v_pk_add_f32 v[14:15], v[14:15], v[62:63]
v_cvt_pk_bf16_f32 v192, v8, v9
v_cvt_pk_bf16_f32 v193, v10, v11
v_cvt_pk_bf16_f32 v194, v12, v13
v_cvt_pk_bf16_f32 v195, v14, v15
buffer_store_dwordx2 v[192:193], v3, s[60:63], s69 offen
buffer_store_dwordx2 v[194:195], v3, s[60:63], s69 offen offset:32
s_endpgm
L_red7:
s_barrier
s_add_u32 s69, s88, 336896
buffer_load_dwordx4 v[160:163], v2, s[48:51], s69 offen sc1
s_add_u32 s69, s88, 459776
buffer_load_dwordx4 v[164:167], v2, s[48:51], s69 offen sc1
s_add_u32 s69, s88, 582656
buffer_load_dwordx4 v[168:171], v2, s[48:51], s69 offen sc1
s_add_u32 s69, s88, 705536
buffer_load_dwordx4 v[172:175], v2, s[48:51], s69 offen sc1
s_add_u32 s69, s88, 828416
buffer_load_dwordx4 v[176:179], v2, s[48:51], s69 offen sc1
s_add_u32 s69, s88, 951296
buffer_load_dwordx4 v[180:183], v2, s[48:51], s69 offen sc1
s_add_u32 s69, s88, 1074176
buffer_load_dwordx4 v[184:187], v2, s[48:51], s69 offen sc1
s_add_u32 s69, s88, 1197056
buffer_load_dwordx4 v[188:191], v2, s[48:51], s69 offen sc1
s_add_u32 s69, s88, 288768
buffer_load_dwordx4 v[192:195], v2, s[48:51], s69 offen sc1
s_add_u32 s69, s88, 411648
buffer_load_dwordx4 v[196:199], v2, s[48:51], s69 offen sc1
s_add_u32 s69, s88, 534528
buffer_load_dwordx4 v[200:203], v2, s[48:51], s69 offen sc1
s_add_u32 s69, s88, 657408
buffer_load_dwordx4 v[204:207], v2, s[48:51], s69 offen sc1
s_add_u32 s69, s88, 780288
buffer_load_dwordx4 v[208:211], v2, s[48:51], s69 offen sc1
s_add_u32 s69, s88, 903168
buffer_load_dwordx4 v[212:215], v2, s[48:51], s69 offen sc1
s_add_u32 s69, s88, 1026048
buffer_load_dwordx4 v[216:219], v2, s[48:51], s69 offen sc1
s_add_u32 s69, s88, 1148928
buffer_load_dwordx4 v[220:223], v2, s[48:51], s69 offen sc1
s_mul_i32 s68, s66, 3
s_add_u32 s68, s68, 1
s_lshr_b32 s69, s68, 3
s_mul_i32 s69, s69, 81920
s_bitcmp1_b32 s68, 0
s_cselect_b32 s73, 40960, 0
s_add_u32 s69, s69, s73
s_and_b32 s68, s68, 6
s_lshl_b32 s68, s68, 5
s_add_u32 s69, s69, s68
s_add_u32 s69, s69, s80
s_add_u32 s69, s69, 768
s_waitcnt vmcnt(15)
v_lshlrev_b32 v8, 16, v160
v_and_b32 v9, 0xffff0000, v160
v_lshlrev_b32 v10, 16, v161
v_and_b32 v11, 0xffff0000, v161
v_lshlrev_b32 v12, 16, v162
v_and_b32 v13, 0xffff0000, v162
v_lshlrev_b32 v14, 16, v163
v_and_b32 v15, 0xffff0000, v163
s_waitcnt vmcnt(14)
v_lshlrev_b32 v56, 16, v164
v_and_b32 v57, 0xffff0000, v164
v_lshlrev_b32 v58, 16, v165
v_and_b32 v59, 0xffff0000, v165
v_lshlrev_b32 v60, 16, v166
v_and_b32 v61, 0xffff0000, v166
v_lshlrev_b32 v62, 16, v167
v_and_b32 v63, 0xffff0000, v167
v_pk_add_f32 v[8:9], v[8:9], v[56:57]
v_pk_add_f32 v[10:11], v[10:11], v[58:59]
v_pk_add_f32 v[12:13], v[12:13], v[60:61]
v_pk_add_f32 v[14:15], v[14:15], v[62:63]
s_waitcnt vmcnt(13)
v_lshlrev_b32 v56, 16, v168
v_and_b32 v57, 0xffff0000, v168
v_lshlrev_b32 v58, 16, v169
v_and_b32 v59, 0xffff0000, v169
v_lshlrev_b32 v60, 16, v170
v_and_b32 v61, 0xffff0000, v170
v_lshlrev_b32 v62, 16, v171
v_and_b32 v63, 0xffff0000, v171
v_pk_add_f32 v[8:9], v[8:9], v[56:57]
v_pk_add_f32 v[10:11], v[10:11], v[58:59]
v_pk_add_f32 v[12:13], v[12:13], v[60:61]
v_pk_add_f32 v[14:15], v[14:15], v[62:63]
s_waitcnt vmcnt(12)
v_lshlrev_b32 v56, 16, v172
v_and_b32 v57, 0xffff0000, v172
v_lshlrev_b32 v58, 16, v173
v_and_b32 v59, 0xffff0000, v173
v_lshlrev_b32 v60, 16, v174
v_and_b32 v61, 0xffff0000, v174
v_lshlrev_b32 v62, 16, v175
v_and_b32 v63, 0xffff0000, v175
v_pk_add_f32 v[8:9], v[8:9], v[56:57]
v_pk_add_f32 v[10:11], v[10:11], v[58:59]
v_pk_add_f32 v[12:13], v[12:13], v[60:61]
v_pk_add_f32 v[14:15], v[14:15], v[62:63]
s_waitcnt vmcnt(11)
v_lshlrev_b32 v56, 16, v176
v_and_b32 v57, 0xffff0000, v176
v_lshlrev_b32 v58, 16, v177
v_and_b32 v59, 0xffff0000, v177
v_lshlrev_b32 v60, 16, v178
v_and_b32 v61, 0xffff0000, v178
v_lshlrev_b32 v62, 16, v179
v_and_b32 v63, 0xffff0000, v179
v_pk_add_f32 v[8:9], v[8:9], v[56:57]
v_pk_add_f32 v[10:11], v[10:11], v[58:59]
v_pk_add_f32 v[12:13], v[12:13], v[60:61]
v_pk_add_f32 v[14:15], v[14:15], v[62:63]
s_waitcnt vmcnt(10)
v_lshlrev_b32 v56, 16, v180
v_and_b32 v57, 0xffff0000, v180
v_lshlrev_b32 v58, 16, v181
v_and_b32 v59, 0xffff0000, v181
v_lshlrev_b32 v60, 16, v182
v_and_b32 v61, 0xffff0000, v182
v_lshlrev_b32 v62, 16, v183
v_and_b32 v63, 0xffff0000, v183
v_pk_add_f32 v[8:9], v[8:9], v[56:57]
v_pk_add_f32 v[10:11], v[10:11], v[58:59]
v_pk_add_f32 v[12:13], v[12:13], v[60:61]
v_pk_add_f32 v[14:15], v[14:15], v[62:63]
s_waitcnt vmcnt(9)
v_lshlrev_b32 v56, 16, v184
v_and_b32 v57, 0xffff0000, v184
v_lshlrev_b32 v58, 16, v185
v_and_b32 v59, 0xffff0000, v185
v_lshlrev_b32 v60, 16, v186
v_and_b32 v61, 0xffff0000, v186
v_lshlrev_b32 v62, 16, v187
v_and_b32 v63, 0xffff0000, v187
v_pk_add_f32 v[8:9], v[8:9], v[56:57]
v_pk_add_f32 v[10:11], v[10:11], v[58:59]
v_pk_add_f32 v[12:13], v[12:13], v[60:61]
v_pk_add_f32 v[14:15], v[14:15], v[62:63]
s_waitcnt vmcnt(8)
v_lshlrev_b32 v56, 16, v188
v_and_b32 v57, 0xffff0000, v188
v_lshlrev_b32 v58, 16, v189
v_and_b32 v59, 0xffff0000, v189
v_lshlrev_b32 v60, 16, v190
v_and_b32 v61, 0xffff0000, v190
v_lshlrev_b32 v62, 16, v191
v_and_b32 v63, 0xffff0000, v191
v_pk_add_f32 v[8:9], v[8:9], v[56:57]
v_pk_add_f32 v[10:11], v[10:11], v[58:59]
v_pk_add_f32 v[12:13], v[12:13], v[60:61]
v_pk_add_f32 v[14:15], v[14:15], v[62:63]
v_cvt_pk_bf16_f32 v160, v8, v9
v_cvt_pk_bf16_f32 v161, v10, v11
v_cvt_pk_bf16_f32 v162, v12, v13
v_cvt_pk_bf16_f32 v163, v14, v15
buffer_store_dwordx2 v[160:161], v3, s[60:63], s69 offen
buffer_store_dwordx2 v[162:163], v3, s[60:63], s69 offen offset:32
s_mul_i32 s68, s66, 3
s_add_u32 s68, s68, 2
s_lshr_b32 s69, s68, 3
s_mul_i32 s69, s69, 81920
s_bitcmp1_b32 s68, 0
s_cselect_b32 s73, 40960, 0
s_add_u32 s69, s69, s73
s_and_b32 s68, s68, 6
s_lshl_b32 s68, s68, 5
s_add_u32 s69, s69, s68
s_add_u32 s69, s69, s80
s_add_u32 s69, s69, 256
s_waitcnt vmcnt(9)
v_lshlrev_b32 v8, 16, v192
v_and_b32 v9, 0xffff0000, v192
v_lshlrev_b32 v10, 16, v193
v_and_b32 v11, 0xffff0000, v193
v_lshlrev_b32 v12, 16, v194
v_and_b32 v13, 0xffff0000, v194
v_lshlrev_b32 v14, 16, v195
v_and_b32 v15, 0xffff0000, v195
s_waitcnt vmcnt(8)
v_lshlrev_b32 v56, 16, v196
v_and_b32 v57, 0xffff0000, v196
v_lshlrev_b32 v58, 16, v197
v_and_b32 v59, 0xffff0000, v197
v_lshlrev_b32 v60, 16, v198
v_and_b32 v61, 0xffff0000, v198
v_lshlrev_b32 v62, 16, v199
v_and_b32 v63, 0xffff0000, v199
v_pk_add_f32 v[8:9], v[8:9], v[56:57]
v_pk_add_f32 v[10:11], v[10:11], v[58:59]
v_pk_add_f32 v[12:13], v[12:13], v[60:61]
v_pk_add_f32 v[14:15], v[14:15], v[62:63]
s_waitcnt vmcnt(7)
v_lshlrev_b32 v56, 16, v200
v_and_b32 v57, 0xffff0000, v200
v_lshlrev_b32 v58, 16, v201
v_and_b32 v59, 0xffff0000, v201
v_lshlrev_b32 v60, 16, v202
v_and_b32 v61, 0xffff0000, v202
v_lshlrev_b32 v62, 16, v203
v_and_b32 v63, 0xffff0000, v203
v_pk_add_f32 v[8:9], v[8:9], v[56:57]
v_pk_add_f32 v[10:11], v[10:11], v[58:59]
v_pk_add_f32 v[12:13], v[12:13], v[60:61]
v_pk_add_f32 v[14:15], v[14:15], v[62:63]
s_waitcnt vmcnt(6)
v_lshlrev_b32 v56, 16, v204
v_and_b32 v57, 0xffff0000, v204
v_lshlrev_b32 v58, 16, v205
v_and_b32 v59, 0xffff0000, v205
v_lshlrev_b32 v60, 16, v206
v_and_b32 v61, 0xffff0000, v206
v_lshlrev_b32 v62, 16, v207
v_and_b32 v63, 0xffff0000, v207
v_pk_add_f32 v[8:9], v[8:9], v[56:57]
v_pk_add_f32 v[10:11], v[10:11], v[58:59]
v_pk_add_f32 v[12:13], v[12:13], v[60:61]
v_pk_add_f32 v[14:15], v[14:15], v[62:63]
s_waitcnt vmcnt(5)
v_lshlrev_b32 v56, 16, v208
v_and_b32 v57, 0xffff0000, v208
v_lshlrev_b32 v58, 16, v209
v_and_b32 v59, 0xffff0000, v209
v_lshlrev_b32 v60, 16, v210
v_and_b32 v61, 0xffff0000, v210
v_lshlrev_b32 v62, 16, v211
v_and_b32 v63, 0xffff0000, v211
v_pk_add_f32 v[8:9], v[8:9], v[56:57]
v_pk_add_f32 v[10:11], v[10:11], v[58:59]
v_pk_add_f32 v[12:13], v[12:13], v[60:61]
v_pk_add_f32 v[14:15], v[14:15], v[62:63]
s_waitcnt vmcnt(4)
v_lshlrev_b32 v56, 16, v212
v_and_b32 v57, 0xffff0000, v212
v_lshlrev_b32 v58, 16, v213
v_and_b32 v59, 0xffff0000, v213
v_lshlrev_b32 v60, 16, v214
v_and_b32 v61, 0xffff0000, v214
v_lshlrev_b32 v62, 16, v215
v_and_b32 v63, 0xffff0000, v215
v_pk_add_f32 v[8:9], v[8:9], v[56:57]
v_pk_add_f32 v[10:11], v[10:11], v[58:59]
v_pk_add_f32 v[12:13], v[12:13], v[60:61]
v_pk_add_f32 v[14:15], v[14:15], v[62:63]
s_waitcnt vmcnt(3)
v_lshlrev_b32 v56, 16, v216
v_and_b32 v57, 0xffff0000, v216
v_lshlrev_b32 v58, 16, v217
v_and_b32 v59, 0xffff0000, v217
v_lshlrev_b32 v60, 16, v218
v_and_b32 v61, 0xffff0000, v218
v_lshlrev_b32 v62, 16, v219
v_and_b32 v63, 0xffff0000, v219
v_pk_add_f32 v[8:9], v[8:9], v[56:57]
v_pk_add_f32 v[10:11], v[10:11], v[58:59]
v_pk_add_f32 v[12:13], v[12:13], v[60:61]
v_pk_add_f32 v[14:15], v[14:15], v[62:63]
s_waitcnt vmcnt(2)
v_lshlrev_b32 v56, 16, v220
v_and_b32 v57, 0xffff0000, v220
v_lshlrev_b32 v58, 16, v221
v_and_b32 v59, 0xffff0000, v221
v_lshlrev_b32 v60, 16, v222
v_and_b32 v61, 0xffff0000, v222
v_lshlrev_b32 v62, 16, v223
v_and_b32 v63, 0xffff0000, v223
v_pk_add_f32 v[8:9], v[8:9], v[56:57]
v_pk_add_f32 v[10:11], v[10:11], v[58:59]
v_pk_add_f32 v[12:13], v[12:13], v[60:61]
v_pk_add_f32 v[14:15], v[14:15], v[62:63]
v_cvt_pk_bf16_f32 v192, v8, v9
v_cvt_pk_bf16_f32 v193, v10, v11
v_cvt_pk_bf16_f32 v194, v12, v13
v_cvt_pk_bf16_f32 v195, v14, v15
buffer_store_dwordx2 v[192:193], v3, s[60:63], s69 offen
buffer_store_dwordx2 v[194:195], v3, s[60:63], s69 offen offset:32
s_endpgm
L_red3:
s_barrier
s_add_u32 s69, s88, 337920
buffer_load_dwordx4 v[160:163], v2, s[48:51], s69 offen sc1
s_add_u32 s69, s88, 460800
buffer_load_dwordx4 v[164:167], v2, s[48:51], s69 offen sc1
s_add_u32 s69, s88, 583680
buffer_load_dwordx4 v[168:171], v2, s[48:51], s69 offen sc1
s_add_u32 s69, s88, 706560
buffer_load_dwordx4 v[172:175], v2, s[48:51], s69 offen sc1
s_add_u32 s69, s88, 829440
buffer_load_dwordx4 v[176:179], v2, s[48:51], s69 offen sc1
s_add_u32 s69, s88, 952320
buffer_load_dwordx4 v[180:183], v2, s[48:51], s69 offen sc1
s_add_u32 s69, s88, 1075200
buffer_load_dwordx4 v[184:187], v2, s[48:51], s69 offen sc1
s_add_u32 s69, s88, 1198080
buffer_load_dwordx4 v[188:191], v2, s[48:51], s69 offen sc1
s_mul_i32 s68, s66, 3
s_add_u32 s68, s68, 2
s_lshr_b32 s69, s68, 3
s_mul_i32 s69, s69, 81920
s_bitcmp1_b32 s68, 0
s_cselect_b32 s73, 40960, 0
s_add_u32 s69, s69, s73
s_and_b32 s68, s68, 6
s_lshl_b32 s68, s68, 5
s_add_u32 s69, s69, s68
s_add_u32 s69, s69, s80
s_add_u32 s69, s69, 768
s_waitcnt vmcnt(7)
v_lshlrev_b32 v8, 16, v160
v_and_b32 v9, 0xffff0000, v160
v_lshlrev_b32 v10, 16, v161
v_and_b32 v11, 0xffff0000, v161
v_lshlrev_b32 v12, 16, v162
v_and_b32 v13, 0xffff0000, v162
v_lshlrev_b32 v14, 16, v163
v_and_b32 v15, 0xffff0000, v163
s_waitcnt vmcnt(6)
v_lshlrev_b32 v56, 16, v164
v_and_b32 v57, 0xffff0000, v164
v_lshlrev_b32 v58, 16, v165
v_and_b32 v59, 0xffff0000, v165
v_lshlrev_b32 v60, 16, v166
v_and_b32 v61, 0xffff0000, v166
v_lshlrev_b32 v62, 16, v167
v_and_b32 v63, 0xffff0000, v167
v_pk_add_f32 v[8:9], v[8:9], v[56:57]
v_pk_add_f32 v[10:11], v[10:11], v[58:59]
v_pk_add_f32 v[12:13], v[12:13], v[60:61]
v_pk_add_f32 v[14:15], v[14:15], v[62:63]
s_waitcnt vmcnt(5)
v_lshlrev_b32 v56, 16, v168
v_and_b32 v57, 0xffff0000, v168
v_lshlrev_b32 v58, 16, v169
v_and_b32 v59, 0xffff0000, v169
v_lshlrev_b32 v60, 16, v170
v_and_b32 v61, 0xffff0000, v170
v_lshlrev_b32 v62, 16, v171
v_and_b32 v63, 0xffff0000, v171
v_pk_add_f32 v[8:9], v[8:9], v[56:57]
v_pk_add_f32 v[10:11], v[10:11], v[58:59]
v_pk_add_f32 v[12:13], v[12:13], v[60:61]
v_pk_add_f32 v[14:15], v[14:15], v[62:63]
s_waitcnt vmcnt(4)
v_lshlrev_b32 v56, 16, v172
v_and_b32 v57, 0xffff0000, v172
v_lshlrev_b32 v58, 16, v173
v_and_b32 v59, 0xffff0000, v173
v_lshlrev_b32 v60, 16, v174
v_and_b32 v61, 0xffff0000, v174
v_lshlrev_b32 v62, 16, v175
v_and_b32 v63, 0xffff0000, v175
v_pk_add_f32 v[8:9], v[8:9], v[56:57]
v_pk_add_f32 v[10:11], v[10:11], v[58:59]
v_pk_add_f32 v[12:13], v[12:13], v[60:61]
v_pk_add_f32 v[14:15], v[14:15], v[62:63]
s_waitcnt vmcnt(3)
v_lshlrev_b32 v56, 16, v176
v_and_b32 v57, 0xffff0000, v176
v_lshlrev_b32 v58, 16, v177
v_and_b32 v59, 0xffff0000, v177
v_lshlrev_b32 v60, 16, v178
v_and_b32 v61, 0xffff0000, v178
v_lshlrev_b32 v62, 16, v179
v_and_b32 v63, 0xffff0000, v179
v_pk_add_f32 v[8:9], v[8:9], v[56:57]
v_pk_add_f32 v[10:11], v[10:11], v[58:59]
v_pk_add_f32 v[12:13], v[12:13], v[60:61]
v_pk_add_f32 v[14:15], v[14:15], v[62:63]
s_waitcnt vmcnt(2)
v_lshlrev_b32 v56, 16, v180
v_and_b32 v57, 0xffff0000, v180
v_lshlrev_b32 v58, 16, v181
v_and_b32 v59, 0xffff0000, v181
v_lshlrev_b32 v60, 16, v182
v_and_b32 v61, 0xffff0000, v182
v_lshlrev_b32 v62, 16, v183
v_and_b32 v63, 0xffff0000, v183
v_pk_add_f32 v[8:9], v[8:9], v[56:57]
v_pk_add_f32 v[10:11], v[10:11], v[58:59]
v_pk_add_f32 v[12:13], v[12:13], v[60:61]
v_pk_add_f32 v[14:15], v[14:15], v[62:63]
s_waitcnt vmcnt(1)
v_lshlrev_b32 v56, 16, v184
v_and_b32 v57, 0xffff0000, v184
v_lshlrev_b32 v58, 16, v185
v_and_b32 v59, 0xffff0000, v185
v_lshlrev_b32 v60, 16, v186
v_and_b32 v61, 0xffff0000, v186
v_lshlrev_b32 v62, 16, v187
v_and_b32 v63, 0xffff0000, v187
v_pk_add_f32 v[8:9], v[8:9], v[56:57]
v_pk_add_f32 v[10:11], v[10:11], v[58:59]
v_pk_add_f32 v[12:13], v[12:13], v[60:61]
v_pk_add_f32 v[14:15], v[14:15], v[62:63]
s_waitcnt vmcnt(0)
v_lshlrev_b32 v56, 16, v188
v_and_b32 v57, 0xffff0000, v188
v_lshlrev_b32 v58, 16, v189
v_and_b32 v59, 0xffff0000, v189
v_lshlrev_b32 v60, 16, v190
v_and_b32 v61, 0xffff0000, v190
v_lshlrev_b32 v62, 16, v191
v_and_b32 v63, 0xffff0000, v191
v_pk_add_f32 v[8:9], v[8:9], v[56:57]
v_pk_add_f32 v[10:11], v[10:11], v[58:59]
v_pk_add_f32 v[12:13], v[12:13], v[60:61]
v_pk_add_f32 v[14:15], v[14:15], v[62:63]
v_cvt_pk_bf16_f32 v160, v8, v9
v_cvt_pk_bf16_f32 v161, v10, v11
v_cvt_pk_bf16_f32 v162, v12, v13
v_cvt_pk_bf16_f32 v163, v14, v15
buffer_store_dwordx2 v[160:161], v3, s[60:63], s69 offen
buffer_store_dwordx2 v[162:163], v3, s[60:63], s69 offen offset:32
s_endpgm
L_code_end:
.fill 8192, 4, 0xbf800000
.section .rodata,"a"
.p2align 6
.amdhsa_kernel concat_heads__mha_block_cached__gqa_block_cached__near_ridge_kernel
  .amdhsa_next_free_vgpr 256
  .amdhsa_next_free_sgpr 102
  .amdhsa_accum_offset 256
  .amdhsa_group_segment_fixed_size 0
  .amdhsa_kernarg_size 104
  .amdhsa_user_sgpr_count 2
  .amdhsa_user_sgpr_kernarg_segment_ptr 1
  .amdhsa_system_sgpr_workgroup_id_x 1
.end_amdhsa_kernel
```
